```python
import torch

def _softmax(x, axis=-1):
    return torch.softmax(x, dim=axis)
def _gelu(x):
    return torch.nn.functional.gelu(x, approximate="tanh")
def _silu(x):
    return torch.nn.functional.silu(x)
def _sigmoid(x):
    return torch.sigmoid(x)
def _layernorm(x, axis=-1, eps=1e-5):
    m = x.mean(dim=axis, keepdim=True)
    v = x.var(dim=axis, keepdim=True, unbiased=False)
    return (x - m) / torch.sqrt(v + eps)
def _scatter_add(tgt, idx, src, axis=0):
    return tgt.clone().index_add_(axis, idx, src)
def _segment_sum(src, seg, n):
    out = torch.zeros((n,) + src.shape[1:], dtype=src.dtype)
    return out.index_add_(0, seg, src)
def _pad(x, pw):
    flat = tuple(v for pair in reversed(pw) for v in pair)
    return torch.nn.functional.pad(x, flat)

kernel_name = 'recurrent_scan__sliding_block_cached__dense_activation_silu__prompt'

def setup_inputs():

    _w = (lambda a: (lambda t: t.to(torch.bfloat16) if t.is_floating_point() else t)(torch.as_tensor(a)))
    def _A_setup():
        B, Sq, D = 1, 2048, 576
        Hq, Hkv, Sk, Dh = 32, 16, 2048, 128
        assert Hq % Hkv == 0, (Hq, Hkv)
        return {
            "x": _w((lambda *s: torch.randn(*s, dtype=torch.bfloat16) * 0.05)(B, Sq, D)),
            "k_cache": _w((lambda *s: torch.randn(*s, dtype=torch.bfloat16) * 1.6)(B, Hkv, Sk, Dh)),
            "v_cache": _w((lambda *s: torch.randn(*s, dtype=torch.bfloat16) * 0.8)(B, Hkv, Sk, Dh)),
            "wq": _w((lambda *s: torch.randn(*s, dtype=torch.bfloat16) * 1.6)(D, Hq * Dh) * (D ** -0.5)),
            "wo": _w((lambda *s: torch.randn(*s, dtype=torch.bfloat16) * 0.8)(Hq * Dh, D) * ((Hq * Dh) ** -0.5)),
        }
    _A_in = _A_setup()

    def _B_setup():
        B, S, D, F = 1, 2048, 576, 4608
        return {
            "x": _w((lambda *s: torch.randn(*s, dtype=torch.bfloat16) * 0.05)(B, S, D)),
            "w1": _w((lambda *s: torch.randn(*s, dtype=torch.bfloat16) * 1.6)(D, F) * (D ** -0.5)),
            "w2": _w((lambda *s: torch.randn(*s, dtype=torch.bfloat16) * 0.2)(F, D) * (F ** -0.5)),
        }
    _B_in = _B_setup()

    return {
        "A_x": _A_in["x"],
        "A_k_cache": _A_in["k_cache"],
        "A_v_cache": _A_in["v_cache"],
        "A_wq": _A_in["wq"],
        "A_wo": _A_in["wo"],
        "B_x": _B_in["x"],
        "B_w1": _B_in["w1"],
        "B_w2": _B_in["w2"],
    }

def reference(A_x, A_k_cache, A_v_cache, A_wq, A_wo, B_x, B_w1, B_w2):
    def _A_ref(x, k_cache, v_cache, wq, wo):
        B, Sq, D = x.shape
        Hq, Dh = 32, 128
        Hkv, Sk = k_cache.shape[1], k_cache.shape[2]
        W = min(4096, max(256, Sk // 4))
        rep = Hq // Hkv
        q = (lambda x, *d: x.permute(*d))((x @ wq).reshape(B, Sq, Hq, Dh), 0, 2, 1, 3)
        k = (lambda x, n, axis: torch.repeat_interleave(x, n, dim=axis))(k_cache[:, :, Sk - W:, :], rep, axis=1)
        v = (lambda x, n, axis: torch.repeat_interleave(x, n, dim=axis))(v_cache[:, :, Sk - W:, :], rep, axis=1)
        scores = torch.einsum("bhqd,bhkd->bhqk", q, k) * (Dh ** -0.5)
        p = _softmax(scores, axis=-1)
        o = torch.einsum("bhqk,bhkd->bhqd", p, v)
        return (lambda x, *d: x.permute(*d))(o, 0, 2, 1, 3).reshape(B, Sq, Hq * Dh) @ wo

    def _B_ref(x, w1, w2):
        h = torch.einsum("bsd,df->bsf", x, w1)
        h = _silu(h)
        out = torch.einsum("bsf,fd->bsd", h, w2)
        return out

    x = A_x
    xn = _layernorm(x, axis=-1)
    s = _A_ref(xn, A_k_cache, A_v_cache, A_wq, A_wo)
    g = _silu(_B_ref(xn, B_w1, B_w2))
    return x + s * g
```

```asm
; @launch grid=(256,1,1) block=(256,1,1) lds=163840
.amdgcn_target "amdgcn-amd-amdhsa--gfx950"
.set CODE_BYTES, L_code_end - recurrent_scan__sliding_block_cached__dense_activation_silu__prompt_kernel
.text
.globl recurrent_scan__sliding_block_cached__dense_activation_silu__prompt_kernel
.p2align 8
.type recurrent_scan__sliding_block_cached__dense_activation_silu__prompt_kernel,@function
recurrent_scan__sliding_block_cached__dense_activation_silu__prompt_kernel:
  s_cmp_ge_u32 s2, 256
  s_cbranch_scc1 L_end
  s_load_dwordx16 s[44:59], s[0:1], 0
  s_load_dwordx4 s[60:63], s[0:1], 64
  s_load_dwordx2 s[64:65], s[0:1], 80
  v_lshrrev_b32 v38, 6, v0
  v_and_b32 v39, 63, v0
  v_readfirstlane_b32 s3, v38
  s_getpc_b64 s[72:73]
L_pc_entry:
  s_mov_b32 s74, L_attn_start-L_pc_entry
  s_mov_b32 s75, 0x20000
  s_lshr_b32 s6, s2, 3
  s_lshl_b32 s6, s6, 2
  s_add_u32 s6, s6, s3
  s_mul_i32 s6, s6, 384
  v_lshlrev_b32 v46, 7, v39
  s_mov_b64 exec, 7
  buffer_load_dword v73, v46, s[72:75], s6 offen
  s_mov_b64 exec, -1
  v_and_b32 v40, 7, v39
  s_lshl_b32 s6, s2, 3
  v_add_u32 v42, s6, v40
  v_mul_u32_u24 v42, 1152, v42
  v_lshrrev_b32 v41, 3, v39
  v_lshlrev_b32 v43, 4, v41
  v_add_u32 v42, v42, v43
  s_lshl_b32 s6, s3, 7
  v_add_u32 v42, s6, v42
  s_mov_b32 s10, 2359296
  s_mov_b32 s11, 0x20000
  s_waitcnt lgkmcnt(0)
  s_mov_b32 s8, s44
  s_mov_b32 s9, s45
  s_mov_b32 s96, s62
  s_mov_b32 s97, s63
  s_mov_b32 s98, 256
  s_mov_b32 s99, 0x20000
  v_mov_b32 v45, 0
  s_lshr_b32 s6, s2, 3
  s_and_b32 s7, s2, 7
  s_cmp_lg_u32 s3, 3
  s_cbranch_scc1 L_ln
  s_cmp_lg_u32 s2, 0
  s_cbranch_scc1 L_warm
  s_memrealtime s[70:71]
  s_waitcnt lgkmcnt(0)
  s_or_b32 s70, s70, 1
  v_mov_b32 v44, s70
  s_mov_b64 exec, 1
  buffer_store_dword v44, v45, s[96:99], 0 offen sc1
  s_mov_b64 exec, -1
  s_branch L_warm
L_ln:
  buffer_load_dwordx4 v[80:83], v42, s[8:11], 0 offen offset:0
  buffer_load_dwordx4 v[84:87], v42, s[8:11], 0 offen offset:384
  buffer_load_dwordx4 v[88:91], v42, s[8:11], 0 offen offset:768
  s_waitcnt vmcnt(0)
  v_lshlrev_b32 v112, 16, v80
  v_and_b32 v113, 0xffff0000, v80
  v_lshlrev_b32 v114, 16, v81
  v_and_b32 v115, 0xffff0000, v81
  v_lshlrev_b32 v116, 16, v82
  v_and_b32 v117, 0xffff0000, v82
  v_lshlrev_b32 v118, 16, v83
  v_and_b32 v119, 0xffff0000, v83
  v_lshlrev_b32 v120, 16, v84
  v_and_b32 v121, 0xffff0000, v84
  v_lshlrev_b32 v122, 16, v85
  v_and_b32 v123, 0xffff0000, v85
  v_lshlrev_b32 v124, 16, v86
  v_and_b32 v125, 0xffff0000, v86
  v_lshlrev_b32 v126, 16, v87
  v_and_b32 v127, 0xffff0000, v87
  v_lshlrev_b32 v128, 16, v88
  v_and_b32 v129, 0xffff0000, v88
  v_lshlrev_b32 v130, 16, v89
  v_and_b32 v131, 0xffff0000, v89
  v_lshlrev_b32 v132, 16, v90
  v_and_b32 v133, 0xffff0000, v90
  v_lshlrev_b32 v134, 16, v91
  v_and_b32 v135, 0xffff0000, v91
  v_add_f32 v42, v112, v113
  v_mul_f32 v43, v112, v112
  v_add_f32 v44, v114, v115
  v_mul_f32 v45, v113, v113
  v_fmac_f32 v43, v114, v114
  v_fmac_f32 v45, v115, v115
  v_add_f32 v42, v42, v116
  v_fmac_f32 v43, v116, v116
  v_add_f32 v44, v44, v117
  v_fmac_f32 v45, v117, v117
  v_add_f32 v42, v42, v118
  v_fmac_f32 v43, v118, v118
  v_add_f32 v44, v44, v119
  v_fmac_f32 v45, v119, v119
  v_add_f32 v42, v42, v120
  v_fmac_f32 v43, v120, v120
  v_add_f32 v44, v44, v121
  v_fmac_f32 v45, v121, v121
  v_add_f32 v42, v42, v122
  v_fmac_f32 v43, v122, v122
  v_add_f32 v44, v44, v123
  v_fmac_f32 v45, v123, v123
  v_add_f32 v42, v42, v124
  v_fmac_f32 v43, v124, v124
  v_add_f32 v44, v44, v125
  v_fmac_f32 v45, v125, v125
  v_add_f32 v42, v42, v126
  v_fmac_f32 v43, v126, v126
  v_add_f32 v44, v44, v127
  v_fmac_f32 v45, v127, v127
  v_add_f32 v42, v42, v128
  v_fmac_f32 v43, v128, v128
  v_add_f32 v44, v44, v129
  v_fmac_f32 v45, v129, v129
  v_add_f32 v42, v42, v130
  v_fmac_f32 v43, v130, v130
  v_add_f32 v44, v44, v131
  v_fmac_f32 v45, v131, v131
  v_add_f32 v42, v42, v132
  v_fmac_f32 v43, v132, v132
  v_add_f32 v44, v44, v133
  v_fmac_f32 v45, v133, v133
  v_add_f32 v42, v42, v134
  v_fmac_f32 v43, v134, v134
  v_add_f32 v44, v44, v135
  v_fmac_f32 v45, v135, v135
  v_add_f32 v42, v42, v44
  v_add_f32 v43, v43, v45
  s_nop 0
  v_add_f32_dpp v42, v42, v42 row_ror:8 row_mask:0xf bank_mask:0xf
  v_add_f32_dpp v43, v43, v43 row_ror:8 row_mask:0xf bank_mask:0xf
  v_mov_b32 v44, v42
  v_mov_b32 v45, v43
  s_nop 0
  v_permlane16_swap_b32 v42, v44
  v_permlane16_swap_b32 v43, v45
  v_add_f32 v42, v42, v44
  v_add_f32 v43, v43, v45
  v_mov_b32 v44, v42
  v_mov_b32 v45, v43
  s_nop 0
  v_permlane32_swap_b32 v42, v44
  v_permlane32_swap_b32 v43, v45
  v_add_f32 v42, v42, v44
  v_add_f32 v43, v43, v45
  v_lshlrev_b32 v46, 5, v40
  v_add_u32 v46, 160768, v46
  s_lshl_b32 s70, s3, 3
  v_add_u32 v47, s70, v46
  ds_write_b64 v47, v[42:43]
  s_lshr_b32 s70, s2, 3
  s_mul_i32 s70, s70, 18
  s_lshl_b32 s71, s3, 1
  s_add_u32 s70, s70, s71
  s_lshl_b32 s70, s70, 12
  s_bfe_u32 s71, s2, 0x20001
  s_lshl_b32 s71, s71, 10
  s_add_u32 s70, s70, s71
  s_and_b32 s71, s2, 1
  s_lshl_b32 s71, s71, 7
  s_add_u32 s70, s70, s71
  v_lshrrev_b32 v38, 5, v39
  v_lshlrev_b32 v38, 12, v38
  v_and_b32 v41, 3, v41
  v_lshlrev_b32 v41, 8, v41
  v_add_u32 v38, v38, v41
  v_lshlrev_b32 v41, 4, v40
  v_add_u32 v38, v38, v41
  v_add_u32 v38, s70, v38
  s_mov_b32 s16, s64
  s_mov_b32 s17, s65
  s_mov_b32 s18, 2359296
  s_mov_b32 s19, 0x20000
  s_waitcnt lgkmcnt(0)
  s_barrier
  ds_read_b128 v[144:147], v46
  ds_read_b64 v[148:149], v46 offset:16
  s_mov_b32 s70, 0x3ae38e39
  s_waitcnt lgkmcnt(0)
  v_add_f32 v144, v144, v146
  v_add_f32 v145, v145, v147
  v_add_f32 v144, v144, v148
  v_add_f32 v145, v145, v149
  v_mul_f32 v47, s70, v144
  v_mul_f32 v45, s70, v145
  v_fma_f32 v45, -v47, v47, v45
  v_max_f32 v45, 0, v45
  v_cvt_pk_bf16_f32 v45, v45, v45
  v_lshlrev_b32 v45, 16, v45
  v_cvt_pk_bf16_f32 v47, v47, v47
  v_lshlrev_b32 v47, 16, v47
  v_add_f32 v45, 0x3727c5ac, v45
  v_cvt_pk_bf16_f32 v45, v45, v45
  v_lshlrev_b32 v45, 16, v45
  v_sqrt_f32 v45, v45
  s_nop 0
  v_cvt_pk_bf16_f32 v45, v45, v45
  v_lshlrev_b32 v45, 16, v45
  v_rcp_f32 v45, v45
  s_nop 0
  v_mul_f32 v45, 0x3fb8aa3b, v45
  v_mul_f32 v47, v47, v45
  v_fma_f32 v112, v112, v45, -v47
  v_fma_f32 v113, v113, v45, -v47
  v_fma_f32 v114, v114, v45, -v47
  v_fma_f32 v115, v115, v45, -v47
  v_fma_f32 v116, v116, v45, -v47
  v_fma_f32 v117, v117, v45, -v47
  v_fma_f32 v118, v118, v45, -v47
  v_fma_f32 v119, v119, v45, -v47
  v_fma_f32 v120, v120, v45, -v47
  v_fma_f32 v121, v121, v45, -v47
  v_fma_f32 v122, v122, v45, -v47
  v_fma_f32 v123, v123, v45, -v47
  v_fma_f32 v124, v124, v45, -v47
  v_fma_f32 v125, v125, v45, -v47
  v_fma_f32 v126, v126, v45, -v47
  v_fma_f32 v127, v127, v45, -v47
  v_fma_f32 v128, v128, v45, -v47
  v_fma_f32 v129, v129, v45, -v47
  v_fma_f32 v130, v130, v45, -v47
  v_fma_f32 v131, v131, v45, -v47
  v_fma_f32 v132, v132, v45, -v47
  v_fma_f32 v133, v133, v45, -v47
  v_fma_f32 v134, v134, v45, -v47
  v_fma_f32 v135, v135, v45, -v47
  v_cvt_pk_bf16_f32 v80, v112, v113
  v_cvt_pk_bf16_f32 v81, v114, v115
  v_cvt_pk_bf16_f32 v82, v116, v117
  v_cvt_pk_bf16_f32 v83, v118, v119
  v_cvt_pk_bf16_f32 v84, v120, v121
  v_cvt_pk_bf16_f32 v85, v122, v123
  v_cvt_pk_bf16_f32 v86, v124, v125
  v_cvt_pk_bf16_f32 v87, v126, v127
  v_cvt_pk_bf16_f32 v88, v128, v129
  v_cvt_pk_bf16_f32 v89, v130, v131
  v_cvt_pk_bf16_f32 v90, v132, v133
  v_cvt_pk_bf16_f32 v91, v134, v135
  v_mov_b32 v44, 0
  buffer_load_dword v74, v44, s[96:99], 0 offen sc1
  s_mov_b32 s70, 24576
  s_mov_b32 s71, 49152
  buffer_store_dwordx4 v[80:83], v38, s[16:19], 0 offen sc1
  buffer_store_dwordx4 v[84:87], v38, s[16:19], s70 offen sc1
  buffer_store_dwordx4 v[88:91], v38, s[16:19], s71 offen sc1
L_ln_done:
  s_and_b32 s4, s2, 7
  s_lshl_b32 s4, s4, 2
  s_bfe_u32 s5, s2, 0x20003
  s_add_u32 s4, s4, s5
  s_lshr_b32 s5, s2, 5
  s_lshl_b32 s5, s5, 2
  s_add_u32 s5, s5, s3
  v_lshrrev_b32 v40, 4, v39
  v_and_b32 v45, 15, v39
  s_mul_i32 s70, s3, 144
  s_and_b32 s43, s4, 1
  s_lshl_b32 s71, s43, 1
  s_add_u32 s36, s70, 0
  v_add_u32 v41, s36, v39
  v_mul_u32_u24 v46, 3641, v41
  v_lshrrev_b32 v46, 16, v46
  v_mul_u32_u24 v47, 18, v46
  v_sub_u32 v41, v41, v47
  v_add_u32 v41, s71, v41
  v_subrev_u32 v47, 18, v41
  v_min_u32 v41, v41, v47
  v_lshlrev_b32 v41, 4, v41
  v_bfe_u32 v47, v46, 2, 2
  v_lshlrev_b32 v47, 3, v47
  v_and_b32 v72, 3, v46
  v_add_u32 v47, v47, v72
  v_lshrrev_b32 v46, 4, v46
  v_lshlrev_b32 v46, 2, v46
  v_add_u32 v47, v47, v46
  v_mul_u32_u24 v47, 9216, v47
  v_add_u32 v13, v47, v41
  s_add_u32 s36, s70, 64
  v_add_u32 v41, s36, v39
  v_mul_u32_u24 v46, 3641, v41
  v_lshrrev_b32 v46, 16, v46
  v_mul_u32_u24 v47, 18, v46
  v_sub_u32 v41, v41, v47
  v_add_u32 v41, s71, v41
  v_subrev_u32 v47, 18, v41
  v_min_u32 v41, v41, v47
  v_lshlrev_b32 v41, 4, v41
  v_bfe_u32 v47, v46, 2, 2
  v_lshlrev_b32 v47, 3, v47
  v_and_b32 v72, 3, v46
  v_add_u32 v47, v47, v72
  v_lshrrev_b32 v46, 4, v46
  v_lshlrev_b32 v46, 2, v46
  v_add_u32 v47, v47, v46
  v_mul_u32_u24 v47, 9216, v47
  v_add_u32 v14, v47, v41
  v_subrev_u32 v14, 1024, v14
  s_add_u32 s36, s70, 128
  v_add_u32 v41, s36, v39
  v_mul_u32_u24 v46, 3641, v41
  v_lshrrev_b32 v46, 16, v46
  v_mul_u32_u24 v47, 18, v46
  v_sub_u32 v41, v41, v47
  v_add_u32 v41, s71, v41
  v_subrev_u32 v47, 18, v41
  v_min_u32 v41, v41, v47
  v_lshlrev_b32 v41, 4, v41
  v_bfe_u32 v47, v46, 2, 2
  v_lshlrev_b32 v47, 3, v47
  v_and_b32 v72, 3, v46
  v_add_u32 v47, v47, v72
  v_lshrrev_b32 v46, 4, v46
  v_lshlrev_b32 v46, 2, v46
  v_add_u32 v47, v47, v46
  v_mul_u32_u24 v47, 9216, v47
  v_add_u32 v15, v47, v41
  v_subrev_u32 v15, 2048, v15
  s_and_b32 s36, s3, 1
  s_lshr_b32 s37, s3, 1
  s_lshl_b32 s70, s36, 4
  s_lshl_b32 s71, s37, 2
  s_add_u32 s70, s70, s71
  s_add_u32 s70, s70, 0
  v_add_u32 v46, s70, v40
  v_lshlrev_b32 v46, 13, v46
  v_lshlrev_b32 v47, 1, v40
  v_xor_b32 v47, 0, v47
  v_xor_b32 v47, v47, v45
  v_lshlrev_b32 v47, 4, v47
  v_add_u32 v11, v46, v47
  s_lshl_b32 s70, s3, 11
  v_lshlrev_b32 v46, 8, v40
  v_add_u32 v46, s70, v46
  v_add_u32 v19, v46, v47
  s_lshl_b32 s71, s36, 3
  s_add_u32 s71, s71, 0
  v_add_u32 v47, s71, v40
  v_xor_b32 v47, v47, v45
  v_lshlrev_b32 v47, 4, v47
  v_add_u32 v17, v46, v47
  s_lshl_b32 s70, s36, 4
  s_lshl_b32 s71, s37, 2
  s_add_u32 s70, s70, s71
  s_add_u32 s70, s70, 8
  v_add_u32 v46, s70, v40
  v_lshlrev_b32 v46, 13, v46
  v_lshlrev_b32 v47, 1, v40
  v_xor_b32 v47, 8, v47
  v_xor_b32 v47, v47, v45
  v_lshlrev_b32 v47, 4, v47
  v_add_u32 v12, v46, v47
  v_subrev_u32 v12, 1024, v12
  s_lshl_b32 s70, s3, 11
  v_lshlrev_b32 v46, 8, v40
  v_add_u32 v46, s70, v46
  v_add_u32 v20, v46, v47
  s_lshl_b32 s71, s36, 3
  s_add_u32 s71, s71, 4
  v_add_u32 v47, s71, v40
  v_xor_b32 v47, v47, v45
  v_lshlrev_b32 v47, 4, v47
  v_add_u32 v18, v46, v47
  s_lshl_b32 s70, s4, 8
  s_sub_u32 s71, 4718592, s70
  s_add_u32 s8, s50, s70
  s_addc_u32 s9, s51, 0
  s_mov_b32 s10, s71
  s_mov_b32 s11, 0x20000
  s_mul_i32 s70, s4, 288
  s_sub_u32 s71, 5308416, s70
  s_add_u32 s12, s56, s70
  s_addc_u32 s13, s57, 0
  s_mov_b32 s14, s71
  s_mov_b32 s15, 0x20000
  s_mov_b32 s36, 0
  s_mov_b32 s37, 0
  s_mov_b32 s38, 0
  s_lshl_b32 s42, s3, 11
  s_mov_b32 s40, s42
  s_mul_i32 s41, s3, 2304
  s_add_u32 s41, s41, 8192
  v_mov_b32 v77, 0x100000
  s_lshl_b32 s70, s2, 10
  v_mov_b32 v46, s70
  s_lshl_b32 s71, s3, 6
  v_add_u32 v47, s71, v39
  v_cmp_eq_u32 vcc, 0, v47
  s_nop 1
  v_cndmask_b32 v77, v77, v46, vcc
  s_and_b32 s70, s2, 0xe0
  v_and_b32 v45, 31, v39
  v_add_u32 v45, s70, v45
  v_lshlrev_b32 v76, 10, v45
  s_mov_b32 s55, 0
  s_mov_b32 s54, 0x400000
  s_cmp_eq_u32 s3, 3
  s_cbranch_scc1 L_skip_lnw
  s_waitcnt vmcnt(0)
  v_readfirstlane_b32 s100, v74
  s_cmp_eq_u32 s100, 0
  s_cbranch_scc1 L_nonce_retry
L_nonce_ok:
  v_mov_b32 v45, 163828
  ds_write_b32 v45, v74
  s_waitcnt lgkmcnt(0)
L_skip_lnw:
  s_add_u32 s96, s64, 117440512
  s_addc_u32 s97, s65, 0
  s_mov_b32 s98, 262144
  s_mov_b32 s99, 0x20000
  s_barrier
  v_mov_b32 v45, 163828
  ds_read_b32 v47, v45
  v_mov_b32 v75, s100
  buffer_store_dword v75, v77, s[96:99], 0 offen offset:128 sc1
  s_add_u32 m0, s41, 65536
  s_nop 0
  buffer_load_dwordx4 v13, s[12:15], s37 offen lds
  buffer_load_dwordx4 v14, s[12:15], s37 offen offset:1024 lds
  s_mov_b64 exec, 0xffff
  buffer_load_dwordx4 v15, s[12:15], s37 offen offset:2048 lds
  s_mov_b64 exec, -1
  s_add_u32 s37, s37, 294912
  s_add_u32 m0, s40, 65536
  s_nop 0
  buffer_load_dwordx4 v11, s[8:11], s36 offen lds
  buffer_load_dwordx4 v12, s[8:11], s36 offen offset:1024 lds
  s_add_u32 s36, s36, 262144
  s_add_u32 m0, s41, 82944
  s_nop 0
  buffer_load_dwordx4 v13, s[12:15], s37 offen lds
  buffer_load_dwordx4 v14, s[12:15], s37 offen offset:1024 lds
  s_mov_b64 exec, 0xffff
  buffer_load_dwordx4 v15, s[12:15], s37 offen offset:2048 lds
  s_mov_b64 exec, -1
  s_add_u32 s37, s37, 294912
  s_add_u32 m0, s40, 82944
  s_nop 0
  buffer_load_dwordx4 v11, s[8:11], s36 offen lds
  buffer_load_dwordx4 v12, s[8:11], s36 offen offset:1024 lds
  s_add_u32 s36, s36, 262144
  s_add_u32 m0, s41, 100352
  s_nop 0
  buffer_load_dwordx4 v13, s[12:15], s37 offen lds
  buffer_load_dwordx4 v14, s[12:15], s37 offen offset:1024 lds
  s_mov_b64 exec, 0xffff
  buffer_load_dwordx4 v15, s[12:15], s37 offen offset:2048 lds
  s_mov_b64 exec, -1
  s_add_u32 s37, s37, 294912
  s_add_u32 m0, s40, 100352
  s_nop 0
  buffer_load_dwordx4 v11, s[8:11], s36 offen lds
  buffer_load_dwordx4 v12, s[8:11], s36 offen offset:1024 lds
  s_add_u32 s36, s36, 262144
  s_add_u32 m0, s41, 117760
  s_nop 0
  buffer_load_dwordx4 v13, s[12:15], s37 offen lds
  buffer_load_dwordx4 v14, s[12:15], s37 offen offset:1024 lds
  s_mov_b64 exec, 0xffff
  buffer_load_dwordx4 v15, s[12:15], s37 offen offset:2048 lds
  s_mov_b64 exec, -1
  s_add_u32 s37, s37, 294912
  s_add_u32 m0, s40, 117760
  s_nop 0
  buffer_load_dwordx4 v11, s[8:11], s36 offen lds
  buffer_load_dwordx4 v12, s[8:11], s36 offen offset:1024 lds
  s_add_u32 s36, s36, 262144
  v_lshlrev_b32 v72, 7, v39
  s_waitcnt lgkmcnt(0)
  v_readfirstlane_b32 s100, v47
  v_bfe_u32 v41, v39, 2, 2
  v_and_b32 v42, 3, v39
  v_bfe_u32 v43, v39, 2, 3
  v_lshrrev_b32 v44, 2, v39
  v_lshlrev_b32 v16, 4, v39
  v_lshrrev_b32 v45, 1, v42
  v_xor_b32 v45, v45, v43
  v_lshlrev_b32 v45, 5, v45
  v_lshlrev_b32 v46, 8, v44
  v_add_u32 v45, v45, v46
  v_and_b32 v46, 1, v42
  v_lshlrev_b32 v46, 4, v46
  v_add_u32 v45, v45, v46
  v_xor_b32 v46, 0, v45
  v_add_u32 v1, 65536, v46
  v_add_u32 v5, 117760, v46
  v_xor_b32 v46, 64, v45
  v_add_u32 v2, 65536, v46
  v_add_u32 v6, 117760, v46
  v_xor_b32 v46, 128, v45
  v_add_u32 v3, 65536, v46
  v_add_u32 v7, 117760, v46
  v_xor_b32 v46, 192, v45
  v_add_u32 v4, 65536, v46
  v_add_u32 v8, 117760, v46
  v_mul_u32_u24 v45, 288, v44
  v_lshlrev_b32 v46, 3, v42
  v_add_u32 v45, v45, v46
  v_add_u32 v9, 73728, v45
  v_add_u32 v10, 125952, v45
  s_mul_i32 s70, s5, 73728
  s_add_u32 s16, s64, s70
  s_addc_u32 s17, s65, 0
  s_mov_b32 s18, 73728
  s_mov_b32 s19, 0x20000
  buffer_load_dword v74, v76, s[96:99], 0 offen offset:128 sc1
  s_waitcnt vmcnt(0)
  v_cmp_eq_u32 vcc, s100, v74
  s_cmp_eq_u64 vcc, -1
  s_cbranch_scc0 L_retry0
L_back0:
  buffer_load_dwordx4 a[128:131], v16, s[16:19], s38 offen offset:0 sc1
  buffer_load_dwordx4 a[132:135], v16, s[16:19], s38 offen offset:1024 sc1
  buffer_load_dwordx4 a[136:139], v16, s[16:19], s38 offen offset:2048 sc1
  buffer_load_dwordx4 a[140:143], v16, s[16:19], s38 offen offset:3072 sc1
  s_add_u32 s38, s38, 4096
  buffer_load_dwordx4 a[144:147], v16, s[16:19], s38 offen offset:0 sc1
  buffer_load_dwordx4 a[148:151], v16, s[16:19], s38 offen offset:1024 sc1
  buffer_load_dwordx4 a[152:155], v16, s[16:19], s38 offen offset:2048 sc1
  buffer_load_dwordx4 a[156:159], v16, s[16:19], s38 offen offset:3072 sc1
  s_add_u32 s38, s38, 4096
  buffer_load_dwordx4 a[160:163], v16, s[16:19], s38 offen offset:0 sc1
  buffer_load_dwordx4 a[164:167], v16, s[16:19], s38 offen offset:1024 sc1
  buffer_load_dwordx4 a[168:171], v16, s[16:19], s38 offen offset:2048 sc1
  buffer_load_dwordx4 a[172:175], v16, s[16:19], s38 offen offset:3072 sc1
  s_add_u32 s38, s38, 4096
  s_barrier
  ds_read_b64_tr_b16 v[48:49], v9 offset:0
  ds_read_b64_tr_b16 v[50:51], v9 offset:4608
  ds_read_b64_tr_b16 v[52:53], v9 offset:32
  ds_read_b64_tr_b16 v[54:55], v9 offset:4640
  ds_read_b64_tr_b16 v[56:57], v9 offset:64
  ds_read_b64_tr_b16 v[58:59], v9 offset:4672
  ds_read_b64_tr_b16 v[60:61], v9 offset:96
  ds_read_b64_tr_b16 v[62:63], v9 offset:4704
  s_waitcnt vmcnt(8) lgkmcnt(4)
  v_mfma_f32_16x16x32_bf16 v[112:115], v[48:51], a[128:131], 0
  ds_read_b64_tr_b16 v[64:65], v9 offset:128
  ds_read_b64_tr_b16 v[66:67], v9 offset:4736
  v_mfma_f32_16x16x32_bf16 v[116:119], v[48:51], a[132:135], 0
  buffer_load_dwordx4 a[176:179], v16, s[16:19], s38 offen offset:0 sc1
  v_mfma_f32_16x16x32_bf16 v[120:123], v[48:51], a[136:139], 0
  ds_read_b64_tr_b16 v[68:69], v9 offset:160
  ds_read_b64_tr_b16 v[70:71], v9 offset:4768
  v_mfma_f32_16x16x32_bf16 v[124:127], v[48:51], a[140:143], 0
  buffer_load_dwordx4 a[180:183], v16, s[16:19], s38 offen offset:1024 sc1
  v_mfma_f32_16x16x32_bf16 v[128:131], v[52:55], a[128:131], 0
  ds_read_b64_tr_b16 v[48:49], v9 offset:192
  ds_read_b64_tr_b16 v[50:51], v9 offset:4800
  v_mfma_f32_16x16x32_bf16 v[132:135], v[52:55], a[132:135], 0
  buffer_load_dwordx4 a[184:187], v16, s[16:19], s38 offen offset:2048 sc1
  v_mfma_f32_16x16x32_bf16 v[136:139], v[52:55], a[136:139], 0
  s_lshl_b32 s6, s6, 2
  s_add_u32 s6, s6, s3
  v_mfma_f32_16x16x32_bf16 v[140:143], v[52:55], a[140:143], 0
  v_mul_u32_u24 v46, 7282, v39
  s_waitcnt lgkmcnt(6)
  v_mfma_f32_16x16x32_bf16 v[144:147], v[56:59], a[128:131], 0
  buffer_load_dwordx4 a[188:191], v16, s[16:19], s38 offen offset:3072 sc1
  v_mfma_f32_16x16x32_bf16 v[148:151], v[56:59], a[132:135], 0
  s_add_u32 s38, s38, 4096
  ds_read_b64_tr_b16 v[52:53], v9 offset:224
  v_mfma_f32_16x16x32_bf16 v[152:155], v[56:59], a[136:139], 0
  ds_read_b64_tr_b16 v[54:55], v9 offset:4832
  v_lshrrev_b32 v46, 16, v46
  v_mfma_f32_16x16x32_bf16 v[156:159], v[56:59], a[140:143], 0
  buffer_load_dwordx4 a[192:195], v16, s[16:19], s38 offen offset:0 sc1
  v_mfma_f32_16x16x32_bf16 v[160:163], v[60:63], a[128:131], 0
  ds_read_b64_tr_b16 v[56:57], v9 offset:256
  ds_read_b64_tr_b16 v[58:59], v9 offset:4864
  v_mfma_f32_16x16x32_bf16 v[164:167], v[60:63], a[132:135], 0
  buffer_load_dwordx4 a[196:199], v16, s[16:19], s38 offen offset:1024 sc1
  v_mfma_f32_16x16x32_bf16 v[168:171], v[60:63], a[136:139], 0
  v_mul_u32_u24 v47, 9, v46
  v_sub_u32 v45, v39, v47
  v_mfma_f32_16x16x32_bf16 v[172:175], v[60:63], a[140:143], 0
  v_mul_u32_u24 v46, 9216, v46
  s_waitcnt lgkmcnt(6)
  v_mfma_f32_16x16x32_bf16 v[176:179], v[64:67], a[128:131], 0
  buffer_load_dwordx4 a[200:203], v16, s[16:19], s38 offen offset:2048 sc1
  v_mfma_f32_16x16x32_bf16 v[180:183], v[64:67], a[132:135], 0
  buffer_load_dwordx4 a[204:207], v16, s[16:19], s38 offen offset:3072 sc1
  v_mfma_f32_16x16x32_bf16 v[184:187], v[64:67], a[136:139], 0
  ds_read_b64_tr_b16 v[60:61], v1 offset:0
  ds_read_b64_tr_b16 v[62:63], v1 offset:4096
  v_mfma_f32_16x16x32_bf16 v[188:191], v[64:67], a[140:143], 0
  s_add_u32 s38, s38, 4096
  v_lshlrev_b32 v45, 7, v45
  v_mfma_f32_16x16x32_bf16 v[192:195], v[68:71], a[128:131], 0
  ds_read_b64_tr_b16 v[64:65], v1 offset:8
  ds_read_b64_tr_b16 v[66:67], v1 offset:4104
  v_mfma_f32_16x16x32_bf16 v[196:199], v[68:71], a[132:135], 0
  s_add_u32 m0, s41, 135168
  v_add_u32 v93, v45, v46
  v_mfma_f32_16x16x32_bf16 v[200:203], v[68:71], a[136:139], 0
  v_lshrrev_b32 v46, 3, v39
  v_lshlrev_b32 v46, 13, v46
  v_mfma_f32_16x16x32_bf16 v[204:207], v[68:71], a[140:143], 0
  v_and_b32 v45, 7, v39
  s_waitcnt lgkmcnt(6)
  v_mfma_f32_16x16x32_bf16 v[208:211], v[48:51], a[128:131], 0
  buffer_load_dwordx4 v13, s[12:15], s37 offen lds
  v_mfma_f32_16x16x32_bf16 v[212:215], v[48:51], a[132:135], 0
  buffer_load_dwordx4 v14, s[12:15], s37 offen offset:1024 lds
  v_mfma_f32_16x16x32_bf16 v[216:219], v[48:51], a[136:139], 0
  ds_read_b64_tr_b16 v[68:69], v2 offset:0
  ds_read_b64_tr_b16 v[70:71], v2 offset:4096
  v_mfma_f32_16x16x32_bf16 v[220:223], v[48:51], a[140:143], 0
  s_mov_b64 exec, 0xffff
  buffer_load_dwordx4 v15, s[12:15], s37 offen offset:2048 lds
  s_mov_b64 exec, -1
  v_mfma_f32_16x16x32_bf16 v[224:227], v[52:55], a[128:131], 0
  ds_read_b64_tr_b16 v[48:49], v2 offset:8
  ds_read_b64_tr_b16 v[50:51], v2 offset:4104
  v_mfma_f32_16x16x32_bf16 v[228:231], v[52:55], a[132:135], 0
  s_add_u32 s37, s37, 294912
  v_lshlrev_b32 v45, 7, v45
  v_mfma_f32_16x16x32_bf16 v[232:235], v[52:55], a[136:139], 0
  v_add_u32 v94, v45, v46
  s_lshl_b32 s70, s6, 1
  v_mfma_f32_16x16x32_bf16 v[236:239], v[52:55], a[140:143], 0
  s_add_u32 m0, s40, 135168
  s_waitcnt lgkmcnt(6)
  v_mfma_f32_16x16x32_bf16 v[240:243], v[56:59], a[128:131], 0
  ds_read_b64_tr_b16 v[52:53], v3 offset:0
  ds_read_b64_tr_b16 v[54:55], v3 offset:4096
  v_mfma_f32_16x16x32_bf16 v[244:247], v[56:59], a[132:135], 0
  buffer_load_dwordx4 v11, s[8:11], s36 offen lds
  v_mfma_f32_16x16x32_bf16 v[248:251], v[56:59], a[136:139], 0
  s_add_u32 s70, s70, 320
  s_mul_i32 s71, s70, 9216
  v_mfma_f32_16x16x32_bf16 v[252:255], v[56:59], a[140:143], 0
  buffer_load_dwordx4 v12, s[8:11], s36 offen offset:1024 lds
  v_mfma_f32_16x16x32_bf16 a[0:3], v[60:63], a[128:131], 0
  ds_read_b64_tr_b16 v[56:57], v3 offset:8
  ds_read_b64_tr_b16 v[58:59], v3 offset:4104
  v_mfma_f32_16x16x32_bf16 a[4:7], v[60:63], a[132:135], 0
  s_add_u32 s36, s36, 262144
  s_mul_i32 s74, s7, 1152
  v_mfma_f32_16x16x32_bf16 a[8:11], v[60:63], a[136:139], 0
  s_add_u32 s71, s71, s74
  v_lshlrev_b32 v95, 5, v43
  v_mfma_f32_16x16x32_bf16 a[12:15], v[60:63], a[140:143], 0
  v_lshlrev_b32 v96, 8, v44
  s_waitcnt lgkmcnt(6)
  v_mfma_f32_16x16x32_bf16 a[16:19], v[64:67], a[128:131], 0
  ds_read_b64_tr_b16 v[60:61], v4 offset:0
  ds_read_b64_tr_b16 v[62:63], v4 offset:4096
  v_mfma_f32_16x16x32_bf16 a[20:23], v[64:67], a[132:135], 0
  s_add_u32 s72, s56, s71
  s_addc_u32 s73, s57, 0
  v_mfma_f32_16x16x32_bf16 a[24:27], v[64:67], a[136:139], 0
  s_mov_b32 s74, 10368
  s_mov_b32 s75, 0x20000
  v_mfma_f32_16x16x32_bf16 a[28:31], v[64:67], a[140:143], 0
  s_lshl_b32 s71, s70, 13
  s_lshl_b32 s74, s7, 10
  v_mfma_f32_16x16x32_bf16 a[32:35], v[68:71], a[128:131], 0
  ds_read_b64_tr_b16 v[64:65], v4 offset:8
  ds_read_b64_tr_b16 v[66:67], v4 offset:4104
  v_mfma_f32_16x16x32_bf16 a[36:39], v[68:71], a[132:135], 0
  s_add_u32 s71, s71, s74
  v_add_u32 v95, v95, v96
  v_mfma_f32_16x16x32_bf16 a[40:43], v[68:71], a[136:139], 0
  s_add_u32 s88, s50, s71
  s_addc_u32 s89, s51, 0
  v_mfma_f32_16x16x32_bf16 a[44:47], v[68:71], a[140:143], 0
  s_mov_b32 s90, 9216
  s_waitcnt lgkmcnt(6)
  v_mfma_f32_16x16x32_bf16 a[48:51], v[48:51], a[128:131], 0
  s_mov_b32 s91, 0x20000
  s_lshr_b32 s92, s6, 5
  v_mfma_f32_16x16x32_bf16 a[52:55], v[48:51], a[132:135], 0
  ds_read_b64_tr_b16 v[68:69], v9 offset:17408
  ds_read_b64_tr_b16 v[70:71], v9 offset:22016
  v_mfma_f32_16x16x32_bf16 a[56:59], v[48:51], a[136:139], 0
  v_lshlrev_b32 v96, 3, v42
  v_add_u32 v95, v95, v96
  v_mfma_f32_16x16x32_bf16 a[60:63], v[48:51], a[140:143], 0
  v_add_u32 v95, 32768, v95
  v_xor_b32 v25, 0, v95
  v_mfma_f32_16x16x32_bf16 a[64:67], v[52:55], a[128:131], 0
  ds_read_b64_tr_b16 v[48:49], v9 offset:17440
  ds_read_b64_tr_b16 v[50:51], v9 offset:22048
  v_mfma_f32_16x16x32_bf16 a[68:71], v[52:55], a[132:135], 0
  v_xor_b32 v26, 32, v95
  v_xor_b32 v27, 64, v95
  v_mfma_f32_16x16x32_bf16 a[72:75], v[52:55], a[136:139], 0
  v_xor_b32 v28, 96, v95
  v_xor_b32 v29, 128, v95
  v_mfma_f32_16x16x32_bf16 a[76:79], v[52:55], a[140:143], 0
  v_xor_b32 v30, 160, v95
  s_waitcnt lgkmcnt(6)
  v_mfma_f32_16x16x32_bf16 a[80:83], v[56:59], a[128:131], 0
  ds_read_b64_tr_b16 v[52:53], v9 offset:17472
  ds_read_b64_tr_b16 v[54:55], v9 offset:22080
  v_mfma_f32_16x16x32_bf16 a[84:87], v[56:59], a[132:135], 0
  s_cmp_lg_u32 s92, 0
  s_cbranch_scc1 L_ct0
  buffer_load_dword v73, v93, s[72:75], 0 offen
  buffer_load_dword v73, v94, s[88:91], 0 offen
L_ct0:
  v_mfma_f32_16x16x32_bf16 a[88:91], v[56:59], a[136:139], 0
  v_xor_b32 v31, 192, v95
  v_xor_b32 v32, 224, v95
  v_mfma_f32_16x16x32_bf16 a[92:95], v[56:59], a[140:143], 0
  v_and_b32 v95, 15, v39
  v_xor_b32 v96, v40, v95
  v_mfma_f32_16x16x32_bf16 a[96:99], v[60:63], a[128:131], 0
  ds_read_b64_tr_b16 v[56:57], v9 offset:17504
  ds_read_b64_tr_b16 v[58:59], v9 offset:22112
  v_mfma_f32_16x16x32_bf16 a[100:103], v[60:63], a[132:135], 0
  v_lshlrev_b32 v96, 4, v96
  v_lshlrev_b32 v95, 8, v95
  v_mfma_f32_16x16x32_bf16 a[104:107], v[60:63], a[136:139], 0
  v_mfma_f32_16x16x32_bf16 a[108:111], v[60:63], a[140:143], 0
  s_waitcnt lgkmcnt(6)
  v_mfma_f32_16x16x32_bf16 a[112:115], v[64:67], a[128:131], 0
  ds_read_b64_tr_b16 v[60:61], v9 offset:17536
  ds_read_b64_tr_b16 v[62:63], v9 offset:22144
  v_mfma_f32_16x16x32_bf16 a[116:119], v[64:67], a[132:135], 0
  v_mfma_f32_16x16x32_bf16 a[120:123], v[64:67], a[136:139], 0
  v_mfma_f32_16x16x32_bf16 a[124:127], v[64:67], a[140:143], 0
  s_barrier
  s_waitcnt vmcnt(17)
  v_mfma_f32_16x16x32_bf16 v[112:115], v[68:71], a[144:147], v[112:115]
  ds_read_b64_tr_b16 v[64:65], v9 offset:17568
  ds_read_b64_tr_b16 v[66:67], v9 offset:22176
  v_mfma_f32_16x16x32_bf16 v[116:119], v[68:71], a[148:151], v[116:119]
  buffer_load_dwordx4 a[128:131], v16, s[16:19], s38 offen offset:0 sc1
  v_mfma_f32_16x16x32_bf16 v[120:123], v[68:71], a[152:155], v[120:123]
  v_add_u32 v95, v95, v96
  v_xor_b32 v21, 0, v95
  v_mfma_f32_16x16x32_bf16 v[124:127], v[68:71], a[156:159], v[124:127]
  v_xor_b32 v22, 64, v95
  s_waitcnt lgkmcnt(6)
  v_mfma_f32_16x16x32_bf16 v[128:131], v[48:51], a[144:147], v[128:131]
  ds_read_b64_tr_b16 v[68:69], v9 offset:17600
  ds_read_b64_tr_b16 v[70:71], v9 offset:22208
  v_mfma_f32_16x16x32_bf16 v[132:135], v[48:51], a[148:151], v[132:135]
  buffer_load_dwordx4 a[132:135], v16, s[16:19], s38 offen offset:1024 sc1
  v_mfma_f32_16x16x32_bf16 v[136:139], v[48:51], a[152:155], v[136:139]
  v_xor_b32 v23, 128, v95
  v_xor_b32 v24, 192, v95
  v_mfma_f32_16x16x32_bf16 v[140:143], v[48:51], a[156:159], v[140:143]
  s_lshl_b32 s76, s43, 9
  v_lshrrev_b32 v33, 1, v16
  v_mfma_f32_16x16x32_bf16 v[144:147], v[52:55], a[144:147], v[144:147]
  ds_read_b64_tr_b16 v[48:49], v9 offset:17632
  ds_read_b64_tr_b16 v[50:51], v9 offset:22240
  v_mfma_f32_16x16x32_bf16 v[148:151], v[52:55], a[148:151], v[148:151]
  buffer_load_dwordx4 a[136:139], v16, s[16:19], s38 offen offset:2048 sc1
  v_mfma_f32_16x16x32_bf16 v[152:155], v[52:55], a[152:155], v[152:155]
  v_add_u32 v33, s76, v33
  v_mov_b32 v34, 0x3f803f80
  v_mfma_f32_16x16x32_bf16 v[156:159], v[52:55], a[156:159], v[156:159]
  v_mov_b32 v35, 0x3f803f80
  s_waitcnt lgkmcnt(6)
  v_mfma_f32_16x16x32_bf16 v[160:163], v[56:59], a[144:147], v[160:163]
  ds_read_b64_tr_b16 v[52:53], v9 offset:17664
  ds_read_b64_tr_b16 v[54:55], v9 offset:22272
  v_mfma_f32_16x16x32_bf16 v[164:167], v[56:59], a[148:151], v[164:167]
  buffer_load_dwordx4 a[140:143], v16, s[16:19], s38 offen offset:3072 sc1
  v_mfma_f32_16x16x32_bf16 v[168:171], v[56:59], a[152:155], v[168:171]
  v_mov_b32 v36, 0x3f803f80
  v_mov_b32 v37, 0x3f803f80
  v_mfma_f32_16x16x32_bf16 v[172:175], v[56:59], a[156:159], v[172:175]
  s_lshr_b32 s76, s4, 1
  s_lshl_b32 s76, s76, 19
  v_mfma_f32_16x16x32_bf16 v[176:179], v[60:63], a[144:147], v[176:179]
  ds_read_b64_tr_b16 v[56:57], v1 offset:17408
  ds_read_b64_tr_b16 v[58:59], v1 offset:21504
  v_mfma_f32_16x16x32_bf16 v[180:183], v[60:63], a[148:151], v[180:183]
  s_add_u32 s38, s38, 4096
  s_add_u32 s76, s76, 393216
  v_mfma_f32_16x16x32_bf16 v[184:187], v[60:63], a[152:155], v[184:187]
  s_add_u32 s20, s46, s76
  s_addc_u32 s21, s47, 0
  v_mfma_f32_16x16x32_bf16 v[188:191], v[60:63], a[156:159], v[188:191]
  s_mov_b32 s22, 131072
  s_waitcnt lgkmcnt(6)
  v_mfma_f32_16x16x32_bf16 v[192:195], v[64:67], a[144:147], v[192:195]
  ds_read_b64_tr_b16 v[60:61], v1 offset:17416
  ds_read_b64_tr_b16 v[62:63], v1 offset:21512
  v_mfma_f32_16x16x32_bf16 v[196:199], v[64:67], a[148:151], v[196:199]
  s_add_u32 m0, s41, 65536
  s_mov_b32 s23, 0x20000
  v_mfma_f32_16x16x32_bf16 v[200:203], v[64:67], a[152:155], v[200:203]
  v_mfma_f32_16x16x32_bf16 v[204:207], v[64:67], a[156:159], v[204:207]
  v_mfma_f32_16x16x32_bf16 v[208:211], v[68:71], a[144:147], v[208:211]
  ds_read_b64_tr_b16 v[64:65], v2 offset:17408
  ds_read_b64_tr_b16 v[66:67], v2 offset:21504
  v_mfma_f32_16x16x32_bf16 v[212:215], v[68:71], a[148:151], v[212:215]
  buffer_load_dwordx4 v13, s[12:15], s37 offen lds
  v_mfma_f32_16x16x32_bf16 v[216:219], v[68:71], a[152:155], v[216:219]
  v_mfma_f32_16x16x32_bf16 v[220:223], v[68:71], a[156:159], v[220:223]
  s_waitcnt lgkmcnt(6)
  v_mfma_f32_16x16x32_bf16 v[224:227], v[48:51], a[144:147], v[224:227]
  ds_read_b64_tr_b16 v[68:69], v2 offset:17416
  ds_read_b64_tr_b16 v[70:71], v2 offset:21512
  v_mfma_f32_16x16x32_bf16 v[228:231], v[48:51], a[148:151], v[228:231]
  buffer_load_dwordx4 v14, s[12:15], s37 offen offset:1024 lds
  v_mfma_f32_16x16x32_bf16 v[232:235], v[48:51], a[152:155], v[232:235]
  v_mfma_f32_16x16x32_bf16 v[236:239], v[48:51], a[156:159], v[236:239]
  v_mfma_f32_16x16x32_bf16 v[240:243], v[52:55], a[144:147], v[240:243]
  ds_read_b64_tr_b16 v[48:49], v3 offset:17408
  ds_read_b64_tr_b16 v[50:51], v3 offset:21504
  v_mfma_f32_16x16x32_bf16 v[244:247], v[52:55], a[148:151], v[244:247]
  s_mov_b64 exec, 0xffff
  buffer_load_dwordx4 v15, s[12:15], s37 offen offset:2048 lds
  s_mov_b64 exec, -1
  v_mfma_f32_16x16x32_bf16 v[248:251], v[52:55], a[152:155], v[248:251]
  v_mfma_f32_16x16x32_bf16 v[252:255], v[52:55], a[156:159], v[252:255]
  s_waitcnt lgkmcnt(6)
  v_mfma_f32_16x16x32_bf16 a[0:3], v[56:59], a[144:147], a[0:3]
  ds_read_b64_tr_b16 v[52:53], v3 offset:17416
  ds_read_b64_tr_b16 v[54:55], v3 offset:21512
  v_mfma_f32_16x16x32_bf16 a[4:7], v[56:59], a[148:151], a[4:7]
  s_add_u32 s37, s37, 294912
  v_mfma_f32_16x16x32_bf16 a[8:11], v[56:59], a[152:155], a[8:11]
  v_mfma_f32_16x16x32_bf16 a[12:15], v[56:59], a[156:159], a[12:15]
  v_mfma_f32_16x16x32_bf16 a[16:19], v[60:63], a[144:147], a[16:19]
  ds_read_b64_tr_b16 v[56:57], v4 offset:17408
  ds_read_b64_tr_b16 v[58:59], v4 offset:21504
  v_mfma_f32_16x16x32_bf16 a[20:23], v[60:63], a[148:151], a[20:23]
  s_add_u32 m0, s40, 65536
  v_mfma_f32_16x16x32_bf16 a[24:27], v[60:63], a[152:155], a[24:27]
  v_mfma_f32_16x16x32_bf16 a[28:31], v[60:63], a[156:159], a[28:31]
  s_waitcnt lgkmcnt(6)
  v_mfma_f32_16x16x32_bf16 a[32:35], v[64:67], a[144:147], a[32:35]
  ds_read_b64_tr_b16 v[60:61], v4 offset:17416
  ds_read_b64_tr_b16 v[62:63], v4 offset:21512
  v_mfma_f32_16x16x32_bf16 a[36:39], v[64:67], a[148:151], a[36:39]
  buffer_load_dwordx4 v11, s[8:11], s36 offen lds
  v_mfma_f32_16x16x32_bf16 a[40:43], v[64:67], a[152:155], a[40:43]
  v_mfma_f32_16x16x32_bf16 a[44:47], v[64:67], a[156:159], a[44:47]
  v_mfma_f32_16x16x32_bf16 a[48:51], v[68:71], a[144:147], a[48:51]
  ds_read_b64_tr_b16 v[64:65], v9 offset:34816
  ds_read_b64_tr_b16 v[66:67], v9 offset:39424
  v_mfma_f32_16x16x32_bf16 a[52:55], v[68:71], a[148:151], a[52:55]
  buffer_load_dwordx4 v12, s[8:11], s36 offen offset:1024 lds
  v_mfma_f32_16x16x32_bf16 a[56:59], v[68:71], a[152:155], a[56:59]
  v_mfma_f32_16x16x32_bf16 a[60:63], v[68:71], a[156:159], a[60:63]
  s_waitcnt lgkmcnt(6)
  v_mfma_f32_16x16x32_bf16 a[64:67], v[48:51], a[144:147], a[64:67]
  ds_read_b64_tr_b16 v[68:69], v9 offset:34848
  ds_read_b64_tr_b16 v[70:71], v9 offset:39456
  v_mfma_f32_16x16x32_bf16 a[68:71], v[48:51], a[148:151], a[68:71]
  s_add_u32 s36, s36, 262144
  v_mfma_f32_16x16x32_bf16 a[72:75], v[48:51], a[152:155], a[72:75]
  v_mfma_f32_16x16x32_bf16 a[76:79], v[48:51], a[156:159], a[76:79]
  v_mfma_f32_16x16x32_bf16 a[80:83], v[52:55], a[144:147], a[80:83]
  ds_read_b64_tr_b16 v[48:49], v9 offset:34880
  ds_read_b64_tr_b16 v[50:51], v9 offset:39488
  v_mfma_f32_16x16x32_bf16 a[84:87], v[52:55], a[148:151], a[84:87]
  s_cmp_lg_u32 s92, 1
  s_cbranch_scc1 L_ct1
  buffer_load_dword v73, v93, s[72:75], 0 offen
  buffer_load_dword v73, v94, s[88:91], 0 offen
L_ct1:
  v_mfma_f32_16x16x32_bf16 a[88:91], v[52:55], a[152:155], a[88:91]
  v_mfma_f32_16x16x32_bf16 a[92:95], v[52:55], a[156:159], a[92:95]
  s_waitcnt lgkmcnt(6)
  v_mfma_f32_16x16x32_bf16 a[96:99], v[56:59], a[144:147], a[96:99]
  ds_read_b64_tr_b16 v[52:53], v9 offset:34912
  ds_read_b64_tr_b16 v[54:55], v9 offset:39520
  v_mfma_f32_16x16x32_bf16 a[100:103], v[56:59], a[148:151], a[100:103]
  v_mfma_f32_16x16x32_bf16 a[104:107], v[56:59], a[152:155], a[104:107]
  v_mfma_f32_16x16x32_bf16 a[108:111], v[56:59], a[156:159], a[108:111]
  v_mfma_f32_16x16x32_bf16 a[112:115], v[60:63], a[144:147], a[112:115]
  ds_read_b64_tr_b16 v[56:57], v9 offset:34944
  ds_read_b64_tr_b16 v[58:59], v9 offset:39552
  v_mfma_f32_16x16x32_bf16 a[116:119], v[60:63], a[148:151], a[116:119]
  v_mfma_f32_16x16x32_bf16 a[120:123], v[60:63], a[152:155], a[120:123]
  v_mfma_f32_16x16x32_bf16 a[124:127], v[60:63], a[156:159], a[124:127]
  s_barrier
  s_waitcnt vmcnt(22) lgkmcnt(6)
  v_mfma_f32_16x16x32_bf16 v[112:115], v[64:67], a[160:163], v[112:115]
  ds_read_b64_tr_b16 v[60:61], v9 offset:34976
  ds_read_b64_tr_b16 v[62:63], v9 offset:39584
  v_mfma_f32_16x16x32_bf16 v[116:119], v[64:67], a[164:167], v[116:119]
  buffer_load_dwordx4 a[144:147], v16, s[16:19], s38 offen offset:0 sc1
  v_mfma_f32_16x16x32_bf16 v[120:123], v[64:67], a[168:171], v[120:123]
  s_add_u32 s24, s48, s76
  s_addc_u32 s25, s49, 0
  v_mfma_f32_16x16x32_bf16 v[124:127], v[64:67], a[172:175], v[124:127]
  s_mov_b32 s26, 131072
  s_mov_b32 s27, 0x20000
  v_mfma_f32_16x16x32_bf16 v[128:131], v[68:71], a[160:163], v[128:131]
  ds_read_b64_tr_b16 v[64:65], v9 offset:35008
  ds_read_b64_tr_b16 v[66:67], v9 offset:39616
  v_mfma_f32_16x16x32_bf16 v[132:135], v[68:71], a[164:167], v[132:135]
  buffer_load_dwordx4 a[148:151], v16, s[16:19], s38 offen offset:1024 sc1
  v_mfma_f32_16x16x32_bf16 v[136:139], v[68:71], a[168:171], v[136:139]
  s_mul_i32 s76, s5, 144
  s_lshr_b32 s77, s4, 1
  v_mfma_f32_16x16x32_bf16 v[140:143], v[68:71], a[172:175], v[140:143]
  s_mul_i32 s77, s77, 9
  s_waitcnt lgkmcnt(6)
  v_mfma_f32_16x16x32_bf16 v[144:147], v[48:51], a[160:163], v[144:147]
  ds_read_b64_tr_b16 v[68:69], v9 offset:35040
  ds_read_b64_tr_b16 v[70:71], v9 offset:39648
  v_mfma_f32_16x16x32_bf16 v[148:151], v[48:51], a[164:167], v[148:151]
  buffer_load_dwordx4 a[152:155], v16, s[16:19], s38 offen offset:2048 sc1
  v_mfma_f32_16x16x32_bf16 v[152:155], v[48:51], a[168:171], v[152:155]
  s_add_u32 s76, s76, s77
  s_lshl_b32 s76, s76, 12
  v_mfma_f32_16x16x32_bf16 v[156:159], v[48:51], a[172:175], v[156:159]
  s_add_u32 s76, s76, 4194304
  v_mfma_f32_16x16x32_bf16 v[160:163], v[52:55], a[160:163], v[160:163]
  ds_read_b64_tr_b16 v[48:49], v9 offset:35072
  ds_read_b64_tr_b16 v[50:51], v9 offset:39680
  v_mfma_f32_16x16x32_bf16 v[164:167], v[52:55], a[164:167], v[164:167]
  buffer_load_dwordx4 a[156:159], v16, s[16:19], s38 offen offset:3072 sc1
  v_mfma_f32_16x16x32_bf16 v[168:171], v[52:55], a[168:171], v[168:171]
  s_add_u32 s28, s64, s76
  s_addc_u32 s29, s65, 0
  v_mfma_f32_16x16x32_bf16 v[172:175], v[52:55], a[172:175], v[172:175]
  s_mov_b32 s30, 36864
  s_waitcnt lgkmcnt(6)
  v_mfma_f32_16x16x32_bf16 v[176:179], v[56:59], a[160:163], v[176:179]
  ds_read_b64_tr_b16 v[52:53], v1 offset:34816
  ds_read_b64_tr_b16 v[54:55], v1 offset:38912
  v_mfma_f32_16x16x32_bf16 v[180:183], v[56:59], a[164:167], v[180:183]
  s_add_u32 s38, s38, 4096
  s_mov_b32 s31, 0x20000
  v_mfma_f32_16x16x32_bf16 v[184:187], v[56:59], a[168:171], v[184:187]
  s_lshl_b32 s76, s5, 7
  s_lshl_b32 s77, s4, 2
  v_mfma_f32_16x16x32_bf16 v[188:191], v[56:59], a[172:175], v[188:191]
  s_add_u32 s76, s76, s77
  s_lshl_b32 s76, s76, 12
  v_mfma_f32_16x16x32_bf16 v[192:195], v[60:63], a[160:163], v[192:195]
  ds_read_b64_tr_b16 v[56:57], v1 offset:34824
  ds_read_b64_tr_b16 v[58:59], v1 offset:38920
  v_mfma_f32_16x16x32_bf16 v[196:199], v[60:63], a[164:167], v[196:199]
  s_add_u32 m0, s41, 82944
  s_add_u32 s76, s76, 25165824
  v_mfma_f32_16x16x32_bf16 v[200:203], v[60:63], a[168:171], v[200:203]
  s_add_u32 s32, s64, s76
  s_addc_u32 s33, s65, 0
  v_mfma_f32_16x16x32_bf16 v[204:207], v[60:63], a[172:175], v[204:207]
  s_waitcnt lgkmcnt(6)
  v_mfma_f32_16x16x32_bf16 v[208:211], v[64:67], a[160:163], v[208:211]
  ds_read_b64_tr_b16 v[60:61], v2 offset:34816
  ds_read_b64_tr_b16 v[62:63], v2 offset:38912
  v_mfma_f32_16x16x32_bf16 v[212:215], v[64:67], a[164:167], v[212:215]
  buffer_load_dwordx4 v13, s[12:15], s37 offen lds
  v_mfma_f32_16x16x32_bf16 v[216:219], v[64:67], a[168:171], v[216:219]
  v_mfma_f32_16x16x32_bf16 v[220:223], v[64:67], a[172:175], v[220:223]
  v_mfma_f32_16x16x32_bf16 v[224:227], v[68:71], a[160:163], v[224:227]
  ds_read_b64_tr_b16 v[64:65], v2 offset:34824
  ds_read_b64_tr_b16 v[66:67], v2 offset:38920
  v_mfma_f32_16x16x32_bf16 v[228:231], v[68:71], a[164:167], v[228:231]
  buffer_load_dwordx4 v14, s[12:15], s37 offen offset:1024 lds
  v_mfma_f32_16x16x32_bf16 v[232:235], v[68:71], a[168:171], v[232:235]
  v_mfma_f32_16x16x32_bf16 v[236:239], v[68:71], a[172:175], v[236:239]
  s_waitcnt lgkmcnt(6)
  v_mfma_f32_16x16x32_bf16 v[240:243], v[48:51], a[160:163], v[240:243]
  ds_read_b64_tr_b16 v[68:69], v3 offset:34816
  ds_read_b64_tr_b16 v[70:71], v3 offset:38912
  v_mfma_f32_16x16x32_bf16 v[244:247], v[48:51], a[164:167], v[244:247]
  s_mov_b64 exec, 0xffff
  buffer_load_dwordx4 v15, s[12:15], s37 offen offset:2048 lds
  s_mov_b64 exec, -1
  v_mfma_f32_16x16x32_bf16 v[248:251], v[48:51], a[168:171], v[248:251]
  v_mfma_f32_16x16x32_bf16 v[252:255], v[48:51], a[172:175], v[252:255]
  v_mfma_f32_16x16x32_bf16 a[0:3], v[52:55], a[160:163], a[0:3]
  ds_read_b64_tr_b16 v[48:49], v3 offset:34824
  ds_read_b64_tr_b16 v[50:51], v3 offset:38920
  v_mfma_f32_16x16x32_bf16 a[4:7], v[52:55], a[164:167], a[4:7]
  s_add_u32 s37, s37, 294912
  v_mfma_f32_16x16x32_bf16 a[8:11], v[52:55], a[168:171], a[8:11]
  v_mfma_f32_16x16x32_bf16 a[12:15], v[52:55], a[172:175], a[12:15]
  s_waitcnt lgkmcnt(6)
  v_mfma_f32_16x16x32_bf16 a[16:19], v[56:59], a[160:163], a[16:19]
  ds_read_b64_tr_b16 v[52:53], v4 offset:34816
  ds_read_b64_tr_b16 v[54:55], v4 offset:38912
  v_mfma_f32_16x16x32_bf16 a[20:23], v[56:59], a[164:167], a[20:23]
  s_add_u32 m0, s40, 82944
  v_mfma_f32_16x16x32_bf16 a[24:27], v[56:59], a[168:171], a[24:27]
  v_mfma_f32_16x16x32_bf16 a[28:31], v[56:59], a[172:175], a[28:31]
  v_mfma_f32_16x16x32_bf16 a[32:35], v[60:63], a[160:163], a[32:35]
  ds_read_b64_tr_b16 v[56:57], v4 offset:34824
  ds_read_b64_tr_b16 v[58:59], v4 offset:38920
  v_mfma_f32_16x16x32_bf16 a[36:39], v[60:63], a[164:167], a[36:39]
  buffer_load_dwordx4 v11, s[8:11], s36 offen lds
  v_mfma_f32_16x16x32_bf16 a[40:43], v[60:63], a[168:171], a[40:43]
  v_mfma_f32_16x16x32_bf16 a[44:47], v[60:63], a[172:175], a[44:47]
  s_waitcnt lgkmcnt(6)
  v_mfma_f32_16x16x32_bf16 a[48:51], v[64:67], a[160:163], a[48:51]
  ds_read_b64_tr_b16 v[60:61], v10 offset:0
  ds_read_b64_tr_b16 v[62:63], v10 offset:4608
  v_mfma_f32_16x16x32_bf16 a[52:55], v[64:67], a[164:167], a[52:55]
  buffer_load_dwordx4 v12, s[8:11], s36 offen offset:1024 lds
  v_mfma_f32_16x16x32_bf16 a[56:59], v[64:67], a[168:171], a[56:59]
  v_mfma_f32_16x16x32_bf16 a[60:63], v[64:67], a[172:175], a[60:63]
  v_mfma_f32_16x16x32_bf16 a[64:67], v[68:71], a[160:163], a[64:67]
  ds_read_b64_tr_b16 v[64:65], v10 offset:32
  ds_read_b64_tr_b16 v[66:67], v10 offset:4640
  v_mfma_f32_16x16x32_bf16 a[68:71], v[68:71], a[164:167], a[68:71]
  s_add_u32 s36, s36, 262144
  v_mfma_f32_16x16x32_bf16 a[72:75], v[68:71], a[168:171], a[72:75]
  v_mfma_f32_16x16x32_bf16 a[76:79], v[68:71], a[172:175], a[76:79]
  s_waitcnt lgkmcnt(6)
  v_mfma_f32_16x16x32_bf16 a[80:83], v[48:51], a[160:163], a[80:83]
  ds_read_b64_tr_b16 v[68:69], v10 offset:64
  ds_read_b64_tr_b16 v[70:71], v10 offset:4672
  v_mfma_f32_16x16x32_bf16 a[84:87], v[48:51], a[164:167], a[84:87]
  s_cmp_lg_u32 s92, 2
  s_cbranch_scc1 L_ct2
  buffer_load_dword v73, v93, s[72:75], 0 offen
  buffer_load_dword v73, v94, s[88:91], 0 offen
L_ct2:
  v_mfma_f32_16x16x32_bf16 a[88:91], v[48:51], a[168:171], a[88:91]
  v_mfma_f32_16x16x32_bf16 a[92:95], v[48:51], a[172:175], a[92:95]
  v_mfma_f32_16x16x32_bf16 a[96:99], v[52:55], a[160:163], a[96:99]
  ds_read_b64_tr_b16 v[48:49], v10 offset:96
  ds_read_b64_tr_b16 v[50:51], v10 offset:4704
  v_mfma_f32_16x16x32_bf16 a[100:103], v[52:55], a[164:167], a[100:103]
  v_mfma_f32_16x16x32_bf16 a[104:107], v[52:55], a[168:171], a[104:107]
  v_mfma_f32_16x16x32_bf16 a[108:111], v[52:55], a[172:175], a[108:111]
  s_waitcnt lgkmcnt(6)
  v_mfma_f32_16x16x32_bf16 a[112:115], v[56:59], a[160:163], a[112:115]
  ds_read_b64_tr_b16 v[52:53], v10 offset:128
  ds_read_b64_tr_b16 v[54:55], v10 offset:4736
  v_mfma_f32_16x16x32_bf16 a[116:119], v[56:59], a[164:167], a[116:119]
  v_mfma_f32_16x16x32_bf16 a[120:123], v[56:59], a[168:171], a[120:123]
  v_mfma_f32_16x16x32_bf16 a[124:127], v[56:59], a[172:175], a[124:127]
  s_waitcnt vmcnt(18)
  s_barrier
  v_mfma_f32_16x16x32_bf16 v[112:115], v[60:63], a[176:179], v[112:115]
  ds_read_b64_tr_b16 v[56:57], v10 offset:160
  ds_read_b64_tr_b16 v[58:59], v10 offset:4768
  v_mfma_f32_16x16x32_bf16 v[116:119], v[60:63], a[180:183], v[116:119]
  buffer_load_dwordx4 a[160:163], v16, s[16:19], s38 offen offset:0 sc1
  v_mfma_f32_16x16x32_bf16 v[120:123], v[60:63], a[184:187], v[120:123]
  s_mov_b32 s34, 16384
  s_mov_b32 s35, 0x20000
  v_mfma_f32_16x16x32_bf16 v[124:127], v[60:63], a[188:191], v[124:127]
  s_mul_i32 s66, s43, 20480
  s_waitcnt lgkmcnt(6)
  v_mfma_f32_16x16x32_bf16 v[128:131], v[64:67], a[176:179], v[128:131]
  ds_read_b64_tr_b16 v[60:61], v10 offset:192
  ds_read_b64_tr_b16 v[62:63], v10 offset:4800
  v_mfma_f32_16x16x32_bf16 v[132:135], v[64:67], a[180:183], v[132:135]
  buffer_load_dwordx4 a[164:167], v16, s[16:19], s38 offen offset:1024 sc1
  v_mfma_f32_16x16x32_bf16 v[136:139], v[64:67], a[184:187], v[136:139]
  s_add_u32 s67, s66, 4096
  s_add_u32 s68, s66, 8192
  v_mfma_f32_16x16x32_bf16 v[140:143], v[64:67], a[188:191], v[140:143]
  s_add_u32 s69, s66, 12288
  s_mov_b32 s101, 16384
  v_mfma_f32_16x16x32_bf16 v[144:147], v[68:71], a[176:179], v[144:147]
  ds_read_b64_tr_b16 v[64:65], v10 offset:224
  ds_read_b64_tr_b16 v[66:67], v10 offset:4832
  v_mfma_f32_16x16x32_bf16 v[148:151], v[68:71], a[180:183], v[148:151]
  buffer_load_dwordx4 a[168:171], v16, s[16:19], s38 offen offset:2048 sc1
  v_mfma_f32_16x16x32_bf16 v[152:155], v[68:71], a[184:187], v[152:155]
  s_and_b32 s76, s2, 0xe6
  v_and_b32 v95, 3, v39
  v_mfma_f32_16x16x32_bf16 v[156:159], v[68:71], a[188:191], v[156:159]
  v_lshlrev_b32 v95, 3, v95
  s_waitcnt lgkmcnt(6)
  v_mfma_f32_16x16x32_bf16 v[160:163], v[48:51], a[176:179], v[160:163]
  ds_read_b64_tr_b16 v[68:69], v10 offset:256
  ds_read_b64_tr_b16 v[70:71], v10 offset:4864
  v_mfma_f32_16x16x32_bf16 v[164:167], v[48:51], a[180:183], v[164:167]
  buffer_load_dwordx4 a[172:175], v16, s[16:19], s38 offen offset:3072 sc1
  v_mfma_f32_16x16x32_bf16 v[168:171], v[48:51], a[184:187], v[168:171]
  v_add_u32 v95, s76, v95
  v_bfe_u32 v96, v39, 2, 1
  v_mfma_f32_16x16x32_bf16 v[172:175], v[48:51], a[188:191], v[172:175]
  v_add_u32 v95, v95, v96
  v_lshlrev_b32 v78, 10, v95
  v_mfma_f32_16x16x32_bf16 v[176:179], v[52:55], a[176:179], v[176:179]
  ds_read_b64_tr_b16 v[48:49], v5 offset:0
  ds_read_b64_tr_b16 v[50:51], v5 offset:4096
  v_mfma_f32_16x16x32_bf16 v[180:183], v[52:55], a[180:183], v[180:183]
  s_add_u32 s38, s38, 4096
  s_and_b32 s76, s2, 0xf8
  v_mfma_f32_16x16x32_bf16 v[184:187], v[52:55], a[184:187], v[184:187]
  v_and_b32 v95, 7, v39
  v_add_u32 v95, s76, v95
  v_mfma_f32_16x16x32_bf16 v[188:191], v[52:55], a[188:191], v[188:191]
  v_lshlrev_b32 v79, 10, v95
  s_waitcnt lgkmcnt(6)
  v_mfma_f32_16x16x32_bf16 v[192:195], v[56:59], a[176:179], v[192:195]
  ds_read_b64_tr_b16 v[52:53], v5 offset:8
  ds_read_b64_tr_b16 v[54:55], v5 offset:4104
  v_mfma_f32_16x16x32_bf16 v[196:199], v[56:59], a[180:183], v[196:199]
  s_add_u32 m0, s41, 100352
  v_mfma_f32_16x16x32_bf16 v[200:203], v[56:59], a[184:187], v[200:203]
  v_mfma_f32_16x16x32_bf16 v[204:207], v[56:59], a[188:191], v[204:207]
  v_mfma_f32_16x16x32_bf16 v[208:211], v[60:63], a[176:179], v[208:211]
  ds_read_b64_tr_b16 v[56:57], v6 offset:0
  ds_read_b64_tr_b16 v[58:59], v6 offset:4096
  v_mfma_f32_16x16x32_bf16 v[212:215], v[60:63], a[180:183], v[212:215]
  buffer_load_dwordx4 v13, s[12:15], s37 offen lds
  v_mfma_f32_16x16x32_bf16 v[216:219], v[60:63], a[184:187], v[216:219]
  v_mfma_f32_16x16x32_bf16 v[220:223], v[60:63], a[188:191], v[220:223]
  s_waitcnt lgkmcnt(6)
  v_mfma_f32_16x16x32_bf16 v[224:227], v[64:67], a[176:179], v[224:227]
  ds_read_b64_tr_b16 v[60:61], v6 offset:8
  ds_read_b64_tr_b16 v[62:63], v6 offset:4104
  v_mfma_f32_16x16x32_bf16 v[228:231], v[64:67], a[180:183], v[228:231]
  buffer_load_dwordx4 v14, s[12:15], s37 offen offset:1024 lds
  v_mfma_f32_16x16x32_bf16 v[232:235], v[64:67], a[184:187], v[232:235]
  v_mfma_f32_16x16x32_bf16 v[236:239], v[64:67], a[188:191], v[236:239]
  v_mfma_f32_16x16x32_bf16 v[240:243], v[68:71], a[176:179], v[240:243]
  ds_read_b64_tr_b16 v[64:65], v7 offset:0
  ds_read_b64_tr_b16 v[66:67], v7 offset:4096
  v_mfma_f32_16x16x32_bf16 v[244:247], v[68:71], a[180:183], v[244:247]
  s_mov_b64 exec, 0xffff
  buffer_load_dwordx4 v15, s[12:15], s37 offen offset:2048 lds
  s_mov_b64 exec, -1
  v_mfma_f32_16x16x32_bf16 v[248:251], v[68:71], a[184:187], v[248:251]
  v_mfma_f32_16x16x32_bf16 v[252:255], v[68:71], a[188:191], v[252:255]
  s_waitcnt lgkmcnt(6)
  v_mfma_f32_16x16x32_bf16 a[0:3], v[48:51], a[176:179], a[0:3]
  ds_read_b64_tr_b16 v[68:69], v7 offset:8
  ds_read_b64_tr_b16 v[70:71], v7 offset:4104
  v_mfma_f32_16x16x32_bf16 a[4:7], v[48:51], a[180:183], a[4:7]
  s_add_u32 s37, s37, 294912
  v_mfma_f32_16x16x32_bf16 a[8:11], v[48:51], a[184:187], a[8:11]
  v_mfma_f32_16x16x32_bf16 a[12:15], v[48:51], a[188:191], a[12:15]
  v_mfma_f32_16x16x32_bf16 a[16:19], v[52:55], a[176:179], a[16:19]
  ds_read_b64_tr_b16 v[48:49], v8 offset:0
  ds_read_b64_tr_b16 v[50:51], v8 offset:4096
  v_mfma_f32_16x16x32_bf16 a[20:23], v[52:55], a[180:183], a[20:23]
  s_add_u32 m0, s40, 100352
  v_mfma_f32_16x16x32_bf16 a[24:27], v[52:55], a[184:187], a[24:27]
  v_mfma_f32_16x16x32_bf16 a[28:31], v[52:55], a[188:191], a[28:31]
  s_waitcnt lgkmcnt(6)
  v_mfma_f32_16x16x32_bf16 a[32:35], v[56:59], a[176:179], a[32:35]
  ds_read_b64_tr_b16 v[52:53], v8 offset:8
  ds_read_b64_tr_b16 v[54:55], v8 offset:4104
  v_mfma_f32_16x16x32_bf16 a[36:39], v[56:59], a[180:183], a[36:39]
  buffer_load_dwordx4 v11, s[8:11], s36 offen lds
  v_mfma_f32_16x16x32_bf16 a[40:43], v[56:59], a[184:187], a[40:43]
  v_mfma_f32_16x16x32_bf16 a[44:47], v[56:59], a[188:191], a[44:47]
  v_mfma_f32_16x16x32_bf16 a[48:51], v[60:63], a[176:179], a[48:51]
  ds_read_b64_tr_b16 v[56:57], v10 offset:17408
  ds_read_b64_tr_b16 v[58:59], v10 offset:22016
  v_mfma_f32_16x16x32_bf16 a[52:55], v[60:63], a[180:183], a[52:55]
  buffer_load_dwordx4 v12, s[8:11], s36 offen offset:1024 lds
  v_mfma_f32_16x16x32_bf16 a[56:59], v[60:63], a[184:187], a[56:59]
  v_mfma_f32_16x16x32_bf16 a[60:63], v[60:63], a[188:191], a[60:63]
  s_waitcnt lgkmcnt(6)
  v_mfma_f32_16x16x32_bf16 a[64:67], v[64:67], a[176:179], a[64:67]
  ds_read_b64_tr_b16 v[60:61], v10 offset:17440
  ds_read_b64_tr_b16 v[62:63], v10 offset:22048
  v_mfma_f32_16x16x32_bf16 a[68:71], v[64:67], a[180:183], a[68:71]
  s_add_u32 s36, s36, 262144
  v_mfma_f32_16x16x32_bf16 a[72:75], v[64:67], a[184:187], a[72:75]
  v_mfma_f32_16x16x32_bf16 a[76:79], v[64:67], a[188:191], a[76:79]
  v_mfma_f32_16x16x32_bf16 a[80:83], v[68:71], a[176:179], a[80:83]
  ds_read_b64_tr_b16 v[64:65], v10 offset:17472
  ds_read_b64_tr_b16 v[66:67], v10 offset:22080
  v_mfma_f32_16x16x32_bf16 a[84:87], v[68:71], a[180:183], a[84:87]
  s_cmp_lg_u32 s92, 3
  s_cbranch_scc1 L_ct3
  buffer_load_dword v73, v93, s[72:75], 0 offen
  buffer_load_dword v73, v94, s[88:91], 0 offen
L_ct3:
  v_mfma_f32_16x16x32_bf16 a[88:91], v[68:71], a[184:187], a[88:91]
  v_mfma_f32_16x16x32_bf16 a[92:95], v[68:71], a[188:191], a[92:95]
  s_waitcnt lgkmcnt(6)
  v_mfma_f32_16x16x32_bf16 a[96:99], v[48:51], a[176:179], a[96:99]
  ds_read_b64_tr_b16 v[68:69], v10 offset:17504
  ds_read_b64_tr_b16 v[70:71], v10 offset:22112
  v_mfma_f32_16x16x32_bf16 a[100:103], v[48:51], a[180:183], a[100:103]
  v_mfma_f32_16x16x32_bf16 a[104:107], v[48:51], a[184:187], a[104:107]
  v_mfma_f32_16x16x32_bf16 a[108:111], v[48:51], a[188:191], a[108:111]
  v_mfma_f32_16x16x32_bf16 a[112:115], v[52:55], a[176:179], a[112:115]
  ds_read_b64_tr_b16 v[48:49], v10 offset:17536
  ds_read_b64_tr_b16 v[50:51], v10 offset:22144
  v_mfma_f32_16x16x32_bf16 a[116:119], v[52:55], a[180:183], a[116:119]
  v_mfma_f32_16x16x32_bf16 a[120:123], v[52:55], a[184:187], a[120:123]
  v_mfma_f32_16x16x32_bf16 a[124:127], v[52:55], a[188:191], a[124:127]
  s_waitcnt vmcnt(18)
  s_barrier
  s_waitcnt lgkmcnt(6)
  v_mfma_f32_16x16x32_bf16 v[112:115], v[56:59], a[192:195], v[112:115]
  ds_read_b64_tr_b16 v[52:53], v10 offset:17568
  ds_read_b64_tr_b16 v[54:55], v10 offset:22176
  v_mfma_f32_16x16x32_bf16 v[116:119], v[56:59], a[196:199], v[116:119]
  buffer_load_dwordx4 a[176:179], v16, s[16:19], s38 offen offset:0 sc1
  v_mfma_f32_16x16x32_bf16 v[120:123], v[56:59], a[200:203], v[120:123]
  s_lshr_b32 s70, s6, 6
  s_lshl_b32 s71, s7, 1
  v_mfma_f32_16x16x32_bf16 v[124:127], v[56:59], a[204:207], v[124:127]
  s_add_u32 s70, s70, s71
  s_lshl_b32 s70, s70, 19
  v_mfma_f32_16x16x32_bf16 v[128:131], v[60:63], a[192:195], v[128:131]
  ds_read_b64_tr_b16 v[56:57], v10 offset:17600
  ds_read_b64_tr_b16 v[58:59], v10 offset:22208
  v_mfma_f32_16x16x32_bf16 v[132:135], v[60:63], a[196:199], v[132:135]
  buffer_load_dwordx4 a[180:183], v16, s[16:19], s38 offen offset:1024 sc1
  v_mfma_f32_16x16x32_bf16 v[136:139], v[60:63], a[200:203], v[136:139]
  s_and_b32 s71, s6, 63
  s_lshl_b32 s71, s71, 11
  v_mfma_f32_16x16x32_bf16 v[140:143], v[60:63], a[204:207], v[140:143]
  s_add_u32 s70, s70, s71
  s_waitcnt lgkmcnt(6)
  v_mfma_f32_16x16x32_bf16 v[144:147], v[64:67], a[192:195], v[144:147]
  ds_read_b64_tr_b16 v[60:61], v10 offset:17632
  ds_read_b64_tr_b16 v[62:63], v10 offset:22240
  v_mfma_f32_16x16x32_bf16 v[148:151], v[64:67], a[196:199], v[148:151]
  buffer_load_dwordx4 a[184:187], v16, s[16:19], s38 offen offset:2048 sc1
  v_mfma_f32_16x16x32_bf16 v[152:155], v[64:67], a[200:203], v[152:155]
  s_add_u32 s70, s70, 393216
  v_mfma_f32_16x16x32_bf16 v[156:159], v[64:67], a[204:207], v[156:159]
  s_add_u32 s72, s46, s70
  s_addc_u32 s73, s47, 0
  v_mfma_f32_16x16x32_bf16 v[160:163], v[68:71], a[192:195], v[160:163]
  ds_read_b64_tr_b16 v[64:65], v10 offset:17664
  ds_read_b64_tr_b16 v[66:67], v10 offset:22272
  v_mfma_f32_16x16x32_bf16 v[164:167], v[68:71], a[196:199], v[164:167]
  buffer_load_dwordx4 a[188:191], v16, s[16:19], s38 offen offset:3072 sc1
  v_mfma_f32_16x16x32_bf16 v[168:171], v[68:71], a[200:203], v[168:171]
  s_mov_b32 s74, 2048
  v_mfma_f32_16x16x32_bf16 v[172:175], v[68:71], a[204:207], v[172:175]
  s_waitcnt lgkmcnt(6)
  v_mfma_f32_16x16x32_bf16 v[176:179], v[48:51], a[192:195], v[176:179]
  ds_read_b64_tr_b16 v[68:69], v5 offset:17408
  ds_read_b64_tr_b16 v[70:71], v5 offset:21504
  v_mfma_f32_16x16x32_bf16 v[180:183], v[48:51], a[196:199], v[180:183]
  s_add_u32 s38, s38, 4096
  v_mfma_f32_16x16x32_bf16 v[184:187], v[48:51], a[200:203], v[184:187]
  s_add_u32 s88, s48, s70
  s_addc_u32 s89, s49, 0
  v_mfma_f32_16x16x32_bf16 v[188:191], v[48:51], a[204:207], v[188:191]
  s_mov_b32 s90, 2048
  s_and_b32 s92, s6, 3
  v_mfma_f32_16x16x32_bf16 v[192:195], v[52:55], a[192:195], v[192:195]
  ds_read_b64_tr_b16 v[48:49], v5 offset:17416
  ds_read_b64_tr_b16 v[50:51], v5 offset:21512
  v_mfma_f32_16x16x32_bf16 v[196:199], v[52:55], a[196:199], v[196:199]
  s_add_u32 m0, s41, 117760
  v_mfma_f32_16x16x32_bf16 v[200:203], v[52:55], a[200:203], v[200:203]
  v_mfma_f32_16x16x32_bf16 v[204:207], v[52:55], a[204:207], v[204:207]
  s_waitcnt lgkmcnt(6)
  v_mfma_f32_16x16x32_bf16 v[208:211], v[56:59], a[192:195], v[208:211]
  ds_read_b64_tr_b16 v[52:53], v6 offset:17408
  ds_read_b64_tr_b16 v[54:55], v6 offset:21504
  v_mfma_f32_16x16x32_bf16 v[212:215], v[56:59], a[196:199], v[212:215]
  buffer_load_dwordx4 v13, s[12:15], s37 offen lds
  v_mfma_f32_16x16x32_bf16 v[216:219], v[56:59], a[200:203], v[216:219]
  v_mfma_f32_16x16x32_bf16 v[220:223], v[56:59], a[204:207], v[220:223]
  v_mfma_f32_16x16x32_bf16 v[224:227], v[60:63], a[192:195], v[224:227]
  ds_read_b64_tr_b16 v[56:57], v6 offset:17416
  ds_read_b64_tr_b16 v[58:59], v6 offset:21512
  v_mfma_f32_16x16x32_bf16 v[228:231], v[60:63], a[196:199], v[228:231]
  buffer_load_dwordx4 v14, s[12:15], s37 offen offset:1024 lds
  v_mfma_f32_16x16x32_bf16 v[232:235], v[60:63], a[200:203], v[232:235]
  v_mfma_f32_16x16x32_bf16 v[236:239], v[60:63], a[204:207], v[236:239]
  s_waitcnt lgkmcnt(6)
  v_mfma_f32_16x16x32_bf16 v[240:243], v[64:67], a[192:195], v[240:243]
  ds_read_b64_tr_b16 v[60:61], v7 offset:17408
  ds_read_b64_tr_b16 v[62:63], v7 offset:21504
  v_mfma_f32_16x16x32_bf16 v[244:247], v[64:67], a[196:199], v[244:247]
  s_mov_b64 exec, 0xffff
  buffer_load_dwordx4 v15, s[12:15], s37 offen offset:2048 lds
  s_mov_b64 exec, -1
  v_mfma_f32_16x16x32_bf16 v[248:251], v[64:67], a[200:203], v[248:251]
  v_mfma_f32_16x16x32_bf16 v[252:255], v[64:67], a[204:207], v[252:255]
  v_mfma_f32_16x16x32_bf16 a[0:3], v[68:71], a[192:195], a[0:3]
  ds_read_b64_tr_b16 v[64:65], v7 offset:17416
  ds_read_b64_tr_b16 v[66:67], v7 offset:21512
  v_mfma_f32_16x16x32_bf16 a[4:7], v[68:71], a[196:199], a[4:7]
  s_add_u32 s37, s37, 294912
  v_mfma_f32_16x16x32_bf16 a[8:11], v[68:71], a[200:203], a[8:11]
  v_mfma_f32_16x16x32_bf16 a[12:15], v[68:71], a[204:207], a[12:15]
  s_waitcnt lgkmcnt(6)
  v_mfma_f32_16x16x32_bf16 a[16:19], v[48:51], a[192:195], a[16:19]
  ds_read_b64_tr_b16 v[68:69], v8 offset:17408
  ds_read_b64_tr_b16 v[70:71], v8 offset:21504
  v_mfma_f32_16x16x32_bf16 a[20:23], v[48:51], a[196:199], a[20:23]
  s_add_u32 m0, s40, 117760
  v_mfma_f32_16x16x32_bf16 a[24:27], v[48:51], a[200:203], a[24:27]
  v_mfma_f32_16x16x32_bf16 a[28:31], v[48:51], a[204:207], a[28:31]
  v_mfma_f32_16x16x32_bf16 a[32:35], v[52:55], a[192:195], a[32:35]
  ds_read_b64_tr_b16 v[48:49], v8 offset:17416
  ds_read_b64_tr_b16 v[50:51], v8 offset:21512
  v_mfma_f32_16x16x32_bf16 a[36:39], v[52:55], a[196:199], a[36:39]
  buffer_load_dwordx4 v11, s[8:11], s36 offen lds
  v_mfma_f32_16x16x32_bf16 a[40:43], v[52:55], a[200:203], a[40:43]
  v_mfma_f32_16x16x32_bf16 a[44:47], v[52:55], a[204:207], a[44:47]
  s_waitcnt lgkmcnt(6)
  v_mfma_f32_16x16x32_bf16 a[48:51], v[56:59], a[192:195], a[48:51]
  ds_read_b64_tr_b16 v[52:53], v9 offset:0
  ds_read_b64_tr_b16 v[54:55], v9 offset:4608
  v_mfma_f32_16x16x32_bf16 a[52:55], v[56:59], a[196:199], a[52:55]
  buffer_load_dwordx4 v12, s[8:11], s36 offen offset:1024 lds
  v_mfma_f32_16x16x32_bf16 a[56:59], v[56:59], a[200:203], a[56:59]
  v_mfma_f32_16x16x32_bf16 a[60:63], v[56:59], a[204:207], a[60:63]
  v_mfma_f32_16x16x32_bf16 a[64:67], v[60:63], a[192:195], a[64:67]
  ds_read_b64_tr_b16 v[56:57], v9 offset:32
  ds_read_b64_tr_b16 v[58:59], v9 offset:4640
  v_mfma_f32_16x16x32_bf16 a[68:71], v[60:63], a[196:199], a[68:71]
  s_add_u32 s36, s36, 262144
  v_mfma_f32_16x16x32_bf16 a[72:75], v[60:63], a[200:203], a[72:75]
  v_mfma_f32_16x16x32_bf16 a[76:79], v[60:63], a[204:207], a[76:79]
  s_waitcnt lgkmcnt(6)
  v_mfma_f32_16x16x32_bf16 a[80:83], v[64:67], a[192:195], a[80:83]
  ds_read_b64_tr_b16 v[60:61], v9 offset:64
  ds_read_b64_tr_b16 v[62:63], v9 offset:4672
  v_mfma_f32_16x16x32_bf16 a[84:87], v[64:67], a[196:199], a[84:87]
  v_mfma_f32_16x16x32_bf16 a[88:91], v[64:67], a[200:203], a[88:91]
  v_mfma_f32_16x16x32_bf16 a[92:95], v[64:67], a[204:207], a[92:95]
  v_mfma_f32_16x16x32_bf16 a[96:99], v[68:71], a[192:195], a[96:99]
  ds_read_b64_tr_b16 v[64:65], v9 offset:96
  ds_read_b64_tr_b16 v[66:67], v9 offset:4704
  v_mfma_f32_16x16x32_bf16 a[100:103], v[68:71], a[196:199], a[100:103]
  v_mfma_f32_16x16x32_bf16 a[104:107], v[68:71], a[200:203], a[104:107]
  v_mfma_f32_16x16x32_bf16 a[108:111], v[68:71], a[204:207], a[108:111]
  s_waitcnt lgkmcnt(6)
  v_mfma_f32_16x16x32_bf16 a[112:115], v[48:51], a[192:195], a[112:115]
  ds_read_b64_tr_b16 v[68:69], v9 offset:128
  ds_read_b64_tr_b16 v[70:71], v9 offset:4736
  v_mfma_f32_16x16x32_bf16 a[116:119], v[48:51], a[196:199], a[116:119]
  v_mfma_f32_16x16x32_bf16 a[120:123], v[48:51], a[200:203], a[120:123]
  v_mfma_f32_16x16x32_bf16 a[124:127], v[48:51], a[204:207], a[124:127]
  s_waitcnt vmcnt(18)
  s_barrier
  v_mfma_f32_16x16x32_bf16 v[112:115], v[52:55], a[128:131], v[112:115]
  ds_read_b64_tr_b16 v[48:49], v9 offset:160
  ds_read_b64_tr_b16 v[50:51], v9 offset:4768
  v_mfma_f32_16x16x32_bf16 v[116:119], v[52:55], a[132:135], v[116:119]
  buffer_load_dwordx4 a[192:195], v16, s[16:19], s38 offen offset:0 sc1
  v_mfma_f32_16x16x32_bf16 v[120:123], v[52:55], a[136:139], v[120:123]
  v_mfma_f32_16x16x32_bf16 v[124:127], v[52:55], a[140:143], v[124:127]
  s_waitcnt lgkmcnt(6)
  v_mfma_f32_16x16x32_bf16 v[128:131], v[56:59], a[128:131], v[128:131]
  ds_read_b64_tr_b16 v[52:53], v9 offset:192
  ds_read_b64_tr_b16 v[54:55], v9 offset:4800
  v_mfma_f32_16x16x32_bf16 v[132:135], v[56:59], a[132:135], v[132:135]
  buffer_load_dwordx4 a[196:199], v16, s[16:19], s38 offen offset:1024 sc1
  v_mfma_f32_16x16x32_bf16 v[136:139], v[56:59], a[136:139], v[136:139]
  v_mfma_f32_16x16x32_bf16 v[140:143], v[56:59], a[140:143], v[140:143]
  v_mfma_f32_16x16x32_bf16 v[144:147], v[60:63], a[128:131], v[144:147]
  ds_read_b64_tr_b16 v[56:57], v9 offset:224
  ds_read_b64_tr_b16 v[58:59], v9 offset:4832
  v_mfma_f32_16x16x32_bf16 v[148:151], v[60:63], a[132:135], v[148:151]
  buffer_load_dwordx4 a[200:203], v16, s[16:19], s38 offen offset:2048 sc1
  v_mfma_f32_16x16x32_bf16 v[152:155], v[60:63], a[136:139], v[152:155]
  v_mfma_f32_16x16x32_bf16 v[156:159], v[60:63], a[140:143], v[156:159]
  s_waitcnt lgkmcnt(6)
  v_mfma_f32_16x16x32_bf16 v[160:163], v[64:67], a[128:131], v[160:163]
  ds_read_b64_tr_b16 v[60:61], v9 offset:256
  ds_read_b64_tr_b16 v[62:63], v9 offset:4864
  v_mfma_f32_16x16x32_bf16 v[164:167], v[64:67], a[132:135], v[164:167]
  buffer_load_dwordx4 a[204:207], v16, s[16:19], s38 offen offset:3072 sc1
  v_mfma_f32_16x16x32_bf16 v[168:171], v[64:67], a[136:139], v[168:171]
  v_mfma_f32_16x16x32_bf16 v[172:175], v[64:67], a[140:143], v[172:175]
  v_mfma_f32_16x16x32_bf16 v[176:179], v[68:71], a[128:131], v[176:179]
  ds_read_b64_tr_b16 v[64:65], v1 offset:0
  ds_read_b64_tr_b16 v[66:67], v1 offset:4096
  v_mfma_f32_16x16x32_bf16 v[180:183], v[68:71], a[132:135], v[180:183]
  s_add_u32 s38, s38, 4096
  v_mfma_f32_16x16x32_bf16 v[184:187], v[68:71], a[136:139], v[184:187]
  v_mfma_f32_16x16x32_bf16 v[188:191], v[68:71], a[140:143], v[188:191]
  s_waitcnt lgkmcnt(6)
  v_mfma_f32_16x16x32_bf16 v[192:195], v[48:51], a[128:131], v[192:195]
  ds_read_b64_tr_b16 v[68:69], v1 offset:8
  ds_read_b64_tr_b16 v[70:71], v1 offset:4104
  v_mfma_f32_16x16x32_bf16 v[196:199], v[48:51], a[132:135], v[196:199]
  s_add_u32 m0, s41, 135168
  v_mfma_f32_16x16x32_bf16 v[200:203], v[48:51], a[136:139], v[200:203]
  v_mfma_f32_16x16x32_bf16 v[204:207], v[48:51], a[140:143], v[204:207]
  v_mfma_f32_16x16x32_bf16 v[208:211], v[52:55], a[128:131], v[208:211]
  ds_read_b64_tr_b16 v[48:49], v2 offset:0
  ds_read_b64_tr_b16 v[50:51], v2 offset:4096
  v_mfma_f32_16x16x32_bf16 v[212:215], v[52:55], a[132:135], v[212:215]
  buffer_load_dwordx4 v13, s[12:15], s37 offen lds
  v_mfma_f32_16x16x32_bf16 v[216:219], v[52:55], a[136:139], v[216:219]
  v_mfma_f32_16x16x32_bf16 v[220:223], v[52:55], a[140:143], v[220:223]
  s_waitcnt lgkmcnt(6)
  v_mfma_f32_16x16x32_bf16 v[224:227], v[56:59], a[128:131], v[224:227]
  ds_read_b64_tr_b16 v[52:53], v2 offset:8
  ds_read_b64_tr_b16 v[54:55], v2 offset:4104
  v_mfma_f32_16x16x32_bf16 v[228:231], v[56:59], a[132:135], v[228:231]
  buffer_load_dwordx4 v14, s[12:15], s37 offen offset:1024 lds
  v_mfma_f32_16x16x32_bf16 v[232:235], v[56:59], a[136:139], v[232:235]
  v_mfma_f32_16x16x32_bf16 v[236:239], v[56:59], a[140:143], v[236:239]
  v_mfma_f32_16x16x32_bf16 v[240:243], v[60:63], a[128:131], v[240:243]
  ds_read_b64_tr_b16 v[56:57], v3 offset:0
  ds_read_b64_tr_b16 v[58:59], v3 offset:4096
  v_mfma_f32_16x16x32_bf16 v[244:247], v[60:63], a[132:135], v[244:247]
  s_mov_b64 exec, 0xffff
  buffer_load_dwordx4 v15, s[12:15], s37 offen offset:2048 lds
  s_mov_b64 exec, -1
  v_mfma_f32_16x16x32_bf16 v[248:251], v[60:63], a[136:139], v[248:251]
  v_mfma_f32_16x16x32_bf16 v[252:255], v[60:63], a[140:143], v[252:255]
  s_waitcnt lgkmcnt(6)
  v_mfma_f32_16x16x32_bf16 a[0:3], v[64:67], a[128:131], a[0:3]
  ds_read_b64_tr_b16 v[60:61], v3 offset:8
  ds_read_b64_tr_b16 v[62:63], v3 offset:4104
  v_mfma_f32_16x16x32_bf16 a[4:7], v[64:67], a[132:135], a[4:7]
  s_add_u32 s37, s37, 294912
  v_mfma_f32_16x16x32_bf16 a[8:11], v[64:67], a[136:139], a[8:11]
  v_mfma_f32_16x16x32_bf16 a[12:15], v[64:67], a[140:143], a[12:15]
  v_mfma_f32_16x16x32_bf16 a[16:19], v[68:71], a[128:131], a[16:19]
  ds_read_b64_tr_b16 v[64:65], v4 offset:0
  ds_read_b64_tr_b16 v[66:67], v4 offset:4096
  v_mfma_f32_16x16x32_bf16 a[20:23], v[68:71], a[132:135], a[20:23]
  s_add_u32 m0, s40, 135168
  v_mfma_f32_16x16x32_bf16 a[24:27], v[68:71], a[136:139], a[24:27]
  v_mfma_f32_16x16x32_bf16 a[28:31], v[68:71], a[140:143], a[28:31]
  s_waitcnt lgkmcnt(6)
  v_mfma_f32_16x16x32_bf16 a[32:35], v[48:51], a[128:131], a[32:35]
  ds_read_b64_tr_b16 v[68:69], v4 offset:8
  ds_read_b64_tr_b16 v[70:71], v4 offset:4104
  v_mfma_f32_16x16x32_bf16 a[36:39], v[48:51], a[132:135], a[36:39]
  buffer_load_dwordx4 v11, s[8:11], s36 offen lds
  v_mfma_f32_16x16x32_bf16 a[40:43], v[48:51], a[136:139], a[40:43]
  v_mfma_f32_16x16x32_bf16 a[44:47], v[48:51], a[140:143], a[44:47]
  v_mfma_f32_16x16x32_bf16 a[48:51], v[52:55], a[128:131], a[48:51]
  ds_read_b64_tr_b16 v[48:49], v9 offset:17408
  ds_read_b64_tr_b16 v[50:51], v9 offset:22016
  v_mfma_f32_16x16x32_bf16 a[52:55], v[52:55], a[132:135], a[52:55]
  buffer_load_dwordx4 v12, s[8:11], s36 offen offset:1024 lds
  v_mfma_f32_16x16x32_bf16 a[56:59], v[52:55], a[136:139], a[56:59]
  v_mfma_f32_16x16x32_bf16 a[60:63], v[52:55], a[140:143], a[60:63]
  s_waitcnt lgkmcnt(6)
  v_mfma_f32_16x16x32_bf16 a[64:67], v[56:59], a[128:131], a[64:67]
  ds_read_b64_tr_b16 v[52:53], v9 offset:17440
  ds_read_b64_tr_b16 v[54:55], v9 offset:22048
  v_mfma_f32_16x16x32_bf16 a[68:71], v[56:59], a[132:135], a[68:71]
  s_add_u32 s36, s36, 262144
  v_mfma_f32_16x16x32_bf16 a[72:75], v[56:59], a[136:139], a[72:75]
  v_mfma_f32_16x16x32_bf16 a[76:79], v[56:59], a[140:143], a[76:79]
  v_mfma_f32_16x16x32_bf16 a[80:83], v[60:63], a[128:131], a[80:83]
  ds_read_b64_tr_b16 v[56:57], v9 offset:17472
  ds_read_b64_tr_b16 v[58:59], v9 offset:22080
  v_mfma_f32_16x16x32_bf16 a[84:87], v[60:63], a[132:135], a[84:87]
  v_mfma_f32_16x16x32_bf16 a[88:91], v[60:63], a[136:139], a[88:91]
  v_mfma_f32_16x16x32_bf16 a[92:95], v[60:63], a[140:143], a[92:95]
  s_waitcnt lgkmcnt(6)
  v_mfma_f32_16x16x32_bf16 a[96:99], v[64:67], a[128:131], a[96:99]
  ds_read_b64_tr_b16 v[60:61], v9 offset:17504
  ds_read_b64_tr_b16 v[62:63], v9 offset:22112
  v_mfma_f32_16x16x32_bf16 a[100:103], v[64:67], a[132:135], a[100:103]
  v_mfma_f32_16x16x32_bf16 a[104:107], v[64:67], a[136:139], a[104:107]
  v_mfma_f32_16x16x32_bf16 a[108:111], v[64:67], a[140:143], a[108:111]
  v_mfma_f32_16x16x32_bf16 a[112:115], v[68:71], a[128:131], a[112:115]
  ds_read_b64_tr_b16 v[64:65], v9 offset:17536
  ds_read_b64_tr_b16 v[66:67], v9 offset:22144
  v_mfma_f32_16x16x32_bf16 a[116:119], v[68:71], a[132:135], a[116:119]
  v_mfma_f32_16x16x32_bf16 a[120:123], v[68:71], a[136:139], a[120:123]
  v_mfma_f32_16x16x32_bf16 a[124:127], v[68:71], a[140:143], a[124:127]
  s_waitcnt vmcnt(18)
  s_barrier
  s_waitcnt lgkmcnt(6)
  v_mfma_f32_16x16x32_bf16 v[112:115], v[48:51], a[144:147], v[112:115]
  ds_read_b64_tr_b16 v[68:69], v9 offset:17568
  ds_read_b64_tr_b16 v[70:71], v9 offset:22176
  v_mfma_f32_16x16x32_bf16 v[116:119], v[48:51], a[148:151], v[116:119]
  buffer_load_dwordx4 a[128:131], v16, s[16:19], s38 offen offset:0 sc1
  v_mfma_f32_16x16x32_bf16 v[120:123], v[48:51], a[152:155], v[120:123]
  v_add_u32 v95, 0, v39
  v_mul_u32_u24 v96, 3641, v95
  v_mfma_f32_16x16x32_bf16 v[124:127], v[48:51], a[156:159], v[124:127]
  v_lshrrev_b32 v96, 16, v96
  v_mul_u32_u24 v97, 18, v96
  v_mfma_f32_16x16x32_bf16 v[128:131], v[52:55], a[144:147], v[128:131]
  ds_read_b64_tr_b16 v[48:49], v9 offset:17600
  ds_read_b64_tr_b16 v[50:51], v9 offset:22208
  v_mfma_f32_16x16x32_bf16 v[132:135], v[52:55], a[148:151], v[132:135]
  buffer_load_dwordx4 a[132:135], v16, s[16:19], s38 offen offset:1024 sc1
  v_mfma_f32_16x16x32_bf16 v[136:139], v[52:55], a[152:155], v[136:139]
  v_sub_u32 v97, v95, v97
  v_mul_u32_u24 v96, 1152, v96
  v_mfma_f32_16x16x32_bf16 v[140:143], v[52:55], a[156:159], v[140:143]
  v_lshlrev_b32 v97, 4, v97
  s_waitcnt lgkmcnt(6)
  v_mfma_f32_16x16x32_bf16 v[144:147], v[56:59], a[144:147], v[144:147]
  ds_read_b64_tr_b16 v[52:53], v9 offset:17632
  ds_read_b64_tr_b16 v[54:55], v9 offset:22240
  v_mfma_f32_16x16x32_bf16 v[148:151], v[56:59], a[148:151], v[148:151]
  buffer_load_dwordx4 a[136:139], v16, s[16:19], s38 offen offset:2048 sc1
  v_mfma_f32_16x16x32_bf16 v[152:155], v[56:59], a[152:155], v[152:155]
  v_add_u32 v96, v96, v97
  v_accvgpr_write_b32 a216, v96
  v_mfma_f32_16x16x32_bf16 v[156:159], v[56:59], a[156:159], v[156:159]
  v_add_u32 v95, 64, v39
  v_mul_u32_u24 v96, 3641, v95
  v_mfma_f32_16x16x32_bf16 v[160:163], v[60:63], a[144:147], v[160:163]
  ds_read_b64_tr_b16 v[56:57], v9 offset:17664
  ds_read_b64_tr_b16 v[58:59], v9 offset:22272
  v_mfma_f32_16x16x32_bf16 v[164:167], v[60:63], a[148:151], v[164:167]
  buffer_load_dwordx4 a[140:143], v16, s[16:19], s38 offen offset:3072 sc1
  v_mfma_f32_16x16x32_bf16 v[168:171], v[60:63], a[152:155], v[168:171]
  v_lshrrev_b32 v96, 16, v96
  v_mul_u32_u24 v97, 18, v96
  v_mfma_f32_16x16x32_bf16 v[172:175], v[60:63], a[156:159], v[172:175]
  v_sub_u32 v97, v95, v97
  s_waitcnt lgkmcnt(6)
  v_mfma_f32_16x16x32_bf16 v[176:179], v[64:67], a[144:147], v[176:179]
  ds_read_b64_tr_b16 v[60:61], v1 offset:17408
  ds_read_b64_tr_b16 v[62:63], v1 offset:21504
  v_mfma_f32_16x16x32_bf16 v[180:183], v[64:67], a[148:151], v[180:183]
  s_add_u32 s38, s38, 4096
  v_mul_u32_u24 v96, 1152, v96
  v_mfma_f32_16x16x32_bf16 v[184:187], v[64:67], a[152:155], v[184:187]
  v_lshlrev_b32 v97, 4, v97
  v_add_u32 v96, v96, v97
  v_mfma_f32_16x16x32_bf16 v[188:191], v[64:67], a[156:159], v[188:191]
  v_subrev_u32 v96, 1024, v96
  v_accvgpr_write_b32 a217, v96
  v_mfma_f32_16x16x32_bf16 v[192:195], v[68:71], a[144:147], v[192:195]
  ds_read_b64_tr_b16 v[64:65], v1 offset:17416
  ds_read_b64_tr_b16 v[66:67], v1 offset:21512
  v_mfma_f32_16x16x32_bf16 v[196:199], v[68:71], a[148:151], v[196:199]
  s_add_u32 m0, s41, 65536
  v_add_u32 v95, 128, v39
  v_mfma_f32_16x16x32_bf16 v[200:203], v[68:71], a[152:155], v[200:203]
  v_mul_u32_u24 v96, 3641, v95
  v_lshrrev_b32 v96, 16, v96
  v_mfma_f32_16x16x32_bf16 v[204:207], v[68:71], a[156:159], v[204:207]
  v_mul_u32_u24 v97, 18, v96
  s_waitcnt lgkmcnt(6)
  v_mfma_f32_16x16x32_bf16 v[208:211], v[48:51], a[144:147], v[208:211]
  ds_read_b64_tr_b16 v[68:69], v2 offset:17408
  ds_read_b64_tr_b16 v[70:71], v2 offset:21504
  v_mfma_f32_16x16x32_bf16 v[212:215], v[48:51], a[148:151], v[212:215]
  buffer_load_dwordx4 v13, s[12:15], s37 offen lds
  v_mfma_f32_16x16x32_bf16 v[216:219], v[48:51], a[152:155], v[216:219]
  v_sub_u32 v97, v95, v97
  v_mul_u32_u24 v96, 1152, v96
  v_mfma_f32_16x16x32_bf16 v[220:223], v[48:51], a[156:159], v[220:223]
  v_lshlrev_b32 v97, 4, v97
  v_add_u32 v96, v96, v97
  v_mfma_f32_16x16x32_bf16 v[224:227], v[52:55], a[144:147], v[224:227]
  ds_read_b64_tr_b16 v[48:49], v2 offset:17416
  ds_read_b64_tr_b16 v[50:51], v2 offset:21512
  v_mfma_f32_16x16x32_bf16 v[228:231], v[52:55], a[148:151], v[228:231]
  buffer_load_dwordx4 v14, s[12:15], s37 offen offset:1024 lds
  v_mfma_f32_16x16x32_bf16 v[232:235], v[52:55], a[152:155], v[232:235]
  v_subrev_u32 v96, 2048, v96
  v_accvgpr_write_b32 a218, v96
  v_mfma_f32_16x16x32_bf16 v[236:239], v[52:55], a[156:159], v[236:239]
  v_add_u32 v95, 192, v39
  s_waitcnt lgkmcnt(6)
  v_mfma_f32_16x16x32_bf16 v[240:243], v[56:59], a[144:147], v[240:243]
  ds_read_b64_tr_b16 v[52:53], v3 offset:17408
  ds_read_b64_tr_b16 v[54:55], v3 offset:21504
  v_mfma_f32_16x16x32_bf16 v[244:247], v[56:59], a[148:151], v[244:247]
  s_mov_b64 exec, 0xffff
  buffer_load_dwordx4 v15, s[12:15], s37 offen offset:2048 lds
  s_mov_b64 exec, -1
  v_mfma_f32_16x16x32_bf16 v[248:251], v[56:59], a[152:155], v[248:251]
  v_mul_u32_u24 v96, 3641, v95
  v_lshrrev_b32 v96, 16, v96
  v_mfma_f32_16x16x32_bf16 v[252:255], v[56:59], a[156:159], v[252:255]
  v_mul_u32_u24 v97, 18, v96
  v_sub_u32 v97, v95, v97
  v_mfma_f32_16x16x32_bf16 a[0:3], v[60:63], a[144:147], a[0:3]
  ds_read_b64_tr_b16 v[56:57], v3 offset:17416
  ds_read_b64_tr_b16 v[58:59], v3 offset:21512
  v_mfma_f32_16x16x32_bf16 a[4:7], v[60:63], a[148:151], a[4:7]
  s_add_u32 s37, s37, 294912
  v_mul_u32_u24 v96, 1152, v96
  v_mfma_f32_16x16x32_bf16 a[8:11], v[60:63], a[152:155], a[8:11]
  v_lshlrev_b32 v97, 4, v97
  v_add_u32 v96, v96, v97
  v_mfma_f32_16x16x32_bf16 a[12:15], v[60:63], a[156:159], a[12:15]
  v_subrev_u32 v96, 3072, v96
  s_waitcnt lgkmcnt(6)
  v_mfma_f32_16x16x32_bf16 a[16:19], v[64:67], a[144:147], a[16:19]
  ds_read_b64_tr_b16 v[60:61], v4 offset:17408
  ds_read_b64_tr_b16 v[62:63], v4 offset:21504
  v_mfma_f32_16x16x32_bf16 a[20:23], v[64:67], a[148:151], a[20:23]
  s_add_u32 m0, s40, 65536
  v_accvgpr_write_b32 a219, v96
  v_mfma_f32_16x16x32_bf16 a[24:27], v[64:67], a[152:155], a[24:27]
  v_add_u32 v95, 256, v39
  v_mul_u32_u24 v96, 3641, v95
  v_mfma_f32_16x16x32_bf16 a[28:31], v[64:67], a[156:159], a[28:31]
  v_lshrrev_b32 v96, 16, v96
  v_mul_u32_u24 v97, 18, v96
  v_mfma_f32_16x16x32_bf16 a[32:35], v[68:71], a[144:147], a[32:35]
  ds_read_b64_tr_b16 v[64:65], v4 offset:17416
  ds_read_b64_tr_b16 v[66:67], v4 offset:21512
  v_mfma_f32_16x16x32_bf16 a[36:39], v[68:71], a[148:151], a[36:39]
  buffer_load_dwordx4 v11, s[8:11], s36 offen lds
  v_mfma_f32_16x16x32_bf16 a[40:43], v[68:71], a[152:155], a[40:43]
  v_sub_u32 v97, v95, v97
  v_mul_u32_u24 v96, 1152, v96
  v_mfma_f32_16x16x32_bf16 a[44:47], v[68:71], a[156:159], a[44:47]
  v_lshlrev_b32 v97, 4, v97
  s_waitcnt lgkmcnt(6)
  v_mfma_f32_16x16x32_bf16 a[48:51], v[48:51], a[144:147], a[48:51]
  ds_read_b64_tr_b16 v[68:69], v9 offset:34816
  ds_read_b64_tr_b16 v[70:71], v9 offset:39424
  v_mfma_f32_16x16x32_bf16 a[52:55], v[48:51], a[148:151], a[52:55]
  buffer_load_dwordx4 v12, s[8:11], s36 offen offset:1024 lds
  v_mfma_f32_16x16x32_bf16 a[56:59], v[48:51], a[152:155], a[56:59]
  v_add_u32 v96, v96, v97
  v_accvgpr_write_b32 a220, v96
  v_mfma_f32_16x16x32_bf16 a[60:63], v[48:51], a[156:159], a[60:63]
  v_add_u32 v95, 320, v39
  v_mul_u32_u24 v96, 3641, v95
  v_mfma_f32_16x16x32_bf16 a[64:67], v[52:55], a[144:147], a[64:67]
  ds_read_b64_tr_b16 v[48:49], v9 offset:34848
  ds_read_b64_tr_b16 v[50:51], v9 offset:39456
  v_mfma_f32_16x16x32_bf16 a[68:71], v[52:55], a[148:151], a[68:71]
  s_add_u32 s36, s36, 262144
  v_lshrrev_b32 v96, 16, v96
  v_mfma_f32_16x16x32_bf16 a[72:75], v[52:55], a[152:155], a[72:75]
  v_mul_u32_u24 v97, 18, v96
  v_sub_u32 v97, v95, v97
  v_mfma_f32_16x16x32_bf16 a[76:79], v[52:55], a[156:159], a[76:79]
  v_mul_u32_u24 v96, 1152, v96
  s_waitcnt lgkmcnt(6)
  v_mfma_f32_16x16x32_bf16 a[80:83], v[56:59], a[144:147], a[80:83]
  ds_read_b64_tr_b16 v[52:53], v9 offset:34880
  ds_read_b64_tr_b16 v[54:55], v9 offset:39488
  v_mfma_f32_16x16x32_bf16 a[84:87], v[56:59], a[148:151], a[84:87]
  v_lshlrev_b32 v97, 4, v97
  v_add_u32 v96, v96, v97
  v_mfma_f32_16x16x32_bf16 a[88:91], v[56:59], a[152:155], a[88:91]
  v_subrev_u32 v96, 1024, v96
  v_accvgpr_write_b32 a221, v96
  v_mfma_f32_16x16x32_bf16 a[92:95], v[56:59], a[156:159], a[92:95]
  v_add_u32 v95, 384, v39
  v_mul_u32_u24 v96, 3641, v95
  v_mfma_f32_16x16x32_bf16 a[96:99], v[60:63], a[144:147], a[96:99]
  ds_read_b64_tr_b16 v[56:57], v9 offset:34912
  ds_read_b64_tr_b16 v[58:59], v9 offset:39520
  v_mfma_f32_16x16x32_bf16 a[100:103], v[60:63], a[148:151], a[100:103]
  v_lshrrev_b32 v96, 16, v96
  v_mul_u32_u24 v97, 18, v96
  v_mfma_f32_16x16x32_bf16 a[104:107], v[60:63], a[152:155], a[104:107]
  v_sub_u32 v97, v95, v97
  v_mul_u32_u24 v96, 1152, v96
  v_mfma_f32_16x16x32_bf16 a[108:111], v[60:63], a[156:159], a[108:111]
  v_lshlrev_b32 v97, 4, v97
  s_waitcnt lgkmcnt(6)
  v_mfma_f32_16x16x32_bf16 a[112:115], v[64:67], a[144:147], a[112:115]
  ds_read_b64_tr_b16 v[60:61], v9 offset:34944
  ds_read_b64_tr_b16 v[62:63], v9 offset:39552
  v_mfma_f32_16x16x32_bf16 a[116:119], v[64:67], a[148:151], a[116:119]
  v_add_u32 v96, v96, v97
  v_subrev_u32 v96, 2048, v96
  v_mfma_f32_16x16x32_bf16 a[120:123], v[64:67], a[152:155], a[120:123]
  v_accvgpr_write_b32 a222, v96
  v_add_u32 v95, 448, v39
  v_mfma_f32_16x16x32_bf16 a[124:127], v[64:67], a[156:159], a[124:127]
  s_waitcnt vmcnt(18)
  s_barrier
  v_mfma_f32_16x16x32_bf16 v[112:115], v[68:71], a[160:163], v[112:115]
  ds_read_b64_tr_b16 v[64:65], v9 offset:34976
  ds_read_b64_tr_b16 v[66:67], v9 offset:39584
  v_mfma_f32_16x16x32_bf16 v[116:119], v[68:71], a[164:167], v[116:119]
  buffer_load_dwordx4 a[144:147], v16, s[16:19], s38 offen offset:0 sc1
  v_mfma_f32_16x16x32_bf16 v[120:123], v[68:71], a[168:171], v[120:123]
  v_mul_u32_u24 v96, 3641, v95
  v_lshrrev_b32 v96, 16, v96
  v_mfma_f32_16x16x32_bf16 v[124:127], v[68:71], a[172:175], v[124:127]
  v_mul_u32_u24 v97, 18, v96
  s_waitcnt lgkmcnt(6)
  v_mfma_f32_16x16x32_bf16 v[128:131], v[48:51], a[160:163], v[128:131]
  ds_read_b64_tr_b16 v[68:69], v9 offset:35008
  ds_read_b64_tr_b16 v[70:71], v9 offset:39616
  v_mfma_f32_16x16x32_bf16 v[132:135], v[48:51], a[164:167], v[132:135]
  buffer_load_dwordx4 a[148:151], v16, s[16:19], s38 offen offset:1024 sc1
  v_mfma_f32_16x16x32_bf16 v[136:139], v[48:51], a[168:171], v[136:139]
  v_sub_u32 v97, v95, v97
  v_mul_u32_u24 v96, 1152, v96
  v_mfma_f32_16x16x32_bf16 v[140:143], v[48:51], a[172:175], v[140:143]
  v_lshlrev_b32 v97, 4, v97
  v_add_u32 v96, v96, v97
  v_mfma_f32_16x16x32_bf16 v[144:147], v[52:55], a[160:163], v[144:147]
  ds_read_b64_tr_b16 v[48:49], v9 offset:35040
  ds_read_b64_tr_b16 v[50:51], v9 offset:39648
  v_mfma_f32_16x16x32_bf16 v[148:151], v[52:55], a[164:167], v[148:151]
  buffer_load_dwordx4 a[152:155], v16, s[16:19], s38 offen offset:2048 sc1
  v_mfma_f32_16x16x32_bf16 v[152:155], v[52:55], a[168:171], v[152:155]
  v_subrev_u32 v96, 3072, v96
  v_accvgpr_write_b32 a223, v96
  v_mfma_f32_16x16x32_bf16 v[156:159], v[52:55], a[172:175], v[156:159]
  v_add_u32 v95, 512, v39
  s_waitcnt lgkmcnt(6)
  v_mfma_f32_16x16x32_bf16 v[160:163], v[56:59], a[160:163], v[160:163]
  ds_read_b64_tr_b16 v[52:53], v9 offset:35072
  ds_read_b64_tr_b16 v[54:55], v9 offset:39680
  v_mfma_f32_16x16x32_bf16 v[164:167], v[56:59], a[164:167], v[164:167]
  buffer_load_dwordx4 a[156:159], v16, s[16:19], s38 offen offset:3072 sc1
  v_mfma_f32_16x16x32_bf16 v[168:171], v[56:59], a[168:171], v[168:171]
  v_mul_u32_u24 v96, 3641, v95
  v_lshrrev_b32 v96, 16, v96
  v_mfma_f32_16x16x32_bf16 v[172:175], v[56:59], a[172:175], v[172:175]
  v_mul_u32_u24 v97, 18, v96
  v_sub_u32 v97, v95, v97
  v_mfma_f32_16x16x32_bf16 v[176:179], v[60:63], a[160:163], v[176:179]
  ds_read_b64_tr_b16 v[56:57], v1 offset:34816
  ds_read_b64_tr_b16 v[58:59], v1 offset:38912
  v_mfma_f32_16x16x32_bf16 v[180:183], v[60:63], a[164:167], v[180:183]
  s_add_u32 s38, s38, 4096
  v_mul_u32_u24 v96, 1152, v96
  v_mfma_f32_16x16x32_bf16 v[184:187], v[60:63], a[168:171], v[184:187]
  v_lshlrev_b32 v97, 4, v97
  v_add_u32 v96, v96, v97
  v_mfma_f32_16x16x32_bf16 v[188:191], v[60:63], a[172:175], v[188:191]
  v_accvgpr_write_b32 a224, v96
  s_waitcnt lgkmcnt(6)
  v_mfma_f32_16x16x32_bf16 v[192:195], v[64:67], a[160:163], v[192:195]
  ds_read_b64_tr_b16 v[60:61], v1 offset:34824
  ds_read_b64_tr_b16 v[62:63], v1 offset:38920
  v_mfma_f32_16x16x32_bf16 v[196:199], v[64:67], a[164:167], v[196:199]
  s_add_u32 m0, s41, 82944
  v_mul_u32_u24 v95, 288, v44
  v_mfma_f32_16x16x32_bf16 v[200:203], v[64:67], a[168:171], v[200:203]
  v_lshlrev_b32 v96, 3, v42
  v_add_u32 v95, v95, v96
  v_mfma_f32_16x16x32_bf16 v[204:207], v[64:67], a[172:175], v[204:207]
  v_accvgpr_write_b32 a225, v95
  v_add_u32 v96, 65536, v95
  v_mfma_f32_16x16x32_bf16 v[208:211], v[68:71], a[160:163], v[208:211]
  ds_read_b64_tr_b16 v[64:65], v2 offset:34816
  ds_read_b64_tr_b16 v[66:67], v2 offset:38912
  v_mfma_f32_16x16x32_bf16 v[212:215], v[68:71], a[164:167], v[212:215]
  buffer_load_dwordx4 v13, s[12:15], s37 offen lds
  v_mfma_f32_16x16x32_bf16 v[216:219], v[68:71], a[168:171], v[216:219]
  v_accvgpr_write_b32 a226, v96
  v_add_u32 v96, 120832, v95
  v_mfma_f32_16x16x32_bf16 v[220:223], v[68:71], a[172:175], v[220:223]
  v_accvgpr_write_b32 a227, v96
  s_waitcnt lgkmcnt(6)
  v_mfma_f32_16x16x32_bf16 v[224:227], v[48:51], a[160:163], v[224:227]
  ds_read_b64_tr_b16 v[68:69], v2 offset:34824
  ds_read_b64_tr_b16 v[70:71], v2 offset:38920
  v_mfma_f32_16x16x32_bf16 v[228:231], v[48:51], a[164:167], v[228:231]
  buffer_load_dwordx4 v14, s[12:15], s37 offen offset:1024 lds
  v_mfma_f32_16x16x32_bf16 v[232:235], v[48:51], a[168:171], v[232:235]
  v_lshrrev_b32 v96, 1, v16
  v_accvgpr_write_b32 a228, v96
  v_mfma_f32_16x16x32_bf16 v[236:239], v[48:51], a[172:175], v[236:239]
  v_lshrrev_b32 v95, 3, v39
  v_lshlrev_b32 v95, 12, v95
  v_mfma_f32_16x16x32_bf16 v[240:243], v[52:55], a[160:163], v[240:243]
  ds_read_b64_tr_b16 v[48:49], v3 offset:34816
  ds_read_b64_tr_b16 v[50:51], v3 offset:38912
  v_mfma_f32_16x16x32_bf16 v[244:247], v[52:55], a[164:167], v[244:247]
  s_mov_b64 exec, 0xffff
  buffer_load_dwordx4 v15, s[12:15], s37 offen offset:2048 lds
  s_mov_b64 exec, -1
  v_mfma_f32_16x16x32_bf16 v[248:251], v[52:55], a[168:171], v[248:251]
  v_and_b32 v96, 7, v39
  v_lshlrev_b32 v96, 7, v96
  v_mfma_f32_16x16x32_bf16 v[252:255], v[52:55], a[172:175], v[252:255]
  v_add_u32 v95, v95, v96
  s_waitcnt lgkmcnt(6)
  v_mfma_f32_16x16x32_bf16 a[0:3], v[56:59], a[160:163], a[0:3]
  ds_read_b64_tr_b16 v[52:53], v3 offset:34824
  ds_read_b64_tr_b16 v[54:55], v3 offset:38920
  v_mfma_f32_16x16x32_bf16 a[4:7], v[56:59], a[164:167], a[4:7]
  s_add_u32 s37, s37, 294912
  s_bfe_u32 s76, s2, 0x20003
  v_mfma_f32_16x16x32_bf16 a[8:11], v[56:59], a[168:171], a[8:11]
  s_lshl_b32 s76, s76, 10
  v_add_u32 v95, s76, v95
  v_mfma_f32_16x16x32_bf16 a[12:15], v[56:59], a[172:175], a[12:15]
  v_accvgpr_write_b32 a229, v95
  s_and_b32 s76, s2, 0xe7
  v_mfma_f32_16x16x32_bf16 a[16:19], v[60:63], a[160:163], a[16:19]
  ds_read_b64_tr_b16 v[56:57], v4 offset:34816
  ds_read_b64_tr_b16 v[58:59], v4 offset:38912
  v_mfma_f32_16x16x32_bf16 a[20:23], v[60:63], a[164:167], a[20:23]
  s_add_u32 m0, s40, 82944
  s_xor_b32 s76, s76, 1
  v_mfma_f32_16x16x32_bf16 a[24:27], v[60:63], a[168:171], a[24:27]
  v_and_b32 v95, 3, v39
  v_lshlrev_b32 v95, 3, v95
  v_mfma_f32_16x16x32_bf16 a[28:31], v[60:63], a[172:175], a[28:31]
  v_add_u32 v95, s76, v95
  s_waitcnt lgkmcnt(6)
  v_mfma_f32_16x16x32_bf16 a[32:35], v[64:67], a[160:163], a[32:35]
  ds_read_b64_tr_b16 v[60:61], v4 offset:34824
  ds_read_b64_tr_b16 v[62:63], v4 offset:38920
  v_mfma_f32_16x16x32_bf16 a[36:39], v[64:67], a[164:167], a[36:39]
  buffer_load_dwordx4 v11, s[8:11], s36 offen lds
  v_mfma_f32_16x16x32_bf16 a[40:43], v[64:67], a[168:171], a[40:43]
  v_lshlrev_b32 v95, 10, v95
  v_accvgpr_write_b32 a230, v95
  v_mfma_f32_16x16x32_bf16 a[44:47], v[64:67], a[172:175], a[44:47]
  v_mfma_f32_16x16x32_bf16 a[48:51], v[68:71], a[160:163], a[48:51]
  ds_read_b64_tr_b16 v[64:65], v10 offset:0
  ds_read_b64_tr_b16 v[66:67], v10 offset:4608
  v_mfma_f32_16x16x32_bf16 a[52:55], v[68:71], a[164:167], a[52:55]
  buffer_load_dwordx4 v12, s[8:11], s36 offen offset:1024 lds
  v_mfma_f32_16x16x32_bf16 a[56:59], v[68:71], a[168:171], a[56:59]
  v_mfma_f32_16x16x32_bf16 a[60:63], v[68:71], a[172:175], a[60:63]
  s_waitcnt lgkmcnt(6)
  v_mfma_f32_16x16x32_bf16 a[64:67], v[48:51], a[160:163], a[64:67]
  ds_read_b64_tr_b16 v[68:69], v10 offset:32
  ds_read_b64_tr_b16 v[70:71], v10 offset:4640
  v_mfma_f32_16x16x32_bf16 a[68:71], v[48:51], a[164:167], a[68:71]
  s_add_u32 s36, s36, 262144
  v_mfma_f32_16x16x32_bf16 a[72:75], v[48:51], a[168:171], a[72:75]
  v_mfma_f32_16x16x32_bf16 a[76:79], v[48:51], a[172:175], a[76:79]
  v_mfma_f32_16x16x32_bf16 a[80:83], v[52:55], a[160:163], a[80:83]
  ds_read_b64_tr_b16 v[48:49], v10 offset:64
  ds_read_b64_tr_b16 v[50:51], v10 offset:4672
  v_mfma_f32_16x16x32_bf16 a[84:87], v[52:55], a[164:167], a[84:87]
  v_mfma_f32_16x16x32_bf16 a[88:91], v[52:55], a[168:171], a[88:91]
  v_mfma_f32_16x16x32_bf16 a[92:95], v[52:55], a[172:175], a[92:95]
  s_waitcnt lgkmcnt(6)
  v_mfma_f32_16x16x32_bf16 a[96:99], v[56:59], a[160:163], a[96:99]
  ds_read_b64_tr_b16 v[52:53], v10 offset:96
  ds_read_b64_tr_b16 v[54:55], v10 offset:4704
  v_mfma_f32_16x16x32_bf16 a[100:103], v[56:59], a[164:167], a[100:103]
  v_mfma_f32_16x16x32_bf16 a[104:107], v[56:59], a[168:171], a[104:107]
  v_mfma_f32_16x16x32_bf16 a[108:111], v[56:59], a[172:175], a[108:111]
  v_mfma_f32_16x16x32_bf16 a[112:115], v[60:63], a[160:163], a[112:115]
  ds_read_b64_tr_b16 v[56:57], v10 offset:128
  ds_read_b64_tr_b16 v[58:59], v10 offset:4736
  v_mfma_f32_16x16x32_bf16 a[116:119], v[60:63], a[164:167], a[116:119]
  v_mfma_f32_16x16x32_bf16 a[120:123], v[60:63], a[168:171], a[120:123]
  v_mfma_f32_16x16x32_bf16 a[124:127], v[60:63], a[172:175], a[124:127]
  s_waitcnt vmcnt(18)
  s_barrier
  s_waitcnt lgkmcnt(6)
  v_mfma_f32_16x16x32_bf16 v[112:115], v[64:67], a[176:179], v[112:115]
  ds_read_b64_tr_b16 v[60:61], v10 offset:160
  ds_read_b64_tr_b16 v[62:63], v10 offset:4768
  v_mfma_f32_16x16x32_bf16 v[116:119], v[64:67], a[180:183], v[116:119]
  buffer_load_dwordx4 a[160:163], v16, s[16:19], s38 offen offset:0 sc1
  v_mfma_f32_16x16x32_bf16 v[120:123], v[64:67], a[184:187], v[120:123]
  v_mfma_f32_16x16x32_bf16 v[124:127], v[64:67], a[188:191], v[124:127]
  v_mfma_f32_16x16x32_bf16 v[128:131], v[68:71], a[176:179], v[128:131]
  ds_read_b64_tr_b16 v[64:65], v10 offset:192
  ds_read_b64_tr_b16 v[66:67], v10 offset:4800
  v_mfma_f32_16x16x32_bf16 v[132:135], v[68:71], a[180:183], v[132:135]
  buffer_load_dwordx4 a[164:167], v16, s[16:19], s38 offen offset:1024 sc1
  v_mfma_f32_16x16x32_bf16 v[136:139], v[68:71], a[184:187], v[136:139]
  v_mfma_f32_16x16x32_bf16 v[140:143], v[68:71], a[188:191], v[140:143]
  s_waitcnt lgkmcnt(6)
  v_mfma_f32_16x16x32_bf16 v[144:147], v[48:51], a[176:179], v[144:147]
  ds_read_b64_tr_b16 v[68:69], v10 offset:224
  ds_read_b64_tr_b16 v[70:71], v10 offset:4832
  v_mfma_f32_16x16x32_bf16 v[148:151], v[48:51], a[180:183], v[148:151]
  buffer_load_dwordx4 a[168:171], v16, s[16:19], s38 offen offset:2048 sc1
  v_mfma_f32_16x16x32_bf16 v[152:155], v[48:51], a[184:187], v[152:155]
  v_mfma_f32_16x16x32_bf16 v[156:159], v[48:51], a[188:191], v[156:159]
  v_mfma_f32_16x16x32_bf16 v[160:163], v[52:55], a[176:179], v[160:163]
  ds_read_b64_tr_b16 v[48:49], v10 offset:256
  ds_read_b64_tr_b16 v[50:51], v10 offset:4864
  v_mfma_f32_16x16x32_bf16 v[164:167], v[52:55], a[180:183], v[164:167]
  buffer_load_dwordx4 a[172:175], v16, s[16:19], s38 offen offset:3072 sc1
  v_mfma_f32_16x16x32_bf16 v[168:171], v[52:55], a[184:187], v[168:171]
  v_mfma_f32_16x16x32_bf16 v[172:175], v[52:55], a[188:191], v[172:175]
  s_waitcnt lgkmcnt(6)
  v_mfma_f32_16x16x32_bf16 v[176:179], v[56:59], a[176:179], v[176:179]
  ds_read_b64_tr_b16 v[52:53], v5 offset:0
  ds_read_b64_tr_b16 v[54:55], v5 offset:4096
  v_mfma_f32_16x16x32_bf16 v[180:183], v[56:59], a[180:183], v[180:183]
  s_add_u32 s38, s38, 4096
  v_mfma_f32_16x16x32_bf16 v[184:187], v[56:59], a[184:187], v[184:187]
  v_mfma_f32_16x16x32_bf16 v[188:191], v[56:59], a[188:191], v[188:191]
  v_mfma_f32_16x16x32_bf16 v[192:195], v[60:63], a[176:179], v[192:195]
  ds_read_b64_tr_b16 v[56:57], v5 offset:8
  ds_read_b64_tr_b16 v[58:59], v5 offset:4104
  v_mfma_f32_16x16x32_bf16 v[196:199], v[60:63], a[180:183], v[196:199]
  s_add_u32 m0, s41, 100352
  v_mfma_f32_16x16x32_bf16 v[200:203], v[60:63], a[184:187], v[200:203]
  v_mfma_f32_16x16x32_bf16 v[204:207], v[60:63], a[188:191], v[204:207]
  s_waitcnt lgkmcnt(6)
  v_mfma_f32_16x16x32_bf16 v[208:211], v[64:67], a[176:179], v[208:211]
  ds_read_b64_tr_b16 v[60:61], v6 offset:0
  ds_read_b64_tr_b16 v[62:63], v6 offset:4096
  v_mfma_f32_16x16x32_bf16 v[212:215], v[64:67], a[180:183], v[212:215]
  buffer_load_dwordx4 v13, s[12:15], s37 offen lds
  v_mfma_f32_16x16x32_bf16 v[216:219], v[64:67], a[184:187], v[216:219]
  v_mfma_f32_16x16x32_bf16 v[220:223], v[64:67], a[188:191], v[220:223]
  v_mfma_f32_16x16x32_bf16 v[224:227], v[68:71], a[176:179], v[224:227]
  ds_read_b64_tr_b16 v[64:65], v6 offset:8
  ds_read_b64_tr_b16 v[66:67], v6 offset:4104
  v_mfma_f32_16x16x32_bf16 v[228:231], v[68:71], a[180:183], v[228:231]
  buffer_load_dwordx4 v14, s[12:15], s37 offen offset:1024 lds
  v_mfma_f32_16x16x32_bf16 v[232:235], v[68:71], a[184:187], v[232:235]
  v_mfma_f32_16x16x32_bf16 v[236:239], v[68:71], a[188:191], v[236:239]
  s_waitcnt lgkmcnt(6)
  v_mfma_f32_16x16x32_bf16 v[240:243], v[48:51], a[176:179], v[240:243]
  ds_read_b64_tr_b16 v[68:69], v7 offset:0
  ds_read_b64_tr_b16 v[70:71], v7 offset:4096
  v_mfma_f32_16x16x32_bf16 v[244:247], v[48:51], a[180:183], v[244:247]
  s_mov_b64 exec, 0xffff
  buffer_load_dwordx4 v15, s[12:15], s37 offen offset:2048 lds
  s_mov_b64 exec, -1
  v_mfma_f32_16x16x32_bf16 v[248:251], v[48:51], a[184:187], v[248:251]
  v_mfma_f32_16x16x32_bf16 v[252:255], v[48:51], a[188:191], v[252:255]
  v_mfma_f32_16x16x32_bf16 a[0:3], v[52:55], a[176:179], a[0:3]
  ds_read_b64_tr_b16 v[48:49], v7 offset:8
  ds_read_b64_tr_b16 v[50:51], v7 offset:4104
  v_mfma_f32_16x16x32_bf16 a[4:7], v[52:55], a[180:183], a[4:7]
  s_add_u32 s37, s37, 294912
  v_mfma_f32_16x16x32_bf16 a[8:11], v[52:55], a[184:187], a[8:11]
  v_mfma_f32_16x16x32_bf16 a[12:15], v[52:55], a[188:191], a[12:15]
  s_waitcnt lgkmcnt(6)
  v_mfma_f32_16x16x32_bf16 a[16:19], v[56:59], a[176:179], a[16:19]
  ds_read_b64_tr_b16 v[52:53], v8 offset:0
  ds_read_b64_tr_b16 v[54:55], v8 offset:4096
  v_mfma_f32_16x16x32_bf16 a[20:23], v[56:59], a[180:183], a[20:23]
  s_add_u32 m0, s40, 100352
  v_mfma_f32_16x16x32_bf16 a[24:27], v[56:59], a[184:187], a[24:27]
  v_mfma_f32_16x16x32_bf16 a[28:31], v[56:59], a[188:191], a[28:31]
  v_mfma_f32_16x16x32_bf16 a[32:35], v[60:63], a[176:179], a[32:35]
  ds_read_b64_tr_b16 v[56:57], v8 offset:8
  ds_read_b64_tr_b16 v[58:59], v8 offset:4104
  v_mfma_f32_16x16x32_bf16 a[36:39], v[60:63], a[180:183], a[36:39]
  buffer_load_dwordx4 v11, s[8:11], s36 offen lds
  v_mfma_f32_16x16x32_bf16 a[40:43], v[60:63], a[184:187], a[40:43]
  v_mfma_f32_16x16x32_bf16 a[44:47], v[60:63], a[188:191], a[44:47]
  s_waitcnt lgkmcnt(6)
  v_mfma_f32_16x16x32_bf16 a[48:51], v[64:67], a[176:179], a[48:51]
  ds_read_b64_tr_b16 v[60:61], v10 offset:17408
  ds_read_b64_tr_b16 v[62:63], v10 offset:22016
  v_mfma_f32_16x16x32_bf16 a[52:55], v[64:67], a[180:183], a[52:55]
  buffer_load_dwordx4 v12, s[8:11], s36 offen offset:1024 lds
  v_mfma_f32_16x16x32_bf16 a[56:59], v[64:67], a[184:187], a[56:59]
  v_mfma_f32_16x16x32_bf16 a[60:63], v[64:67], a[188:191], a[60:63]
  v_mfma_f32_16x16x32_bf16 a[64:67], v[68:71], a[176:179], a[64:67]
  ds_read_b64_tr_b16 v[64:65], v10 offset:17440
  ds_read_b64_tr_b16 v[66:67], v10 offset:22048
  v_mfma_f32_16x16x32_bf16 a[68:71], v[68:71], a[180:183], a[68:71]
  s_add_u32 s36, s36, 262144
  v_mfma_f32_16x16x32_bf16 a[72:75], v[68:71], a[184:187], a[72:75]
  v_mfma_f32_16x16x32_bf16 a[76:79], v[68:71], a[188:191], a[76:79]
  s_waitcnt lgkmcnt(6)
  v_mfma_f32_16x16x32_bf16 a[80:83], v[48:51], a[176:179], a[80:83]
  ds_read_b64_tr_b16 v[68:69], v10 offset:17472
  ds_read_b64_tr_b16 v[70:71], v10 offset:22080
  v_mfma_f32_16x16x32_bf16 a[84:87], v[48:51], a[180:183], a[84:87]
  v_mfma_f32_16x16x32_bf16 a[88:91], v[48:51], a[184:187], a[88:91]
  v_mfma_f32_16x16x32_bf16 a[92:95], v[48:51], a[188:191], a[92:95]
  v_mfma_f32_16x16x32_bf16 a[96:99], v[52:55], a[176:179], a[96:99]
  ds_read_b64_tr_b16 v[48:49], v10 offset:17504
  ds_read_b64_tr_b16 v[50:51], v10 offset:22112
  v_mfma_f32_16x16x32_bf16 a[100:103], v[52:55], a[180:183], a[100:103]
  v_mfma_f32_16x16x32_bf16 a[104:107], v[52:55], a[184:187], a[104:107]
  v_mfma_f32_16x16x32_bf16 a[108:111], v[52:55], a[188:191], a[108:111]
  s_waitcnt lgkmcnt(6)
  v_mfma_f32_16x16x32_bf16 a[112:115], v[56:59], a[176:179], a[112:115]
  ds_read_b64_tr_b16 v[52:53], v10 offset:17536
  ds_read_b64_tr_b16 v[54:55], v10 offset:22144
  v_mfma_f32_16x16x32_bf16 a[116:119], v[56:59], a[180:183], a[116:119]
  v_mfma_f32_16x16x32_bf16 a[120:123], v[56:59], a[184:187], a[120:123]
  v_mfma_f32_16x16x32_bf16 a[124:127], v[56:59], a[188:191], a[124:127]
  s_waitcnt vmcnt(18)
  s_barrier
  v_mfma_f32_16x16x32_bf16 v[112:115], v[60:63], a[192:195], v[112:115]
  ds_read_b64_tr_b16 v[56:57], v10 offset:17568
  ds_read_b64_tr_b16 v[58:59], v10 offset:22176
  v_mfma_f32_16x16x32_bf16 v[116:119], v[60:63], a[196:199], v[116:119]
  buffer_load_dwordx4 a[176:179], v16, s[16:19], s38 offen offset:0 sc1
  v_mfma_f32_16x16x32_bf16 v[120:123], v[60:63], a[200:203], v[120:123]
  v_mfma_f32_16x16x32_bf16 v[124:127], v[60:63], a[204:207], v[124:127]
  s_waitcnt lgkmcnt(6)
  v_mfma_f32_16x16x32_bf16 v[128:131], v[64:67], a[192:195], v[128:131]
  ds_read_b64_tr_b16 v[60:61], v10 offset:17600
  ds_read_b64_tr_b16 v[62:63], v10 offset:22208
  v_mfma_f32_16x16x32_bf16 v[132:135], v[64:67], a[196:199], v[132:135]
  buffer_load_dwordx4 a[180:183], v16, s[16:19], s38 offen offset:1024 sc1
  v_mfma_f32_16x16x32_bf16 v[136:139], v[64:67], a[200:203], v[136:139]
  v_mfma_f32_16x16x32_bf16 v[140:143], v[64:67], a[204:207], v[140:143]
  v_mfma_f32_16x16x32_bf16 v[144:147], v[68:71], a[192:195], v[144:147]
  ds_read_b64_tr_b16 v[64:65], v10 offset:17632
  ds_read_b64_tr_b16 v[66:67], v10 offset:22240
  v_mfma_f32_16x16x32_bf16 v[148:151], v[68:71], a[196:199], v[148:151]
  buffer_load_dwordx4 a[184:187], v16, s[16:19], s38 offen offset:2048 sc1
  v_mfma_f32_16x16x32_bf16 v[152:155], v[68:71], a[200:203], v[152:155]
  v_mfma_f32_16x16x32_bf16 v[156:159], v[68:71], a[204:207], v[156:159]
  s_waitcnt lgkmcnt(6)
  v_mfma_f32_16x16x32_bf16 v[160:163], v[48:51], a[192:195], v[160:163]
  ds_read_b64_tr_b16 v[68:69], v10 offset:17664
  ds_read_b64_tr_b16 v[70:71], v10 offset:22272
  v_mfma_f32_16x16x32_bf16 v[164:167], v[48:51], a[196:199], v[164:167]
  buffer_load_dwordx4 a[188:191], v16, s[16:19], s38 offen offset:3072 sc1
  v_mfma_f32_16x16x32_bf16 v[168:171], v[48:51], a[200:203], v[168:171]
  v_mfma_f32_16x16x32_bf16 v[172:175], v[48:51], a[204:207], v[172:175]
  v_mfma_f32_16x16x32_bf16 v[176:179], v[52:55], a[192:195], v[176:179]
  ds_read_b64_tr_b16 v[48:49], v5 offset:17408
  ds_read_b64_tr_b16 v[50:51], v5 offset:21504
  v_mfma_f32_16x16x32_bf16 v[180:183], v[52:55], a[196:199], v[180:183]
  s_add_u32 s38, s38, 4096
  v_mfma_f32_16x16x32_bf16 v[184:187], v[52:55], a[200:203], v[184:187]
  v_mfma_f32_16x16x32_bf16 v[188:191], v[52:55], a[204:207], v[188:191]
  s_waitcnt lgkmcnt(6)
  v_mfma_f32_16x16x32_bf16 v[192:195], v[56:59], a[192:195], v[192:195]
  ds_read_b64_tr_b16 v[52:53], v5 offset:17416
  ds_read_b64_tr_b16 v[54:55], v5 offset:21512
  v_mfma_f32_16x16x32_bf16 v[196:199], v[56:59], a[196:199], v[196:199]
  s_add_u32 m0, s41, 117760
  v_mfma_f32_16x16x32_bf16 v[200:203], v[56:59], a[200:203], v[200:203]
  v_mfma_f32_16x16x32_bf16 v[204:207], v[56:59], a[204:207], v[204:207]
  v_mfma_f32_16x16x32_bf16 v[208:211], v[60:63], a[192:195], v[208:211]
  ds_read_b64_tr_b16 v[56:57], v6 offset:17408
  ds_read_b64_tr_b16 v[58:59], v6 offset:21504
  v_mfma_f32_16x16x32_bf16 v[212:215], v[60:63], a[196:199], v[212:215]
  buffer_load_dwordx4 v13, s[12:15], s37 offen lds
  v_mfma_f32_16x16x32_bf16 v[216:219], v[60:63], a[200:203], v[216:219]
  v_mfma_f32_16x16x32_bf16 v[220:223], v[60:63], a[204:207], v[220:223]
  s_waitcnt lgkmcnt(6)
  v_mfma_f32_16x16x32_bf16 v[224:227], v[64:67], a[192:195], v[224:227]
  ds_read_b64_tr_b16 v[60:61], v6 offset:17416
  ds_read_b64_tr_b16 v[62:63], v6 offset:21512
  v_mfma_f32_16x16x32_bf16 v[228:231], v[64:67], a[196:199], v[228:231]
  buffer_load_dwordx4 v14, s[12:15], s37 offen offset:1024 lds
  v_mfma_f32_16x16x32_bf16 v[232:235], v[64:67], a[200:203], v[232:235]
  v_mfma_f32_16x16x32_bf16 v[236:239], v[64:67], a[204:207], v[236:239]
  v_mfma_f32_16x16x32_bf16 v[240:243], v[68:71], a[192:195], v[240:243]
  ds_read_b64_tr_b16 v[64:65], v7 offset:17408
  ds_read_b64_tr_b16 v[66:67], v7 offset:21504
  v_mfma_f32_16x16x32_bf16 v[244:247], v[68:71], a[196:199], v[244:247]
  s_mov_b64 exec, 0xffff
  buffer_load_dwordx4 v15, s[12:15], s37 offen offset:2048 lds
  s_mov_b64 exec, -1
  v_mfma_f32_16x16x32_bf16 v[248:251], v[68:71], a[200:203], v[248:251]
  v_mfma_f32_16x16x32_bf16 v[252:255], v[68:71], a[204:207], v[252:255]
  s_waitcnt lgkmcnt(6)
  v_mfma_f32_16x16x32_bf16 a[0:3], v[48:51], a[192:195], a[0:3]
  ds_read_b64_tr_b16 v[68:69], v7 offset:17416
  ds_read_b64_tr_b16 v[70:71], v7 offset:21512
  v_mfma_f32_16x16x32_bf16 a[4:7], v[48:51], a[196:199], a[4:7]
  s_add_u32 s37, s37, 294912
  v_mfma_f32_16x16x32_bf16 a[8:11], v[48:51], a[200:203], a[8:11]
  v_mfma_f32_16x16x32_bf16 a[12:15], v[48:51], a[204:207], a[12:15]
  v_mfma_f32_16x16x32_bf16 a[16:19], v[52:55], a[192:195], a[16:19]
  ds_read_b64_tr_b16 v[48:49], v8 offset:17408
  ds_read_b64_tr_b16 v[50:51], v8 offset:21504
  v_mfma_f32_16x16x32_bf16 a[20:23], v[52:55], a[196:199], a[20:23]
  s_add_u32 m0, s40, 117760
  v_mfma_f32_16x16x32_bf16 a[24:27], v[52:55], a[200:203], a[24:27]
  v_mfma_f32_16x16x32_bf16 a[28:31], v[52:55], a[204:207], a[28:31]
  s_waitcnt lgkmcnt(6)
  v_mfma_f32_16x16x32_bf16 a[32:35], v[56:59], a[192:195], a[32:35]
  ds_read_b64_tr_b16 v[52:53], v8 offset:17416
  ds_read_b64_tr_b16 v[54:55], v8 offset:21512
  v_mfma_f32_16x16x32_bf16 a[36:39], v[56:59], a[196:199], a[36:39]
  buffer_load_dwordx4 v11, s[8:11], s36 offen lds
  v_mfma_f32_16x16x32_bf16 a[40:43], v[56:59], a[200:203], a[40:43]
  v_mfma_f32_16x16x32_bf16 a[44:47], v[56:59], a[204:207], a[44:47]
  v_mfma_f32_16x16x32_bf16 a[48:51], v[60:63], a[192:195], a[48:51]
  ds_read_b64_tr_b16 v[56:57], v9 offset:0
  ds_read_b64_tr_b16 v[58:59], v9 offset:4608
  v_mfma_f32_16x16x32_bf16 a[52:55], v[60:63], a[196:199], a[52:55]
  buffer_load_dwordx4 v12, s[8:11], s36 offen offset:1024 lds
  v_mfma_f32_16x16x32_bf16 a[56:59], v[60:63], a[200:203], a[56:59]
  v_mfma_f32_16x16x32_bf16 a[60:63], v[60:63], a[204:207], a[60:63]
  s_waitcnt lgkmcnt(6)
  v_mfma_f32_16x16x32_bf16 a[64:67], v[64:67], a[192:195], a[64:67]
  ds_read_b64_tr_b16 v[60:61], v9 offset:32
  ds_read_b64_tr_b16 v[62:63], v9 offset:4640
  v_mfma_f32_16x16x32_bf16 a[68:71], v[64:67], a[196:199], a[68:71]
  s_add_u32 s36, s36, 262144
  v_mfma_f32_16x16x32_bf16 a[72:75], v[64:67], a[200:203], a[72:75]
  v_mfma_f32_16x16x32_bf16 a[76:79], v[64:67], a[204:207], a[76:79]
  v_mfma_f32_16x16x32_bf16 a[80:83], v[68:71], a[192:195], a[80:83]
  ds_read_b64_tr_b16 v[64:65], v9 offset:64
  ds_read_b64_tr_b16 v[66:67], v9 offset:4672
  v_mfma_f32_16x16x32_bf16 a[84:87], v[68:71], a[196:199], a[84:87]
  v_mfma_f32_16x16x32_bf16 a[88:91], v[68:71], a[200:203], a[88:91]
  v_mfma_f32_16x16x32_bf16 a[92:95], v[68:71], a[204:207], a[92:95]
  s_waitcnt lgkmcnt(6)
  v_mfma_f32_16x16x32_bf16 a[96:99], v[48:51], a[192:195], a[96:99]
  ds_read_b64_tr_b16 v[68:69], v9 offset:96
  ds_read_b64_tr_b16 v[70:71], v9 offset:4704
  v_mfma_f32_16x16x32_bf16 a[100:103], v[48:51], a[196:199], a[100:103]
  v_mfma_f32_16x16x32_bf16 a[104:107], v[48:51], a[200:203], a[104:107]
  v_mfma_f32_16x16x32_bf16 a[108:111], v[48:51], a[204:207], a[108:111]
  v_mfma_f32_16x16x32_bf16 a[112:115], v[52:55], a[192:195], a[112:115]
  ds_read_b64_tr_b16 v[48:49], v9 offset:128
  ds_read_b64_tr_b16 v[50:51], v9 offset:4736
  v_mfma_f32_16x16x32_bf16 a[116:119], v[52:55], a[196:199], a[116:119]
  v_mfma_f32_16x16x32_bf16 a[120:123], v[52:55], a[200:203], a[120:123]
  v_mfma_f32_16x16x32_bf16 a[124:127], v[52:55], a[204:207], a[124:127]
  s_waitcnt vmcnt(18)
  s_barrier
  s_waitcnt lgkmcnt(6)
  v_mfma_f32_16x16x32_bf16 v[112:115], v[56:59], a[128:131], v[112:115]
  ds_read_b64_tr_b16 v[52:53], v9 offset:160
  ds_read_b64_tr_b16 v[54:55], v9 offset:4768
  v_mfma_f32_16x16x32_bf16 v[116:119], v[56:59], a[132:135], v[116:119]
  buffer_load_dwordx4 a[192:195], v16, s[16:19], s38 offen offset:0 sc1
  v_mfma_f32_16x16x32_bf16 v[120:123], v[56:59], a[136:139], v[120:123]
  v_mfma_f32_16x16x32_bf16 v[124:127], v[56:59], a[140:143], v[124:127]
  v_mfma_f32_16x16x32_bf16 v[128:131], v[60:63], a[128:131], v[128:131]
  ds_read_b64_tr_b16 v[56:57], v9 offset:192
  ds_read_b64_tr_b16 v[58:59], v9 offset:4800
  v_mfma_f32_16x16x32_bf16 v[132:135], v[60:63], a[132:135], v[132:135]
  buffer_load_dwordx4 a[196:199], v16, s[16:19], s38 offen offset:1024 sc1
  v_mfma_f32_16x16x32_bf16 v[136:139], v[60:63], a[136:139], v[136:139]
  v_mfma_f32_16x16x32_bf16 v[140:143], v[60:63], a[140:143], v[140:143]
  s_waitcnt lgkmcnt(6)
  v_mfma_f32_16x16x32_bf16 v[144:147], v[64:67], a[128:131], v[144:147]
  ds_read_b64_tr_b16 v[60:61], v9 offset:224
  ds_read_b64_tr_b16 v[62:63], v9 offset:4832
  v_mfma_f32_16x16x32_bf16 v[148:151], v[64:67], a[132:135], v[148:151]
  buffer_load_dwordx4 a[200:203], v16, s[16:19], s38 offen offset:2048 sc1
  v_mfma_f32_16x16x32_bf16 v[152:155], v[64:67], a[136:139], v[152:155]
  v_mfma_f32_16x16x32_bf16 v[156:159], v[64:67], a[140:143], v[156:159]
  v_mfma_f32_16x16x32_bf16 v[160:163], v[68:71], a[128:131], v[160:163]
  ds_read_b64_tr_b16 v[64:65], v9 offset:256
  ds_read_b64_tr_b16 v[66:67], v9 offset:4864
  v_mfma_f32_16x16x32_bf16 v[164:167], v[68:71], a[132:135], v[164:167]
  buffer_load_dwordx4 a[204:207], v16, s[16:19], s38 offen offset:3072 sc1
  v_mfma_f32_16x16x32_bf16 v[168:171], v[68:71], a[136:139], v[168:171]
  v_mfma_f32_16x16x32_bf16 v[172:175], v[68:71], a[140:143], v[172:175]
  s_waitcnt lgkmcnt(6)
  v_mfma_f32_16x16x32_bf16 v[176:179], v[48:51], a[128:131], v[176:179]
  ds_read_b64_tr_b16 v[68:69], v1 offset:0
  ds_read_b64_tr_b16 v[70:71], v1 offset:4096
  v_mfma_f32_16x16x32_bf16 v[180:183], v[48:51], a[132:135], v[180:183]
  s_add_u32 s38, s38, 4096
  v_mfma_f32_16x16x32_bf16 v[184:187], v[48:51], a[136:139], v[184:187]
  v_mfma_f32_16x16x32_bf16 v[188:191], v[48:51], a[140:143], v[188:191]
  v_mfma_f32_16x16x32_bf16 v[192:195], v[52:55], a[128:131], v[192:195]
  ds_read_b64_tr_b16 v[48:49], v1 offset:8
  ds_read_b64_tr_b16 v[50:51], v1 offset:4104
  v_mfma_f32_16x16x32_bf16 v[196:199], v[52:55], a[132:135], v[196:199]
  s_add_u32 m0, s41, 135168
  v_mfma_f32_16x16x32_bf16 v[200:203], v[52:55], a[136:139], v[200:203]
  v_mfma_f32_16x16x32_bf16 v[204:207], v[52:55], a[140:143], v[204:207]
  s_waitcnt lgkmcnt(6)
  v_mfma_f32_16x16x32_bf16 v[208:211], v[56:59], a[128:131], v[208:211]
  ds_read_b64_tr_b16 v[52:53], v2 offset:0
  ds_read_b64_tr_b16 v[54:55], v2 offset:4096
  v_mfma_f32_16x16x32_bf16 v[212:215], v[56:59], a[132:135], v[212:215]
  buffer_load_dwordx4 v13, s[12:15], s37 offen lds
  v_mfma_f32_16x16x32_bf16 v[216:219], v[56:59], a[136:139], v[216:219]
  v_mfma_f32_16x16x32_bf16 v[220:223], v[56:59], a[140:143], v[220:223]
  v_mfma_f32_16x16x32_bf16 v[224:227], v[60:63], a[128:131], v[224:227]
  ds_read_b64_tr_b16 v[56:57], v2 offset:8
  ds_read_b64_tr_b16 v[58:59], v2 offset:4104
  v_mfma_f32_16x16x32_bf16 v[228:231], v[60:63], a[132:135], v[228:231]
  buffer_load_dwordx4 v14, s[12:15], s37 offen offset:1024 lds
  v_mfma_f32_16x16x32_bf16 v[232:235], v[60:63], a[136:139], v[232:235]
  v_mfma_f32_16x16x32_bf16 v[236:239], v[60:63], a[140:143], v[236:239]
  s_waitcnt lgkmcnt(6)
  v_mfma_f32_16x16x32_bf16 v[240:243], v[64:67], a[128:131], v[240:243]
  ds_read_b64_tr_b16 v[60:61], v3 offset:0
  ds_read_b64_tr_b16 v[62:63], v3 offset:4096
  v_mfma_f32_16x16x32_bf16 v[244:247], v[64:67], a[132:135], v[244:247]
  s_mov_b64 exec, 0xffff
  buffer_load_dwordx4 v15, s[12:15], s37 offen offset:2048 lds
  s_mov_b64 exec, -1
  v_mfma_f32_16x16x32_bf16 v[248:251], v[64:67], a[136:139], v[248:251]
  v_mfma_f32_16x16x32_bf16 v[252:255], v[64:67], a[140:143], v[252:255]
  v_mfma_f32_16x16x32_bf16 a[0:3], v[68:71], a[128:131], a[0:3]
  ds_read_b64_tr_b16 v[64:65], v3 offset:8
  ds_read_b64_tr_b16 v[66:67], v3 offset:4104
  v_mfma_f32_16x16x32_bf16 a[4:7], v[68:71], a[132:135], a[4:7]
  s_add_u32 s37, s37, 294912
  v_mfma_f32_16x16x32_bf16 a[8:11], v[68:71], a[136:139], a[8:11]
  v_mfma_f32_16x16x32_bf16 a[12:15], v[68:71], a[140:143], a[12:15]
  s_waitcnt lgkmcnt(6)
  v_mfma_f32_16x16x32_bf16 a[16:19], v[48:51], a[128:131], a[16:19]
  ds_read_b64_tr_b16 v[68:69], v4 offset:0
  ds_read_b64_tr_b16 v[70:71], v4 offset:4096
  v_mfma_f32_16x16x32_bf16 a[20:23], v[48:51], a[132:135], a[20:23]
  s_add_u32 m0, s40, 135168
  v_mfma_f32_16x16x32_bf16 a[24:27], v[48:51], a[136:139], a[24:27]
  v_mfma_f32_16x16x32_bf16 a[28:31], v[48:51], a[140:143], a[28:31]
  v_mfma_f32_16x16x32_bf16 a[32:35], v[52:55], a[128:131], a[32:35]
  ds_read_b64_tr_b16 v[48:49], v4 offset:8
  ds_read_b64_tr_b16 v[50:51], v4 offset:4104
  v_mfma_f32_16x16x32_bf16 a[36:39], v[52:55], a[132:135], a[36:39]
  buffer_load_dwordx4 v11, s[8:11], s36 offen lds
  v_mfma_f32_16x16x32_bf16 a[40:43], v[52:55], a[136:139], a[40:43]
  v_mfma_f32_16x16x32_bf16 a[44:47], v[52:55], a[140:143], a[44:47]
  s_waitcnt lgkmcnt(6)
  v_mfma_f32_16x16x32_bf16 a[48:51], v[56:59], a[128:131], a[48:51]
  ds_read_b64_tr_b16 v[52:53], v9 offset:17408
  ds_read_b64_tr_b16 v[54:55], v9 offset:22016
  v_mfma_f32_16x16x32_bf16 a[52:55], v[56:59], a[132:135], a[52:55]
  buffer_load_dwordx4 v12, s[8:11], s36 offen offset:1024 lds
  v_mfma_f32_16x16x32_bf16 a[56:59], v[56:59], a[136:139], a[56:59]
  v_mfma_f32_16x16x32_bf16 a[60:63], v[56:59], a[140:143], a[60:63]
  v_mfma_f32_16x16x32_bf16 a[64:67], v[60:63], a[128:131], a[64:67]
  ds_read_b64_tr_b16 v[56:57], v9 offset:17440
  ds_read_b64_tr_b16 v[58:59], v9 offset:22048
  v_mfma_f32_16x16x32_bf16 a[68:71], v[60:63], a[132:135], a[68:71]
  s_add_u32 s36, s36, 262144
  v_mfma_f32_16x16x32_bf16 a[72:75], v[60:63], a[136:139], a[72:75]
  v_mfma_f32_16x16x32_bf16 a[76:79], v[60:63], a[140:143], a[76:79]
  s_waitcnt lgkmcnt(6)
  v_mfma_f32_16x16x32_bf16 a[80:83], v[64:67], a[128:131], a[80:83]
  ds_read_b64_tr_b16 v[60:61], v9 offset:17472
  ds_read_b64_tr_b16 v[62:63], v9 offset:22080
  v_mfma_f32_16x16x32_bf16 a[84:87], v[64:67], a[132:135], a[84:87]
  v_mfma_f32_16x16x32_bf16 a[88:91], v[64:67], a[136:139], a[88:91]
  v_mfma_f32_16x16x32_bf16 a[92:95], v[64:67], a[140:143], a[92:95]
  v_mfma_f32_16x16x32_bf16 a[96:99], v[68:71], a[128:131], a[96:99]
  ds_read_b64_tr_b16 v[64:65], v9 offset:17504
  ds_read_b64_tr_b16 v[66:67], v9 offset:22112
  v_mfma_f32_16x16x32_bf16 a[100:103], v[68:71], a[132:135], a[100:103]
  v_mfma_f32_16x16x32_bf16 a[104:107], v[68:71], a[136:139], a[104:107]
  v_mfma_f32_16x16x32_bf16 a[108:111], v[68:71], a[140:143], a[108:111]
  s_waitcnt lgkmcnt(6)
  v_mfma_f32_16x16x32_bf16 a[112:115], v[48:51], a[128:131], a[112:115]
  ds_read_b64_tr_b16 v[68:69], v9 offset:17536
  ds_read_b64_tr_b16 v[70:71], v9 offset:22144
  v_mfma_f32_16x16x32_bf16 a[116:119], v[48:51], a[132:135], a[116:119]
  v_mfma_f32_16x16x32_bf16 a[120:123], v[48:51], a[136:139], a[120:123]
  v_mfma_f32_16x16x32_bf16 a[124:127], v[48:51], a[140:143], a[124:127]
  s_waitcnt vmcnt(18)
  s_barrier
  v_mfma_f32_16x16x32_bf16 v[112:115], v[52:55], a[144:147], v[112:115]
  ds_read_b64_tr_b16 v[48:49], v9 offset:17568
  ds_read_b64_tr_b16 v[50:51], v9 offset:22176
  v_mfma_f32_16x16x32_bf16 v[116:119], v[52:55], a[148:151], v[116:119]
  buffer_load_dwordx4 a[128:131], v16, s[16:19], s38 offen offset:0 sc1
  v_mfma_f32_16x16x32_bf16 v[120:123], v[52:55], a[152:155], v[120:123]
  v_mfma_f32_16x16x32_bf16 v[124:127], v[52:55], a[156:159], v[124:127]
  s_waitcnt lgkmcnt(6)
  v_mfma_f32_16x16x32_bf16 v[128:131], v[56:59], a[144:147], v[128:131]
  ds_read_b64_tr_b16 v[52:53], v9 offset:17600
  ds_read_b64_tr_b16 v[54:55], v9 offset:22208
  v_mfma_f32_16x16x32_bf16 v[132:135], v[56:59], a[148:151], v[132:135]
  buffer_load_dwordx4 a[132:135], v16, s[16:19], s38 offen offset:1024 sc1
  v_mfma_f32_16x16x32_bf16 v[136:139], v[56:59], a[152:155], v[136:139]
  v_mfma_f32_16x16x32_bf16 v[140:143], v[56:59], a[156:159], v[140:143]
  v_mfma_f32_16x16x32_bf16 v[144:147], v[60:63], a[144:147], v[144:147]
  ds_read_b64_tr_b16 v[56:57], v9 offset:17632
  ds_read_b64_tr_b16 v[58:59], v9 offset:22240
  v_mfma_f32_16x16x32_bf16 v[148:151], v[60:63], a[148:151], v[148:151]
  buffer_load_dwordx4 a[136:139], v16, s[16:19], s38 offen offset:2048 sc1
  v_mfma_f32_16x16x32_bf16 v[152:155], v[60:63], a[152:155], v[152:155]
  v_mfma_f32_16x16x32_bf16 v[156:159], v[60:63], a[156:159], v[156:159]
  s_waitcnt lgkmcnt(6)
  v_mfma_f32_16x16x32_bf16 v[160:163], v[64:67], a[144:147], v[160:163]
  ds_read_b64_tr_b16 v[60:61], v9 offset:17664
  ds_read_b64_tr_b16 v[62:63], v9 offset:22272
  v_mfma_f32_16x16x32_bf16 v[164:167], v[64:67], a[148:151], v[164:167]
  buffer_load_dwordx4 a[140:143], v16, s[16:19], s38 offen offset:3072 sc1
  v_mfma_f32_16x16x32_bf16 v[168:171], v[64:67], a[152:155], v[168:171]
  v_mfma_f32_16x16x32_bf16 v[172:175], v[64:67], a[156:159], v[172:175]
  v_mfma_f32_16x16x32_bf16 v[176:179], v[68:71], a[144:147], v[176:179]
  ds_read_b64_tr_b16 v[64:65], v1 offset:17408
  ds_read_b64_tr_b16 v[66:67], v1 offset:21504
  v_mfma_f32_16x16x32_bf16 v[180:183], v[68:71], a[148:151], v[180:183]
  s_add_u32 s38, s38, 4096
  v_mfma_f32_16x16x32_bf16 v[184:187], v[68:71], a[152:155], v[184:187]
  v_mfma_f32_16x16x32_bf16 v[188:191], v[68:71], a[156:159], v[188:191]
  s_waitcnt lgkmcnt(6)
  v_mfma_f32_16x16x32_bf16 v[192:195], v[48:51], a[144:147], v[192:195]
  ds_read_b64_tr_b16 v[68:69], v1 offset:17416
  ds_read_b64_tr_b16 v[70:71], v1 offset:21512
  v_mfma_f32_16x16x32_bf16 v[196:199], v[48:51], a[148:151], v[196:199]
  s_add_u32 m0, s41, 65536
  v_mfma_f32_16x16x32_bf16 v[200:203], v[48:51], a[152:155], v[200:203]
  v_mfma_f32_16x16x32_bf16 v[204:207], v[48:51], a[156:159], v[204:207]
  v_mfma_f32_16x16x32_bf16 v[208:211], v[52:55], a[144:147], v[208:211]
  ds_read_b64_tr_b16 v[48:49], v2 offset:17408
  ds_read_b64_tr_b16 v[50:51], v2 offset:21504
  v_mfma_f32_16x16x32_bf16 v[212:215], v[52:55], a[148:151], v[212:215]
  buffer_load_dwordx4 v13, s[12:15], s37 offen lds
  v_mfma_f32_16x16x32_bf16 v[216:219], v[52:55], a[152:155], v[216:219]
  v_mfma_f32_16x16x32_bf16 v[220:223], v[52:55], a[156:159], v[220:223]
  s_waitcnt lgkmcnt(6)
  v_mfma_f32_16x16x32_bf16 v[224:227], v[56:59], a[144:147], v[224:227]
  ds_read_b64_tr_b16 v[52:53], v2 offset:17416
  ds_read_b64_tr_b16 v[54:55], v2 offset:21512
  v_mfma_f32_16x16x32_bf16 v[228:231], v[56:59], a[148:151], v[228:231]
  buffer_load_dwordx4 v14, s[12:15], s37 offen offset:1024 lds
  v_mfma_f32_16x16x32_bf16 v[232:235], v[56:59], a[152:155], v[232:235]
  v_mfma_f32_16x16x32_bf16 v[236:239], v[56:59], a[156:159], v[236:239]
  v_mfma_f32_16x16x32_bf16 v[240:243], v[60:63], a[144:147], v[240:243]
  ds_read_b64_tr_b16 v[56:57], v3 offset:17408
  ds_read_b64_tr_b16 v[58:59], v3 offset:21504
  v_mfma_f32_16x16x32_bf16 v[244:247], v[60:63], a[148:151], v[244:247]
  s_mov_b64 exec, 0xffff
  buffer_load_dwordx4 v15, s[12:15], s37 offen offset:2048 lds
  s_mov_b64 exec, -1
  v_mfma_f32_16x16x32_bf16 v[248:251], v[60:63], a[152:155], v[248:251]
  v_mfma_f32_16x16x32_bf16 v[252:255], v[60:63], a[156:159], v[252:255]
  s_waitcnt lgkmcnt(6)
  v_mfma_f32_16x16x32_bf16 a[0:3], v[64:67], a[144:147], a[0:3]
  ds_read_b64_tr_b16 v[60:61], v3 offset:17416
  ds_read_b64_tr_b16 v[62:63], v3 offset:21512
  v_mfma_f32_16x16x32_bf16 a[4:7], v[64:67], a[148:151], a[4:7]
  s_add_u32 s37, s37, 294912
  v_mfma_f32_16x16x32_bf16 a[8:11], v[64:67], a[152:155], a[8:11]
  v_mfma_f32_16x16x32_bf16 a[12:15], v[64:67], a[156:159], a[12:15]
  v_mfma_f32_16x16x32_bf16 a[16:19], v[68:71], a[144:147], a[16:19]
  ds_read_b64_tr_b16 v[64:65], v4 offset:17408
  ds_read_b64_tr_b16 v[66:67], v4 offset:21504
  v_mfma_f32_16x16x32_bf16 a[20:23], v[68:71], a[148:151], a[20:23]
  s_add_u32 m0, s40, 65536
  v_mfma_f32_16x16x32_bf16 a[24:27], v[68:71], a[152:155], a[24:27]
  v_mfma_f32_16x16x32_bf16 a[28:31], v[68:71], a[156:159], a[28:31]
  s_waitcnt lgkmcnt(6)
  v_mfma_f32_16x16x32_bf16 a[32:35], v[48:51], a[144:147], a[32:35]
  ds_read_b64_tr_b16 v[68:69], v4 offset:17416
  ds_read_b64_tr_b16 v[70:71], v4 offset:21512
  v_mfma_f32_16x16x32_bf16 a[36:39], v[48:51], a[148:151], a[36:39]
  buffer_load_dwordx4 v11, s[8:11], s36 offen lds
  v_mfma_f32_16x16x32_bf16 a[40:43], v[48:51], a[152:155], a[40:43]
  v_mfma_f32_16x16x32_bf16 a[44:47], v[48:51], a[156:159], a[44:47]
  v_mfma_f32_16x16x32_bf16 a[48:51], v[52:55], a[144:147], a[48:51]
  ds_read_b64_tr_b16 v[48:49], v9 offset:34816
  ds_read_b64_tr_b16 v[50:51], v9 offset:39424
  v_mfma_f32_16x16x32_bf16 a[52:55], v[52:55], a[148:151], a[52:55]
  buffer_load_dwordx4 v12, s[8:11], s36 offen offset:1024 lds
  v_mfma_f32_16x16x32_bf16 a[56:59], v[52:55], a[152:155], a[56:59]
  v_mfma_f32_16x16x32_bf16 a[60:63], v[52:55], a[156:159], a[60:63]
  s_waitcnt lgkmcnt(6)
  v_mfma_f32_16x16x32_bf16 a[64:67], v[56:59], a[144:147], a[64:67]
  ds_read_b64_tr_b16 v[52:53], v9 offset:34848
  ds_read_b64_tr_b16 v[54:55], v9 offset:39456
  v_mfma_f32_16x16x32_bf16 a[68:71], v[56:59], a[148:151], a[68:71]
  s_add_u32 s36, s36, 262144
  v_mfma_f32_16x16x32_bf16 a[72:75], v[56:59], a[152:155], a[72:75]
  v_mfma_f32_16x16x32_bf16 a[76:79], v[56:59], a[156:159], a[76:79]
  v_mfma_f32_16x16x32_bf16 a[80:83], v[60:63], a[144:147], a[80:83]
  ds_read_b64_tr_b16 v[56:57], v9 offset:34880
  ds_read_b64_tr_b16 v[58:59], v9 offset:39488
  v_mfma_f32_16x16x32_bf16 a[84:87], v[60:63], a[148:151], a[84:87]
  v_mfma_f32_16x16x32_bf16 a[88:91], v[60:63], a[152:155], a[88:91]
  v_mfma_f32_16x16x32_bf16 a[92:95], v[60:63], a[156:159], a[92:95]
  s_waitcnt lgkmcnt(6)
  v_mfma_f32_16x16x32_bf16 a[96:99], v[64:67], a[144:147], a[96:99]
  ds_read_b64_tr_b16 v[60:61], v9 offset:34912
  ds_read_b64_tr_b16 v[62:63], v9 offset:39520
  v_mfma_f32_16x16x32_bf16 a[100:103], v[64:67], a[148:151], a[100:103]
  v_mfma_f32_16x16x32_bf16 a[104:107], v[64:67], a[152:155], a[104:107]
  v_mfma_f32_16x16x32_bf16 a[108:111], v[64:67], a[156:159], a[108:111]
  v_mfma_f32_16x16x32_bf16 a[112:115], v[68:71], a[144:147], a[112:115]
  ds_read_b64_tr_b16 v[64:65], v9 offset:34944
  ds_read_b64_tr_b16 v[66:67], v9 offset:39552
  v_mfma_f32_16x16x32_bf16 a[116:119], v[68:71], a[148:151], a[116:119]
  v_mfma_f32_16x16x32_bf16 a[120:123], v[68:71], a[152:155], a[120:123]
  v_mfma_f32_16x16x32_bf16 a[124:127], v[68:71], a[156:159], a[124:127]
  s_waitcnt vmcnt(18)
  s_barrier
  s_waitcnt lgkmcnt(6)
  v_mfma_f32_16x16x32_bf16 v[112:115], v[48:51], a[160:163], v[112:115]
  ds_read_b64_tr_b16 v[68:69], v9 offset:34976
  ds_read_b64_tr_b16 v[70:71], v9 offset:39584
  v_mfma_f32_16x16x32_bf16 v[116:119], v[48:51], a[164:167], v[116:119]
  buffer_load_dwordx4 a[144:147], v16, s[16:19], s38 offen offset:0 sc1
  v_mfma_f32_16x16x32_bf16 v[120:123], v[48:51], a[168:171], v[120:123]
  v_mfma_f32_16x16x32_bf16 v[124:127], v[48:51], a[172:175], v[124:127]
  v_mfma_f32_16x16x32_bf16 v[128:131], v[52:55], a[160:163], v[128:131]
  ds_read_b64_tr_b16 v[48:49], v9 offset:35008
  ds_read_b64_tr_b16 v[50:51], v9 offset:39616
  v_mfma_f32_16x16x32_bf16 v[132:135], v[52:55], a[164:167], v[132:135]
  buffer_load_dwordx4 a[148:151], v16, s[16:19], s38 offen offset:1024 sc1
  v_mfma_f32_16x16x32_bf16 v[136:139], v[52:55], a[168:171], v[136:139]
  v_mfma_f32_16x16x32_bf16 v[140:143], v[52:55], a[172:175], v[140:143]
  s_waitcnt lgkmcnt(6)
  v_mfma_f32_16x16x32_bf16 v[144:147], v[56:59], a[160:163], v[144:147]
  ds_read_b64_tr_b16 v[52:53], v9 offset:35040
  ds_read_b64_tr_b16 v[54:55], v9 offset:39648
  v_mfma_f32_16x16x32_bf16 v[148:151], v[56:59], a[164:167], v[148:151]
  buffer_load_dwordx4 a[152:155], v16, s[16:19], s38 offen offset:2048 sc1
  v_mfma_f32_16x16x32_bf16 v[152:155], v[56:59], a[168:171], v[152:155]
  v_mfma_f32_16x16x32_bf16 v[156:159], v[56:59], a[172:175], v[156:159]
  v_mfma_f32_16x16x32_bf16 v[160:163], v[60:63], a[160:163], v[160:163]
  ds_read_b64_tr_b16 v[56:57], v9 offset:35072
  ds_read_b64_tr_b16 v[58:59], v9 offset:39680
  v_mfma_f32_16x16x32_bf16 v[164:167], v[60:63], a[164:167], v[164:167]
  buffer_load_dwordx4 a[156:159], v16, s[16:19], s38 offen offset:3072 sc1
  v_mfma_f32_16x16x32_bf16 v[168:171], v[60:63], a[168:171], v[168:171]
  v_mfma_f32_16x16x32_bf16 v[172:175], v[60:63], a[172:175], v[172:175]
  s_waitcnt lgkmcnt(6)
  v_mfma_f32_16x16x32_bf16 v[176:179], v[64:67], a[160:163], v[176:179]
  ds_read_b64_tr_b16 v[60:61], v1 offset:34816
  ds_read_b64_tr_b16 v[62:63], v1 offset:38912
  v_mfma_f32_16x16x32_bf16 v[180:183], v[64:67], a[164:167], v[180:183]
  s_add_u32 s38, s38, 4096
  v_mfma_f32_16x16x32_bf16 v[184:187], v[64:67], a[168:171], v[184:187]
  v_mfma_f32_16x16x32_bf16 v[188:191], v[64:67], a[172:175], v[188:191]
  v_mfma_f32_16x16x32_bf16 v[192:195], v[68:71], a[160:163], v[192:195]
  ds_read_b64_tr_b16 v[64:65], v1 offset:34824
  ds_read_b64_tr_b16 v[66:67], v1 offset:38920
  v_mfma_f32_16x16x32_bf16 v[196:199], v[68:71], a[164:167], v[196:199]
  s_add_u32 m0, s41, 82944
  v_mfma_f32_16x16x32_bf16 v[200:203], v[68:71], a[168:171], v[200:203]
  v_mfma_f32_16x16x32_bf16 v[204:207], v[68:71], a[172:175], v[204:207]
  s_waitcnt lgkmcnt(6)
  v_mfma_f32_16x16x32_bf16 v[208:211], v[48:51], a[160:163], v[208:211]
  ds_read_b64_tr_b16 v[68:69], v2 offset:34816
  ds_read_b64_tr_b16 v[70:71], v2 offset:38912
  v_mfma_f32_16x16x32_bf16 v[212:215], v[48:51], a[164:167], v[212:215]
  buffer_load_dwordx4 v13, s[12:15], s37 offen lds
  v_mfma_f32_16x16x32_bf16 v[216:219], v[48:51], a[168:171], v[216:219]
  v_mfma_f32_16x16x32_bf16 v[220:223], v[48:51], a[172:175], v[220:223]
  v_mfma_f32_16x16x32_bf16 v[224:227], v[52:55], a[160:163], v[224:227]
  ds_read_b64_tr_b16 v[48:49], v2 offset:34824
  ds_read_b64_tr_b16 v[50:51], v2 offset:38920
  v_mfma_f32_16x16x32_bf16 v[228:231], v[52:55], a[164:167], v[228:231]
  buffer_load_dwordx4 v14, s[12:15], s37 offen offset:1024 lds
  v_mfma_f32_16x16x32_bf16 v[232:235], v[52:55], a[168:171], v[232:235]
  v_mfma_f32_16x16x32_bf16 v[236:239], v[52:55], a[172:175], v[236:239]
  s_waitcnt lgkmcnt(6)
  v_mfma_f32_16x16x32_bf16 v[240:243], v[56:59], a[160:163], v[240:243]
  ds_read_b64_tr_b16 v[52:53], v3 offset:34816
  ds_read_b64_tr_b16 v[54:55], v3 offset:38912
  v_mfma_f32_16x16x32_bf16 v[244:247], v[56:59], a[164:167], v[244:247]
  s_mov_b64 exec, 0xffff
  buffer_load_dwordx4 v15, s[12:15], s37 offen offset:2048 lds
  s_mov_b64 exec, -1
  v_mfma_f32_16x16x32_bf16 v[248:251], v[56:59], a[168:171], v[248:251]
  v_mfma_f32_16x16x32_bf16 v[252:255], v[56:59], a[172:175], v[252:255]
  v_mfma_f32_16x16x32_bf16 a[0:3], v[60:63], a[160:163], a[0:3]
  ds_read_b64_tr_b16 v[56:57], v3 offset:34824
  ds_read_b64_tr_b16 v[58:59], v3 offset:38920
  v_mfma_f32_16x16x32_bf16 a[4:7], v[60:63], a[164:167], a[4:7]
  s_add_u32 s37, s37, 294912
  v_mfma_f32_16x16x32_bf16 a[8:11], v[60:63], a[168:171], a[8:11]
  v_mfma_f32_16x16x32_bf16 a[12:15], v[60:63], a[172:175], a[12:15]
  s_waitcnt lgkmcnt(6)
  v_mfma_f32_16x16x32_bf16 a[16:19], v[64:67], a[160:163], a[16:19]
  ds_read_b64_tr_b16 v[60:61], v4 offset:34816
  ds_read_b64_tr_b16 v[62:63], v4 offset:38912
  v_mfma_f32_16x16x32_bf16 a[20:23], v[64:67], a[164:167], a[20:23]
  s_add_u32 m0, s40, 82944
  v_mfma_f32_16x16x32_bf16 a[24:27], v[64:67], a[168:171], a[24:27]
  v_mfma_f32_16x16x32_bf16 a[28:31], v[64:67], a[172:175], a[28:31]
  v_mfma_f32_16x16x32_bf16 a[32:35], v[68:71], a[160:163], a[32:35]
  ds_read_b64_tr_b16 v[64:65], v4 offset:34824
  ds_read_b64_tr_b16 v[66:67], v4 offset:38920
  v_mfma_f32_16x16x32_bf16 a[36:39], v[68:71], a[164:167], a[36:39]
  buffer_load_dwordx4 v11, s[8:11], s36 offen lds
  v_mfma_f32_16x16x32_bf16 a[40:43], v[68:71], a[168:171], a[40:43]
  v_mfma_f32_16x16x32_bf16 a[44:47], v[68:71], a[172:175], a[44:47]
  s_waitcnt lgkmcnt(6)
  v_mfma_f32_16x16x32_bf16 a[48:51], v[48:51], a[160:163], a[48:51]
  ds_read_b64_tr_b16 v[68:69], v10 offset:0
  ds_read_b64_tr_b16 v[70:71], v10 offset:4608
  v_mfma_f32_16x16x32_bf16 a[52:55], v[48:51], a[164:167], a[52:55]
  buffer_load_dwordx4 v12, s[8:11], s36 offen offset:1024 lds
  v_mfma_f32_16x16x32_bf16 a[56:59], v[48:51], a[168:171], a[56:59]
  s_getpc_b64 s[50:51]
L_pc0:
  s_add_u32 s48, s50, L_g1_done-L_pc0
  s_addc_u32 s49, s51, 0
  s_mov_b32 s50, L_attn_done-L_g1_done
  s_mov_b32 s51, 0x20000
  s_lshr_b32 s4, s2, 3
  s_lshl_b32 s4, s4, 2
  s_add_u32 s4, s4, s3
  s_lshl_b32 s4, s4, 9
  s_mov_b64 exec, 0xf
  buffer_load_dword v73, v72, s[48:51], s4 offen
  s_mov_b64 exec, -1
  v_mfma_f32_16x16x32_bf16 a[60:63], v[48:51], a[172:175], a[60:63]
  v_mfma_f32_16x16x32_bf16 a[64:67], v[52:55], a[160:163], a[64:67]
  ds_read_b64_tr_b16 v[48:49], v10 offset:32
  ds_read_b64_tr_b16 v[50:51], v10 offset:4640
  v_mfma_f32_16x16x32_bf16 a[68:71], v[52:55], a[164:167], a[68:71]
  s_add_u32 s36, s36, 262144
  v_mfma_f32_16x16x32_bf16 a[72:75], v[52:55], a[168:171], a[72:75]
  v_mfma_f32_16x16x32_bf16 a[76:79], v[52:55], a[172:175], a[76:79]
  s_waitcnt lgkmcnt(6)
  v_mfma_f32_16x16x32_bf16 a[80:83], v[56:59], a[160:163], a[80:83]
  ds_read_b64_tr_b16 v[52:53], v10 offset:64
  ds_read_b64_tr_b16 v[54:55], v10 offset:4672
  v_mfma_f32_16x16x32_bf16 a[84:87], v[56:59], a[164:167], a[84:87]
  v_mfma_f32_16x16x32_bf16 a[88:91], v[56:59], a[168:171], a[88:91]
  v_mfma_f32_16x16x32_bf16 a[92:95], v[56:59], a[172:175], a[92:95]
  v_mfma_f32_16x16x32_bf16 a[96:99], v[60:63], a[160:163], a[96:99]
  ds_read_b64_tr_b16 v[56:57], v10 offset:96
  ds_read_b64_tr_b16 v[58:59], v10 offset:4704
  v_mfma_f32_16x16x32_bf16 a[100:103], v[60:63], a[164:167], a[100:103]
  v_mfma_f32_16x16x32_bf16 a[104:107], v[60:63], a[168:171], a[104:107]
  v_mfma_f32_16x16x32_bf16 a[108:111], v[60:63], a[172:175], a[108:111]
  s_waitcnt lgkmcnt(6)
  v_mfma_f32_16x16x32_bf16 a[112:115], v[64:67], a[160:163], a[112:115]
  ds_read_b64_tr_b16 v[60:61], v10 offset:128
  ds_read_b64_tr_b16 v[62:63], v10 offset:4736
  v_mfma_f32_16x16x32_bf16 a[116:119], v[64:67], a[164:167], a[116:119]
  v_mfma_f32_16x16x32_bf16 a[120:123], v[64:67], a[168:171], a[120:123]
  v_mfma_f32_16x16x32_bf16 a[124:127], v[64:67], a[172:175], a[124:127]
  s_waitcnt vmcnt(19)
  s_barrier
  v_mfma_f32_16x16x32_bf16 v[112:115], v[68:71], a[176:179], v[112:115]
  ds_read_b64_tr_b16 v[64:65], v10 offset:160
  ds_read_b64_tr_b16 v[66:67], v10 offset:4768
  v_mfma_f32_16x16x32_bf16 v[116:119], v[68:71], a[180:183], v[116:119]
  buffer_load_dwordx4 a[160:163], v16, s[16:19], s38 offen offset:0 sc1
  v_mfma_f32_16x16x32_bf16 v[120:123], v[68:71], a[184:187], v[120:123]
  v_mfma_f32_16x16x32_bf16 v[124:127], v[68:71], a[188:191], v[124:127]
  s_waitcnt lgkmcnt(6)
  v_mfma_f32_16x16x32_bf16 v[128:131], v[48:51], a[176:179], v[128:131]
  ds_read_b64_tr_b16 v[68:69], v10 offset:192
  ds_read_b64_tr_b16 v[70:71], v10 offset:4800
  v_mfma_f32_16x16x32_bf16 v[132:135], v[48:51], a[180:183], v[132:135]
  buffer_load_dwordx4 a[164:167], v16, s[16:19], s38 offen offset:1024 sc1
  v_mfma_f32_16x16x32_bf16 v[136:139], v[48:51], a[184:187], v[136:139]
  v_mfma_f32_16x16x32_bf16 v[140:143], v[48:51], a[188:191], v[140:143]
  v_mfma_f32_16x16x32_bf16 v[144:147], v[52:55], a[176:179], v[144:147]
  ds_read_b64_tr_b16 v[48:49], v10 offset:224
  ds_read_b64_tr_b16 v[50:51], v10 offset:4832
  v_mfma_f32_16x16x32_bf16 v[148:151], v[52:55], a[180:183], v[148:151]
  buffer_load_dwordx4 a[168:171], v16, s[16:19], s38 offen offset:2048 sc1
  v_mfma_f32_16x16x32_bf16 v[152:155], v[52:55], a[184:187], v[152:155]
  v_mfma_f32_16x16x32_bf16 v[156:159], v[52:55], a[188:191], v[156:159]
  s_waitcnt lgkmcnt(6)
  v_mfma_f32_16x16x32_bf16 v[160:163], v[56:59], a[176:179], v[160:163]
  ds_read_b64_tr_b16 v[52:53], v10 offset:256
  ds_read_b64_tr_b16 v[54:55], v10 offset:4864
  v_mfma_f32_16x16x32_bf16 v[164:167], v[56:59], a[180:183], v[164:167]
  buffer_load_dwordx4 a[172:175], v16, s[16:19], s38 offen offset:3072 sc1
  v_mfma_f32_16x16x32_bf16 v[168:171], v[56:59], a[184:187], v[168:171]
  v_mfma_f32_16x16x32_bf16 v[172:175], v[56:59], a[188:191], v[172:175]
  v_mfma_f32_16x16x32_bf16 v[176:179], v[60:63], a[176:179], v[176:179]
  ds_read_b64_tr_b16 v[56:57], v5 offset:0
  ds_read_b64_tr_b16 v[58:59], v5 offset:4096
  v_mfma_f32_16x16x32_bf16 v[180:183], v[60:63], a[180:183], v[180:183]
  s_add_u32 s38, s38, 4096
  v_mfma_f32_16x16x32_bf16 v[184:187], v[60:63], a[184:187], v[184:187]
  v_mfma_f32_16x16x32_bf16 v[188:191], v[60:63], a[188:191], v[188:191]
  s_waitcnt lgkmcnt(6)
  v_mfma_f32_16x16x32_bf16 v[192:195], v[64:67], a[176:179], v[192:195]
  ds_read_b64_tr_b16 v[60:61], v5 offset:8
  ds_read_b64_tr_b16 v[62:63], v5 offset:4104
  v_mfma_f32_16x16x32_bf16 v[196:199], v[64:67], a[180:183], v[196:199]
  s_add_u32 m0, s41, 100352
  v_mfma_f32_16x16x32_bf16 v[200:203], v[64:67], a[184:187], v[200:203]
  v_mfma_f32_16x16x32_bf16 v[204:207], v[64:67], a[188:191], v[204:207]
  v_mfma_f32_16x16x32_bf16 v[208:211], v[68:71], a[176:179], v[208:211]
  ds_read_b64_tr_b16 v[64:65], v6 offset:0
  ds_read_b64_tr_b16 v[66:67], v6 offset:4096
  v_mfma_f32_16x16x32_bf16 v[212:215], v[68:71], a[180:183], v[212:215]
  buffer_load_dwordx4 v13, s[12:15], s37 offen lds
  v_mfma_f32_16x16x32_bf16 v[216:219], v[68:71], a[184:187], v[216:219]
  v_mfma_f32_16x16x32_bf16 v[220:223], v[68:71], a[188:191], v[220:223]
  s_waitcnt lgkmcnt(6)
  v_mfma_f32_16x16x32_bf16 v[224:227], v[48:51], a[176:179], v[224:227]
  ds_read_b64_tr_b16 v[68:69], v6 offset:8
  ds_read_b64_tr_b16 v[70:71], v6 offset:4104
  v_mfma_f32_16x16x32_bf16 v[228:231], v[48:51], a[180:183], v[228:231]
  buffer_load_dwordx4 v14, s[12:15], s37 offen offset:1024 lds
  v_mfma_f32_16x16x32_bf16 v[232:235], v[48:51], a[184:187], v[232:235]
  v_mfma_f32_16x16x32_bf16 v[236:239], v[48:51], a[188:191], v[236:239]
  v_mfma_f32_16x16x32_bf16 v[240:243], v[52:55], a[176:179], v[240:243]
  ds_read_b64_tr_b16 v[48:49], v7 offset:0
  ds_read_b64_tr_b16 v[50:51], v7 offset:4096
  v_mfma_f32_16x16x32_bf16 v[244:247], v[52:55], a[180:183], v[244:247]
  s_mov_b64 exec, 0xffff
  buffer_load_dwordx4 v15, s[12:15], s37 offen offset:2048 lds
  s_mov_b64 exec, -1
  v_mfma_f32_16x16x32_bf16 v[248:251], v[52:55], a[184:187], v[248:251]
  v_mfma_f32_16x16x32_bf16 v[252:255], v[52:55], a[188:191], v[252:255]
  s_waitcnt lgkmcnt(6)
  v_mfma_f32_16x16x32_bf16 a[0:3], v[56:59], a[176:179], a[0:3]
  ds_read_b64_tr_b16 v[52:53], v7 offset:8
  ds_read_b64_tr_b16 v[54:55], v7 offset:4104
  v_mfma_f32_16x16x32_bf16 a[4:7], v[56:59], a[180:183], a[4:7]
  s_add_u32 s37, s37, 294912
  v_mfma_f32_16x16x32_bf16 a[8:11], v[56:59], a[184:187], a[8:11]
  v_mfma_f32_16x16x32_bf16 a[12:15], v[56:59], a[188:191], a[12:15]
  v_mfma_f32_16x16x32_bf16 a[16:19], v[60:63], a[176:179], a[16:19]
  ds_read_b64_tr_b16 v[56:57], v8 offset:0
  ds_read_b64_tr_b16 v[58:59], v8 offset:4096
  v_mfma_f32_16x16x32_bf16 a[20:23], v[60:63], a[180:183], a[20:23]
  s_add_u32 m0, s40, 100352
  v_mfma_f32_16x16x32_bf16 a[24:27], v[60:63], a[184:187], a[24:27]
  v_mfma_f32_16x16x32_bf16 a[28:31], v[60:63], a[188:191], a[28:31]
  s_waitcnt lgkmcnt(6)
  v_mfma_f32_16x16x32_bf16 a[32:35], v[64:67], a[176:179], a[32:35]
  ds_read_b64_tr_b16 v[60:61], v8 offset:8
  ds_read_b64_tr_b16 v[62:63], v8 offset:4104
  v_mfma_f32_16x16x32_bf16 a[36:39], v[64:67], a[180:183], a[36:39]
  buffer_load_dwordx4 v11, s[8:11], s36 offen lds
  v_mfma_f32_16x16x32_bf16 a[40:43], v[64:67], a[184:187], a[40:43]
  v_mfma_f32_16x16x32_bf16 a[44:47], v[64:67], a[188:191], a[44:47]
  v_mfma_f32_16x16x32_bf16 a[48:51], v[68:71], a[176:179], a[48:51]
  ds_read_b64_tr_b16 v[64:65], v10 offset:17408
  ds_read_b64_tr_b16 v[66:67], v10 offset:22016
  v_mfma_f32_16x16x32_bf16 a[52:55], v[68:71], a[180:183], a[52:55]
  buffer_load_dwordx4 v12, s[8:11], s36 offen offset:1024 lds
  v_mfma_f32_16x16x32_bf16 a[56:59], v[68:71], a[184:187], a[56:59]
  v_mfma_f32_16x16x32_bf16 a[60:63], v[68:71], a[188:191], a[60:63]
  s_waitcnt lgkmcnt(6)
  v_mfma_f32_16x16x32_bf16 a[64:67], v[48:51], a[176:179], a[64:67]
  ds_read_b64_tr_b16 v[68:69], v10 offset:17440
  ds_read_b64_tr_b16 v[70:71], v10 offset:22048
  v_mfma_f32_16x16x32_bf16 a[68:71], v[48:51], a[180:183], a[68:71]
  s_add_u32 s36, s36, 262144
  v_mfma_f32_16x16x32_bf16 a[72:75], v[48:51], a[184:187], a[72:75]
  v_mfma_f32_16x16x32_bf16 a[76:79], v[48:51], a[188:191], a[76:79]
  v_mfma_f32_16x16x32_bf16 a[80:83], v[52:55], a[176:179], a[80:83]
  ds_read_b64_tr_b16 v[48:49], v10 offset:17472
  ds_read_b64_tr_b16 v[50:51], v10 offset:22080
  v_mfma_f32_16x16x32_bf16 a[84:87], v[52:55], a[180:183], a[84:87]
  v_mfma_f32_16x16x32_bf16 a[88:91], v[52:55], a[184:187], a[88:91]
  buffer_load_dword v73, v72, s[72:75], 0 offen
  v_mfma_f32_16x16x32_bf16 a[92:95], v[52:55], a[188:191], a[92:95]
  s_waitcnt lgkmcnt(6)
  v_mfma_f32_16x16x32_bf16 a[96:99], v[56:59], a[176:179], a[96:99]
  buffer_load_dword v73, v72, s[88:91], 0 offen
  v_mfma_f32_16x16x32_bf16 a[100:103], v[56:59], a[180:183], a[100:103]
  ds_read_b64_tr_b16 v[52:53], v10 offset:17504
  ds_read_b64_tr_b16 v[54:55], v10 offset:22112
  v_mfma_f32_16x16x32_bf16 a[104:107], v[56:59], a[184:187], a[104:107]
  v_mfma_f32_16x16x32_bf16 a[108:111], v[56:59], a[188:191], a[108:111]
  v_mfma_f32_16x16x32_bf16 a[112:115], v[60:63], a[176:179], a[112:115]
  ds_read_b64_tr_b16 v[56:57], v10 offset:17536
  ds_read_b64_tr_b16 v[58:59], v10 offset:22144
  v_mfma_f32_16x16x32_bf16 a[116:119], v[60:63], a[180:183], a[116:119]
  s_and_b32 s92, s6, 7
  s_mov_b32 s74, 9216
  v_mfma_f32_16x16x32_bf16 a[120:123], v[60:63], a[184:187], a[120:123]
  s_bitcmp0_b32 s7, 0
  s_cselect_b32 s72, s58, s52
  s_cselect_b32 s73, s59, s53
  s_cselect_b32 s74, 10368, s74
  v_mfma_f32_16x16x32_bf16 a[124:127], v[60:63], a[188:191], a[124:127]
  s_waitcnt vmcnt(21)
  s_barrier
  s_waitcnt lgkmcnt(6)
  v_mfma_f32_16x16x32_bf16 v[112:115], v[64:67], a[192:195], v[112:115]
  ds_read_b64_tr_b16 v[60:61], v10 offset:17568
  ds_read_b64_tr_b16 v[62:63], v10 offset:22176
  v_mfma_f32_16x16x32_bf16 v[116:119], v[64:67], a[196:199], v[116:119]
  s_add_u32 m0, s42, 0
  s_lshr_b32 s70, s7, 1
  v_mfma_f32_16x16x32_bf16 v[120:123], v[64:67], a[200:203], v[120:123]
  s_lshl_b32 s70, s70, 7
  s_add_u32 s70, s70, s6
  v_mfma_f32_16x16x32_bf16 v[124:127], v[64:67], a[204:207], v[124:127]
  s_mul_i32 s70, s70, s74
  v_mfma_f32_16x16x32_bf16 v[128:131], v[68:71], a[192:195], v[128:131]
  ds_read_b64_tr_b16 v[64:65], v10 offset:17600
  ds_read_b64_tr_b16 v[66:67], v10 offset:22208
  v_mfma_f32_16x16x32_bf16 v[132:135], v[68:71], a[196:199], v[132:135]
  s_mov_b32 s39, 0
  v_mfma_f32_16x16x32_bf16 v[136:139], v[68:71], a[200:203], v[136:139]
  s_add_u32 s72, s72, s70
  s_addc_u32 s73, s73, 0
  v_mfma_f32_16x16x32_bf16 v[140:143], v[68:71], a[204:207], v[140:143]
  s_waitcnt lgkmcnt(6)
  v_mfma_f32_16x16x32_bf16 v[144:147], v[48:51], a[192:195], v[144:147]
  ds_read_b64_tr_b16 v[68:69], v10 offset:17632
  ds_read_b64_tr_b16 v[70:71], v10 offset:22240
  v_mfma_f32_16x16x32_bf16 v[148:151], v[48:51], a[196:199], v[148:151]
  buffer_load_dwordx4 v17, s[20:23], s39 offen lds
  v_mfma_f32_16x16x32_bf16 v[152:155], v[48:51], a[200:203], v[152:155]
  s_add_u32 s88, s72, 8192
  s_addc_u32 s89, s73, 0
  v_mfma_f32_16x16x32_bf16 v[156:159], v[48:51], a[204:207], v[156:159]
  s_sub_u32 s90, s74, 8192
  s_mov_b32 s75, 0x20000
  v_mfma_f32_16x16x32_bf16 v[160:163], v[52:55], a[192:195], v[160:163]
  ds_read_b64_tr_b16 v[48:49], v10 offset:17664
  ds_read_b64_tr_b16 v[50:51], v10 offset:22272
  v_mfma_f32_16x16x32_bf16 v[164:167], v[52:55], a[196:199], v[164:167]
  buffer_load_dwordx4 v18, s[20:23], s39 offen offset:1024 lds
  v_mfma_f32_16x16x32_bf16 v[168:171], v[52:55], a[200:203], v[168:171]
  s_mov_b32 s91, 0x20000
  v_mfma_f32_16x16x32_bf16 v[172:175], v[52:55], a[204:207], v[172:175]
  s_waitcnt lgkmcnt(6)
  v_mfma_f32_16x16x32_bf16 v[176:179], v[56:59], a[192:195], v[176:179]
  ds_read_b64_tr_b16 v[52:53], v5 offset:17408
  ds_read_b64_tr_b16 v[54:55], v5 offset:21504
  v_mfma_f32_16x16x32_bf16 v[180:183], v[56:59], a[196:199], v[180:183]
  s_add_u32 m0, s42, 8192
  v_mfma_f32_16x16x32_bf16 v[184:187], v[56:59], a[200:203], v[184:187]
  v_mfma_f32_16x16x32_bf16 v[188:191], v[56:59], a[204:207], v[188:191]
  v_mfma_f32_16x16x32_bf16 v[192:195], v[60:63], a[192:195], v[192:195]
  ds_read_b64_tr_b16 v[56:57], v5 offset:17416
  ds_read_b64_tr_b16 v[58:59], v5 offset:21512
  v_mfma_f32_16x16x32_bf16 v[196:199], v[60:63], a[196:199], v[196:199]
  s_mov_b32 s39, 8192
  v_mfma_f32_16x16x32_bf16 v[200:203], v[60:63], a[200:203], v[200:203]
  v_mfma_f32_16x16x32_bf16 v[204:207], v[60:63], a[204:207], v[204:207]
  s_waitcnt lgkmcnt(6)
  v_mfma_f32_16x16x32_bf16 v[208:211], v[64:67], a[192:195], v[208:211]
  ds_read_b64_tr_b16 v[60:61], v6 offset:17408
  ds_read_b64_tr_b16 v[62:63], v6 offset:21504
  v_mfma_f32_16x16x32_bf16 v[212:215], v[64:67], a[196:199], v[212:215]
  buffer_load_dwordx4 v17, s[20:23], s39 offen lds
  v_mfma_f32_16x16x32_bf16 v[216:219], v[64:67], a[200:203], v[216:219]
  v_mfma_f32_16x16x32_bf16 v[220:223], v[64:67], a[204:207], v[220:223]
  v_mfma_f32_16x16x32_bf16 v[224:227], v[68:71], a[192:195], v[224:227]
  ds_read_b64_tr_b16 v[64:65], v6 offset:17416
  ds_read_b64_tr_b16 v[66:67], v6 offset:21512
  v_mfma_f32_16x16x32_bf16 v[228:231], v[68:71], a[196:199], v[228:231]
  buffer_load_dwordx4 v18, s[20:23], s39 offen offset:1024 lds
  v_mfma_f32_16x16x32_bf16 v[232:235], v[68:71], a[200:203], v[232:235]
  v_mfma_f32_16x16x32_bf16 v[236:239], v[68:71], a[204:207], v[236:239]
  s_waitcnt lgkmcnt(6)
  v_mfma_f32_16x16x32_bf16 v[240:243], v[48:51], a[192:195], v[240:243]
  ds_read_b64_tr_b16 v[68:69], v7 offset:17408
  ds_read_b64_tr_b16 v[70:71], v7 offset:21504
  v_mfma_f32_16x16x32_bf16 v[244:247], v[48:51], a[196:199], v[244:247]
  v_mfma_f32_16x16x32_bf16 v[248:251], v[48:51], a[200:203], v[248:251]
  v_mfma_f32_16x16x32_bf16 v[252:255], v[48:51], a[204:207], v[252:255]
  v_mfma_f32_16x16x32_bf16 a[0:3], v[52:55], a[192:195], a[0:3]
  ds_read_b64_tr_b16 v[48:49], v7 offset:17416
  ds_read_b64_tr_b16 v[50:51], v7 offset:21512
  v_mfma_f32_16x16x32_bf16 a[4:7], v[52:55], a[196:199], a[4:7]
  v_mfma_f32_16x16x32_bf16 a[8:11], v[52:55], a[200:203], a[8:11]
  v_mfma_f32_16x16x32_bf16 a[12:15], v[52:55], a[204:207], a[12:15]
  s_waitcnt lgkmcnt(6)
  v_mfma_f32_16x16x32_bf16 a[16:19], v[56:59], a[192:195], a[16:19]
  ds_read_b64_tr_b16 v[52:53], v8 offset:17408
  ds_read_b64_tr_b16 v[54:55], v8 offset:21504
  v_mfma_f32_16x16x32_bf16 a[20:23], v[56:59], a[196:199], a[20:23]
  v_mfma_f32_16x16x32_bf16 a[24:27], v[56:59], a[200:203], a[24:27]
  v_mfma_f32_16x16x32_bf16 a[28:31], v[56:59], a[204:207], a[28:31]
  v_mfma_f32_16x16x32_bf16 a[32:35], v[60:63], a[192:195], a[32:35]
  ds_read_b64_tr_b16 v[56:57], v8 offset:17416
  ds_read_b64_tr_b16 v[58:59], v8 offset:21512
  v_mfma_f32_16x16x32_bf16 a[36:39], v[60:63], a[196:199], a[36:39]
  v_mfma_f32_16x16x32_bf16 a[40:43], v[60:63], a[200:203], a[40:43]
  v_mfma_f32_16x16x32_bf16 a[44:47], v[60:63], a[204:207], a[44:47]
  s_waitcnt lgkmcnt(6)
  v_mfma_f32_16x16x32_bf16 a[48:51], v[64:67], a[192:195], a[48:51]
  ds_read_b64_tr_b16 v[60:61], v9 offset:0
  ds_read_b64_tr_b16 v[62:63], v9 offset:4608
  v_mfma_f32_16x16x32_bf16 a[52:55], v[64:67], a[196:199], a[52:55]
  v_mfma_f32_16x16x32_bf16 a[56:59], v[64:67], a[200:203], a[56:59]
  v_mfma_f32_16x16x32_bf16 a[60:63], v[64:67], a[204:207], a[60:63]
  v_mfma_f32_16x16x32_bf16 a[64:67], v[68:71], a[192:195], a[64:67]
  ds_read_b64_tr_b16 v[64:65], v9 offset:32
  ds_read_b64_tr_b16 v[66:67], v9 offset:4640
  v_mfma_f32_16x16x32_bf16 a[68:71], v[68:71], a[196:199], a[68:71]
  v_mfma_f32_16x16x32_bf16 a[72:75], v[68:71], a[200:203], a[72:75]
  v_mfma_f32_16x16x32_bf16 a[76:79], v[68:71], a[204:207], a[76:79]
  s_waitcnt lgkmcnt(6)
  v_mfma_f32_16x16x32_bf16 a[80:83], v[48:51], a[192:195], a[80:83]
  ds_read_b64_tr_b16 v[68:69], v9 offset:64
  ds_read_b64_tr_b16 v[70:71], v9 offset:4672
  v_mfma_f32_16x16x32_bf16 a[84:87], v[48:51], a[196:199], a[84:87]
  v_mfma_f32_16x16x32_bf16 a[88:91], v[48:51], a[200:203], a[88:91]
  v_mfma_f32_16x16x32_bf16 a[92:95], v[48:51], a[204:207], a[92:95]
  v_mfma_f32_16x16x32_bf16 a[96:99], v[52:55], a[192:195], a[96:99]
  ds_read_b64_tr_b16 v[48:49], v9 offset:96
  ds_read_b64_tr_b16 v[50:51], v9 offset:4704
  v_mfma_f32_16x16x32_bf16 a[100:103], v[52:55], a[196:199], a[100:103]
  v_mfma_f32_16x16x32_bf16 a[104:107], v[52:55], a[200:203], a[104:107]
  v_mfma_f32_16x16x32_bf16 a[108:111], v[52:55], a[204:207], a[108:111]
  s_waitcnt lgkmcnt(6)
  v_mfma_f32_16x16x32_bf16 a[112:115], v[56:59], a[192:195], a[112:115]
  ds_read_b64_tr_b16 v[52:53], v9 offset:128
  ds_read_b64_tr_b16 v[54:55], v9 offset:4736
  v_mfma_f32_16x16x32_bf16 a[116:119], v[56:59], a[196:199], a[116:119]
  v_mfma_f32_16x16x32_bf16 a[120:123], v[56:59], a[200:203], a[120:123]
  v_mfma_f32_16x16x32_bf16 a[124:127], v[56:59], a[204:207], a[124:127]
  s_waitcnt vmcnt(16)
  s_barrier
  v_mfma_f32_16x16x32_bf16 v[112:115], v[60:63], a[128:131], v[112:115]
  ds_read_b64_tr_b16 v[56:57], v9 offset:160
  ds_read_b64_tr_b16 v[58:59], v9 offset:4768
  v_mfma_f32_16x16x32_bf16 v[116:119], v[60:63], a[132:135], v[116:119]
  s_add_u32 m0, s42, 32768
  v_mfma_f32_16x16x32_bf16 v[120:123], v[60:63], a[136:139], v[120:123]
  v_mfma_f32_16x16x32_bf16 v[124:127], v[60:63], a[140:143], v[124:127]
  s_waitcnt lgkmcnt(6)
  v_mfma_f32_16x16x32_bf16 v[128:131], v[64:67], a[128:131], v[128:131]
  ds_read_b64_tr_b16 v[60:61], v9 offset:192
  ds_read_b64_tr_b16 v[62:63], v9 offset:4800
  v_mfma_f32_16x16x32_bf16 v[132:135], v[64:67], a[132:135], v[132:135]
  s_mov_b32 s39, 0
  v_mfma_f32_16x16x32_bf16 v[136:139], v[64:67], a[136:139], v[136:139]
  v_mfma_f32_16x16x32_bf16 v[140:143], v[64:67], a[140:143], v[140:143]
  v_mfma_f32_16x16x32_bf16 v[144:147], v[68:71], a[128:131], v[144:147]
  ds_read_b64_tr_b16 v[64:65], v9 offset:224
  ds_read_b64_tr_b16 v[66:67], v9 offset:4832
  v_mfma_f32_16x16x32_bf16 v[148:151], v[68:71], a[132:135], v[148:151]
  buffer_load_dwordx4 v19, s[24:27], s39 offen lds
  v_mfma_f32_16x16x32_bf16 v[152:155], v[68:71], a[136:139], v[152:155]
  v_mfma_f32_16x16x32_bf16 v[156:159], v[68:71], a[140:143], v[156:159]
  s_waitcnt lgkmcnt(6)
  v_mfma_f32_16x16x32_bf16 v[160:163], v[48:51], a[128:131], v[160:163]
  ds_read_b64_tr_b16 v[68:69], v9 offset:256
  ds_read_b64_tr_b16 v[70:71], v9 offset:4864
  v_mfma_f32_16x16x32_bf16 v[164:167], v[48:51], a[132:135], v[164:167]
  buffer_load_dwordx4 v20, s[24:27], s39 offen offset:1024 lds
  v_mfma_f32_16x16x32_bf16 v[168:171], v[48:51], a[136:139], v[168:171]
  v_mfma_f32_16x16x32_bf16 v[172:175], v[48:51], a[140:143], v[172:175]
  v_mfma_f32_16x16x32_bf16 v[176:179], v[52:55], a[128:131], v[176:179]
  ds_read_b64_tr_b16 v[48:49], v1 offset:0
  ds_read_b64_tr_b16 v[50:51], v1 offset:4096
  v_mfma_f32_16x16x32_bf16 v[180:183], v[52:55], a[132:135], v[180:183]
  s_add_u32 m0, s42, 16384
  v_mfma_f32_16x16x32_bf16 v[184:187], v[52:55], a[136:139], v[184:187]
  v_mfma_f32_16x16x32_bf16 v[188:191], v[52:55], a[140:143], v[188:191]
  s_waitcnt lgkmcnt(6)
  v_mfma_f32_16x16x32_bf16 v[192:195], v[56:59], a[128:131], v[192:195]
  ds_read_b64_tr_b16 v[52:53], v1 offset:8
  ds_read_b64_tr_b16 v[54:55], v1 offset:4104
  v_mfma_f32_16x16x32_bf16 v[196:199], v[56:59], a[132:135], v[196:199]
  s_mov_b32 s39, 16384
  v_mfma_f32_16x16x32_bf16 v[200:203], v[56:59], a[136:139], v[200:203]
  v_mfma_f32_16x16x32_bf16 v[204:207], v[56:59], a[140:143], v[204:207]
  v_mfma_f32_16x16x32_bf16 v[208:211], v[60:63], a[128:131], v[208:211]
  ds_read_b64_tr_b16 v[56:57], v2 offset:0
  ds_read_b64_tr_b16 v[58:59], v2 offset:4096
  v_mfma_f32_16x16x32_bf16 v[212:215], v[60:63], a[132:135], v[212:215]
  buffer_load_dwordx4 v17, s[20:23], s39 offen lds
  v_mfma_f32_16x16x32_bf16 v[216:219], v[60:63], a[136:139], v[216:219]
  v_mfma_f32_16x16x32_bf16 v[220:223], v[60:63], a[140:143], v[220:223]
  s_waitcnt lgkmcnt(6)
  v_mfma_f32_16x16x32_bf16 v[224:227], v[64:67], a[128:131], v[224:227]
  ds_read_b64_tr_b16 v[60:61], v2 offset:8
  ds_read_b64_tr_b16 v[62:63], v2 offset:4104
  v_mfma_f32_16x16x32_bf16 v[228:231], v[64:67], a[132:135], v[228:231]
  buffer_load_dwordx4 v18, s[20:23], s39 offen offset:1024 lds
  v_mfma_f32_16x16x32_bf16 v[232:235], v[64:67], a[136:139], v[232:235]
  v_mfma_f32_16x16x32_bf16 v[236:239], v[64:67], a[140:143], v[236:239]
  v_mfma_f32_16x16x32_bf16 v[240:243], v[68:71], a[128:131], v[240:243]
  ds_read_b64_tr_b16 v[64:65], v3 offset:0
  ds_read_b64_tr_b16 v[66:67], v3 offset:4096
  v_mfma_f32_16x16x32_bf16 v[244:247], v[68:71], a[132:135], v[244:247]
  v_mfma_f32_16x16x32_bf16 v[248:251], v[68:71], a[136:139], v[248:251]
  v_mfma_f32_16x16x32_bf16 v[252:255], v[68:71], a[140:143], v[252:255]
  s_waitcnt lgkmcnt(6)
  v_mfma_f32_16x16x32_bf16 a[0:3], v[48:51], a[128:131], a[0:3]
  ds_read_b64_tr_b16 v[68:69], v3 offset:8
  ds_read_b64_tr_b16 v[70:71], v3 offset:4104
  v_mfma_f32_16x16x32_bf16 a[4:7], v[48:51], a[132:135], a[4:7]
  v_mfma_f32_16x16x32_bf16 a[8:11], v[48:51], a[136:139], a[8:11]
  v_mfma_f32_16x16x32_bf16 a[12:15], v[48:51], a[140:143], a[12:15]
  v_mfma_f32_16x16x32_bf16 a[16:19], v[52:55], a[128:131], a[16:19]
  ds_read_b64_tr_b16 v[48:49], v4 offset:0
  ds_read_b64_tr_b16 v[50:51], v4 offset:4096
  v_mfma_f32_16x16x32_bf16 a[20:23], v[52:55], a[132:135], a[20:23]
  v_mfma_f32_16x16x32_bf16 a[24:27], v[52:55], a[136:139], a[24:27]
  v_mfma_f32_16x16x32_bf16 a[28:31], v[52:55], a[140:143], a[28:31]
  s_waitcnt lgkmcnt(6)
  v_mfma_f32_16x16x32_bf16 a[32:35], v[56:59], a[128:131], a[32:35]
  ds_read_b64_tr_b16 v[52:53], v4 offset:8
  ds_read_b64_tr_b16 v[54:55], v4 offset:4104
  v_mfma_f32_16x16x32_bf16 a[36:39], v[56:59], a[132:135], a[36:39]
  v_mfma_f32_16x16x32_bf16 a[40:43], v[56:59], a[136:139], a[40:43]
  v_mfma_f32_16x16x32_bf16 a[44:47], v[56:59], a[140:143], a[44:47]
  v_mfma_f32_16x16x32_bf16 a[48:51], v[60:63], a[128:131], a[48:51]
  ds_read_b64_tr_b16 v[56:57], v9 offset:17408
  ds_read_b64_tr_b16 v[58:59], v9 offset:22016
  v_mfma_f32_16x16x32_bf16 a[52:55], v[60:63], a[132:135], a[52:55]
  v_mfma_f32_16x16x32_bf16 a[56:59], v[60:63], a[136:139], a[56:59]
  v_mfma_f32_16x16x32_bf16 a[60:63], v[60:63], a[140:143], a[60:63]
  s_waitcnt lgkmcnt(6)
  v_mfma_f32_16x16x32_bf16 a[64:67], v[64:67], a[128:131], a[64:67]
  ds_read_b64_tr_b16 v[60:61], v9 offset:17440
  ds_read_b64_tr_b16 v[62:63], v9 offset:22048
  v_mfma_f32_16x16x32_bf16 a[68:71], v[64:67], a[132:135], a[68:71]
  v_mfma_f32_16x16x32_bf16 a[72:75], v[64:67], a[136:139], a[72:75]
  v_mfma_f32_16x16x32_bf16 a[76:79], v[64:67], a[140:143], a[76:79]
  v_mfma_f32_16x16x32_bf16 a[80:83], v[68:71], a[128:131], a[80:83]
  ds_read_b64_tr_b16 v[64:65], v9 offset:17472
  ds_read_b64_tr_b16 v[66:67], v9 offset:22080
  v_mfma_f32_16x16x32_bf16 a[84:87], v[68:71], a[132:135], a[84:87]
  v_mfma_f32_16x16x32_bf16 a[88:91], v[68:71], a[136:139], a[88:91]
  v_mfma_f32_16x16x32_bf16 a[92:95], v[68:71], a[140:143], a[92:95]
  s_waitcnt lgkmcnt(6)
  v_mfma_f32_16x16x32_bf16 a[96:99], v[48:51], a[128:131], a[96:99]
  ds_read_b64_tr_b16 v[68:69], v9 offset:17504
  ds_read_b64_tr_b16 v[70:71], v9 offset:22112
  v_mfma_f32_16x16x32_bf16 a[100:103], v[48:51], a[132:135], a[100:103]
  v_mfma_f32_16x16x32_bf16 a[104:107], v[48:51], a[136:139], a[104:107]
  v_mfma_f32_16x16x32_bf16 a[108:111], v[48:51], a[140:143], a[108:111]
  v_mfma_f32_16x16x32_bf16 a[112:115], v[52:55], a[128:131], a[112:115]
  ds_read_b64_tr_b16 v[48:49], v9 offset:17536
  ds_read_b64_tr_b16 v[50:51], v9 offset:22144
  v_mfma_f32_16x16x32_bf16 a[116:119], v[52:55], a[132:135], a[116:119]
  v_mfma_f32_16x16x32_bf16 a[120:123], v[52:55], a[136:139], a[120:123]
  v_mfma_f32_16x16x32_bf16 a[124:127], v[52:55], a[140:143], a[124:127]
  s_waitcnt vmcnt(10)
  s_barrier
  s_waitcnt lgkmcnt(6)
  v_mfma_f32_16x16x32_bf16 v[112:115], v[56:59], a[144:147], v[112:115]
  ds_read_b64_tr_b16 v[52:53], v9 offset:17568
  ds_read_b64_tr_b16 v[54:55], v9 offset:22176
  v_mfma_f32_16x16x32_bf16 v[116:119], v[56:59], a[148:151], v[116:119]
  s_add_u32 m0, s42, 40960
  s_bfe_u32 s6, s2, 0x20003
  v_mfma_f32_16x16x32_bf16 v[120:123], v[56:59], a[152:155], v[120:123]
  s_mul_i32 s43, s6, 288
  s_lshr_b32 s92, s7, 1
  v_mfma_f32_16x16x32_bf16 v[124:127], v[56:59], a[156:159], v[124:127]
  s_and_b32 s38, s7, 1
  s_xor_b32 s38, s38, 1
  v_mfma_f32_16x16x32_bf16 v[128:131], v[60:63], a[144:147], v[128:131]
  ds_read_b64_tr_b16 v[56:57], v9 offset:17600
  ds_read_b64_tr_b16 v[58:59], v9 offset:22208
  v_mfma_f32_16x16x32_bf16 v[132:135], v[60:63], a[148:151], v[132:135]
  s_mov_b32 s39, 8192
  s_mov_b32 s37, 25165824
  v_mfma_f32_16x16x32_bf16 v[136:139], v[60:63], a[152:155], v[136:139]
  s_cmp_eq_u32 s38, 1
  s_cselect_b32 s8, s58, s52
  s_cselect_b32 s9, s59, s53
  v_mfma_f32_16x16x32_bf16 v[140:143], v[60:63], a[156:159], v[140:143]
  s_waitcnt lgkmcnt(6)
  v_mfma_f32_16x16x32_bf16 v[144:147], v[64:67], a[144:147], v[144:147]
  ds_read_b64_tr_b16 v[60:61], v9 offset:17632
  ds_read_b64_tr_b16 v[62:63], v9 offset:22240
  v_mfma_f32_16x16x32_bf16 v[148:151], v[64:67], a[148:151], v[148:151]
  buffer_load_dwordx4 v19, s[24:27], s39 offen lds
  v_mfma_f32_16x16x32_bf16 v[152:155], v[64:67], a[152:155], v[152:155]
  s_cmp_eq_u32 s38, 1
  s_cselect_b32 s18, 147456, 0
  s_cselect_b32 s36, 36, 32
  s_cselect_b32 s37, 4194304, s37
  v_mfma_f32_16x16x32_bf16 v[156:159], v[64:67], a[156:159], v[156:159]
  s_mul_i32 s71, s36, 36864
  s_sub_u32 s10, s71, s43
  v_mfma_f32_16x16x32_bf16 v[160:163], v[68:71], a[144:147], v[160:163]
  ds_read_b64_tr_b16 v[64:65], v9 offset:17664
  ds_read_b64_tr_b16 v[66:67], v9 offset:22272
  v_mfma_f32_16x16x32_bf16 v[164:167], v[68:71], a[148:151], v[164:167]
  buffer_load_dwordx4 v20, s[24:27], s39 offen offset:1024 lds
  v_mfma_f32_16x16x32_bf16 v[168:171], v[68:71], a[152:155], v[168:171]
  s_mul_i32 s71, s71, s92
  s_add_u32 s70, s71, s43
  v_mfma_f32_16x16x32_bf16 v[172:175], v[68:71], a[156:159], v[172:175]
  s_waitcnt lgkmcnt(6)
  v_mfma_f32_16x16x32_bf16 v[176:179], v[48:51], a[144:147], v[176:179]
  ds_read_b64_tr_b16 v[68:69], v1 offset:17408
  ds_read_b64_tr_b16 v[70:71], v1 offset:21504
  v_mfma_f32_16x16x32_bf16 v[180:183], v[48:51], a[148:151], v[180:183]
  s_add_u32 m0, s42, 24576
  v_mfma_f32_16x16x32_bf16 v[184:187], v[48:51], a[152:155], v[184:187]
  s_add_u32 s8, s8, s70
  s_addc_u32 s9, s9, 0
  v_mfma_f32_16x16x32_bf16 v[188:191], v[48:51], a[156:159], v[188:191]
  s_lshl_b32 s70, s5, 2
  s_add_u32 s70, s70, s92
  v_mfma_f32_16x16x32_bf16 v[192:195], v[52:55], a[144:147], v[192:195]
  ds_read_b64_tr_b16 v[48:49], v1 offset:17416
  ds_read_b64_tr_b16 v[50:51], v1 offset:21512
  v_mfma_f32_16x16x32_bf16 v[196:199], v[52:55], a[148:151], v[196:199]
  s_mov_b32 s39, 24576
  s_mul_i32 s70, s70, s36
  v_mfma_f32_16x16x32_bf16 v[200:203], v[52:55], a[152:155], v[200:203]
  s_lshl_b32 s70, s70, 12
  s_add_u32 s70, s70, s37
  v_mfma_f32_16x16x32_bf16 v[204:207], v[52:55], a[156:159], v[204:207]
  s_waitcnt lgkmcnt(6)
  v_mfma_f32_16x16x32_bf16 v[208:211], v[56:59], a[144:147], v[208:211]
  ds_read_b64_tr_b16 v[52:53], v2 offset:17408
  ds_read_b64_tr_b16 v[54:55], v2 offset:21504
  v_mfma_f32_16x16x32_bf16 v[212:215], v[56:59], a[148:151], v[212:215]
  buffer_load_dwordx4 v17, s[20:23], s39 offen lds
  v_mfma_f32_16x16x32_bf16 v[216:219], v[56:59], a[152:155], v[216:219]
  s_add_u32 s16, s64, s70
  s_addc_u32 s17, s65, 0
  v_mfma_f32_16x16x32_bf16 v[220:223], v[56:59], a[156:159], v[220:223]
  s_and_b32 s37, s7, 1
  s_lshl_b32 s37, s37, 2
  v_mfma_f32_16x16x32_bf16 v[224:227], v[60:63], a[144:147], v[224:227]
  ds_read_b64_tr_b16 v[56:57], v2 offset:17416
  ds_read_b64_tr_b16 v[58:59], v2 offset:21512
  v_mfma_f32_16x16x32_bf16 v[228:231], v[60:63], a[148:151], v[228:231]
  buffer_load_dwordx4 v18, s[20:23], s39 offen offset:1024 lds
  v_mfma_f32_16x16x32_bf16 v[232:235], v[60:63], a[152:155], v[232:235]
  s_add_u32 s37, s37, s6
  s_xor_b32 s70, s37, 0
  v_mfma_f32_16x16x32_bf16 v[236:239], v[60:63], a[156:159], v[236:239]
  s_add_u32 s71, s70, 1
  s_waitcnt lgkmcnt(6)
  v_mfma_f32_16x16x32_bf16 v[240:243], v[64:67], a[144:147], v[240:243]
  ds_read_b64_tr_b16 v[60:61], v3 offset:17408
  ds_read_b64_tr_b16 v[62:63], v3 offset:21504
  v_mfma_f32_16x16x32_bf16 v[244:247], v[64:67], a[148:151], v[244:247]
  s_lshr_b32 s71, s71, 1
  s_mul_i32 s71, s71, s38
  v_mfma_f32_16x16x32_bf16 v[248:251], v[64:67], a[152:155], v[248:251]
  s_lshl_b32 s70, s70, 2
  s_add_u32 s70, s70, s71
  v_mfma_f32_16x16x32_bf16 v[252:255], v[64:67], a[156:159], v[252:255]
  s_lshl_b32 s76, s70, 12
  s_add_u32 s70, s70, s3
  v_mfma_f32_16x16x32_bf16 a[0:3], v[68:71], a[144:147], a[0:3]
  ds_read_b64_tr_b16 v[64:65], v3 offset:17416
  ds_read_b64_tr_b16 v[66:67], v3 offset:21512
  v_mfma_f32_16x16x32_bf16 a[4:7], v[68:71], a[148:151], a[4:7]
  s_mul_i32 s84, s70, 36864
  s_xor_b32 s70, s37, 4
  v_mfma_f32_16x16x32_bf16 a[8:11], v[68:71], a[152:155], a[8:11]
  s_add_u32 s71, s70, 1
  s_lshr_b32 s71, s71, 1
  v_mfma_f32_16x16x32_bf16 a[12:15], v[68:71], a[156:159], a[12:15]
  s_mul_i32 s71, s71, s38
  s_waitcnt lgkmcnt(6)
  v_mfma_f32_16x16x32_bf16 a[16:19], v[48:51], a[144:147], a[16:19]
  ds_read_b64_tr_b16 v[68:69], v4 offset:17408
  ds_read_b64_tr_b16 v[70:71], v4 offset:21504
  v_mfma_f32_16x16x32_bf16 a[20:23], v[48:51], a[148:151], a[20:23]
  s_lshl_b32 s70, s70, 2
  s_add_u32 s70, s70, s71
  v_mfma_f32_16x16x32_bf16 a[24:27], v[48:51], a[152:155], a[24:27]
  s_lshl_b32 s77, s70, 12
  s_add_u32 s70, s70, s3
  v_mfma_f32_16x16x32_bf16 a[28:31], v[48:51], a[156:159], a[28:31]
  s_mul_i32 s85, s70, 36864
  s_xor_b32 s70, s37, 5
  v_mfma_f32_16x16x32_bf16 a[32:35], v[52:55], a[144:147], a[32:35]
  ds_read_b64_tr_b16 v[48:49], v4 offset:17416
  ds_read_b64_tr_b16 v[50:51], v4 offset:21512
  v_mfma_f32_16x16x32_bf16 a[36:39], v[52:55], a[148:151], a[36:39]
  s_add_u32 s71, s70, 1
  s_lshr_b32 s71, s71, 1
  v_mfma_f32_16x16x32_bf16 a[40:43], v[52:55], a[152:155], a[40:43]
  s_mul_i32 s71, s71, s38
  s_lshl_b32 s70, s70, 2
  v_mfma_f32_16x16x32_bf16 a[44:47], v[52:55], a[156:159], a[44:47]
  s_add_u32 s70, s70, s71
  s_waitcnt lgkmcnt(6)
  v_mfma_f32_16x16x32_bf16 a[48:51], v[56:59], a[144:147], a[48:51]
  ds_read_b64_tr_b16 v[52:53], v9 offset:34816
  ds_read_b64_tr_b16 v[54:55], v9 offset:39424
  v_mfma_f32_16x16x32_bf16 a[52:55], v[56:59], a[148:151], a[52:55]
  s_lshl_b32 s78, s70, 12
  s_add_u32 s70, s70, s3
  v_mfma_f32_16x16x32_bf16 a[56:59], v[56:59], a[152:155], a[56:59]
  s_mul_i32 s86, s70, 36864
  s_xor_b32 s70, s37, 6
  v_mfma_f32_16x16x32_bf16 a[60:63], v[56:59], a[156:159], a[60:63]
  s_add_u32 s71, s70, 1
  s_lshr_b32 s71, s71, 1
  v_mfma_f32_16x16x32_bf16 a[64:67], v[60:63], a[144:147], a[64:67]
  ds_read_b64_tr_b16 v[56:57], v9 offset:34848
  ds_read_b64_tr_b16 v[58:59], v9 offset:39456
  v_mfma_f32_16x16x32_bf16 a[68:71], v[60:63], a[148:151], a[68:71]
  s_mul_i32 s71, s71, s38
  s_lshl_b32 s70, s70, 2
  v_mfma_f32_16x16x32_bf16 a[72:75], v[60:63], a[152:155], a[72:75]
  s_add_u32 s70, s70, s71
  s_lshl_b32 s79, s70, 12
  v_mfma_f32_16x16x32_bf16 a[76:79], v[60:63], a[156:159], a[76:79]
  s_add_u32 s70, s70, s3
  s_waitcnt lgkmcnt(6)
  v_mfma_f32_16x16x32_bf16 a[80:83], v[64:67], a[144:147], a[80:83]
  ds_read_b64_tr_b16 v[60:61], v9 offset:34880
  ds_read_b64_tr_b16 v[62:63], v9 offset:39488
  v_mfma_f32_16x16x32_bf16 a[84:87], v[64:67], a[148:151], a[84:87]
  s_mul_i32 s87, s70, 36864
  s_xor_b32 s70, s37, 7
  v_mfma_f32_16x16x32_bf16 a[88:91], v[64:67], a[152:155], a[88:91]
  s_add_u32 s71, s70, 1
  s_lshr_b32 s71, s71, 1
  v_mfma_f32_16x16x32_bf16 a[92:95], v[64:67], a[156:159], a[92:95]
  s_mul_i32 s71, s71, s38
  s_lshl_b32 s70, s70, 2
  v_mfma_f32_16x16x32_bf16 a[96:99], v[68:71], a[144:147], a[96:99]
  ds_read_b64_tr_b16 v[64:65], v9 offset:34912
  ds_read_b64_tr_b16 v[66:67], v9 offset:39520
  v_mfma_f32_16x16x32_bf16 a[100:103], v[68:71], a[148:151], a[100:103]
  s_add_u32 s70, s70, s71
  s_lshl_b32 s80, s70, 12
  v_mfma_f32_16x16x32_bf16 a[104:107], v[68:71], a[152:155], a[104:107]
  s_add_u32 s70, s70, s3
  s_mul_i32 s88, s70, 36864
  v_mfma_f32_16x16x32_bf16 a[108:111], v[68:71], a[156:159], a[108:111]
  s_xor_b32 s70, s37, 1
  s_waitcnt lgkmcnt(6)
  v_mfma_f32_16x16x32_bf16 a[112:115], v[48:51], a[144:147], a[112:115]
  ds_read_b64_tr_b16 v[68:69], v9 offset:34944
  ds_read_b64_tr_b16 v[70:71], v9 offset:39552
  v_mfma_f32_16x16x32_bf16 a[116:119], v[48:51], a[148:151], a[116:119]
  s_add_u32 s71, s70, 1
  s_lshr_b32 s71, s71, 1
  v_mfma_f32_16x16x32_bf16 a[120:123], v[48:51], a[152:155], a[120:123]
  s_mul_i32 s71, s71, s38
  s_lshl_b32 s70, s70, 2
  v_mfma_f32_16x16x32_bf16 a[124:127], v[48:51], a[156:159], a[124:127]
  s_add_u32 s70, s70, s71
  v_mfma_f32_16x16x32_bf16 v[112:115], v[52:55], a[160:163], v[112:115]
  ds_read_b64_tr_b16 v[48:49], v9 offset:34976
  ds_read_b64_tr_b16 v[50:51], v9 offset:39584
  v_mfma_f32_16x16x32_bf16 v[116:119], v[52:55], a[164:167], v[116:119]
  s_lshl_b32 s81, s70, 12
  s_add_u32 s70, s70, s3
  v_mfma_f32_16x16x32_bf16 v[120:123], v[52:55], a[168:171], v[120:123]
  buffer_load_dword v73, v72, s[72:75], 0 offen
  v_mfma_f32_16x16x32_bf16 v[124:127], v[52:55], a[172:175], v[124:127]
  s_mul_i32 s89, s70, 36864
  s_waitcnt lgkmcnt(6)
  v_mfma_f32_16x16x32_bf16 v[128:131], v[56:59], a[160:163], v[128:131]
  ds_read_b64_tr_b16 v[52:53], v9 offset:35008
  ds_read_b64_tr_b16 v[54:55], v9 offset:39616
  v_mfma_f32_16x16x32_bf16 v[132:135], v[56:59], a[164:167], v[132:135]
  s_xor_b32 s70, s37, 2
  s_add_u32 s71, s70, 1
  v_mfma_f32_16x16x32_bf16 v[136:139], v[56:59], a[168:171], v[136:139]
  s_mov_b32 s4, 8192
  s_lshr_b32 s71, s71, 1
  v_mfma_f32_16x16x32_bf16 v[140:143], v[56:59], a[172:175], v[140:143]
  s_mul_i32 s71, s71, s38
  s_lshl_b32 s70, s70, 2
  v_mfma_f32_16x16x32_bf16 v[144:147], v[60:63], a[160:163], v[144:147]
  ds_read_b64_tr_b16 v[56:57], v9 offset:35040
  ds_read_b64_tr_b16 v[58:59], v9 offset:39648
  v_mfma_f32_16x16x32_bf16 v[148:151], v[60:63], a[164:167], v[148:151]
  s_add_u32 s70, s70, s71
  s_lshl_b32 s82, s70, 12
  v_mfma_f32_16x16x32_bf16 v[152:155], v[60:63], a[168:171], v[152:155]
  buffer_load_dword v73, v72, s[72:75], s4 offen
  v_mfma_f32_16x16x32_bf16 v[156:159], v[60:63], a[172:175], v[156:159]
  s_add_u32 s70, s70, s3
  s_waitcnt lgkmcnt(6)
  v_mfma_f32_16x16x32_bf16 v[160:163], v[64:67], a[160:163], v[160:163]
  ds_read_b64_tr_b16 v[60:61], v9 offset:35072
  ds_read_b64_tr_b16 v[62:63], v9 offset:39680
  v_mfma_f32_16x16x32_bf16 v[164:167], v[64:67], a[164:167], v[164:167]
  s_mul_i32 s90, s70, 36864
  s_xor_b32 s70, s37, 3
  v_mfma_f32_16x16x32_bf16 v[168:171], v[64:67], a[168:171], v[168:171]
  s_add_u32 s71, s70, 1
  s_lshr_b32 s71, s71, 1
  v_mfma_f32_16x16x32_bf16 v[172:175], v[64:67], a[172:175], v[172:175]
  s_mul_i32 s71, s71, s38
  s_lshl_b32 s70, s70, 2
  v_mfma_f32_16x16x32_bf16 v[176:179], v[68:71], a[160:163], v[176:179]
  ds_read_b64_tr_b16 v[64:65], v1 offset:34816
  ds_read_b64_tr_b16 v[66:67], v1 offset:38912
  v_mfma_f32_16x16x32_bf16 v[180:183], v[68:71], a[164:167], v[180:183]
  s_add_u32 s70, s70, s71
  s_lshl_b32 s83, s70, 12
  v_mfma_f32_16x16x32_bf16 v[184:187], v[68:71], a[168:171], v[184:187]
  s_add_u32 s70, s70, s3
  s_mul_i32 s91, s70, 36864
  v_mfma_f32_16x16x32_bf16 v[188:191], v[68:71], a[172:175], v[188:191]
  s_and_b32 s36, s3, 1
  s_waitcnt lgkmcnt(6)
  v_mfma_f32_16x16x32_bf16 v[192:195], v[48:51], a[160:163], v[192:195]
  ds_read_b64_tr_b16 v[68:69], v1 offset:34824
  ds_read_b64_tr_b16 v[70:71], v1 offset:38920
  v_mfma_f32_16x16x32_bf16 v[196:199], v[48:51], a[164:167], v[196:199]
  s_mul_i32 s36, s36, 36864
  s_add_u32 s70, s77, 0
  v_mfma_f32_16x16x32_bf16 v[200:203], v[48:51], a[168:171], v[200:203]
  s_add_u32 s71, s78, 0
  v_mfma_f32_16x16x32_bf16 v[204:207], v[48:51], a[172:175], v[204:207]
  s_cmp_lt_u32 s3, 2
  s_cselect_b32 s70, s70, s71
  v_mfma_f32_16x16x32_bf16 v[208:211], v[52:55], a[160:163], v[208:211]
  ds_read_b64_tr_b16 v[48:49], v2 offset:34816
  ds_read_b64_tr_b16 v[50:51], v2 offset:38912
  v_mfma_f32_16x16x32_bf16 v[212:215], v[52:55], a[164:167], v[212:215]
  s_mul_i32 s70, s70, 9
  s_add_u32 s70, s70, s36
  v_mfma_f32_16x16x32_bf16 v[216:219], v[52:55], a[168:171], v[216:219]
  s_cmp_eq_u32 s38, 0
  s_cselect_b32 s85, s70, s85
  v_mfma_f32_16x16x32_bf16 v[220:223], v[52:55], a[172:175], v[220:223]
  s_add_u32 s70, s79, 0
  s_waitcnt lgkmcnt(6)
  v_mfma_f32_16x16x32_bf16 v[224:227], v[56:59], a[160:163], v[224:227]
  ds_read_b64_tr_b16 v[52:53], v2 offset:34824
  ds_read_b64_tr_b16 v[54:55], v2 offset:38920
  v_mfma_f32_16x16x32_bf16 v[228:231], v[56:59], a[164:167], v[228:231]
  s_add_u32 s71, s80, 0
  v_mfma_f32_16x16x32_bf16 v[232:235], v[56:59], a[168:171], v[232:235]
  s_cmp_lt_u32 s3, 2
  s_cselect_b32 s70, s70, s71
  v_mfma_f32_16x16x32_bf16 v[236:239], v[56:59], a[172:175], v[236:239]
  s_mul_i32 s70, s70, 9
  s_add_u32 s70, s70, s36
  v_mfma_f32_16x16x32_bf16 v[240:243], v[60:63], a[160:163], v[240:243]
  ds_read_b64_tr_b16 v[56:57], v3 offset:34816
  ds_read_b64_tr_b16 v[58:59], v3 offset:38912
  v_mfma_f32_16x16x32_bf16 v[244:247], v[60:63], a[164:167], v[244:247]
  s_cmp_eq_u32 s38, 0
  s_cselect_b32 s86, s70, s86
  v_mfma_f32_16x16x32_bf16 v[248:251], v[60:63], a[168:171], v[248:251]
  s_add_u32 s70, s81, 0
  s_add_u32 s71, s82, 0
  v_mfma_f32_16x16x32_bf16 v[252:255], v[60:63], a[172:175], v[252:255]
  s_waitcnt lgkmcnt(6)
  v_mfma_f32_16x16x32_bf16 a[0:3], v[64:67], a[160:163], a[0:3]
  ds_read_b64_tr_b16 v[60:61], v3 offset:34824
  ds_read_b64_tr_b16 v[62:63], v3 offset:38920
  v_mfma_f32_16x16x32_bf16 a[4:7], v[64:67], a[164:167], a[4:7]
  s_cmp_lt_u32 s3, 2
  s_cselect_b32 s70, s70, s71
  v_mfma_f32_16x16x32_bf16 a[8:11], v[64:67], a[168:171], a[8:11]
  s_mul_i32 s70, s70, 9
  s_add_u32 s70, s70, s36
  v_mfma_f32_16x16x32_bf16 a[12:15], v[64:67], a[172:175], a[12:15]
  s_cmp_eq_u32 s38, 0
  s_cselect_b32 s87, s70, s87
  v_mfma_f32_16x16x32_bf16 a[16:19], v[68:71], a[160:163], a[16:19]
  ds_read_b64_tr_b16 v[64:65], v4 offset:34816
  ds_read_b64_tr_b16 v[66:67], v4 offset:38912
  v_mfma_f32_16x16x32_bf16 a[20:23], v[68:71], a[164:167], a[20:23]
  s_add_u32 s70, s83, 0
  s_add_u32 s71, s77, 8192
  v_mfma_f32_16x16x32_bf16 a[24:27], v[68:71], a[168:171], a[24:27]
  s_cmp_lt_u32 s3, 2
  s_cselect_b32 s70, s70, s71
  v_mfma_f32_16x16x32_bf16 a[28:31], v[68:71], a[172:175], a[28:31]
  s_mul_i32 s70, s70, 9
  s_waitcnt lgkmcnt(6)
  v_mfma_f32_16x16x32_bf16 a[32:35], v[48:51], a[160:163], a[32:35]
  ds_read_b64_tr_b16 v[68:69], v4 offset:34824
  ds_read_b64_tr_b16 v[70:71], v4 offset:38920
  v_mfma_f32_16x16x32_bf16 a[36:39], v[48:51], a[164:167], a[36:39]
  s_add_u32 s70, s70, s36
  v_mfma_f32_16x16x32_bf16 a[40:43], v[48:51], a[168:171], a[40:43]
  s_cmp_eq_u32 s38, 0
  s_cselect_b32 s88, s70, s88
  v_mfma_f32_16x16x32_bf16 a[44:47], v[48:51], a[172:175], a[44:47]
  s_add_u32 s70, s78, 8192
  s_add_u32 s71, s79, 8192
  v_mfma_f32_16x16x32_bf16 a[48:51], v[52:55], a[160:163], a[48:51]
  s_cmp_lt_u32 s3, 2
  s_cselect_b32 s70, s70, s71
  v_mfma_f32_16x16x32_bf16 a[52:55], v[52:55], a[164:167], a[52:55]
  s_mul_i32 s70, s70, 9
  s_add_u32 s70, s70, s36
  v_mfma_f32_16x16x32_bf16 a[56:59], v[52:55], a[168:171], a[56:59]
  s_cmp_eq_u32 s38, 0
  s_cselect_b32 s89, s70, s89
  v_mfma_f32_16x16x32_bf16 a[60:63], v[52:55], a[172:175], a[60:63]
  s_add_u32 s70, s80, 8192
  s_waitcnt lgkmcnt(4)
  v_mfma_f32_16x16x32_bf16 a[64:67], v[56:59], a[160:163], a[64:67]
  s_add_u32 s71, s81, 8192
  v_mfma_f32_16x16x32_bf16 a[68:71], v[56:59], a[164:167], a[68:71]
  s_cmp_lt_u32 s3, 2
  s_cselect_b32 s70, s70, s71
  v_mfma_f32_16x16x32_bf16 a[72:75], v[56:59], a[168:171], a[72:75]
  s_mul_i32 s70, s70, 9
  s_add_u32 s70, s70, s36
  v_mfma_f32_16x16x32_bf16 a[76:79], v[56:59], a[172:175], a[76:79]
  s_cmp_eq_u32 s38, 0
  s_cselect_b32 s90, s70, s90
  v_mfma_f32_16x16x32_bf16 a[80:83], v[60:63], a[160:163], a[80:83]
  s_add_u32 s70, s82, 8192
  s_add_u32 s71, s83, 8192
  v_mfma_f32_16x16x32_bf16 a[84:87], v[60:63], a[164:167], a[84:87]
  s_cmp_lt_u32 s3, 2
  s_cselect_b32 s70, s70, s71
  v_mfma_f32_16x16x32_bf16 a[88:91], v[60:63], a[168:171], a[88:91]
  s_mul_i32 s70, s70, 9
  s_add_u32 s70, s70, s36
  v_mfma_f32_16x16x32_bf16 a[92:95], v[60:63], a[172:175], a[92:95]
  s_waitcnt lgkmcnt(0)
  v_mfma_f32_16x16x32_bf16 a[96:99], v[64:67], a[160:163], a[96:99]
  s_cmp_eq_u32 s38, 0
  s_cselect_b32 s91, s70, s91
  v_mfma_f32_16x16x32_bf16 a[100:103], v[64:67], a[164:167], a[100:103]
  s_mul_i32 s93, s3, 331776
  s_add_u32 s93, s93, 147456
  v_mfma_f32_16x16x32_bf16 a[104:107], v[64:67], a[168:171], a[104:107]
  s_mul_i32 s40, s3, 9216
  s_add_u32 s41, s40, 139264
  v_mfma_f32_16x16x32_bf16 a[108:111], v[64:67], a[172:175], a[108:111]
  s_add_u32 s70, s40, 18432
  s_cmp_lt_u32 s3, 2
  s_cselect_b32 s41, s41, s70
  v_mfma_f32_16x16x32_bf16 a[112:115], v[68:71], a[160:163], a[112:115]
  v_mfma_f32_16x16x32_bf16 a[116:119], v[68:71], a[164:167], a[116:119]
  v_mfma_f32_16x16x32_bf16 a[120:123], v[68:71], a[168:171], a[120:123]
  v_mfma_f32_16x16x32_bf16 a[124:127], v[68:71], a[172:175], a[124:127]
L_g1_done:
  s_nop 7
  v_exp_f32_e64 v38, -v112
  v_exp_f32_e64 v39, -v113
  v_exp_f32_e64 v40, -v114
  v_exp_f32_e64 v41, -v115
  v_exp_f32_e64 v42, -v128
  v_exp_f32_e64 v43, -v129
  v_exp_f32_e64 v44, -v130
  v_exp_f32_e64 v45, -v131
  v_pk_add_f32 v[38:39], v[38:39], 1.0 op_sel_hi:[1,0]
  v_pk_add_f32 v[40:41], v[40:41], 1.0 op_sel_hi:[1,0]
  v_pk_add_f32 v[42:43], v[42:43], 1.0 op_sel_hi:[1,0]
  v_pk_add_f32 v[44:45], v[44:45], 1.0 op_sel_hi:[1,0]
  v_rcp_f32 v38, v38
  v_rcp_f32 v39, v39
  v_rcp_f32 v40, v40
  v_rcp_f32 v41, v41
  v_rcp_f32 v42, v42
  v_rcp_f32 v43, v43
  v_rcp_f32 v44, v44
  v_rcp_f32 v45, v45
  v_pk_mul_f32 v[112:113], v[112:113], v[38:39]
  v_pk_mul_f32 v[114:115], v[114:115], v[40:41]
  v_pk_mul_f32 v[128:129], v[128:129], v[42:43]
  v_pk_mul_f32 v[130:131], v[130:131], v[44:45]
  v_cvt_pk_bf16_f32 v38, v112, v113
  v_cvt_pk_bf16_f32 v39, v114, v115
  v_cvt_pk_bf16_f32 v40, v128, v129
  v_cvt_pk_bf16_f32 v41, v130, v131
  v_accvgpr_write_b32 a144, v38
  v_accvgpr_write_b32 a145, v39
  v_accvgpr_write_b32 a146, v40
  v_accvgpr_write_b32 a147, v41
  v_exp_f32_e64 v38, -v116
  v_exp_f32_e64 v39, -v117
  v_exp_f32_e64 v40, -v118
  v_exp_f32_e64 v41, -v119
  v_exp_f32_e64 v42, -v132
  v_exp_f32_e64 v43, -v133
  v_exp_f32_e64 v44, -v134
  v_exp_f32_e64 v45, -v135
  v_pk_add_f32 v[38:39], v[38:39], 1.0 op_sel_hi:[1,0]
  v_pk_add_f32 v[40:41], v[40:41], 1.0 op_sel_hi:[1,0]
  v_pk_add_f32 v[42:43], v[42:43], 1.0 op_sel_hi:[1,0]
  v_pk_add_f32 v[44:45], v[44:45], 1.0 op_sel_hi:[1,0]
  v_rcp_f32 v38, v38
  v_rcp_f32 v39, v39
  v_rcp_f32 v40, v40
  v_rcp_f32 v41, v41
  v_rcp_f32 v42, v42
  v_rcp_f32 v43, v43
  v_rcp_f32 v44, v44
  v_rcp_f32 v45, v45
  v_pk_mul_f32 v[116:117], v[116:117], v[38:39]
  v_pk_mul_f32 v[118:119], v[118:119], v[40:41]
  v_pk_mul_f32 v[132:133], v[132:133], v[42:43]
  v_pk_mul_f32 v[134:135], v[134:135], v[44:45]
  v_cvt_pk_bf16_f32 v38, v116, v117
  v_cvt_pk_bf16_f32 v39, v118, v119
  v_cvt_pk_bf16_f32 v40, v132, v133
  v_cvt_pk_bf16_f32 v41, v134, v135
  v_accvgpr_write_b32 a148, v38
  v_accvgpr_write_b32 a149, v39
  v_accvgpr_write_b32 a150, v40
  v_accvgpr_write_b32 a151, v41
  v_exp_f32_e64 v38, -v120
  v_exp_f32_e64 v39, -v121
  v_exp_f32_e64 v40, -v122
  v_exp_f32_e64 v41, -v123
  v_exp_f32_e64 v42, -v136
  v_exp_f32_e64 v43, -v137
  v_exp_f32_e64 v44, -v138
  v_exp_f32_e64 v45, -v139
  v_pk_add_f32 v[38:39], v[38:39], 1.0 op_sel_hi:[1,0]
  v_pk_add_f32 v[40:41], v[40:41], 1.0 op_sel_hi:[1,0]
  v_pk_add_f32 v[42:43], v[42:43], 1.0 op_sel_hi:[1,0]
  v_pk_add_f32 v[44:45], v[44:45], 1.0 op_sel_hi:[1,0]
  v_rcp_f32 v38, v38
  v_rcp_f32 v39, v39
  v_rcp_f32 v40, v40
  v_rcp_f32 v41, v41
  v_rcp_f32 v42, v42
  v_rcp_f32 v43, v43
  v_rcp_f32 v44, v44
  v_rcp_f32 v45, v45
  v_pk_mul_f32 v[120:121], v[120:121], v[38:39]
  v_pk_mul_f32 v[122:123], v[122:123], v[40:41]
  v_pk_mul_f32 v[136:137], v[136:137], v[42:43]
  v_pk_mul_f32 v[138:139], v[138:139], v[44:45]
  v_cvt_pk_bf16_f32 v38, v120, v121
  v_cvt_pk_bf16_f32 v39, v122, v123
  v_cvt_pk_bf16_f32 v40, v136, v137
  v_cvt_pk_bf16_f32 v41, v138, v139
  v_accvgpr_write_b32 a152, v38
  v_accvgpr_write_b32 a153, v39
  v_accvgpr_write_b32 a154, v40
  v_accvgpr_write_b32 a155, v41
  v_exp_f32_e64 v38, -v124
  v_exp_f32_e64 v39, -v125
  v_exp_f32_e64 v40, -v126
  v_exp_f32_e64 v41, -v127
  v_exp_f32_e64 v42, -v140
  v_exp_f32_e64 v43, -v141
  v_exp_f32_e64 v44, -v142
  v_exp_f32_e64 v45, -v143
  v_pk_add_f32 v[38:39], v[38:39], 1.0 op_sel_hi:[1,0]
  v_pk_add_f32 v[40:41], v[40:41], 1.0 op_sel_hi:[1,0]
  v_pk_add_f32 v[42:43], v[42:43], 1.0 op_sel_hi:[1,0]
  v_pk_add_f32 v[44:45], v[44:45], 1.0 op_sel_hi:[1,0]
  v_rcp_f32 v38, v38
  v_rcp_f32 v39, v39
  v_rcp_f32 v40, v40
  v_rcp_f32 v41, v41
  v_rcp_f32 v42, v42
  v_rcp_f32 v43, v43
  v_rcp_f32 v44, v44
  v_rcp_f32 v45, v45
  v_pk_mul_f32 v[124:125], v[124:125], v[38:39]
  v_pk_mul_f32 v[126:127], v[126:127], v[40:41]
  v_pk_mul_f32 v[140:141], v[140:141], v[42:43]
  v_pk_mul_f32 v[142:143], v[142:143], v[44:45]
  v_cvt_pk_bf16_f32 v38, v124, v125
  v_cvt_pk_bf16_f32 v39, v126, v127
  v_cvt_pk_bf16_f32 v40, v140, v141
  v_cvt_pk_bf16_f32 v41, v142, v143
  v_accvgpr_write_b32 a156, v38
  v_accvgpr_write_b32 a157, v39
  v_accvgpr_write_b32 a158, v40
  v_accvgpr_write_b32 a159, v41
  v_exp_f32_e64 v38, -v144
  v_exp_f32_e64 v39, -v145
  v_exp_f32_e64 v40, -v146
  v_exp_f32_e64 v41, -v147
  v_exp_f32_e64 v42, -v160
  v_exp_f32_e64 v43, -v161
  v_exp_f32_e64 v44, -v162
  v_exp_f32_e64 v45, -v163
  v_pk_add_f32 v[38:39], v[38:39], 1.0 op_sel_hi:[1,0]
  v_pk_add_f32 v[40:41], v[40:41], 1.0 op_sel_hi:[1,0]
  v_pk_add_f32 v[42:43], v[42:43], 1.0 op_sel_hi:[1,0]
  v_pk_add_f32 v[44:45], v[44:45], 1.0 op_sel_hi:[1,0]
  v_rcp_f32 v38, v38
  v_rcp_f32 v39, v39
  v_rcp_f32 v40, v40
  v_rcp_f32 v41, v41
  v_rcp_f32 v42, v42
  v_rcp_f32 v43, v43
  v_rcp_f32 v44, v44
  v_rcp_f32 v45, v45
  v_pk_mul_f32 v[144:145], v[144:145], v[38:39]
  v_pk_mul_f32 v[146:147], v[146:147], v[40:41]
  v_pk_mul_f32 v[160:161], v[160:161], v[42:43]
  v_pk_mul_f32 v[162:163], v[162:163], v[44:45]
  v_cvt_pk_bf16_f32 v38, v144, v145
  v_cvt_pk_bf16_f32 v39, v146, v147
  v_cvt_pk_bf16_f32 v40, v160, v161
  v_cvt_pk_bf16_f32 v41, v162, v163
  v_accvgpr_write_b32 a160, v38
  v_accvgpr_write_b32 a161, v39
  v_accvgpr_write_b32 a162, v40
  v_accvgpr_write_b32 a163, v41
  v_exp_f32_e64 v38, -v148
  v_exp_f32_e64 v39, -v149
  v_exp_f32_e64 v40, -v150
  v_exp_f32_e64 v41, -v151
  v_exp_f32_e64 v42, -v164
  v_exp_f32_e64 v43, -v165
  v_exp_f32_e64 v44, -v166
  v_exp_f32_e64 v45, -v167
  v_pk_add_f32 v[38:39], v[38:39], 1.0 op_sel_hi:[1,0]
  v_pk_add_f32 v[40:41], v[40:41], 1.0 op_sel_hi:[1,0]
  v_pk_add_f32 v[42:43], v[42:43], 1.0 op_sel_hi:[1,0]
  v_pk_add_f32 v[44:45], v[44:45], 1.0 op_sel_hi:[1,0]
  v_rcp_f32 v38, v38
  v_rcp_f32 v39, v39
  v_rcp_f32 v40, v40
  v_rcp_f32 v41, v41
  v_rcp_f32 v42, v42
  v_rcp_f32 v43, v43
  v_rcp_f32 v44, v44
  v_rcp_f32 v45, v45
  v_pk_mul_f32 v[148:149], v[148:149], v[38:39]
  v_pk_mul_f32 v[150:151], v[150:151], v[40:41]
  v_pk_mul_f32 v[164:165], v[164:165], v[42:43]
  v_pk_mul_f32 v[166:167], v[166:167], v[44:45]
  v_cvt_pk_bf16_f32 v38, v148, v149
  v_cvt_pk_bf16_f32 v39, v150, v151
  v_cvt_pk_bf16_f32 v40, v164, v165
  v_cvt_pk_bf16_f32 v41, v166, v167
  v_accvgpr_write_b32 a164, v38
  v_accvgpr_write_b32 a165, v39
  v_accvgpr_write_b32 a166, v40
  v_accvgpr_write_b32 a167, v41
  v_exp_f32_e64 v38, -v152
  v_exp_f32_e64 v39, -v153
  v_exp_f32_e64 v40, -v154
  v_exp_f32_e64 v41, -v155
  v_exp_f32_e64 v42, -v168
  v_exp_f32_e64 v43, -v169
  v_exp_f32_e64 v44, -v170
  v_exp_f32_e64 v45, -v171
  v_pk_add_f32 v[38:39], v[38:39], 1.0 op_sel_hi:[1,0]
  v_pk_add_f32 v[40:41], v[40:41], 1.0 op_sel_hi:[1,0]
  v_pk_add_f32 v[42:43], v[42:43], 1.0 op_sel_hi:[1,0]
  v_pk_add_f32 v[44:45], v[44:45], 1.0 op_sel_hi:[1,0]
  v_rcp_f32 v38, v38
  v_rcp_f32 v39, v39
  v_rcp_f32 v40, v40
  v_rcp_f32 v41, v41
  v_rcp_f32 v42, v42
  v_rcp_f32 v43, v43
  v_rcp_f32 v44, v44
  v_rcp_f32 v45, v45
  v_pk_mul_f32 v[152:153], v[152:153], v[38:39]
  v_pk_mul_f32 v[154:155], v[154:155], v[40:41]
  v_pk_mul_f32 v[168:169], v[168:169], v[42:43]
  v_pk_mul_f32 v[170:171], v[170:171], v[44:45]
  v_cvt_pk_bf16_f32 v38, v152, v153
  v_cvt_pk_bf16_f32 v39, v154, v155
  v_cvt_pk_bf16_f32 v40, v168, v169
  v_cvt_pk_bf16_f32 v41, v170, v171
  v_accvgpr_write_b32 a168, v38
  v_accvgpr_write_b32 a169, v39
  v_accvgpr_write_b32 a170, v40
  v_accvgpr_write_b32 a171, v41
  v_exp_f32_e64 v38, -v156
  v_exp_f32_e64 v39, -v157
  v_exp_f32_e64 v40, -v158
  v_exp_f32_e64 v41, -v159
  v_exp_f32_e64 v42, -v172
  v_exp_f32_e64 v43, -v173
  v_exp_f32_e64 v44, -v174
  v_exp_f32_e64 v45, -v175
  v_pk_add_f32 v[38:39], v[38:39], 1.0 op_sel_hi:[1,0]
  v_pk_add_f32 v[40:41], v[40:41], 1.0 op_sel_hi:[1,0]
  v_pk_add_f32 v[42:43], v[42:43], 1.0 op_sel_hi:[1,0]
  v_pk_add_f32 v[44:45], v[44:45], 1.0 op_sel_hi:[1,0]
  v_rcp_f32 v38, v38
  v_rcp_f32 v39, v39
  v_rcp_f32 v40, v40
  v_rcp_f32 v41, v41
  v_rcp_f32 v42, v42
  v_rcp_f32 v43, v43
  v_rcp_f32 v44, v44
  v_rcp_f32 v45, v45
  v_pk_mul_f32 v[156:157], v[156:157], v[38:39]
  v_pk_mul_f32 v[158:159], v[158:159], v[40:41]
  v_pk_mul_f32 v[172:173], v[172:173], v[42:43]
  v_pk_mul_f32 v[174:175], v[174:175], v[44:45]
  v_cvt_pk_bf16_f32 v38, v156, v157
  v_cvt_pk_bf16_f32 v39, v158, v159
  v_cvt_pk_bf16_f32 v40, v172, v173
  v_cvt_pk_bf16_f32 v41, v174, v175
  v_accvgpr_write_b32 a172, v38
  v_accvgpr_write_b32 a173, v39
  v_accvgpr_write_b32 a174, v40
  v_accvgpr_write_b32 a175, v41
  v_exp_f32_e64 v38, -v176
  v_exp_f32_e64 v39, -v177
  v_exp_f32_e64 v40, -v178
  v_exp_f32_e64 v41, -v179
  v_exp_f32_e64 v42, -v192
  v_exp_f32_e64 v43, -v193
  v_exp_f32_e64 v44, -v194
  v_exp_f32_e64 v45, -v195
  v_pk_add_f32 v[38:39], v[38:39], 1.0 op_sel_hi:[1,0]
  v_pk_add_f32 v[40:41], v[40:41], 1.0 op_sel_hi:[1,0]
  v_pk_add_f32 v[42:43], v[42:43], 1.0 op_sel_hi:[1,0]
  v_pk_add_f32 v[44:45], v[44:45], 1.0 op_sel_hi:[1,0]
  v_rcp_f32 v38, v38
  v_rcp_f32 v39, v39
  v_rcp_f32 v40, v40
  v_rcp_f32 v41, v41
  v_rcp_f32 v42, v42
  v_rcp_f32 v43, v43
  v_rcp_f32 v44, v44
  v_rcp_f32 v45, v45
  v_pk_mul_f32 v[176:177], v[176:177], v[38:39]
  v_pk_mul_f32 v[178:179], v[178:179], v[40:41]
  v_pk_mul_f32 v[192:193], v[192:193], v[42:43]
  v_pk_mul_f32 v[194:195], v[194:195], v[44:45]
  v_cvt_pk_bf16_f32 v38, v176, v177
  v_cvt_pk_bf16_f32 v39, v178, v179
  v_cvt_pk_bf16_f32 v40, v192, v193
  v_cvt_pk_bf16_f32 v41, v194, v195
  v_accvgpr_write_b32 a176, v38
  v_accvgpr_write_b32 a177, v39
  v_accvgpr_write_b32 a178, v40
  v_accvgpr_write_b32 a179, v41
  v_exp_f32_e64 v38, -v180
  v_exp_f32_e64 v39, -v181
  v_exp_f32_e64 v40, -v182
  v_exp_f32_e64 v41, -v183
  v_exp_f32_e64 v42, -v196
  v_exp_f32_e64 v43, -v197
  v_exp_f32_e64 v44, -v198
  v_exp_f32_e64 v45, -v199
  v_pk_add_f32 v[38:39], v[38:39], 1.0 op_sel_hi:[1,0]
  v_pk_add_f32 v[40:41], v[40:41], 1.0 op_sel_hi:[1,0]
  v_pk_add_f32 v[42:43], v[42:43], 1.0 op_sel_hi:[1,0]
  v_pk_add_f32 v[44:45], v[44:45], 1.0 op_sel_hi:[1,0]
  v_rcp_f32 v38, v38
  v_rcp_f32 v39, v39
  v_rcp_f32 v40, v40
  v_rcp_f32 v41, v41
  v_rcp_f32 v42, v42
  v_rcp_f32 v43, v43
  v_rcp_f32 v44, v44
  v_rcp_f32 v45, v45
  v_pk_mul_f32 v[180:181], v[180:181], v[38:39]
  v_pk_mul_f32 v[182:183], v[182:183], v[40:41]
  v_pk_mul_f32 v[196:197], v[196:197], v[42:43]
  v_pk_mul_f32 v[198:199], v[198:199], v[44:45]
  v_cvt_pk_bf16_f32 v38, v180, v181
  v_cvt_pk_bf16_f32 v39, v182, v183
  v_cvt_pk_bf16_f32 v40, v196, v197
  v_cvt_pk_bf16_f32 v41, v198, v199
  v_accvgpr_write_b32 a180, v38
  v_accvgpr_write_b32 a181, v39
  v_accvgpr_write_b32 a182, v40
  v_accvgpr_write_b32 a183, v41
  v_exp_f32_e64 v38, -v184
  v_exp_f32_e64 v39, -v185
  v_exp_f32_e64 v40, -v186
  v_exp_f32_e64 v41, -v187
  v_exp_f32_e64 v42, -v200
  v_exp_f32_e64 v43, -v201
  v_exp_f32_e64 v44, -v202
  v_exp_f32_e64 v45, -v203
  v_pk_add_f32 v[38:39], v[38:39], 1.0 op_sel_hi:[1,0]
  v_pk_add_f32 v[40:41], v[40:41], 1.0 op_sel_hi:[1,0]
  v_pk_add_f32 v[42:43], v[42:43], 1.0 op_sel_hi:[1,0]
  v_pk_add_f32 v[44:45], v[44:45], 1.0 op_sel_hi:[1,0]
  v_rcp_f32 v38, v38
  v_rcp_f32 v39, v39
  v_rcp_f32 v40, v40
  v_rcp_f32 v41, v41
  v_rcp_f32 v42, v42
  v_rcp_f32 v43, v43
  v_rcp_f32 v44, v44
  v_rcp_f32 v45, v45
  v_pk_mul_f32 v[184:185], v[184:185], v[38:39]
  v_pk_mul_f32 v[186:187], v[186:187], v[40:41]
  v_pk_mul_f32 v[200:201], v[200:201], v[42:43]
  v_pk_mul_f32 v[202:203], v[202:203], v[44:45]
  v_cvt_pk_bf16_f32 v38, v184, v185
  v_cvt_pk_bf16_f32 v39, v186, v187
  v_cvt_pk_bf16_f32 v40, v200, v201
  v_cvt_pk_bf16_f32 v41, v202, v203
  v_accvgpr_write_b32 a184, v38
  v_accvgpr_write_b32 a185, v39
  v_accvgpr_write_b32 a186, v40
  v_accvgpr_write_b32 a187, v41
  v_exp_f32_e64 v38, -v188
  v_exp_f32_e64 v39, -v189
  v_exp_f32_e64 v40, -v190
  v_exp_f32_e64 v41, -v191
  v_exp_f32_e64 v42, -v204
  v_exp_f32_e64 v43, -v205
  v_exp_f32_e64 v44, -v206
  v_exp_f32_e64 v45, -v207
  v_pk_add_f32 v[38:39], v[38:39], 1.0 op_sel_hi:[1,0]
  v_pk_add_f32 v[40:41], v[40:41], 1.0 op_sel_hi:[1,0]
  v_pk_add_f32 v[42:43], v[42:43], 1.0 op_sel_hi:[1,0]
  v_pk_add_f32 v[44:45], v[44:45], 1.0 op_sel_hi:[1,0]
  v_rcp_f32 v38, v38
  v_rcp_f32 v39, v39
  v_rcp_f32 v40, v40
  v_rcp_f32 v41, v41
  v_rcp_f32 v42, v42
  v_rcp_f32 v43, v43
  v_rcp_f32 v44, v44
  v_rcp_f32 v45, v45
  v_pk_mul_f32 v[188:189], v[188:189], v[38:39]
  v_pk_mul_f32 v[190:191], v[190:191], v[40:41]
  v_pk_mul_f32 v[204:205], v[204:205], v[42:43]
  v_pk_mul_f32 v[206:207], v[206:207], v[44:45]
  v_cvt_pk_bf16_f32 v38, v188, v189
  v_cvt_pk_bf16_f32 v39, v190, v191
  v_cvt_pk_bf16_f32 v40, v204, v205
  v_cvt_pk_bf16_f32 v41, v206, v207
  v_accvgpr_write_b32 a188, v38
  v_accvgpr_write_b32 a189, v39
  v_accvgpr_write_b32 a190, v40
  v_accvgpr_write_b32 a191, v41
  v_exp_f32_e64 v38, -v208
  v_exp_f32_e64 v39, -v209
  v_exp_f32_e64 v40, -v210
  v_exp_f32_e64 v41, -v211
  v_exp_f32_e64 v42, -v224
  v_exp_f32_e64 v43, -v225
  v_exp_f32_e64 v44, -v226
  v_exp_f32_e64 v45, -v227
  v_pk_add_f32 v[38:39], v[38:39], 1.0 op_sel_hi:[1,0]
  v_pk_add_f32 v[40:41], v[40:41], 1.0 op_sel_hi:[1,0]
  v_pk_add_f32 v[42:43], v[42:43], 1.0 op_sel_hi:[1,0]
  v_pk_add_f32 v[44:45], v[44:45], 1.0 op_sel_hi:[1,0]
  v_rcp_f32 v38, v38
  v_rcp_f32 v39, v39
  v_rcp_f32 v40, v40
  v_rcp_f32 v41, v41
  v_rcp_f32 v42, v42
  v_rcp_f32 v43, v43
  v_rcp_f32 v44, v44
  v_rcp_f32 v45, v45
  v_pk_mul_f32 v[208:209], v[208:209], v[38:39]
  v_pk_mul_f32 v[210:211], v[210:211], v[40:41]
  v_pk_mul_f32 v[224:225], v[224:225], v[42:43]
  v_pk_mul_f32 v[226:227], v[226:227], v[44:45]
  v_cvt_pk_bf16_f32 v38, v208, v209
  v_cvt_pk_bf16_f32 v39, v210, v211
  v_cvt_pk_bf16_f32 v40, v224, v225
  v_cvt_pk_bf16_f32 v41, v226, v227
  v_accvgpr_write_b32 a192, v38
  v_accvgpr_write_b32 a193, v39
  v_accvgpr_write_b32 a194, v40
  v_accvgpr_write_b32 a195, v41
  v_exp_f32_e64 v38, -v212
  v_exp_f32_e64 v39, -v213
  v_exp_f32_e64 v40, -v214
  v_exp_f32_e64 v41, -v215
  v_exp_f32_e64 v42, -v228
  v_exp_f32_e64 v43, -v229
  v_exp_f32_e64 v44, -v230
  v_exp_f32_e64 v45, -v231
  v_pk_add_f32 v[38:39], v[38:39], 1.0 op_sel_hi:[1,0]
  v_pk_add_f32 v[40:41], v[40:41], 1.0 op_sel_hi:[1,0]
  v_pk_add_f32 v[42:43], v[42:43], 1.0 op_sel_hi:[1,0]
  v_pk_add_f32 v[44:45], v[44:45], 1.0 op_sel_hi:[1,0]
  v_rcp_f32 v38, v38
  v_rcp_f32 v39, v39
  v_rcp_f32 v40, v40
  v_rcp_f32 v41, v41
  v_rcp_f32 v42, v42
  v_rcp_f32 v43, v43
  v_rcp_f32 v44, v44
  v_rcp_f32 v45, v45
  v_pk_mul_f32 v[212:213], v[212:213], v[38:39]
  v_pk_mul_f32 v[214:215], v[214:215], v[40:41]
  v_pk_mul_f32 v[228:229], v[228:229], v[42:43]
  v_pk_mul_f32 v[230:231], v[230:231], v[44:45]
  v_cvt_pk_bf16_f32 v38, v212, v213
  v_cvt_pk_bf16_f32 v39, v214, v215
  v_cvt_pk_bf16_f32 v40, v228, v229
  v_cvt_pk_bf16_f32 v41, v230, v231
  v_accvgpr_write_b32 a196, v38
  v_accvgpr_write_b32 a197, v39
  v_accvgpr_write_b32 a198, v40
  v_accvgpr_write_b32 a199, v41
  v_exp_f32_e64 v38, -v216
  v_exp_f32_e64 v39, -v217
  v_exp_f32_e64 v40, -v218
  v_exp_f32_e64 v41, -v219
  v_exp_f32_e64 v42, -v232
  v_exp_f32_e64 v43, -v233
  v_exp_f32_e64 v44, -v234
  v_exp_f32_e64 v45, -v235
  v_pk_add_f32 v[38:39], v[38:39], 1.0 op_sel_hi:[1,0]
  v_pk_add_f32 v[40:41], v[40:41], 1.0 op_sel_hi:[1,0]
  v_pk_add_f32 v[42:43], v[42:43], 1.0 op_sel_hi:[1,0]
  v_pk_add_f32 v[44:45], v[44:45], 1.0 op_sel_hi:[1,0]
  v_rcp_f32 v38, v38
  v_rcp_f32 v39, v39
  v_rcp_f32 v40, v40
  v_rcp_f32 v41, v41
  v_rcp_f32 v42, v42
  v_rcp_f32 v43, v43
  v_rcp_f32 v44, v44
  v_rcp_f32 v45, v45
  v_pk_mul_f32 v[216:217], v[216:217], v[38:39]
  v_pk_mul_f32 v[218:219], v[218:219], v[40:41]
  v_pk_mul_f32 v[232:233], v[232:233], v[42:43]
  v_pk_mul_f32 v[234:235], v[234:235], v[44:45]
  v_cvt_pk_bf16_f32 v38, v216, v217
  v_cvt_pk_bf16_f32 v39, v218, v219
  v_cvt_pk_bf16_f32 v40, v232, v233
  v_cvt_pk_bf16_f32 v41, v234, v235
  v_accvgpr_write_b32 a200, v38
  v_accvgpr_write_b32 a201, v39
  v_accvgpr_write_b32 a202, v40
  v_accvgpr_write_b32 a203, v41
  v_exp_f32_e64 v38, -v220
  v_exp_f32_e64 v39, -v221
  v_exp_f32_e64 v40, -v222
  v_exp_f32_e64 v41, -v223
  v_exp_f32_e64 v42, -v236
  v_exp_f32_e64 v43, -v237
  v_exp_f32_e64 v44, -v238
  v_exp_f32_e64 v45, -v239
  v_pk_add_f32 v[38:39], v[38:39], 1.0 op_sel_hi:[1,0]
  v_pk_add_f32 v[40:41], v[40:41], 1.0 op_sel_hi:[1,0]
  v_pk_add_f32 v[42:43], v[42:43], 1.0 op_sel_hi:[1,0]
  v_pk_add_f32 v[44:45], v[44:45], 1.0 op_sel_hi:[1,0]
  v_rcp_f32 v38, v38
  v_rcp_f32 v39, v39
  v_rcp_f32 v40, v40
  v_rcp_f32 v41, v41
  v_rcp_f32 v42, v42
  v_rcp_f32 v43, v43
  v_rcp_f32 v44, v44
  v_rcp_f32 v45, v45
  v_pk_mul_f32 v[220:221], v[220:221], v[38:39]
  v_pk_mul_f32 v[222:223], v[222:223], v[40:41]
  v_pk_mul_f32 v[236:237], v[236:237], v[42:43]
  v_pk_mul_f32 v[238:239], v[238:239], v[44:45]
  v_cvt_pk_bf16_f32 v38, v220, v221
  v_cvt_pk_bf16_f32 v39, v222, v223
  v_cvt_pk_bf16_f32 v40, v236, v237
  v_cvt_pk_bf16_f32 v41, v238, v239
  v_accvgpr_write_b32 a204, v38
  v_accvgpr_write_b32 a205, v39
  v_accvgpr_write_b32 a206, v40
  v_accvgpr_write_b32 a207, v41
  v_exp_f32_e64 v38, -v240
  v_exp_f32_e64 v39, -v241
  v_exp_f32_e64 v40, -v242
  v_exp_f32_e64 v41, -v243
  v_exp_f32_e64 v42, -v244
  v_exp_f32_e64 v43, -v245
  v_exp_f32_e64 v44, -v246
  v_exp_f32_e64 v45, -v247
  v_pk_add_f32 v[38:39], v[38:39], 1.0 op_sel_hi:[1,0]
  v_pk_add_f32 v[40:41], v[40:41], 1.0 op_sel_hi:[1,0]
  v_pk_add_f32 v[42:43], v[42:43], 1.0 op_sel_hi:[1,0]
  v_pk_add_f32 v[44:45], v[44:45], 1.0 op_sel_hi:[1,0]
  v_rcp_f32 v38, v38
  v_rcp_f32 v39, v39
  v_rcp_f32 v40, v40
  v_rcp_f32 v41, v41
  v_rcp_f32 v42, v42
  v_rcp_f32 v43, v43
  v_rcp_f32 v44, v44
  v_rcp_f32 v45, v45
  v_pk_mul_f32 v[240:241], v[240:241], v[38:39]
  v_pk_mul_f32 v[242:243], v[242:243], v[40:41]
  v_pk_mul_f32 v[244:245], v[244:245], v[42:43]
  v_pk_mul_f32 v[246:247], v[246:247], v[44:45]
  v_cvt_pk_bf16_f32 v38, v240, v241
  v_cvt_pk_bf16_f32 v39, v242, v243
  v_cvt_pk_bf16_f32 v40, v244, v245
  v_cvt_pk_bf16_f32 v41, v246, v247
  v_accvgpr_write_b32 a208, v38
  v_accvgpr_write_b32 a209, v39
  v_accvgpr_write_b32 a210, v40
  v_accvgpr_write_b32 a211, v41
  v_exp_f32_e64 v38, -v248
  v_exp_f32_e64 v39, -v249
  v_exp_f32_e64 v40, -v250
  v_exp_f32_e64 v41, -v251
  v_exp_f32_e64 v42, -v252
  v_exp_f32_e64 v43, -v253
  v_exp_f32_e64 v44, -v254
  v_exp_f32_e64 v45, -v255
  v_pk_add_f32 v[38:39], v[38:39], 1.0 op_sel_hi:[1,0]
  v_pk_add_f32 v[40:41], v[40:41], 1.0 op_sel_hi:[1,0]
  v_pk_add_f32 v[42:43], v[42:43], 1.0 op_sel_hi:[1,0]
  v_pk_add_f32 v[44:45], v[44:45], 1.0 op_sel_hi:[1,0]
  v_rcp_f32 v38, v38
  v_rcp_f32 v39, v39
  v_rcp_f32 v40, v40
  v_rcp_f32 v41, v41
  v_rcp_f32 v42, v42
  v_rcp_f32 v43, v43
  v_rcp_f32 v44, v44
  v_rcp_f32 v45, v45
  v_pk_mul_f32 v[248:249], v[248:249], v[38:39]
  v_pk_mul_f32 v[250:251], v[250:251], v[40:41]
  v_pk_mul_f32 v[252:253], v[252:253], v[42:43]
  v_pk_mul_f32 v[254:255], v[254:255], v[44:45]
  v_cvt_pk_bf16_f32 v38, v248, v249
  v_cvt_pk_bf16_f32 v39, v250, v251
  v_cvt_pk_bf16_f32 v40, v252, v253
  v_cvt_pk_bf16_f32 v41, v254, v255
  v_accvgpr_write_b32 a212, v38
  v_accvgpr_write_b32 a213, v39
  v_accvgpr_write_b32 a214, v40
  v_accvgpr_write_b32 a215, v41
  s_mov_b32 s70, 0x3db504f3
  s_mov_b32 s71, 0x3db504f3
  v_accvgpr_read_b32 v38, a0
  v_accvgpr_read_b32 v39, a1
  v_accvgpr_read_b32 v40, a2
  v_accvgpr_read_b32 v41, a3
  v_accvgpr_read_b32 v42, a16
  v_accvgpr_read_b32 v43, a17
  v_accvgpr_read_b32 v44, a18
  v_accvgpr_read_b32 v45, a19
  v_pk_mul_f32 v[38:39], v[38:39], s[70:71]
  v_pk_mul_f32 v[40:41], v[40:41], s[70:71]
  v_pk_mul_f32 v[42:43], v[42:43], s[70:71]
  v_pk_mul_f32 v[44:45], v[44:45], s[70:71]
  v_cvt_pk_bf16_f32 v80, v38, v39
  v_cvt_pk_bf16_f32 v81, v40, v41
  v_cvt_pk_bf16_f32 v82, v42, v43
  v_cvt_pk_bf16_f32 v83, v44, v45
  v_accvgpr_read_b32 v38, a4
  v_accvgpr_read_b32 v39, a5
  v_accvgpr_read_b32 v40, a6
  v_accvgpr_read_b32 v41, a7
  v_accvgpr_read_b32 v42, a20
  v_accvgpr_read_b32 v43, a21
  v_accvgpr_read_b32 v44, a22
  v_accvgpr_read_b32 v45, a23
  v_pk_mul_f32 v[38:39], v[38:39], s[70:71]
  v_pk_mul_f32 v[40:41], v[40:41], s[70:71]
  v_pk_mul_f32 v[42:43], v[42:43], s[70:71]
  v_pk_mul_f32 v[44:45], v[44:45], s[70:71]
  v_cvt_pk_bf16_f32 v84, v38, v39
  v_cvt_pk_bf16_f32 v85, v40, v41
  v_cvt_pk_bf16_f32 v86, v42, v43
  v_cvt_pk_bf16_f32 v87, v44, v45
  v_accvgpr_read_b32 v38, a8
  v_accvgpr_read_b32 v39, a9
  v_accvgpr_read_b32 v40, a10
  v_accvgpr_read_b32 v41, a11
  v_accvgpr_read_b32 v42, a24
  v_accvgpr_read_b32 v43, a25
  v_accvgpr_read_b32 v44, a26
  v_accvgpr_read_b32 v45, a27
  v_pk_mul_f32 v[38:39], v[38:39], s[70:71]
  v_pk_mul_f32 v[40:41], v[40:41], s[70:71]
  v_pk_mul_f32 v[42:43], v[42:43], s[70:71]
  v_pk_mul_f32 v[44:45], v[44:45], s[70:71]
  v_cvt_pk_bf16_f32 v88, v38, v39
  v_cvt_pk_bf16_f32 v89, v40, v41
  v_cvt_pk_bf16_f32 v90, v42, v43
  v_cvt_pk_bf16_f32 v91, v44, v45
  v_accvgpr_read_b32 v38, a12
  v_accvgpr_read_b32 v39, a13
  v_accvgpr_read_b32 v40, a14
  v_accvgpr_read_b32 v41, a15
  v_accvgpr_read_b32 v42, a28
  v_accvgpr_read_b32 v43, a29
  v_accvgpr_read_b32 v44, a30
  v_accvgpr_read_b32 v45, a31
  v_pk_mul_f32 v[38:39], v[38:39], s[70:71]
  v_pk_mul_f32 v[40:41], v[40:41], s[70:71]
  v_pk_mul_f32 v[42:43], v[42:43], s[70:71]
  v_pk_mul_f32 v[44:45], v[44:45], s[70:71]
  v_cvt_pk_bf16_f32 v92, v38, v39
  v_cvt_pk_bf16_f32 v93, v40, v41
  v_cvt_pk_bf16_f32 v94, v42, v43
  v_cvt_pk_bf16_f32 v95, v44, v45
  v_accvgpr_read_b32 v38, a32
  v_accvgpr_read_b32 v39, a33
  v_accvgpr_read_b32 v40, a34
  v_accvgpr_read_b32 v41, a35
  v_accvgpr_read_b32 v42, a48
  v_accvgpr_read_b32 v43, a49
  v_accvgpr_read_b32 v44, a50
  v_accvgpr_read_b32 v45, a51
  v_pk_mul_f32 v[38:39], v[38:39], s[70:71]
  v_pk_mul_f32 v[40:41], v[40:41], s[70:71]
  v_pk_mul_f32 v[42:43], v[42:43], s[70:71]
  v_pk_mul_f32 v[44:45], v[44:45], s[70:71]
  v_cvt_pk_bf16_f32 v96, v38, v39
  v_cvt_pk_bf16_f32 v97, v40, v41
  v_cvt_pk_bf16_f32 v98, v42, v43
  v_cvt_pk_bf16_f32 v99, v44, v45
  v_accvgpr_read_b32 v38, a36
  v_accvgpr_read_b32 v39, a37
  v_accvgpr_read_b32 v40, a38
  v_accvgpr_read_b32 v41, a39
  v_accvgpr_read_b32 v42, a52
  v_accvgpr_read_b32 v43, a53
  v_accvgpr_read_b32 v44, a54
  v_accvgpr_read_b32 v45, a55
  v_pk_mul_f32 v[38:39], v[38:39], s[70:71]
  v_pk_mul_f32 v[40:41], v[40:41], s[70:71]
  v_pk_mul_f32 v[42:43], v[42:43], s[70:71]
  v_pk_mul_f32 v[44:45], v[44:45], s[70:71]
  v_cvt_pk_bf16_f32 v100, v38, v39
  v_cvt_pk_bf16_f32 v101, v40, v41
  v_cvt_pk_bf16_f32 v102, v42, v43
  v_cvt_pk_bf16_f32 v103, v44, v45
  v_accvgpr_read_b32 v38, a40
  v_accvgpr_read_b32 v39, a41
  v_accvgpr_read_b32 v40, a42
  v_accvgpr_read_b32 v41, a43
  v_accvgpr_read_b32 v42, a56
  v_accvgpr_read_b32 v43, a57
  v_accvgpr_read_b32 v44, a58
  v_accvgpr_read_b32 v45, a59
  v_pk_mul_f32 v[38:39], v[38:39], s[70:71]
  v_pk_mul_f32 v[40:41], v[40:41], s[70:71]
  v_pk_mul_f32 v[42:43], v[42:43], s[70:71]
  v_pk_mul_f32 v[44:45], v[44:45], s[70:71]
  v_cvt_pk_bf16_f32 v104, v38, v39
  v_cvt_pk_bf16_f32 v105, v40, v41
  v_cvt_pk_bf16_f32 v106, v42, v43
  v_cvt_pk_bf16_f32 v107, v44, v45
  v_accvgpr_read_b32 v38, a44
  v_accvgpr_read_b32 v39, a45
  v_accvgpr_read_b32 v40, a46
  v_accvgpr_read_b32 v41, a47
  v_accvgpr_read_b32 v42, a60
  v_accvgpr_read_b32 v43, a61
  v_accvgpr_read_b32 v44, a62
  v_accvgpr_read_b32 v45, a63
  v_pk_mul_f32 v[38:39], v[38:39], s[70:71]
  v_pk_mul_f32 v[40:41], v[40:41], s[70:71]
  v_pk_mul_f32 v[42:43], v[42:43], s[70:71]
  v_pk_mul_f32 v[44:45], v[44:45], s[70:71]
  v_cvt_pk_bf16_f32 v108, v38, v39
  v_cvt_pk_bf16_f32 v109, v40, v41
  v_cvt_pk_bf16_f32 v110, v42, v43
  v_cvt_pk_bf16_f32 v111, v44, v45
  v_accvgpr_read_b32 v38, a64
  v_accvgpr_read_b32 v39, a65
  v_accvgpr_read_b32 v40, a66
  v_accvgpr_read_b32 v41, a67
  v_accvgpr_read_b32 v42, a80
  v_accvgpr_read_b32 v43, a81
  v_accvgpr_read_b32 v44, a82
  v_accvgpr_read_b32 v45, a83
  v_pk_mul_f32 v[38:39], v[38:39], s[70:71]
  v_pk_mul_f32 v[40:41], v[40:41], s[70:71]
  v_pk_mul_f32 v[42:43], v[42:43], s[70:71]
  v_pk_mul_f32 v[44:45], v[44:45], s[70:71]
  v_cvt_pk_bf16_f32 v112, v38, v39
  v_cvt_pk_bf16_f32 v113, v40, v41
  v_cvt_pk_bf16_f32 v114, v42, v43
  v_cvt_pk_bf16_f32 v115, v44, v45
  v_accvgpr_read_b32 v38, a68
  v_accvgpr_read_b32 v39, a69
  v_accvgpr_read_b32 v40, a70
  v_accvgpr_read_b32 v41, a71
  v_accvgpr_read_b32 v42, a84
  v_accvgpr_read_b32 v43, a85
  v_accvgpr_read_b32 v44, a86
  v_accvgpr_read_b32 v45, a87
  v_pk_mul_f32 v[38:39], v[38:39], s[70:71]
  v_pk_mul_f32 v[40:41], v[40:41], s[70:71]
  v_pk_mul_f32 v[42:43], v[42:43], s[70:71]
  v_pk_mul_f32 v[44:45], v[44:45], s[70:71]
  v_cvt_pk_bf16_f32 v116, v38, v39
  v_cvt_pk_bf16_f32 v117, v40, v41
  v_cvt_pk_bf16_f32 v118, v42, v43
  v_cvt_pk_bf16_f32 v119, v44, v45
  v_accvgpr_read_b32 v38, a72
  v_accvgpr_read_b32 v39, a73
  v_accvgpr_read_b32 v40, a74
  v_accvgpr_read_b32 v41, a75
  v_accvgpr_read_b32 v42, a88
  v_accvgpr_read_b32 v43, a89
  v_accvgpr_read_b32 v44, a90
  v_accvgpr_read_b32 v45, a91
  v_pk_mul_f32 v[38:39], v[38:39], s[70:71]
  v_pk_mul_f32 v[40:41], v[40:41], s[70:71]
  v_pk_mul_f32 v[42:43], v[42:43], s[70:71]
  v_pk_mul_f32 v[44:45], v[44:45], s[70:71]
  v_cvt_pk_bf16_f32 v120, v38, v39
  v_cvt_pk_bf16_f32 v121, v40, v41
  v_cvt_pk_bf16_f32 v122, v42, v43
  v_cvt_pk_bf16_f32 v123, v44, v45
  v_accvgpr_read_b32 v38, a76
  v_accvgpr_read_b32 v39, a77
  v_accvgpr_read_b32 v40, a78
  v_accvgpr_read_b32 v41, a79
  v_accvgpr_read_b32 v42, a92
  v_accvgpr_read_b32 v43, a93
  v_accvgpr_read_b32 v44, a94
  v_accvgpr_read_b32 v45, a95
  v_pk_mul_f32 v[38:39], v[38:39], s[70:71]
  v_pk_mul_f32 v[40:41], v[40:41], s[70:71]
  v_pk_mul_f32 v[42:43], v[42:43], s[70:71]
  v_pk_mul_f32 v[44:45], v[44:45], s[70:71]
  v_cvt_pk_bf16_f32 v124, v38, v39
  v_cvt_pk_bf16_f32 v125, v40, v41
  v_cvt_pk_bf16_f32 v126, v42, v43
  v_cvt_pk_bf16_f32 v127, v44, v45
  v_accvgpr_read_b32 v38, a96
  v_accvgpr_read_b32 v39, a97
  v_accvgpr_read_b32 v40, a98
  v_accvgpr_read_b32 v41, a99
  v_accvgpr_read_b32 v42, a112
  v_accvgpr_read_b32 v43, a113
  v_accvgpr_read_b32 v44, a114
  v_accvgpr_read_b32 v45, a115
  v_pk_mul_f32 v[38:39], v[38:39], s[70:71]
  v_pk_mul_f32 v[40:41], v[40:41], s[70:71]
  v_pk_mul_f32 v[42:43], v[42:43], s[70:71]
  v_pk_mul_f32 v[44:45], v[44:45], s[70:71]
  v_cvt_pk_bf16_f32 v128, v38, v39
  v_cvt_pk_bf16_f32 v129, v40, v41
  v_cvt_pk_bf16_f32 v130, v42, v43
  v_cvt_pk_bf16_f32 v131, v44, v45
  v_accvgpr_read_b32 v38, a100
  v_accvgpr_read_b32 v39, a101
  v_accvgpr_read_b32 v40, a102
  v_accvgpr_read_b32 v41, a103
  v_accvgpr_read_b32 v42, a116
  v_accvgpr_read_b32 v43, a117
  v_accvgpr_read_b32 v44, a118
  v_accvgpr_read_b32 v45, a119
  v_pk_mul_f32 v[38:39], v[38:39], s[70:71]
  v_pk_mul_f32 v[40:41], v[40:41], s[70:71]
  v_pk_mul_f32 v[42:43], v[42:43], s[70:71]
  v_pk_mul_f32 v[44:45], v[44:45], s[70:71]
  v_cvt_pk_bf16_f32 v132, v38, v39
  v_cvt_pk_bf16_f32 v133, v40, v41
  v_cvt_pk_bf16_f32 v134, v42, v43
  v_cvt_pk_bf16_f32 v135, v44, v45
  v_accvgpr_read_b32 v38, a104
  v_accvgpr_read_b32 v39, a105
  v_accvgpr_read_b32 v40, a106
  v_accvgpr_read_b32 v41, a107
  v_accvgpr_read_b32 v42, a120
  v_accvgpr_read_b32 v43, a121
  v_accvgpr_read_b32 v44, a122
  v_accvgpr_read_b32 v45, a123
  v_pk_mul_f32 v[38:39], v[38:39], s[70:71]
  v_pk_mul_f32 v[40:41], v[40:41], s[70:71]
  v_pk_mul_f32 v[42:43], v[42:43], s[70:71]
  v_pk_mul_f32 v[44:45], v[44:45], s[70:71]
  v_cvt_pk_bf16_f32 v136, v38, v39
  v_cvt_pk_bf16_f32 v137, v40, v41
  v_cvt_pk_bf16_f32 v138, v42, v43
  v_cvt_pk_bf16_f32 v139, v44, v45
  v_accvgpr_read_b32 v38, a108
  v_accvgpr_read_b32 v39, a109
  v_accvgpr_read_b32 v40, a110
  v_accvgpr_read_b32 v41, a111
  v_accvgpr_read_b32 v42, a124
  v_accvgpr_read_b32 v43, a125
  v_accvgpr_read_b32 v44, a126
  v_accvgpr_read_b32 v45, a127
  v_pk_mul_f32 v[38:39], v[38:39], s[70:71]
  v_pk_mul_f32 v[40:41], v[40:41], s[70:71]
  v_pk_mul_f32 v[42:43], v[42:43], s[70:71]
  v_pk_mul_f32 v[44:45], v[44:45], s[70:71]
  v_cvt_pk_bf16_f32 v140, v38, v39
  v_cvt_pk_bf16_f32 v141, v40, v41
  v_cvt_pk_bf16_f32 v142, v42, v43
  v_cvt_pk_bf16_f32 v143, v44, v45
  v_accvgpr_read_b32 v1, a216
  v_accvgpr_read_b32 v2, a217
  v_accvgpr_read_b32 v3, a218
  v_accvgpr_read_b32 v4, a219
  v_accvgpr_read_b32 v5, a220
  v_accvgpr_read_b32 v6, a221
  v_accvgpr_read_b32 v7, a222
  v_accvgpr_read_b32 v8, a223
  v_accvgpr_read_b32 v9, a224
  v_accvgpr_read_b32 v10, a225
  v_accvgpr_read_b32 v11, a226
  v_accvgpr_read_b32 v12, a227
  v_accvgpr_read_b32 v13, a228
  v_accvgpr_read_b32 v14, a229
  v_accvgpr_read_b32 v15, a230
L_attn_start:
  s_waitcnt vmcnt(8)
  s_barrier
  ds_read_b128 v[48:51], v21 offset:0
  ds_read_b128 v[52:55], v22 offset:0
  ds_read_b128 v[56:59], v23 offset:0
  ds_read_b128 v[60:63], v24 offset:0
  ds_read_b128 v[64:67], v21 offset:4096
  ds_read_b128 v[68:71], v22 offset:4096
  s_waitcnt lgkmcnt(5)
  v_mfma_f32_16x16x32_bf16 v[192:195], v[48:51], v[80:83], 0
  v_mfma_f32_16x16x32_bf16 v[196:199], v[48:51], v[84:87], 0
  buffer_store_dwordx4 a[144:147], v16, s[28:31], s66 offen offset:0 sc1
  v_mfma_f32_16x16x32_bf16 v[200:203], v[48:51], v[88:91], 0
  v_mfma_f32_16x16x32_bf16 v[204:207], v[48:51], v[92:95], 0
  ds_read_b128 v[48:51], v23 offset:4096
  s_waitcnt lgkmcnt(5)
  v_mfma_f32_16x16x32_bf16 v[192:195], v[52:55], v[96:99], v[192:195]
  v_mfma_f32_16x16x32_bf16 v[196:199], v[52:55], v[100:103], v[196:199]
  buffer_store_dwordx4 a[148:151], v16, s[28:31], s66 offen offset:1024 sc1
  v_mfma_f32_16x16x32_bf16 v[200:203], v[52:55], v[104:107], v[200:203]
  v_mfma_f32_16x16x32_bf16 v[204:207], v[52:55], v[108:111], v[204:207]
  ds_read_b128 v[52:55], v24 offset:4096
  s_waitcnt lgkmcnt(5)
  v_mfma_f32_16x16x32_bf16 v[192:195], v[56:59], v[112:115], v[192:195]
  v_mfma_f32_16x16x32_bf16 v[196:199], v[56:59], v[116:119], v[196:199]
  buffer_store_dwordx4 a[152:155], v16, s[28:31], s66 offen offset:2048 sc1
  v_mfma_f32_16x16x32_bf16 v[200:203], v[56:59], v[120:123], v[200:203]
  v_mfma_f32_16x16x32_bf16 v[204:207], v[56:59], v[124:127], v[204:207]
  s_waitcnt lgkmcnt(4)
  v_mfma_f32_16x16x32_bf16 v[192:195], v[60:63], v[128:131], v[192:195]
  v_mfma_f32_16x16x32_bf16 v[196:199], v[60:63], v[132:135], v[196:199]
  buffer_store_dwordx4 a[156:159], v16, s[28:31], s66 offen offset:3072 sc1
  v_mfma_f32_16x16x32_bf16 v[200:203], v[60:63], v[136:139], v[200:203]
  v_mfma_f32_16x16x32_bf16 v[204:207], v[60:63], v[140:143], v[204:207]
  s_waitcnt lgkmcnt(3)
  v_mfma_f32_16x16x32_bf16 v[208:211], v[64:67], v[80:83], 0
  v_mfma_f32_16x16x32_bf16 v[212:215], v[64:67], v[84:87], 0
  v_mfma_f32_16x16x32_bf16 v[216:219], v[64:67], v[88:91], 0
  v_mfma_f32_16x16x32_bf16 v[220:223], v[64:67], v[92:95], 0
  s_waitcnt lgkmcnt(2)
  v_mfma_f32_16x16x32_bf16 v[208:211], v[68:71], v[96:99], v[208:211]
  v_mfma_f32_16x16x32_bf16 v[212:215], v[68:71], v[100:103], v[212:215]
  v_mfma_f32_16x16x32_bf16 v[216:219], v[68:71], v[104:107], v[216:219]
  v_mfma_f32_16x16x32_bf16 v[220:223], v[68:71], v[108:111], v[220:223]
  s_waitcnt lgkmcnt(1)
  v_mfma_f32_16x16x32_bf16 v[208:211], v[48:51], v[112:115], v[208:211]
  v_mfma_f32_16x16x32_bf16 v[212:215], v[48:51], v[116:119], v[212:215]
  v_mfma_f32_16x16x32_bf16 v[216:219], v[48:51], v[120:123], v[216:219]
  v_mfma_f32_16x16x32_bf16 v[220:223], v[48:51], v[124:127], v[220:223]
  s_waitcnt lgkmcnt(0)
  v_mfma_f32_16x16x32_bf16 v[208:211], v[52:55], v[128:131], v[208:211]
  v_mfma_f32_16x16x32_bf16 v[212:215], v[52:55], v[132:135], v[212:215]
  v_mfma_f32_16x16x32_bf16 v[216:219], v[52:55], v[136:139], v[216:219]
  v_mfma_f32_16x16x32_bf16 v[220:223], v[52:55], v[140:143], v[220:223]
  ds_read_b128 v[56:59], v21 offset:8192
  ds_read_b128 v[60:63], v22 offset:8192
  ds_read_b128 v[64:67], v23 offset:8192
  ds_read_b128 v[68:71], v24 offset:8192
  s_nop 4
  v_max3_f32 v38, v192, v193, v194
  v_max3_f32 v38, v38, v195, v208
  v_max3_f32 v38, v38, v209, v210
  v_max_f32 v38, v38, v211
  v_max3_f32 v39, v196, v197, v198
  v_max3_f32 v39, v39, v199, v212
  v_max3_f32 v39, v39, v213, v214
  v_max_f32 v39, v39, v215
  v_max3_f32 v40, v200, v201, v202
  v_max3_f32 v40, v40, v203, v216
  v_max3_f32 v40, v40, v217, v218
  v_max_f32 v40, v40, v219
  v_max3_f32 v41, v204, v205, v206
  v_max3_f32 v41, v41, v207, v220
  v_max3_f32 v41, v41, v221, v222
  v_max_f32 v41, v41, v223
  v_mov_b32 v42, v38
  v_mov_b32 v43, v39
  v_mov_b32 v44, v40
  v_mov_b32 v45, v41
  v_permlane32_swap_b32 v38, v42
  v_permlane32_swap_b32 v39, v43
  v_permlane32_swap_b32 v40, v44
  v_permlane32_swap_b32 v41, v45
  v_max_f32 v38, v38, v42
  v_max_f32 v39, v39, v43
  v_max_f32 v40, v40, v44
  v_max_f32 v41, v41, v45
  v_mov_b32 v42, v38
  v_mov_b32 v43, v39
  v_mov_b32 v44, v40
  v_mov_b32 v45, v41
  v_permlane16_swap_b32 v38, v42
  v_permlane16_swap_b32 v39, v43
  v_permlane16_swap_b32 v40, v44
  v_permlane16_swap_b32 v41, v45
  v_max_f32 v38, v38, v42
  v_max_f32 v39, v39, v43
  v_max_f32 v40, v40, v44
  v_max_f32 v41, v41, v45
  v_sub_f32 v144, 0, v38
  v_sub_f32 v145, 0, v38
  v_sub_f32 v146, 0, v38
  v_sub_f32 v147, 0, v38
  v_sub_f32 v148, 0, v39
  v_sub_f32 v149, 0, v39
  v_sub_f32 v150, 0, v39
  v_sub_f32 v151, 0, v39
  v_sub_f32 v152, 0, v40
  v_sub_f32 v153, 0, v40
  v_sub_f32 v154, 0, v40
  v_sub_f32 v155, 0, v40
  v_sub_f32 v156, 0, v41
  v_sub_f32 v157, 0, v41
  v_sub_f32 v158, 0, v41
  v_sub_f32 v159, 0, v41
  s_barrier
  s_waitcnt lgkmcnt(2)
  v_mfma_f32_16x16x32_bf16 v[224:227], v[56:59], v[80:83], v[144:147]
  ds_read_b128 v[48:51], v21 offset:12288
  v_add_f32 v192, v192, v144
  v_mfma_f32_16x16x32_bf16 v[228:231], v[56:59], v[84:87], v[148:151]
  ds_read_b128 v[52:55], v22 offset:12288
  s_add_u32 m0, s42, 49152
  v_mfma_f32_16x16x32_bf16 v[232:235], v[56:59], v[88:91], v[152:155]
  s_mov_b32 s39, 16384
  v_add_f32 v193, v193, v144
  v_mfma_f32_16x16x32_bf16 v[236:239], v[56:59], v[92:95], v[156:159]
  buffer_load_dwordx4 v19, s[24:27], s39 offen lds
  v_mfma_f32_16x16x32_bf16 v[224:227], v[60:63], v[96:99], v[224:227]
  buffer_load_dwordx4 v20, s[24:27], s39 offen offset:1024 lds
  v_mfma_f32_16x16x32_bf16 v[228:231], v[60:63], v[100:103], v[228:231]
  ds_read_b128 v[56:59], v23 offset:12288
  v_add_f32 v194, v194, v144
  v_mfma_f32_16x16x32_bf16 v[232:235], v[60:63], v[104:107], v[232:235]
  buffer_store_dwordx4 a[160:163], v16, s[28:31], s67 offen offset:0 sc1
  v_mfma_f32_16x16x32_bf16 v[236:239], v[60:63], v[108:111], v[236:239]
  v_add_f32 v195, v195, v144
  s_waitcnt lgkmcnt(3)
  v_mfma_f32_16x16x32_bf16 v[224:227], v[64:67], v[112:115], v[224:227]
  buffer_store_dwordx4 a[164:167], v16, s[28:31], s67 offen offset:1024 sc1
  v_mfma_f32_16x16x32_bf16 v[228:231], v[64:67], v[116:119], v[228:231]
  ds_read_b128 v[60:63], v24 offset:12288
  v_mfma_f32_16x16x32_bf16 v[232:235], v[64:67], v[120:123], v[232:235]
  buffer_store_dwordx4 a[168:171], v16, s[28:31], s67 offen offset:2048 sc1
  v_mfma_f32_16x16x32_bf16 v[236:239], v[64:67], v[124:127], v[236:239]
  s_add_u32 m0, s42, 0
  s_mov_b32 s39, 32768
  v_mfma_f32_16x16x32_bf16 v[224:227], v[68:71], v[128:131], v[224:227]
  buffer_load_dwordx4 v17, s[20:23], s39 offen lds
  v_mfma_f32_16x16x32_bf16 v[228:231], v[68:71], v[132:135], v[228:231]
  ds_read_b64_tr_b16 v[64:65], v25 offset:0
  ds_read_b64_tr_b16 v[66:67], v25 offset:4096
  v_mfma_f32_16x16x32_bf16 v[232:235], v[68:71], v[136:139], v[232:235]
  buffer_load_dwordx4 v18, s[20:23], s39 offen offset:1024 lds
  v_mfma_f32_16x16x32_bf16 v[236:239], v[68:71], v[140:143], v[236:239]
  s_waitcnt lgkmcnt(4)
  v_mfma_f32_16x16x32_bf16 v[240:243], v[48:51], v[80:83], v[144:147]
  v_exp_f32 v192, v192
  v_mfma_f32_16x16x32_bf16 v[244:247], v[48:51], v[84:87], v[148:151]
  ds_read_b64_tr_b16 v[68:69], v26 offset:0
  ds_read_b64_tr_b16 v[70:71], v26 offset:4096
  v_mfma_f32_16x16x32_bf16 v[248:251], v[48:51], v[88:91], v[152:155]
  v_exp_f32 v193, v193
  v_mfma_f32_16x16x32_bf16 v[252:255], v[48:51], v[92:95], v[156:159]
  v_exp_f32 v194, v194
  v_mfma_f32_16x16x32_bf16 v[240:243], v[52:55], v[96:99], v[240:243]
  v_exp_f32 v195, v195
  v_mfma_f32_16x16x32_bf16 v[244:247], v[52:55], v[100:103], v[244:247]
  ds_read_b64_tr_b16 v[48:49], v27 offset:0
  ds_read_b64_tr_b16 v[50:51], v27 offset:4096
  v_mfma_f32_16x16x32_bf16 v[248:251], v[52:55], v[104:107], v[248:251]
  v_add_f32 v196, v196, v148
  v_add_f32 v197, v197, v148
  v_mfma_f32_16x16x32_bf16 v[252:255], v[52:55], v[108:111], v[252:255]
  v_add_f32 v198, v198, v148
  s_waitcnt lgkmcnt(6)
  v_mfma_f32_16x16x32_bf16 v[240:243], v[56:59], v[112:115], v[240:243]
  v_add_f32 v199, v199, v148
  v_mfma_f32_16x16x32_bf16 v[244:247], v[56:59], v[116:119], v[244:247]
  ds_read_b64_tr_b16 v[52:53], v28 offset:0
  ds_read_b64_tr_b16 v[54:55], v28 offset:4096
  v_mfma_f32_16x16x32_bf16 v[248:251], v[56:59], v[120:123], v[248:251]
  v_exp_f32 v196, v196
  v_mfma_f32_16x16x32_bf16 v[252:255], v[56:59], v[124:127], v[252:255]
  v_exp_f32 v197, v197
  v_mfma_f32_16x16x32_bf16 v[240:243], v[60:63], v[128:131], v[240:243]
  v_exp_f32 v198, v198
  v_mfma_f32_16x16x32_bf16 v[244:247], v[60:63], v[132:135], v[244:247]
  v_exp_f32 v199, v199
  v_mfma_f32_16x16x32_bf16 v[248:251], v[60:63], v[136:139], v[248:251]
  v_cvt_pk_bf16_f32 v160, v192, v193
  v_cvt_pk_bf16_f32 v161, v194, v195
  v_add_f32 v200, v200, v152
  v_add_f32 v201, v201, v152
  v_add_f32 v202, v202, v152
  v_add_f32 v203, v203, v152
  v_exp_f32 v200, v200
  v_exp_f32 v201, v201
  v_exp_f32 v202, v202
  v_exp_f32 v203, v203
  v_cvt_pk_bf16_f32 v164, v196, v197
  v_cvt_pk_bf16_f32 v165, v198, v199
  v_add_f32 v204, v204, v156
  v_add_f32 v205, v205, v156
  v_add_f32 v206, v206, v156
  v_add_f32 v207, v207, v156
  v_exp_f32 v204, v204
  v_exp_f32 v205, v205
  v_exp_f32 v206, v206
  v_exp_f32 v207, v207
  v_cvt_pk_bf16_f32 v168, v200, v201
  v_cvt_pk_bf16_f32 v169, v202, v203
  v_add_f32 v208, v208, v144
  v_add_f32 v209, v209, v144
  v_add_f32 v210, v210, v144
  v_add_f32 v211, v211, v144
  v_exp_f32 v208, v208
  v_exp_f32 v209, v209
  v_exp_f32 v210, v210
  v_exp_f32 v211, v211
  v_cvt_pk_bf16_f32 v172, v204, v205
  v_cvt_pk_bf16_f32 v173, v206, v207
  v_add_f32 v212, v212, v148
  v_add_f32 v213, v213, v148
  v_add_f32 v214, v214, v148
  v_add_f32 v215, v215, v148
  v_exp_f32 v212, v212
  v_exp_f32 v213, v213
  v_exp_f32 v214, v214
  v_exp_f32 v215, v215
  v_cvt_pk_bf16_f32 v162, v208, v209
  v_cvt_pk_bf16_f32 v163, v210, v211
  v_add_f32 v216, v216, v152
  v_add_f32 v217, v217, v152
  v_add_f32 v218, v218, v152
  v_add_f32 v219, v219, v152
  v_exp_f32 v216, v216
  v_exp_f32 v217, v217
  v_exp_f32 v218, v218
  v_exp_f32 v219, v219
  v_cvt_pk_bf16_f32 v166, v212, v213
  v_cvt_pk_bf16_f32 v167, v214, v215
  v_add_f32 v220, v220, v156
  v_add_f32 v221, v221, v156
  v_add_f32 v222, v222, v156
  v_add_f32 v223, v223, v156
  v_exp_f32 v220, v220
  v_exp_f32 v221, v221
  v_exp_f32 v222, v222
  v_exp_f32 v223, v223
  v_cvt_pk_bf16_f32 v170, v216, v217
  v_cvt_pk_bf16_f32 v171, v218, v219
  v_cvt_pk_bf16_f32 v174, v220, v221
  v_cvt_pk_bf16_f32 v175, v222, v223
  v_mfma_f32_16x16x32_bf16 v[252:255], v[60:63], v[140:143], v[252:255]
  s_waitcnt vmcnt(15)
  s_barrier
  s_waitcnt lgkmcnt(4)
  v_mfma_f32_16x16x32_bf16 a[0:3], v[64:67], v[160:163], 0
  ds_read_b64_tr_b16 v[56:57], v29 offset:0
  ds_read_b64_tr_b16 v[58:59], v29 offset:4096
  v_mfma_f32_16x16x32_bf16 a[4:7], v[64:67], v[164:167], 0
  ds_read_b64_tr_b16 v[60:61], v30 offset:0
  ds_read_b64_tr_b16 v[62:63], v30 offset:4096
  v_mfma_f32_16x16x32_bf16 a[8:11], v[64:67], v[168:171], 0
  s_add_u32 m0, s42, 57344
  v_mfma_f32_16x16x32_bf16 a[12:15], v[64:67], v[172:175], 0
  v_exp_f32 v224, v224
  v_mfma_f32_16x16x32_bf16 a[16:19], v[68:71], v[160:163], 0
  v_exp_f32 v225, v225
  v_mfma_f32_16x16x32_bf16 a[20:23], v[68:71], v[164:167], 0
  ds_read_b64_tr_b16 v[64:65], v31 offset:0
  ds_read_b64_tr_b16 v[66:67], v31 offset:4096
  v_mfma_f32_16x16x32_bf16 a[24:27], v[68:71], v[168:171], 0
  s_mov_b32 s39, 24576
  v_mfma_f32_16x16x32_bf16 a[28:31], v[68:71], v[172:175], 0
  s_waitcnt lgkmcnt(6)
  v_mfma_f32_16x16x32_bf16 a[32:35], v[48:51], v[160:163], 0
  v_exp_f32 v226, v226
  v_mfma_f32_16x16x32_bf16 a[36:39], v[48:51], v[164:167], 0
  ds_read_b64_tr_b16 v[68:69], v32 offset:0
  ds_read_b64_tr_b16 v[70:71], v32 offset:4096
  v_mfma_f32_16x16x32_bf16 a[40:43], v[48:51], v[168:171], 0
  buffer_load_dwordx4 v19, s[24:27], s39 offen lds
  v_mfma_f32_16x16x32_bf16 a[44:47], v[48:51], v[172:175], 0
  v_exp_f32 v227, v227
  v_mfma_f32_16x16x32_bf16 a[48:51], v[52:55], v[160:163], 0
  v_exp_f32 v228, v228
  v_mfma_f32_16x16x32_bf16 a[52:55], v[52:55], v[164:167], 0
  buffer_load_dwordx4 v20, s[24:27], s39 offen offset:1024 lds
  v_mfma_f32_16x16x32_bf16 a[56:59], v[52:55], v[168:171], 0
  v_exp_f32 v229, v229
  v_mfma_f32_16x16x32_bf16 a[60:63], v[52:55], v[172:175], 0
  v_exp_f32 v230, v230
  v_mfma_f32_16x16x32_bf16 a[128:131], v[34:37], v[160:163], 0
  v_exp_f32 v231, v231
  v_mfma_f32_16x16x32_bf16 a[132:135], v[34:37], v[164:167], 0
  ds_read_b128 v[48:51], v21 offset:16384
  v_cvt_pk_bf16_f32 v176, v224, v225
  v_mfma_f32_16x16x32_bf16 a[136:139], v[34:37], v[168:171], 0
  buffer_store_dwordx4 a[172:175], v16, s[28:31], s67 offen offset:3072 sc1
  v_mfma_f32_16x16x32_bf16 a[140:143], v[34:37], v[172:175], 0
  v_cvt_pk_bf16_f32 v177, v226, v227
  s_waitcnt lgkmcnt(5)
  v_mfma_f32_16x16x32_bf16 a[64:67], v[56:59], v[160:163], 0
  v_exp_f32 v232, v232
  v_mfma_f32_16x16x32_bf16 a[68:71], v[56:59], v[164:167], 0
  ds_read_b128 v[52:55], v22 offset:16384
  v_mfma_f32_16x16x32_bf16 a[72:75], v[56:59], v[168:171], 0
  buffer_store_dwordx4 a[176:179], v16, s[28:31], s68 offen offset:0 sc1
  v_mfma_f32_16x16x32_bf16 a[76:79], v[56:59], v[172:175], 0
  v_exp_f32 v233, v233
  v_mfma_f32_16x16x32_bf16 a[80:83], v[60:63], v[160:163], 0
  v_exp_f32 v234, v234
  v_mfma_f32_16x16x32_bf16 a[84:87], v[60:63], v[164:167], 0
  ds_read_b128 v[56:59], v23 offset:16384
  v_mfma_f32_16x16x32_bf16 a[88:91], v[60:63], v[168:171], 0
  buffer_store_dwordx4 a[180:183], v16, s[28:31], s68 offen offset:1024 sc1
  v_mfma_f32_16x16x32_bf16 a[92:95], v[60:63], v[172:175], 0
  s_waitcnt lgkmcnt(3)
  v_mfma_f32_16x16x32_bf16 a[96:99], v[64:67], v[160:163], 0
  v_exp_f32 v235, v235
  v_mfma_f32_16x16x32_bf16 a[100:103], v[64:67], v[164:167], 0
  ds_read_b128 v[60:63], v24 offset:16384
  s_add_u32 m0, s42, 8192
  v_mfma_f32_16x16x32_bf16 a[104:107], v[64:67], v[168:171], 0
  v_cvt_pk_bf16_f32 v180, v228, v229
  v_cvt_pk_bf16_f32 v181, v230, v231
  v_mfma_f32_16x16x32_bf16 a[108:111], v[64:67], v[172:175], 0
  v_exp_f32 v236, v236
  v_mfma_f32_16x16x32_bf16 a[112:115], v[68:71], v[160:163], 0
  v_exp_f32 v237, v237
  v_mfma_f32_16x16x32_bf16 a[116:119], v[68:71], v[164:167], 0
  ds_read_b128 v[64:67], v21 offset:20480
  s_mov_b32 s39, 40960
  v_mfma_f32_16x16x32_bf16 a[120:123], v[68:71], v[168:171], 0
  v_exp_f32 v238, v238
  v_mfma_f32_16x16x32_bf16 a[124:127], v[68:71], v[172:175], 0
  s_waitcnt lgkmcnt(3)
  v_mfma_f32_16x16x32_bf16 v[192:195], v[48:51], v[80:83], v[144:147]
  v_exp_f32 v239, v239
  v_mfma_f32_16x16x32_bf16 v[196:199], v[48:51], v[84:87], v[148:151]
  ds_read_b128 v[68:71], v22 offset:20480
  v_cvt_pk_bf16_f32 v184, v232, v233
  v_mfma_f32_16x16x32_bf16 v[200:203], v[48:51], v[88:91], v[152:155]
  buffer_load_dwordx4 v17, s[20:23], s39 offen lds
  v_mfma_f32_16x16x32_bf16 v[204:207], v[48:51], v[92:95], v[156:159]
  v_cvt_pk_bf16_f32 v185, v234, v235
  v_mfma_f32_16x16x32_bf16 v[192:195], v[52:55], v[96:99], v[192:195]
  v_exp_f32 v240, v240
  v_mfma_f32_16x16x32_bf16 v[196:199], v[52:55], v[100:103], v[196:199]
  ds_read_b128 v[48:51], v23 offset:20480
  v_mfma_f32_16x16x32_bf16 v[200:203], v[52:55], v[104:107], v[200:203]
  buffer_load_dwordx4 v18, s[20:23], s39 offen offset:1024 lds
  v_mfma_f32_16x16x32_bf16 v[204:207], v[52:55], v[108:111], v[204:207]
  s_waitcnt lgkmcnt(3)
  v_mfma_f32_16x16x32_bf16 v[192:195], v[56:59], v[112:115], v[192:195]
  v_exp_f32 v241, v241
  v_mfma_f32_16x16x32_bf16 v[196:199], v[56:59], v[116:119], v[196:199]
  ds_read_b128 v[52:55], v24 offset:20480
  v_mfma_f32_16x16x32_bf16 v[200:203], v[56:59], v[120:123], v[200:203]
  v_exp_f32 v242, v242
  v_mfma_f32_16x16x32_bf16 v[204:207], v[56:59], v[124:127], v[204:207]
  v_exp_f32 v243, v243
  v_mfma_f32_16x16x32_bf16 v[192:195], v[60:63], v[128:131], v[192:195]
  v_cvt_pk_bf16_f32 v188, v236, v237
  v_cvt_pk_bf16_f32 v189, v238, v239
  v_mfma_f32_16x16x32_bf16 v[196:199], v[60:63], v[132:135], v[196:199]
  ds_read_b64_tr_b16 v[56:57], v25 offset:8192
  ds_read_b64_tr_b16 v[58:59], v25 offset:12288
  v_mfma_f32_16x16x32_bf16 v[200:203], v[60:63], v[136:139], v[200:203]
  v_exp_f32 v244, v244
  v_mfma_f32_16x16x32_bf16 v[204:207], v[60:63], v[140:143], v[204:207]
  s_waitcnt lgkmcnt(4)
  v_mfma_f32_16x16x32_bf16 v[208:211], v[64:67], v[80:83], v[144:147]
  v_exp_f32 v245, v245
  v_mfma_f32_16x16x32_bf16 v[212:215], v[64:67], v[84:87], v[148:151]
  ds_read_b64_tr_b16 v[60:61], v26 offset:8192
  ds_read_b64_tr_b16 v[62:63], v26 offset:12288
  v_mfma_f32_16x16x32_bf16 v[216:219], v[64:67], v[88:91], v[152:155]
  v_exp_f32 v246, v246
  v_mfma_f32_16x16x32_bf16 v[220:223], v[64:67], v[92:95], v[156:159]
  v_exp_f32 v247, v247
  v_mfma_f32_16x16x32_bf16 v[208:211], v[68:71], v[96:99], v[208:211]
  v_cvt_pk_bf16_f32 v178, v240, v241
  v_cvt_pk_bf16_f32 v179, v242, v243
  v_mfma_f32_16x16x32_bf16 v[212:215], v[68:71], v[100:103], v[212:215]
  ds_read_b64_tr_b16 v[64:65], v27 offset:8192
  ds_read_b64_tr_b16 v[66:67], v27 offset:12288
  v_mfma_f32_16x16x32_bf16 v[216:219], v[68:71], v[104:107], v[216:219]
  v_exp_f32 v248, v248
  v_mfma_f32_16x16x32_bf16 v[220:223], v[68:71], v[108:111], v[220:223]
  s_waitcnt lgkmcnt(6)
  v_mfma_f32_16x16x32_bf16 v[208:211], v[48:51], v[112:115], v[208:211]
  v_exp_f32 v249, v249
  v_mfma_f32_16x16x32_bf16 v[212:215], v[48:51], v[116:119], v[212:215]
  ds_read_b64_tr_b16 v[68:69], v28 offset:8192
  ds_read_b64_tr_b16 v[70:71], v28 offset:12288
  v_mfma_f32_16x16x32_bf16 v[216:219], v[48:51], v[120:123], v[216:219]
  v_exp_f32 v250, v250
  v_mfma_f32_16x16x32_bf16 v[220:223], v[48:51], v[124:127], v[220:223]
  v_exp_f32 v251, v251
  v_mfma_f32_16x16x32_bf16 v[208:211], v[52:55], v[128:131], v[208:211]
  v_cvt_pk_bf16_f32 v182, v244, v245
  v_cvt_pk_bf16_f32 v183, v246, v247
  v_mfma_f32_16x16x32_bf16 v[212:215], v[52:55], v[132:135], v[212:215]
  v_exp_f32 v252, v252
  v_mfma_f32_16x16x32_bf16 v[216:219], v[52:55], v[136:139], v[216:219]
  v_exp_f32 v253, v253
  v_exp_f32 v254, v254
  v_exp_f32 v255, v255
  v_cvt_pk_bf16_f32 v186, v248, v249
  v_cvt_pk_bf16_f32 v187, v250, v251
  v_cvt_pk_bf16_f32 v190, v252, v253
  v_cvt_pk_bf16_f32 v191, v254, v255
  v_mfma_f32_16x16x32_bf16 v[220:223], v[52:55], v[140:143], v[220:223]
  s_waitcnt vmcnt(12)
  s_barrier
  s_waitcnt lgkmcnt(4)
  v_mfma_f32_16x16x32_bf16 a[0:3], v[56:59], v[176:179], a[0:3]
  ds_read_b64_tr_b16 v[48:49], v29 offset:8192
  ds_read_b64_tr_b16 v[50:51], v29 offset:12288
  v_mfma_f32_16x16x32_bf16 a[4:7], v[56:59], v[180:183], a[4:7]
  ds_read_b64_tr_b16 v[52:53], v30 offset:8192
  ds_read_b64_tr_b16 v[54:55], v30 offset:12288
  v_mfma_f32_16x16x32_bf16 a[8:11], v[56:59], v[184:187], a[8:11]
  s_add_u32 m0, s42, 32768
  v_mfma_f32_16x16x32_bf16 a[12:15], v[56:59], v[188:191], a[12:15]
  v_exp_f32 v192, v192
  v_mfma_f32_16x16x32_bf16 a[16:19], v[60:63], v[176:179], a[16:19]
  v_exp_f32 v193, v193
  v_mfma_f32_16x16x32_bf16 a[20:23], v[60:63], v[180:183], a[20:23]
  ds_read_b64_tr_b16 v[56:57], v31 offset:8192
  ds_read_b64_tr_b16 v[58:59], v31 offset:12288
  v_mfma_f32_16x16x32_bf16 a[24:27], v[60:63], v[184:187], a[24:27]
  s_mov_b32 s39, 32768
  v_mfma_f32_16x16x32_bf16 a[28:31], v[60:63], v[188:191], a[28:31]
  s_waitcnt lgkmcnt(6)
  v_mfma_f32_16x16x32_bf16 a[32:35], v[64:67], v[176:179], a[32:35]
  v_exp_f32 v194, v194
  v_mfma_f32_16x16x32_bf16 a[36:39], v[64:67], v[180:183], a[36:39]
  ds_read_b64_tr_b16 v[60:61], v32 offset:8192
  ds_read_b64_tr_b16 v[62:63], v32 offset:12288
  v_mfma_f32_16x16x32_bf16 a[40:43], v[64:67], v[184:187], a[40:43]
  buffer_load_dwordx4 v19, s[24:27], s39 offen lds
  v_mfma_f32_16x16x32_bf16 a[44:47], v[64:67], v[188:191], a[44:47]
  v_exp_f32 v195, v195
  v_mfma_f32_16x16x32_bf16 a[48:51], v[68:71], v[176:179], a[48:51]
  v_exp_f32 v196, v196
  v_mfma_f32_16x16x32_bf16 a[52:55], v[68:71], v[180:183], a[52:55]
  buffer_load_dwordx4 v20, s[24:27], s39 offen offset:1024 lds
  v_mfma_f32_16x16x32_bf16 a[56:59], v[68:71], v[184:187], a[56:59]
  v_exp_f32 v197, v197
  v_mfma_f32_16x16x32_bf16 a[60:63], v[68:71], v[188:191], a[60:63]
  v_exp_f32 v198, v198
  v_mfma_f32_16x16x32_bf16 a[128:131], v[34:37], v[176:179], a[128:131]
  v_exp_f32 v199, v199
  v_mfma_f32_16x16x32_bf16 a[132:135], v[34:37], v[180:183], a[132:135]
  ds_read_b128 v[64:67], v21 offset:24576
  v_cvt_pk_bf16_f32 v160, v192, v193
  v_mfma_f32_16x16x32_bf16 a[136:139], v[34:37], v[184:187], a[136:139]
  buffer_store_dwordx4 a[184:187], v16, s[28:31], s68 offen offset:2048 sc1
  v_mfma_f32_16x16x32_bf16 a[140:143], v[34:37], v[188:191], a[140:143]
  v_cvt_pk_bf16_f32 v161, v194, v195
  s_waitcnt lgkmcnt(5)
  v_mfma_f32_16x16x32_bf16 a[64:67], v[48:51], v[176:179], a[64:67]
  v_exp_f32 v200, v200
  v_mfma_f32_16x16x32_bf16 a[68:71], v[48:51], v[180:183], a[68:71]
  ds_read_b128 v[68:71], v22 offset:24576
  v_mfma_f32_16x16x32_bf16 a[72:75], v[48:51], v[184:187], a[72:75]
  buffer_store_dwordx4 a[188:191], v16, s[28:31], s68 offen offset:3072 sc1
  v_mfma_f32_16x16x32_bf16 a[76:79], v[48:51], v[188:191], a[76:79]
  v_exp_f32 v201, v201
  v_mfma_f32_16x16x32_bf16 a[80:83], v[52:55], v[176:179], a[80:83]
  v_exp_f32 v202, v202
  v_mfma_f32_16x16x32_bf16 a[84:87], v[52:55], v[180:183], a[84:87]
  ds_read_b128 v[48:51], v23 offset:24576
  v_mfma_f32_16x16x32_bf16 a[88:91], v[52:55], v[184:187], a[88:91]
  buffer_store_dwordx4 a[192:195], v16, s[28:31], s69 offen offset:0 sc1
  v_mfma_f32_16x16x32_bf16 a[92:95], v[52:55], v[188:191], a[92:95]
  s_waitcnt lgkmcnt(3)
  v_mfma_f32_16x16x32_bf16 a[96:99], v[56:59], v[176:179], a[96:99]
  v_exp_f32 v203, v203
  v_mfma_f32_16x16x32_bf16 a[100:103], v[56:59], v[180:183], a[100:103]
  ds_read_b128 v[52:55], v24 offset:24576
  s_add_u32 m0, s42, 16384
  v_mfma_f32_16x16x32_bf16 a[104:107], v[56:59], v[184:187], a[104:107]
  v_cvt_pk_bf16_f32 v164, v196, v197
  v_cvt_pk_bf16_f32 v165, v198, v199
  v_mfma_f32_16x16x32_bf16 a[108:111], v[56:59], v[188:191], a[108:111]
  v_exp_f32 v204, v204
  v_mfma_f32_16x16x32_bf16 a[112:115], v[60:63], v[176:179], a[112:115]
  v_exp_f32 v205, v205
  v_mfma_f32_16x16x32_bf16 a[116:119], v[60:63], v[180:183], a[116:119]
  ds_read_b128 v[56:59], v21 offset:28672
  s_mov_b32 s39, 49152
  v_mfma_f32_16x16x32_bf16 a[120:123], v[60:63], v[184:187], a[120:123]
  v_exp_f32 v206, v206
  v_mfma_f32_16x16x32_bf16 a[124:127], v[60:63], v[188:191], a[124:127]
  s_waitcnt lgkmcnt(3)
  v_mfma_f32_16x16x32_bf16 v[224:227], v[64:67], v[80:83], v[144:147]
  v_exp_f32 v207, v207
  v_mfma_f32_16x16x32_bf16 v[228:231], v[64:67], v[84:87], v[148:151]
  ds_read_b128 v[60:63], v22 offset:28672
  v_cvt_pk_bf16_f32 v168, v200, v201
  v_mfma_f32_16x16x32_bf16 v[232:235], v[64:67], v[88:91], v[152:155]
  buffer_load_dwordx4 v17, s[20:23], s39 offen lds
  v_mfma_f32_16x16x32_bf16 v[236:239], v[64:67], v[92:95], v[156:159]
  v_cvt_pk_bf16_f32 v169, v202, v203
  v_mfma_f32_16x16x32_bf16 v[224:227], v[68:71], v[96:99], v[224:227]
  v_exp_f32 v208, v208
  v_mfma_f32_16x16x32_bf16 v[228:231], v[68:71], v[100:103], v[228:231]
  ds_read_b128 v[64:67], v23 offset:28672
  v_mfma_f32_16x16x32_bf16 v[232:235], v[68:71], v[104:107], v[232:235]
  buffer_load_dwordx4 v18, s[20:23], s39 offen offset:1024 lds
  v_mfma_f32_16x16x32_bf16 v[236:239], v[68:71], v[108:111], v[236:239]
  s_waitcnt lgkmcnt(3)
  v_mfma_f32_16x16x32_bf16 v[224:227], v[48:51], v[112:115], v[224:227]
  v_exp_f32 v209, v209
  v_mfma_f32_16x16x32_bf16 v[228:231], v[48:51], v[116:119], v[228:231]
  ds_read_b128 v[68:71], v24 offset:28672
  v_mfma_f32_16x16x32_bf16 v[232:235], v[48:51], v[120:123], v[232:235]
  v_exp_f32 v210, v210
  v_mfma_f32_16x16x32_bf16 v[236:239], v[48:51], v[124:127], v[236:239]
  v_exp_f32 v211, v211
  v_mfma_f32_16x16x32_bf16 v[224:227], v[52:55], v[128:131], v[224:227]
  v_cvt_pk_bf16_f32 v172, v204, v205
  v_cvt_pk_bf16_f32 v173, v206, v207
  v_mfma_f32_16x16x32_bf16 v[228:231], v[52:55], v[132:135], v[228:231]
  ds_read_b64_tr_b16 v[48:49], v25 offset:16384
  ds_read_b64_tr_b16 v[50:51], v25 offset:20480
  v_mfma_f32_16x16x32_bf16 v[232:235], v[52:55], v[136:139], v[232:235]
  v_exp_f32 v212, v212
  v_mfma_f32_16x16x32_bf16 v[236:239], v[52:55], v[140:143], v[236:239]
  s_waitcnt lgkmcnt(4)
  v_mfma_f32_16x16x32_bf16 v[240:243], v[56:59], v[80:83], v[144:147]
  v_exp_f32 v213, v213
  v_mfma_f32_16x16x32_bf16 v[244:247], v[56:59], v[84:87], v[148:151]
  ds_read_b64_tr_b16 v[52:53], v26 offset:16384
  ds_read_b64_tr_b16 v[54:55], v26 offset:20480
  v_mfma_f32_16x16x32_bf16 v[248:251], v[56:59], v[88:91], v[152:155]
  v_exp_f32 v214, v214
  v_mfma_f32_16x16x32_bf16 v[252:255], v[56:59], v[92:95], v[156:159]
  v_exp_f32 v215, v215
  v_mfma_f32_16x16x32_bf16 v[240:243], v[60:63], v[96:99], v[240:243]
  v_cvt_pk_bf16_f32 v162, v208, v209
  v_cvt_pk_bf16_f32 v163, v210, v211
  v_mfma_f32_16x16x32_bf16 v[244:247], v[60:63], v[100:103], v[244:247]
  ds_read_b64_tr_b16 v[56:57], v27 offset:16384
  ds_read_b64_tr_b16 v[58:59], v27 offset:20480
  v_mfma_f32_16x16x32_bf16 v[248:251], v[60:63], v[104:107], v[248:251]
  v_exp_f32 v216, v216
  v_mfma_f32_16x16x32_bf16 v[252:255], v[60:63], v[108:111], v[252:255]
  s_waitcnt lgkmcnt(6)
  v_mfma_f32_16x16x32_bf16 v[240:243], v[64:67], v[112:115], v[240:243]
  v_exp_f32 v217, v217
  v_mfma_f32_16x16x32_bf16 v[244:247], v[64:67], v[116:119], v[244:247]
  ds_read_b64_tr_b16 v[60:61], v28 offset:16384
  ds_read_b64_tr_b16 v[62:63], v28 offset:20480
  v_mfma_f32_16x16x32_bf16 v[248:251], v[64:67], v[120:123], v[248:251]
  v_exp_f32 v218, v218
  v_mfma_f32_16x16x32_bf16 v[252:255], v[64:67], v[124:127], v[252:255]
  v_exp_f32 v219, v219
  v_mfma_f32_16x16x32_bf16 v[240:243], v[68:71], v[128:131], v[240:243]
  v_cvt_pk_bf16_f32 v166, v212, v213
  v_cvt_pk_bf16_f32 v167, v214, v215
  v_mfma_f32_16x16x32_bf16 v[244:247], v[68:71], v[132:135], v[244:247]
  v_exp_f32 v220, v220
  v_mfma_f32_16x16x32_bf16 v[248:251], v[68:71], v[136:139], v[248:251]
  v_exp_f32 v221, v221
  v_exp_f32 v222, v222
  v_exp_f32 v223, v223
  v_cvt_pk_bf16_f32 v170, v216, v217
  v_cvt_pk_bf16_f32 v171, v218, v219
  v_cvt_pk_bf16_f32 v174, v220, v221
  v_cvt_pk_bf16_f32 v175, v222, v223
  v_mfma_f32_16x16x32_bf16 v[252:255], v[68:71], v[140:143], v[252:255]
  s_waitcnt vmcnt(12)
  s_barrier
  s_waitcnt lgkmcnt(4)
  v_mfma_f32_16x16x32_bf16 a[0:3], v[48:51], v[160:163], a[0:3]
  ds_read_b64_tr_b16 v[64:65], v29 offset:16384
  ds_read_b64_tr_b16 v[66:67], v29 offset:20480
  v_mfma_f32_16x16x32_bf16 a[4:7], v[48:51], v[164:167], a[4:7]
  ds_read_b64_tr_b16 v[68:69], v30 offset:16384
  ds_read_b64_tr_b16 v[70:71], v30 offset:20480
  v_mfma_f32_16x16x32_bf16 a[8:11], v[48:51], v[168:171], a[8:11]
  s_add_u32 m0, s42, 40960
  v_mfma_f32_16x16x32_bf16 a[12:15], v[48:51], v[172:175], a[12:15]
  v_exp_f32 v224, v224
  v_mfma_f32_16x16x32_bf16 a[16:19], v[52:55], v[160:163], a[16:19]
  v_exp_f32 v225, v225
  v_mfma_f32_16x16x32_bf16 a[20:23], v[52:55], v[164:167], a[20:23]
  ds_read_b64_tr_b16 v[48:49], v31 offset:16384
  ds_read_b64_tr_b16 v[50:51], v31 offset:20480
  v_mfma_f32_16x16x32_bf16 a[24:27], v[52:55], v[168:171], a[24:27]
  s_mov_b32 s39, 40960
  v_mfma_f32_16x16x32_bf16 a[28:31], v[52:55], v[172:175], a[28:31]
  s_waitcnt lgkmcnt(6)
  v_mfma_f32_16x16x32_bf16 a[32:35], v[56:59], v[160:163], a[32:35]
  v_exp_f32 v226, v226
  v_mfma_f32_16x16x32_bf16 a[36:39], v[56:59], v[164:167], a[36:39]
  ds_read_b64_tr_b16 v[52:53], v32 offset:16384
  ds_read_b64_tr_b16 v[54:55], v32 offset:20480
  v_mfma_f32_16x16x32_bf16 a[40:43], v[56:59], v[168:171], a[40:43]
  buffer_load_dwordx4 v19, s[24:27], s39 offen lds
  v_mfma_f32_16x16x32_bf16 a[44:47], v[56:59], v[172:175], a[44:47]
  v_exp_f32 v227, v227
  v_mfma_f32_16x16x32_bf16 a[48:51], v[60:63], v[160:163], a[48:51]
  v_exp_f32 v228, v228
  v_mfma_f32_16x16x32_bf16 a[52:55], v[60:63], v[164:167], a[52:55]
  buffer_load_dwordx4 v20, s[24:27], s39 offen offset:1024 lds
  v_mfma_f32_16x16x32_bf16 a[56:59], v[60:63], v[168:171], a[56:59]
  v_exp_f32 v229, v229
  v_mfma_f32_16x16x32_bf16 a[60:63], v[60:63], v[172:175], a[60:63]
  v_exp_f32 v230, v230
  v_mfma_f32_16x16x32_bf16 a[128:131], v[34:37], v[160:163], a[128:131]
  v_exp_f32 v231, v231
  v_mfma_f32_16x16x32_bf16 a[132:135], v[34:37], v[164:167], a[132:135]
  ds_read_b128 v[56:59], v21 offset:0
  v_cvt_pk_bf16_f32 v176, v224, v225
  v_mfma_f32_16x16x32_bf16 a[136:139], v[34:37], v[168:171], a[136:139]
  buffer_store_dwordx4 a[196:199], v16, s[28:31], s69 offen offset:1024 sc1
  v_mfma_f32_16x16x32_bf16 a[140:143], v[34:37], v[172:175], a[140:143]
  v_cvt_pk_bf16_f32 v177, v226, v227
  s_waitcnt lgkmcnt(5)
  v_mfma_f32_16x16x32_bf16 a[64:67], v[64:67], v[160:163], a[64:67]
  v_exp_f32 v232, v232
  v_mfma_f32_16x16x32_bf16 a[68:71], v[64:67], v[164:167], a[68:71]
  ds_read_b128 v[60:63], v22 offset:0
  v_mfma_f32_16x16x32_bf16 a[72:75], v[64:67], v[168:171], a[72:75]
  buffer_store_dwordx4 a[200:203], v16, s[28:31], s69 offen offset:2048 sc1
  v_mfma_f32_16x16x32_bf16 a[76:79], v[64:67], v[172:175], a[76:79]
  v_exp_f32 v233, v233
  v_mfma_f32_16x16x32_bf16 a[80:83], v[68:71], v[160:163], a[80:83]
  v_exp_f32 v234, v234
  v_mfma_f32_16x16x32_bf16 a[84:87], v[68:71], v[164:167], a[84:87]
  ds_read_b128 v[64:67], v23 offset:0
  v_mfma_f32_16x16x32_bf16 a[88:91], v[68:71], v[168:171], a[88:91]
  buffer_store_dwordx4 a[204:207], v16, s[28:31], s69 offen offset:3072 sc1
  v_mfma_f32_16x16x32_bf16 a[92:95], v[68:71], v[172:175], a[92:95]
  s_waitcnt lgkmcnt(3)
  v_mfma_f32_16x16x32_bf16 a[96:99], v[48:51], v[160:163], a[96:99]
  v_exp_f32 v235, v235
  v_mfma_f32_16x16x32_bf16 a[100:103], v[48:51], v[164:167], a[100:103]
  ds_read_b128 v[68:71], v24 offset:0
  s_add_u32 m0, s42, 24576
  v_mfma_f32_16x16x32_bf16 a[104:107], v[48:51], v[168:171], a[104:107]
  v_cvt_pk_bf16_f32 v180, v228, v229
  v_cvt_pk_bf16_f32 v181, v230, v231
  v_mfma_f32_16x16x32_bf16 a[108:111], v[48:51], v[172:175], a[108:111]
  v_exp_f32 v236, v236
  v_mfma_f32_16x16x32_bf16 a[112:115], v[52:55], v[160:163], a[112:115]
  v_exp_f32 v237, v237
  v_mfma_f32_16x16x32_bf16 a[116:119], v[52:55], v[164:167], a[116:119]
  ds_read_b128 v[48:51], v21 offset:4096
  s_mov_b32 s39, 57344
  v_mfma_f32_16x16x32_bf16 a[120:123], v[52:55], v[168:171], a[120:123]
  v_exp_f32 v238, v238
  v_mfma_f32_16x16x32_bf16 a[124:127], v[52:55], v[172:175], a[124:127]
  s_waitcnt lgkmcnt(3)
  v_mfma_f32_16x16x32_bf16 v[192:195], v[56:59], v[80:83], v[144:147]
  v_exp_f32 v239, v239
  v_mfma_f32_16x16x32_bf16 v[196:199], v[56:59], v[84:87], v[148:151]
  ds_read_b128 v[52:55], v22 offset:4096
  v_cvt_pk_bf16_f32 v184, v232, v233
  v_mfma_f32_16x16x32_bf16 v[200:203], v[56:59], v[88:91], v[152:155]
  buffer_load_dwordx4 v17, s[20:23], s39 offen lds
  v_mfma_f32_16x16x32_bf16 v[204:207], v[56:59], v[92:95], v[156:159]
  v_cvt_pk_bf16_f32 v185, v234, v235
  v_mfma_f32_16x16x32_bf16 v[192:195], v[60:63], v[96:99], v[192:195]
  v_exp_f32 v240, v240
  v_mfma_f32_16x16x32_bf16 v[196:199], v[60:63], v[100:103], v[196:199]
  ds_read_b128 v[56:59], v23 offset:4096
  v_mfma_f32_16x16x32_bf16 v[200:203], v[60:63], v[104:107], v[200:203]
  buffer_load_dwordx4 v18, s[20:23], s39 offen offset:1024 lds
  v_mfma_f32_16x16x32_bf16 v[204:207], v[60:63], v[108:111], v[204:207]
  s_waitcnt lgkmcnt(3)
  v_mfma_f32_16x16x32_bf16 v[192:195], v[64:67], v[112:115], v[192:195]
  v_exp_f32 v241, v241
  v_mfma_f32_16x16x32_bf16 v[196:199], v[64:67], v[116:119], v[196:199]
  ds_read_b128 v[60:63], v24 offset:4096
  v_mfma_f32_16x16x32_bf16 v[200:203], v[64:67], v[120:123], v[200:203]
  v_exp_f32 v242, v242
  v_mfma_f32_16x16x32_bf16 v[204:207], v[64:67], v[124:127], v[204:207]
  v_exp_f32 v243, v243
  v_mfma_f32_16x16x32_bf16 v[192:195], v[68:71], v[128:131], v[192:195]
  v_cvt_pk_bf16_f32 v188, v236, v237
  v_cvt_pk_bf16_f32 v189, v238, v239
  v_mfma_f32_16x16x32_bf16 v[196:199], v[68:71], v[132:135], v[196:199]
  ds_read_b64_tr_b16 v[64:65], v25 offset:24576
  ds_read_b64_tr_b16 v[66:67], v25 offset:28672
  v_mfma_f32_16x16x32_bf16 v[200:203], v[68:71], v[136:139], v[200:203]
  v_exp_f32 v244, v244
  v_mfma_f32_16x16x32_bf16 v[204:207], v[68:71], v[140:143], v[204:207]
  s_waitcnt lgkmcnt(4)
  v_mfma_f32_16x16x32_bf16 v[208:211], v[48:51], v[80:83], v[144:147]
  v_exp_f32 v245, v245
  v_mfma_f32_16x16x32_bf16 v[212:215], v[48:51], v[84:87], v[148:151]
  ds_read_b64_tr_b16 v[68:69], v26 offset:24576
  ds_read_b64_tr_b16 v[70:71], v26 offset:28672
  v_mfma_f32_16x16x32_bf16 v[216:219], v[48:51], v[88:91], v[152:155]
  v_exp_f32 v246, v246
  v_mfma_f32_16x16x32_bf16 v[220:223], v[48:51], v[92:95], v[156:159]
  v_exp_f32 v247, v247
  v_mfma_f32_16x16x32_bf16 v[208:211], v[52:55], v[96:99], v[208:211]
  v_cvt_pk_bf16_f32 v178, v240, v241
  v_cvt_pk_bf16_f32 v179, v242, v243
  v_mfma_f32_16x16x32_bf16 v[212:215], v[52:55], v[100:103], v[212:215]
  ds_read_b64_tr_b16 v[48:49], v27 offset:24576
  ds_read_b64_tr_b16 v[50:51], v27 offset:28672
  v_mfma_f32_16x16x32_bf16 v[216:219], v[52:55], v[104:107], v[216:219]
  v_exp_f32 v248, v248
  v_mfma_f32_16x16x32_bf16 v[220:223], v[52:55], v[108:111], v[220:223]
  s_waitcnt lgkmcnt(6)
  v_mfma_f32_16x16x32_bf16 v[208:211], v[56:59], v[112:115], v[208:211]
  v_exp_f32 v249, v249
  v_mfma_f32_16x16x32_bf16 v[212:215], v[56:59], v[116:119], v[212:215]
  ds_read_b64_tr_b16 v[52:53], v28 offset:24576
  ds_read_b64_tr_b16 v[54:55], v28 offset:28672
  v_mfma_f32_16x16x32_bf16 v[216:219], v[56:59], v[120:123], v[216:219]
  v_exp_f32 v250, v250
  v_mfma_f32_16x16x32_bf16 v[220:223], v[56:59], v[124:127], v[220:223]
  v_exp_f32 v251, v251
  v_mfma_f32_16x16x32_bf16 v[208:211], v[60:63], v[128:131], v[208:211]
  v_cvt_pk_bf16_f32 v182, v244, v245
  v_cvt_pk_bf16_f32 v183, v246, v247
  v_mfma_f32_16x16x32_bf16 v[212:215], v[60:63], v[132:135], v[212:215]
  v_exp_f32 v252, v252
  v_mfma_f32_16x16x32_bf16 v[216:219], v[60:63], v[136:139], v[216:219]
  v_exp_f32 v253, v253
  v_exp_f32 v254, v254
  v_exp_f32 v255, v255
  v_cvt_pk_bf16_f32 v186, v248, v249
  v_cvt_pk_bf16_f32 v187, v250, v251
  v_cvt_pk_bf16_f32 v190, v252, v253
  v_cvt_pk_bf16_f32 v191, v254, v255
  v_mfma_f32_16x16x32_bf16 v[220:223], v[60:63], v[140:143], v[220:223]
  s_waitcnt vmcnt(12)
  s_barrier
  s_waitcnt lgkmcnt(4)
  v_mfma_f32_16x16x32_bf16 a[0:3], v[64:67], v[176:179], a[0:3]
  ds_read_b64_tr_b16 v[56:57], v29 offset:24576
  ds_read_b64_tr_b16 v[58:59], v29 offset:28672
  v_mfma_f32_16x16x32_bf16 a[4:7], v[64:67], v[180:183], a[4:7]
  ds_read_b64_tr_b16 v[60:61], v30 offset:24576
  ds_read_b64_tr_b16 v[62:63], v30 offset:28672
  v_mfma_f32_16x16x32_bf16 a[8:11], v[64:67], v[184:187], a[8:11]
  s_add_u32 m0, s42, 49152
  v_mfma_f32_16x16x32_bf16 a[12:15], v[64:67], v[188:191], a[12:15]
  v_exp_f32 v192, v192
  v_mfma_f32_16x16x32_bf16 a[16:19], v[68:71], v[176:179], a[16:19]
  v_exp_f32 v193, v193
  v_mfma_f32_16x16x32_bf16 a[20:23], v[68:71], v[180:183], a[20:23]
  ds_read_b64_tr_b16 v[64:65], v31 offset:24576
  ds_read_b64_tr_b16 v[66:67], v31 offset:28672
  v_mfma_f32_16x16x32_bf16 a[24:27], v[68:71], v[184:187], a[24:27]
  s_mov_b32 s39, 49152
  v_mfma_f32_16x16x32_bf16 a[28:31], v[68:71], v[188:191], a[28:31]
  s_waitcnt lgkmcnt(6)
  v_mfma_f32_16x16x32_bf16 a[32:35], v[48:51], v[176:179], a[32:35]
  v_exp_f32 v194, v194
  v_mfma_f32_16x16x32_bf16 a[36:39], v[48:51], v[180:183], a[36:39]
  ds_read_b64_tr_b16 v[68:69], v32 offset:24576
  ds_read_b64_tr_b16 v[70:71], v32 offset:28672
  v_mfma_f32_16x16x32_bf16 a[40:43], v[48:51], v[184:187], a[40:43]
  buffer_load_dwordx4 v19, s[24:27], s39 offen lds
  v_mfma_f32_16x16x32_bf16 a[44:47], v[48:51], v[188:191], a[44:47]
  v_exp_f32 v195, v195
  v_mfma_f32_16x16x32_bf16 a[48:51], v[52:55], v[176:179], a[48:51]
  v_exp_f32 v196, v196
  v_mfma_f32_16x16x32_bf16 a[52:55], v[52:55], v[180:183], a[52:55]
  buffer_load_dwordx4 v20, s[24:27], s39 offen offset:1024 lds
  v_mfma_f32_16x16x32_bf16 a[56:59], v[52:55], v[184:187], a[56:59]
  v_exp_f32 v197, v197
  v_mfma_f32_16x16x32_bf16 a[60:63], v[52:55], v[188:191], a[60:63]
  v_exp_f32 v198, v198
  v_mfma_f32_16x16x32_bf16 a[128:131], v[34:37], v[176:179], a[128:131]
  v_exp_f32 v199, v199
  v_mfma_f32_16x16x32_bf16 a[132:135], v[34:37], v[180:183], a[132:135]
  ds_read_b128 v[48:51], v21 offset:8192
  v_cvt_pk_bf16_f32 v160, v192, v193
  v_mfma_f32_16x16x32_bf16 a[136:139], v[34:37], v[184:187], a[136:139]
  buffer_store_dwordx2 a[208:209], v33, s[28:31], s101 offen offset:0 sc1
  v_mfma_f32_16x16x32_bf16 a[140:143], v[34:37], v[188:191], a[140:143]
  v_cvt_pk_bf16_f32 v161, v194, v195
  s_waitcnt lgkmcnt(5)
  v_mfma_f32_16x16x32_bf16 a[64:67], v[56:59], v[176:179], a[64:67]
  v_exp_f32 v200, v200
  v_mfma_f32_16x16x32_bf16 a[68:71], v[56:59], v[180:183], a[68:71]
  ds_read_b128 v[52:55], v22 offset:8192
  v_mfma_f32_16x16x32_bf16 a[72:75], v[56:59], v[184:187], a[72:75]
  buffer_store_dwordx2 a[210:211], v33, s[28:31], s101 offen offset:1024 sc1
  v_mfma_f32_16x16x32_bf16 a[76:79], v[56:59], v[188:191], a[76:79]
  v_exp_f32 v201, v201
  v_mfma_f32_16x16x32_bf16 a[80:83], v[60:63], v[176:179], a[80:83]
  v_exp_f32 v202, v202
  v_mfma_f32_16x16x32_bf16 a[84:87], v[60:63], v[180:183], a[84:87]
  ds_read_b128 v[56:59], v23 offset:8192
  s_add_u32 m0, s42, 0
  v_mfma_f32_16x16x32_bf16 a[88:91], v[60:63], v[184:187], a[88:91]
  v_exp_f32 v203, v203
  v_mfma_f32_16x16x32_bf16 a[92:95], v[60:63], v[188:191], a[92:95]
  v_cvt_pk_bf16_f32 v164, v196, v197
  s_waitcnt lgkmcnt(3)
  v_mfma_f32_16x16x32_bf16 a[96:99], v[64:67], v[176:179], a[96:99]
  v_cvt_pk_bf16_f32 v165, v198, v199
  v_mfma_f32_16x16x32_bf16 a[100:103], v[64:67], v[180:183], a[100:103]
  ds_read_b128 v[60:63], v24 offset:8192
  s_mov_b32 s39, 65536
  v_mfma_f32_16x16x32_bf16 a[104:107], v[64:67], v[184:187], a[104:107]
  v_exp_f32 v204, v204
  v_mfma_f32_16x16x32_bf16 a[108:111], v[64:67], v[188:191], a[108:111]
  v_exp_f32 v205, v205
  v_mfma_f32_16x16x32_bf16 a[112:115], v[68:71], v[176:179], a[112:115]
  v_exp_f32 v206, v206
  v_mfma_f32_16x16x32_bf16 a[116:119], v[68:71], v[180:183], a[116:119]
  ds_read_b128 v[64:67], v21 offset:12288
  v_mfma_f32_16x16x32_bf16 a[120:123], v[68:71], v[184:187], a[120:123]
  buffer_load_dwordx4 v17, s[20:23], s39 offen lds
  v_mfma_f32_16x16x32_bf16 a[124:127], v[68:71], v[188:191], a[124:127]
  s_waitcnt lgkmcnt(3)
  v_mfma_f32_16x16x32_bf16 v[224:227], v[48:51], v[80:83], v[144:147]
  v_exp_f32 v207, v207
  v_mfma_f32_16x16x32_bf16 v[228:231], v[48:51], v[84:87], v[148:151]
  ds_read_b128 v[68:71], v22 offset:12288
  v_cvt_pk_bf16_f32 v168, v200, v201
  v_mfma_f32_16x16x32_bf16 v[232:235], v[48:51], v[88:91], v[152:155]
  buffer_load_dwordx4 v18, s[20:23], s39 offen offset:1024 lds
  v_mfma_f32_16x16x32_bf16 v[236:239], v[48:51], v[92:95], v[156:159]
  v_cvt_pk_bf16_f32 v169, v202, v203
  v_mfma_f32_16x16x32_bf16 v[224:227], v[52:55], v[96:99], v[224:227]
  v_exp_f32 v208, v208
  v_mfma_f32_16x16x32_bf16 v[228:231], v[52:55], v[100:103], v[228:231]
  ds_read_b128 v[48:51], v23 offset:12288
  v_mfma_f32_16x16x32_bf16 v[232:235], v[52:55], v[104:107], v[232:235]
  v_exp_f32 v209, v209
  v_mfma_f32_16x16x32_bf16 v[236:239], v[52:55], v[108:111], v[236:239]
  s_waitcnt lgkmcnt(3)
  v_mfma_f32_16x16x32_bf16 v[224:227], v[56:59], v[112:115], v[224:227]
  v_exp_f32 v210, v210
  v_mfma_f32_16x16x32_bf16 v[228:231], v[56:59], v[116:119], v[228:231]
  ds_read_b128 v[52:55], v24 offset:12288
  v_mfma_f32_16x16x32_bf16 v[232:235], v[56:59], v[120:123], v[232:235]
  v_exp_f32 v211, v211
  v_mfma_f32_16x16x32_bf16 v[236:239], v[56:59], v[124:127], v[236:239]
  v_cvt_pk_bf16_f32 v172, v204, v205
  v_cvt_pk_bf16_f32 v173, v206, v207
  v_mfma_f32_16x16x32_bf16 v[224:227], v[60:63], v[128:131], v[224:227]
  v_exp_f32 v212, v212
  v_mfma_f32_16x16x32_bf16 v[228:231], v[60:63], v[132:135], v[228:231]
  ds_read_b64_tr_b16 v[56:57], v25 offset:0
  ds_read_b64_tr_b16 v[58:59], v25 offset:4096
  v_mfma_f32_16x16x32_bf16 v[232:235], v[60:63], v[136:139], v[232:235]
  v_exp_f32 v213, v213
  v_mfma_f32_16x16x32_bf16 v[236:239], v[60:63], v[140:143], v[236:239]
  s_waitcnt lgkmcnt(4)
  v_mfma_f32_16x16x32_bf16 v[240:243], v[64:67], v[80:83], v[144:147]
  v_exp_f32 v214, v214
  v_mfma_f32_16x16x32_bf16 v[244:247], v[64:67], v[84:87], v[148:151]
  ds_read_b64_tr_b16 v[60:61], v26 offset:0
  ds_read_b64_tr_b16 v[62:63], v26 offset:4096
  v_mfma_f32_16x16x32_bf16 v[248:251], v[64:67], v[88:91], v[152:155]
  v_exp_f32 v215, v215
  v_mfma_f32_16x16x32_bf16 v[252:255], v[64:67], v[92:95], v[156:159]
  v_cvt_pk_bf16_f32 v162, v208, v209
  v_cvt_pk_bf16_f32 v163, v210, v211
  v_mfma_f32_16x16x32_bf16 v[240:243], v[68:71], v[96:99], v[240:243]
  v_exp_f32 v216, v216
  v_mfma_f32_16x16x32_bf16 v[244:247], v[68:71], v[100:103], v[244:247]
  ds_read_b64_tr_b16 v[64:65], v27 offset:0
  ds_read_b64_tr_b16 v[66:67], v27 offset:4096
  v_mfma_f32_16x16x32_bf16 v[248:251], v[68:71], v[104:107], v[248:251]
  v_exp_f32 v217, v217
  v_mfma_f32_16x16x32_bf16 v[252:255], v[68:71], v[108:111], v[252:255]
  s_waitcnt lgkmcnt(6)
  v_mfma_f32_16x16x32_bf16 v[240:243], v[48:51], v[112:115], v[240:243]
  v_exp_f32 v218, v218
  v_mfma_f32_16x16x32_bf16 v[244:247], v[48:51], v[116:119], v[244:247]
  ds_read_b64_tr_b16 v[68:69], v28 offset:0
  ds_read_b64_tr_b16 v[70:71], v28 offset:4096
  v_mfma_f32_16x16x32_bf16 v[248:251], v[48:51], v[120:123], v[248:251]
  v_exp_f32 v219, v219
  v_mfma_f32_16x16x32_bf16 v[252:255], v[48:51], v[124:127], v[252:255]
  v_cvt_pk_bf16_f32 v166, v212, v213
  v_cvt_pk_bf16_f32 v167, v214, v215
  v_mfma_f32_16x16x32_bf16 v[240:243], v[52:55], v[128:131], v[240:243]
  v_exp_f32 v220, v220
  v_mfma_f32_16x16x32_bf16 v[244:247], v[52:55], v[132:135], v[244:247]
  v_exp_f32 v221, v221
  v_mfma_f32_16x16x32_bf16 v[248:251], v[52:55], v[136:139], v[248:251]
  v_exp_f32 v222, v222
  v_exp_f32 v223, v223
  v_cvt_pk_bf16_f32 v170, v216, v217
  v_cvt_pk_bf16_f32 v171, v218, v219
  v_cvt_pk_bf16_f32 v174, v220, v221
  v_cvt_pk_bf16_f32 v175, v222, v223
  v_mfma_f32_16x16x32_bf16 v[252:255], v[52:55], v[140:143], v[252:255]
  s_waitcnt vmcnt(11)
  s_barrier
  s_waitcnt lgkmcnt(4)
  v_mfma_f32_16x16x32_bf16 a[0:3], v[56:59], v[160:163], a[0:3]
  ds_read_b64_tr_b16 v[48:49], v29 offset:0
  ds_read_b64_tr_b16 v[50:51], v29 offset:4096
  v_mfma_f32_16x16x32_bf16 a[4:7], v[56:59], v[164:167], a[4:7]
  ds_read_b64_tr_b16 v[52:53], v30 offset:0
  ds_read_b64_tr_b16 v[54:55], v30 offset:4096
  v_mfma_f32_16x16x32_bf16 a[8:11], v[56:59], v[168:171], a[8:11]
  s_add_u32 m0, s42, 57344
  v_mfma_f32_16x16x32_bf16 a[12:15], v[56:59], v[172:175], a[12:15]
  v_exp_f32 v224, v224
  v_mfma_f32_16x16x32_bf16 a[16:19], v[60:63], v[160:163], a[16:19]
  v_exp_f32 v225, v225
  v_mfma_f32_16x16x32_bf16 a[20:23], v[60:63], v[164:167], a[20:23]
  ds_read_b64_tr_b16 v[56:57], v31 offset:0
  ds_read_b64_tr_b16 v[58:59], v31 offset:4096
  v_mfma_f32_16x16x32_bf16 a[24:27], v[60:63], v[168:171], a[24:27]
  s_mov_b32 s39, 57344
  v_mfma_f32_16x16x32_bf16 a[28:31], v[60:63], v[172:175], a[28:31]
  s_waitcnt lgkmcnt(6)
  v_mfma_f32_16x16x32_bf16 a[32:35], v[64:67], v[160:163], a[32:35]
  v_exp_f32 v226, v226
  v_mfma_f32_16x16x32_bf16 a[36:39], v[64:67], v[164:167], a[36:39]
  ds_read_b64_tr_b16 v[60:61], v32 offset:0
  ds_read_b64_tr_b16 v[62:63], v32 offset:4096
  v_mfma_f32_16x16x32_bf16 a[40:43], v[64:67], v[168:171], a[40:43]
  buffer_load_dwordx4 v19, s[24:27], s39 offen lds
  v_mfma_f32_16x16x32_bf16 a[44:47], v[64:67], v[172:175], a[44:47]
  v_exp_f32 v227, v227
  v_mfma_f32_16x16x32_bf16 a[48:51], v[68:71], v[160:163], a[48:51]
  v_exp_f32 v228, v228
  v_mfma_f32_16x16x32_bf16 a[52:55], v[68:71], v[164:167], a[52:55]
  buffer_load_dwordx4 v20, s[24:27], s39 offen offset:1024 lds
  v_mfma_f32_16x16x32_bf16 a[56:59], v[68:71], v[168:171], a[56:59]
  v_exp_f32 v229, v229
  v_mfma_f32_16x16x32_bf16 a[60:63], v[68:71], v[172:175], a[60:63]
  v_exp_f32 v230, v230
  v_mfma_f32_16x16x32_bf16 a[128:131], v[34:37], v[160:163], a[128:131]
  v_exp_f32 v231, v231
  v_mfma_f32_16x16x32_bf16 a[132:135], v[34:37], v[164:167], a[132:135]
  ds_read_b128 v[64:67], v21 offset:16384
  v_cvt_pk_bf16_f32 v176, v224, v225
  v_mfma_f32_16x16x32_bf16 a[136:139], v[34:37], v[168:171], a[136:139]
  buffer_store_dwordx2 a[212:213], v33, s[28:31], s101 offen offset:2048 sc1
  v_mfma_f32_16x16x32_bf16 a[140:143], v[34:37], v[172:175], a[140:143]
  v_cvt_pk_bf16_f32 v177, v226, v227
  s_waitcnt lgkmcnt(5)
  v_mfma_f32_16x16x32_bf16 a[64:67], v[48:51], v[160:163], a[64:67]
  v_exp_f32 v232, v232
  v_mfma_f32_16x16x32_bf16 a[68:71], v[48:51], v[164:167], a[68:71]
  ds_read_b128 v[68:71], v22 offset:16384
  v_mfma_f32_16x16x32_bf16 a[72:75], v[48:51], v[168:171], a[72:75]
  buffer_store_dwordx2 a[214:215], v33, s[28:31], s101 offen offset:3072 sc1
  v_mfma_f32_16x16x32_bf16 a[76:79], v[48:51], v[172:175], a[76:79]
  v_exp_f32 v233, v233
  v_mfma_f32_16x16x32_bf16 a[80:83], v[52:55], v[160:163], a[80:83]
  v_exp_f32 v234, v234
  v_mfma_f32_16x16x32_bf16 a[84:87], v[52:55], v[164:167], a[84:87]
  ds_read_b128 v[48:51], v23 offset:16384
  s_add_u32 m0, s42, 8192
  v_mfma_f32_16x16x32_bf16 a[88:91], v[52:55], v[168:171], a[88:91]
  v_exp_f32 v235, v235
  v_mfma_f32_16x16x32_bf16 a[92:95], v[52:55], v[172:175], a[92:95]
  v_cvt_pk_bf16_f32 v180, v228, v229
  s_waitcnt lgkmcnt(3)
  v_mfma_f32_16x16x32_bf16 a[96:99], v[56:59], v[160:163], a[96:99]
  v_cvt_pk_bf16_f32 v181, v230, v231
  v_mfma_f32_16x16x32_bf16 a[100:103], v[56:59], v[164:167], a[100:103]
  ds_read_b128 v[52:55], v24 offset:16384
  s_mov_b32 s39, 73728
  v_mfma_f32_16x16x32_bf16 a[104:107], v[56:59], v[168:171], a[104:107]
  v_exp_f32 v236, v236
  v_mfma_f32_16x16x32_bf16 a[108:111], v[56:59], v[172:175], a[108:111]
  v_exp_f32 v237, v237
  v_mfma_f32_16x16x32_bf16 a[112:115], v[60:63], v[160:163], a[112:115]
  v_exp_f32 v238, v238
  v_mfma_f32_16x16x32_bf16 a[116:119], v[60:63], v[164:167], a[116:119]
  ds_read_b128 v[56:59], v21 offset:20480
  v_mfma_f32_16x16x32_bf16 a[120:123], v[60:63], v[168:171], a[120:123]
  buffer_load_dwordx4 v17, s[20:23], s39 offen lds
  v_mfma_f32_16x16x32_bf16 a[124:127], v[60:63], v[172:175], a[124:127]
  s_waitcnt lgkmcnt(3)
  v_mfma_f32_16x16x32_bf16 v[192:195], v[64:67], v[80:83], v[144:147]
  v_exp_f32 v239, v239
  v_mfma_f32_16x16x32_bf16 v[196:199], v[64:67], v[84:87], v[148:151]
  ds_read_b128 v[60:63], v22 offset:20480
  v_cvt_pk_bf16_f32 v184, v232, v233
  v_mfma_f32_16x16x32_bf16 v[200:203], v[64:67], v[88:91], v[152:155]
  buffer_load_dwordx4 v18, s[20:23], s39 offen offset:1024 lds
  v_mfma_f32_16x16x32_bf16 v[204:207], v[64:67], v[92:95], v[156:159]
  v_cvt_pk_bf16_f32 v185, v234, v235
  v_mfma_f32_16x16x32_bf16 v[192:195], v[68:71], v[96:99], v[192:195]
  v_exp_f32 v240, v240
  v_mfma_f32_16x16x32_bf16 v[196:199], v[68:71], v[100:103], v[196:199]
  ds_read_b128 v[64:67], v23 offset:20480
  v_mfma_f32_16x16x32_bf16 v[200:203], v[68:71], v[104:107], v[200:203]
  v_exp_f32 v241, v241
  v_mfma_f32_16x16x32_bf16 v[204:207], v[68:71], v[108:111], v[204:207]
  s_waitcnt lgkmcnt(3)
  v_mfma_f32_16x16x32_bf16 v[192:195], v[48:51], v[112:115], v[192:195]
  v_exp_f32 v242, v242
  v_mfma_f32_16x16x32_bf16 v[196:199], v[48:51], v[116:119], v[196:199]
  ds_read_b128 v[68:71], v24 offset:20480
  v_mfma_f32_16x16x32_bf16 v[200:203], v[48:51], v[120:123], v[200:203]
  v_exp_f32 v243, v243
  v_mfma_f32_16x16x32_bf16 v[204:207], v[48:51], v[124:127], v[204:207]
  v_cvt_pk_bf16_f32 v188, v236, v237
  v_cvt_pk_bf16_f32 v189, v238, v239
  v_mfma_f32_16x16x32_bf16 v[192:195], v[52:55], v[128:131], v[192:195]
  v_exp_f32 v244, v244
  v_mfma_f32_16x16x32_bf16 v[196:199], v[52:55], v[132:135], v[196:199]
  ds_read_b64_tr_b16 v[48:49], v25 offset:8192
  ds_read_b64_tr_b16 v[50:51], v25 offset:12288
  v_mfma_f32_16x16x32_bf16 v[200:203], v[52:55], v[136:139], v[200:203]
  v_exp_f32 v245, v245
  v_mfma_f32_16x16x32_bf16 v[204:207], v[52:55], v[140:143], v[204:207]
  s_waitcnt lgkmcnt(4)
  v_mfma_f32_16x16x32_bf16 v[208:211], v[56:59], v[80:83], v[144:147]
  v_exp_f32 v246, v246
  v_mfma_f32_16x16x32_bf16 v[212:215], v[56:59], v[84:87], v[148:151]
  ds_read_b64_tr_b16 v[52:53], v26 offset:8192
  ds_read_b64_tr_b16 v[54:55], v26 offset:12288
  v_mfma_f32_16x16x32_bf16 v[216:219], v[56:59], v[88:91], v[152:155]
  v_exp_f32 v247, v247
  v_mfma_f32_16x16x32_bf16 v[220:223], v[56:59], v[92:95], v[156:159]
  v_cvt_pk_bf16_f32 v178, v240, v241
  v_cvt_pk_bf16_f32 v179, v242, v243
  v_mfma_f32_16x16x32_bf16 v[208:211], v[60:63], v[96:99], v[208:211]
  v_exp_f32 v248, v248
  v_mfma_f32_16x16x32_bf16 v[212:215], v[60:63], v[100:103], v[212:215]
  ds_read_b64_tr_b16 v[56:57], v27 offset:8192
  ds_read_b64_tr_b16 v[58:59], v27 offset:12288
  v_mfma_f32_16x16x32_bf16 v[216:219], v[60:63], v[104:107], v[216:219]
  v_exp_f32 v249, v249
  v_mfma_f32_16x16x32_bf16 v[220:223], v[60:63], v[108:111], v[220:223]
  s_waitcnt lgkmcnt(6)
  v_mfma_f32_16x16x32_bf16 v[208:211], v[64:67], v[112:115], v[208:211]
  v_exp_f32 v250, v250
  v_mfma_f32_16x16x32_bf16 v[212:215], v[64:67], v[116:119], v[212:215]
  ds_read_b64_tr_b16 v[60:61], v28 offset:8192
  ds_read_b64_tr_b16 v[62:63], v28 offset:12288
  v_mfma_f32_16x16x32_bf16 v[216:219], v[64:67], v[120:123], v[216:219]
  v_exp_f32 v251, v251
  v_mfma_f32_16x16x32_bf16 v[220:223], v[64:67], v[124:127], v[220:223]
  v_cvt_pk_bf16_f32 v182, v244, v245
  v_cvt_pk_bf16_f32 v183, v246, v247
  v_mfma_f32_16x16x32_bf16 v[208:211], v[68:71], v[128:131], v[208:211]
  v_exp_f32 v252, v252
  v_mfma_f32_16x16x32_bf16 v[212:215], v[68:71], v[132:135], v[212:215]
  v_exp_f32 v253, v253
  v_mfma_f32_16x16x32_bf16 v[216:219], v[68:71], v[136:139], v[216:219]
  v_exp_f32 v254, v254
  v_exp_f32 v255, v255
  v_cvt_pk_bf16_f32 v186, v248, v249
  v_cvt_pk_bf16_f32 v187, v250, v251
  v_cvt_pk_bf16_f32 v190, v252, v253
  v_cvt_pk_bf16_f32 v191, v254, v255
  v_mfma_f32_16x16x32_bf16 v[220:223], v[68:71], v[140:143], v[220:223]
  s_waitcnt vmcnt(10)
  s_barrier
  s_waitcnt lgkmcnt(4)
  v_mfma_f32_16x16x32_bf16 a[0:3], v[48:51], v[176:179], a[0:3]
  ds_read_b64_tr_b16 v[64:65], v29 offset:8192
  ds_read_b64_tr_b16 v[66:67], v29 offset:12288
  v_mfma_f32_16x16x32_bf16 a[4:7], v[48:51], v[180:183], a[4:7]
  ds_read_b64_tr_b16 v[68:69], v30 offset:8192
  ds_read_b64_tr_b16 v[70:71], v30 offset:12288
  v_mfma_f32_16x16x32_bf16 a[8:11], v[48:51], v[184:187], a[8:11]
  s_add_u32 m0, s42, 32768
  v_mfma_f32_16x16x32_bf16 a[12:15], v[48:51], v[188:191], a[12:15]
  v_exp_f32 v192, v192
  v_mfma_f32_16x16x32_bf16 a[16:19], v[52:55], v[176:179], a[16:19]
  v_exp_f32 v193, v193
  v_mfma_f32_16x16x32_bf16 a[20:23], v[52:55], v[180:183], a[20:23]
  ds_read_b64_tr_b16 v[48:49], v31 offset:8192
  ds_read_b64_tr_b16 v[50:51], v31 offset:12288
  v_mfma_f32_16x16x32_bf16 a[24:27], v[52:55], v[184:187], a[24:27]
  s_mov_b32 s39, 65536
  v_mfma_f32_16x16x32_bf16 a[28:31], v[52:55], v[188:191], a[28:31]
  s_waitcnt lgkmcnt(6)
  v_mfma_f32_16x16x32_bf16 a[32:35], v[56:59], v[176:179], a[32:35]
  v_exp_f32 v194, v194
  v_mfma_f32_16x16x32_bf16 a[36:39], v[56:59], v[180:183], a[36:39]
  ds_read_b64_tr_b16 v[52:53], v32 offset:8192
  ds_read_b64_tr_b16 v[54:55], v32 offset:12288
  v_mfma_f32_16x16x32_bf16 a[40:43], v[56:59], v[184:187], a[40:43]
  buffer_load_dwordx4 v19, s[24:27], s39 offen lds
  v_mfma_f32_16x16x32_bf16 a[44:47], v[56:59], v[188:191], a[44:47]
  v_exp_f32 v195, v195
  v_mfma_f32_16x16x32_bf16 a[48:51], v[60:63], v[176:179], a[48:51]
  v_exp_f32 v196, v196
  v_mfma_f32_16x16x32_bf16 a[52:55], v[60:63], v[180:183], a[52:55]
  buffer_load_dwordx4 v20, s[24:27], s39 offen offset:1024 lds
  v_mfma_f32_16x16x32_bf16 a[56:59], v[60:63], v[184:187], a[56:59]
  v_exp_f32 v197, v197
  v_mfma_f32_16x16x32_bf16 a[60:63], v[60:63], v[188:191], a[60:63]
  v_exp_f32 v198, v198
  v_mfma_f32_16x16x32_bf16 a[128:131], v[34:37], v[176:179], a[128:131]
  v_exp_f32 v199, v199
  v_mfma_f32_16x16x32_bf16 a[132:135], v[34:37], v[180:183], a[132:135]
  ds_read_b128 v[56:59], v21 offset:24576
  s_add_u32 m0, s42, 16384
  v_mfma_f32_16x16x32_bf16 a[136:139], v[34:37], v[184:187], a[136:139]
  v_cvt_pk_bf16_f32 v160, v192, v193
  v_cvt_pk_bf16_f32 v161, v194, v195
  v_mfma_f32_16x16x32_bf16 a[140:143], v[34:37], v[188:191], a[140:143]
  s_waitcnt lgkmcnt(5)
  v_mfma_f32_16x16x32_bf16 a[64:67], v[64:67], v[176:179], a[64:67]
  v_exp_f32 v200, v200
  v_mfma_f32_16x16x32_bf16 a[68:71], v[64:67], v[180:183], a[68:71]
  ds_read_b128 v[60:63], v22 offset:24576
  s_mov_b32 s39, 81920
  v_mfma_f32_16x16x32_bf16 a[72:75], v[64:67], v[184:187], a[72:75]
  v_exp_f32 v201, v201
  v_mfma_f32_16x16x32_bf16 a[76:79], v[64:67], v[188:191], a[76:79]
  v_exp_f32 v202, v202
  v_mfma_f32_16x16x32_bf16 a[80:83], v[68:71], v[176:179], a[80:83]
  v_exp_f32 v203, v203
  v_mfma_f32_16x16x32_bf16 a[84:87], v[68:71], v[180:183], a[84:87]
  ds_read_b128 v[64:67], v23 offset:24576
  v_cvt_pk_bf16_f32 v164, v196, v197
  v_mfma_f32_16x16x32_bf16 a[88:91], v[68:71], v[184:187], a[88:91]
  buffer_load_dwordx4 v17, s[20:23], s39 offen lds
  v_mfma_f32_16x16x32_bf16 a[92:95], v[68:71], v[188:191], a[92:95]
  v_cvt_pk_bf16_f32 v165, v198, v199
  s_waitcnt lgkmcnt(3)
  v_mfma_f32_16x16x32_bf16 a[96:99], v[48:51], v[176:179], a[96:99]
  v_exp_f32 v204, v204
  v_mfma_f32_16x16x32_bf16 a[100:103], v[48:51], v[180:183], a[100:103]
  ds_read_b128 v[68:71], v24 offset:24576
  v_mfma_f32_16x16x32_bf16 a[104:107], v[48:51], v[184:187], a[104:107]
  buffer_load_dwordx4 v18, s[20:23], s39 offen offset:1024 lds
  v_mfma_f32_16x16x32_bf16 a[108:111], v[48:51], v[188:191], a[108:111]
  v_exp_f32 v205, v205
  v_mfma_f32_16x16x32_bf16 a[112:115], v[52:55], v[176:179], a[112:115]
  v_exp_f32 v206, v206
  v_mfma_f32_16x16x32_bf16 a[116:119], v[52:55], v[180:183], a[116:119]
  ds_read_b128 v[48:51], v21 offset:28672
  v_mfma_f32_16x16x32_bf16 a[120:123], v[52:55], v[184:187], a[120:123]
  v_exp_f32 v207, v207
  v_mfma_f32_16x16x32_bf16 a[124:127], v[52:55], v[188:191], a[124:127]
  v_cvt_pk_bf16_f32 v168, v200, v201
  s_waitcnt lgkmcnt(3)
  v_mfma_f32_16x16x32_bf16 v[224:227], v[56:59], v[80:83], v[144:147]
  v_cvt_pk_bf16_f32 v169, v202, v203
  v_mfma_f32_16x16x32_bf16 v[228:231], v[56:59], v[84:87], v[148:151]
  ds_read_b128 v[52:55], v22 offset:28672
  v_mfma_f32_16x16x32_bf16 v[232:235], v[56:59], v[88:91], v[152:155]
  v_exp_f32 v208, v208
  v_mfma_f32_16x16x32_bf16 v[236:239], v[56:59], v[92:95], v[156:159]
  v_exp_f32 v209, v209
  v_mfma_f32_16x16x32_bf16 v[224:227], v[60:63], v[96:99], v[224:227]
  v_exp_f32 v210, v210
  v_mfma_f32_16x16x32_bf16 v[228:231], v[60:63], v[100:103], v[228:231]
  ds_read_b128 v[56:59], v23 offset:28672
  v_mfma_f32_16x16x32_bf16 v[232:235], v[60:63], v[104:107], v[232:235]
  v_exp_f32 v211, v211
  v_mfma_f32_16x16x32_bf16 v[236:239], v[60:63], v[108:111], v[236:239]
  v_cvt_pk_bf16_f32 v172, v204, v205
  s_waitcnt lgkmcnt(3)
  v_mfma_f32_16x16x32_bf16 v[224:227], v[64:67], v[112:115], v[224:227]
  v_cvt_pk_bf16_f32 v173, v206, v207
  v_mfma_f32_16x16x32_bf16 v[228:231], v[64:67], v[116:119], v[228:231]
  ds_read_b128 v[60:63], v24 offset:28672
  v_mfma_f32_16x16x32_bf16 v[232:235], v[64:67], v[120:123], v[232:235]
  v_exp_f32 v212, v212
  v_mfma_f32_16x16x32_bf16 v[236:239], v[64:67], v[124:127], v[236:239]
  v_exp_f32 v213, v213
  v_mfma_f32_16x16x32_bf16 v[224:227], v[68:71], v[128:131], v[224:227]
  v_exp_f32 v214, v214
  v_mfma_f32_16x16x32_bf16 v[228:231], v[68:71], v[132:135], v[228:231]
  ds_read_b64_tr_b16 v[64:65], v25 offset:16384
  ds_read_b64_tr_b16 v[66:67], v25 offset:20480
  v_mfma_f32_16x16x32_bf16 v[232:235], v[68:71], v[136:139], v[232:235]
  v_exp_f32 v215, v215
  v_mfma_f32_16x16x32_bf16 v[236:239], v[68:71], v[140:143], v[236:239]
  v_cvt_pk_bf16_f32 v162, v208, v209
  s_waitcnt lgkmcnt(4)
  v_mfma_f32_16x16x32_bf16 v[240:243], v[48:51], v[80:83], v[144:147]
  v_cvt_pk_bf16_f32 v163, v210, v211
  v_mfma_f32_16x16x32_bf16 v[244:247], v[48:51], v[84:87], v[148:151]
  ds_read_b64_tr_b16 v[68:69], v26 offset:16384
  ds_read_b64_tr_b16 v[70:71], v26 offset:20480
  v_mfma_f32_16x16x32_bf16 v[248:251], v[48:51], v[88:91], v[152:155]
  v_exp_f32 v216, v216
  v_mfma_f32_16x16x32_bf16 v[252:255], v[48:51], v[92:95], v[156:159]
  v_exp_f32 v217, v217
  v_mfma_f32_16x16x32_bf16 v[240:243], v[52:55], v[96:99], v[240:243]
  v_exp_f32 v218, v218
  v_mfma_f32_16x16x32_bf16 v[244:247], v[52:55], v[100:103], v[244:247]
  ds_read_b64_tr_b16 v[48:49], v27 offset:16384
  ds_read_b64_tr_b16 v[50:51], v27 offset:20480
  v_mfma_f32_16x16x32_bf16 v[248:251], v[52:55], v[104:107], v[248:251]
  v_exp_f32 v219, v219
  v_mfma_f32_16x16x32_bf16 v[252:255], v[52:55], v[108:111], v[252:255]
  v_cvt_pk_bf16_f32 v166, v212, v213
  s_waitcnt lgkmcnt(6)
  v_mfma_f32_16x16x32_bf16 v[240:243], v[56:59], v[112:115], v[240:243]
  v_cvt_pk_bf16_f32 v167, v214, v215
  v_mfma_f32_16x16x32_bf16 v[244:247], v[56:59], v[116:119], v[244:247]
  ds_read_b64_tr_b16 v[52:53], v28 offset:16384
  ds_read_b64_tr_b16 v[54:55], v28 offset:20480
  v_mfma_f32_16x16x32_bf16 v[248:251], v[56:59], v[120:123], v[248:251]
  v_exp_f32 v220, v220
  v_mfma_f32_16x16x32_bf16 v[252:255], v[56:59], v[124:127], v[252:255]
  v_exp_f32 v221, v221
  v_mfma_f32_16x16x32_bf16 v[240:243], v[60:63], v[128:131], v[240:243]
  v_exp_f32 v222, v222
  v_mfma_f32_16x16x32_bf16 v[244:247], v[60:63], v[132:135], v[244:247]
  v_exp_f32 v223, v223
  v_mfma_f32_16x16x32_bf16 v[248:251], v[60:63], v[136:139], v[248:251]
  v_cvt_pk_bf16_f32 v170, v216, v217
  v_cvt_pk_bf16_f32 v171, v218, v219
  v_cvt_pk_bf16_f32 v174, v220, v221
  v_cvt_pk_bf16_f32 v175, v222, v223
  v_mfma_f32_16x16x32_bf16 v[252:255], v[60:63], v[140:143], v[252:255]
  s_waitcnt vmcnt(6)
  s_barrier
  s_waitcnt lgkmcnt(4)
  v_mfma_f32_16x16x32_bf16 a[0:3], v[64:67], v[160:163], a[0:3]
  ds_read_b64_tr_b16 v[56:57], v29 offset:16384
  ds_read_b64_tr_b16 v[58:59], v29 offset:20480
  v_mfma_f32_16x16x32_bf16 a[4:7], v[64:67], v[164:167], a[4:7]
  ds_read_b64_tr_b16 v[60:61], v30 offset:16384
  ds_read_b64_tr_b16 v[62:63], v30 offset:20480
  v_mfma_f32_16x16x32_bf16 a[8:11], v[64:67], v[168:171], a[8:11]
  v_mov_b32 v75, s100
  buffer_store_dword v75, v77, s[96:99], 0 offen offset:256 sc1
  v_mfma_f32_16x16x32_bf16 a[12:15], v[64:67], v[172:175], a[12:15]
  v_exp_f32 v224, v224
  v_mfma_f32_16x16x32_bf16 a[16:19], v[68:71], v[160:163], a[16:19]
  v_exp_f32 v225, v225
  v_mfma_f32_16x16x32_bf16 a[20:23], v[68:71], v[164:167], a[20:23]
  ds_read_b64_tr_b16 v[64:65], v31 offset:16384
  ds_read_b64_tr_b16 v[66:67], v31 offset:20480
  v_mfma_f32_16x16x32_bf16 a[24:27], v[68:71], v[168:171], a[24:27]
  s_add_u32 m0, s42, 40960
  v_mfma_f32_16x16x32_bf16 a[28:31], v[68:71], v[172:175], a[28:31]
  s_waitcnt lgkmcnt(6)
  v_mfma_f32_16x16x32_bf16 a[32:35], v[48:51], v[160:163], a[32:35]
  v_exp_f32 v226, v226
  v_mfma_f32_16x16x32_bf16 a[36:39], v[48:51], v[164:167], a[36:39]
  ds_read_b64_tr_b16 v[68:69], v32 offset:16384
  ds_read_b64_tr_b16 v[70:71], v32 offset:20480
  v_mfma_f32_16x16x32_bf16 a[40:43], v[48:51], v[168:171], a[40:43]
  s_mov_b32 s39, 73728
  v_mfma_f32_16x16x32_bf16 a[44:47], v[48:51], v[172:175], a[44:47]
  v_exp_f32 v227, v227
  v_mfma_f32_16x16x32_bf16 a[48:51], v[52:55], v[160:163], a[48:51]
  v_exp_f32 v228, v228
  v_mfma_f32_16x16x32_bf16 a[52:55], v[52:55], v[164:167], a[52:55]
  buffer_load_dwordx4 v19, s[24:27], s39 offen lds
  v_mfma_f32_16x16x32_bf16 a[56:59], v[52:55], v[168:171], a[56:59]
  v_exp_f32 v229, v229
  v_mfma_f32_16x16x32_bf16 a[60:63], v[52:55], v[172:175], a[60:63]
  v_exp_f32 v230, v230
  v_mfma_f32_16x16x32_bf16 a[128:131], v[34:37], v[160:163], a[128:131]
  v_exp_f32 v231, v231
  v_mfma_f32_16x16x32_bf16 a[132:135], v[34:37], v[164:167], a[132:135]
  ds_read_b128 v[48:51], v21 offset:0
  v_cvt_pk_bf16_f32 v176, v224, v225
  v_mfma_f32_16x16x32_bf16 a[136:139], v[34:37], v[168:171], a[136:139]
  buffer_load_dwordx4 v20, s[24:27], s39 offen offset:1024 lds
  v_mfma_f32_16x16x32_bf16 a[140:143], v[34:37], v[172:175], a[140:143]
  v_cvt_pk_bf16_f32 v177, v226, v227
  s_waitcnt lgkmcnt(5)
  v_mfma_f32_16x16x32_bf16 a[64:67], v[56:59], v[160:163], a[64:67]
  v_exp_f32 v232, v232
  v_mfma_f32_16x16x32_bf16 a[68:71], v[56:59], v[164:167], a[68:71]
  ds_read_b128 v[52:55], v22 offset:0
  s_add_u32 m0, s42, 24576
  v_mfma_f32_16x16x32_bf16 a[72:75], v[56:59], v[168:171], a[72:75]
  v_exp_f32 v233, v233
  v_mfma_f32_16x16x32_bf16 a[76:79], v[56:59], v[172:175], a[76:79]
  v_exp_f32 v234, v234
  v_mfma_f32_16x16x32_bf16 a[80:83], v[60:63], v[160:163], a[80:83]
  v_exp_f32 v235, v235
  v_mfma_f32_16x16x32_bf16 a[84:87], v[60:63], v[164:167], a[84:87]
  ds_read_b128 v[56:59], v23 offset:0
  s_mov_b32 s39, 90112
  v_mfma_f32_16x16x32_bf16 a[88:91], v[60:63], v[168:171], a[88:91]
  v_cvt_pk_bf16_f32 v180, v228, v229
  v_cvt_pk_bf16_f32 v181, v230, v231
  v_mfma_f32_16x16x32_bf16 a[92:95], v[60:63], v[172:175], a[92:95]
  s_waitcnt lgkmcnt(3)
  v_mfma_f32_16x16x32_bf16 a[96:99], v[64:67], v[160:163], a[96:99]
  v_exp_f32 v236, v236
  v_mfma_f32_16x16x32_bf16 a[100:103], v[64:67], v[164:167], a[100:103]
  ds_read_b128 v[60:63], v24 offset:0
  v_mfma_f32_16x16x32_bf16 a[104:107], v[64:67], v[168:171], a[104:107]
  buffer_load_dwordx4 v17, s[20:23], s39 offen lds
  v_mfma_f32_16x16x32_bf16 a[108:111], v[64:67], v[172:175], a[108:111]
  v_exp_f32 v237, v237
  v_mfma_f32_16x16x32_bf16 a[112:115], v[68:71], v[160:163], a[112:115]
  v_exp_f32 v238, v238
  v_mfma_f32_16x16x32_bf16 a[116:119], v[68:71], v[164:167], a[116:119]
  ds_read_b128 v[64:67], v21 offset:4096
  v_mfma_f32_16x16x32_bf16 a[120:123], v[68:71], v[168:171], a[120:123]
  buffer_load_dwordx4 v18, s[20:23], s39 offen offset:1024 lds
  v_mfma_f32_16x16x32_bf16 a[124:127], v[68:71], v[172:175], a[124:127]
  s_waitcnt lgkmcnt(3)
  v_mfma_f32_16x16x32_bf16 v[192:195], v[48:51], v[80:83], v[144:147]
  v_exp_f32 v239, v239
  v_mfma_f32_16x16x32_bf16 v[196:199], v[48:51], v[84:87], v[148:151]
  ds_read_b128 v[68:71], v22 offset:4096
  v_cvt_pk_bf16_f32 v184, v232, v233
  v_mfma_f32_16x16x32_bf16 v[200:203], v[48:51], v[88:91], v[152:155]
  v_cvt_pk_bf16_f32 v185, v234, v235
  v_mfma_f32_16x16x32_bf16 v[204:207], v[48:51], v[92:95], v[156:159]
  v_exp_f32 v240, v240
  v_mfma_f32_16x16x32_bf16 v[192:195], v[52:55], v[96:99], v[192:195]
  v_exp_f32 v241, v241
  v_mfma_f32_16x16x32_bf16 v[196:199], v[52:55], v[100:103], v[196:199]
  ds_read_b128 v[48:51], v23 offset:4096
  v_mfma_f32_16x16x32_bf16 v[200:203], v[52:55], v[104:107], v[200:203]
  v_exp_f32 v242, v242
  v_mfma_f32_16x16x32_bf16 v[204:207], v[52:55], v[108:111], v[204:207]
  s_waitcnt lgkmcnt(3)
  v_mfma_f32_16x16x32_bf16 v[192:195], v[56:59], v[112:115], v[192:195]
  v_exp_f32 v243, v243
  v_mfma_f32_16x16x32_bf16 v[196:199], v[56:59], v[116:119], v[196:199]
  ds_read_b128 v[52:55], v24 offset:4096
  v_cvt_pk_bf16_f32 v188, v236, v237
  v_mfma_f32_16x16x32_bf16 v[200:203], v[56:59], v[120:123], v[200:203]
  v_cvt_pk_bf16_f32 v189, v238, v239
  v_mfma_f32_16x16x32_bf16 v[204:207], v[56:59], v[124:127], v[204:207]
  v_exp_f32 v244, v244
  v_mfma_f32_16x16x32_bf16 v[192:195], v[60:63], v[128:131], v[192:195]
  v_exp_f32 v245, v245
  v_mfma_f32_16x16x32_bf16 v[196:199], v[60:63], v[132:135], v[196:199]
  ds_read_b64_tr_b16 v[56:57], v25 offset:24576
  ds_read_b64_tr_b16 v[58:59], v25 offset:28672
  v_mfma_f32_16x16x32_bf16 v[200:203], v[60:63], v[136:139], v[200:203]
  v_exp_f32 v246, v246
  v_mfma_f32_16x16x32_bf16 v[204:207], v[60:63], v[140:143], v[204:207]
  s_waitcnt lgkmcnt(4)
  v_mfma_f32_16x16x32_bf16 v[208:211], v[64:67], v[80:83], v[144:147]
  v_exp_f32 v247, v247
  v_mfma_f32_16x16x32_bf16 v[212:215], v[64:67], v[84:87], v[148:151]
  ds_read_b64_tr_b16 v[60:61], v26 offset:24576
  ds_read_b64_tr_b16 v[62:63], v26 offset:28672
  v_mfma_f32_16x16x32_bf16 v[216:219], v[64:67], v[88:91], v[152:155]
  v_cvt_pk_bf16_f32 v178, v240, v241
  v_cvt_pk_bf16_f32 v179, v242, v243
  v_mfma_f32_16x16x32_bf16 v[220:223], v[64:67], v[92:95], v[156:159]
  v_exp_f32 v248, v248
  v_mfma_f32_16x16x32_bf16 v[208:211], v[68:71], v[96:99], v[208:211]
  v_exp_f32 v249, v249
  v_mfma_f32_16x16x32_bf16 v[212:215], v[68:71], v[100:103], v[212:215]
  ds_read_b64_tr_b16 v[64:65], v27 offset:24576
  ds_read_b64_tr_b16 v[66:67], v27 offset:28672
  v_mfma_f32_16x16x32_bf16 v[216:219], v[68:71], v[104:107], v[216:219]
  v_exp_f32 v250, v250
  v_mfma_f32_16x16x32_bf16 v[220:223], v[68:71], v[108:111], v[220:223]
  s_waitcnt lgkmcnt(6)
  v_mfma_f32_16x16x32_bf16 v[208:211], v[48:51], v[112:115], v[208:211]
  v_exp_f32 v251, v251
  v_mfma_f32_16x16x32_bf16 v[212:215], v[48:51], v[116:119], v[212:215]
  ds_read_b64_tr_b16 v[68:69], v28 offset:24576
  v_cvt_pk_bf16_f32 v182, v244, v245
  v_mfma_f32_16x16x32_bf16 v[216:219], v[48:51], v[120:123], v[216:219]
  v_cvt_pk_bf16_f32 v183, v246, v247
  ds_read_b64_tr_b16 v[70:71], v28 offset:28672
  v_mfma_f32_16x16x32_bf16 v[220:223], v[48:51], v[124:127], v[220:223]
  v_exp_f32 v252, v252
  v_mfma_f32_16x16x32_bf16 v[208:211], v[52:55], v[128:131], v[208:211]
  v_exp_f32 v253, v253
  v_mfma_f32_16x16x32_bf16 v[212:215], v[52:55], v[132:135], v[212:215]
  v_exp_f32 v254, v254
  v_mfma_f32_16x16x32_bf16 v[216:219], v[52:55], v[136:139], v[216:219]
  v_exp_f32 v255, v255
  v_cvt_pk_bf16_f32 v186, v248, v249
  v_cvt_pk_bf16_f32 v187, v250, v251
  v_cvt_pk_bf16_f32 v190, v252, v253
  v_cvt_pk_bf16_f32 v191, v254, v255
  v_mfma_f32_16x16x32_bf16 v[220:223], v[52:55], v[140:143], v[220:223]
  s_waitcnt vmcnt(7)
  s_barrier
  s_waitcnt lgkmcnt(4)
  v_mfma_f32_16x16x32_bf16 a[0:3], v[56:59], v[176:179], a[0:3]
  ds_read_b64_tr_b16 v[48:49], v29 offset:24576
  ds_read_b64_tr_b16 v[50:51], v29 offset:28672
  v_mfma_f32_16x16x32_bf16 a[4:7], v[56:59], v[180:183], a[4:7]
  ds_read_b64_tr_b16 v[52:53], v30 offset:24576
  ds_read_b64_tr_b16 v[54:55], v30 offset:28672
  v_mfma_f32_16x16x32_bf16 a[8:11], v[56:59], v[184:187], a[8:11]
  s_add_u32 m0, s42, 49152
  v_mfma_f32_16x16x32_bf16 a[12:15], v[56:59], v[188:191], a[12:15]
  v_exp_f32 v192, v192
  v_mfma_f32_16x16x32_bf16 a[16:19], v[60:63], v[176:179], a[16:19]
  v_exp_f32 v193, v193
  v_mfma_f32_16x16x32_bf16 a[20:23], v[60:63], v[180:183], a[20:23]
  ds_read_b64_tr_b16 v[56:57], v31 offset:24576
  ds_read_b64_tr_b16 v[58:59], v31 offset:28672
  v_mfma_f32_16x16x32_bf16 a[24:27], v[60:63], v[184:187], a[24:27]
  s_mov_b32 s39, 81920
  v_mfma_f32_16x16x32_bf16 a[28:31], v[60:63], v[188:191], a[28:31]
  s_waitcnt lgkmcnt(6)
  v_mfma_f32_16x16x32_bf16 a[32:35], v[64:67], v[176:179], a[32:35]
  v_exp_f32 v194, v194
  v_mfma_f32_16x16x32_bf16 a[36:39], v[64:67], v[180:183], a[36:39]
  ds_read_b64_tr_b16 v[60:61], v32 offset:24576
  ds_read_b64_tr_b16 v[62:63], v32 offset:28672
  v_mfma_f32_16x16x32_bf16 a[40:43], v[64:67], v[184:187], a[40:43]
  buffer_load_dwordx4 v19, s[24:27], s39 offen lds
  v_mfma_f32_16x16x32_bf16 a[44:47], v[64:67], v[188:191], a[44:47]
  v_exp_f32 v195, v195
  v_mfma_f32_16x16x32_bf16 a[48:51], v[68:71], v[176:179], a[48:51]
  v_exp_f32 v196, v196
  v_mfma_f32_16x16x32_bf16 a[52:55], v[68:71], v[180:183], a[52:55]
  buffer_load_dwordx4 v20, s[24:27], s39 offen offset:1024 lds
  v_mfma_f32_16x16x32_bf16 a[56:59], v[68:71], v[184:187], a[56:59]
  v_exp_f32 v197, v197
  v_mfma_f32_16x16x32_bf16 a[60:63], v[68:71], v[188:191], a[60:63]
  v_exp_f32 v198, v198
  v_mfma_f32_16x16x32_bf16 a[128:131], v[34:37], v[176:179], a[128:131]
  v_exp_f32 v199, v199
  v_mfma_f32_16x16x32_bf16 a[132:135], v[34:37], v[180:183], a[132:135]
  ds_read_b128 v[64:67], v21 offset:8192
  s_add_u32 m0, s42, 0
  v_mfma_f32_16x16x32_bf16 a[136:139], v[34:37], v[184:187], a[136:139]
  v_cvt_pk_bf16_f32 v160, v192, v193
  v_cvt_pk_bf16_f32 v161, v194, v195
  v_mfma_f32_16x16x32_bf16 a[140:143], v[34:37], v[188:191], a[140:143]
  s_waitcnt lgkmcnt(5)
  v_mfma_f32_16x16x32_bf16 a[64:67], v[48:51], v[176:179], a[64:67]
  v_exp_f32 v200, v200
  v_mfma_f32_16x16x32_bf16 a[68:71], v[48:51], v[180:183], a[68:71]
  ds_read_b128 v[68:71], v22 offset:8192
  s_mov_b32 s39, 98304
  v_mfma_f32_16x16x32_bf16 a[72:75], v[48:51], v[184:187], a[72:75]
  v_exp_f32 v201, v201
  v_mfma_f32_16x16x32_bf16 a[76:79], v[48:51], v[188:191], a[76:79]
  v_exp_f32 v202, v202
  v_mfma_f32_16x16x32_bf16 a[80:83], v[52:55], v[176:179], a[80:83]
  v_exp_f32 v203, v203
  v_mfma_f32_16x16x32_bf16 a[84:87], v[52:55], v[180:183], a[84:87]
  ds_read_b128 v[48:51], v23 offset:8192
  v_cvt_pk_bf16_f32 v164, v196, v197
  v_mfma_f32_16x16x32_bf16 a[88:91], v[52:55], v[184:187], a[88:91]
  buffer_load_dwordx4 v17, s[20:23], s39 offen lds
  v_mfma_f32_16x16x32_bf16 a[92:95], v[52:55], v[188:191], a[92:95]
  v_cvt_pk_bf16_f32 v165, v198, v199
  s_waitcnt lgkmcnt(3)
  v_mfma_f32_16x16x32_bf16 a[96:99], v[56:59], v[176:179], a[96:99]
  v_exp_f32 v204, v204
  v_mfma_f32_16x16x32_bf16 a[100:103], v[56:59], v[180:183], a[100:103]
  ds_read_b128 v[52:55], v24 offset:8192
  v_mfma_f32_16x16x32_bf16 a[104:107], v[56:59], v[184:187], a[104:107]
  buffer_load_dwordx4 v18, s[20:23], s39 offen offset:1024 lds
  v_mfma_f32_16x16x32_bf16 a[108:111], v[56:59], v[188:191], a[108:111]
  v_exp_f32 v205, v205
  v_mfma_f32_16x16x32_bf16 a[112:115], v[60:63], v[176:179], a[112:115]
  v_exp_f32 v206, v206
  v_mfma_f32_16x16x32_bf16 a[116:119], v[60:63], v[180:183], a[116:119]
  ds_read_b128 v[56:59], v21 offset:12288
  v_mfma_f32_16x16x32_bf16 a[120:123], v[60:63], v[184:187], a[120:123]
  v_exp_f32 v207, v207
  v_mfma_f32_16x16x32_bf16 a[124:127], v[60:63], v[188:191], a[124:127]
  v_cvt_pk_bf16_f32 v168, v200, v201
  s_waitcnt lgkmcnt(3)
  v_mfma_f32_16x16x32_bf16 v[224:227], v[64:67], v[80:83], v[144:147]
  v_cvt_pk_bf16_f32 v169, v202, v203
  v_mfma_f32_16x16x32_bf16 v[228:231], v[64:67], v[84:87], v[148:151]
  ds_read_b128 v[60:63], v22 offset:12288
  v_mfma_f32_16x16x32_bf16 v[232:235], v[64:67], v[88:91], v[152:155]
  v_exp_f32 v208, v208
  v_mfma_f32_16x16x32_bf16 v[236:239], v[64:67], v[92:95], v[156:159]
  v_exp_f32 v209, v209
  v_mfma_f32_16x16x32_bf16 v[224:227], v[68:71], v[96:99], v[224:227]
  v_exp_f32 v210, v210
  v_mfma_f32_16x16x32_bf16 v[228:231], v[68:71], v[100:103], v[228:231]
  ds_read_b128 v[64:67], v23 offset:12288
  v_mfma_f32_16x16x32_bf16 v[232:235], v[68:71], v[104:107], v[232:235]
  v_exp_f32 v211, v211
  v_mfma_f32_16x16x32_bf16 v[236:239], v[68:71], v[108:111], v[236:239]
  v_cvt_pk_bf16_f32 v172, v204, v205
  s_waitcnt lgkmcnt(3)
  v_mfma_f32_16x16x32_bf16 v[224:227], v[48:51], v[112:115], v[224:227]
  v_cvt_pk_bf16_f32 v173, v206, v207
  v_mfma_f32_16x16x32_bf16 v[228:231], v[48:51], v[116:119], v[228:231]
  ds_read_b128 v[68:71], v24 offset:12288
  v_mfma_f32_16x16x32_bf16 v[232:235], v[48:51], v[120:123], v[232:235]
  v_exp_f32 v212, v212
  v_mfma_f32_16x16x32_bf16 v[236:239], v[48:51], v[124:127], v[236:239]
  v_exp_f32 v213, v213
  v_mfma_f32_16x16x32_bf16 v[224:227], v[52:55], v[128:131], v[224:227]
  v_exp_f32 v214, v214
  v_mfma_f32_16x16x32_bf16 v[228:231], v[52:55], v[132:135], v[228:231]
  ds_read_b64_tr_b16 v[48:49], v25 offset:0
  ds_read_b64_tr_b16 v[50:51], v25 offset:4096
  v_mfma_f32_16x16x32_bf16 v[232:235], v[52:55], v[136:139], v[232:235]
  v_exp_f32 v215, v215
  v_mfma_f32_16x16x32_bf16 v[236:239], v[52:55], v[140:143], v[236:239]
  v_cvt_pk_bf16_f32 v162, v208, v209
  s_waitcnt lgkmcnt(4)
  v_mfma_f32_16x16x32_bf16 v[240:243], v[56:59], v[80:83], v[144:147]
  v_cvt_pk_bf16_f32 v163, v210, v211
  v_mfma_f32_16x16x32_bf16 v[244:247], v[56:59], v[84:87], v[148:151]
  ds_read_b64_tr_b16 v[52:53], v26 offset:0
  ds_read_b64_tr_b16 v[54:55], v26 offset:4096
  v_mfma_f32_16x16x32_bf16 v[248:251], v[56:59], v[88:91], v[152:155]
  v_exp_f32 v216, v216
  v_mfma_f32_16x16x32_bf16 v[252:255], v[56:59], v[92:95], v[156:159]
  v_exp_f32 v217, v217
  v_mfma_f32_16x16x32_bf16 v[240:243], v[60:63], v[96:99], v[240:243]
  v_exp_f32 v218, v218
  v_mfma_f32_16x16x32_bf16 v[244:247], v[60:63], v[100:103], v[244:247]
  ds_read_b64_tr_b16 v[56:57], v27 offset:0
  ds_read_b64_tr_b16 v[58:59], v27 offset:4096
  v_mfma_f32_16x16x32_bf16 v[248:251], v[60:63], v[104:107], v[248:251]
  v_exp_f32 v219, v219
  v_mfma_f32_16x16x32_bf16 v[252:255], v[60:63], v[108:111], v[252:255]
  v_cvt_pk_bf16_f32 v166, v212, v213
  s_waitcnt lgkmcnt(6)
  v_mfma_f32_16x16x32_bf16 v[240:243], v[64:67], v[112:115], v[240:243]
  v_cvt_pk_bf16_f32 v167, v214, v215
  v_mfma_f32_16x16x32_bf16 v[244:247], v[64:67], v[116:119], v[244:247]
  ds_read_b64_tr_b16 v[60:61], v28 offset:0
  ds_read_b64_tr_b16 v[62:63], v28 offset:4096
  v_mfma_f32_16x16x32_bf16 v[248:251], v[64:67], v[120:123], v[248:251]
  v_exp_f32 v220, v220
  v_mfma_f32_16x16x32_bf16 v[252:255], v[64:67], v[124:127], v[252:255]
  v_exp_f32 v221, v221
  v_mfma_f32_16x16x32_bf16 v[240:243], v[68:71], v[128:131], v[240:243]
  v_exp_f32 v222, v222
  v_mfma_f32_16x16x32_bf16 v[244:247], v[68:71], v[132:135], v[244:247]
  v_exp_f32 v223, v223
  v_mfma_f32_16x16x32_bf16 v[248:251], v[68:71], v[136:139], v[248:251]
  v_cvt_pk_bf16_f32 v170, v216, v217
  v_cvt_pk_bf16_f32 v171, v218, v219
  v_cvt_pk_bf16_f32 v174, v220, v221
  v_cvt_pk_bf16_f32 v175, v222, v223
  v_mfma_f32_16x16x32_bf16 v[252:255], v[68:71], v[140:143], v[252:255]
  s_waitcnt vmcnt(6)
  s_barrier
  s_waitcnt lgkmcnt(4)
  v_mfma_f32_16x16x32_bf16 a[0:3], v[48:51], v[160:163], a[0:3]
  ds_read_b64_tr_b16 v[64:65], v29 offset:0
  ds_read_b64_tr_b16 v[66:67], v29 offset:4096
  v_mfma_f32_16x16x32_bf16 a[4:7], v[48:51], v[164:167], a[4:7]
  ds_read_b64_tr_b16 v[68:69], v30 offset:0
  ds_read_b64_tr_b16 v[70:71], v30 offset:4096
  v_mfma_f32_16x16x32_bf16 a[8:11], v[48:51], v[168:171], a[8:11]
  s_add_u32 m0, s42, 57344
  v_mfma_f32_16x16x32_bf16 a[12:15], v[48:51], v[172:175], a[12:15]
  v_exp_f32 v224, v224
  v_mfma_f32_16x16x32_bf16 a[16:19], v[52:55], v[160:163], a[16:19]
  v_exp_f32 v225, v225
  v_mfma_f32_16x16x32_bf16 a[20:23], v[52:55], v[164:167], a[20:23]
  ds_read_b64_tr_b16 v[48:49], v31 offset:0
  ds_read_b64_tr_b16 v[50:51], v31 offset:4096
  v_mfma_f32_16x16x32_bf16 a[24:27], v[52:55], v[168:171], a[24:27]
  s_mov_b32 s39, 90112
  v_mfma_f32_16x16x32_bf16 a[28:31], v[52:55], v[172:175], a[28:31]
  s_waitcnt lgkmcnt(6)
  v_mfma_f32_16x16x32_bf16 a[32:35], v[56:59], v[160:163], a[32:35]
  v_exp_f32 v226, v226
  v_mfma_f32_16x16x32_bf16 a[36:39], v[56:59], v[164:167], a[36:39]
  ds_read_b64_tr_b16 v[52:53], v32 offset:0
  ds_read_b64_tr_b16 v[54:55], v32 offset:4096
  v_mfma_f32_16x16x32_bf16 a[40:43], v[56:59], v[168:171], a[40:43]
  buffer_load_dwordx4 v19, s[24:27], s39 offen lds
  v_mfma_f32_16x16x32_bf16 a[44:47], v[56:59], v[172:175], a[44:47]
  v_exp_f32 v227, v227
  v_mfma_f32_16x16x32_bf16 a[48:51], v[60:63], v[160:163], a[48:51]
  v_exp_f32 v228, v228
  v_mfma_f32_16x16x32_bf16 a[52:55], v[60:63], v[164:167], a[52:55]
  buffer_load_dwordx4 v20, s[24:27], s39 offen offset:1024 lds
  v_mfma_f32_16x16x32_bf16 a[56:59], v[60:63], v[168:171], a[56:59]
  v_exp_f32 v229, v229
  v_mfma_f32_16x16x32_bf16 a[60:63], v[60:63], v[172:175], a[60:63]
  v_exp_f32 v230, v230
  v_mfma_f32_16x16x32_bf16 a[128:131], v[34:37], v[160:163], a[128:131]
  v_exp_f32 v231, v231
  v_mfma_f32_16x16x32_bf16 a[132:135], v[34:37], v[164:167], a[132:135]
  ds_read_b128 v[56:59], v21 offset:16384
  s_add_u32 m0, s42, 8192
  v_mfma_f32_16x16x32_bf16 a[136:139], v[34:37], v[168:171], a[136:139]
  v_cvt_pk_bf16_f32 v176, v224, v225
  v_cvt_pk_bf16_f32 v177, v226, v227
  v_mfma_f32_16x16x32_bf16 a[140:143], v[34:37], v[172:175], a[140:143]
  s_waitcnt lgkmcnt(5)
  v_mfma_f32_16x16x32_bf16 a[64:67], v[64:67], v[160:163], a[64:67]
  v_exp_f32 v232, v232
  v_mfma_f32_16x16x32_bf16 a[68:71], v[64:67], v[164:167], a[68:71]
  ds_read_b128 v[60:63], v22 offset:16384
  s_mov_b32 s39, 106496
  v_mfma_f32_16x16x32_bf16 a[72:75], v[64:67], v[168:171], a[72:75]
  v_exp_f32 v233, v233
  v_mfma_f32_16x16x32_bf16 a[76:79], v[64:67], v[172:175], a[76:79]
  v_exp_f32 v234, v234
  v_mfma_f32_16x16x32_bf16 a[80:83], v[68:71], v[160:163], a[80:83]
  v_exp_f32 v235, v235
  v_mfma_f32_16x16x32_bf16 a[84:87], v[68:71], v[164:167], a[84:87]
  ds_read_b128 v[64:67], v23 offset:16384
  v_cvt_pk_bf16_f32 v180, v228, v229
  v_mfma_f32_16x16x32_bf16 a[88:91], v[68:71], v[168:171], a[88:91]
  buffer_load_dwordx4 v17, s[20:23], s39 offen lds
  v_mfma_f32_16x16x32_bf16 a[92:95], v[68:71], v[172:175], a[92:95]
  v_cvt_pk_bf16_f32 v181, v230, v231
  s_waitcnt lgkmcnt(3)
  v_mfma_f32_16x16x32_bf16 a[96:99], v[48:51], v[160:163], a[96:99]
  v_exp_f32 v236, v236
  v_mfma_f32_16x16x32_bf16 a[100:103], v[48:51], v[164:167], a[100:103]
  ds_read_b128 v[68:71], v24 offset:16384
  v_mfma_f32_16x16x32_bf16 a[104:107], v[48:51], v[168:171], a[104:107]
  buffer_load_dwordx4 v18, s[20:23], s39 offen offset:1024 lds
  v_mfma_f32_16x16x32_bf16 a[108:111], v[48:51], v[172:175], a[108:111]
  v_exp_f32 v237, v237
  v_mfma_f32_16x16x32_bf16 a[112:115], v[52:55], v[160:163], a[112:115]
  v_exp_f32 v238, v238
  v_mfma_f32_16x16x32_bf16 a[116:119], v[52:55], v[164:167], a[116:119]
  ds_read_b128 v[48:51], v21 offset:20480
  v_mfma_f32_16x16x32_bf16 a[120:123], v[52:55], v[168:171], a[120:123]
  v_exp_f32 v239, v239
  v_mfma_f32_16x16x32_bf16 a[124:127], v[52:55], v[172:175], a[124:127]
  v_cvt_pk_bf16_f32 v184, v232, v233
  s_waitcnt lgkmcnt(3)
  v_mfma_f32_16x16x32_bf16 v[192:195], v[56:59], v[80:83], v[144:147]
  v_cvt_pk_bf16_f32 v185, v234, v235
  v_mfma_f32_16x16x32_bf16 v[196:199], v[56:59], v[84:87], v[148:151]
  ds_read_b128 v[52:55], v22 offset:20480
  v_mfma_f32_16x16x32_bf16 v[200:203], v[56:59], v[88:91], v[152:155]
  v_exp_f32 v240, v240
  v_mfma_f32_16x16x32_bf16 v[204:207], v[56:59], v[92:95], v[156:159]
  v_exp_f32 v241, v241
  v_mfma_f32_16x16x32_bf16 v[192:195], v[60:63], v[96:99], v[192:195]
  v_exp_f32 v242, v242
  v_mfma_f32_16x16x32_bf16 v[196:199], v[60:63], v[100:103], v[196:199]
  ds_read_b128 v[56:59], v23 offset:20480
  v_mfma_f32_16x16x32_bf16 v[200:203], v[60:63], v[104:107], v[200:203]
  v_exp_f32 v243, v243
  v_mfma_f32_16x16x32_bf16 v[204:207], v[60:63], v[108:111], v[204:207]
  v_cvt_pk_bf16_f32 v188, v236, v237
  s_waitcnt lgkmcnt(3)
  v_mfma_f32_16x16x32_bf16 v[192:195], v[64:67], v[112:115], v[192:195]
  v_cvt_pk_bf16_f32 v189, v238, v239
  v_mfma_f32_16x16x32_bf16 v[196:199], v[64:67], v[116:119], v[196:199]
  ds_read_b128 v[60:63], v24 offset:20480
  v_mfma_f32_16x16x32_bf16 v[200:203], v[64:67], v[120:123], v[200:203]
  v_exp_f32 v244, v244
  v_mfma_f32_16x16x32_bf16 v[204:207], v[64:67], v[124:127], v[204:207]
  v_exp_f32 v245, v245
  v_mfma_f32_16x16x32_bf16 v[192:195], v[68:71], v[128:131], v[192:195]
  v_exp_f32 v246, v246
  v_mfma_f32_16x16x32_bf16 v[196:199], v[68:71], v[132:135], v[196:199]
  ds_read_b64_tr_b16 v[64:65], v25 offset:8192
  ds_read_b64_tr_b16 v[66:67], v25 offset:12288
  v_mfma_f32_16x16x32_bf16 v[200:203], v[68:71], v[136:139], v[200:203]
  v_exp_f32 v247, v247
  v_mfma_f32_16x16x32_bf16 v[204:207], v[68:71], v[140:143], v[204:207]
  v_cvt_pk_bf16_f32 v178, v240, v241
  s_waitcnt lgkmcnt(4)
  v_mfma_f32_16x16x32_bf16 v[208:211], v[48:51], v[80:83], v[144:147]
  v_cvt_pk_bf16_f32 v179, v242, v243
  v_mfma_f32_16x16x32_bf16 v[212:215], v[48:51], v[84:87], v[148:151]
  ds_read_b64_tr_b16 v[68:69], v26 offset:8192
  ds_read_b64_tr_b16 v[70:71], v26 offset:12288
  v_mfma_f32_16x16x32_bf16 v[216:219], v[48:51], v[88:91], v[152:155]
  v_exp_f32 v248, v248
  v_mfma_f32_16x16x32_bf16 v[220:223], v[48:51], v[92:95], v[156:159]
  v_exp_f32 v249, v249
  v_mfma_f32_16x16x32_bf16 v[208:211], v[52:55], v[96:99], v[208:211]
  v_exp_f32 v250, v250
  v_mfma_f32_16x16x32_bf16 v[212:215], v[52:55], v[100:103], v[212:215]
  ds_read_b64_tr_b16 v[48:49], v27 offset:8192
  ds_read_b64_tr_b16 v[50:51], v27 offset:12288
  v_mfma_f32_16x16x32_bf16 v[216:219], v[52:55], v[104:107], v[216:219]
  v_exp_f32 v251, v251
  v_mfma_f32_16x16x32_bf16 v[220:223], v[52:55], v[108:111], v[220:223]
  v_cvt_pk_bf16_f32 v182, v244, v245
  s_waitcnt lgkmcnt(6)
  v_mfma_f32_16x16x32_bf16 v[208:211], v[56:59], v[112:115], v[208:211]
  v_cvt_pk_bf16_f32 v183, v246, v247
  v_mfma_f32_16x16x32_bf16 v[212:215], v[56:59], v[116:119], v[212:215]
  ds_read_b64_tr_b16 v[52:53], v28 offset:8192
  ds_read_b64_tr_b16 v[54:55], v28 offset:12288
  v_mfma_f32_16x16x32_bf16 v[216:219], v[56:59], v[120:123], v[216:219]
  v_exp_f32 v252, v252
  v_mfma_f32_16x16x32_bf16 v[220:223], v[56:59], v[124:127], v[220:223]
  v_exp_f32 v253, v253
  v_mfma_f32_16x16x32_bf16 v[208:211], v[60:63], v[128:131], v[208:211]
  v_exp_f32 v254, v254
  v_mfma_f32_16x16x32_bf16 v[212:215], v[60:63], v[132:135], v[212:215]
  v_exp_f32 v255, v255
  v_mfma_f32_16x16x32_bf16 v[216:219], v[60:63], v[136:139], v[216:219]
  v_cvt_pk_bf16_f32 v186, v248, v249
  v_cvt_pk_bf16_f32 v187, v250, v251
  v_cvt_pk_bf16_f32 v190, v252, v253
  v_cvt_pk_bf16_f32 v191, v254, v255
  v_mfma_f32_16x16x32_bf16 v[220:223], v[60:63], v[140:143], v[220:223]
  s_waitcnt vmcnt(6)
  s_barrier
  s_waitcnt lgkmcnt(4)
  v_mfma_f32_16x16x32_bf16 a[0:3], v[64:67], v[176:179], a[0:3]
  ds_read_b64_tr_b16 v[56:57], v29 offset:8192
  ds_read_b64_tr_b16 v[58:59], v29 offset:12288
  v_mfma_f32_16x16x32_bf16 a[4:7], v[64:67], v[180:183], a[4:7]
  ds_read_b64_tr_b16 v[60:61], v30 offset:8192
  ds_read_b64_tr_b16 v[62:63], v30 offset:12288
  v_mfma_f32_16x16x32_bf16 a[8:11], v[64:67], v[184:187], a[8:11]
  s_add_u32 m0, s42, 32768
  v_mfma_f32_16x16x32_bf16 a[12:15], v[64:67], v[188:191], a[12:15]
  v_exp_f32 v192, v192
  v_mfma_f32_16x16x32_bf16 a[16:19], v[68:71], v[176:179], a[16:19]
  v_exp_f32 v193, v193
  v_mfma_f32_16x16x32_bf16 a[20:23], v[68:71], v[180:183], a[20:23]
  ds_read_b64_tr_b16 v[64:65], v31 offset:8192
  ds_read_b64_tr_b16 v[66:67], v31 offset:12288
  v_mfma_f32_16x16x32_bf16 a[24:27], v[68:71], v[184:187], a[24:27]
  s_mov_b32 s39, 98304
  v_mfma_f32_16x16x32_bf16 a[28:31], v[68:71], v[188:191], a[28:31]
  s_waitcnt lgkmcnt(6)
  v_mfma_f32_16x16x32_bf16 a[32:35], v[48:51], v[176:179], a[32:35]
  v_exp_f32 v194, v194
  v_mfma_f32_16x16x32_bf16 a[36:39], v[48:51], v[180:183], a[36:39]
  ds_read_b64_tr_b16 v[68:69], v32 offset:8192
  ds_read_b64_tr_b16 v[70:71], v32 offset:12288
  v_mfma_f32_16x16x32_bf16 a[40:43], v[48:51], v[184:187], a[40:43]
  buffer_load_dwordx4 v19, s[24:27], s39 offen lds
  v_mfma_f32_16x16x32_bf16 a[44:47], v[48:51], v[188:191], a[44:47]
  v_exp_f32 v195, v195
  v_mfma_f32_16x16x32_bf16 a[48:51], v[52:55], v[176:179], a[48:51]
  v_exp_f32 v196, v196
  v_mfma_f32_16x16x32_bf16 a[52:55], v[52:55], v[180:183], a[52:55]
  buffer_load_dwordx4 v20, s[24:27], s39 offen offset:1024 lds
  v_mfma_f32_16x16x32_bf16 a[56:59], v[52:55], v[184:187], a[56:59]
  v_exp_f32 v197, v197
  v_mfma_f32_16x16x32_bf16 a[60:63], v[52:55], v[188:191], a[60:63]
  v_exp_f32 v198, v198
  v_mfma_f32_16x16x32_bf16 a[128:131], v[34:37], v[176:179], a[128:131]
  v_exp_f32 v199, v199
  v_mfma_f32_16x16x32_bf16 a[132:135], v[34:37], v[180:183], a[132:135]
  ds_read_b128 v[48:51], v21 offset:24576
  s_add_u32 m0, s42, 16384
  v_mfma_f32_16x16x32_bf16 a[136:139], v[34:37], v[184:187], a[136:139]
  v_cvt_pk_bf16_f32 v160, v192, v193
  v_cvt_pk_bf16_f32 v161, v194, v195
  v_mfma_f32_16x16x32_bf16 a[140:143], v[34:37], v[188:191], a[140:143]
  s_waitcnt lgkmcnt(5)
  v_mfma_f32_16x16x32_bf16 a[64:67], v[56:59], v[176:179], a[64:67]
  v_exp_f32 v200, v200
  v_mfma_f32_16x16x32_bf16 a[68:71], v[56:59], v[180:183], a[68:71]
  ds_read_b128 v[52:55], v22 offset:24576
  s_mov_b32 s39, 114688
  v_mfma_f32_16x16x32_bf16 a[72:75], v[56:59], v[184:187], a[72:75]
  v_exp_f32 v201, v201
  v_mfma_f32_16x16x32_bf16 a[76:79], v[56:59], v[188:191], a[76:79]
  v_exp_f32 v202, v202
  v_mfma_f32_16x16x32_bf16 a[80:83], v[60:63], v[176:179], a[80:83]
  v_exp_f32 v203, v203
  v_mfma_f32_16x16x32_bf16 a[84:87], v[60:63], v[180:183], a[84:87]
  ds_read_b128 v[56:59], v23 offset:24576
  v_cvt_pk_bf16_f32 v164, v196, v197
  v_mfma_f32_16x16x32_bf16 a[88:91], v[60:63], v[184:187], a[88:91]
  buffer_load_dwordx4 v17, s[20:23], s39 offen lds
  v_mfma_f32_16x16x32_bf16 a[92:95], v[60:63], v[188:191], a[92:95]
  v_cvt_pk_bf16_f32 v165, v198, v199
  s_waitcnt lgkmcnt(3)
  v_mfma_f32_16x16x32_bf16 a[96:99], v[64:67], v[176:179], a[96:99]
  v_exp_f32 v204, v204
  v_mfma_f32_16x16x32_bf16 a[100:103], v[64:67], v[180:183], a[100:103]
  ds_read_b128 v[60:63], v24 offset:24576
  v_mfma_f32_16x16x32_bf16 a[104:107], v[64:67], v[184:187], a[104:107]
  buffer_load_dwordx4 v18, s[20:23], s39 offen offset:1024 lds
  v_mfma_f32_16x16x32_bf16 a[108:111], v[64:67], v[188:191], a[108:111]
  v_exp_f32 v205, v205
  v_mfma_f32_16x16x32_bf16 a[112:115], v[68:71], v[176:179], a[112:115]
  v_exp_f32 v206, v206
  v_mfma_f32_16x16x32_bf16 a[116:119], v[68:71], v[180:183], a[116:119]
  ds_read_b128 v[64:67], v21 offset:28672
  v_mfma_f32_16x16x32_bf16 a[120:123], v[68:71], v[184:187], a[120:123]
  buffer_load_dword v74, v78, s[96:99], 0 offen offset:256 sc1
  v_mfma_f32_16x16x32_bf16 a[124:127], v[68:71], v[188:191], a[124:127]
  s_waitcnt lgkmcnt(3)
  v_mfma_f32_16x16x32_bf16 v[224:227], v[48:51], v[80:83], v[144:147]
  v_exp_f32 v207, v207
  v_mfma_f32_16x16x32_bf16 v[228:231], v[48:51], v[84:87], v[148:151]
  ds_read_b128 v[68:71], v22 offset:28672
  v_cvt_pk_bf16_f32 v168, v200, v201
  v_mfma_f32_16x16x32_bf16 v[232:235], v[48:51], v[88:91], v[152:155]
  v_cvt_pk_bf16_f32 v169, v202, v203
  v_mfma_f32_16x16x32_bf16 v[236:239], v[48:51], v[92:95], v[156:159]
  v_exp_f32 v208, v208
  v_mfma_f32_16x16x32_bf16 v[224:227], v[52:55], v[96:99], v[224:227]
  v_exp_f32 v209, v209
  v_mfma_f32_16x16x32_bf16 v[228:231], v[52:55], v[100:103], v[228:231]
  ds_read_b128 v[48:51], v23 offset:28672
  v_mfma_f32_16x16x32_bf16 v[232:235], v[52:55], v[104:107], v[232:235]
  v_exp_f32 v210, v210
  v_mfma_f32_16x16x32_bf16 v[236:239], v[52:55], v[108:111], v[236:239]
  s_waitcnt lgkmcnt(3)
  v_mfma_f32_16x16x32_bf16 v[224:227], v[56:59], v[112:115], v[224:227]
  v_exp_f32 v211, v211
  v_mfma_f32_16x16x32_bf16 v[228:231], v[56:59], v[116:119], v[228:231]
  ds_read_b128 v[52:55], v24 offset:28672
  v_cvt_pk_bf16_f32 v172, v204, v205
  v_mfma_f32_16x16x32_bf16 v[232:235], v[56:59], v[120:123], v[232:235]
  v_cvt_pk_bf16_f32 v173, v206, v207
  v_mfma_f32_16x16x32_bf16 v[236:239], v[56:59], v[124:127], v[236:239]
  v_exp_f32 v212, v212
  v_mfma_f32_16x16x32_bf16 v[224:227], v[60:63], v[128:131], v[224:227]
  v_exp_f32 v213, v213
  v_mfma_f32_16x16x32_bf16 v[228:231], v[60:63], v[132:135], v[228:231]
  ds_read_b64_tr_b16 v[56:57], v25 offset:16384
  ds_read_b64_tr_b16 v[58:59], v25 offset:20480
  v_mfma_f32_16x16x32_bf16 v[232:235], v[60:63], v[136:139], v[232:235]
  v_exp_f32 v214, v214
  v_mfma_f32_16x16x32_bf16 v[236:239], v[60:63], v[140:143], v[236:239]
  s_waitcnt lgkmcnt(4)
  v_mfma_f32_16x16x32_bf16 v[240:243], v[64:67], v[80:83], v[144:147]
  v_exp_f32 v215, v215
  v_mfma_f32_16x16x32_bf16 v[244:247], v[64:67], v[84:87], v[148:151]
  ds_read_b64_tr_b16 v[60:61], v26 offset:16384
  ds_read_b64_tr_b16 v[62:63], v26 offset:20480
  v_mfma_f32_16x16x32_bf16 v[248:251], v[64:67], v[88:91], v[152:155]
  v_cvt_pk_bf16_f32 v162, v208, v209
  v_cvt_pk_bf16_f32 v163, v210, v211
  v_mfma_f32_16x16x32_bf16 v[252:255], v[64:67], v[92:95], v[156:159]
  v_exp_f32 v216, v216
  v_mfma_f32_16x16x32_bf16 v[240:243], v[68:71], v[96:99], v[240:243]
  v_exp_f32 v217, v217
  v_mfma_f32_16x16x32_bf16 v[244:247], v[68:71], v[100:103], v[244:247]
  ds_read_b64_tr_b16 v[64:65], v27 offset:16384
  ds_read_b64_tr_b16 v[66:67], v27 offset:20480
  v_mfma_f32_16x16x32_bf16 v[248:251], v[68:71], v[104:107], v[248:251]
  v_exp_f32 v218, v218
  v_mfma_f32_16x16x32_bf16 v[252:255], v[68:71], v[108:111], v[252:255]
  s_waitcnt lgkmcnt(6)
  v_mfma_f32_16x16x32_bf16 v[240:243], v[48:51], v[112:115], v[240:243]
  v_exp_f32 v219, v219
  v_mfma_f32_16x16x32_bf16 v[244:247], v[48:51], v[116:119], v[244:247]
  ds_read_b64_tr_b16 v[68:69], v28 offset:16384
  v_cvt_pk_bf16_f32 v166, v212, v213
  v_mfma_f32_16x16x32_bf16 v[248:251], v[48:51], v[120:123], v[248:251]
  v_cvt_pk_bf16_f32 v167, v214, v215
  ds_read_b64_tr_b16 v[70:71], v28 offset:20480
  v_mfma_f32_16x16x32_bf16 v[252:255], v[48:51], v[124:127], v[252:255]
  v_exp_f32 v220, v220
  v_mfma_f32_16x16x32_bf16 v[240:243], v[52:55], v[128:131], v[240:243]
  v_exp_f32 v221, v221
  v_mfma_f32_16x16x32_bf16 v[244:247], v[52:55], v[132:135], v[244:247]
  v_exp_f32 v222, v222
  v_mfma_f32_16x16x32_bf16 v[248:251], v[52:55], v[136:139], v[248:251]
  v_exp_f32 v223, v223
  v_cvt_pk_bf16_f32 v170, v216, v217
  v_cvt_pk_bf16_f32 v171, v218, v219
  v_cvt_pk_bf16_f32 v174, v220, v221
  v_cvt_pk_bf16_f32 v175, v222, v223
  v_mfma_f32_16x16x32_bf16 v[252:255], v[52:55], v[140:143], v[252:255]
  s_waitcnt vmcnt(7)
  s_barrier
  s_waitcnt lgkmcnt(4)
  v_mfma_f32_16x16x32_bf16 a[0:3], v[56:59], v[160:163], a[0:3]
  ds_read_b64_tr_b16 v[48:49], v29 offset:16384
  ds_read_b64_tr_b16 v[50:51], v29 offset:20480
  v_mfma_f32_16x16x32_bf16 a[4:7], v[56:59], v[164:167], a[4:7]
  ds_read_b64_tr_b16 v[52:53], v30 offset:16384
  ds_read_b64_tr_b16 v[54:55], v30 offset:20480
  v_mfma_f32_16x16x32_bf16 a[8:11], v[56:59], v[168:171], a[8:11]
  s_add_u32 m0, s42, 40960
  v_mfma_f32_16x16x32_bf16 a[12:15], v[56:59], v[172:175], a[12:15]
  v_exp_f32 v224, v224
  v_mfma_f32_16x16x32_bf16 a[16:19], v[60:63], v[160:163], a[16:19]
  v_exp_f32 v225, v225
  v_mfma_f32_16x16x32_bf16 a[20:23], v[60:63], v[164:167], a[20:23]
  ds_read_b64_tr_b16 v[56:57], v31 offset:16384
  ds_read_b64_tr_b16 v[58:59], v31 offset:20480
  v_mfma_f32_16x16x32_bf16 a[24:27], v[60:63], v[168:171], a[24:27]
  s_mov_b32 s39, 106496
  v_mfma_f32_16x16x32_bf16 a[28:31], v[60:63], v[172:175], a[28:31]
  s_waitcnt lgkmcnt(6)
  v_mfma_f32_16x16x32_bf16 a[32:35], v[64:67], v[160:163], a[32:35]
  v_exp_f32 v226, v226
  v_mfma_f32_16x16x32_bf16 a[36:39], v[64:67], v[164:167], a[36:39]
  ds_read_b64_tr_b16 v[60:61], v32 offset:16384
  ds_read_b64_tr_b16 v[62:63], v32 offset:20480
  v_mfma_f32_16x16x32_bf16 a[40:43], v[64:67], v[168:171], a[40:43]
  buffer_load_dwordx4 v19, s[24:27], s39 offen lds
  v_mfma_f32_16x16x32_bf16 a[44:47], v[64:67], v[172:175], a[44:47]
  v_exp_f32 v227, v227
  v_mfma_f32_16x16x32_bf16 a[48:51], v[68:71], v[160:163], a[48:51]
  v_exp_f32 v228, v228
  v_mfma_f32_16x16x32_bf16 a[52:55], v[68:71], v[164:167], a[52:55]
  buffer_load_dwordx4 v20, s[24:27], s39 offen offset:1024 lds
  v_mfma_f32_16x16x32_bf16 a[56:59], v[68:71], v[168:171], a[56:59]
  v_exp_f32 v229, v229
  v_mfma_f32_16x16x32_bf16 a[60:63], v[68:71], v[172:175], a[60:63]
  v_exp_f32 v230, v230
  v_mfma_f32_16x16x32_bf16 a[128:131], v[34:37], v[160:163], a[128:131]
  v_exp_f32 v231, v231
  v_mfma_f32_16x16x32_bf16 a[132:135], v[34:37], v[164:167], a[132:135]
  ds_read_b128 v[64:67], v21 offset:0
  s_add_u32 m0, s42, 24576
  v_mfma_f32_16x16x32_bf16 a[136:139], v[34:37], v[168:171], a[136:139]
  v_cvt_pk_bf16_f32 v176, v224, v225
  v_cvt_pk_bf16_f32 v177, v226, v227
  v_mfma_f32_16x16x32_bf16 a[140:143], v[34:37], v[172:175], a[140:143]
  s_waitcnt lgkmcnt(5)
  v_mfma_f32_16x16x32_bf16 a[64:67], v[48:51], v[160:163], a[64:67]
  v_exp_f32 v232, v232
  v_mfma_f32_16x16x32_bf16 a[68:71], v[48:51], v[164:167], a[68:71]
  ds_read_b128 v[68:71], v22 offset:0
  s_mov_b32 s39, 122880
  v_mfma_f32_16x16x32_bf16 a[72:75], v[48:51], v[168:171], a[72:75]
  v_exp_f32 v233, v233
  v_mfma_f32_16x16x32_bf16 a[76:79], v[48:51], v[172:175], a[76:79]
  v_exp_f32 v234, v234
  v_mfma_f32_16x16x32_bf16 a[80:83], v[52:55], v[160:163], a[80:83]
  v_exp_f32 v235, v235
  v_mfma_f32_16x16x32_bf16 a[84:87], v[52:55], v[164:167], a[84:87]
  ds_read_b128 v[48:51], v23 offset:0
  v_cvt_pk_bf16_f32 v180, v228, v229
  v_mfma_f32_16x16x32_bf16 a[88:91], v[52:55], v[168:171], a[88:91]
  buffer_load_dwordx4 v17, s[20:23], s39 offen lds
  v_mfma_f32_16x16x32_bf16 a[92:95], v[52:55], v[172:175], a[92:95]
  v_cvt_pk_bf16_f32 v181, v230, v231
  s_waitcnt lgkmcnt(3)
  v_mfma_f32_16x16x32_bf16 a[96:99], v[56:59], v[160:163], a[96:99]
  v_exp_f32 v236, v236
  v_mfma_f32_16x16x32_bf16 a[100:103], v[56:59], v[164:167], a[100:103]
  ds_read_b128 v[52:55], v24 offset:0
  v_mfma_f32_16x16x32_bf16 a[104:107], v[56:59], v[168:171], a[104:107]
  buffer_load_dwordx4 v18, s[20:23], s39 offen offset:1024 lds
  v_mfma_f32_16x16x32_bf16 a[108:111], v[56:59], v[172:175], a[108:111]
  v_exp_f32 v237, v237
  v_mfma_f32_16x16x32_bf16 a[112:115], v[60:63], v[160:163], a[112:115]
  v_exp_f32 v238, v238
  v_mfma_f32_16x16x32_bf16 a[116:119], v[60:63], v[164:167], a[116:119]
  ds_read_b128 v[56:59], v21 offset:4096
  v_mfma_f32_16x16x32_bf16 a[120:123], v[60:63], v[168:171], a[120:123]
  s_waitcnt vmcnt(4)
  v_cmp_eq_u32 vcc, s100, v74
  s_cmp_eq_u64 vcc, -1
  s_cbranch_scc0 L_retry1
L_back1:
  v_mfma_f32_16x16x32_bf16 a[124:127], v[60:63], v[172:175], a[124:127]
  s_waitcnt lgkmcnt(3)
  v_mfma_f32_16x16x32_bf16 v[192:195], v[64:67], v[80:83], v[144:147]
  v_exp_f32 v239, v239
  v_mfma_f32_16x16x32_bf16 v[196:199], v[64:67], v[84:87], v[148:151]
  ds_read_b128 v[60:63], v22 offset:4096
  v_cvt_pk_bf16_f32 v184, v232, v233
  v_mfma_f32_16x16x32_bf16 v[200:203], v[64:67], v[88:91], v[152:155]
  s_getpc_b64 s[50:51]
L_pc1:
  s_add_u32 s48, s50, L_attn_done-L_pc1
  s_addc_u32 s49, s51, 0
  s_mov_b32 s50, L_code_end-L_attn_done
  s_mov_b32 s51, 0x20000
  s_lshr_b32 s4, s2, 3
  s_lshl_b32 s4, s4, 2
  s_add_u32 s4, s4, s3
  s_lshl_b32 s4, s4, 9
  s_mov_b64 exec, 0xf
  buffer_load_dword v73, v72, s[48:51], s4 offen
  s_mov_b64 exec, -1
  v_mfma_f32_16x16x32_bf16 v[204:207], v[64:67], v[92:95], v[156:159]
  v_cvt_pk_bf16_f32 v185, v234, v235
  v_mfma_f32_16x16x32_bf16 v[192:195], v[68:71], v[96:99], v[192:195]
  v_exp_f32 v240, v240
  v_mfma_f32_16x16x32_bf16 v[196:199], v[68:71], v[100:103], v[196:199]
  ds_read_b128 v[64:67], v23 offset:4096
  v_mfma_f32_16x16x32_bf16 v[200:203], v[68:71], v[104:107], v[200:203]
  v_exp_f32 v241, v241
  v_mfma_f32_16x16x32_bf16 v[204:207], v[68:71], v[108:111], v[204:207]
  s_waitcnt lgkmcnt(3)
  v_mfma_f32_16x16x32_bf16 v[192:195], v[48:51], v[112:115], v[192:195]
  v_exp_f32 v242, v242
  v_mfma_f32_16x16x32_bf16 v[196:199], v[48:51], v[116:119], v[196:199]
  ds_read_b128 v[68:71], v24 offset:4096
  v_mfma_f32_16x16x32_bf16 v[200:203], v[48:51], v[120:123], v[200:203]
  v_exp_f32 v243, v243
  v_mfma_f32_16x16x32_bf16 v[204:207], v[48:51], v[124:127], v[204:207]
  v_cvt_pk_bf16_f32 v188, v236, v237
  v_cvt_pk_bf16_f32 v189, v238, v239
  v_mfma_f32_16x16x32_bf16 v[192:195], v[52:55], v[128:131], v[192:195]
  v_exp_f32 v244, v244
  v_mfma_f32_16x16x32_bf16 v[196:199], v[52:55], v[132:135], v[196:199]
  ds_read_b64_tr_b16 v[48:49], v25 offset:24576
  ds_read_b64_tr_b16 v[50:51], v25 offset:28672
  v_mfma_f32_16x16x32_bf16 v[200:203], v[52:55], v[136:139], v[200:203]
  v_exp_f32 v245, v245
  v_mfma_f32_16x16x32_bf16 v[204:207], v[52:55], v[140:143], v[204:207]
  s_waitcnt lgkmcnt(4)
  v_mfma_f32_16x16x32_bf16 v[208:211], v[56:59], v[80:83], v[144:147]
  v_exp_f32 v246, v246
  v_mfma_f32_16x16x32_bf16 v[212:215], v[56:59], v[84:87], v[148:151]
  ds_read_b64_tr_b16 v[52:53], v26 offset:24576
  ds_read_b64_tr_b16 v[54:55], v26 offset:28672
  v_mfma_f32_16x16x32_bf16 v[216:219], v[56:59], v[88:91], v[152:155]
  v_exp_f32 v247, v247
  v_mfma_f32_16x16x32_bf16 v[220:223], v[56:59], v[92:95], v[156:159]
  v_cvt_pk_bf16_f32 v178, v240, v241
  v_cvt_pk_bf16_f32 v179, v242, v243
  v_mfma_f32_16x16x32_bf16 v[208:211], v[60:63], v[96:99], v[208:211]
  v_exp_f32 v248, v248
  v_mfma_f32_16x16x32_bf16 v[212:215], v[60:63], v[100:103], v[212:215]
  ds_read_b64_tr_b16 v[56:57], v27 offset:24576
  ds_read_b64_tr_b16 v[58:59], v27 offset:28672
  v_mfma_f32_16x16x32_bf16 v[216:219], v[60:63], v[104:107], v[216:219]
  v_exp_f32 v249, v249
  v_mfma_f32_16x16x32_bf16 v[220:223], v[60:63], v[108:111], v[220:223]
  s_waitcnt lgkmcnt(6)
  v_mfma_f32_16x16x32_bf16 v[208:211], v[64:67], v[112:115], v[208:211]
  v_exp_f32 v250, v250
  v_mfma_f32_16x16x32_bf16 v[212:215], v[64:67], v[116:119], v[212:215]
  ds_read_b64_tr_b16 v[60:61], v28 offset:24576
  ds_read_b64_tr_b16 v[62:63], v28 offset:28672
  v_mfma_f32_16x16x32_bf16 v[216:219], v[64:67], v[120:123], v[216:219]
  v_exp_f32 v251, v251
  v_mfma_f32_16x16x32_bf16 v[220:223], v[64:67], v[124:127], v[220:223]
  v_cvt_pk_bf16_f32 v182, v244, v245
  v_cvt_pk_bf16_f32 v183, v246, v247
  v_mfma_f32_16x16x32_bf16 v[208:211], v[68:71], v[128:131], v[208:211]
  v_exp_f32 v252, v252
  v_mfma_f32_16x16x32_bf16 v[212:215], v[68:71], v[132:135], v[212:215]
  v_exp_f32 v253, v253
  v_mfma_f32_16x16x32_bf16 v[216:219], v[68:71], v[136:139], v[216:219]
  v_exp_f32 v254, v254
  v_exp_f32 v255, v255
  v_cvt_pk_bf16_f32 v186, v248, v249
  v_cvt_pk_bf16_f32 v187, v250, v251
  v_cvt_pk_bf16_f32 v190, v252, v253
  v_cvt_pk_bf16_f32 v191, v254, v255
  v_mfma_f32_16x16x32_bf16 v[220:223], v[68:71], v[140:143], v[220:223]
  s_barrier
  s_waitcnt lgkmcnt(4)
  v_mfma_f32_16x16x32_bf16 a[0:3], v[48:51], v[176:179], a[0:3]
  ds_read_b64_tr_b16 v[64:65], v29 offset:24576
  ds_read_b64_tr_b16 v[66:67], v29 offset:28672
  v_mfma_f32_16x16x32_bf16 a[4:7], v[48:51], v[180:183], a[4:7]
  ds_read_b64_tr_b16 v[68:69], v30 offset:24576
  ds_read_b64_tr_b16 v[70:71], v30 offset:28672
  v_mfma_f32_16x16x32_bf16 a[8:11], v[48:51], v[184:187], a[8:11]
  s_add_u32 m0, s42, 49152
  v_mfma_f32_16x16x32_bf16 a[12:15], v[48:51], v[188:191], a[12:15]
  s_mov_b32 s39, 114688
  v_mfma_f32_16x16x32_bf16 a[16:19], v[52:55], v[176:179], a[16:19]
  v_exp_f32 v192, v192
  v_mfma_f32_16x16x32_bf16 a[20:23], v[52:55], v[180:183], a[20:23]
  ds_read_b64_tr_b16 v[48:49], v31 offset:24576
  ds_read_b64_tr_b16 v[50:51], v31 offset:28672
  v_mfma_f32_16x16x32_bf16 a[24:27], v[52:55], v[184:187], a[24:27]
  buffer_load_dwordx4 v19, s[24:27], s39 offen lds
  v_mfma_f32_16x16x32_bf16 a[28:31], v[52:55], v[188:191], a[28:31]
  s_waitcnt lgkmcnt(6)
  v_mfma_f32_16x16x32_bf16 a[32:35], v[56:59], v[176:179], a[32:35]
  buffer_load_dwordx4 v20, s[24:27], s39 offen offset:1024 lds
  v_mfma_f32_16x16x32_bf16 a[36:39], v[56:59], v[180:183], a[36:39]
  ds_read_b64_tr_b16 v[52:53], v32 offset:24576
  ds_read_b64_tr_b16 v[54:55], v32 offset:28672
  v_mfma_f32_16x16x32_bf16 a[40:43], v[56:59], v[184:187], a[40:43]
  s_add_u32 m0, s40, 65536
  v_mfma_f32_16x16x32_bf16 a[44:47], v[56:59], v[188:191], a[44:47]
  buffer_load_dwordx4 v1, s[8:11], s84 offen offset:0 lds
  v_mfma_f32_16x16x32_bf16 a[48:51], v[60:63], v[176:179], a[48:51]
  v_exp_f32 v193, v193
  v_mfma_f32_16x16x32_bf16 a[52:55], v[60:63], v[180:183], a[52:55]
  buffer_load_dwordx4 v2, s[8:11], s84 offen offset:1024 lds
  v_mfma_f32_16x16x32_bf16 a[56:59], v[60:63], v[184:187], a[56:59]
  v_exp_f32 v194, v194
  v_mfma_f32_16x16x32_bf16 a[60:63], v[60:63], v[188:191], a[60:63]
  buffer_load_dwordx4 v3, s[8:11], s84 offen offset:2048 lds
  v_mfma_f32_16x16x32_bf16 a[128:131], v[34:37], v[176:179], a[128:131]
  v_exp_f32 v195, v195
  v_mfma_f32_16x16x32_bf16 a[132:135], v[34:37], v[180:183], a[132:135]
  ds_read_b128 v[56:59], v21 offset:8192
  v_mfma_f32_16x16x32_bf16 a[136:139], v[34:37], v[184:187], a[136:139]
  buffer_load_dwordx4 v4, s[8:11], s84 offen offset:3072 lds
  v_mfma_f32_16x16x32_bf16 a[140:143], v[34:37], v[188:191], a[140:143]
  s_add_u32 m0, s40, 69632
  s_waitcnt lgkmcnt(5)
  v_mfma_f32_16x16x32_bf16 a[64:67], v[64:67], v[176:179], a[64:67]
  v_exp_f32 v196, v196
  v_mfma_f32_16x16x32_bf16 a[68:71], v[64:67], v[180:183], a[68:71]
  ds_read_b128 v[60:63], v22 offset:8192
  v_mfma_f32_16x16x32_bf16 a[72:75], v[64:67], v[184:187], a[72:75]
  buffer_load_dwordx4 v5, s[8:11], s84 offen offset:0 lds
  v_mfma_f32_16x16x32_bf16 a[76:79], v[64:67], v[188:191], a[76:79]
  buffer_load_dwordx4 v6, s[8:11], s84 offen offset:1024 lds
  v_mfma_f32_16x16x32_bf16 a[80:83], v[68:71], v[176:179], a[80:83]
  v_exp_f32 v197, v197
  v_mfma_f32_16x16x32_bf16 a[84:87], v[68:71], v[180:183], a[84:87]
  ds_read_b128 v[64:67], v23 offset:8192
  v_mfma_f32_16x16x32_bf16 a[88:91], v[68:71], v[184:187], a[88:91]
  buffer_load_dwordx4 v7, s[8:11], s84 offen offset:2048 lds
  v_mfma_f32_16x16x32_bf16 a[92:95], v[68:71], v[188:191], a[92:95]
  s_waitcnt lgkmcnt(3)
  v_mfma_f32_16x16x32_bf16 a[96:99], v[48:51], v[176:179], a[96:99]
  buffer_load_dwordx4 v8, s[8:11], s84 offen offset:3072 lds
  v_mfma_f32_16x16x32_bf16 a[100:103], v[48:51], v[180:183], a[100:103]
  ds_read_b128 v[68:71], v24 offset:8192
  s_add_u32 m0, s40, 73728
  v_mfma_f32_16x16x32_bf16 a[104:107], v[48:51], v[184:187], a[104:107]
  v_exp_f32 v198, v198
  v_mfma_f32_16x16x32_bf16 a[108:111], v[48:51], v[188:191], a[108:111]
  buffer_load_dwordx4 v9, s[8:11], s84 offen offset:0 lds
  v_mfma_f32_16x16x32_bf16 a[112:115], v[52:55], v[176:179], a[112:115]
  v_exp_f32 v199, v199
  v_mfma_f32_16x16x32_bf16 a[116:119], v[52:55], v[180:183], a[116:119]
  ds_read_b128 v[48:51], v21 offset:12288
  v_cvt_pk_bf16_f32 v160, v192, v193
  v_mfma_f32_16x16x32_bf16 a[120:123], v[52:55], v[184:187], a[120:123]
  v_cvt_pk_bf16_f32 v161, v194, v195
  v_mfma_f32_16x16x32_bf16 a[124:127], v[52:55], v[188:191], a[124:127]
  s_waitcnt lgkmcnt(3)
  v_mfma_f32_16x16x32_bf16 v[224:227], v[56:59], v[80:83], v[144:147]
  v_exp_f32 v200, v200
  v_mfma_f32_16x16x32_bf16 v[228:231], v[56:59], v[84:87], v[148:151]
  ds_read_b128 v[52:55], v22 offset:12288
  v_mfma_f32_16x16x32_bf16 v[232:235], v[56:59], v[88:91], v[152:155]
  v_exp_f32 v201, v201
  v_mfma_f32_16x16x32_bf16 v[236:239], v[56:59], v[92:95], v[156:159]
  v_exp_f32 v202, v202
  v_mfma_f32_16x16x32_bf16 v[224:227], v[60:63], v[96:99], v[224:227]
  v_exp_f32 v203, v203
  v_mfma_f32_16x16x32_bf16 v[228:231], v[60:63], v[100:103], v[228:231]
  ds_read_b128 v[56:59], v23 offset:12288
  v_cvt_pk_bf16_f32 v164, v196, v197
  v_mfma_f32_16x16x32_bf16 v[232:235], v[60:63], v[104:107], v[232:235]
  v_cvt_pk_bf16_f32 v165, v198, v199
  v_mfma_f32_16x16x32_bf16 v[236:239], v[60:63], v[108:111], v[236:239]
  s_waitcnt lgkmcnt(3)
  v_mfma_f32_16x16x32_bf16 v[224:227], v[64:67], v[112:115], v[224:227]
  v_exp_f32 v204, v204
  v_mfma_f32_16x16x32_bf16 v[228:231], v[64:67], v[116:119], v[228:231]
  ds_read_b128 v[60:63], v24 offset:12288
  v_mfma_f32_16x16x32_bf16 v[232:235], v[64:67], v[120:123], v[232:235]
  v_exp_f32 v205, v205
  v_mfma_f32_16x16x32_bf16 v[236:239], v[64:67], v[124:127], v[236:239]
  v_exp_f32 v206, v206
  v_mfma_f32_16x16x32_bf16 v[224:227], v[68:71], v[128:131], v[224:227]
  v_exp_f32 v207, v207
  v_mfma_f32_16x16x32_bf16 v[228:231], v[68:71], v[132:135], v[228:231]
  ds_read_b64_tr_b16 v[64:65], v25 offset:0
  ds_read_b64_tr_b16 v[66:67], v25 offset:4096
  v_mfma_f32_16x16x32_bf16 v[232:235], v[68:71], v[136:139], v[232:235]
  v_cvt_pk_bf16_f32 v168, v200, v201
  v_cvt_pk_bf16_f32 v169, v202, v203
  v_mfma_f32_16x16x32_bf16 v[236:239], v[68:71], v[140:143], v[236:239]
  s_waitcnt lgkmcnt(4)
  v_mfma_f32_16x16x32_bf16 v[240:243], v[48:51], v[80:83], v[144:147]
  v_exp_f32 v208, v208
  v_mfma_f32_16x16x32_bf16 v[244:247], v[48:51], v[84:87], v[148:151]
  ds_read_b64_tr_b16 v[68:69], v26 offset:0
  ds_read_b64_tr_b16 v[70:71], v26 offset:4096
  v_mfma_f32_16x16x32_bf16 v[248:251], v[48:51], v[88:91], v[152:155]
  v_exp_f32 v209, v209
  v_mfma_f32_16x16x32_bf16 v[252:255], v[48:51], v[92:95], v[156:159]
  v_exp_f32 v210, v210
  v_mfma_f32_16x16x32_bf16 v[240:243], v[52:55], v[96:99], v[240:243]
  v_exp_f32 v211, v211
  v_mfma_f32_16x16x32_bf16 v[244:247], v[52:55], v[100:103], v[244:247]
  ds_read_b64_tr_b16 v[48:49], v27 offset:0
  ds_read_b64_tr_b16 v[50:51], v27 offset:4096
  v_mfma_f32_16x16x32_bf16 v[248:251], v[52:55], v[104:107], v[248:251]
  v_cvt_pk_bf16_f32 v172, v204, v205
  v_cvt_pk_bf16_f32 v173, v206, v207
  v_mfma_f32_16x16x32_bf16 v[252:255], v[52:55], v[108:111], v[252:255]
  s_waitcnt lgkmcnt(6)
  v_mfma_f32_16x16x32_bf16 v[240:243], v[56:59], v[112:115], v[240:243]
  v_exp_f32 v212, v212
  v_mfma_f32_16x16x32_bf16 v[244:247], v[56:59], v[116:119], v[244:247]
  ds_read_b64_tr_b16 v[52:53], v28 offset:0
  ds_read_b64_tr_b16 v[54:55], v28 offset:4096
  v_mfma_f32_16x16x32_bf16 v[248:251], v[56:59], v[120:123], v[248:251]
  v_exp_f32 v213, v213
  v_mfma_f32_16x16x32_bf16 v[252:255], v[56:59], v[124:127], v[252:255]
  v_exp_f32 v214, v214
  v_mfma_f32_16x16x32_bf16 v[240:243], v[60:63], v[128:131], v[240:243]
  v_exp_f32 v215, v215
  v_mfma_f32_16x16x32_bf16 v[244:247], v[60:63], v[132:135], v[244:247]
  v_cvt_pk_bf16_f32 v162, v208, v209
  v_cvt_pk_bf16_f32 v163, v210, v211
  v_mfma_f32_16x16x32_bf16 v[248:251], v[60:63], v[136:139], v[248:251]
  v_exp_f32 v216, v216
  v_exp_f32 v217, v217
  v_exp_f32 v218, v218
  v_exp_f32 v219, v219
  v_cvt_pk_bf16_f32 v166, v212, v213
  v_cvt_pk_bf16_f32 v167, v214, v215
  v_exp_f32 v220, v220
  v_exp_f32 v221, v221
  v_exp_f32 v222, v222
  v_exp_f32 v223, v223
  v_cvt_pk_bf16_f32 v170, v216, v217
  v_cvt_pk_bf16_f32 v171, v218, v219
  v_cvt_pk_bf16_f32 v174, v220, v221
  v_cvt_pk_bf16_f32 v175, v222, v223
  v_mfma_f32_16x16x32_bf16 v[252:255], v[60:63], v[140:143], v[252:255]
  s_waitcnt vmcnt(14)
  s_barrier
  s_waitcnt lgkmcnt(4)
  v_mfma_f32_16x16x32_bf16 a[0:3], v[64:67], v[160:163], a[0:3]
  ds_read_b64_tr_b16 v[56:57], v29 offset:0
  ds_read_b64_tr_b16 v[58:59], v29 offset:4096
  v_mfma_f32_16x16x32_bf16 a[4:7], v[64:67], v[164:167], a[4:7]
  ds_read_b64_tr_b16 v[60:61], v30 offset:0
  ds_read_b64_tr_b16 v[62:63], v30 offset:4096
  v_mfma_f32_16x16x32_bf16 a[8:11], v[64:67], v[168:171], a[8:11]
  s_add_u32 m0, s42, 57344
  v_mfma_f32_16x16x32_bf16 a[12:15], v[64:67], v[172:175], a[12:15]
  s_mov_b32 s39, 122880
  v_mfma_f32_16x16x32_bf16 a[16:19], v[68:71], v[160:163], a[16:19]
  v_exp_f32 v224, v224
  v_mfma_f32_16x16x32_bf16 a[20:23], v[68:71], v[164:167], a[20:23]
  ds_read_b64_tr_b16 v[64:65], v31 offset:0
  ds_read_b64_tr_b16 v[66:67], v31 offset:4096
  v_mfma_f32_16x16x32_bf16 a[24:27], v[68:71], v[168:171], a[24:27]
  buffer_load_dwordx4 v19, s[24:27], s39 offen lds
  v_mfma_f32_16x16x32_bf16 a[28:31], v[68:71], v[172:175], a[28:31]
  s_waitcnt lgkmcnt(6)
  v_mfma_f32_16x16x32_bf16 a[32:35], v[48:51], v[160:163], a[32:35]
  buffer_load_dwordx4 v20, s[24:27], s39 offen offset:1024 lds
  v_mfma_f32_16x16x32_bf16 a[36:39], v[48:51], v[164:167], a[36:39]
  ds_read_b64_tr_b16 v[68:69], v32 offset:0
  ds_read_b64_tr_b16 v[70:71], v32 offset:4096
  v_mfma_f32_16x16x32_bf16 a[40:43], v[48:51], v[168:171], a[40:43]
  s_add_u32 m0, s40, 102400
  v_mfma_f32_16x16x32_bf16 a[44:47], v[48:51], v[172:175], a[44:47]
  buffer_load_dwordx4 v1, s[8:11], s85 offen offset:0 lds
  v_mfma_f32_16x16x32_bf16 a[48:51], v[52:55], v[160:163], a[48:51]
  v_exp_f32 v225, v225
  v_mfma_f32_16x16x32_bf16 a[52:55], v[52:55], v[164:167], a[52:55]
  buffer_load_dwordx4 v2, s[8:11], s85 offen offset:1024 lds
  v_mfma_f32_16x16x32_bf16 a[56:59], v[52:55], v[168:171], a[56:59]
  v_exp_f32 v226, v226
  v_mfma_f32_16x16x32_bf16 a[60:63], v[52:55], v[172:175], a[60:63]
  buffer_load_dwordx4 v3, s[8:11], s85 offen offset:2048 lds
  v_mfma_f32_16x16x32_bf16 a[128:131], v[34:37], v[160:163], a[128:131]
  v_exp_f32 v227, v227
  v_mfma_f32_16x16x32_bf16 a[132:135], v[34:37], v[164:167], a[132:135]
  ds_read_b128 v[48:51], v21 offset:16384
  v_mfma_f32_16x16x32_bf16 a[136:139], v[34:37], v[168:171], a[136:139]
  buffer_load_dwordx4 v4, s[8:11], s85 offen offset:3072 lds
  v_mfma_f32_16x16x32_bf16 a[140:143], v[34:37], v[172:175], a[140:143]
  s_add_u32 m0, s40, 106496
  s_waitcnt lgkmcnt(5)
  v_mfma_f32_16x16x32_bf16 a[64:67], v[56:59], v[160:163], a[64:67]
  v_exp_f32 v228, v228
  v_mfma_f32_16x16x32_bf16 a[68:71], v[56:59], v[164:167], a[68:71]
  ds_read_b128 v[52:55], v22 offset:16384
  v_mfma_f32_16x16x32_bf16 a[72:75], v[56:59], v[168:171], a[72:75]
  buffer_load_dwordx4 v5, s[8:11], s85 offen offset:0 lds
  v_mfma_f32_16x16x32_bf16 a[76:79], v[56:59], v[172:175], a[76:79]
  buffer_load_dwordx4 v6, s[8:11], s85 offen offset:1024 lds
  v_mfma_f32_16x16x32_bf16 a[80:83], v[60:63], v[160:163], a[80:83]
  v_exp_f32 v229, v229
  v_mfma_f32_16x16x32_bf16 a[84:87], v[60:63], v[164:167], a[84:87]
  ds_read_b128 v[56:59], v23 offset:16384
  v_mfma_f32_16x16x32_bf16 a[88:91], v[60:63], v[168:171], a[88:91]
  buffer_load_dwordx4 v7, s[8:11], s85 offen offset:2048 lds
  v_mfma_f32_16x16x32_bf16 a[92:95], v[60:63], v[172:175], a[92:95]
  s_waitcnt lgkmcnt(3)
  v_mfma_f32_16x16x32_bf16 a[96:99], v[64:67], v[160:163], a[96:99]
  buffer_load_dwordx4 v8, s[8:11], s85 offen offset:3072 lds
  v_mfma_f32_16x16x32_bf16 a[100:103], v[64:67], v[164:167], a[100:103]
  ds_read_b128 v[60:63], v24 offset:16384
  s_add_u32 m0, s40, 110592
  v_mfma_f32_16x16x32_bf16 a[104:107], v[64:67], v[168:171], a[104:107]
  v_exp_f32 v230, v230
  v_mfma_f32_16x16x32_bf16 a[108:111], v[64:67], v[172:175], a[108:111]
  buffer_load_dwordx4 v9, s[8:11], s85 offen offset:0 lds
  v_mfma_f32_16x16x32_bf16 a[112:115], v[68:71], v[160:163], a[112:115]
  v_exp_f32 v231, v231
  v_mfma_f32_16x16x32_bf16 a[116:119], v[68:71], v[164:167], a[116:119]
  ds_read_b128 v[64:67], v21 offset:20480
  v_cvt_pk_bf16_f32 v176, v224, v225
  v_mfma_f32_16x16x32_bf16 a[120:123], v[68:71], v[168:171], a[120:123]
  v_cvt_pk_bf16_f32 v177, v226, v227
  v_mfma_f32_16x16x32_bf16 a[124:127], v[68:71], v[172:175], a[124:127]
  s_waitcnt lgkmcnt(3)
  v_mfma_f32_16x16x32_bf16 v[192:195], v[48:51], v[80:83], v[144:147]
  v_exp_f32 v232, v232
  v_mfma_f32_16x16x32_bf16 v[196:199], v[48:51], v[84:87], v[148:151]
  ds_read_b128 v[68:71], v22 offset:20480
  v_mfma_f32_16x16x32_bf16 v[200:203], v[48:51], v[88:91], v[152:155]
  v_exp_f32 v233, v233
  v_mfma_f32_16x16x32_bf16 v[204:207], v[48:51], v[92:95], v[156:159]
  v_exp_f32 v234, v234
  v_mfma_f32_16x16x32_bf16 v[192:195], v[52:55], v[96:99], v[192:195]
  v_exp_f32 v235, v235
  v_mfma_f32_16x16x32_bf16 v[196:199], v[52:55], v[100:103], v[196:199]
  ds_read_b128 v[48:51], v23 offset:20480
  v_cvt_pk_bf16_f32 v180, v228, v229
  v_mfma_f32_16x16x32_bf16 v[200:203], v[52:55], v[104:107], v[200:203]
  v_cvt_pk_bf16_f32 v181, v230, v231
  v_mfma_f32_16x16x32_bf16 v[204:207], v[52:55], v[108:111], v[204:207]
  s_waitcnt lgkmcnt(3)
  v_mfma_f32_16x16x32_bf16 v[192:195], v[56:59], v[112:115], v[192:195]
  v_exp_f32 v236, v236
  v_mfma_f32_16x16x32_bf16 v[196:199], v[56:59], v[116:119], v[196:199]
  ds_read_b128 v[52:55], v24 offset:20480
  v_mfma_f32_16x16x32_bf16 v[200:203], v[56:59], v[120:123], v[200:203]
  v_exp_f32 v237, v237
  v_mfma_f32_16x16x32_bf16 v[204:207], v[56:59], v[124:127], v[204:207]
  v_exp_f32 v238, v238
  v_mfma_f32_16x16x32_bf16 v[192:195], v[60:63], v[128:131], v[192:195]
  v_exp_f32 v239, v239
  v_mfma_f32_16x16x32_bf16 v[196:199], v[60:63], v[132:135], v[196:199]
  ds_read_b64_tr_b16 v[56:57], v25 offset:8192
  ds_read_b64_tr_b16 v[58:59], v25 offset:12288
  v_mfma_f32_16x16x32_bf16 v[200:203], v[60:63], v[136:139], v[200:203]
  v_cvt_pk_bf16_f32 v184, v232, v233
  v_cvt_pk_bf16_f32 v185, v234, v235
  v_mfma_f32_16x16x32_bf16 v[204:207], v[60:63], v[140:143], v[204:207]
  s_waitcnt lgkmcnt(4)
  v_mfma_f32_16x16x32_bf16 v[208:211], v[64:67], v[80:83], v[144:147]
  v_exp_f32 v240, v240
  v_mfma_f32_16x16x32_bf16 v[212:215], v[64:67], v[84:87], v[148:151]
  ds_read_b64_tr_b16 v[60:61], v26 offset:8192
  ds_read_b64_tr_b16 v[62:63], v26 offset:12288
  v_mfma_f32_16x16x32_bf16 v[216:219], v[64:67], v[88:91], v[152:155]
  v_exp_f32 v241, v241
  v_mfma_f32_16x16x32_bf16 v[220:223], v[64:67], v[92:95], v[156:159]
  v_exp_f32 v242, v242
  v_mfma_f32_16x16x32_bf16 v[208:211], v[68:71], v[96:99], v[208:211]
  v_exp_f32 v243, v243
  v_mfma_f32_16x16x32_bf16 v[212:215], v[68:71], v[100:103], v[212:215]
  ds_read_b64_tr_b16 v[64:65], v27 offset:8192
  ds_read_b64_tr_b16 v[66:67], v27 offset:12288
  v_mfma_f32_16x16x32_bf16 v[216:219], v[68:71], v[104:107], v[216:219]
  v_cvt_pk_bf16_f32 v188, v236, v237
  v_cvt_pk_bf16_f32 v189, v238, v239
  v_mfma_f32_16x16x32_bf16 v[220:223], v[68:71], v[108:111], v[220:223]
  s_waitcnt lgkmcnt(6)
  v_mfma_f32_16x16x32_bf16 v[208:211], v[48:51], v[112:115], v[208:211]
  v_exp_f32 v244, v244
  v_mfma_f32_16x16x32_bf16 v[212:215], v[48:51], v[116:119], v[212:215]
  ds_read_b64_tr_b16 v[68:69], v28 offset:8192
  ds_read_b64_tr_b16 v[70:71], v28 offset:12288
  v_mfma_f32_16x16x32_bf16 v[216:219], v[48:51], v[120:123], v[216:219]
  v_exp_f32 v245, v245
  v_mfma_f32_16x16x32_bf16 v[220:223], v[48:51], v[124:127], v[220:223]
  v_exp_f32 v246, v246
  v_mfma_f32_16x16x32_bf16 v[208:211], v[52:55], v[128:131], v[208:211]
  v_exp_f32 v247, v247
  v_mfma_f32_16x16x32_bf16 v[212:215], v[52:55], v[132:135], v[212:215]
  v_cvt_pk_bf16_f32 v178, v240, v241
  v_cvt_pk_bf16_f32 v179, v242, v243
  v_mfma_f32_16x16x32_bf16 v[216:219], v[52:55], v[136:139], v[216:219]
  v_exp_f32 v248, v248
  v_exp_f32 v249, v249
  v_exp_f32 v250, v250
  v_exp_f32 v251, v251
  v_cvt_pk_bf16_f32 v182, v244, v245
  v_cvt_pk_bf16_f32 v183, v246, v247
  v_exp_f32 v252, v252
  v_exp_f32 v253, v253
  v_exp_f32 v254, v254
  v_exp_f32 v255, v255
  v_cvt_pk_bf16_f32 v186, v248, v249
  v_cvt_pk_bf16_f32 v187, v250, v251
  v_cvt_pk_bf16_f32 v190, v252, v253
  v_cvt_pk_bf16_f32 v191, v254, v255
  v_mfma_f32_16x16x32_bf16 v[220:223], v[52:55], v[140:143], v[220:223]
  s_waitcnt vmcnt(20)
  s_barrier
  s_waitcnt lgkmcnt(4)
  v_mfma_f32_16x16x32_bf16 a[0:3], v[56:59], v[176:179], a[0:3]
  ds_read_b64_tr_b16 v[48:49], v29 offset:8192
  ds_read_b64_tr_b16 v[50:51], v29 offset:12288
  v_mfma_f32_16x16x32_bf16 a[4:7], v[56:59], v[180:183], a[4:7]
  ds_read_b64_tr_b16 v[52:53], v30 offset:8192
  ds_read_b64_tr_b16 v[54:55], v30 offset:12288
  v_mfma_f32_16x16x32_bf16 a[8:11], v[56:59], v[184:187], a[8:11]
  s_add_u32 s38, s77, 0
  v_mfma_f32_16x16x32_bf16 a[12:15], v[56:59], v[188:191], a[12:15]
  v_exp_f32 v192, v192
  v_mfma_f32_16x16x32_bf16 a[16:19], v[60:63], v[176:179], a[16:19]
  v_exp_f32 v193, v193
  v_mfma_f32_16x16x32_bf16 a[20:23], v[60:63], v[180:183], a[20:23]
  ds_read_b64_tr_b16 v[56:57], v31 offset:8192
  ds_read_b64_tr_b16 v[58:59], v31 offset:12288
  v_mfma_f32_16x16x32_bf16 a[24:27], v[60:63], v[184:187], a[24:27]
  buffer_load_dwordx4 a[208:211], v16, s[16:19], s38 offen offset:0 sc1
  v_mfma_f32_16x16x32_bf16 a[28:31], v[60:63], v[188:191], a[28:31]
  s_waitcnt lgkmcnt(6)
  v_mfma_f32_16x16x32_bf16 a[32:35], v[64:67], v[176:179], a[32:35]
  v_exp_f32 v194, v194
  v_mfma_f32_16x16x32_bf16 a[36:39], v[64:67], v[180:183], a[36:39]
  ds_read_b64_tr_b16 v[60:61], v32 offset:8192
  ds_read_b64_tr_b16 v[62:63], v32 offset:12288
  v_mfma_f32_16x16x32_bf16 a[40:43], v[64:67], v[184:187], a[40:43]
  buffer_load_dwordx4 a[212:215], v16, s[16:19], s38 offen offset:1024 sc1
  v_mfma_f32_16x16x32_bf16 a[44:47], v[64:67], v[188:191], a[44:47]
  v_exp_f32 v195, v195
  v_mfma_f32_16x16x32_bf16 a[48:51], v[68:71], v[176:179], a[48:51]
  v_exp_f32 v196, v196
  v_mfma_f32_16x16x32_bf16 a[52:55], v[68:71], v[180:183], a[52:55]
  buffer_load_dwordx4 a[216:219], v16, s[16:19], s38 offen offset:2048 sc1
  v_mfma_f32_16x16x32_bf16 a[56:59], v[68:71], v[184:187], a[56:59]
  v_exp_f32 v197, v197
  v_mfma_f32_16x16x32_bf16 a[60:63], v[68:71], v[188:191], a[60:63]
  v_exp_f32 v198, v198
  v_mfma_f32_16x16x32_bf16 a[128:131], v[34:37], v[176:179], a[128:131]
  v_exp_f32 v199, v199
  v_mfma_f32_16x16x32_bf16 a[132:135], v[34:37], v[180:183], a[132:135]
  ds_read_b128 v[64:67], v21 offset:24576
  v_cvt_pk_bf16_f32 v160, v192, v193
  v_mfma_f32_16x16x32_bf16 a[136:139], v[34:37], v[184:187], a[136:139]
  buffer_load_dwordx4 a[220:223], v16, s[16:19], s38 offen offset:3072 sc1
  v_mfma_f32_16x16x32_bf16 a[140:143], v[34:37], v[188:191], a[140:143]
  v_cvt_pk_bf16_f32 v161, v194, v195
  s_waitcnt lgkmcnt(5)
  v_mfma_f32_16x16x32_bf16 a[64:67], v[48:51], v[176:179], a[64:67]
  v_exp_f32 v200, v200
  v_mfma_f32_16x16x32_bf16 a[68:71], v[48:51], v[180:183], a[68:71]
  ds_read_b128 v[68:71], v22 offset:24576
  s_add_u32 s38, s77, 4096
  v_mfma_f32_16x16x32_bf16 a[72:75], v[48:51], v[184:187], a[72:75]
  v_exp_f32 v201, v201
  v_mfma_f32_16x16x32_bf16 a[76:79], v[48:51], v[188:191], a[76:79]
  v_exp_f32 v202, v202
  v_mfma_f32_16x16x32_bf16 a[80:83], v[52:55], v[176:179], a[80:83]
  v_exp_f32 v203, v203
  v_mfma_f32_16x16x32_bf16 a[84:87], v[52:55], v[180:183], a[84:87]
  ds_read_b128 v[48:51], v23 offset:24576
  v_cvt_pk_bf16_f32 v164, v196, v197
  v_mfma_f32_16x16x32_bf16 a[88:91], v[52:55], v[184:187], a[88:91]
  buffer_load_dwordx4 a[224:227], v16, s[16:19], s38 offen offset:0 sc1
  v_mfma_f32_16x16x32_bf16 a[92:95], v[52:55], v[188:191], a[92:95]
  v_cvt_pk_bf16_f32 v165, v198, v199
  s_waitcnt lgkmcnt(3)
  v_mfma_f32_16x16x32_bf16 a[96:99], v[56:59], v[176:179], a[96:99]
  v_exp_f32 v204, v204
  v_mfma_f32_16x16x32_bf16 a[100:103], v[56:59], v[180:183], a[100:103]
  ds_read_b128 v[52:55], v24 offset:24576
  v_mfma_f32_16x16x32_bf16 a[104:107], v[56:59], v[184:187], a[104:107]
  buffer_load_dwordx4 a[228:231], v16, s[16:19], s38 offen offset:1024 sc1
  v_mfma_f32_16x16x32_bf16 a[108:111], v[56:59], v[188:191], a[108:111]
  v_exp_f32 v205, v205
  v_mfma_f32_16x16x32_bf16 a[112:115], v[60:63], v[176:179], a[112:115]
  v_exp_f32 v206, v206
  v_mfma_f32_16x16x32_bf16 a[116:119], v[60:63], v[180:183], a[116:119]
  ds_read_b128 v[56:59], v21 offset:28672
  v_mfma_f32_16x16x32_bf16 a[120:123], v[60:63], v[184:187], a[120:123]
  buffer_load_dwordx4 a[232:235], v16, s[16:19], s38 offen offset:2048 sc1
  v_mfma_f32_16x16x32_bf16 a[124:127], v[60:63], v[188:191], a[124:127]
  s_waitcnt lgkmcnt(3)
  v_mfma_f32_16x16x32_bf16 v[224:227], v[64:67], v[80:83], v[144:147]
  v_exp_f32 v207, v207
  v_mfma_f32_16x16x32_bf16 v[228:231], v[64:67], v[84:87], v[148:151]
  ds_read_b128 v[60:63], v22 offset:28672
  v_cvt_pk_bf16_f32 v168, v200, v201
  v_mfma_f32_16x16x32_bf16 v[232:235], v[64:67], v[88:91], v[152:155]
  buffer_load_dwordx4 a[236:239], v16, s[16:19], s38 offen offset:3072 sc1
  v_mfma_f32_16x16x32_bf16 v[236:239], v[64:67], v[92:95], v[156:159]
  v_cvt_pk_bf16_f32 v169, v202, v203
  v_mfma_f32_16x16x32_bf16 v[224:227], v[68:71], v[96:99], v[224:227]
  v_exp_f32 v208, v208
  v_mfma_f32_16x16x32_bf16 v[228:231], v[68:71], v[100:103], v[228:231]
  ds_read_b128 v[64:67], v23 offset:28672
  v_mfma_f32_16x16x32_bf16 v[232:235], v[68:71], v[104:107], v[232:235]
  v_exp_f32 v209, v209
  v_mfma_f32_16x16x32_bf16 v[236:239], v[68:71], v[108:111], v[236:239]
  s_waitcnt lgkmcnt(3)
  v_mfma_f32_16x16x32_bf16 v[224:227], v[48:51], v[112:115], v[224:227]
  v_exp_f32 v210, v210
  v_mfma_f32_16x16x32_bf16 v[228:231], v[48:51], v[116:119], v[228:231]
  ds_read_b128 v[68:71], v24 offset:28672
  v_mfma_f32_16x16x32_bf16 v[232:235], v[48:51], v[120:123], v[232:235]
  v_exp_f32 v211, v211
  v_mfma_f32_16x16x32_bf16 v[236:239], v[48:51], v[124:127], v[236:239]
  v_cvt_pk_bf16_f32 v172, v204, v205
  v_cvt_pk_bf16_f32 v173, v206, v207
  v_mfma_f32_16x16x32_bf16 v[224:227], v[52:55], v[128:131], v[224:227]
  v_exp_f32 v212, v212
  v_mfma_f32_16x16x32_bf16 v[228:231], v[52:55], v[132:135], v[228:231]
  ds_read_b64_tr_b16 v[48:49], v25 offset:16384
  ds_read_b64_tr_b16 v[50:51], v25 offset:20480
  v_mfma_f32_16x16x32_bf16 v[232:235], v[52:55], v[136:139], v[232:235]
  v_exp_f32 v213, v213
  v_mfma_f32_16x16x32_bf16 v[236:239], v[52:55], v[140:143], v[236:239]
  s_waitcnt lgkmcnt(4)
  v_mfma_f32_16x16x32_bf16 v[240:243], v[56:59], v[80:83], v[144:147]
  v_exp_f32 v214, v214
  v_mfma_f32_16x16x32_bf16 v[244:247], v[56:59], v[84:87], v[148:151]
  ds_read_b64_tr_b16 v[52:53], v26 offset:16384
  ds_read_b64_tr_b16 v[54:55], v26 offset:20480
  v_mfma_f32_16x16x32_bf16 v[248:251], v[56:59], v[88:91], v[152:155]
  v_exp_f32 v215, v215
  v_mfma_f32_16x16x32_bf16 v[252:255], v[56:59], v[92:95], v[156:159]
  v_cvt_pk_bf16_f32 v162, v208, v209
  v_cvt_pk_bf16_f32 v163, v210, v211
  v_mfma_f32_16x16x32_bf16 v[240:243], v[60:63], v[96:99], v[240:243]
  v_exp_f32 v216, v216
  v_mfma_f32_16x16x32_bf16 v[244:247], v[60:63], v[100:103], v[244:247]
  ds_read_b64_tr_b16 v[56:57], v27 offset:16384
  ds_read_b64_tr_b16 v[58:59], v27 offset:20480
  v_mfma_f32_16x16x32_bf16 v[248:251], v[60:63], v[104:107], v[248:251]
  v_exp_f32 v217, v217
  v_mfma_f32_16x16x32_bf16 v[252:255], v[60:63], v[108:111], v[252:255]
  s_waitcnt lgkmcnt(6)
  v_mfma_f32_16x16x32_bf16 v[240:243], v[64:67], v[112:115], v[240:243]
  v_exp_f32 v218, v218
  v_mfma_f32_16x16x32_bf16 v[244:247], v[64:67], v[116:119], v[244:247]
  ds_read_b64_tr_b16 v[60:61], v28 offset:16384
  ds_read_b64_tr_b16 v[62:63], v28 offset:20480
  v_mfma_f32_16x16x32_bf16 v[248:251], v[64:67], v[120:123], v[248:251]
  v_exp_f32 v219, v219
  v_mfma_f32_16x16x32_bf16 v[252:255], v[64:67], v[124:127], v[252:255]
  v_cvt_pk_bf16_f32 v166, v212, v213
  v_cvt_pk_bf16_f32 v167, v214, v215
  v_mfma_f32_16x16x32_bf16 v[240:243], v[68:71], v[128:131], v[240:243]
  v_exp_f32 v220, v220
  v_mfma_f32_16x16x32_bf16 v[244:247], v[68:71], v[132:135], v[244:247]
  v_exp_f32 v221, v221
  v_mfma_f32_16x16x32_bf16 v[248:251], v[68:71], v[136:139], v[248:251]
  v_exp_f32 v222, v222
  v_exp_f32 v223, v223
  v_cvt_pk_bf16_f32 v170, v216, v217
  v_cvt_pk_bf16_f32 v171, v218, v219
  v_cvt_pk_bf16_f32 v174, v220, v221
  v_cvt_pk_bf16_f32 v175, v222, v223
  v_mfma_f32_16x16x32_bf16 v[252:255], v[68:71], v[140:143], v[252:255]
  s_waitcnt vmcnt(17)
  s_barrier
  s_waitcnt lgkmcnt(4)
  v_mfma_f32_16x16x32_bf16 a[0:3], v[48:51], v[160:163], a[0:3]
  ds_read_b64_tr_b16 v[64:65], v29 offset:16384
  ds_read_b64_tr_b16 v[66:67], v29 offset:20480
  v_mfma_f32_16x16x32_bf16 a[4:7], v[48:51], v[164:167], a[4:7]
  ds_read_b64_tr_b16 v[68:69], v30 offset:16384
  ds_read_b64_tr_b16 v[70:71], v30 offset:20480
  v_mfma_f32_16x16x32_bf16 a[8:11], v[48:51], v[168:171], a[8:11]
  s_add_u32 s38, s77, 8192
  v_mfma_f32_16x16x32_bf16 a[12:15], v[48:51], v[172:175], a[12:15]
  buffer_load_dwordx4 a[240:243], v16, s[16:19], s38 offen offset:0 sc1
  v_mfma_f32_16x16x32_bf16 a[16:19], v[52:55], v[160:163], a[16:19]
  v_exp_f32 v224, v224
  v_mfma_f32_16x16x32_bf16 a[20:23], v[52:55], v[164:167], a[20:23]
  ds_read_b64_tr_b16 v[48:49], v31 offset:16384
  ds_read_b64_tr_b16 v[50:51], v31 offset:20480
  v_mfma_f32_16x16x32_bf16 a[24:27], v[52:55], v[168:171], a[24:27]
  buffer_load_dwordx4 a[244:247], v16, s[16:19], s38 offen offset:1024 sc1
  v_mfma_f32_16x16x32_bf16 a[28:31], v[52:55], v[172:175], a[28:31]
  s_waitcnt lgkmcnt(6)
  v_mfma_f32_16x16x32_bf16 a[32:35], v[56:59], v[160:163], a[32:35]
  buffer_load_dwordx4 a[248:251], v16, s[16:19], s38 offen offset:2048 sc1
  v_mfma_f32_16x16x32_bf16 a[36:39], v[56:59], v[164:167], a[36:39]
  ds_read_b64_tr_b16 v[52:53], v32 offset:16384
  ds_read_b64_tr_b16 v[54:55], v32 offset:20480
  v_mfma_f32_16x16x32_bf16 a[40:43], v[56:59], v[168:171], a[40:43]
  buffer_load_dwordx4 a[252:255], v16, s[16:19], s38 offen offset:3072 sc1
  v_mfma_f32_16x16x32_bf16 a[44:47], v[56:59], v[172:175], a[44:47]
  s_add_u32 m0, s40, 0
  v_mfma_f32_16x16x32_bf16 a[48:51], v[60:63], v[160:163], a[48:51]
  v_exp_f32 v225, v225
  v_mfma_f32_16x16x32_bf16 a[52:55], v[60:63], v[164:167], a[52:55]
  buffer_load_dwordx4 v1, s[8:11], s86 offen offset:0 lds
  v_mfma_f32_16x16x32_bf16 a[56:59], v[60:63], v[168:171], a[56:59]
  v_exp_f32 v226, v226
  v_mfma_f32_16x16x32_bf16 a[60:63], v[60:63], v[172:175], a[60:63]
  buffer_load_dwordx4 v2, s[8:11], s86 offen offset:1024 lds
  v_mfma_f32_16x16x32_bf16 a[128:131], v[34:37], v[160:163], a[128:131]
  v_exp_f32 v227, v227
  v_mfma_f32_16x16x32_bf16 a[132:135], v[34:37], v[164:167], a[132:135]
  ds_read_b64_tr_b16 v[56:57], v25 offset:24576
  ds_read_b64_tr_b16 v[58:59], v25 offset:28672
  v_mfma_f32_16x16x32_bf16 a[136:139], v[34:37], v[168:171], a[136:139]
  buffer_load_dwordx4 v3, s[8:11], s86 offen offset:2048 lds
  v_mfma_f32_16x16x32_bf16 a[140:143], v[34:37], v[172:175], a[140:143]
  s_waitcnt lgkmcnt(6)
  v_mfma_f32_16x16x32_bf16 a[64:67], v[64:67], v[160:163], a[64:67]
  buffer_load_dwordx4 v4, s[8:11], s86 offen offset:3072 lds
  v_mfma_f32_16x16x32_bf16 a[68:71], v[64:67], v[164:167], a[68:71]
  ds_read_b64_tr_b16 v[60:61], v26 offset:24576
  ds_read_b64_tr_b16 v[62:63], v26 offset:28672
  v_mfma_f32_16x16x32_bf16 a[72:75], v[64:67], v[168:171], a[72:75]
  v_exp_f32 v228, v228
  v_mfma_f32_16x16x32_bf16 a[76:79], v[64:67], v[172:175], a[76:79]
  v_exp_f32 v229, v229
  v_mfma_f32_16x16x32_bf16 a[80:83], v[68:71], v[160:163], a[80:83]
  v_exp_f32 v230, v230
  v_mfma_f32_16x16x32_bf16 a[84:87], v[68:71], v[164:167], a[84:87]
  ds_read_b64_tr_b16 v[64:65], v27 offset:24576
  ds_read_b64_tr_b16 v[66:67], v27 offset:28672
  v_mfma_f32_16x16x32_bf16 a[88:91], v[68:71], v[168:171], a[88:91]
  v_exp_f32 v231, v231
  v_mfma_f32_16x16x32_bf16 a[92:95], v[68:71], v[172:175], a[92:95]
  v_cvt_pk_bf16_f32 v176, v224, v225
  s_waitcnt lgkmcnt(6)
  v_mfma_f32_16x16x32_bf16 a[96:99], v[48:51], v[160:163], a[96:99]
  v_cvt_pk_bf16_f32 v177, v226, v227
  s_add_u32 m0, s40, 4096
  v_mfma_f32_16x16x32_bf16 a[100:103], v[48:51], v[164:167], a[100:103]
  ds_read_b64_tr_b16 v[68:69], v28 offset:24576
  ds_read_b64_tr_b16 v[70:71], v28 offset:28672
  v_mfma_f32_16x16x32_bf16 a[104:107], v[48:51], v[168:171], a[104:107]
  v_exp_f32 v232, v232
  v_mfma_f32_16x16x32_bf16 a[108:111], v[48:51], v[172:175], a[108:111]
  v_exp_f32 v233, v233
  v_mfma_f32_16x16x32_bf16 a[112:115], v[52:55], v[160:163], a[112:115]
  v_exp_f32 v234, v234
  v_mfma_f32_16x16x32_bf16 a[116:119], v[52:55], v[164:167], a[116:119]
  v_exp_f32 v235, v235
  v_mfma_f32_16x16x32_bf16 a[120:123], v[52:55], v[168:171], a[120:123]
  v_cvt_pk_bf16_f32 v180, v228, v229
  v_cvt_pk_bf16_f32 v181, v230, v231
  v_exp_f32 v236, v236
  v_exp_f32 v237, v237
  v_exp_f32 v238, v238
  v_exp_f32 v239, v239
  v_cvt_pk_bf16_f32 v184, v232, v233
  v_cvt_pk_bf16_f32 v185, v234, v235
  v_exp_f32 v240, v240
  v_exp_f32 v241, v241
  v_exp_f32 v242, v242
  v_exp_f32 v243, v243
  v_cvt_pk_bf16_f32 v188, v236, v237
  v_cvt_pk_bf16_f32 v189, v238, v239
  v_exp_f32 v244, v244
  v_exp_f32 v245, v245
  v_exp_f32 v246, v246
  v_exp_f32 v247, v247
  v_cvt_pk_bf16_f32 v178, v240, v241
  v_cvt_pk_bf16_f32 v179, v242, v243
  v_exp_f32 v248, v248
  v_exp_f32 v249, v249
  v_exp_f32 v250, v250
  v_exp_f32 v251, v251
  v_cvt_pk_bf16_f32 v182, v244, v245
  v_cvt_pk_bf16_f32 v183, v246, v247
  v_exp_f32 v252, v252
  v_exp_f32 v253, v253
  v_exp_f32 v254, v254
  v_exp_f32 v255, v255
  v_cvt_pk_bf16_f32 v186, v248, v249
  v_cvt_pk_bf16_f32 v187, v250, v251
  v_cvt_pk_bf16_f32 v190, v252, v253
  v_cvt_pk_bf16_f32 v191, v254, v255
  v_mfma_f32_16x16x32_bf16 a[124:127], v[52:55], v[172:175], a[124:127]
  ds_read_b64_tr_b16 v[48:49], v29 offset:24576
  s_waitcnt lgkmcnt(5)
  v_mfma_f32_16x16x32_bf16 a[0:3], v[56:59], v[176:179], a[0:3]
  ds_read_b64_tr_b16 v[50:51], v29 offset:28672
  v_mfma_f32_16x16x32_bf16 a[4:7], v[56:59], v[180:183], a[4:7]
  buffer_load_dwordx4 v5, s[8:11], s86 offen offset:0 lds
  v_mfma_f32_16x16x32_bf16 a[8:11], v[56:59], v[184:187], a[8:11]
  buffer_load_dwordx4 v6, s[8:11], s86 offen offset:1024 lds
  v_mfma_f32_16x16x32_bf16 a[12:15], v[56:59], v[188:191], a[12:15]
  buffer_load_dwordx4 v7, s[8:11], s86 offen offset:2048 lds
  v_mfma_f32_16x16x32_bf16 a[128:131], v[34:37], v[176:179], a[128:131]
  buffer_load_dwordx4 v8, s[8:11], s86 offen offset:3072 lds
  v_mfma_f32_16x16x32_bf16 a[132:135], v[34:37], v[180:183], a[132:135]
  ds_read_b64_tr_b16 v[52:53], v30 offset:24576
  ds_read_b64_tr_b16 v[54:55], v30 offset:28672
  v_mfma_f32_16x16x32_bf16 a[136:139], v[34:37], v[184:187], a[136:139]
  s_add_u32 m0, s40, 8192
  v_mfma_f32_16x16x32_bf16 a[140:143], v[34:37], v[188:191], a[140:143]
  buffer_load_dwordx4 v9, s[8:11], s86 offen offset:0 lds
  v_mfma_f32_16x16x32_bf16 a[16:19], v[60:63], v[176:179], a[16:19]
  v_mfma_f32_16x16x32_bf16 a[20:23], v[60:63], v[180:183], a[20:23]
  ds_read_b64_tr_b16 v[56:57], v31 offset:24576
  ds_read_b64_tr_b16 v[58:59], v31 offset:28672
  v_mfma_f32_16x16x32_bf16 a[24:27], v[60:63], v[184:187], a[24:27]
  v_mfma_f32_16x16x32_bf16 a[28:31], v[60:63], v[188:191], a[28:31]
  s_waitcnt lgkmcnt(6)
  v_mfma_f32_16x16x32_bf16 a[32:35], v[64:67], v[176:179], a[32:35]
  v_mfma_f32_16x16x32_bf16 a[36:39], v[64:67], v[180:183], a[36:39]
  ds_read_b64_tr_b16 v[60:61], v32 offset:24576
  ds_read_b64_tr_b16 v[62:63], v32 offset:28672
  v_mfma_f32_16x16x32_bf16 a[40:43], v[64:67], v[184:187], a[40:43]
  v_accvgpr_read_b32 v40, a128
  v_accvgpr_read_b32 v41, a132
  v_mfma_f32_16x16x32_bf16 a[44:47], v[64:67], v[188:191], a[44:47]
  v_accvgpr_read_b32 v42, a136
  v_accvgpr_read_b32 v43, a140
  v_mfma_f32_16x16x32_bf16 a[48:51], v[68:71], v[176:179], a[48:51]
  v_add_f32 v38, v40, v41
  v_add_f32 v39, v42, v43
  v_mfma_f32_16x16x32_bf16 a[52:55], v[68:71], v[180:183], a[52:55]
  s_mov_b32 s70, 0x4e800000
  v_add_f32 v38, v38, v39
  v_mfma_f32_16x16x32_bf16 a[56:59], v[68:71], v[184:187], a[56:59]
  v_cmp_ngt_f32 vcc, s70, v38
  s_lshl_b32 s70, s3, 2
  v_mfma_f32_16x16x32_bf16 a[60:63], v[68:71], v[188:191], a[60:63]
  s_add_u32 s70, s70, 163808
  s_waitcnt lgkmcnt(4)
  v_mfma_f32_16x16x32_bf16 a[64:67], v[48:51], v[176:179], a[64:67]
  v_mov_b32 v45, s70
  v_mfma_f32_16x16x32_bf16 a[68:71], v[48:51], v[180:183], a[68:71]
  s_cmp_lg_u64 vcc, 0
  s_cselect_b32 s70, 1, 0
  v_mfma_f32_16x16x32_bf16 a[72:75], v[48:51], v[184:187], a[72:75]
  v_mov_b32 v46, s70
  ds_write_b32 v45, v46
  v_mfma_f32_16x16x32_bf16 a[76:79], v[48:51], v[188:191], a[76:79]
  v_mov_b32 v45, 163808
  v_mfma_f32_16x16x32_bf16 a[80:83], v[52:55], v[176:179], a[80:83]
  v_rcp_f32 v40, v40
  v_mfma_f32_16x16x32_bf16 a[84:87], v[52:55], v[180:183], a[84:87]
  v_rcp_f32 v41, v41
  v_mfma_f32_16x16x32_bf16 a[88:91], v[52:55], v[184:187], a[88:91]
  v_rcp_f32 v42, v42
  v_mfma_f32_16x16x32_bf16 a[92:95], v[52:55], v[188:191], a[92:95]
  s_waitcnt lgkmcnt(1)
  v_mfma_f32_16x16x32_bf16 a[96:99], v[56:59], v[176:179], a[96:99]
  v_rcp_f32 v43, v43
  v_mfma_f32_16x16x32_bf16 a[100:103], v[56:59], v[180:183], a[100:103]
  v_accvgpr_read_b32 v192, a0
  v_accvgpr_read_b32 v193, a1
  v_mfma_f32_16x16x32_bf16 a[104:107], v[56:59], v[184:187], a[104:107]
  v_accvgpr_read_b32 v194, a2
  v_accvgpr_read_b32 v195, a3
  v_mfma_f32_16x16x32_bf16 a[108:111], v[56:59], v[188:191], a[108:111]
  v_accvgpr_read_b32 v224, a16
  v_accvgpr_read_b32 v225, a17
  v_mfma_f32_16x16x32_bf16 a[112:115], v[60:63], v[176:179], a[112:115]
  v_accvgpr_read_b32 v226, a18
  v_accvgpr_read_b32 v227, a19
  v_mfma_f32_16x16x32_bf16 a[116:119], v[60:63], v[180:183], a[116:119]
  v_mul_f32 v192, v192, v40
  v_mul_f32 v193, v193, v40
  v_mfma_f32_16x16x32_bf16 a[120:123], v[60:63], v[184:187], a[120:123]
  v_mul_f32 v194, v194, v40
  v_mul_f32 v195, v195, v40
  v_mfma_f32_16x16x32_bf16 a[124:127], v[60:63], v[188:191], a[124:127]
  v_mul_f32 v224, v224, v40
  v_mul_f32 v225, v225, v40
  v_mul_f32 v226, v226, v40
  v_mul_f32 v227, v227, v40
  v_cvt_pk_bf16_f32 v192, v192, v193
  v_cvt_pk_bf16_f32 v193, v194, v195
  v_cvt_pk_bf16_f32 v194, v224, v225
  v_cvt_pk_bf16_f32 v195, v226, v227
  s_mov_b32 s68, 0
  buffer_store_dwordx4 v[192:195], v16, s[32:35], s68 offen offset:0 sc1
  v_accvgpr_read_b32 v196, a4
  v_accvgpr_read_b32 v197, a5
  v_accvgpr_read_b32 v198, a6
  v_accvgpr_read_b32 v199, a7
  v_accvgpr_read_b32 v224, a20
  v_accvgpr_read_b32 v225, a21
  v_accvgpr_read_b32 v226, a22
  v_accvgpr_read_b32 v227, a23
  v_mul_f32 v196, v196, v41
  v_mul_f32 v197, v197, v41
  v_mul_f32 v198, v198, v41
  v_mul_f32 v199, v199, v41
  v_mul_f32 v224, v224, v41
  v_mul_f32 v225, v225, v41
  v_mul_f32 v226, v226, v41
  v_mul_f32 v227, v227, v41
  v_cvt_pk_bf16_f32 v196, v196, v197
  v_cvt_pk_bf16_f32 v197, v198, v199
  v_cvt_pk_bf16_f32 v198, v224, v225
  v_cvt_pk_bf16_f32 v199, v226, v227
  s_mov_b32 s68, 0
  buffer_store_dwordx4 v[196:199], v16, s[32:35], s68 offen offset:1024 sc1
  v_accvgpr_read_b32 v200, a8
  v_accvgpr_read_b32 v201, a9
  v_accvgpr_read_b32 v202, a10
  v_accvgpr_read_b32 v203, a11
  v_accvgpr_read_b32 v224, a24
  v_accvgpr_read_b32 v225, a25
  v_accvgpr_read_b32 v226, a26
  v_accvgpr_read_b32 v227, a27
  v_mul_f32 v200, v200, v42
  v_mul_f32 v201, v201, v42
  v_mul_f32 v202, v202, v42
  v_mul_f32 v203, v203, v42
  v_mul_f32 v224, v224, v42
  v_mul_f32 v225, v225, v42
  v_mul_f32 v226, v226, v42
  v_mul_f32 v227, v227, v42
  v_cvt_pk_bf16_f32 v200, v200, v201
  v_cvt_pk_bf16_f32 v201, v202, v203
  v_cvt_pk_bf16_f32 v202, v224, v225
  v_cvt_pk_bf16_f32 v203, v226, v227
  s_mov_b32 s68, 0
  buffer_store_dwordx4 v[200:203], v16, s[32:35], s68 offen offset:2048 sc1
  v_accvgpr_read_b32 v204, a12
  v_accvgpr_read_b32 v205, a13
  v_accvgpr_read_b32 v206, a14
  v_accvgpr_read_b32 v207, a15
  v_accvgpr_read_b32 v224, a28
  v_accvgpr_read_b32 v225, a29
  v_accvgpr_read_b32 v226, a30
  v_accvgpr_read_b32 v227, a31
  v_mul_f32 v204, v204, v43
  v_mul_f32 v205, v205, v43
  v_mul_f32 v206, v206, v43
  v_mul_f32 v207, v207, v43
  v_mul_f32 v224, v224, v43
  v_mul_f32 v225, v225, v43
  v_mul_f32 v226, v226, v43
  v_mul_f32 v227, v227, v43
  v_cvt_pk_bf16_f32 v204, v204, v205
  v_cvt_pk_bf16_f32 v205, v206, v207
  v_cvt_pk_bf16_f32 v206, v224, v225
  v_cvt_pk_bf16_f32 v207, v226, v227
  s_mov_b32 s68, 0
  buffer_store_dwordx4 v[204:207], v16, s[32:35], s68 offen offset:3072 sc1
  v_accvgpr_read_b32 v208, a32
  v_accvgpr_read_b32 v209, a33
  v_accvgpr_read_b32 v210, a34
  v_accvgpr_read_b32 v211, a35
  v_accvgpr_read_b32 v224, a48
  v_accvgpr_read_b32 v225, a49
  v_accvgpr_read_b32 v226, a50
  v_accvgpr_read_b32 v227, a51
  v_mul_f32 v208, v208, v40
  v_mul_f32 v209, v209, v40
  v_mul_f32 v210, v210, v40
  v_mul_f32 v211, v211, v40
  v_mul_f32 v224, v224, v40
  v_mul_f32 v225, v225, v40
  v_mul_f32 v226, v226, v40
  v_mul_f32 v227, v227, v40
  v_cvt_pk_bf16_f32 v208, v208, v209
  v_cvt_pk_bf16_f32 v209, v210, v211
  v_cvt_pk_bf16_f32 v210, v224, v225
  v_cvt_pk_bf16_f32 v211, v226, v227
  s_mov_b32 s68, 4096
  buffer_store_dwordx4 v[208:211], v16, s[32:35], s68 offen offset:0 sc1
  v_accvgpr_read_b32 v212, a36
  v_accvgpr_read_b32 v213, a37
  v_accvgpr_read_b32 v214, a38
  v_accvgpr_read_b32 v215, a39
  v_accvgpr_read_b32 v224, a52
  v_accvgpr_read_b32 v225, a53
  v_accvgpr_read_b32 v226, a54
  v_accvgpr_read_b32 v227, a55
  v_mul_f32 v212, v212, v41
  v_mul_f32 v213, v213, v41
  v_mul_f32 v214, v214, v41
  v_mul_f32 v215, v215, v41
  v_mul_f32 v224, v224, v41
  v_mul_f32 v225, v225, v41
  v_mul_f32 v226, v226, v41
  v_mul_f32 v227, v227, v41
  v_cvt_pk_bf16_f32 v212, v212, v213
  v_cvt_pk_bf16_f32 v213, v214, v215
  v_cvt_pk_bf16_f32 v214, v224, v225
  v_cvt_pk_bf16_f32 v215, v226, v227
  s_mov_b32 s68, 4096
  buffer_store_dwordx4 v[212:215], v16, s[32:35], s68 offen offset:1024 sc1
  v_accvgpr_read_b32 v216, a40
  v_accvgpr_read_b32 v217, a41
  v_accvgpr_read_b32 v218, a42
  v_accvgpr_read_b32 v219, a43
  v_accvgpr_read_b32 v224, a56
  v_accvgpr_read_b32 v225, a57
  v_accvgpr_read_b32 v226, a58
  v_accvgpr_read_b32 v227, a59
  v_mul_f32 v216, v216, v42
  v_mul_f32 v217, v217, v42
  v_mul_f32 v218, v218, v42
  v_mul_f32 v219, v219, v42
  v_mul_f32 v224, v224, v42
  v_mul_f32 v225, v225, v42
  v_mul_f32 v226, v226, v42
  v_mul_f32 v227, v227, v42
  v_cvt_pk_bf16_f32 v216, v216, v217
  v_cvt_pk_bf16_f32 v217, v218, v219
  v_cvt_pk_bf16_f32 v218, v224, v225
  v_cvt_pk_bf16_f32 v219, v226, v227
  s_mov_b32 s68, 4096
  buffer_store_dwordx4 v[216:219], v16, s[32:35], s68 offen offset:2048 sc1
  v_accvgpr_read_b32 v220, a44
  v_accvgpr_read_b32 v221, a45
  v_accvgpr_read_b32 v222, a46
  v_accvgpr_read_b32 v223, a47
  v_accvgpr_read_b32 v224, a60
  v_accvgpr_read_b32 v225, a61
  v_accvgpr_read_b32 v226, a62
  v_accvgpr_read_b32 v227, a63
  v_mul_f32 v220, v220, v43
  v_mul_f32 v221, v221, v43
  v_mul_f32 v222, v222, v43
  v_mul_f32 v223, v223, v43
  v_mul_f32 v224, v224, v43
  v_mul_f32 v225, v225, v43
  v_mul_f32 v226, v226, v43
  v_mul_f32 v227, v227, v43
  v_cvt_pk_bf16_f32 v220, v220, v221
  v_cvt_pk_bf16_f32 v221, v222, v223
  v_cvt_pk_bf16_f32 v222, v224, v225
  v_cvt_pk_bf16_f32 v223, v226, v227
  s_mov_b32 s68, 4096
  buffer_store_dwordx4 v[220:223], v16, s[32:35], s68 offen offset:3072 sc1
L_attn_done:
  s_waitcnt vmcnt(29) lgkmcnt(0)
  s_barrier
  ds_read_b128 v[44:47], v45
  ds_read_b64_tr_b16 v[48:49], v11 offset:0
  ds_read_b64_tr_b16 v[50:51], v11 offset:4608
  ds_read_b64_tr_b16 v[52:53], v11 offset:32
  ds_read_b64_tr_b16 v[54:55], v11 offset:4640
  ds_read_b64_tr_b16 v[56:57], v11 offset:64
  ds_read_b64_tr_b16 v[58:59], v11 offset:4672
  ds_read_b64_tr_b16 v[60:61], v11 offset:96
  ds_read_b64_tr_b16 v[62:63], v11 offset:4704
  s_waitcnt lgkmcnt(8)
  v_or3_b32 v46, v44, v45, v46
  v_or_b32 v46, v46, v47
  s_nop 0
  v_readfirstlane_b32 s70, v46
  s_xor_b32 s71, s55, 1
  s_and_b32 s70, s70, s71
  s_cbranch_scc1 L_fallback
  s_bitcmp0_b32 s7, 0
  s_cbranch_scc1 L_gpath
  v_accvgpr_write_b32 a144, v192
  v_accvgpr_write_b32 a145, v193
  v_accvgpr_write_b32 a146, v194
  v_accvgpr_write_b32 a147, v195
  v_accvgpr_write_b32 a148, v196
  v_accvgpr_write_b32 a149, v197
  v_accvgpr_write_b32 a150, v198
  v_accvgpr_write_b32 a151, v199
  v_accvgpr_write_b32 a152, v200
  v_accvgpr_write_b32 a153, v201
  v_accvgpr_write_b32 a154, v202
  v_accvgpr_write_b32 a155, v203
  v_accvgpr_write_b32 a156, v204
  v_accvgpr_write_b32 a157, v205
  v_accvgpr_write_b32 a158, v206
  v_accvgpr_write_b32 a159, v207
  s_waitcnt lgkmcnt(4)
  v_mfma_f32_16x16x32_bf16 v[112:115], v[48:51], a[144:147], 0
  ds_read_b64_tr_b16 v[64:65], v11 offset:128
  ds_read_b64_tr_b16 v[66:67], v11 offset:4736
  v_mfma_f32_16x16x32_bf16 v[116:119], v[48:51], a[148:151], 0
  ds_read_b64_tr_b16 v[68:69], v11 offset:160
  ds_read_b64_tr_b16 v[70:71], v11 offset:4768
  v_mfma_f32_16x16x32_bf16 v[120:123], v[48:51], a[152:155], 0
  v_accvgpr_write_b32 a160, v208
  v_accvgpr_write_b32 a161, v209
  v_mfma_f32_16x16x32_bf16 v[124:127], v[48:51], a[156:159], 0
  v_accvgpr_write_b32 a162, v210
  v_accvgpr_write_b32 a163, v211
  v_mfma_f32_16x16x32_bf16 v[128:131], v[52:55], a[144:147], 0
  ds_read_b64_tr_b16 v[48:49], v11 offset:192
  ds_read_b64_tr_b16 v[50:51], v11 offset:4800
  v_mfma_f32_16x16x32_bf16 v[132:135], v[52:55], a[148:151], 0
  v_accvgpr_write_b32 a164, v212
  v_accvgpr_write_b32 a165, v213
  v_mfma_f32_16x16x32_bf16 v[136:139], v[52:55], a[152:155], 0
  v_accvgpr_write_b32 a166, v214
  v_accvgpr_write_b32 a167, v215
  v_mfma_f32_16x16x32_bf16 v[140:143], v[52:55], a[156:159], 0
  v_accvgpr_write_b32 a168, v216
  s_waitcnt lgkmcnt(6)
  v_mfma_f32_16x16x32_bf16 v[144:147], v[56:59], a[144:147], 0
  ds_read_b64_tr_b16 v[52:53], v11 offset:224
  ds_read_b64_tr_b16 v[54:55], v11 offset:4832
  v_mfma_f32_16x16x32_bf16 v[148:151], v[56:59], a[148:151], 0
  v_accvgpr_write_b32 a169, v217
  v_accvgpr_write_b32 a170, v218
  v_mfma_f32_16x16x32_bf16 v[152:155], v[56:59], a[152:155], 0
  v_accvgpr_write_b32 a171, v219
  v_accvgpr_write_b32 a172, v220
  v_mfma_f32_16x16x32_bf16 v[156:159], v[56:59], a[156:159], 0
  v_accvgpr_write_b32 a173, v221
  v_accvgpr_write_b32 a174, v222
  v_mfma_f32_16x16x32_bf16 v[160:163], v[60:63], a[144:147], 0
  v_accvgpr_write_b32 a175, v223
  ds_read_b64_tr_b16 v[56:57], v11 offset:256
  v_mfma_f32_16x16x32_bf16 v[164:167], v[60:63], a[148:151], 0
  ds_read_b64_tr_b16 v[58:59], v11 offset:4864
  v_accvgpr_read_b32 v80, a64
  v_mfma_f32_16x16x32_bf16 v[168:171], v[60:63], a[152:155], 0
  v_accvgpr_read_b32 v81, a65
  v_accvgpr_read_b32 v82, a66
  v_mfma_f32_16x16x32_bf16 v[172:175], v[60:63], a[156:159], 0
  v_accvgpr_read_b32 v83, a67
  s_waitcnt lgkmcnt(6)
  v_mfma_f32_16x16x32_bf16 v[176:179], v[64:67], a[144:147], 0
  ds_read_b64_tr_b16 v[60:61], v11 offset:9216
  ds_read_b64_tr_b16 v[62:63], v11 offset:13824
  v_mfma_f32_16x16x32_bf16 v[180:183], v[64:67], a[148:151], 0
  v_accvgpr_read_b32 v84, a80
  v_accvgpr_read_b32 v85, a81
  v_mfma_f32_16x16x32_bf16 v[184:187], v[64:67], a[152:155], 0
  v_accvgpr_read_b32 v86, a82
  v_accvgpr_read_b32 v87, a83
  v_mfma_f32_16x16x32_bf16 v[188:191], v[64:67], a[156:159], 0
  v_mul_f32 v80, v80, v40
  v_mul_f32 v81, v81, v40
  v_mfma_f32_16x16x32_bf16 v[192:195], v[68:71], a[144:147], 0
  ds_read_b64_tr_b16 v[64:65], v11 offset:9248
  ds_read_b64_tr_b16 v[66:67], v11 offset:13856
  v_mfma_f32_16x16x32_bf16 v[196:199], v[68:71], a[148:151], 0
  v_mul_f32 v82, v82, v40
  v_mul_f32 v83, v83, v40
  v_mfma_f32_16x16x32_bf16 v[200:203], v[68:71], a[152:155], 0
  v_mul_f32 v84, v84, v40
  v_mul_f32 v85, v85, v40
  v_mfma_f32_16x16x32_bf16 v[204:207], v[68:71], a[156:159], 0
  v_mul_f32 v86, v86, v40
  s_waitcnt lgkmcnt(6)
  v_mfma_f32_16x16x32_bf16 v[208:211], v[48:51], a[144:147], 0
  ds_read_b64_tr_b16 v[68:69], v11 offset:9280
  ds_read_b64_tr_b16 v[70:71], v11 offset:13888
  v_mfma_f32_16x16x32_bf16 v[212:215], v[48:51], a[148:151], 0
  v_mul_f32 v87, v87, v40
  v_cvt_pk_bf16_f32 v80, v80, v81
  v_mfma_f32_16x16x32_bf16 v[216:219], v[48:51], a[152:155], 0
  v_cvt_pk_bf16_f32 v81, v82, v83
  v_cvt_pk_bf16_f32 v82, v84, v85
  v_mfma_f32_16x16x32_bf16 v[220:223], v[48:51], a[156:159], 0
  v_cvt_pk_bf16_f32 v83, v86, v87
  v_accvgpr_write_b32 a176, v80
  v_mfma_f32_16x16x32_bf16 v[224:227], v[52:55], a[144:147], 0
  ds_read_b64_tr_b16 v[48:49], v11 offset:9312
  ds_read_b64_tr_b16 v[50:51], v11 offset:13920
  v_mfma_f32_16x16x32_bf16 v[228:231], v[52:55], a[148:151], 0
  v_accvgpr_write_b32 a177, v81
  v_accvgpr_write_b32 a178, v82
  v_mfma_f32_16x16x32_bf16 v[232:235], v[52:55], a[152:155], 0
  v_accvgpr_write_b32 a179, v83
  v_accvgpr_read_b32 v84, a68
  v_mfma_f32_16x16x32_bf16 v[236:239], v[52:55], a[156:159], 0
  v_accvgpr_read_b32 v85, a69
  s_waitcnt lgkmcnt(6)
  v_mfma_f32_16x16x32_bf16 v[240:243], v[56:59], a[144:147], 0
  ds_read_b64_tr_b16 v[52:53], v11 offset:9344
  ds_read_b64_tr_b16 v[54:55], v11 offset:13952
  v_mfma_f32_16x16x32_bf16 v[244:247], v[56:59], a[148:151], 0
  v_accvgpr_read_b32 v86, a70
  v_accvgpr_read_b32 v87, a71
  v_mfma_f32_16x16x32_bf16 v[248:251], v[56:59], a[152:155], 0
  v_accvgpr_read_b32 v88, a84
  v_accvgpr_read_b32 v89, a85
  v_mfma_f32_16x16x32_bf16 v[252:255], v[56:59], a[156:159], 0
  v_accvgpr_read_b32 v90, a86
  v_accvgpr_read_b32 v91, a87
  v_mfma_f32_16x16x32_bf16 v[112:115], v[60:63], a[160:163], v[112:115]
  ds_read_b64_tr_b16 v[56:57], v11 offset:9376
  ds_read_b64_tr_b16 v[58:59], v11 offset:13984
  v_mfma_f32_16x16x32_bf16 v[116:119], v[60:63], a[164:167], v[116:119]
  v_mul_f32 v84, v84, v41
  v_mul_f32 v85, v85, v41
  v_mfma_f32_16x16x32_bf16 v[120:123], v[60:63], a[168:171], v[120:123]
  v_mul_f32 v86, v86, v41
  v_mul_f32 v87, v87, v41
  v_mfma_f32_16x16x32_bf16 v[124:127], v[60:63], a[172:175], v[124:127]
  v_mul_f32 v88, v88, v41
  s_waitcnt lgkmcnt(6)
  v_mfma_f32_16x16x32_bf16 v[128:131], v[64:67], a[160:163], v[128:131]
  s_waitcnt vmcnt(0)
  s_barrier
  v_mfma_f32_16x16x32_bf16 v[132:135], v[64:67], a[164:167], v[132:135]
  v_mov_b32 v75, s100
  buffer_store_dword v75, v77, s[96:99], 0 offen offset:384 sc1
  v_mfma_f32_16x16x32_bf16 v[136:139], v[64:67], a[168:171], v[136:139]
  ds_read_b64_tr_b16 v[60:61], v11 offset:9408
  ds_read_b64_tr_b16 v[62:63], v11 offset:14016
  v_mfma_f32_16x16x32_bf16 v[140:143], v[64:67], a[172:175], v[140:143]
  v_mul_f32 v89, v89, v41
  v_mul_f32 v90, v90, v41
  v_mfma_f32_16x16x32_bf16 v[144:147], v[68:71], a[160:163], v[144:147]
  ds_read_b64_tr_b16 v[64:65], v11 offset:9440
  ds_read_b64_tr_b16 v[66:67], v11 offset:14048
  v_mfma_f32_16x16x32_bf16 v[148:151], v[68:71], a[164:167], v[148:151]
  v_mul_f32 v91, v91, v41
  v_cvt_pk_bf16_f32 v84, v84, v85
  v_mfma_f32_16x16x32_bf16 v[152:155], v[68:71], a[168:171], v[152:155]
  v_cvt_pk_bf16_f32 v85, v86, v87
  v_cvt_pk_bf16_f32 v86, v88, v89
  v_mfma_f32_16x16x32_bf16 v[156:159], v[68:71], a[172:175], v[156:159]
  v_cvt_pk_bf16_f32 v87, v90, v91
  s_waitcnt lgkmcnt(6)
  v_mfma_f32_16x16x32_bf16 v[160:163], v[48:51], a[160:163], v[160:163]
  ds_read_b64_tr_b16 v[68:69], v11 offset:9472
  ds_read_b64_tr_b16 v[70:71], v11 offset:14080
  v_mfma_f32_16x16x32_bf16 v[164:167], v[48:51], a[164:167], v[164:167]
  v_accvgpr_write_b32 a180, v84
  v_accvgpr_write_b32 a181, v85
  v_mfma_f32_16x16x32_bf16 v[168:171], v[48:51], a[168:171], v[168:171]
  s_add_u32 m0, s41, 0
  v_accvgpr_write_b32 a182, v86
  v_mfma_f32_16x16x32_bf16 v[172:175], v[48:51], a[172:175], v[172:175]
  v_accvgpr_write_b32 a183, v87
  v_accvgpr_read_b32 v88, a72
  v_mfma_f32_16x16x32_bf16 v[176:179], v[52:55], a[160:163], v[176:179]
  ds_read_b64_tr_b16 v[48:49], v11 offset:18432
  ds_read_b64_tr_b16 v[50:51], v11 offset:23040
  v_mfma_f32_16x16x32_bf16 v[180:183], v[52:55], a[164:167], v[180:183]
  v_accvgpr_read_b32 v89, a73
  v_accvgpr_read_b32 v90, a74
  v_mfma_f32_16x16x32_bf16 v[184:187], v[52:55], a[168:171], v[184:187]
  v_accvgpr_read_b32 v91, a75
  v_accvgpr_read_b32 v92, a88
  v_mfma_f32_16x16x32_bf16 v[188:191], v[52:55], a[172:175], v[188:191]
  v_accvgpr_read_b32 v93, a89
  s_waitcnt lgkmcnt(6)
  v_mfma_f32_16x16x32_bf16 v[192:195], v[56:59], a[160:163], v[192:195]
  buffer_load_dwordx4 v1, s[8:11], s87 offen offset:0 lds
  v_mfma_f32_16x16x32_bf16 v[196:199], v[56:59], a[164:167], v[196:199]
  ds_read_b64_tr_b16 v[52:53], v11 offset:18464
  ds_read_b64_tr_b16 v[54:55], v11 offset:23072
  v_mfma_f32_16x16x32_bf16 v[200:203], v[56:59], a[168:171], v[200:203]
  v_accvgpr_read_b32 v94, a90
  v_accvgpr_read_b32 v95, a91
  v_mfma_f32_16x16x32_bf16 v[204:207], v[56:59], a[172:175], v[204:207]
  v_mul_f32 v88, v88, v42
  v_mul_f32 v89, v89, v42
  v_mfma_f32_16x16x32_bf16 v[208:211], v[60:63], a[160:163], v[208:211]
  buffer_load_dwordx4 v2, s[8:11], s87 offen offset:1024 lds
  v_mfma_f32_16x16x32_bf16 v[212:215], v[60:63], a[164:167], v[212:215]
  ds_read_b64_tr_b16 v[56:57], v11 offset:18496
  ds_read_b64_tr_b16 v[58:59], v11 offset:23104
  v_mfma_f32_16x16x32_bf16 v[216:219], v[60:63], a[168:171], v[216:219]
  v_mul_f32 v90, v90, v42
  v_mul_f32 v91, v91, v42
  v_mfma_f32_16x16x32_bf16 v[220:223], v[60:63], a[172:175], v[220:223]
  v_mul_f32 v92, v92, v42
  s_waitcnt lgkmcnt(6)
  v_mfma_f32_16x16x32_bf16 v[224:227], v[64:67], a[160:163], v[224:227]
  ds_read_b64_tr_b16 v[60:61], v11 offset:18528
  v_mul_f32 v93, v93, v42
  v_mfma_f32_16x16x32_bf16 v[228:231], v[64:67], a[164:167], v[228:231]
  v_mul_f32 v94, v94, v42
  v_mul_f32 v95, v95, v42
  v_mfma_f32_16x16x32_bf16 v[232:235], v[64:67], a[168:171], v[232:235]
  v_cvt_pk_bf16_f32 v88, v88, v89
  v_cvt_pk_bf16_f32 v89, v90, v91
  v_mfma_f32_16x16x32_bf16 v[236:239], v[64:67], a[172:175], v[236:239]
  v_cvt_pk_bf16_f32 v90, v92, v93
  v_cvt_pk_bf16_f32 v91, v94, v95
  v_mfma_f32_16x16x32_bf16 v[240:243], v[68:71], a[160:163], v[240:243]
  v_accvgpr_write_b32 a184, v88
  v_accvgpr_write_b32 a185, v89
  v_mfma_f32_16x16x32_bf16 v[244:247], v[68:71], a[164:167], v[244:247]
  v_accvgpr_write_b32 a186, v90
  v_accvgpr_write_b32 a187, v91
  v_accvgpr_read_b32 v92, a76
  v_accvgpr_read_b32 v93, a77
  v_accvgpr_read_b32 v94, a78
  v_accvgpr_read_b32 v95, a79
  v_accvgpr_read_b32 v96, a92
  v_accvgpr_read_b32 v97, a93
  v_accvgpr_read_b32 v98, a94
  v_accvgpr_read_b32 v99, a95
  v_mul_f32 v92, v92, v43
  v_mul_f32 v93, v93, v43
  v_mul_f32 v94, v94, v43
  v_mul_f32 v95, v95, v43
  v_mul_f32 v96, v96, v43
  v_mul_f32 v97, v97, v43
  v_mul_f32 v98, v98, v43
  v_mul_f32 v99, v99, v43
  v_cvt_pk_bf16_f32 v92, v92, v93
  v_cvt_pk_bf16_f32 v93, v94, v95
  v_cvt_pk_bf16_f32 v94, v96, v97
  v_cvt_pk_bf16_f32 v95, v98, v99
  v_accvgpr_write_b32 a188, v92
  v_accvgpr_write_b32 a189, v93
  v_accvgpr_write_b32 a190, v94
  v_accvgpr_write_b32 a191, v95
  buffer_load_dwordx4 v3, s[8:11], s87 offen offset:2048 lds
  v_mfma_f32_16x16x32_bf16 v[248:251], v[68:71], a[168:171], v[248:251]
  ds_read_b64_tr_b16 v[62:63], v11 offset:23136
  ds_read_b64_tr_b16 v[64:65], v11 offset:18560
  v_mfma_f32_16x16x32_bf16 v[252:255], v[68:71], a[172:175], v[252:255]
  ds_read_b64_tr_b16 v[66:67], v11 offset:23168
  s_waitcnt lgkmcnt(6)
  v_mfma_f32_16x16x32_bf16 v[112:115], v[48:51], a[176:179], v[112:115]
  buffer_load_dwordx4 v4, s[8:11], s87 offen offset:3072 lds
  v_mfma_f32_16x16x32_bf16 v[116:119], v[48:51], a[180:183], v[116:119]
  ds_read_b64_tr_b16 v[68:69], v11 offset:18592
  ds_read_b64_tr_b16 v[70:71], v11 offset:23200
  v_mfma_f32_16x16x32_bf16 v[120:123], v[48:51], a[184:187], v[120:123]
  buffer_load_dword v74, v15, s[96:99], 0 offen offset:384 sc1
  v_mfma_f32_16x16x32_bf16 v[124:127], v[48:51], a[188:191], v[124:127]
  s_add_u32 m0, s41, 4096
  v_accvgpr_read_b32 v96, a96
  v_mfma_f32_16x16x32_bf16 v[128:131], v[52:55], a[176:179], v[128:131]
  ds_read_b64_tr_b16 v[48:49], v11 offset:18624
  ds_read_b64_tr_b16 v[50:51], v11 offset:23232
  v_mfma_f32_16x16x32_bf16 v[132:135], v[52:55], a[180:183], v[132:135]
  v_accvgpr_read_b32 v97, a97
  v_accvgpr_read_b32 v98, a98
  v_mfma_f32_16x16x32_bf16 v[136:139], v[52:55], a[184:187], v[136:139]
  v_accvgpr_read_b32 v99, a99
  v_accvgpr_read_b32 v100, a112
  v_mfma_f32_16x16x32_bf16 v[140:143], v[52:55], a[188:191], v[140:143]
  v_accvgpr_read_b32 v101, a113
  s_waitcnt lgkmcnt(6)
  v_mfma_f32_16x16x32_bf16 v[144:147], v[56:59], a[176:179], v[144:147]
  s_waitcnt vmcnt(0)
  v_cmp_eq_u32 vcc, s100, v74
  s_cmp_eq_u64 vcc, -1
  s_cbranch_scc0 L_retry2
L_back2:
  s_mov_b32 s18, 131072
  s_add_u32 s38, s77, 0
  v_mfma_f32_16x16x32_bf16 v[148:151], v[56:59], a[180:183], v[148:151]
  buffer_load_dwordx4 a[208:211], v16, s[16:19], s38 offen offset:0 sc1
  v_mfma_f32_16x16x32_bf16 v[152:155], v[56:59], a[184:187], v[152:155]
  buffer_load_dwordx4 a[212:215], v16, s[16:19], s38 offen offset:1024 sc1
  v_mfma_f32_16x16x32_bf16 v[156:159], v[56:59], a[188:191], v[156:159]
  buffer_load_dwordx4 a[216:219], v16, s[16:19], s38 offen offset:2048 sc1
  v_mfma_f32_16x16x32_bf16 v[160:163], v[60:63], a[176:179], v[160:163]
  buffer_load_dwordx4 v5, s[8:11], s87 offen offset:0 lds
  buffer_load_dwordx4 a[220:223], v16, s[16:19], s38 offen offset:3072 sc1
  v_mfma_f32_16x16x32_bf16 v[164:167], v[60:63], a[180:183], v[164:167]
  ds_read_b64_tr_b16 v[52:53], v11 offset:18656
  s_add_u32 s38, s77, 4096
  v_mfma_f32_16x16x32_bf16 v[168:171], v[60:63], a[184:187], v[168:171]
  ds_read_b64_tr_b16 v[54:55], v11 offset:23264
  buffer_load_dwordx4 a[224:227], v16, s[16:19], s38 offen offset:0 sc1
  v_mfma_f32_16x16x32_bf16 v[172:175], v[60:63], a[188:191], v[172:175]
  buffer_load_dwordx4 a[228:231], v16, s[16:19], s38 offen offset:1024 sc1
  s_waitcnt lgkmcnt(4)
  v_mfma_f32_16x16x32_bf16 v[176:179], v[64:67], a[176:179], v[176:179]
  buffer_load_dwordx4 a[232:235], v16, s[16:19], s38 offen offset:2048 sc1
  v_mfma_f32_16x16x32_bf16 v[180:183], v[64:67], a[180:183], v[180:183]
  ds_read_b64_tr_b16 v[56:57], v11 offset:18688
  buffer_load_dwordx4 v6, s[8:11], s87 offen offset:1024 lds
  buffer_load_dwordx4 a[236:239], v16, s[16:19], s38 offen offset:3072 sc1
  v_mfma_f32_16x16x32_bf16 v[184:187], v[64:67], a[184:187], v[184:187]
  ds_read_b64_tr_b16 v[58:59], v11 offset:23296
  s_add_u32 s38, s78, 0
  v_mfma_f32_16x16x32_bf16 v[188:191], v[64:67], a[188:191], v[188:191]
  buffer_load_dwordx4 a[240:243], v16, s[16:19], s38 offen offset:0 sc1
  v_mfma_f32_16x16x32_bf16 v[192:195], v[68:71], a[176:179], v[192:195]
  buffer_load_dwordx4 a[244:247], v16, s[16:19], s38 offen offset:1024 sc1
  v_mfma_f32_16x16x32_bf16 v[196:199], v[68:71], a[180:183], v[196:199]
  ds_read_b64_tr_b16 v[60:61], v11 offset:27648
  buffer_load_dwordx4 a[248:251], v16, s[16:19], s38 offen offset:2048 sc1
  v_mfma_f32_16x16x32_bf16 v[200:203], v[68:71], a[184:187], v[200:203]
  ds_read_b64_tr_b16 v[62:63], v11 offset:32256
  buffer_load_dwordx4 v7, s[8:11], s87 offen offset:2048 lds
  buffer_load_dwordx4 a[252:255], v16, s[16:19], s38 offen offset:3072 sc1
  v_mfma_f32_16x16x32_bf16 v[204:207], v[68:71], a[188:191], v[204:207]
  s_add_u32 s52, s79, 0
  s_mov_b64 exec, 0xffff
  buffer_load_dword v73, v14, s[16:19], s52 offen sc1
  s_mov_b64 exec, -1
  s_waitcnt lgkmcnt(4)
  v_mfma_f32_16x16x32_bf16 v[208:211], v[48:51], a[176:179], v[208:211]
  s_add_u32 s52, s80, 0
  s_mov_b64 exec, 0xffff
  buffer_load_dword v73, v14, s[16:19], s52 offen sc1
  s_mov_b64 exec, -1
  v_mfma_f32_16x16x32_bf16 v[212:215], v[48:51], a[180:183], v[212:215]
  ds_read_b64_tr_b16 v[64:65], v11 offset:27680
  ds_read_b64_tr_b16 v[66:67], v11 offset:32288
  v_mfma_f32_16x16x32_bf16 v[216:219], v[48:51], a[184:187], v[216:219]
  buffer_load_dwordx4 v8, s[8:11], s87 offen offset:3072 lds
  v_mfma_f32_16x16x32_bf16 v[220:223], v[48:51], a[188:191], v[220:223]
  ds_read_b64_tr_b16 v[68:69], v11 offset:27712
  ds_read_b64_tr_b16 v[70:71], v11 offset:32320
  v_mfma_f32_16x16x32_bf16 v[224:227], v[52:55], a[176:179], v[224:227]
  s_add_u32 m0, s41, 8192
  ds_read_b64_tr_b16 v[48:49], v11 offset:27744
  v_mfma_f32_16x16x32_bf16 v[228:231], v[52:55], a[180:183], v[228:231]
  v_accvgpr_read_b32 v102, a114
  v_accvgpr_read_b32 v103, a115
  v_mfma_f32_16x16x32_bf16 v[232:235], v[52:55], a[184:187], v[232:235]
  v_mul_f32 v96, v96, v40
  v_mul_f32 v97, v97, v40
  v_mfma_f32_16x16x32_bf16 v[236:239], v[52:55], a[188:191], v[236:239]
  v_mul_f32 v98, v98, v40
  s_waitcnt lgkmcnt(5)
  v_mfma_f32_16x16x32_bf16 v[240:243], v[56:59], a[176:179], v[240:243]
  v_mul_f32 v99, v99, v40
  v_mul_f32 v100, v100, v40
  v_mfma_f32_16x16x32_bf16 v[244:247], v[56:59], a[180:183], v[244:247]
  v_mul_f32 v101, v101, v40
  v_mul_f32 v102, v102, v40
  v_mul_f32 v103, v103, v40
  v_cvt_pk_bf16_f32 v96, v96, v97
  v_cvt_pk_bf16_f32 v97, v98, v99
  v_cvt_pk_bf16_f32 v98, v100, v101
  v_cvt_pk_bf16_f32 v99, v102, v103
  v_accvgpr_write_b32 a192, v96
  v_accvgpr_write_b32 a193, v97
  v_accvgpr_write_b32 a194, v98
  v_accvgpr_write_b32 a195, v99
  v_accvgpr_read_b32 v100, a100
  v_accvgpr_read_b32 v101, a101
  v_accvgpr_read_b32 v102, a102
  v_accvgpr_read_b32 v103, a103
  v_accvgpr_read_b32 v104, a116
  v_accvgpr_read_b32 v105, a117
  v_accvgpr_read_b32 v106, a118
  v_accvgpr_read_b32 v107, a119
  v_mul_f32 v100, v100, v41
  v_mul_f32 v101, v101, v41
  v_mul_f32 v102, v102, v41
  v_mul_f32 v103, v103, v41
  v_mul_f32 v104, v104, v41
  v_mul_f32 v105, v105, v41
  v_mul_f32 v106, v106, v41
  v_mul_f32 v107, v107, v41
  v_cvt_pk_bf16_f32 v100, v100, v101
  v_cvt_pk_bf16_f32 v101, v102, v103
  v_cvt_pk_bf16_f32 v102, v104, v105
  v_cvt_pk_bf16_f32 v103, v106, v107
  v_accvgpr_write_b32 a196, v100
  v_accvgpr_write_b32 a197, v101
  v_accvgpr_write_b32 a198, v102
  v_accvgpr_write_b32 a199, v103
  v_accvgpr_read_b32 v104, a104
  v_accvgpr_read_b32 v105, a105
  v_accvgpr_read_b32 v106, a106
  v_accvgpr_read_b32 v107, a107
  v_accvgpr_read_b32 v108, a120
  v_accvgpr_read_b32 v109, a121
  v_accvgpr_read_b32 v110, a122
  v_accvgpr_read_b32 v111, a123
  v_mul_f32 v104, v104, v42
  v_mul_f32 v105, v105, v42
  v_mul_f32 v106, v106, v42
  v_mul_f32 v107, v107, v42
  v_mul_f32 v108, v108, v42
  v_mul_f32 v109, v109, v42
  v_mul_f32 v110, v110, v42
  v_mul_f32 v111, v111, v42
  v_cvt_pk_bf16_f32 v104, v104, v105
  v_cvt_pk_bf16_f32 v105, v106, v107
  v_cvt_pk_bf16_f32 v106, v108, v109
  v_cvt_pk_bf16_f32 v107, v110, v111
  v_accvgpr_write_b32 a200, v104
  v_accvgpr_write_b32 a201, v105
  v_accvgpr_write_b32 a202, v106
  v_accvgpr_write_b32 a203, v107
  v_accvgpr_read_b32 v108, a108
  v_accvgpr_read_b32 v109, a109
  v_accvgpr_read_b32 v110, a110
  v_accvgpr_read_b32 v111, a111
  v_accvgpr_read_b32 v44, a124
  v_accvgpr_read_b32 v45, a125
  v_accvgpr_read_b32 v46, a126
  v_accvgpr_read_b32 v47, a127
  v_mul_f32 v108, v108, v43
  v_mul_f32 v109, v109, v43
  v_mul_f32 v110, v110, v43
  v_mul_f32 v111, v111, v43
  v_mul_f32 v44, v44, v43
  v_mul_f32 v45, v45, v43
  v_mul_f32 v46, v46, v43
  v_mul_f32 v47, v47, v43
  v_cvt_pk_bf16_f32 v108, v108, v109
  v_cvt_pk_bf16_f32 v109, v110, v111
  v_cvt_pk_bf16_f32 v110, v44, v45
  v_cvt_pk_bf16_f32 v111, v46, v47
  v_accvgpr_write_b32 a204, v108
  v_accvgpr_write_b32 a205, v109
  v_accvgpr_write_b32 a206, v110
  v_accvgpr_write_b32 a207, v111
  v_mfma_f32_16x16x32_bf16 v[248:251], v[56:59], a[184:187], v[248:251]
  ds_read_b64_tr_b16 v[50:51], v11 offset:32352
  ds_read_b64_tr_b16 v[52:53], v11 offset:27776
  v_mfma_f32_16x16x32_bf16 v[252:255], v[56:59], a[188:191], v[252:255]
  buffer_load_dwordx4 v9, s[8:11], s87 offen offset:0 lds
  v_mfma_f32_16x16x32_bf16 v[112:115], v[60:63], a[192:195], v[112:115]
  ds_read_b64_tr_b16 v[54:55], v11 offset:32384
  ds_read_b64_tr_b16 v[56:57], v11 offset:27808
  v_mfma_f32_16x16x32_bf16 v[116:119], v[60:63], a[196:199], v[116:119]
  ds_read_b64_tr_b16 v[58:59], v11 offset:32416
  v_mfma_f32_16x16x32_bf16 v[120:123], v[60:63], a[200:203], v[120:123]
  v_mfma_f32_16x16x32_bf16 v[124:127], v[60:63], a[204:207], v[124:127]
  s_waitcnt lgkmcnt(6)
  v_mfma_f32_16x16x32_bf16 v[128:131], v[64:67], a[192:195], v[128:131]
  ds_read_b64_tr_b16 v[60:61], v11 offset:27840
  ds_read_b64_tr_b16 v[62:63], v11 offset:32448
  v_mfma_f32_16x16x32_bf16 v[132:135], v[64:67], a[196:199], v[132:135]
  v_mfma_f32_16x16x32_bf16 v[136:139], v[64:67], a[200:203], v[136:139]
  v_mfma_f32_16x16x32_bf16 v[140:143], v[64:67], a[204:207], v[140:143]
  v_mfma_f32_16x16x32_bf16 v[144:147], v[68:71], a[192:195], v[144:147]
  ds_read_b64_tr_b16 v[64:65], v11 offset:27872
  ds_read_b64_tr_b16 v[66:67], v11 offset:32480
  v_mfma_f32_16x16x32_bf16 v[148:151], v[68:71], a[196:199], v[148:151]
  v_mfma_f32_16x16x32_bf16 v[152:155], v[68:71], a[200:203], v[152:155]
  v_mfma_f32_16x16x32_bf16 v[156:159], v[68:71], a[204:207], v[156:159]
  s_waitcnt lgkmcnt(6)
  v_mfma_f32_16x16x32_bf16 v[160:163], v[48:51], a[192:195], v[160:163]
  ds_read_b64_tr_b16 v[68:69], v11 offset:27904
  ds_read_b64_tr_b16 v[70:71], v11 offset:32512
  v_mfma_f32_16x16x32_bf16 v[164:167], v[48:51], a[196:199], v[164:167]
  v_mfma_f32_16x16x32_bf16 v[168:171], v[48:51], a[200:203], v[168:171]
  v_mfma_f32_16x16x32_bf16 v[172:175], v[48:51], a[204:207], v[172:175]
  v_mfma_f32_16x16x32_bf16 v[176:179], v[52:55], a[192:195], v[176:179]
  ds_read_b64_tr_b16 v[48:49], v11 offset:36864
  ds_read_b64_tr_b16 v[50:51], v11 offset:41472
  v_mfma_f32_16x16x32_bf16 v[180:183], v[52:55], a[196:199], v[180:183]
  v_mfma_f32_16x16x32_bf16 v[184:187], v[52:55], a[200:203], v[184:187]
  v_mfma_f32_16x16x32_bf16 v[188:191], v[52:55], a[204:207], v[188:191]
  s_waitcnt lgkmcnt(6)
  v_mfma_f32_16x16x32_bf16 v[192:195], v[56:59], a[192:195], v[192:195]
  ds_read_b64_tr_b16 v[52:53], v11 offset:36896
  ds_read_b64_tr_b16 v[54:55], v11 offset:41504
  v_mfma_f32_16x16x32_bf16 v[196:199], v[56:59], a[196:199], v[196:199]
  v_mfma_f32_16x16x32_bf16 v[200:203], v[56:59], a[200:203], v[200:203]
  v_mfma_f32_16x16x32_bf16 v[204:207], v[56:59], a[204:207], v[204:207]
  v_mfma_f32_16x16x32_bf16 v[208:211], v[60:63], a[192:195], v[208:211]
  ds_read_b64_tr_b16 v[56:57], v11 offset:36928
  ds_read_b64_tr_b16 v[58:59], v11 offset:41536
  v_mfma_f32_16x16x32_bf16 v[212:215], v[60:63], a[196:199], v[212:215]
  v_mfma_f32_16x16x32_bf16 v[216:219], v[60:63], a[200:203], v[216:219]
  v_mfma_f32_16x16x32_bf16 v[220:223], v[60:63], a[204:207], v[220:223]
  s_waitcnt lgkmcnt(6)
  v_mfma_f32_16x16x32_bf16 v[224:227], v[64:67], a[192:195], v[224:227]
  ds_read_b64_tr_b16 v[60:61], v11 offset:36960
  ds_read_b64_tr_b16 v[62:63], v11 offset:41568
  v_mfma_f32_16x16x32_bf16 v[228:231], v[64:67], a[196:199], v[228:231]
  v_mfma_f32_16x16x32_bf16 v[232:235], v[64:67], a[200:203], v[232:235]
  v_mfma_f32_16x16x32_bf16 v[236:239], v[64:67], a[204:207], v[236:239]
  v_mfma_f32_16x16x32_bf16 v[240:243], v[68:71], a[192:195], v[240:243]
  ds_read_b64_tr_b16 v[64:65], v11 offset:36992
  ds_read_b64_tr_b16 v[66:67], v11 offset:41600
  v_mfma_f32_16x16x32_bf16 v[244:247], v[68:71], a[196:199], v[244:247]
  v_mfma_f32_16x16x32_bf16 v[248:251], v[68:71], a[200:203], v[248:251]
  v_mfma_f32_16x16x32_bf16 v[252:255], v[68:71], a[204:207], v[252:255]
  s_barrier
  s_waitcnt vmcnt(14) lgkmcnt(6)
  v_mfma_f32_16x16x32_bf16 v[112:115], v[48:51], a[208:211], v[112:115]
  ds_read_b64_tr_b16 v[68:69], v11 offset:37024
  ds_read_b64_tr_b16 v[70:71], v11 offset:41632
  v_mfma_f32_16x16x32_bf16 v[116:119], v[48:51], a[212:215], v[116:119]
  v_mfma_f32_16x16x32_bf16 v[120:123], v[48:51], a[216:219], v[120:123]
  s_add_u32 m0, s40, 65536
  v_mfma_f32_16x16x32_bf16 v[124:127], v[48:51], a[220:223], v[124:127]
  buffer_load_dword v74, v78, s[96:99], 0 offen offset:384 sc1
  v_mfma_f32_16x16x32_bf16 v[128:131], v[52:55], a[208:211], v[128:131]
  ds_read_b64_tr_b16 v[48:49], v11 offset:37056
  ds_read_b64_tr_b16 v[50:51], v11 offset:41664
  v_mfma_f32_16x16x32_bf16 v[132:135], v[52:55], a[212:215], v[132:135]
  v_mfma_f32_16x16x32_bf16 v[136:139], v[52:55], a[216:219], v[136:139]
  v_mfma_f32_16x16x32_bf16 v[140:143], v[52:55], a[220:223], v[140:143]
  s_add_u32 s38, s78, 4096
  s_waitcnt lgkmcnt(6)
  v_mfma_f32_16x16x32_bf16 v[144:147], v[56:59], a[208:211], v[144:147]
  ds_read_b64_tr_b16 v[52:53], v11 offset:37088
  ds_read_b64_tr_b16 v[54:55], v11 offset:41696
  v_mfma_f32_16x16x32_bf16 v[148:151], v[56:59], a[212:215], v[148:151]
  v_mfma_f32_16x16x32_bf16 v[152:155], v[56:59], a[216:219], v[152:155]
  buffer_load_dwordx4 v1, s[8:11], s88 offen offset:0 lds
  v_mfma_f32_16x16x32_bf16 v[156:159], v[56:59], a[220:223], v[156:159]
  v_mfma_f32_16x16x32_bf16 v[160:163], v[60:63], a[208:211], v[160:163]
  ds_read_b64_tr_b16 v[56:57], v11 offset:37120
  ds_read_b64_tr_b16 v[58:59], v11 offset:41728
  v_mfma_f32_16x16x32_bf16 v[164:167], v[60:63], a[212:215], v[164:167]
  buffer_load_dwordx4 a[0:3], v16, s[16:19], s38 offen offset:0 sc1
  v_mfma_f32_16x16x32_bf16 v[168:171], v[60:63], a[216:219], v[168:171]
  v_mfma_f32_16x16x32_bf16 v[172:175], v[60:63], a[220:223], v[172:175]
  s_waitcnt lgkmcnt(6)
  v_mfma_f32_16x16x32_bf16 v[176:179], v[64:67], a[208:211], v[176:179]
  ds_read_b64_tr_b16 v[60:61], v11 offset:46080
  ds_read_b64_tr_b16 v[62:63], v11 offset:50688
  v_mfma_f32_16x16x32_bf16 v[180:183], v[64:67], a[212:215], v[180:183]
  buffer_load_dwordx4 a[4:7], v16, s[16:19], s38 offen offset:1024 sc1
  v_mfma_f32_16x16x32_bf16 v[184:187], v[64:67], a[216:219], v[184:187]
  buffer_load_dwordx4 v2, s[8:11], s88 offen offset:1024 lds
  v_mfma_f32_16x16x32_bf16 v[188:191], v[64:67], a[220:223], v[188:191]
  v_mfma_f32_16x16x32_bf16 v[192:195], v[68:71], a[208:211], v[192:195]
  ds_read_b64_tr_b16 v[64:65], v11 offset:46112
  ds_read_b64_tr_b16 v[66:67], v11 offset:50720
  v_mfma_f32_16x16x32_bf16 v[196:199], v[68:71], a[212:215], v[196:199]
  v_mfma_f32_16x16x32_bf16 v[200:203], v[68:71], a[216:219], v[200:203]
  buffer_load_dwordx4 a[8:11], v16, s[16:19], s38 offen offset:2048 sc1
  v_mfma_f32_16x16x32_bf16 v[204:207], v[68:71], a[220:223], v[204:207]
  s_waitcnt lgkmcnt(6)
  v_mfma_f32_16x16x32_bf16 v[208:211], v[48:51], a[208:211], v[208:211]
  ds_read_b64_tr_b16 v[68:69], v11 offset:46144
  ds_read_b64_tr_b16 v[70:71], v11 offset:50752
  v_mfma_f32_16x16x32_bf16 v[212:215], v[48:51], a[212:215], v[212:215]
  v_mfma_f32_16x16x32_bf16 v[216:219], v[48:51], a[216:219], v[216:219]
  buffer_load_dwordx4 v3, s[8:11], s88 offen offset:2048 lds
  v_mfma_f32_16x16x32_bf16 v[220:223], v[48:51], a[220:223], v[220:223]
  buffer_load_dwordx4 a[12:15], v16, s[16:19], s38 offen offset:3072 sc1
  v_mfma_f32_16x16x32_bf16 v[224:227], v[52:55], a[208:211], v[224:227]
  ds_read_b64_tr_b16 v[48:49], v11 offset:46176
  ds_read_b64_tr_b16 v[50:51], v11 offset:50784
  v_mfma_f32_16x16x32_bf16 v[228:231], v[52:55], a[212:215], v[228:231]
  v_mfma_f32_16x16x32_bf16 v[232:235], v[52:55], a[216:219], v[232:235]
  v_mfma_f32_16x16x32_bf16 v[236:239], v[52:55], a[220:223], v[236:239]
  s_waitcnt lgkmcnt(6)
  v_mfma_f32_16x16x32_bf16 v[240:243], v[56:59], a[208:211], v[240:243]
  ds_read_b64_tr_b16 v[52:53], v11 offset:46208
  ds_read_b64_tr_b16 v[54:55], v11 offset:50816
  v_mfma_f32_16x16x32_bf16 v[244:247], v[56:59], a[212:215], v[244:247]
  v_mfma_f32_16x16x32_bf16 v[248:251], v[56:59], a[216:219], v[248:251]
  buffer_load_dwordx4 v4, s[8:11], s88 offen offset:3072 lds
  v_mfma_f32_16x16x32_bf16 v[252:255], v[56:59], a[220:223], v[252:255]
  s_waitcnt vmcnt(18)
  v_mfma_f32_16x16x32_bf16 v[112:115], v[60:63], a[224:227], v[112:115]
  ds_read_b64_tr_b16 v[56:57], v11 offset:46240
  ds_read_b64_tr_b16 v[58:59], v11 offset:50848
  v_mfma_f32_16x16x32_bf16 v[116:119], v[60:63], a[228:231], v[116:119]
  v_mfma_f32_16x16x32_bf16 v[120:123], v[60:63], a[232:235], v[120:123]
  s_waitcnt vmcnt(8)
  v_cmp_eq_u32 vcc, s100, v74
  s_cmp_eq_u64 vcc, -1
  s_cbranch_scc0 L_retry3
L_back3:
  v_mfma_f32_16x16x32_bf16 v[124:127], v[60:63], a[236:239], v[124:127]
  s_waitcnt lgkmcnt(6)
  v_mfma_f32_16x16x32_bf16 v[128:131], v[64:67], a[224:227], v[128:131]
  ds_read_b64_tr_b16 v[60:61], v11 offset:46272
  ds_read_b64_tr_b16 v[62:63], v11 offset:50880
  v_mfma_f32_16x16x32_bf16 v[132:135], v[64:67], a[228:231], v[132:135]
  s_add_u32 s52, s81, 0
  s_mov_b64 exec, 0xffff
  buffer_load_dword v73, v14, s[16:19], s52 offen sc1
  s_mov_b64 exec, -1
  v_mfma_f32_16x16x32_bf16 v[136:139], v[64:67], a[232:235], v[136:139]
  s_add_u32 m0, s40, 69632
  v_mfma_f32_16x16x32_bf16 v[140:143], v[64:67], a[236:239], v[140:143]
  v_mfma_f32_16x16x32_bf16 v[144:147], v[68:71], a[224:227], v[144:147]
  ds_read_b64_tr_b16 v[64:65], v11 offset:46304
  ds_read_b64_tr_b16 v[66:67], v11 offset:50912
  v_mfma_f32_16x16x32_bf16 v[148:151], v[68:71], a[228:231], v[148:151]
  s_add_u32 s52, s82, 0
  s_mov_b64 exec, 0xffff
  buffer_load_dword v73, v14, s[16:19], s52 offen sc1
  s_mov_b64 exec, -1
  v_mfma_f32_16x16x32_bf16 v[152:155], v[68:71], a[232:235], v[152:155]
  v_mfma_f32_16x16x32_bf16 v[156:159], v[68:71], a[236:239], v[156:159]
  s_add_u32 s38, s79, 0
  s_waitcnt lgkmcnt(6)
  v_mfma_f32_16x16x32_bf16 v[160:163], v[48:51], a[224:227], v[160:163]
  ds_read_b64_tr_b16 v[68:69], v11 offset:46336
  ds_read_b64_tr_b16 v[70:71], v11 offset:50944
  v_mfma_f32_16x16x32_bf16 v[164:167], v[48:51], a[228:231], v[164:167]
  v_mfma_f32_16x16x32_bf16 v[168:171], v[48:51], a[232:235], v[168:171]
  buffer_load_dwordx4 v5, s[8:11], s88 offen offset:0 lds
  v_mfma_f32_16x16x32_bf16 v[172:175], v[48:51], a[236:239], v[172:175]
  buffer_load_dwordx4 a[16:19], v16, s[16:19], s38 offen offset:0 sc1
  v_mfma_f32_16x16x32_bf16 v[176:179], v[52:55], a[224:227], v[176:179]
  ds_read_b64_tr_b16 v[48:49], v12 offset:0
  ds_read_b64_tr_b16 v[50:51], v12 offset:4608
  v_mfma_f32_16x16x32_bf16 v[180:183], v[52:55], a[228:231], v[180:183]
  buffer_load_dwordx4 a[20:23], v16, s[16:19], s38 offen offset:1024 sc1
  v_mfma_f32_16x16x32_bf16 v[184:187], v[52:55], a[232:235], v[184:187]
  v_mfma_f32_16x16x32_bf16 v[188:191], v[52:55], a[236:239], v[188:191]
  s_waitcnt lgkmcnt(6)
  v_mfma_f32_16x16x32_bf16 v[192:195], v[56:59], a[224:227], v[192:195]
  s_mov_b32 s39, 8192
  buffer_store_dwordx4 a[176:179], v16, s[32:35], s39 offen offset:0 sc1
  v_mfma_f32_16x16x32_bf16 v[196:199], v[56:59], a[228:231], v[196:199]
  ds_read_b64_tr_b16 v[52:53], v12 offset:32
  ds_read_b64_tr_b16 v[54:55], v12 offset:4640
  v_mfma_f32_16x16x32_bf16 v[200:203], v[56:59], a[232:235], v[200:203]
  buffer_load_dwordx4 v6, s[8:11], s88 offen offset:1024 lds
  v_mfma_f32_16x16x32_bf16 v[204:207], v[56:59], a[236:239], v[204:207]
  buffer_load_dwordx4 a[24:27], v16, s[16:19], s38 offen offset:2048 sc1
  v_mfma_f32_16x16x32_bf16 v[208:211], v[60:63], a[224:227], v[208:211]
  ds_read_b64_tr_b16 v[56:57], v12 offset:64
  ds_read_b64_tr_b16 v[58:59], v12 offset:4672
  v_mfma_f32_16x16x32_bf16 v[212:215], v[60:63], a[228:231], v[212:215]
  buffer_load_dwordx4 a[28:31], v16, s[16:19], s38 offen offset:3072 sc1
  v_mfma_f32_16x16x32_bf16 v[216:219], v[60:63], a[232:235], v[216:219]
  v_mfma_f32_16x16x32_bf16 v[220:223], v[60:63], a[236:239], v[220:223]
  s_waitcnt lgkmcnt(6)
  v_mfma_f32_16x16x32_bf16 v[224:227], v[64:67], a[224:227], v[224:227]
  ds_read_b64_tr_b16 v[60:61], v12 offset:96
  ds_read_b64_tr_b16 v[62:63], v12 offset:4704
  v_mfma_f32_16x16x32_bf16 v[228:231], v[64:67], a[228:231], v[228:231]
  v_mfma_f32_16x16x32_bf16 v[232:235], v[64:67], a[232:235], v[232:235]
  buffer_load_dwordx4 v7, s[8:11], s88 offen offset:2048 lds
  v_mfma_f32_16x16x32_bf16 v[236:239], v[64:67], a[236:239], v[236:239]
  v_mfma_f32_16x16x32_bf16 v[240:243], v[68:71], a[224:227], v[240:243]
  s_mov_b32 s39, 8192
  buffer_store_dwordx4 a[180:183], v16, s[32:35], s39 offen offset:1024 sc1
  v_mfma_f32_16x16x32_bf16 v[244:247], v[68:71], a[228:231], v[244:247]
  ds_read_b64_tr_b16 v[64:65], v12 offset:128
  ds_read_b64_tr_b16 v[66:67], v12 offset:4736
  v_mfma_f32_16x16x32_bf16 v[248:251], v[68:71], a[232:235], v[248:251]
  v_mfma_f32_16x16x32_bf16 v[252:255], v[68:71], a[236:239], v[252:255]
  s_waitcnt lgkmcnt(6)
  v_mfma_f32_16x16x32_bf16 v[112:115], v[48:51], a[240:243], v[112:115]
  ds_read_b64_tr_b16 v[68:69], v12 offset:160
  ds_read_b64_tr_b16 v[70:71], v12 offset:4768
  v_mfma_f32_16x16x32_bf16 v[116:119], v[48:51], a[244:247], v[116:119]
  v_mfma_f32_16x16x32_bf16 v[120:123], v[48:51], a[248:251], v[120:123]
  buffer_load_dwordx4 v8, s[8:11], s88 offen offset:3072 lds
  v_mfma_f32_16x16x32_bf16 v[124:127], v[48:51], a[252:255], v[124:127]
  s_add_u32 s52, s83, 0
  s_mov_b64 exec, 0xffff
  buffer_load_dword v73, v14, s[16:19], s52 offen sc1
  s_mov_b64 exec, -1
  v_mfma_f32_16x16x32_bf16 v[128:131], v[52:55], a[240:243], v[128:131]
  ds_read_b64_tr_b16 v[48:49], v12 offset:192
  ds_read_b64_tr_b16 v[50:51], v12 offset:4800
  v_mfma_f32_16x16x32_bf16 v[132:135], v[52:55], a[244:247], v[132:135]
  v_mfma_f32_16x16x32_bf16 v[136:139], v[52:55], a[248:251], v[136:139]
  v_mfma_f32_16x16x32_bf16 v[140:143], v[52:55], a[252:255], v[140:143]
  s_add_u32 s38, s79, 4096
  s_waitcnt lgkmcnt(6)
  v_mfma_f32_16x16x32_bf16 v[144:147], v[56:59], a[240:243], v[144:147]
  s_mov_b32 s39, 8192
  buffer_store_dwordx4 a[184:187], v16, s[32:35], s39 offen offset:2048 sc1
  v_mfma_f32_16x16x32_bf16 v[148:151], v[56:59], a[244:247], v[148:151]
  ds_read_b64_tr_b16 v[52:53], v12 offset:224
  ds_read_b64_tr_b16 v[54:55], v12 offset:4832
  v_mfma_f32_16x16x32_bf16 v[152:155], v[56:59], a[248:251], v[152:155]
  s_add_u32 m0, s40, 73728
  v_mfma_f32_16x16x32_bf16 v[156:159], v[56:59], a[252:255], v[156:159]
  v_mfma_f32_16x16x32_bf16 v[160:163], v[60:63], a[240:243], v[160:163]
  ds_read_b64_tr_b16 v[56:57], v12 offset:256
  ds_read_b64_tr_b16 v[58:59], v12 offset:4864
  v_mfma_f32_16x16x32_bf16 v[164:167], v[60:63], a[244:247], v[164:167]
  buffer_load_dwordx4 a[32:35], v16, s[16:19], s38 offen offset:0 sc1
  v_mfma_f32_16x16x32_bf16 v[168:171], v[60:63], a[248:251], v[168:171]
  v_mfma_f32_16x16x32_bf16 v[172:175], v[60:63], a[252:255], v[172:175]
  s_waitcnt lgkmcnt(6)
  v_mfma_f32_16x16x32_bf16 v[176:179], v[64:67], a[240:243], v[176:179]
  ds_read_b64_tr_b16 v[60:61], v12 offset:9216
  ds_read_b64_tr_b16 v[62:63], v12 offset:13824
  v_mfma_f32_16x16x32_bf16 v[180:183], v[64:67], a[244:247], v[180:183]
  buffer_load_dwordx4 a[36:39], v16, s[16:19], s38 offen offset:1024 sc1
  v_mfma_f32_16x16x32_bf16 v[184:187], v[64:67], a[248:251], v[184:187]
  buffer_load_dwordx4 v9, s[8:11], s88 offen offset:0 lds
  v_mfma_f32_16x16x32_bf16 v[188:191], v[64:67], a[252:255], v[188:191]
  v_mfma_f32_16x16x32_bf16 v[192:195], v[68:71], a[240:243], v[192:195]
  s_mov_b32 s39, 8192
  buffer_store_dwordx4 a[188:191], v16, s[32:35], s39 offen offset:3072 sc1
  v_mfma_f32_16x16x32_bf16 v[196:199], v[68:71], a[244:247], v[196:199]
  ds_read_b64_tr_b16 v[64:65], v12 offset:9248
  ds_read_b64_tr_b16 v[66:67], v12 offset:13856
  v_mfma_f32_16x16x32_bf16 v[200:203], v[68:71], a[248:251], v[200:203]
  buffer_load_dwordx4 a[40:43], v16, s[16:19], s38 offen offset:2048 sc1
  v_mfma_f32_16x16x32_bf16 v[204:207], v[68:71], a[252:255], v[204:207]
  s_waitcnt lgkmcnt(6)
  v_mfma_f32_16x16x32_bf16 v[208:211], v[48:51], a[240:243], v[208:211]
  ds_read_b64_tr_b16 v[68:69], v12 offset:9280
  ds_read_b64_tr_b16 v[70:71], v12 offset:13888
  v_mfma_f32_16x16x32_bf16 v[212:215], v[48:51], a[244:247], v[212:215]
  v_mfma_f32_16x16x32_bf16 v[216:219], v[48:51], a[248:251], v[216:219]
  v_mfma_f32_16x16x32_bf16 v[220:223], v[48:51], a[252:255], v[220:223]
  buffer_load_dwordx4 a[44:47], v16, s[16:19], s38 offen offset:3072 sc1
  v_mfma_f32_16x16x32_bf16 v[224:227], v[52:55], a[240:243], v[224:227]
  ds_read_b64_tr_b16 v[48:49], v12 offset:9312
  ds_read_b64_tr_b16 v[50:51], v12 offset:13920
  v_mfma_f32_16x16x32_bf16 v[228:231], v[52:55], a[244:247], v[228:231]
  v_mfma_f32_16x16x32_bf16 v[232:235], v[52:55], a[248:251], v[232:235]
  v_mfma_f32_16x16x32_bf16 v[236:239], v[52:55], a[252:255], v[236:239]
  s_waitcnt lgkmcnt(6)
  v_mfma_f32_16x16x32_bf16 v[240:243], v[56:59], a[240:243], v[240:243]
  s_mov_b32 s39, 12288
  buffer_store_dwordx4 a[192:195], v16, s[32:35], s39 offen offset:0 sc1
  v_mfma_f32_16x16x32_bf16 v[244:247], v[56:59], a[244:247], v[244:247]
  ds_read_b64_tr_b16 v[52:53], v12 offset:9344
  ds_read_b64_tr_b16 v[54:55], v12 offset:13952
  v_mfma_f32_16x16x32_bf16 v[248:251], v[56:59], a[248:251], v[248:251]
  v_mfma_f32_16x16x32_bf16 v[252:255], v[56:59], a[252:255], v[252:255]
  s_barrier
  s_waitcnt vmcnt(22)
  v_mfma_f32_16x16x32_bf16 v[112:115], v[60:63], a[0:3], v[112:115]
  ds_read_b64_tr_b16 v[56:57], v12 offset:9376
  ds_read_b64_tr_b16 v[58:59], v12 offset:13984
  v_mfma_f32_16x16x32_bf16 v[116:119], v[60:63], a[4:7], v[116:119]
  v_mfma_f32_16x16x32_bf16 v[120:123], v[60:63], a[8:11], v[120:123]
  s_add_u32 s38, s80, 0
  v_mfma_f32_16x16x32_bf16 v[124:127], v[60:63], a[12:15], v[124:127]
  s_waitcnt lgkmcnt(6)
  v_mfma_f32_16x16x32_bf16 v[128:131], v[64:67], a[0:3], v[128:131]
  ds_read_b64_tr_b16 v[60:61], v12 offset:9408
  ds_read_b64_tr_b16 v[62:63], v12 offset:14016
  v_mfma_f32_16x16x32_bf16 v[132:135], v[64:67], a[4:7], v[132:135]
  v_mfma_f32_16x16x32_bf16 v[136:139], v[64:67], a[8:11], v[136:139]
  v_mfma_f32_16x16x32_bf16 v[140:143], v[64:67], a[12:15], v[140:143]
  v_mfma_f32_16x16x32_bf16 v[144:147], v[68:71], a[0:3], v[144:147]
  s_mov_b32 s39, 12288
  buffer_store_dwordx4 a[196:199], v16, s[32:35], s39 offen offset:1024 sc1
  v_mfma_f32_16x16x32_bf16 v[148:151], v[68:71], a[4:7], v[148:151]
  ds_read_b64_tr_b16 v[64:65], v12 offset:9440
  ds_read_b64_tr_b16 v[66:67], v12 offset:14048
  v_mfma_f32_16x16x32_bf16 v[152:155], v[68:71], a[8:11], v[152:155]
  buffer_load_dwordx4 a[48:51], v16, s[16:19], s38 offen offset:0 sc1
  v_mfma_f32_16x16x32_bf16 v[156:159], v[68:71], a[12:15], v[156:159]
  s_waitcnt lgkmcnt(6)
  v_mfma_f32_16x16x32_bf16 v[160:163], v[48:51], a[0:3], v[160:163]
  ds_read_b64_tr_b16 v[68:69], v12 offset:9472
  ds_read_b64_tr_b16 v[70:71], v12 offset:14080
  v_mfma_f32_16x16x32_bf16 v[164:167], v[48:51], a[4:7], v[164:167]
  v_mfma_f32_16x16x32_bf16 v[168:171], v[48:51], a[8:11], v[168:171]
  buffer_load_dwordx4 a[52:55], v16, s[16:19], s38 offen offset:1024 sc1
  v_mfma_f32_16x16x32_bf16 v[172:175], v[48:51], a[12:15], v[172:175]
  v_mfma_f32_16x16x32_bf16 v[176:179], v[52:55], a[0:3], v[176:179]
  ds_read_b64_tr_b16 v[48:49], v10 offset:0
  ds_read_b64_tr_b16 v[50:51], v10 offset:4608
  v_mfma_f32_16x16x32_bf16 v[180:183], v[52:55], a[4:7], v[180:183]
  v_mfma_f32_16x16x32_bf16 v[184:187], v[52:55], a[8:11], v[184:187]
  v_mfma_f32_16x16x32_bf16 v[188:191], v[52:55], a[12:15], v[188:191]
  s_waitcnt lgkmcnt(6)
  v_mfma_f32_16x16x32_bf16 v[192:195], v[56:59], a[0:3], v[192:195]
  s_mov_b32 s39, 12288
  buffer_store_dwordx4 a[200:203], v16, s[32:35], s39 offen offset:2048 sc1
  v_mfma_f32_16x16x32_bf16 v[196:199], v[56:59], a[4:7], v[196:199]
  ds_read_b64_tr_b16 v[52:53], v10 offset:32
  ds_read_b64_tr_b16 v[54:55], v10 offset:4640
  v_mfma_f32_16x16x32_bf16 v[200:203], v[56:59], a[8:11], v[200:203]
  buffer_load_dwordx4 a[56:59], v16, s[16:19], s38 offen offset:2048 sc1
  v_mfma_f32_16x16x32_bf16 v[204:207], v[56:59], a[12:15], v[204:207]
  v_mfma_f32_16x16x32_bf16 v[208:211], v[60:63], a[0:3], v[208:211]
  ds_read_b64_tr_b16 v[56:57], v10 offset:64
  ds_read_b64_tr_b16 v[58:59], v10 offset:4672
  v_mfma_f32_16x16x32_bf16 v[212:215], v[60:63], a[4:7], v[212:215]
  v_mfma_f32_16x16x32_bf16 v[216:219], v[60:63], a[8:11], v[216:219]
  buffer_load_dwordx4 a[60:63], v16, s[16:19], s38 offen offset:3072 sc1
  v_mfma_f32_16x16x32_bf16 v[220:223], v[60:63], a[12:15], v[220:223]
  s_waitcnt lgkmcnt(6)
  v_mfma_f32_16x16x32_bf16 v[224:227], v[64:67], a[0:3], v[224:227]
  ds_read_b64_tr_b16 v[60:61], v10 offset:96
  ds_read_b64_tr_b16 v[62:63], v10 offset:4704
  v_mfma_f32_16x16x32_bf16 v[228:231], v[64:67], a[4:7], v[228:231]
  v_mfma_f32_16x16x32_bf16 v[232:235], v[64:67], a[8:11], v[232:235]
  v_mfma_f32_16x16x32_bf16 v[236:239], v[64:67], a[12:15], v[236:239]
  v_mfma_f32_16x16x32_bf16 v[240:243], v[68:71], a[0:3], v[240:243]
  s_mov_b32 s39, 12288
  buffer_store_dwordx4 a[204:207], v16, s[32:35], s39 offen offset:3072 sc1
  v_mfma_f32_16x16x32_bf16 v[244:247], v[68:71], a[4:7], v[244:247]
  ds_read_b64_tr_b16 v[64:65], v10 offset:128
  ds_read_b64_tr_b16 v[66:67], v10 offset:4736
  v_mfma_f32_16x16x32_bf16 v[248:251], v[68:71], a[8:11], v[248:251]
  v_mfma_f32_16x16x32_bf16 v[252:255], v[68:71], a[12:15], v[252:255]
  s_barrier
  s_waitcnt vmcnt(19) lgkmcnt(6)
  v_mfma_f32_16x16x32_bf16 v[112:115], v[48:51], a[16:19], v[112:115]
  ds_read_b64_tr_b16 v[68:69], v10 offset:160
  ds_read_b64_tr_b16 v[70:71], v10 offset:4768
  v_mfma_f32_16x16x32_bf16 v[116:119], v[48:51], a[20:23], v[116:119]
  v_mfma_f32_16x16x32_bf16 v[120:123], v[48:51], a[24:27], v[120:123]
  s_add_u32 m0, s40, 102400
  s_add_u32 s38, s80, 4096
  v_mfma_f32_16x16x32_bf16 v[124:127], v[48:51], a[28:31], v[124:127]
  v_mfma_f32_16x16x32_bf16 v[128:131], v[52:55], a[16:19], v[128:131]
  ds_read_b64_tr_b16 v[48:49], v10 offset:192
  ds_read_b64_tr_b16 v[50:51], v10 offset:4800
  v_mfma_f32_16x16x32_bf16 v[132:135], v[52:55], a[20:23], v[132:135]
  v_mfma_f32_16x16x32_bf16 v[136:139], v[52:55], a[24:27], v[136:139]
  v_mfma_f32_16x16x32_bf16 v[140:143], v[52:55], a[28:31], v[140:143]
  s_waitcnt lgkmcnt(6)
  v_mfma_f32_16x16x32_bf16 v[144:147], v[56:59], a[16:19], v[144:147]
  ds_read_b64_tr_b16 v[52:53], v10 offset:224
  ds_read_b64_tr_b16 v[54:55], v10 offset:4832
  v_mfma_f32_16x16x32_bf16 v[148:151], v[56:59], a[20:23], v[148:151]
  buffer_load_dwordx4 a[64:67], v16, s[16:19], s38 offen offset:0 sc1
  v_mfma_f32_16x16x32_bf16 v[152:155], v[56:59], a[24:27], v[152:155]
  buffer_load_dwordx4 v1, s[8:11], s89 offen offset:0 lds
  v_mfma_f32_16x16x32_bf16 v[156:159], v[56:59], a[28:31], v[156:159]
  v_mfma_f32_16x16x32_bf16 v[160:163], v[60:63], a[16:19], v[160:163]
  ds_read_b64_tr_b16 v[56:57], v10 offset:256
  ds_read_b64_tr_b16 v[58:59], v10 offset:4864
  v_mfma_f32_16x16x32_bf16 v[164:167], v[60:63], a[20:23], v[164:167]
  v_mfma_f32_16x16x32_bf16 v[168:171], v[60:63], a[24:27], v[168:171]
  buffer_load_dwordx4 a[68:71], v16, s[16:19], s38 offen offset:1024 sc1
  v_mfma_f32_16x16x32_bf16 v[172:175], v[60:63], a[28:31], v[172:175]
  s_waitcnt lgkmcnt(6)
  v_mfma_f32_16x16x32_bf16 v[176:179], v[64:67], a[16:19], v[176:179]
  ds_read_b64_tr_b16 v[60:61], v10 offset:9216
  ds_read_b64_tr_b16 v[62:63], v10 offset:13824
  v_mfma_f32_16x16x32_bf16 v[180:183], v[64:67], a[20:23], v[180:183]
  v_mfma_f32_16x16x32_bf16 v[184:187], v[64:67], a[24:27], v[184:187]
  buffer_load_dwordx4 v2, s[8:11], s89 offen offset:1024 lds
  v_mfma_f32_16x16x32_bf16 v[188:191], v[64:67], a[28:31], v[188:191]
  v_mfma_f32_16x16x32_bf16 v[192:195], v[68:71], a[16:19], v[192:195]
  ds_read_b64_tr_b16 v[64:65], v10 offset:9248
  ds_read_b64_tr_b16 v[66:67], v10 offset:13856
  v_mfma_f32_16x16x32_bf16 v[196:199], v[68:71], a[20:23], v[196:199]
  buffer_load_dwordx4 a[72:75], v16, s[16:19], s38 offen offset:2048 sc1
  v_mfma_f32_16x16x32_bf16 v[200:203], v[68:71], a[24:27], v[200:203]
  v_mfma_f32_16x16x32_bf16 v[204:207], v[68:71], a[28:31], v[204:207]
  s_waitcnt lgkmcnt(6)
  v_mfma_f32_16x16x32_bf16 v[208:211], v[48:51], a[16:19], v[208:211]
  ds_read_b64_tr_b16 v[68:69], v10 offset:9280
  ds_read_b64_tr_b16 v[70:71], v10 offset:13888
  v_mfma_f32_16x16x32_bf16 v[212:215], v[48:51], a[20:23], v[212:215]
  v_mfma_f32_16x16x32_bf16 v[216:219], v[48:51], a[24:27], v[216:219]
  buffer_load_dwordx4 v3, s[8:11], s89 offen offset:2048 lds
  v_mfma_f32_16x16x32_bf16 v[220:223], v[48:51], a[28:31], v[220:223]
  buffer_load_dwordx4 a[76:79], v16, s[16:19], s38 offen offset:3072 sc1
  v_mfma_f32_16x16x32_bf16 v[224:227], v[52:55], a[16:19], v[224:227]
  ds_read_b64_tr_b16 v[48:49], v10 offset:9312
  ds_read_b64_tr_b16 v[50:51], v10 offset:13920
  v_mfma_f32_16x16x32_bf16 v[228:231], v[52:55], a[20:23], v[228:231]
  v_mfma_f32_16x16x32_bf16 v[232:235], v[52:55], a[24:27], v[232:235]
  v_mfma_f32_16x16x32_bf16 v[236:239], v[52:55], a[28:31], v[236:239]
  s_waitcnt lgkmcnt(6)
  v_mfma_f32_16x16x32_bf16 v[240:243], v[56:59], a[16:19], v[240:243]
  ds_read_b64_tr_b16 v[52:53], v10 offset:9344
  ds_read_b64_tr_b16 v[54:55], v10 offset:13952
  v_mfma_f32_16x16x32_bf16 v[244:247], v[56:59], a[20:23], v[244:247]
  v_mfma_f32_16x16x32_bf16 v[248:251], v[56:59], a[24:27], v[248:251]
  buffer_load_dwordx4 v4, s[8:11], s89 offen offset:3072 lds
  v_mfma_f32_16x16x32_bf16 v[252:255], v[56:59], a[28:31], v[252:255]
  s_waitcnt vmcnt(16)
  v_mfma_f32_16x16x32_bf16 v[112:115], v[60:63], a[32:35], v[112:115]
  s_waitcnt vmcnt(8)
  s_barrier
  v_mfma_f32_16x16x32_bf16 v[116:119], v[60:63], a[36:39], v[116:119]
  v_mov_b32 v75, s100
  buffer_store_dword v75, v77, s[96:99], 0 offen offset:896 sc1
  v_mfma_f32_16x16x32_bf16 v[120:123], v[60:63], a[40:43], v[120:123]
  ds_read_b64_tr_b16 v[56:57], v10 offset:9376
  ds_read_b64_tr_b16 v[58:59], v10 offset:13984
  v_mfma_f32_16x16x32_bf16 v[124:127], v[60:63], a[44:47], v[124:127]
  s_add_u32 s38, s81, 0
  s_waitcnt lgkmcnt(6)
  v_mfma_f32_16x16x32_bf16 v[128:131], v[64:67], a[32:35], v[128:131]
  ds_read_b64_tr_b16 v[60:61], v10 offset:9408
  ds_read_b64_tr_b16 v[62:63], v10 offset:14016
  v_mfma_f32_16x16x32_bf16 v[132:135], v[64:67], a[36:39], v[132:135]
  s_and_b32 s67, s2, 0xf8
  s_lshl_b32 s66, s3, 1
  v_mfma_f32_16x16x32_bf16 v[136:139], v[64:67], a[40:43], v[136:139]
  s_add_u32 m0, s40, 106496
  s_add_u32 s70, s67, s66
  v_mfma_f32_16x16x32_bf16 v[140:143], v[64:67], a[44:47], v[140:143]
  s_mul_i32 s70, s70, 9216
  s_mul_i32 s69, s7, 2359296
  v_mfma_f32_16x16x32_bf16 v[144:147], v[68:71], a[32:35], v[144:147]
  ds_read_b64_tr_b16 v[64:65], v10 offset:9440
  ds_read_b64_tr_b16 v[66:67], v10 offset:14048
  v_mfma_f32_16x16x32_bf16 v[148:151], v[68:71], a[36:39], v[148:151]
  buffer_load_dwordx4 a[80:83], v16, s[16:19], s38 offen offset:0 sc1
  v_mfma_f32_16x16x32_bf16 v[152:155], v[68:71], a[40:43], v[152:155]
  s_add_u32 s70, s70, s69
  s_add_u32 s70, s70, 50331648
  v_mfma_f32_16x16x32_bf16 v[156:159], v[68:71], a[44:47], v[156:159]
  s_waitcnt lgkmcnt(6)
  v_mfma_f32_16x16x32_bf16 v[160:163], v[48:51], a[32:35], v[160:163]
  ds_read_b64_tr_b16 v[68:69], v10 offset:9472
  ds_read_b64_tr_b16 v[70:71], v10 offset:14080
  v_mfma_f32_16x16x32_bf16 v[164:167], v[48:51], a[36:39], v[164:167]
  s_add_u32 s28, s64, s70
  s_addc_u32 s29, s65, 0
  v_mfma_f32_16x16x32_bf16 v[168:171], v[48:51], a[40:43], v[168:171]
  buffer_load_dwordx4 v5, s[8:11], s89 offen offset:0 lds
  v_mfma_f32_16x16x32_bf16 v[172:175], v[48:51], a[44:47], v[172:175]
  buffer_load_dwordx4 a[84:87], v16, s[16:19], s38 offen offset:1024 sc1
  v_mfma_f32_16x16x32_bf16 v[176:179], v[52:55], a[32:35], v[176:179]
  ds_read_b64_tr_b16 v[48:49], v10 offset:18432
  ds_read_b64_tr_b16 v[50:51], v10 offset:23040
  v_mfma_f32_16x16x32_bf16 v[180:183], v[52:55], a[36:39], v[180:183]
  s_mov_b32 s30, 18432
  s_mul_i32 s70, s2, 9216
  v_mfma_f32_16x16x32_bf16 v[184:187], v[52:55], a[40:43], v[184:187]
  s_add_u32 s70, s70, 50331648
  v_mfma_f32_16x16x32_bf16 v[188:191], v[52:55], a[44:47], v[188:191]
  s_waitcnt lgkmcnt(6)
  v_mfma_f32_16x16x32_bf16 v[192:195], v[56:59], a[32:35], v[192:195]
  ds_read_b64_tr_b16 v[52:53], v10 offset:18464
  ds_read_b64_tr_b16 v[54:55], v10 offset:23072
  v_mfma_f32_16x16x32_bf16 v[196:199], v[56:59], a[36:39], v[196:199]
  buffer_load_dwordx4 a[88:91], v16, s[16:19], s38 offen offset:2048 sc1
  v_mfma_f32_16x16x32_bf16 v[200:203], v[56:59], a[40:43], v[200:203]
  buffer_load_dwordx4 v6, s[8:11], s89 offen offset:1024 lds
  v_mfma_f32_16x16x32_bf16 v[204:207], v[56:59], a[44:47], v[204:207]
  s_add_u32 s32, s64, s70
  s_addc_u32 s33, s65, 0
  v_mfma_f32_16x16x32_bf16 v[208:211], v[60:63], a[32:35], v[208:211]
  ds_read_b64_tr_b16 v[56:57], v10 offset:18496
  ds_read_b64_tr_b16 v[58:59], v10 offset:23104
  v_mfma_f32_16x16x32_bf16 v[212:215], v[60:63], a[36:39], v[212:215]
  s_mov_b32 s34, 16524288
  s_lshr_b32 s70, s2, 5
  v_mfma_f32_16x16x32_bf16 v[216:219], v[60:63], a[40:43], v[216:219]
  buffer_load_dwordx4 a[92:95], v16, s[16:19], s38 offen offset:3072 sc1
  v_mfma_f32_16x16x32_bf16 v[220:223], v[60:63], a[44:47], v[220:223]
  s_lshl_b32 s70, s70, 3
  s_waitcnt lgkmcnt(6)
  v_mfma_f32_16x16x32_bf16 v[224:227], v[64:67], a[32:35], v[224:227]
  ds_read_b64_tr_b16 v[60:61], v10 offset:18528
  ds_read_b64_tr_b16 v[62:63], v10 offset:23136
  v_mfma_f32_16x16x32_bf16 v[228:231], v[64:67], a[36:39], v[228:231]
  s_add_u32 s70, s70, s7
  s_mul_i32 s70, s70, 36864
  v_mfma_f32_16x16x32_bf16 v[232:235], v[64:67], a[40:43], v[232:235]
  buffer_load_dwordx4 v7, s[8:11], s89 offen offset:2048 lds
  v_mfma_f32_16x16x32_bf16 v[236:239], v[64:67], a[44:47], v[236:239]
  s_add_u32 s69, s70, s43
  v_lshrrev_b32 v39, 4, v16
  v_mfma_f32_16x16x32_bf16 v[240:243], v[68:71], a[32:35], v[240:243]
  ds_read_b64_tr_b16 v[64:65], v10 offset:18560
  ds_read_b64_tr_b16 v[66:67], v10 offset:23168
  v_mfma_f32_16x16x32_bf16 v[244:247], v[68:71], a[36:39], v[244:247]
  v_and_b32 v46, 15, v39
  v_mul_u32_u24 v46, 1152, v46
  v_mfma_f32_16x16x32_bf16 v[248:251], v[68:71], a[40:43], v[248:251]
  v_lshrrev_b32 v47, 4, v39
  v_lshlrev_b32 v47, 3, v47
  v_mfma_f32_16x16x32_bf16 v[252:255], v[68:71], a[44:47], v[252:255]
  v_add_u32 v46, v46, v47
  s_waitcnt lgkmcnt(6)
  v_mfma_f32_16x16x32_bf16 v[112:115], v[48:51], a[48:51], v[112:115]
  ds_read_b64_tr_b16 v[68:69], v10 offset:18592
  ds_read_b64_tr_b16 v[70:71], v10 offset:23200
  v_mfma_f32_16x16x32_bf16 v[116:119], v[48:51], a[52:55], v[116:119]
  v_add_u32 v46, s69, v46
  s_lshl_b32 s70, s3, 10
  v_mfma_f32_16x16x32_bf16 v[120:123], v[48:51], a[56:59], v[120:123]
  buffer_load_dwordx4 v8, s[8:11], s89 offen offset:3072 lds
  v_mfma_f32_16x16x32_bf16 v[124:127], v[48:51], a[60:63], v[124:127]
  s_add_u32 s38, s81, 4096
  v_add_u32 v80, s70, v16
  v_mfma_f32_16x16x32_bf16 v[128:131], v[52:55], a[48:51], v[128:131]
  ds_read_b64_tr_b16 v[48:49], v10 offset:18624
  ds_read_b64_tr_b16 v[50:51], v10 offset:23232
  v_mfma_f32_16x16x32_bf16 v[132:135], v[52:55], a[52:55], v[132:135]
  s_lshl_b32 s70, s3, 5
  v_add_u32 v81, s70, v46
  v_mfma_f32_16x16x32_bf16 v[136:139], v[52:55], a[56:59], v[136:139]
  s_add_u32 s71, s3, 5
  v_mfma_f32_16x16x32_bf16 v[140:143], v[52:55], a[60:63], v[140:143]
  s_waitcnt lgkmcnt(6)
  v_mfma_f32_16x16x32_bf16 v[144:147], v[56:59], a[48:51], v[144:147]
  ds_read_b64_tr_b16 v[52:53], v10 offset:18656
  ds_read_b64_tr_b16 v[54:55], v10 offset:23264
  v_mfma_f32_16x16x32_bf16 v[148:151], v[56:59], a[52:55], v[148:151]
  buffer_load_dwordx4 a[96:99], v16, s[16:19], s38 offen offset:0 sc1
  v_mfma_f32_16x16x32_bf16 v[152:155], v[56:59], a[56:59], v[152:155]
  s_add_u32 m0, s40, 110592
  v_mfma_f32_16x16x32_bf16 v[156:159], v[56:59], a[60:63], v[156:159]
  s_cmp_eq_u32 s3, 0
  s_cselect_b32 s71, 4, s71
  v_mfma_f32_16x16x32_bf16 v[160:163], v[60:63], a[48:51], v[160:163]
  ds_read_b64_tr_b16 v[56:57], v10 offset:18688
  ds_read_b64_tr_b16 v[58:59], v10 offset:23296
  v_mfma_f32_16x16x32_bf16 v[164:167], v[60:63], a[52:55], v[164:167]
  s_lshl_b32 s70, s71, 10
  v_add_u32 v82, s70, v16
  v_mfma_f32_16x16x32_bf16 v[168:171], v[60:63], a[56:59], v[168:171]
  buffer_load_dwordx4 a[100:103], v16, s[16:19], s38 offen offset:1024 sc1
  v_mfma_f32_16x16x32_bf16 v[172:175], v[60:63], a[60:63], v[172:175]
  s_lshl_b32 s70, s71, 5
  s_waitcnt lgkmcnt(6)
  v_mfma_f32_16x16x32_bf16 v[176:179], v[64:67], a[48:51], v[176:179]
  ds_read_b64_tr_b16 v[60:61], v10 offset:27648
  ds_read_b64_tr_b16 v[62:63], v10 offset:32256
  v_mfma_f32_16x16x32_bf16 v[180:183], v[64:67], a[52:55], v[180:183]
  v_add_u32 v83, s70, v46
  s_lshr_b32 s70, s3, 1
  v_mfma_f32_16x16x32_bf16 v[184:187], v[64:67], a[56:59], v[184:187]
  buffer_load_dwordx4 v9, s[8:11], s89 offen offset:0 lds
  v_mfma_f32_16x16x32_bf16 v[188:191], v[64:67], a[60:63], v[188:191]
  s_lshl_b32 s70, s70, 7
  v_add_u32 v84, s70, v79
  v_mfma_f32_16x16x32_bf16 v[192:195], v[68:71], a[48:51], v[192:195]
  ds_read_b64_tr_b16 v[64:65], v10 offset:27680
  ds_read_b64_tr_b16 v[66:67], v10 offset:32288
  v_mfma_f32_16x16x32_bf16 v[196:199], v[68:71], a[52:55], v[196:199]
  buffer_load_dwordx4 a[104:107], v16, s[16:19], s38 offen offset:2048 sc1
  v_mfma_f32_16x16x32_bf16 v[200:203], v[68:71], a[56:59], v[200:203]
  s_mov_b32 s66, 18432
  s_mov_b32 s20, s44
  v_mfma_f32_16x16x32_bf16 v[204:207], v[68:71], a[60:63], v[204:207]
  s_mov_b32 s21, s45
  s_waitcnt lgkmcnt(6)
  v_mfma_f32_16x16x32_bf16 v[208:211], v[48:51], a[48:51], v[208:211]
  ds_read_b64_tr_b16 v[68:69], v10 offset:27712
  ds_read_b64_tr_b16 v[70:71], v10 offset:32320
  v_mfma_f32_16x16x32_bf16 v[212:215], v[48:51], a[52:55], v[212:215]
  s_mov_b32 s22, 2359296
  s_mov_b32 s24, s60
  v_mfma_f32_16x16x32_bf16 v[216:219], v[48:51], a[56:59], v[216:219]
  buffer_load_dwordx4 a[108:111], v16, s[16:19], s38 offen offset:3072 sc1
  v_mfma_f32_16x16x32_bf16 v[220:223], v[48:51], a[60:63], v[220:223]
  s_mov_b32 s25, s61
  s_mov_b32 s26, 2359296
  v_mfma_f32_16x16x32_bf16 v[224:227], v[52:55], a[48:51], v[224:227]
  ds_read_b64_tr_b16 v[48:49], v10 offset:27744
  ds_read_b64_tr_b16 v[50:51], v10 offset:32352
  v_mfma_f32_16x16x32_bf16 v[228:231], v[52:55], a[52:55], v[228:231]
  v_mfma_f32_16x16x32_bf16 v[232:235], v[52:55], a[56:59], v[232:235]
  v_mfma_f32_16x16x32_bf16 v[236:239], v[52:55], a[60:63], v[236:239]
  s_waitcnt lgkmcnt(6)
  v_mfma_f32_16x16x32_bf16 v[240:243], v[56:59], a[48:51], v[240:243]
  ds_read_b64_tr_b16 v[52:53], v10 offset:27776
  ds_read_b64_tr_b16 v[54:55], v10 offset:32384
  v_mfma_f32_16x16x32_bf16 v[244:247], v[56:59], a[52:55], v[244:247]
  v_mfma_f32_16x16x32_bf16 v[248:251], v[56:59], a[56:59], v[248:251]
  v_mfma_f32_16x16x32_bf16 v[252:255], v[56:59], a[60:63], v[252:255]
  s_barrier
  s_waitcnt vmcnt(15)
  v_mfma_f32_16x16x32_bf16 v[112:115], v[60:63], a[64:67], v[112:115]
  ds_read_b64_tr_b16 v[56:57], v10 offset:27808
  ds_read_b64_tr_b16 v[58:59], v10 offset:32416
  v_mfma_f32_16x16x32_bf16 v[116:119], v[60:63], a[68:71], v[116:119]
  v_mfma_f32_16x16x32_bf16 v[120:123], v[60:63], a[72:75], v[120:123]
  s_add_u32 s38, s82, 0
  v_mfma_f32_16x16x32_bf16 v[124:127], v[60:63], a[76:79], v[124:127]
  s_waitcnt lgkmcnt(6)
  v_mfma_f32_16x16x32_bf16 v[128:131], v[64:67], a[64:67], v[128:131]
  ds_read_b64_tr_b16 v[60:61], v10 offset:27840
  ds_read_b64_tr_b16 v[62:63], v10 offset:32448
  v_mfma_f32_16x16x32_bf16 v[132:135], v[64:67], a[68:71], v[132:135]
  v_mfma_f32_16x16x32_bf16 v[136:139], v[64:67], a[72:75], v[136:139]
  v_mfma_f32_16x16x32_bf16 v[140:143], v[64:67], a[76:79], v[140:143]
  v_mfma_f32_16x16x32_bf16 v[144:147], v[68:71], a[64:67], v[144:147]
  ds_read_b64_tr_b16 v[64:65], v10 offset:27872
  ds_read_b64_tr_b16 v[66:67], v10 offset:32480
  v_mfma_f32_16x16x32_bf16 v[148:151], v[68:71], a[68:71], v[148:151]
  buffer_load_dwordx4 a[112:115], v16, s[16:19], s38 offen offset:0 sc1
  v_mfma_f32_16x16x32_bf16 v[152:155], v[68:71], a[72:75], v[152:155]
  v_mfma_f32_16x16x32_bf16 v[156:159], v[68:71], a[76:79], v[156:159]
  s_waitcnt lgkmcnt(6)
  v_mfma_f32_16x16x32_bf16 v[160:163], v[48:51], a[64:67], v[160:163]
  ds_read_b64_tr_b16 v[68:69], v10 offset:27904
  ds_read_b64_tr_b16 v[70:71], v10 offset:32512
  v_mfma_f32_16x16x32_bf16 v[164:167], v[48:51], a[68:71], v[164:167]
  v_mfma_f32_16x16x32_bf16 v[168:171], v[48:51], a[72:75], v[168:171]
  buffer_load_dwordx4 a[116:119], v16, s[16:19], s38 offen offset:1024 sc1
  v_mfma_f32_16x16x32_bf16 v[172:175], v[48:51], a[76:79], v[172:175]
  v_mfma_f32_16x16x32_bf16 v[176:179], v[52:55], a[64:67], v[176:179]
  ds_read_b64_tr_b16 v[48:49], v12 offset:18432
  ds_read_b64_tr_b16 v[50:51], v12 offset:23040
  v_mfma_f32_16x16x32_bf16 v[180:183], v[52:55], a[68:71], v[180:183]
  v_mfma_f32_16x16x32_bf16 v[184:187], v[52:55], a[72:75], v[184:187]
  v_mfma_f32_16x16x32_bf16 v[188:191], v[52:55], a[76:79], v[188:191]
  s_waitcnt lgkmcnt(6)
  v_mfma_f32_16x16x32_bf16 v[192:195], v[56:59], a[64:67], v[192:195]
  ds_read_b64_tr_b16 v[52:53], v12 offset:18464
  ds_read_b64_tr_b16 v[54:55], v12 offset:23072
  v_mfma_f32_16x16x32_bf16 v[196:199], v[56:59], a[68:71], v[196:199]
  buffer_load_dwordx4 a[120:123], v16, s[16:19], s38 offen offset:2048 sc1
  v_mfma_f32_16x16x32_bf16 v[200:203], v[56:59], a[72:75], v[200:203]
  v_mfma_f32_16x16x32_bf16 v[204:207], v[56:59], a[76:79], v[204:207]
  v_mfma_f32_16x16x32_bf16 v[208:211], v[60:63], a[64:67], v[208:211]
  ds_read_b64_tr_b16 v[56:57], v12 offset:18496
  ds_read_b64_tr_b16 v[58:59], v12 offset:23104
  v_mfma_f32_16x16x32_bf16 v[212:215], v[60:63], a[68:71], v[212:215]
  v_mfma_f32_16x16x32_bf16 v[216:219], v[60:63], a[72:75], v[216:219]
  buffer_load_dwordx4 a[124:127], v16, s[16:19], s38 offen offset:3072 sc1
  v_mfma_f32_16x16x32_bf16 v[220:223], v[60:63], a[76:79], v[220:223]
  s_waitcnt lgkmcnt(6)
  v_mfma_f32_16x16x32_bf16 v[224:227], v[64:67], a[64:67], v[224:227]
  ds_read_b64_tr_b16 v[60:61], v12 offset:18528
  ds_read_b64_tr_b16 v[62:63], v12 offset:23136
  v_mfma_f32_16x16x32_bf16 v[228:231], v[64:67], a[68:71], v[228:231]
  v_mfma_f32_16x16x32_bf16 v[232:235], v[64:67], a[72:75], v[232:235]
  v_mfma_f32_16x16x32_bf16 v[236:239], v[64:67], a[76:79], v[236:239]
  v_mfma_f32_16x16x32_bf16 v[240:243], v[68:71], a[64:67], v[240:243]
  ds_read_b64_tr_b16 v[64:65], v12 offset:18560
  ds_read_b64_tr_b16 v[66:67], v12 offset:23168
  v_mfma_f32_16x16x32_bf16 v[244:247], v[68:71], a[68:71], v[244:247]
  v_mfma_f32_16x16x32_bf16 v[248:251], v[68:71], a[72:75], v[248:251]
  v_mfma_f32_16x16x32_bf16 v[252:255], v[68:71], a[76:79], v[252:255]
  s_barrier
  s_waitcnt vmcnt(11) lgkmcnt(6)
  v_mfma_f32_16x16x32_bf16 v[112:115], v[48:51], a[80:83], v[112:115]
  ds_read_b64_tr_b16 v[68:69], v12 offset:18592
  ds_read_b64_tr_b16 v[70:71], v12 offset:23200
  v_mfma_f32_16x16x32_bf16 v[116:119], v[48:51], a[84:87], v[116:119]
  v_mfma_f32_16x16x32_bf16 v[120:123], v[48:51], a[88:91], v[120:123]
  s_add_u32 m0, s40, 0
  v_mfma_f32_16x16x32_bf16 v[124:127], v[48:51], a[92:95], v[124:127]
  buffer_load_dword v74, v78, s[96:99], 0 offen offset:896 sc1
  v_mfma_f32_16x16x32_bf16 v[128:131], v[52:55], a[80:83], v[128:131]
  ds_read_b64_tr_b16 v[48:49], v12 offset:18624
  ds_read_b64_tr_b16 v[50:51], v12 offset:23232
  v_mfma_f32_16x16x32_bf16 v[132:135], v[52:55], a[84:87], v[132:135]
  v_mfma_f32_16x16x32_bf16 v[136:139], v[52:55], a[88:91], v[136:139]
  v_mfma_f32_16x16x32_bf16 v[140:143], v[52:55], a[92:95], v[140:143]
  s_add_u32 s38, s82, 4096
  s_waitcnt lgkmcnt(6)
  v_mfma_f32_16x16x32_bf16 v[144:147], v[56:59], a[80:83], v[144:147]
  ds_read_b64_tr_b16 v[52:53], v12 offset:18656
  ds_read_b64_tr_b16 v[54:55], v12 offset:23264
  v_mfma_f32_16x16x32_bf16 v[148:151], v[56:59], a[84:87], v[148:151]
  v_mfma_f32_16x16x32_bf16 v[152:155], v[56:59], a[88:91], v[152:155]
  buffer_load_dwordx4 v1, s[8:11], s90 offen offset:0 lds
  v_mfma_f32_16x16x32_bf16 v[156:159], v[56:59], a[92:95], v[156:159]
  v_mfma_f32_16x16x32_bf16 v[160:163], v[60:63], a[80:83], v[160:163]
  ds_read_b64_tr_b16 v[56:57], v12 offset:18688
  ds_read_b64_tr_b16 v[58:59], v12 offset:23296
  v_mfma_f32_16x16x32_bf16 v[164:167], v[60:63], a[84:87], v[164:167]
  buffer_load_dwordx4 a[128:131], v16, s[16:19], s38 offen offset:0 sc1
  v_mfma_f32_16x16x32_bf16 v[168:171], v[60:63], a[88:91], v[168:171]
  v_mfma_f32_16x16x32_bf16 v[172:175], v[60:63], a[92:95], v[172:175]
  s_waitcnt lgkmcnt(6)
  v_mfma_f32_16x16x32_bf16 v[176:179], v[64:67], a[80:83], v[176:179]
  ds_read_b64_tr_b16 v[60:61], v12 offset:27648
  ds_read_b64_tr_b16 v[62:63], v12 offset:32256
  v_mfma_f32_16x16x32_bf16 v[180:183], v[64:67], a[84:87], v[180:183]
  buffer_load_dwordx4 a[132:135], v16, s[16:19], s38 offen offset:1024 sc1
  v_mfma_f32_16x16x32_bf16 v[184:187], v[64:67], a[88:91], v[184:187]
  buffer_load_dwordx4 v2, s[8:11], s90 offen offset:1024 lds
  v_mfma_f32_16x16x32_bf16 v[188:191], v[64:67], a[92:95], v[188:191]
  v_mfma_f32_16x16x32_bf16 v[192:195], v[68:71], a[80:83], v[192:195]
  ds_read_b64_tr_b16 v[64:65], v12 offset:27680
  ds_read_b64_tr_b16 v[66:67], v12 offset:32288
  v_mfma_f32_16x16x32_bf16 v[196:199], v[68:71], a[84:87], v[196:199]
  v_mfma_f32_16x16x32_bf16 v[200:203], v[68:71], a[88:91], v[200:203]
  buffer_load_dwordx4 a[136:139], v16, s[16:19], s38 offen offset:2048 sc1
  v_mfma_f32_16x16x32_bf16 v[204:207], v[68:71], a[92:95], v[204:207]
  s_waitcnt lgkmcnt(6)
  v_mfma_f32_16x16x32_bf16 v[208:211], v[48:51], a[80:83], v[208:211]
  ds_read_b64_tr_b16 v[68:69], v12 offset:27712
  ds_read_b64_tr_b16 v[70:71], v12 offset:32320
  v_mfma_f32_16x16x32_bf16 v[212:215], v[48:51], a[84:87], v[212:215]
  v_mfma_f32_16x16x32_bf16 v[216:219], v[48:51], a[88:91], v[216:219]
  buffer_load_dwordx4 v3, s[8:11], s90 offen offset:2048 lds
  v_mfma_f32_16x16x32_bf16 v[220:223], v[48:51], a[92:95], v[220:223]
  buffer_load_dwordx4 a[140:143], v16, s[16:19], s38 offen offset:3072 sc1
  v_mfma_f32_16x16x32_bf16 v[224:227], v[52:55], a[80:83], v[224:227]
  ds_read_b64_tr_b16 v[48:49], v12 offset:27744
  ds_read_b64_tr_b16 v[50:51], v12 offset:32352
  v_mfma_f32_16x16x32_bf16 v[228:231], v[52:55], a[84:87], v[228:231]
  v_mfma_f32_16x16x32_bf16 v[232:235], v[52:55], a[88:91], v[232:235]
  v_mfma_f32_16x16x32_bf16 v[236:239], v[52:55], a[92:95], v[236:239]
  s_waitcnt lgkmcnt(6)
  v_mfma_f32_16x16x32_bf16 v[240:243], v[56:59], a[80:83], v[240:243]
  ds_read_b64_tr_b16 v[52:53], v12 offset:27776
  ds_read_b64_tr_b16 v[54:55], v12 offset:32384
  v_mfma_f32_16x16x32_bf16 v[244:247], v[56:59], a[84:87], v[244:247]
  v_mfma_f32_16x16x32_bf16 v[248:251], v[56:59], a[88:91], v[248:251]
  buffer_load_dwordx4 v4, s[8:11], s90 offen offset:3072 lds
  v_mfma_f32_16x16x32_bf16 v[252:255], v[56:59], a[92:95], v[252:255]
  s_waitcnt vmcnt(13)
  v_mfma_f32_16x16x32_bf16 v[112:115], v[60:63], a[96:99], v[112:115]
  ds_read_b64_tr_b16 v[56:57], v12 offset:27808
  ds_read_b64_tr_b16 v[58:59], v12 offset:32416
  v_mfma_f32_16x16x32_bf16 v[116:119], v[60:63], a[100:103], v[116:119]
  v_mfma_f32_16x16x32_bf16 v[120:123], v[60:63], a[104:107], v[120:123]
  s_waitcnt vmcnt(8)
  v_cmp_eq_u32 vcc, s100, v74
  s_cmp_eq_u64 vcc, -1
  s_cbranch_scc0 L_retry4
L_back4:
  v_mfma_f32_16x16x32_bf16 v[124:127], v[60:63], a[108:111], v[124:127]
  s_waitcnt lgkmcnt(6)
  v_mfma_f32_16x16x32_bf16 v[128:131], v[64:67], a[96:99], v[128:131]
  ds_read_b64_tr_b16 v[60:61], v12 offset:27840
  ds_read_b64_tr_b16 v[62:63], v12 offset:32448
  v_mfma_f32_16x16x32_bf16 v[132:135], v[64:67], a[100:103], v[132:135]
  s_add_u32 s52, s77, 8192
  s_mov_b64 exec, 0xffff
  buffer_load_dword v73, v14, s[16:19], s52 offen sc1
  s_mov_b64 exec, -1
  v_mfma_f32_16x16x32_bf16 v[136:139], v[64:67], a[104:107], v[136:139]
  s_add_u32 m0, s40, 4096
  v_mfma_f32_16x16x32_bf16 v[140:143], v[64:67], a[108:111], v[140:143]
  s_add_u32 s52, s78, 8192
  s_mov_b64 exec, 0xffff
  buffer_load_dword v73, v14, s[16:19], s52 offen sc1
  s_mov_b64 exec, -1
  v_mfma_f32_16x16x32_bf16 v[144:147], v[68:71], a[96:99], v[144:147]
  ds_read_b64_tr_b16 v[64:65], v12 offset:27872
  ds_read_b64_tr_b16 v[66:67], v12 offset:32480
  v_mfma_f32_16x16x32_bf16 v[148:151], v[68:71], a[100:103], v[148:151]
  s_add_u32 s38, s83, 0
  v_mfma_f32_16x16x32_bf16 v[152:155], v[68:71], a[104:107], v[152:155]
  buffer_load_dwordx4 a[144:147], v16, s[16:19], s38 offen offset:0 sc1
  v_mfma_f32_16x16x32_bf16 v[156:159], v[68:71], a[108:111], v[156:159]
  s_waitcnt lgkmcnt(6)
  v_mfma_f32_16x16x32_bf16 v[160:163], v[48:51], a[96:99], v[160:163]
  ds_read_b64_tr_b16 v[68:69], v12 offset:27904
  ds_read_b64_tr_b16 v[70:71], v12 offset:32512
  v_mfma_f32_16x16x32_bf16 v[164:167], v[48:51], a[100:103], v[164:167]
  buffer_load_dwordx4 a[148:151], v16, s[16:19], s38 offen offset:1024 sc1
  v_mfma_f32_16x16x32_bf16 v[168:171], v[48:51], a[104:107], v[168:171]
  buffer_load_dwordx4 v5, s[8:11], s90 offen offset:0 lds
  v_mfma_f32_16x16x32_bf16 v[172:175], v[48:51], a[108:111], v[172:175]
  buffer_load_dwordx4 a[152:155], v16, s[16:19], s38 offen offset:2048 sc1
  v_mfma_f32_16x16x32_bf16 v[176:179], v[52:55], a[96:99], v[176:179]
  ds_read_b64_tr_b16 v[48:49], v10 offset:36864
  ds_read_b64_tr_b16 v[50:51], v10 offset:41472
  v_mfma_f32_16x16x32_bf16 v[180:183], v[52:55], a[100:103], v[180:183]
  buffer_load_dwordx4 a[156:159], v16, s[16:19], s38 offen offset:3072 sc1
  v_mfma_f32_16x16x32_bf16 v[184:187], v[52:55], a[104:107], v[184:187]
  s_add_u32 s38, s83, 4096
  v_mfma_f32_16x16x32_bf16 v[188:191], v[52:55], a[108:111], v[188:191]
  s_waitcnt lgkmcnt(6)
  v_mfma_f32_16x16x32_bf16 v[192:195], v[56:59], a[96:99], v[192:195]
  ds_read_b64_tr_b16 v[52:53], v10 offset:36896
  ds_read_b64_tr_b16 v[54:55], v10 offset:41504
  v_mfma_f32_16x16x32_bf16 v[196:199], v[56:59], a[100:103], v[196:199]
  buffer_load_dwordx4 a[160:163], v16, s[16:19], s38 offen offset:0 sc1
  v_mfma_f32_16x16x32_bf16 v[200:203], v[56:59], a[104:107], v[200:203]
  buffer_load_dwordx4 v6, s[8:11], s90 offen offset:1024 lds
  v_mfma_f32_16x16x32_bf16 v[204:207], v[56:59], a[108:111], v[204:207]
  buffer_load_dwordx4 a[164:167], v16, s[16:19], s38 offen offset:1024 sc1
  v_mfma_f32_16x16x32_bf16 v[208:211], v[60:63], a[96:99], v[208:211]
  ds_read_b64_tr_b16 v[56:57], v10 offset:36928
  ds_read_b64_tr_b16 v[58:59], v10 offset:41536
  v_mfma_f32_16x16x32_bf16 v[212:215], v[60:63], a[100:103], v[212:215]
  buffer_load_dwordx4 a[168:171], v16, s[16:19], s38 offen offset:2048 sc1
  v_mfma_f32_16x16x32_bf16 v[216:219], v[60:63], a[104:107], v[216:219]
  buffer_load_dwordx4 a[172:175], v16, s[16:19], s38 offen offset:3072 sc1
  v_mfma_f32_16x16x32_bf16 v[220:223], v[60:63], a[108:111], v[220:223]
  s_waitcnt lgkmcnt(6)
  v_mfma_f32_16x16x32_bf16 v[224:227], v[64:67], a[96:99], v[224:227]
  ds_read_b64_tr_b16 v[60:61], v10 offset:36960
  ds_read_b64_tr_b16 v[62:63], v10 offset:41568
  v_mfma_f32_16x16x32_bf16 v[228:231], v[64:67], a[100:103], v[228:231]
  v_mfma_f32_16x16x32_bf16 v[232:235], v[64:67], a[104:107], v[232:235]
  buffer_load_dwordx4 v7, s[8:11], s90 offen offset:2048 lds
  v_mfma_f32_16x16x32_bf16 v[236:239], v[64:67], a[108:111], v[236:239]
  v_mfma_f32_16x16x32_bf16 v[240:243], v[68:71], a[96:99], v[240:243]
  ds_read_b64_tr_b16 v[64:65], v10 offset:36992
  ds_read_b64_tr_b16 v[66:67], v10 offset:41600
  v_mfma_f32_16x16x32_bf16 v[244:247], v[68:71], a[100:103], v[244:247]
  v_mfma_f32_16x16x32_bf16 v[248:251], v[68:71], a[104:107], v[248:251]
  v_mfma_f32_16x16x32_bf16 v[252:255], v[68:71], a[108:111], v[252:255]
  s_waitcnt lgkmcnt(6)
  v_mfma_f32_16x16x32_bf16 v[112:115], v[48:51], a[112:115], v[112:115]
  ds_read_b64_tr_b16 v[68:69], v10 offset:37024
  ds_read_b64_tr_b16 v[70:71], v10 offset:41632
  v_mfma_f32_16x16x32_bf16 v[116:119], v[48:51], a[116:119], v[116:119]
  v_mfma_f32_16x16x32_bf16 v[120:123], v[48:51], a[120:123], v[120:123]
  buffer_load_dwordx4 v8, s[8:11], s90 offen offset:3072 lds
  v_mfma_f32_16x16x32_bf16 v[124:127], v[48:51], a[124:127], v[124:127]
  s_add_u32 s52, s79, 8192
  s_mov_b64 exec, 0xffff
  buffer_load_dword v73, v14, s[16:19], s52 offen sc1
  s_mov_b64 exec, -1
  v_mfma_f32_16x16x32_bf16 v[128:131], v[52:55], a[112:115], v[128:131]
  ds_read_b64_tr_b16 v[48:49], v10 offset:37056
  ds_read_b64_tr_b16 v[50:51], v10 offset:41664
  v_mfma_f32_16x16x32_bf16 v[132:135], v[52:55], a[116:119], v[132:135]
  s_add_u32 s52, s80, 8192
  s_mov_b64 exec, 0xffff
  buffer_load_dword v73, v14, s[16:19], s52 offen sc1
  s_mov_b64 exec, -1
  v_mfma_f32_16x16x32_bf16 v[136:139], v[52:55], a[120:123], v[136:139]
  v_mfma_f32_16x16x32_bf16 v[140:143], v[52:55], a[124:127], v[140:143]
  s_waitcnt lgkmcnt(6)
  v_mfma_f32_16x16x32_bf16 v[144:147], v[56:59], a[112:115], v[144:147]
  ds_read_b64_tr_b16 v[52:53], v10 offset:37088
  ds_read_b64_tr_b16 v[54:55], v10 offset:41696
  v_mfma_f32_16x16x32_bf16 v[148:151], v[56:59], a[116:119], v[148:151]
  s_lshr_b32 s52, s2, 3
  s_lshl_b32 s52, s52, 2
  s_add_u32 s52, s52, s3
  s_lshl_b32 s52, s52, 9
  s_mov_b64 exec, 0xf
  buffer_load_dword v73, v72, s[48:51], s52 offen
  s_mov_b64 exec, -1
  v_mfma_f32_16x16x32_bf16 v[152:155], v[56:59], a[120:123], v[152:155]
  s_add_u32 m0, s40, 8192
  v_mfma_f32_16x16x32_bf16 v[156:159], v[56:59], a[124:127], v[156:159]
  s_add_u32 s38, s77, 8192
  v_mfma_f32_16x16x32_bf16 v[160:163], v[60:63], a[112:115], v[160:163]
  ds_read_b64_tr_b16 v[56:57], v10 offset:37120
  ds_read_b64_tr_b16 v[58:59], v10 offset:41728
  v_mfma_f32_16x16x32_bf16 v[164:167], v[60:63], a[116:119], v[164:167]
  v_mfma_f32_16x16x32_bf16 v[168:171], v[60:63], a[120:123], v[168:171]
  buffer_load_dwordx4 a[176:179], v16, s[16:19], s38 offen offset:0 sc1
  v_mfma_f32_16x16x32_bf16 v[172:175], v[60:63], a[124:127], v[172:175]
  s_waitcnt lgkmcnt(6)
  v_mfma_f32_16x16x32_bf16 v[176:179], v[64:67], a[112:115], v[176:179]
  ds_read_b64_tr_b16 v[60:61], v10 offset:46080
  ds_read_b64_tr_b16 v[62:63], v10 offset:50688
  v_mfma_f32_16x16x32_bf16 v[180:183], v[64:67], a[116:119], v[180:183]
  buffer_load_dwordx4 a[180:183], v16, s[16:19], s38 offen offset:1024 sc1
  v_mfma_f32_16x16x32_bf16 v[184:187], v[64:67], a[120:123], v[184:187]
  buffer_load_dwordx4 v9, s[8:11], s90 offen offset:0 lds
  v_mfma_f32_16x16x32_bf16 v[188:191], v[64:67], a[124:127], v[188:191]
  v_mfma_f32_16x16x32_bf16 v[192:195], v[68:71], a[112:115], v[192:195]
  ds_read_b64_tr_b16 v[64:65], v10 offset:46112
  ds_read_b64_tr_b16 v[66:67], v10 offset:50720
  v_mfma_f32_16x16x32_bf16 v[196:199], v[68:71], a[116:119], v[196:199]
  buffer_load_dwordx4 a[184:187], v16, s[16:19], s38 offen offset:2048 sc1
  v_mfma_f32_16x16x32_bf16 v[200:203], v[68:71], a[120:123], v[200:203]
  v_mfma_f32_16x16x32_bf16 v[204:207], v[68:71], a[124:127], v[204:207]
  s_waitcnt lgkmcnt(6)
  v_mfma_f32_16x16x32_bf16 v[208:211], v[48:51], a[112:115], v[208:211]
  ds_read_b64_tr_b16 v[68:69], v10 offset:46144
  ds_read_b64_tr_b16 v[70:71], v10 offset:50752
  v_mfma_f32_16x16x32_bf16 v[212:215], v[48:51], a[116:119], v[212:215]
  buffer_load_dwordx4 a[188:191], v16, s[16:19], s38 offen offset:3072 sc1
  v_mfma_f32_16x16x32_bf16 v[216:219], v[48:51], a[120:123], v[216:219]
  v_mfma_f32_16x16x32_bf16 v[220:223], v[48:51], a[124:127], v[220:223]
  v_mfma_f32_16x16x32_bf16 v[224:227], v[52:55], a[112:115], v[224:227]
  ds_read_b64_tr_b16 v[48:49], v10 offset:46176
  ds_read_b64_tr_b16 v[50:51], v10 offset:50784
  v_mfma_f32_16x16x32_bf16 v[228:231], v[52:55], a[116:119], v[228:231]
  v_mfma_f32_16x16x32_bf16 v[232:235], v[52:55], a[120:123], v[232:235]
  v_mfma_f32_16x16x32_bf16 v[236:239], v[52:55], a[124:127], v[236:239]
  s_waitcnt lgkmcnt(6)
  v_mfma_f32_16x16x32_bf16 v[240:243], v[56:59], a[112:115], v[240:243]
  ds_read_b64_tr_b16 v[52:53], v10 offset:46208
  ds_read_b64_tr_b16 v[54:55], v10 offset:50816
  v_mfma_f32_16x16x32_bf16 v[244:247], v[56:59], a[116:119], v[244:247]
  v_mfma_f32_16x16x32_bf16 v[248:251], v[56:59], a[120:123], v[248:251]
  v_mfma_f32_16x16x32_bf16 v[252:255], v[56:59], a[124:127], v[252:255]
  s_barrier
  s_waitcnt vmcnt(23)
  v_mfma_f32_16x16x32_bf16 v[112:115], v[60:63], a[128:131], v[112:115]
  ds_read_b64_tr_b16 v[56:57], v10 offset:46240
  ds_read_b64_tr_b16 v[58:59], v10 offset:50848
  v_mfma_f32_16x16x32_bf16 v[116:119], v[60:63], a[132:135], v[116:119]
  v_mfma_f32_16x16x32_bf16 v[120:123], v[60:63], a[136:139], v[120:123]
  s_add_u32 s52, s81, 8192
  s_mov_b64 exec, 0xffff
  buffer_load_dword v73, v14, s[16:19], s52 offen sc1
  s_mov_b64 exec, -1
  v_mfma_f32_16x16x32_bf16 v[124:127], v[60:63], a[140:143], v[124:127]
  s_waitcnt lgkmcnt(6)
  v_mfma_f32_16x16x32_bf16 v[128:131], v[64:67], a[128:131], v[128:131]
  ds_read_b64_tr_b16 v[60:61], v10 offset:46272
  ds_read_b64_tr_b16 v[62:63], v10 offset:50880
  v_mfma_f32_16x16x32_bf16 v[132:135], v[64:67], a[132:135], v[132:135]
  v_mfma_f32_16x16x32_bf16 v[136:139], v[64:67], a[136:139], v[136:139]
  v_mfma_f32_16x16x32_bf16 v[140:143], v[64:67], a[140:143], v[140:143]
  s_add_u32 s38, s77, 12288
  v_mfma_f32_16x16x32_bf16 v[144:147], v[68:71], a[128:131], v[144:147]
  ds_read_b64_tr_b16 v[64:65], v10 offset:46304
  ds_read_b64_tr_b16 v[66:67], v10 offset:50912
  v_mfma_f32_16x16x32_bf16 v[148:151], v[68:71], a[132:135], v[148:151]
  v_mfma_f32_16x16x32_bf16 v[152:155], v[68:71], a[136:139], v[152:155]
  v_mfma_f32_16x16x32_bf16 v[156:159], v[68:71], a[140:143], v[156:159]
  s_waitcnt lgkmcnt(6)
  v_mfma_f32_16x16x32_bf16 v[160:163], v[48:51], a[128:131], v[160:163]
  ds_read_b64_tr_b16 v[68:69], v10 offset:46336
  ds_read_b64_tr_b16 v[70:71], v10 offset:50944
  v_mfma_f32_16x16x32_bf16 v[164:167], v[48:51], a[132:135], v[164:167]
  buffer_load_dwordx4 a[192:195], v16, s[16:19], s38 offen offset:0 sc1
  v_mfma_f32_16x16x32_bf16 v[168:171], v[48:51], a[136:139], v[168:171]
  v_mfma_f32_16x16x32_bf16 v[172:175], v[48:51], a[140:143], v[172:175]
  v_mfma_f32_16x16x32_bf16 v[176:179], v[52:55], a[128:131], v[176:179]
  ds_read_b64_tr_b16 v[48:49], v11 offset:0
  ds_read_b64_tr_b16 v[50:51], v11 offset:4608
  v_mfma_f32_16x16x32_bf16 v[180:183], v[52:55], a[132:135], v[180:183]
  buffer_load_dwordx4 a[196:199], v16, s[16:19], s38 offen offset:1024 sc1
  v_mfma_f32_16x16x32_bf16 v[184:187], v[52:55], a[136:139], v[184:187]
  v_mfma_f32_16x16x32_bf16 v[188:191], v[52:55], a[140:143], v[188:191]
  s_waitcnt lgkmcnt(6)
  v_mfma_f32_16x16x32_bf16 v[192:195], v[56:59], a[128:131], v[192:195]
  ds_read_b64_tr_b16 v[52:53], v11 offset:32
  ds_read_b64_tr_b16 v[54:55], v11 offset:4640
  v_mfma_f32_16x16x32_bf16 v[196:199], v[56:59], a[132:135], v[196:199]
  v_mfma_f32_16x16x32_bf16 v[200:203], v[56:59], a[136:139], v[200:203]
  buffer_load_dwordx4 a[200:203], v16, s[16:19], s38 offen offset:2048 sc1
  v_mfma_f32_16x16x32_bf16 v[204:207], v[56:59], a[140:143], v[204:207]
  v_mfma_f32_16x16x32_bf16 v[208:211], v[60:63], a[128:131], v[208:211]
  ds_read_b64_tr_b16 v[56:57], v11 offset:64
  ds_read_b64_tr_b16 v[58:59], v11 offset:4672
  v_mfma_f32_16x16x32_bf16 v[212:215], v[60:63], a[132:135], v[212:215]
  v_mfma_f32_16x16x32_bf16 v[216:219], v[60:63], a[136:139], v[216:219]
  v_mfma_f32_16x16x32_bf16 v[220:223], v[60:63], a[140:143], v[220:223]
  s_waitcnt lgkmcnt(6)
  v_mfma_f32_16x16x32_bf16 v[224:227], v[64:67], a[128:131], v[224:227]
  ds_read_b64_tr_b16 v[60:61], v11 offset:96
  ds_read_b64_tr_b16 v[62:63], v11 offset:4704
  v_mfma_f32_16x16x32_bf16 v[228:231], v[64:67], a[132:135], v[228:231]
  buffer_load_dwordx4 a[204:207], v16, s[16:19], s38 offen offset:3072 sc1
  v_mfma_f32_16x16x32_bf16 v[232:235], v[64:67], a[136:139], v[232:235]
  v_mfma_f32_16x16x32_bf16 v[236:239], v[64:67], a[140:143], v[236:239]
  v_mfma_f32_16x16x32_bf16 v[240:243], v[68:71], a[128:131], v[240:243]
  ds_read_b64_tr_b16 v[64:65], v11 offset:128
  ds_read_b64_tr_b16 v[66:67], v11 offset:4736
  v_mfma_f32_16x16x32_bf16 v[244:247], v[68:71], a[132:135], v[244:247]
  v_mfma_f32_16x16x32_bf16 v[248:251], v[68:71], a[136:139], v[248:251]
  v_mfma_f32_16x16x32_bf16 v[252:255], v[68:71], a[140:143], v[252:255]
  s_barrier
  s_waitcnt vmcnt(20) lgkmcnt(6)
  v_mfma_f32_16x16x32_bf16 v[112:115], v[48:51], a[144:147], v[112:115]
  ds_read_b64_tr_b16 v[68:69], v11 offset:160
  ds_read_b64_tr_b16 v[70:71], v11 offset:4768
  v_mfma_f32_16x16x32_bf16 v[116:119], v[48:51], a[148:151], v[116:119]
  v_mfma_f32_16x16x32_bf16 v[120:123], v[48:51], a[152:155], v[120:123]
  s_add_u32 m0, s41, 0
  v_mfma_f32_16x16x32_bf16 v[124:127], v[48:51], a[156:159], v[124:127]
  s_add_u32 s52, s82, 8192
  s_mov_b64 exec, 0xffff
  buffer_load_dword v73, v14, s[16:19], s52 offen sc1
  s_mov_b64 exec, -1
  v_mfma_f32_16x16x32_bf16 v[128:131], v[52:55], a[144:147], v[128:131]
  ds_read_b64_tr_b16 v[48:49], v11 offset:192
  ds_read_b64_tr_b16 v[50:51], v11 offset:4800
  v_mfma_f32_16x16x32_bf16 v[132:135], v[52:55], a[148:151], v[132:135]
  s_add_u32 s38, s78, 8192
  v_mfma_f32_16x16x32_bf16 v[136:139], v[52:55], a[152:155], v[136:139]
  buffer_load_dwordx4 a[208:211], v16, s[16:19], s38 offen offset:0 sc1
  v_mfma_f32_16x16x32_bf16 v[140:143], v[52:55], a[156:159], v[140:143]
  s_waitcnt lgkmcnt(6)
  v_mfma_f32_16x16x32_bf16 v[144:147], v[56:59], a[144:147], v[144:147]
  ds_read_b64_tr_b16 v[52:53], v11 offset:224
  ds_read_b64_tr_b16 v[54:55], v11 offset:4832
  v_mfma_f32_16x16x32_bf16 v[148:151], v[56:59], a[148:151], v[148:151]
  buffer_load_dwordx4 a[212:215], v16, s[16:19], s38 offen offset:1024 sc1
  v_mfma_f32_16x16x32_bf16 v[152:155], v[56:59], a[152:155], v[152:155]
  buffer_load_dwordx4 v1, s[8:11], s91 offen offset:0 lds
  v_mfma_f32_16x16x32_bf16 v[156:159], v[56:59], a[156:159], v[156:159]
  buffer_load_dwordx4 a[216:219], v16, s[16:19], s38 offen offset:2048 sc1
  v_mfma_f32_16x16x32_bf16 v[160:163], v[60:63], a[144:147], v[160:163]
  ds_read_b64_tr_b16 v[56:57], v11 offset:256
  ds_read_b64_tr_b16 v[58:59], v11 offset:4864
  v_mfma_f32_16x16x32_bf16 v[164:167], v[60:63], a[148:151], v[164:167]
  buffer_load_dwordx4 a[220:223], v16, s[16:19], s38 offen offset:3072 sc1
  v_mfma_f32_16x16x32_bf16 v[168:171], v[60:63], a[152:155], v[168:171]
  s_add_u32 s38, s78, 12288
  v_mfma_f32_16x16x32_bf16 v[172:175], v[60:63], a[156:159], v[172:175]
  s_waitcnt lgkmcnt(6)
  v_mfma_f32_16x16x32_bf16 v[176:179], v[64:67], a[144:147], v[176:179]
  ds_read_b64_tr_b16 v[60:61], v11 offset:9216
  ds_read_b64_tr_b16 v[62:63], v11 offset:13824
  v_mfma_f32_16x16x32_bf16 v[180:183], v[64:67], a[148:151], v[180:183]
  buffer_load_dwordx4 a[224:227], v16, s[16:19], s38 offen offset:0 sc1
  v_mfma_f32_16x16x32_bf16 v[184:187], v[64:67], a[152:155], v[184:187]
  buffer_load_dwordx4 v2, s[8:11], s91 offen offset:1024 lds
  v_mfma_f32_16x16x32_bf16 v[188:191], v[64:67], a[156:159], v[188:191]
  buffer_load_dwordx4 a[228:231], v16, s[16:19], s38 offen offset:1024 sc1
  v_mfma_f32_16x16x32_bf16 v[192:195], v[68:71], a[144:147], v[192:195]
  ds_read_b64_tr_b16 v[64:65], v11 offset:9248
  ds_read_b64_tr_b16 v[66:67], v11 offset:13856
  v_mfma_f32_16x16x32_bf16 v[196:199], v[68:71], a[148:151], v[196:199]
  buffer_load_dwordx4 a[232:235], v16, s[16:19], s38 offen offset:2048 sc1
  v_mfma_f32_16x16x32_bf16 v[200:203], v[68:71], a[152:155], v[200:203]
  buffer_load_dwordx4 a[236:239], v16, s[16:19], s38 offen offset:3072 sc1
  v_mfma_f32_16x16x32_bf16 v[204:207], v[68:71], a[156:159], v[204:207]
  s_waitcnt lgkmcnt(6)
  v_mfma_f32_16x16x32_bf16 v[208:211], v[48:51], a[144:147], v[208:211]
  ds_read_b64_tr_b16 v[68:69], v11 offset:9280
  ds_read_b64_tr_b16 v[70:71], v11 offset:13888
  v_mfma_f32_16x16x32_bf16 v[212:215], v[48:51], a[148:151], v[212:215]
  v_mfma_f32_16x16x32_bf16 v[216:219], v[48:51], a[152:155], v[216:219]
  buffer_load_dwordx4 v3, s[8:11], s91 offen offset:2048 lds
  v_mfma_f32_16x16x32_bf16 v[220:223], v[48:51], a[156:159], v[220:223]
  v_mfma_f32_16x16x32_bf16 v[224:227], v[52:55], a[144:147], v[224:227]
  ds_read_b64_tr_b16 v[48:49], v11 offset:9312
  ds_read_b64_tr_b16 v[50:51], v11 offset:13920
  v_mfma_f32_16x16x32_bf16 v[228:231], v[52:55], a[148:151], v[228:231]
  v_mfma_f32_16x16x32_bf16 v[232:235], v[52:55], a[152:155], v[232:235]
  v_mfma_f32_16x16x32_bf16 v[236:239], v[52:55], a[156:159], v[236:239]
  s_waitcnt lgkmcnt(6)
  v_mfma_f32_16x16x32_bf16 v[240:243], v[56:59], a[144:147], v[240:243]
  ds_read_b64_tr_b16 v[52:53], v11 offset:9344
  ds_read_b64_tr_b16 v[54:55], v11 offset:13952
  v_mfma_f32_16x16x32_bf16 v[244:247], v[56:59], a[148:151], v[244:247]
  v_mfma_f32_16x16x32_bf16 v[248:251], v[56:59], a[152:155], v[248:251]
  buffer_load_dwordx4 v4, s[8:11], s91 offen offset:3072 lds
  v_mfma_f32_16x16x32_bf16 v[252:255], v[56:59], a[156:159], v[252:255]
  s_waitcnt vmcnt(28)
  v_mfma_f32_16x16x32_bf16 v[112:115], v[60:63], a[160:163], v[112:115]
  ds_read_b64_tr_b16 v[56:57], v11 offset:9376
  ds_read_b64_tr_b16 v[58:59], v11 offset:13984
  v_mfma_f32_16x16x32_bf16 v[116:119], v[60:63], a[164:167], v[116:119]
  v_mfma_f32_16x16x32_bf16 v[120:123], v[60:63], a[168:171], v[120:123]
  s_add_u32 s38, s79, 8192
  v_mfma_f32_16x16x32_bf16 v[124:127], v[60:63], a[172:175], v[124:127]
  s_waitcnt lgkmcnt(6)
  v_mfma_f32_16x16x32_bf16 v[128:131], v[64:67], a[160:163], v[128:131]
  ds_read_b64_tr_b16 v[60:61], v11 offset:9408
  ds_read_b64_tr_b16 v[62:63], v11 offset:14016
  v_mfma_f32_16x16x32_bf16 v[132:135], v[64:67], a[164:167], v[132:135]
  v_mfma_f32_16x16x32_bf16 v[136:139], v[64:67], a[168:171], v[136:139]
  s_add_u32 m0, s41, 4096
  v_mfma_f32_16x16x32_bf16 v[140:143], v[64:67], a[172:175], v[140:143]
  v_mfma_f32_16x16x32_bf16 v[144:147], v[68:71], a[160:163], v[144:147]
  ds_read_b64_tr_b16 v[64:65], v11 offset:9440
  ds_read_b64_tr_b16 v[66:67], v11 offset:14048
  v_mfma_f32_16x16x32_bf16 v[148:151], v[68:71], a[164:167], v[148:151]
  buffer_load_dwordx4 a[240:243], v16, s[16:19], s38 offen offset:0 sc1
  v_mfma_f32_16x16x32_bf16 v[152:155], v[68:71], a[168:171], v[152:155]
  v_mfma_f32_16x16x32_bf16 v[156:159], v[68:71], a[172:175], v[156:159]
  s_waitcnt lgkmcnt(6)
  v_mfma_f32_16x16x32_bf16 v[160:163], v[48:51], a[160:163], v[160:163]
  ds_read_b64_tr_b16 v[68:69], v11 offset:9472
  ds_read_b64_tr_b16 v[70:71], v11 offset:14080
  v_mfma_f32_16x16x32_bf16 v[164:167], v[48:51], a[164:167], v[164:167]
  v_mfma_f32_16x16x32_bf16 v[168:171], v[48:51], a[168:171], v[168:171]
  buffer_load_dwordx4 v5, s[8:11], s91 offen offset:0 lds
  v_mfma_f32_16x16x32_bf16 v[172:175], v[48:51], a[172:175], v[172:175]
  buffer_load_dwordx4 a[244:247], v16, s[16:19], s38 offen offset:1024 sc1
  v_mfma_f32_16x16x32_bf16 v[176:179], v[52:55], a[160:163], v[176:179]
  ds_read_b64_tr_b16 v[48:49], v11 offset:18432
  ds_read_b64_tr_b16 v[50:51], v11 offset:23040
  v_mfma_f32_16x16x32_bf16 v[180:183], v[52:55], a[164:167], v[180:183]
  v_mfma_f32_16x16x32_bf16 v[184:187], v[52:55], a[168:171], v[184:187]
  v_mfma_f32_16x16x32_bf16 v[188:191], v[52:55], a[172:175], v[188:191]
  s_waitcnt lgkmcnt(6)
  v_mfma_f32_16x16x32_bf16 v[192:195], v[56:59], a[160:163], v[192:195]
  ds_read_b64_tr_b16 v[52:53], v11 offset:18464
  ds_read_b64_tr_b16 v[54:55], v11 offset:23072
  v_mfma_f32_16x16x32_bf16 v[196:199], v[56:59], a[164:167], v[196:199]
  buffer_load_dwordx4 a[248:251], v16, s[16:19], s38 offen offset:2048 sc1
  v_mfma_f32_16x16x32_bf16 v[200:203], v[56:59], a[168:171], v[200:203]
  buffer_load_dwordx4 v6, s[8:11], s91 offen offset:1024 lds
  v_mfma_f32_16x16x32_bf16 v[204:207], v[56:59], a[172:175], v[204:207]
  v_mfma_f32_16x16x32_bf16 v[208:211], v[60:63], a[160:163], v[208:211]
  ds_read_b64_tr_b16 v[56:57], v11 offset:18496
  ds_read_b64_tr_b16 v[58:59], v11 offset:23104
  v_mfma_f32_16x16x32_bf16 v[212:215], v[60:63], a[164:167], v[212:215]
  v_mfma_f32_16x16x32_bf16 v[216:219], v[60:63], a[168:171], v[216:219]
  buffer_load_dwordx4 a[252:255], v16, s[16:19], s38 offen offset:3072 sc1
  v_mfma_f32_16x16x32_bf16 v[220:223], v[60:63], a[172:175], v[220:223]
  s_waitcnt lgkmcnt(6)
  v_mfma_f32_16x16x32_bf16 v[224:227], v[64:67], a[160:163], v[224:227]
  ds_read_b64_tr_b16 v[60:61], v11 offset:18528
  ds_read_b64_tr_b16 v[62:63], v11 offset:23136
  v_mfma_f32_16x16x32_bf16 v[228:231], v[64:67], a[164:167], v[228:231]
  v_mfma_f32_16x16x32_bf16 v[232:235], v[64:67], a[168:171], v[232:235]
  buffer_load_dwordx4 v7, s[8:11], s91 offen offset:2048 lds
  v_mfma_f32_16x16x32_bf16 v[236:239], v[64:67], a[172:175], v[236:239]
  v_mfma_f32_16x16x32_bf16 v[240:243], v[68:71], a[160:163], v[240:243]
  ds_read_b64_tr_b16 v[64:65], v11 offset:18560
  ds_read_b64_tr_b16 v[66:67], v11 offset:23168
  v_mfma_f32_16x16x32_bf16 v[244:247], v[68:71], a[164:167], v[244:247]
  v_mfma_f32_16x16x32_bf16 v[248:251], v[68:71], a[168:171], v[248:251]
  v_mfma_f32_16x16x32_bf16 v[252:255], v[68:71], a[172:175], v[252:255]
  s_waitcnt vmcnt(25) lgkmcnt(6)
  v_mfma_f32_16x16x32_bf16 v[112:115], v[48:51], a[176:179], v[112:115]
  ds_read_b64_tr_b16 v[68:69], v11 offset:18592
  ds_read_b64_tr_b16 v[70:71], v11 offset:23200
  v_mfma_f32_16x16x32_bf16 v[116:119], v[48:51], a[180:183], v[116:119]
  v_mfma_f32_16x16x32_bf16 v[120:123], v[48:51], a[184:187], v[120:123]
  buffer_load_dwordx4 v8, s[8:11], s91 offen offset:3072 lds
  v_mfma_f32_16x16x32_bf16 v[124:127], v[48:51], a[188:191], v[124:127]
  s_add_u32 s52, s83, 8192
  s_mov_b64 exec, 0xffff
  buffer_load_dword v73, v14, s[16:19], s52 offen sc1
  s_mov_b64 exec, -1
  v_mfma_f32_16x16x32_bf16 v[128:131], v[52:55], a[176:179], v[128:131]
  ds_read_b64_tr_b16 v[48:49], v11 offset:18624
  ds_read_b64_tr_b16 v[50:51], v11 offset:23232
  v_mfma_f32_16x16x32_bf16 v[132:135], v[52:55], a[180:183], v[132:135]
  s_add_u32 s38, s79, 12288
  v_mfma_f32_16x16x32_bf16 v[136:139], v[52:55], a[184:187], v[136:139]
  buffer_load_dwordx4 a[0:3], v16, s[16:19], s38 offen offset:0 sc1
  v_mfma_f32_16x16x32_bf16 v[140:143], v[52:55], a[188:191], v[140:143]
  s_waitcnt lgkmcnt(6)
  v_mfma_f32_16x16x32_bf16 v[144:147], v[56:59], a[176:179], v[144:147]
  ds_read_b64_tr_b16 v[52:53], v11 offset:18656
  ds_read_b64_tr_b16 v[54:55], v11 offset:23264
  v_mfma_f32_16x16x32_bf16 v[148:151], v[56:59], a[180:183], v[148:151]
  buffer_load_dwordx4 a[4:7], v16, s[16:19], s38 offen offset:1024 sc1
  v_mfma_f32_16x16x32_bf16 v[152:155], v[56:59], a[184:187], v[152:155]
  s_add_u32 m0, s41, 8192
  v_mfma_f32_16x16x32_bf16 v[156:159], v[56:59], a[188:191], v[156:159]
  buffer_load_dwordx4 a[8:11], v16, s[16:19], s38 offen offset:2048 sc1
  v_mfma_f32_16x16x32_bf16 v[160:163], v[60:63], a[176:179], v[160:163]
  ds_read_b64_tr_b16 v[56:57], v11 offset:18688
  ds_read_b64_tr_b16 v[58:59], v11 offset:23296
  v_mfma_f32_16x16x32_bf16 v[164:167], v[60:63], a[180:183], v[164:167]
  buffer_load_dwordx4 a[12:15], v16, s[16:19], s38 offen offset:3072 sc1
  v_mfma_f32_16x16x32_bf16 v[168:171], v[60:63], a[184:187], v[168:171]
  s_add_u32 s38, s80, 8192
  v_mfma_f32_16x16x32_bf16 v[172:175], v[60:63], a[188:191], v[172:175]
  s_waitcnt lgkmcnt(6)
  v_mfma_f32_16x16x32_bf16 v[176:179], v[64:67], a[176:179], v[176:179]
  ds_read_b64_tr_b16 v[60:61], v11 offset:27648
  ds_read_b64_tr_b16 v[62:63], v11 offset:32256
  v_mfma_f32_16x16x32_bf16 v[180:183], v[64:67], a[180:183], v[180:183]
  buffer_load_dwordx4 a[16:19], v16, s[16:19], s38 offen offset:0 sc1
  v_mfma_f32_16x16x32_bf16 v[184:187], v[64:67], a[184:187], v[184:187]
  buffer_load_dwordx4 v9, s[8:11], s91 offen offset:0 lds
  v_mfma_f32_16x16x32_bf16 v[188:191], v[64:67], a[188:191], v[188:191]
  buffer_load_dwordx4 a[20:23], v16, s[16:19], s38 offen offset:1024 sc1
  v_mfma_f32_16x16x32_bf16 v[192:195], v[68:71], a[176:179], v[192:195]
  ds_read_b64_tr_b16 v[64:65], v11 offset:27680
  ds_read_b64_tr_b16 v[66:67], v11 offset:32288
  v_mfma_f32_16x16x32_bf16 v[196:199], v[68:71], a[180:183], v[196:199]
  buffer_load_dwordx4 a[24:27], v16, s[16:19], s38 offen offset:2048 sc1
  v_mfma_f32_16x16x32_bf16 v[200:203], v[68:71], a[184:187], v[200:203]
  buffer_load_dwordx4 a[28:31], v16, s[16:19], s38 offen offset:3072 sc1
  v_mfma_f32_16x16x32_bf16 v[204:207], v[68:71], a[188:191], v[204:207]
  s_waitcnt lgkmcnt(6)
  v_mfma_f32_16x16x32_bf16 v[208:211], v[48:51], a[176:179], v[208:211]
  ds_read_b64_tr_b16 v[68:69], v11 offset:27712
  ds_read_b64_tr_b16 v[70:71], v11 offset:32320
  v_mfma_f32_16x16x32_bf16 v[212:215], v[48:51], a[180:183], v[212:215]
  v_mfma_f32_16x16x32_bf16 v[216:219], v[48:51], a[184:187], v[216:219]
  v_mfma_f32_16x16x32_bf16 v[220:223], v[48:51], a[188:191], v[220:223]
  v_mfma_f32_16x16x32_bf16 v[224:227], v[52:55], a[176:179], v[224:227]
  ds_read_b64_tr_b16 v[48:49], v11 offset:27744
  ds_read_b64_tr_b16 v[50:51], v11 offset:32352
  v_mfma_f32_16x16x32_bf16 v[228:231], v[52:55], a[180:183], v[228:231]
  v_mfma_f32_16x16x32_bf16 v[232:235], v[52:55], a[184:187], v[232:235]
  v_mfma_f32_16x16x32_bf16 v[236:239], v[52:55], a[188:191], v[236:239]
  s_waitcnt lgkmcnt(6)
  v_mfma_f32_16x16x32_bf16 v[240:243], v[56:59], a[176:179], v[240:243]
  ds_read_b64_tr_b16 v[52:53], v11 offset:27776
  ds_read_b64_tr_b16 v[54:55], v11 offset:32384
  v_mfma_f32_16x16x32_bf16 v[244:247], v[56:59], a[180:183], v[244:247]
  v_mfma_f32_16x16x32_bf16 v[248:251], v[56:59], a[184:187], v[248:251]
  v_mfma_f32_16x16x32_bf16 v[252:255], v[56:59], a[188:191], v[252:255]
  s_barrier
  s_waitcnt vmcnt(31)
  v_mfma_f32_16x16x32_bf16 v[112:115], v[60:63], a[192:195], v[112:115]
  ds_read_b64_tr_b16 v[56:57], v11 offset:27808
  ds_read_b64_tr_b16 v[58:59], v11 offset:32416
  v_mfma_f32_16x16x32_bf16 v[116:119], v[60:63], a[196:199], v[116:119]
  v_mfma_f32_16x16x32_bf16 v[120:123], v[60:63], a[200:203], v[120:123]
  s_add_u32 s38, s80, 12288
  v_mfma_f32_16x16x32_bf16 v[124:127], v[60:63], a[204:207], v[124:127]
  s_waitcnt lgkmcnt(6)
  v_mfma_f32_16x16x32_bf16 v[128:131], v[64:67], a[192:195], v[128:131]
  ds_read_b64_tr_b16 v[60:61], v11 offset:27840
  ds_read_b64_tr_b16 v[62:63], v11 offset:32448
  v_mfma_f32_16x16x32_bf16 v[132:135], v[64:67], a[196:199], v[132:135]
  v_mfma_f32_16x16x32_bf16 v[136:139], v[64:67], a[200:203], v[136:139]
  v_mfma_f32_16x16x32_bf16 v[140:143], v[64:67], a[204:207], v[140:143]
  v_mfma_f32_16x16x32_bf16 v[144:147], v[68:71], a[192:195], v[144:147]
  ds_read_b64_tr_b16 v[64:65], v11 offset:27872
  ds_read_b64_tr_b16 v[66:67], v11 offset:32480
  v_mfma_f32_16x16x32_bf16 v[148:151], v[68:71], a[196:199], v[148:151]
  buffer_load_dwordx4 a[32:35], v16, s[16:19], s38 offen offset:0 sc1
  v_mfma_f32_16x16x32_bf16 v[152:155], v[68:71], a[200:203], v[152:155]
  v_mfma_f32_16x16x32_bf16 v[156:159], v[68:71], a[204:207], v[156:159]
  s_waitcnt lgkmcnt(6)
  v_mfma_f32_16x16x32_bf16 v[160:163], v[48:51], a[192:195], v[160:163]
  ds_read_b64_tr_b16 v[68:69], v11 offset:27904
  ds_read_b64_tr_b16 v[70:71], v11 offset:32512
  v_mfma_f32_16x16x32_bf16 v[164:167], v[48:51], a[196:199], v[164:167]
  v_mfma_f32_16x16x32_bf16 v[168:171], v[48:51], a[200:203], v[168:171]
  buffer_load_dwordx4 a[36:39], v16, s[16:19], s38 offen offset:1024 sc1
  v_mfma_f32_16x16x32_bf16 v[172:175], v[48:51], a[204:207], v[172:175]
  v_mfma_f32_16x16x32_bf16 v[176:179], v[52:55], a[192:195], v[176:179]
  ds_read_b64_tr_b16 v[48:49], v11 offset:36864
  ds_read_b64_tr_b16 v[50:51], v11 offset:41472
  v_mfma_f32_16x16x32_bf16 v[180:183], v[52:55], a[196:199], v[180:183]
  v_mfma_f32_16x16x32_bf16 v[184:187], v[52:55], a[200:203], v[184:187]
  v_mfma_f32_16x16x32_bf16 v[188:191], v[52:55], a[204:207], v[188:191]
  s_waitcnt lgkmcnt(6)
  v_mfma_f32_16x16x32_bf16 v[192:195], v[56:59], a[192:195], v[192:195]
  ds_read_b64_tr_b16 v[52:53], v11 offset:36896
  ds_read_b64_tr_b16 v[54:55], v11 offset:41504
  v_mfma_f32_16x16x32_bf16 v[196:199], v[56:59], a[196:199], v[196:199]
  buffer_load_dwordx4 a[40:43], v16, s[16:19], s38 offen offset:2048 sc1
  v_mfma_f32_16x16x32_bf16 v[200:203], v[56:59], a[200:203], v[200:203]
  v_mfma_f32_16x16x32_bf16 v[204:207], v[56:59], a[204:207], v[204:207]
  v_mfma_f32_16x16x32_bf16 v[208:211], v[60:63], a[192:195], v[208:211]
  ds_read_b64_tr_b16 v[56:57], v11 offset:36928
  ds_read_b64_tr_b16 v[58:59], v11 offset:41536
  v_mfma_f32_16x16x32_bf16 v[212:215], v[60:63], a[196:199], v[212:215]
  v_mfma_f32_16x16x32_bf16 v[216:219], v[60:63], a[200:203], v[216:219]
  buffer_load_dwordx4 a[44:47], v16, s[16:19], s38 offen offset:3072 sc1
  v_mfma_f32_16x16x32_bf16 v[220:223], v[60:63], a[204:207], v[220:223]
  s_waitcnt lgkmcnt(6)
  v_mfma_f32_16x16x32_bf16 v[224:227], v[64:67], a[192:195], v[224:227]
  ds_read_b64_tr_b16 v[60:61], v11 offset:36960
  ds_read_b64_tr_b16 v[62:63], v11 offset:41568
  v_mfma_f32_16x16x32_bf16 v[228:231], v[64:67], a[196:199], v[228:231]
  v_mfma_f32_16x16x32_bf16 v[232:235], v[64:67], a[200:203], v[232:235]
  v_mfma_f32_16x16x32_bf16 v[236:239], v[64:67], a[204:207], v[236:239]
  v_mfma_f32_16x16x32_bf16 v[240:243], v[68:71], a[192:195], v[240:243]
  ds_read_b64_tr_b16 v[64:65], v11 offset:36992
  ds_read_b64_tr_b16 v[66:67], v11 offset:41600
  v_mfma_f32_16x16x32_bf16 v[244:247], v[68:71], a[196:199], v[244:247]
  v_mfma_f32_16x16x32_bf16 v[248:251], v[68:71], a[200:203], v[248:251]
  v_mfma_f32_16x16x32_bf16 v[252:255], v[68:71], a[204:207], v[252:255]
  s_waitcnt vmcnt(29) lgkmcnt(6)
  v_mfma_f32_16x16x32_bf16 v[112:115], v[48:51], a[208:211], v[112:115]
  ds_read_b64_tr_b16 v[68:69], v11 offset:37024
  ds_read_b64_tr_b16 v[70:71], v11 offset:41632
  v_mfma_f32_16x16x32_bf16 v[116:119], v[48:51], a[212:215], v[116:119]
  v_mfma_f32_16x16x32_bf16 v[120:123], v[48:51], a[216:219], v[120:123]
  s_add_u32 s38, s81, 8192
  v_mfma_f32_16x16x32_bf16 v[124:127], v[48:51], a[220:223], v[124:127]
  v_mfma_f32_16x16x32_bf16 v[128:131], v[52:55], a[208:211], v[128:131]
  ds_read_b64_tr_b16 v[48:49], v11 offset:37056
  ds_read_b64_tr_b16 v[50:51], v11 offset:41664
  v_mfma_f32_16x16x32_bf16 v[132:135], v[52:55], a[212:215], v[132:135]
  v_mfma_f32_16x16x32_bf16 v[136:139], v[52:55], a[216:219], v[136:139]
  v_mfma_f32_16x16x32_bf16 v[140:143], v[52:55], a[220:223], v[140:143]
  s_waitcnt lgkmcnt(6)
  v_mfma_f32_16x16x32_bf16 v[144:147], v[56:59], a[208:211], v[144:147]
  ds_read_b64_tr_b16 v[52:53], v11 offset:37088
  ds_read_b64_tr_b16 v[54:55], v11 offset:41696
  v_mfma_f32_16x16x32_bf16 v[148:151], v[56:59], a[212:215], v[148:151]
  buffer_load_dwordx4 a[48:51], v16, s[16:19], s38 offen offset:0 sc1
  v_mfma_f32_16x16x32_bf16 v[152:155], v[56:59], a[216:219], v[152:155]
  v_mfma_f32_16x16x32_bf16 v[156:159], v[56:59], a[220:223], v[156:159]
  v_mfma_f32_16x16x32_bf16 v[160:163], v[60:63], a[208:211], v[160:163]
  ds_read_b64_tr_b16 v[56:57], v11 offset:37120
  ds_read_b64_tr_b16 v[58:59], v11 offset:41728
  v_mfma_f32_16x16x32_bf16 v[164:167], v[60:63], a[212:215], v[164:167]
  v_mfma_f32_16x16x32_bf16 v[168:171], v[60:63], a[216:219], v[168:171]
  buffer_load_dwordx4 a[52:55], v16, s[16:19], s38 offen offset:1024 sc1
  v_mfma_f32_16x16x32_bf16 v[172:175], v[60:63], a[220:223], v[172:175]
  s_waitcnt lgkmcnt(6)
  v_mfma_f32_16x16x32_bf16 v[176:179], v[64:67], a[208:211], v[176:179]
  ds_read_b64_tr_b16 v[60:61], v11 offset:46080
  ds_read_b64_tr_b16 v[62:63], v11 offset:50688
  v_mfma_f32_16x16x32_bf16 v[180:183], v[64:67], a[212:215], v[180:183]
  v_mfma_f32_16x16x32_bf16 v[184:187], v[64:67], a[216:219], v[184:187]
  v_mfma_f32_16x16x32_bf16 v[188:191], v[64:67], a[220:223], v[188:191]
  v_mfma_f32_16x16x32_bf16 v[192:195], v[68:71], a[208:211], v[192:195]
  ds_read_b64_tr_b16 v[64:65], v11 offset:46112
  ds_read_b64_tr_b16 v[66:67], v11 offset:50720
  v_mfma_f32_16x16x32_bf16 v[196:199], v[68:71], a[212:215], v[196:199]
  buffer_load_dwordx4 a[56:59], v16, s[16:19], s38 offen offset:2048 sc1
  v_mfma_f32_16x16x32_bf16 v[200:203], v[68:71], a[216:219], v[200:203]
  v_mfma_f32_16x16x32_bf16 v[204:207], v[68:71], a[220:223], v[204:207]
  s_waitcnt lgkmcnt(6)
  v_mfma_f32_16x16x32_bf16 v[208:211], v[48:51], a[208:211], v[208:211]
  ds_read_b64_tr_b16 v[68:69], v11 offset:46144
  ds_read_b64_tr_b16 v[70:71], v11 offset:50752
  v_mfma_f32_16x16x32_bf16 v[212:215], v[48:51], a[212:215], v[212:215]
  v_mfma_f32_16x16x32_bf16 v[216:219], v[48:51], a[216:219], v[216:219]
  buffer_load_dwordx4 a[60:63], v16, s[16:19], s38 offen offset:3072 sc1
  v_mfma_f32_16x16x32_bf16 v[220:223], v[48:51], a[220:223], v[220:223]
  v_mfma_f32_16x16x32_bf16 v[224:227], v[52:55], a[208:211], v[224:227]
  ds_read_b64_tr_b16 v[48:49], v11 offset:46176
  ds_read_b64_tr_b16 v[50:51], v11 offset:50784
  v_mfma_f32_16x16x32_bf16 v[228:231], v[52:55], a[212:215], v[228:231]
  v_mfma_f32_16x16x32_bf16 v[232:235], v[52:55], a[216:219], v[232:235]
  v_mfma_f32_16x16x32_bf16 v[236:239], v[52:55], a[220:223], v[236:239]
  s_waitcnt lgkmcnt(6)
  v_mfma_f32_16x16x32_bf16 v[240:243], v[56:59], a[208:211], v[240:243]
  ds_read_b64_tr_b16 v[52:53], v11 offset:46208
  ds_read_b64_tr_b16 v[54:55], v11 offset:50816
  v_mfma_f32_16x16x32_bf16 v[244:247], v[56:59], a[212:215], v[244:247]
  v_mfma_f32_16x16x32_bf16 v[248:251], v[56:59], a[216:219], v[248:251]
  v_mfma_f32_16x16x32_bf16 v[252:255], v[56:59], a[220:223], v[252:255]
  s_waitcnt vmcnt(28)
  v_mfma_f32_16x16x32_bf16 v[112:115], v[60:63], a[224:227], v[112:115]
  ds_read_b64_tr_b16 v[56:57], v11 offset:46240
  ds_read_b64_tr_b16 v[58:59], v11 offset:50848
  v_mfma_f32_16x16x32_bf16 v[116:119], v[60:63], a[228:231], v[116:119]
  v_mfma_f32_16x16x32_bf16 v[120:123], v[60:63], a[232:235], v[120:123]
  s_add_u32 s38, s81, 12288
  v_mfma_f32_16x16x32_bf16 v[124:127], v[60:63], a[236:239], v[124:127]
  s_waitcnt lgkmcnt(6)
  v_mfma_f32_16x16x32_bf16 v[128:131], v[64:67], a[224:227], v[128:131]
  ds_read_b64_tr_b16 v[60:61], v11 offset:46272
  ds_read_b64_tr_b16 v[62:63], v11 offset:50880
  v_mfma_f32_16x16x32_bf16 v[132:135], v[64:67], a[228:231], v[132:135]
  buffer_load_dwordx4 a[64:67], v16, s[16:19], s38 offen offset:0 sc1
  v_mfma_f32_16x16x32_bf16 v[136:139], v[64:67], a[232:235], v[136:139]
  v_mfma_f32_16x16x32_bf16 v[140:143], v[64:67], a[236:239], v[140:143]
  v_mfma_f32_16x16x32_bf16 v[144:147], v[68:71], a[224:227], v[144:147]
  ds_read_b64_tr_b16 v[64:65], v11 offset:46304
  ds_read_b64_tr_b16 v[66:67], v11 offset:50912
  v_mfma_f32_16x16x32_bf16 v[148:151], v[68:71], a[228:231], v[148:151]
  buffer_load_dwordx4 a[68:71], v16, s[16:19], s38 offen offset:1024 sc1
  v_mfma_f32_16x16x32_bf16 v[152:155], v[68:71], a[232:235], v[152:155]
  v_mfma_f32_16x16x32_bf16 v[156:159], v[68:71], a[236:239], v[156:159]
  s_waitcnt lgkmcnt(6)
  v_mfma_f32_16x16x32_bf16 v[160:163], v[48:51], a[224:227], v[160:163]
  ds_read_b64_tr_b16 v[68:69], v11 offset:46336
  ds_read_b64_tr_b16 v[70:71], v11 offset:50944
  v_mfma_f32_16x16x32_bf16 v[164:167], v[48:51], a[228:231], v[164:167]
  buffer_load_dwordx4 a[72:75], v16, s[16:19], s38 offen offset:2048 sc1
  v_mfma_f32_16x16x32_bf16 v[168:171], v[48:51], a[232:235], v[168:171]
  buffer_load_dwordx4 a[76:79], v16, s[16:19], s38 offen offset:3072 sc1
  v_mfma_f32_16x16x32_bf16 v[172:175], v[48:51], a[236:239], v[172:175]
  v_mfma_f32_16x16x32_bf16 v[176:179], v[52:55], a[224:227], v[176:179]
  ds_read_b64_tr_b16 v[48:49], v12 offset:0
  ds_read_b64_tr_b16 v[50:51], v12 offset:4608
  v_mfma_f32_16x16x32_bf16 v[180:183], v[52:55], a[228:231], v[180:183]
  s_add_u32 s38, s82, 8192
  v_mfma_f32_16x16x32_bf16 v[184:187], v[52:55], a[232:235], v[184:187]
  v_mfma_f32_16x16x32_bf16 v[188:191], v[52:55], a[236:239], v[188:191]
  s_waitcnt lgkmcnt(6)
  v_mfma_f32_16x16x32_bf16 v[192:195], v[56:59], a[224:227], v[192:195]
  ds_read_b64_tr_b16 v[52:53], v12 offset:32
  ds_read_b64_tr_b16 v[54:55], v12 offset:4640
  v_mfma_f32_16x16x32_bf16 v[196:199], v[56:59], a[228:231], v[196:199]
  buffer_load_dwordx4 a[80:83], v16, s[16:19], s38 offen offset:0 sc1
  v_mfma_f32_16x16x32_bf16 v[200:203], v[56:59], a[232:235], v[200:203]
  v_mfma_f32_16x16x32_bf16 v[204:207], v[56:59], a[236:239], v[204:207]
  buffer_load_dwordx4 a[84:87], v16, s[16:19], s38 offen offset:1024 sc1
  v_mfma_f32_16x16x32_bf16 v[208:211], v[60:63], a[224:227], v[208:211]
  ds_read_b64_tr_b16 v[56:57], v12 offset:64
  ds_read_b64_tr_b16 v[58:59], v12 offset:4672
  v_mfma_f32_16x16x32_bf16 v[212:215], v[60:63], a[228:231], v[212:215]
  v_mfma_f32_16x16x32_bf16 v[216:219], v[60:63], a[232:235], v[216:219]
  buffer_load_dwordx4 a[88:91], v16, s[16:19], s38 offen offset:2048 sc1
  v_mfma_f32_16x16x32_bf16 v[220:223], v[60:63], a[236:239], v[220:223]
  s_waitcnt lgkmcnt(6)
  v_mfma_f32_16x16x32_bf16 v[224:227], v[64:67], a[224:227], v[224:227]
  ds_read_b64_tr_b16 v[60:61], v12 offset:96
  ds_read_b64_tr_b16 v[62:63], v12 offset:4704
  v_mfma_f32_16x16x32_bf16 v[228:231], v[64:67], a[228:231], v[228:231]
  buffer_load_dwordx4 a[92:95], v16, s[16:19], s38 offen offset:3072 sc1
  v_mfma_f32_16x16x32_bf16 v[232:235], v[64:67], a[232:235], v[232:235]
  v_mfma_f32_16x16x32_bf16 v[236:239], v[64:67], a[236:239], v[236:239]
  v_mfma_f32_16x16x32_bf16 v[240:243], v[68:71], a[224:227], v[240:243]
  ds_read_b64_tr_b16 v[64:65], v12 offset:128
  ds_read_b64_tr_b16 v[66:67], v12 offset:4736
  v_mfma_f32_16x16x32_bf16 v[244:247], v[68:71], a[228:231], v[244:247]
  v_mfma_f32_16x16x32_bf16 v[248:251], v[68:71], a[232:235], v[248:251]
  v_mfma_f32_16x16x32_bf16 v[252:255], v[68:71], a[236:239], v[252:255]
  s_waitcnt vmcnt(28) lgkmcnt(6)
  v_mfma_f32_16x16x32_bf16 v[112:115], v[48:51], a[240:243], v[112:115]
  ds_read_b64_tr_b16 v[68:69], v12 offset:160
  ds_read_b64_tr_b16 v[70:71], v12 offset:4768
  v_mfma_f32_16x16x32_bf16 v[116:119], v[48:51], a[244:247], v[116:119]
  v_mfma_f32_16x16x32_bf16 v[120:123], v[48:51], a[248:251], v[120:123]
  s_add_u32 s38, s82, 12288
  v_mfma_f32_16x16x32_bf16 v[124:127], v[48:51], a[252:255], v[124:127]
  v_mfma_f32_16x16x32_bf16 v[128:131], v[52:55], a[240:243], v[128:131]
  ds_read_b64_tr_b16 v[48:49], v12 offset:192
  ds_read_b64_tr_b16 v[50:51], v12 offset:4800
  v_mfma_f32_16x16x32_bf16 v[132:135], v[52:55], a[244:247], v[132:135]
  v_mfma_f32_16x16x32_bf16 v[136:139], v[52:55], a[248:251], v[136:139]
  v_mfma_f32_16x16x32_bf16 v[140:143], v[52:55], a[252:255], v[140:143]
  s_waitcnt lgkmcnt(6)
  v_mfma_f32_16x16x32_bf16 v[144:147], v[56:59], a[240:243], v[144:147]
  ds_read_b64_tr_b16 v[52:53], v12 offset:224
  ds_read_b64_tr_b16 v[54:55], v12 offset:4832
  v_mfma_f32_16x16x32_bf16 v[148:151], v[56:59], a[244:247], v[148:151]
  buffer_load_dwordx4 a[96:99], v16, s[16:19], s38 offen offset:0 sc1
  v_mfma_f32_16x16x32_bf16 v[152:155], v[56:59], a[248:251], v[152:155]
  v_mfma_f32_16x16x32_bf16 v[156:159], v[56:59], a[252:255], v[156:159]
  v_mfma_f32_16x16x32_bf16 v[160:163], v[60:63], a[240:243], v[160:163]
  ds_read_b64_tr_b16 v[56:57], v12 offset:256
  ds_read_b64_tr_b16 v[58:59], v12 offset:4864
  v_mfma_f32_16x16x32_bf16 v[164:167], v[60:63], a[244:247], v[164:167]
  v_mfma_f32_16x16x32_bf16 v[168:171], v[60:63], a[248:251], v[168:171]
  buffer_load_dwordx4 a[100:103], v16, s[16:19], s38 offen offset:1024 sc1
  v_mfma_f32_16x16x32_bf16 v[172:175], v[60:63], a[252:255], v[172:175]
  s_waitcnt lgkmcnt(6)
  v_mfma_f32_16x16x32_bf16 v[176:179], v[64:67], a[240:243], v[176:179]
  ds_read_b64_tr_b16 v[60:61], v12 offset:9216
  ds_read_b64_tr_b16 v[62:63], v12 offset:13824
  v_mfma_f32_16x16x32_bf16 v[180:183], v[64:67], a[244:247], v[180:183]
  v_mfma_f32_16x16x32_bf16 v[184:187], v[64:67], a[248:251], v[184:187]
  v_mfma_f32_16x16x32_bf16 v[188:191], v[64:67], a[252:255], v[188:191]
  v_mfma_f32_16x16x32_bf16 v[192:195], v[68:71], a[240:243], v[192:195]
  ds_read_b64_tr_b16 v[64:65], v12 offset:9248
  ds_read_b64_tr_b16 v[66:67], v12 offset:13856
  v_mfma_f32_16x16x32_bf16 v[196:199], v[68:71], a[244:247], v[196:199]
  buffer_load_dwordx4 a[104:107], v16, s[16:19], s38 offen offset:2048 sc1
  v_mfma_f32_16x16x32_bf16 v[200:203], v[68:71], a[248:251], v[200:203]
  v_mfma_f32_16x16x32_bf16 v[204:207], v[68:71], a[252:255], v[204:207]
  s_waitcnt lgkmcnt(6)
  v_mfma_f32_16x16x32_bf16 v[208:211], v[48:51], a[240:243], v[208:211]
  ds_read_b64_tr_b16 v[68:69], v12 offset:9280
  ds_read_b64_tr_b16 v[70:71], v12 offset:13888
  v_mfma_f32_16x16x32_bf16 v[212:215], v[48:51], a[244:247], v[212:215]
  v_mfma_f32_16x16x32_bf16 v[216:219], v[48:51], a[248:251], v[216:219]
  buffer_load_dwordx4 a[108:111], v16, s[16:19], s38 offen offset:3072 sc1
  v_mfma_f32_16x16x32_bf16 v[220:223], v[48:51], a[252:255], v[220:223]
  v_mfma_f32_16x16x32_bf16 v[224:227], v[52:55], a[240:243], v[224:227]
  ds_read_b64_tr_b16 v[48:49], v12 offset:9312
  ds_read_b64_tr_b16 v[50:51], v12 offset:13920
  v_mfma_f32_16x16x32_bf16 v[228:231], v[52:55], a[244:247], v[228:231]
  v_mfma_f32_16x16x32_bf16 v[232:235], v[52:55], a[248:251], v[232:235]
  v_mfma_f32_16x16x32_bf16 v[236:239], v[52:55], a[252:255], v[236:239]
  s_waitcnt lgkmcnt(6)
  v_mfma_f32_16x16x32_bf16 v[240:243], v[56:59], a[240:243], v[240:243]
  ds_read_b64_tr_b16 v[52:53], v12 offset:9344
  ds_read_b64_tr_b16 v[54:55], v12 offset:13952
  v_mfma_f32_16x16x32_bf16 v[244:247], v[56:59], a[244:247], v[244:247]
  v_mfma_f32_16x16x32_bf16 v[248:251], v[56:59], a[248:251], v[248:251]
  v_mfma_f32_16x16x32_bf16 v[252:255], v[56:59], a[252:255], v[252:255]
  s_waitcnt vmcnt(23)
  s_barrier
  v_mfma_f32_16x16x32_bf16 v[112:115], v[60:63], a[0:3], v[112:115]
  ds_read_b64_tr_b16 v[56:57], v12 offset:9376
  ds_read_b64_tr_b16 v[58:59], v12 offset:13984
  v_mfma_f32_16x16x32_bf16 v[116:119], v[60:63], a[4:7], v[116:119]
  v_mfma_f32_16x16x32_bf16 v[120:123], v[60:63], a[8:11], v[120:123]
  s_add_u32 s38, s83, 8192
  v_mfma_f32_16x16x32_bf16 v[124:127], v[60:63], a[12:15], v[124:127]
  s_waitcnt lgkmcnt(6)
  v_mfma_f32_16x16x32_bf16 v[128:131], v[64:67], a[0:3], v[128:131]
  ds_read_b64_tr_b16 v[60:61], v12 offset:9408
  ds_read_b64_tr_b16 v[62:63], v12 offset:14016
  v_mfma_f32_16x16x32_bf16 v[132:135], v[64:67], a[4:7], v[132:135]
  buffer_load_dwordx4 a[112:115], v16, s[16:19], s38 offen offset:0 sc1
  v_mfma_f32_16x16x32_bf16 v[136:139], v[64:67], a[8:11], v[136:139]
  v_mfma_f32_16x16x32_bf16 v[140:143], v[64:67], a[12:15], v[140:143]
  v_mfma_f32_16x16x32_bf16 v[144:147], v[68:71], a[0:3], v[144:147]
  ds_read_b64_tr_b16 v[64:65], v12 offset:9440
  ds_read_b64_tr_b16 v[66:67], v12 offset:14048
  v_mfma_f32_16x16x32_bf16 v[148:151], v[68:71], a[4:7], v[148:151]
  buffer_load_dwordx4 a[116:119], v16, s[16:19], s38 offen offset:1024 sc1
  v_mfma_f32_16x16x32_bf16 v[152:155], v[68:71], a[8:11], v[152:155]
  v_mfma_f32_16x16x32_bf16 v[156:159], v[68:71], a[12:15], v[156:159]
  s_waitcnt lgkmcnt(6)
  v_mfma_f32_16x16x32_bf16 v[160:163], v[48:51], a[0:3], v[160:163]
  ds_read_b64_tr_b16 v[68:69], v12 offset:9472
  ds_read_b64_tr_b16 v[70:71], v12 offset:14080
  v_mfma_f32_16x16x32_bf16 v[164:167], v[48:51], a[4:7], v[164:167]
  buffer_load_dwordx4 a[120:123], v16, s[16:19], s38 offen offset:2048 sc1
  v_mfma_f32_16x16x32_bf16 v[168:171], v[48:51], a[8:11], v[168:171]
  buffer_load_dwordx4 a[124:127], v16, s[16:19], s38 offen offset:3072 sc1
  v_mfma_f32_16x16x32_bf16 v[172:175], v[48:51], a[12:15], v[172:175]
  v_mfma_f32_16x16x32_bf16 v[176:179], v[52:55], a[0:3], v[176:179]
  ds_read_b64_tr_b16 v[48:49], v10 offset:0
  ds_read_b64_tr_b16 v[50:51], v10 offset:4608
  v_mfma_f32_16x16x32_bf16 v[180:183], v[52:55], a[4:7], v[180:183]
  s_add_u32 s38, s83, 12288
  v_mfma_f32_16x16x32_bf16 v[184:187], v[52:55], a[8:11], v[184:187]
  v_mfma_f32_16x16x32_bf16 v[188:191], v[52:55], a[12:15], v[188:191]
  s_waitcnt lgkmcnt(6)
  v_mfma_f32_16x16x32_bf16 v[192:195], v[56:59], a[0:3], v[192:195]
  ds_read_b64_tr_b16 v[52:53], v10 offset:9216
  ds_read_b64_tr_b16 v[54:55], v10 offset:13824
  v_mfma_f32_16x16x32_bf16 v[196:199], v[56:59], a[4:7], v[196:199]
  buffer_load_dwordx4 a[128:131], v16, s[16:19], s38 offen offset:0 sc1
  v_mfma_f32_16x16x32_bf16 v[200:203], v[56:59], a[8:11], v[200:203]
  v_mfma_f32_16x16x32_bf16 v[204:207], v[56:59], a[12:15], v[204:207]
  buffer_load_dwordx4 a[132:135], v16, s[16:19], s38 offen offset:1024 sc1
  v_mfma_f32_16x16x32_bf16 v[208:211], v[60:63], a[0:3], v[208:211]
  ds_read_b64_tr_b16 v[56:57], v10 offset:18432
  ds_read_b64_tr_b16 v[58:59], v10 offset:23040
  v_mfma_f32_16x16x32_bf16 v[212:215], v[60:63], a[4:7], v[212:215]
  v_mfma_f32_16x16x32_bf16 v[216:219], v[60:63], a[8:11], v[216:219]
  buffer_load_dwordx4 a[136:139], v16, s[16:19], s38 offen offset:2048 sc1
  v_mfma_f32_16x16x32_bf16 v[220:223], v[60:63], a[12:15], v[220:223]
  s_waitcnt lgkmcnt(6)
  v_mfma_f32_16x16x32_bf16 v[224:227], v[64:67], a[0:3], v[224:227]
  ds_read_b64_tr_b16 v[60:61], v10 offset:27648
  ds_read_b64_tr_b16 v[62:63], v10 offset:32256
  v_mfma_f32_16x16x32_bf16 v[228:231], v[64:67], a[4:7], v[228:231]
  buffer_load_dwordx4 a[140:143], v16, s[16:19], s38 offen offset:3072 sc1
  v_mfma_f32_16x16x32_bf16 v[232:235], v[64:67], a[8:11], v[232:235]
  v_mfma_f32_16x16x32_bf16 v[236:239], v[64:67], a[12:15], v[236:239]
  v_mfma_f32_16x16x32_bf16 v[240:243], v[68:71], a[0:3], v[240:243]
  ds_read_b64_tr_b16 v[64:65], v12 offset:18432
  ds_read_b64_tr_b16 v[66:67], v12 offset:23040
  v_mfma_f32_16x16x32_bf16 v[244:247], v[68:71], a[4:7], v[244:247]
  v_mfma_f32_16x16x32_bf16 v[248:251], v[68:71], a[8:11], v[248:251]
  v_mfma_f32_16x16x32_bf16 v[252:255], v[68:71], a[12:15], v[252:255]
  s_waitcnt vmcnt(28) lgkmcnt(6)
  v_mfma_f32_16x16x32_bf16 v[112:115], v[48:51], a[16:19], v[112:115]
  ds_read_b64_tr_b16 v[68:69], v12 offset:27648
  ds_read_b64_tr_b16 v[70:71], v12 offset:32256
  v_mfma_f32_16x16x32_bf16 v[116:119], v[48:51], a[20:23], v[116:119]
  v_mfma_f32_16x16x32_bf16 v[120:123], v[48:51], a[24:27], v[120:123]
  v_mfma_f32_16x16x32_bf16 v[124:127], v[48:51], a[28:31], v[124:127]
  s_waitcnt vmcnt(24)
  v_mfma_f32_16x16x32_bf16 v[112:115], v[52:55], a[32:35], v[112:115]
  ds_read_b64_tr_b16 v[48:49], v10 offset:36864
  ds_read_b64_tr_b16 v[50:51], v10 offset:41472
  v_mfma_f32_16x16x32_bf16 v[116:119], v[52:55], a[36:39], v[116:119]
  v_mfma_f32_16x16x32_bf16 v[120:123], v[52:55], a[40:43], v[120:123]
  v_mfma_f32_16x16x32_bf16 v[124:127], v[52:55], a[44:47], v[124:127]
  s_waitcnt vmcnt(20) lgkmcnt(6)
  v_mfma_f32_16x16x32_bf16 v[112:115], v[56:59], a[48:51], v[112:115]
  ds_read_b64_tr_b16 v[52:53], v10 offset:46080
  ds_read_b64_tr_b16 v[54:55], v10 offset:50688
  v_mfma_f32_16x16x32_bf16 v[116:119], v[56:59], a[52:55], v[116:119]
  v_mfma_f32_16x16x32_bf16 v[120:123], v[56:59], a[56:59], v[120:123]
  v_mfma_f32_16x16x32_bf16 v[124:127], v[56:59], a[60:63], v[124:127]
  s_waitcnt vmcnt(16)
  v_mfma_f32_16x16x32_bf16 v[112:115], v[60:63], a[64:67], v[112:115]
  ds_read_b64_tr_b16 v[56:57], v10 offset:32
  ds_read_b64_tr_b16 v[58:59], v10 offset:4640
  v_mfma_f32_16x16x32_bf16 v[116:119], v[60:63], a[68:71], v[116:119]
  v_mfma_f32_16x16x32_bf16 v[120:123], v[60:63], a[72:75], v[120:123]
  v_mfma_f32_16x16x32_bf16 v[124:127], v[60:63], a[76:79], v[124:127]
  s_waitcnt vmcnt(12) lgkmcnt(6)
  v_mfma_f32_16x16x32_bf16 v[112:115], v[64:67], a[80:83], v[112:115]
  ds_read_b64_tr_b16 v[60:61], v10 offset:9248
  ds_read_b64_tr_b16 v[62:63], v10 offset:13856
  v_mfma_f32_16x16x32_bf16 v[116:119], v[64:67], a[84:87], v[116:119]
  v_mfma_f32_16x16x32_bf16 v[120:123], v[64:67], a[88:91], v[120:123]
  v_mfma_f32_16x16x32_bf16 v[124:127], v[64:67], a[92:95], v[124:127]
  s_waitcnt vmcnt(8)
  v_mfma_f32_16x16x32_bf16 v[112:115], v[68:71], a[96:99], v[112:115]
  ds_read_b64_tr_b16 v[64:65], v10 offset:18464
  ds_read_b64_tr_b16 v[66:67], v10 offset:23072
  v_mfma_f32_16x16x32_bf16 v[116:119], v[68:71], a[100:103], v[116:119]
  v_mfma_f32_16x16x32_bf16 v[120:123], v[68:71], a[104:107], v[120:123]
  v_mfma_f32_16x16x32_bf16 v[124:127], v[68:71], a[108:111], v[124:127]
  s_waitcnt vmcnt(4) lgkmcnt(6)
  v_mfma_f32_16x16x32_bf16 v[112:115], v[48:51], a[112:115], v[112:115]
  ds_read_b64_tr_b16 v[68:69], v10 offset:27680
  ds_read_b64_tr_b16 v[70:71], v10 offset:32288
  v_mfma_f32_16x16x32_bf16 v[116:119], v[48:51], a[116:119], v[116:119]
  v_mfma_f32_16x16x32_bf16 v[120:123], v[48:51], a[120:123], v[120:123]
  v_mfma_f32_16x16x32_bf16 v[124:127], v[48:51], a[124:127], v[124:127]
  s_waitcnt vmcnt(0)
  v_mfma_f32_16x16x32_bf16 v[112:115], v[52:55], a[128:131], v[112:115]
  ds_read_b64_tr_b16 v[48:49], v12 offset:18464
  ds_read_b64_tr_b16 v[50:51], v12 offset:23072
  v_mfma_f32_16x16x32_bf16 v[116:119], v[52:55], a[132:135], v[116:119]
  v_mfma_f32_16x16x32_bf16 v[120:123], v[52:55], a[136:139], v[120:123]
  v_mfma_f32_16x16x32_bf16 v[124:127], v[52:55], a[140:143], v[124:127]
  s_waitcnt lgkmcnt(6)
  v_mfma_f32_16x16x32_bf16 v[128:131], v[56:59], a[16:19], v[128:131]
  ds_read_b64_tr_b16 v[52:53], v12 offset:27680
  ds_read_b64_tr_b16 v[54:55], v12 offset:32288
  v_mfma_f32_16x16x32_bf16 v[132:135], v[56:59], a[20:23], v[132:135]
  v_mfma_f32_16x16x32_bf16 v[136:139], v[56:59], a[24:27], v[136:139]
  v_mfma_f32_16x16x32_bf16 v[140:143], v[56:59], a[28:31], v[140:143]
  v_cvt_pk_bf16_f32 v96, v112, v113
  v_cvt_pk_bf16_f32 v97, v114, v115
  v_mfma_f32_16x16x32_bf16 v[128:131], v[60:63], a[32:35], v[128:131]
  ds_read_b64_tr_b16 v[56:57], v10 offset:36896
  ds_read_b64_tr_b16 v[58:59], v10 offset:41504
  v_mfma_f32_16x16x32_bf16 v[132:135], v[60:63], a[36:39], v[132:135]
  v_cvt_pk_bf16_f32 v98, v116, v117
  v_cvt_pk_bf16_f32 v99, v118, v119
  v_mfma_f32_16x16x32_bf16 v[136:139], v[60:63], a[40:43], v[136:139]
  s_mov_b32 s68, 0
  buffer_store_dwordx4 v[96:99], v16, s[28:31], s68 offen sc1
  v_mfma_f32_16x16x32_bf16 v[140:143], v[60:63], a[44:47], v[140:143]
  v_cvt_pk_bf16_f32 v100, v120, v121
  s_waitcnt lgkmcnt(6)
  v_mfma_f32_16x16x32_bf16 v[128:131], v[64:67], a[48:51], v[128:131]
  ds_read_b64_tr_b16 v[60:61], v10 offset:46112
  ds_read_b64_tr_b16 v[62:63], v10 offset:50720
  v_mfma_f32_16x16x32_bf16 v[132:135], v[64:67], a[52:55], v[132:135]
  v_cvt_pk_bf16_f32 v101, v122, v123
  v_cvt_pk_bf16_f32 v102, v124, v125
  v_mfma_f32_16x16x32_bf16 v[136:139], v[64:67], a[56:59], v[136:139]
  v_cvt_pk_bf16_f32 v103, v126, v127
  v_mfma_f32_16x16x32_bf16 v[140:143], v[64:67], a[60:63], v[140:143]
  v_mfma_f32_16x16x32_bf16 v[128:131], v[68:71], a[64:67], v[128:131]
  ds_read_b64_tr_b16 v[64:65], v10 offset:64
  ds_read_b64_tr_b16 v[66:67], v10 offset:4672
  v_mfma_f32_16x16x32_bf16 v[132:135], v[68:71], a[68:71], v[132:135]
  v_mfma_f32_16x16x32_bf16 v[136:139], v[68:71], a[72:75], v[136:139]
  v_mfma_f32_16x16x32_bf16 v[140:143], v[68:71], a[76:79], v[140:143]
  s_waitcnt lgkmcnt(6)
  v_mfma_f32_16x16x32_bf16 v[128:131], v[48:51], a[80:83], v[128:131]
  ds_read_b64_tr_b16 v[68:69], v10 offset:9280
  ds_read_b64_tr_b16 v[70:71], v10 offset:13888
  v_mfma_f32_16x16x32_bf16 v[132:135], v[48:51], a[84:87], v[132:135]
  v_mfma_f32_16x16x32_bf16 v[136:139], v[48:51], a[88:91], v[136:139]
  v_mfma_f32_16x16x32_bf16 v[140:143], v[48:51], a[92:95], v[140:143]
  s_mov_b32 s68, 9216
  buffer_store_dwordx4 v[100:103], v16, s[28:31], s68 offen sc1
  v_mfma_f32_16x16x32_bf16 v[128:131], v[52:55], a[96:99], v[128:131]
  ds_read_b64_tr_b16 v[48:49], v10 offset:18496
  ds_read_b64_tr_b16 v[50:51], v10 offset:23104
  v_mfma_f32_16x16x32_bf16 v[132:135], v[52:55], a[100:103], v[132:135]
  v_mfma_f32_16x16x32_bf16 v[136:139], v[52:55], a[104:107], v[136:139]
  v_mfma_f32_16x16x32_bf16 v[140:143], v[52:55], a[108:111], v[140:143]
  s_waitcnt lgkmcnt(6)
  v_mfma_f32_16x16x32_bf16 v[128:131], v[56:59], a[112:115], v[128:131]
  ds_read_b64_tr_b16 v[52:53], v10 offset:27712
  ds_read_b64_tr_b16 v[54:55], v10 offset:32320
  v_mfma_f32_16x16x32_bf16 v[132:135], v[56:59], a[116:119], v[132:135]
  v_mfma_f32_16x16x32_bf16 v[136:139], v[56:59], a[120:123], v[136:139]
  v_mfma_f32_16x16x32_bf16 v[140:143], v[56:59], a[124:127], v[140:143]
  v_mfma_f32_16x16x32_bf16 v[128:131], v[60:63], a[128:131], v[128:131]
  ds_read_b64_tr_b16 v[56:57], v12 offset:18496
  ds_read_b64_tr_b16 v[58:59], v12 offset:23104
  v_mfma_f32_16x16x32_bf16 v[132:135], v[60:63], a[132:135], v[132:135]
  v_mfma_f32_16x16x32_bf16 v[136:139], v[60:63], a[136:139], v[136:139]
  v_mfma_f32_16x16x32_bf16 v[140:143], v[60:63], a[140:143], v[140:143]
  s_waitcnt lgkmcnt(6)
  v_mfma_f32_16x16x32_bf16 v[144:147], v[64:67], a[16:19], v[144:147]
  ds_read_b64_tr_b16 v[60:61], v12 offset:27712
  ds_read_b64_tr_b16 v[62:63], v12 offset:32320
  v_mfma_f32_16x16x32_bf16 v[148:151], v[64:67], a[20:23], v[148:151]
  v_mfma_f32_16x16x32_bf16 v[152:155], v[64:67], a[24:27], v[152:155]
  v_mfma_f32_16x16x32_bf16 v[156:159], v[64:67], a[28:31], v[156:159]
  v_cvt_pk_bf16_f32 v104, v128, v129
  v_cvt_pk_bf16_f32 v105, v130, v131
  v_mfma_f32_16x16x32_bf16 v[144:147], v[68:71], a[32:35], v[144:147]
  ds_read_b64_tr_b16 v[64:65], v10 offset:36928
  ds_read_b64_tr_b16 v[66:67], v10 offset:41536
  v_mfma_f32_16x16x32_bf16 v[148:151], v[68:71], a[36:39], v[148:151]
  v_cvt_pk_bf16_f32 v106, v132, v133
  v_cvt_pk_bf16_f32 v107, v134, v135
  v_mfma_f32_16x16x32_bf16 v[152:155], v[68:71], a[40:43], v[152:155]
  s_mov_b32 s68, 1024
  buffer_store_dwordx4 v[104:107], v16, s[28:31], s68 offen sc1
  v_mfma_f32_16x16x32_bf16 v[156:159], v[68:71], a[44:47], v[156:159]
  v_cvt_pk_bf16_f32 v108, v136, v137
  s_waitcnt lgkmcnt(6)
  v_mfma_f32_16x16x32_bf16 v[144:147], v[48:51], a[48:51], v[144:147]
  ds_read_b64_tr_b16 v[68:69], v10 offset:46144
  ds_read_b64_tr_b16 v[70:71], v10 offset:50752
  v_mfma_f32_16x16x32_bf16 v[148:151], v[48:51], a[52:55], v[148:151]
  v_cvt_pk_bf16_f32 v109, v138, v139
  v_cvt_pk_bf16_f32 v110, v140, v141
  v_mfma_f32_16x16x32_bf16 v[152:155], v[48:51], a[56:59], v[152:155]
  v_cvt_pk_bf16_f32 v111, v142, v143
  v_mfma_f32_16x16x32_bf16 v[156:159], v[48:51], a[60:63], v[156:159]
  v_mfma_f32_16x16x32_bf16 v[144:147], v[52:55], a[64:67], v[144:147]
  ds_read_b64_tr_b16 v[48:49], v10 offset:96
  ds_read_b64_tr_b16 v[50:51], v10 offset:4704
  v_mfma_f32_16x16x32_bf16 v[148:151], v[52:55], a[68:71], v[148:151]
  v_mfma_f32_16x16x32_bf16 v[152:155], v[52:55], a[72:75], v[152:155]
  v_mfma_f32_16x16x32_bf16 v[156:159], v[52:55], a[76:79], v[156:159]
  s_waitcnt lgkmcnt(6)
  v_mfma_f32_16x16x32_bf16 v[144:147], v[56:59], a[80:83], v[144:147]
  ds_read_b64_tr_b16 v[52:53], v10 offset:9312
  ds_read_b64_tr_b16 v[54:55], v10 offset:13920
  v_mfma_f32_16x16x32_bf16 v[148:151], v[56:59], a[84:87], v[148:151]
  v_mfma_f32_16x16x32_bf16 v[152:155], v[56:59], a[88:91], v[152:155]
  v_mfma_f32_16x16x32_bf16 v[156:159], v[56:59], a[92:95], v[156:159]
  s_mov_b32 s68, 10240
  buffer_store_dwordx4 v[108:111], v16, s[28:31], s68 offen sc1
  v_mfma_f32_16x16x32_bf16 v[144:147], v[60:63], a[96:99], v[144:147]
  ds_read_b64_tr_b16 v[56:57], v10 offset:18528
  ds_read_b64_tr_b16 v[58:59], v10 offset:23136
  v_mfma_f32_16x16x32_bf16 v[148:151], v[60:63], a[100:103], v[148:151]
  v_mfma_f32_16x16x32_bf16 v[152:155], v[60:63], a[104:107], v[152:155]
  v_mfma_f32_16x16x32_bf16 v[156:159], v[60:63], a[108:111], v[156:159]
  s_waitcnt lgkmcnt(6)
  v_mfma_f32_16x16x32_bf16 v[144:147], v[64:67], a[112:115], v[144:147]
  ds_read_b64_tr_b16 v[60:61], v10 offset:27744
  ds_read_b64_tr_b16 v[62:63], v10 offset:32352
  v_mfma_f32_16x16x32_bf16 v[148:151], v[64:67], a[116:119], v[148:151]
  v_mfma_f32_16x16x32_bf16 v[152:155], v[64:67], a[120:123], v[152:155]
  v_mfma_f32_16x16x32_bf16 v[156:159], v[64:67], a[124:127], v[156:159]
  v_mfma_f32_16x16x32_bf16 v[144:147], v[68:71], a[128:131], v[144:147]
  ds_read_b64_tr_b16 v[64:65], v12 offset:18528
  ds_read_b64_tr_b16 v[66:67], v12 offset:23136
  v_mfma_f32_16x16x32_bf16 v[148:151], v[68:71], a[132:135], v[148:151]
  v_mfma_f32_16x16x32_bf16 v[152:155], v[68:71], a[136:139], v[152:155]
  v_mfma_f32_16x16x32_bf16 v[156:159], v[68:71], a[140:143], v[156:159]
  s_waitcnt lgkmcnt(6)
  v_mfma_f32_16x16x32_bf16 v[160:163], v[48:51], a[16:19], v[160:163]
  ds_read_b64_tr_b16 v[68:69], v12 offset:27744
  ds_read_b64_tr_b16 v[70:71], v12 offset:32352
  v_mfma_f32_16x16x32_bf16 v[164:167], v[48:51], a[20:23], v[164:167]
  v_mfma_f32_16x16x32_bf16 v[168:171], v[48:51], a[24:27], v[168:171]
  v_mfma_f32_16x16x32_bf16 v[172:175], v[48:51], a[28:31], v[172:175]
  v_cvt_pk_bf16_f32 v96, v144, v145
  v_cvt_pk_bf16_f32 v97, v146, v147
  v_mfma_f32_16x16x32_bf16 v[160:163], v[52:55], a[32:35], v[160:163]
  ds_read_b64_tr_b16 v[48:49], v10 offset:36960
  ds_read_b64_tr_b16 v[50:51], v10 offset:41568
  v_mfma_f32_16x16x32_bf16 v[164:167], v[52:55], a[36:39], v[164:167]
  v_cvt_pk_bf16_f32 v98, v148, v149
  v_cvt_pk_bf16_f32 v99, v150, v151
  v_mfma_f32_16x16x32_bf16 v[168:171], v[52:55], a[40:43], v[168:171]
  s_mov_b32 s68, 2048
  buffer_store_dwordx4 v[96:99], v16, s[28:31], s68 offen sc1
  v_mfma_f32_16x16x32_bf16 v[172:175], v[52:55], a[44:47], v[172:175]
  v_cvt_pk_bf16_f32 v100, v152, v153
  s_waitcnt lgkmcnt(6)
  v_mfma_f32_16x16x32_bf16 v[160:163], v[56:59], a[48:51], v[160:163]
  ds_read_b64_tr_b16 v[52:53], v10 offset:46176
  ds_read_b64_tr_b16 v[54:55], v10 offset:50784
  v_mfma_f32_16x16x32_bf16 v[164:167], v[56:59], a[52:55], v[164:167]
  v_cvt_pk_bf16_f32 v101, v154, v155
  v_cvt_pk_bf16_f32 v102, v156, v157
  v_mfma_f32_16x16x32_bf16 v[168:171], v[56:59], a[56:59], v[168:171]
  v_cvt_pk_bf16_f32 v103, v158, v159
  v_mfma_f32_16x16x32_bf16 v[172:175], v[56:59], a[60:63], v[172:175]
  v_mfma_f32_16x16x32_bf16 v[160:163], v[60:63], a[64:67], v[160:163]
  ds_read_b64_tr_b16 v[56:57], v10 offset:128
  ds_read_b64_tr_b16 v[58:59], v10 offset:4736
  v_mfma_f32_16x16x32_bf16 v[164:167], v[60:63], a[68:71], v[164:167]
  v_mfma_f32_16x16x32_bf16 v[168:171], v[60:63], a[72:75], v[168:171]
  v_mfma_f32_16x16x32_bf16 v[172:175], v[60:63], a[76:79], v[172:175]
  s_waitcnt lgkmcnt(6)
  v_mfma_f32_16x16x32_bf16 v[160:163], v[64:67], a[80:83], v[160:163]
  ds_read_b64_tr_b16 v[60:61], v10 offset:9344
  ds_read_b64_tr_b16 v[62:63], v10 offset:13952
  v_mfma_f32_16x16x32_bf16 v[164:167], v[64:67], a[84:87], v[164:167]
  v_mfma_f32_16x16x32_bf16 v[168:171], v[64:67], a[88:91], v[168:171]
  v_mfma_f32_16x16x32_bf16 v[172:175], v[64:67], a[92:95], v[172:175]
  s_mov_b32 s68, 11264
  buffer_store_dwordx4 v[100:103], v16, s[28:31], s68 offen sc1
  v_mfma_f32_16x16x32_bf16 v[160:163], v[68:71], a[96:99], v[160:163]
  ds_read_b64_tr_b16 v[64:65], v10 offset:18560
  ds_read_b64_tr_b16 v[66:67], v10 offset:23168
  v_mfma_f32_16x16x32_bf16 v[164:167], v[68:71], a[100:103], v[164:167]
  v_mfma_f32_16x16x32_bf16 v[168:171], v[68:71], a[104:107], v[168:171]
  v_mfma_f32_16x16x32_bf16 v[172:175], v[68:71], a[108:111], v[172:175]
  s_waitcnt lgkmcnt(6)
  v_mfma_f32_16x16x32_bf16 v[160:163], v[48:51], a[112:115], v[160:163]
  ds_read_b64_tr_b16 v[68:69], v10 offset:27776
  ds_read_b64_tr_b16 v[70:71], v10 offset:32384
  v_mfma_f32_16x16x32_bf16 v[164:167], v[48:51], a[116:119], v[164:167]
  v_mfma_f32_16x16x32_bf16 v[168:171], v[48:51], a[120:123], v[168:171]
  v_mfma_f32_16x16x32_bf16 v[172:175], v[48:51], a[124:127], v[172:175]
  v_mfma_f32_16x16x32_bf16 v[160:163], v[52:55], a[128:131], v[160:163]
  ds_read_b64_tr_b16 v[48:49], v12 offset:18560
  ds_read_b64_tr_b16 v[50:51], v12 offset:23168
  v_mfma_f32_16x16x32_bf16 v[164:167], v[52:55], a[132:135], v[164:167]
  v_mfma_f32_16x16x32_bf16 v[168:171], v[52:55], a[136:139], v[168:171]
  v_mfma_f32_16x16x32_bf16 v[172:175], v[52:55], a[140:143], v[172:175]
  s_waitcnt lgkmcnt(6)
  v_mfma_f32_16x16x32_bf16 v[176:179], v[56:59], a[16:19], v[176:179]
  ds_read_b64_tr_b16 v[52:53], v12 offset:27776
  ds_read_b64_tr_b16 v[54:55], v12 offset:32384
  v_mfma_f32_16x16x32_bf16 v[180:183], v[56:59], a[20:23], v[180:183]
  v_mfma_f32_16x16x32_bf16 v[184:187], v[56:59], a[24:27], v[184:187]
  v_mfma_f32_16x16x32_bf16 v[188:191], v[56:59], a[28:31], v[188:191]
  v_cvt_pk_bf16_f32 v104, v160, v161
  v_cvt_pk_bf16_f32 v105, v162, v163
  v_mfma_f32_16x16x32_bf16 v[176:179], v[60:63], a[32:35], v[176:179]
  ds_read_b64_tr_b16 v[56:57], v10 offset:36992
  ds_read_b64_tr_b16 v[58:59], v10 offset:41600
  v_mfma_f32_16x16x32_bf16 v[180:183], v[60:63], a[36:39], v[180:183]
  v_cvt_pk_bf16_f32 v106, v164, v165
  v_cvt_pk_bf16_f32 v107, v166, v167
  v_mfma_f32_16x16x32_bf16 v[184:187], v[60:63], a[40:43], v[184:187]
  s_mov_b32 s68, 3072
  buffer_store_dwordx4 v[104:107], v16, s[28:31], s68 offen sc1
  v_mfma_f32_16x16x32_bf16 v[188:191], v[60:63], a[44:47], v[188:191]
  v_cvt_pk_bf16_f32 v108, v168, v169
  s_waitcnt lgkmcnt(6)
  v_mfma_f32_16x16x32_bf16 v[176:179], v[64:67], a[48:51], v[176:179]
  ds_read_b64_tr_b16 v[60:61], v10 offset:46208
  ds_read_b64_tr_b16 v[62:63], v10 offset:50816
  v_mfma_f32_16x16x32_bf16 v[180:183], v[64:67], a[52:55], v[180:183]
  v_cvt_pk_bf16_f32 v109, v170, v171
  v_cvt_pk_bf16_f32 v110, v172, v173
  v_mfma_f32_16x16x32_bf16 v[184:187], v[64:67], a[56:59], v[184:187]
  v_cvt_pk_bf16_f32 v111, v174, v175
  v_mfma_f32_16x16x32_bf16 v[188:191], v[64:67], a[60:63], v[188:191]
  v_mfma_f32_16x16x32_bf16 v[176:179], v[68:71], a[64:67], v[176:179]
  ds_read_b64_tr_b16 v[64:65], v10 offset:160
  ds_read_b64_tr_b16 v[66:67], v10 offset:4768
  v_mfma_f32_16x16x32_bf16 v[180:183], v[68:71], a[68:71], v[180:183]
  v_mfma_f32_16x16x32_bf16 v[184:187], v[68:71], a[72:75], v[184:187]
  v_mfma_f32_16x16x32_bf16 v[188:191], v[68:71], a[76:79], v[188:191]
  s_waitcnt lgkmcnt(6)
  v_mfma_f32_16x16x32_bf16 v[176:179], v[48:51], a[80:83], v[176:179]
  ds_read_b64_tr_b16 v[68:69], v10 offset:9376
  ds_read_b64_tr_b16 v[70:71], v10 offset:13984
  v_mfma_f32_16x16x32_bf16 v[180:183], v[48:51], a[84:87], v[180:183]
  v_mfma_f32_16x16x32_bf16 v[184:187], v[48:51], a[88:91], v[184:187]
  v_mfma_f32_16x16x32_bf16 v[188:191], v[48:51], a[92:95], v[188:191]
  s_mov_b32 s68, 12288
  buffer_store_dwordx4 v[108:111], v16, s[28:31], s68 offen sc1
  v_mfma_f32_16x16x32_bf16 v[176:179], v[52:55], a[96:99], v[176:179]
  ds_read_b64_tr_b16 v[48:49], v10 offset:18592
  ds_read_b64_tr_b16 v[50:51], v10 offset:23200
  v_mfma_f32_16x16x32_bf16 v[180:183], v[52:55], a[100:103], v[180:183]
  v_mfma_f32_16x16x32_bf16 v[184:187], v[52:55], a[104:107], v[184:187]
  v_mfma_f32_16x16x32_bf16 v[188:191], v[52:55], a[108:111], v[188:191]
  s_waitcnt lgkmcnt(6)
  v_mfma_f32_16x16x32_bf16 v[176:179], v[56:59], a[112:115], v[176:179]
  ds_read_b64_tr_b16 v[52:53], v10 offset:27808
  ds_read_b64_tr_b16 v[54:55], v10 offset:32416
  v_mfma_f32_16x16x32_bf16 v[180:183], v[56:59], a[116:119], v[180:183]
  v_mfma_f32_16x16x32_bf16 v[184:187], v[56:59], a[120:123], v[184:187]
  v_mfma_f32_16x16x32_bf16 v[188:191], v[56:59], a[124:127], v[188:191]
  v_mfma_f32_16x16x32_bf16 v[176:179], v[60:63], a[128:131], v[176:179]
  ds_read_b64_tr_b16 v[56:57], v12 offset:18592
  ds_read_b64_tr_b16 v[58:59], v12 offset:23200
  v_mfma_f32_16x16x32_bf16 v[180:183], v[60:63], a[132:135], v[180:183]
  v_mfma_f32_16x16x32_bf16 v[184:187], v[60:63], a[136:139], v[184:187]
  v_mfma_f32_16x16x32_bf16 v[188:191], v[60:63], a[140:143], v[188:191]
  s_waitcnt lgkmcnt(6)
  v_mfma_f32_16x16x32_bf16 v[192:195], v[64:67], a[16:19], v[192:195]
  ds_read_b64_tr_b16 v[60:61], v12 offset:27808
  ds_read_b64_tr_b16 v[62:63], v12 offset:32416
  v_mfma_f32_16x16x32_bf16 v[196:199], v[64:67], a[20:23], v[196:199]
  v_mfma_f32_16x16x32_bf16 v[200:203], v[64:67], a[24:27], v[200:203]
  v_mfma_f32_16x16x32_bf16 v[204:207], v[64:67], a[28:31], v[204:207]
  v_cvt_pk_bf16_f32 v96, v176, v177
  v_cvt_pk_bf16_f32 v97, v178, v179
  v_mfma_f32_16x16x32_bf16 v[192:195], v[68:71], a[32:35], v[192:195]
  ds_read_b64_tr_b16 v[64:65], v10 offset:37024
  ds_read_b64_tr_b16 v[66:67], v10 offset:41632
  v_mfma_f32_16x16x32_bf16 v[196:199], v[68:71], a[36:39], v[196:199]
  v_cvt_pk_bf16_f32 v98, v180, v181
  v_cvt_pk_bf16_f32 v99, v182, v183
  v_mfma_f32_16x16x32_bf16 v[200:203], v[68:71], a[40:43], v[200:203]
  s_mov_b32 s68, 4096
  buffer_store_dwordx4 v[96:99], v16, s[28:31], s68 offen sc1
  v_mfma_f32_16x16x32_bf16 v[204:207], v[68:71], a[44:47], v[204:207]
  v_cvt_pk_bf16_f32 v100, v184, v185
  s_waitcnt lgkmcnt(6)
  v_mfma_f32_16x16x32_bf16 v[192:195], v[48:51], a[48:51], v[192:195]
  ds_read_b64_tr_b16 v[68:69], v10 offset:46240
  ds_read_b64_tr_b16 v[70:71], v10 offset:50848
  v_mfma_f32_16x16x32_bf16 v[196:199], v[48:51], a[52:55], v[196:199]
  v_cvt_pk_bf16_f32 v101, v186, v187
  v_cvt_pk_bf16_f32 v102, v188, v189
  v_mfma_f32_16x16x32_bf16 v[200:203], v[48:51], a[56:59], v[200:203]
  v_cvt_pk_bf16_f32 v103, v190, v191
  v_mfma_f32_16x16x32_bf16 v[204:207], v[48:51], a[60:63], v[204:207]
  v_mfma_f32_16x16x32_bf16 v[192:195], v[52:55], a[64:67], v[192:195]
  ds_read_b64_tr_b16 v[48:49], v10 offset:192
  ds_read_b64_tr_b16 v[50:51], v10 offset:4800
  v_mfma_f32_16x16x32_bf16 v[196:199], v[52:55], a[68:71], v[196:199]
  v_mfma_f32_16x16x32_bf16 v[200:203], v[52:55], a[72:75], v[200:203]
  v_mfma_f32_16x16x32_bf16 v[204:207], v[52:55], a[76:79], v[204:207]
  s_waitcnt lgkmcnt(6)
  v_mfma_f32_16x16x32_bf16 v[192:195], v[56:59], a[80:83], v[192:195]
  ds_read_b64_tr_b16 v[52:53], v10 offset:9408
  ds_read_b64_tr_b16 v[54:55], v10 offset:14016
  v_mfma_f32_16x16x32_bf16 v[196:199], v[56:59], a[84:87], v[196:199]
  v_mfma_f32_16x16x32_bf16 v[200:203], v[56:59], a[88:91], v[200:203]
  v_mfma_f32_16x16x32_bf16 v[204:207], v[56:59], a[92:95], v[204:207]
  s_mov_b32 s68, 13312
  buffer_store_dwordx4 v[100:103], v16, s[28:31], s68 offen sc1
  v_mfma_f32_16x16x32_bf16 v[192:195], v[60:63], a[96:99], v[192:195]
  ds_read_b64_tr_b16 v[56:57], v10 offset:18624
  ds_read_b64_tr_b16 v[58:59], v10 offset:23232
  v_mfma_f32_16x16x32_bf16 v[196:199], v[60:63], a[100:103], v[196:199]
  v_mfma_f32_16x16x32_bf16 v[200:203], v[60:63], a[104:107], v[200:203]
  v_mfma_f32_16x16x32_bf16 v[204:207], v[60:63], a[108:111], v[204:207]
  s_waitcnt lgkmcnt(6)
  v_mfma_f32_16x16x32_bf16 v[192:195], v[64:67], a[112:115], v[192:195]
  ds_read_b64_tr_b16 v[60:61], v10 offset:27840
  ds_read_b64_tr_b16 v[62:63], v10 offset:32448
  v_mfma_f32_16x16x32_bf16 v[196:199], v[64:67], a[116:119], v[196:199]
  v_mfma_f32_16x16x32_bf16 v[200:203], v[64:67], a[120:123], v[200:203]
  v_mfma_f32_16x16x32_bf16 v[204:207], v[64:67], a[124:127], v[204:207]
  v_mfma_f32_16x16x32_bf16 v[192:195], v[68:71], a[128:131], v[192:195]
  ds_read_b64_tr_b16 v[64:65], v12 offset:18624
  ds_read_b64_tr_b16 v[66:67], v12 offset:23232
  v_mfma_f32_16x16x32_bf16 v[196:199], v[68:71], a[132:135], v[196:199]
  s_waitcnt vmcnt(2)
  s_barrier
  v_mfma_f32_16x16x32_bf16 v[200:203], v[68:71], a[136:139], v[200:203]
  v_mov_b32 v75, s100
  buffer_store_dword v75, v77, s[96:99], 0 offen offset:512 sc1
  v_mfma_f32_16x16x32_bf16 v[204:207], v[68:71], a[140:143], v[204:207]
  s_waitcnt lgkmcnt(6)
  v_mfma_f32_16x16x32_bf16 v[208:211], v[48:51], a[16:19], v[208:211]
  ds_read_b64_tr_b16 v[68:69], v12 offset:27840
  ds_read_b64_tr_b16 v[70:71], v12 offset:32448
  v_mfma_f32_16x16x32_bf16 v[212:215], v[48:51], a[20:23], v[212:215]
  v_mfma_f32_16x16x32_bf16 v[216:219], v[48:51], a[24:27], v[216:219]
  v_mfma_f32_16x16x32_bf16 v[220:223], v[48:51], a[28:31], v[220:223]
  v_cvt_pk_bf16_f32 v104, v192, v193
  v_cvt_pk_bf16_f32 v105, v194, v195
  v_mfma_f32_16x16x32_bf16 v[208:211], v[52:55], a[32:35], v[208:211]
  ds_read_b64_tr_b16 v[48:49], v10 offset:37056
  ds_read_b64_tr_b16 v[50:51], v10 offset:41664
  v_mfma_f32_16x16x32_bf16 v[212:215], v[52:55], a[36:39], v[212:215]
  v_cvt_pk_bf16_f32 v106, v196, v197
  v_cvt_pk_bf16_f32 v107, v198, v199
  v_mfma_f32_16x16x32_bf16 v[216:219], v[52:55], a[40:43], v[216:219]
  s_mov_b32 s68, 5120
  buffer_store_dwordx4 v[104:107], v16, s[28:31], s68 offen sc1
  v_mfma_f32_16x16x32_bf16 v[220:223], v[52:55], a[44:47], v[220:223]
  v_cvt_pk_bf16_f32 v108, v200, v201
  s_waitcnt lgkmcnt(6)
  v_mfma_f32_16x16x32_bf16 v[208:211], v[56:59], a[48:51], v[208:211]
  ds_read_b64_tr_b16 v[52:53], v10 offset:46272
  ds_read_b64_tr_b16 v[54:55], v10 offset:50880
  v_mfma_f32_16x16x32_bf16 v[212:215], v[56:59], a[52:55], v[212:215]
  v_cvt_pk_bf16_f32 v109, v202, v203
  v_cvt_pk_bf16_f32 v110, v204, v205
  v_mfma_f32_16x16x32_bf16 v[216:219], v[56:59], a[56:59], v[216:219]
  v_cvt_pk_bf16_f32 v111, v206, v207
  v_mfma_f32_16x16x32_bf16 v[220:223], v[56:59], a[60:63], v[220:223]
  v_mfma_f32_16x16x32_bf16 v[208:211], v[60:63], a[64:67], v[208:211]
  ds_read_b64_tr_b16 v[56:57], v10 offset:224
  ds_read_b64_tr_b16 v[58:59], v10 offset:4832
  v_mfma_f32_16x16x32_bf16 v[212:215], v[60:63], a[68:71], v[212:215]
  v_mfma_f32_16x16x32_bf16 v[216:219], v[60:63], a[72:75], v[216:219]
  v_mfma_f32_16x16x32_bf16 v[220:223], v[60:63], a[76:79], v[220:223]
  s_waitcnt lgkmcnt(6)
  v_mfma_f32_16x16x32_bf16 v[208:211], v[64:67], a[80:83], v[208:211]
  ds_read_b64_tr_b16 v[60:61], v10 offset:9440
  ds_read_b64_tr_b16 v[62:63], v10 offset:14048
  v_mfma_f32_16x16x32_bf16 v[212:215], v[64:67], a[84:87], v[212:215]
  v_mfma_f32_16x16x32_bf16 v[216:219], v[64:67], a[88:91], v[216:219]
  v_mfma_f32_16x16x32_bf16 v[220:223], v[64:67], a[92:95], v[220:223]
  s_mov_b32 s68, 14336
  buffer_store_dwordx4 v[108:111], v16, s[28:31], s68 offen sc1
  v_mfma_f32_16x16x32_bf16 v[208:211], v[68:71], a[96:99], v[208:211]
  ds_read_b64_tr_b16 v[64:65], v10 offset:18656
  ds_read_b64_tr_b16 v[66:67], v10 offset:23264
  v_mfma_f32_16x16x32_bf16 v[212:215], v[68:71], a[100:103], v[212:215]
  v_mfma_f32_16x16x32_bf16 v[216:219], v[68:71], a[104:107], v[216:219]
  v_mfma_f32_16x16x32_bf16 v[220:223], v[68:71], a[108:111], v[220:223]
  s_waitcnt lgkmcnt(6)
  v_mfma_f32_16x16x32_bf16 v[208:211], v[48:51], a[112:115], v[208:211]
  ds_read_b64_tr_b16 v[68:69], v10 offset:27872
  ds_read_b64_tr_b16 v[70:71], v10 offset:32480
  v_mfma_f32_16x16x32_bf16 v[212:215], v[48:51], a[116:119], v[212:215]
  v_mfma_f32_16x16x32_bf16 v[216:219], v[48:51], a[120:123], v[216:219]
  v_mfma_f32_16x16x32_bf16 v[220:223], v[48:51], a[124:127], v[220:223]
  v_mfma_f32_16x16x32_bf16 v[208:211], v[52:55], a[128:131], v[208:211]
  ds_read_b64_tr_b16 v[48:49], v12 offset:18656
  ds_read_b64_tr_b16 v[50:51], v12 offset:23264
  v_mfma_f32_16x16x32_bf16 v[212:215], v[52:55], a[132:135], v[212:215]
  v_mfma_f32_16x16x32_bf16 v[216:219], v[52:55], a[136:139], v[216:219]
  v_mfma_f32_16x16x32_bf16 v[220:223], v[52:55], a[140:143], v[220:223]
  s_waitcnt lgkmcnt(6)
  v_mfma_f32_16x16x32_bf16 v[224:227], v[56:59], a[16:19], v[224:227]
  ds_read_b64_tr_b16 v[52:53], v12 offset:27872
  ds_read_b64_tr_b16 v[54:55], v12 offset:32480
  v_mfma_f32_16x16x32_bf16 v[228:231], v[56:59], a[20:23], v[228:231]
  v_mfma_f32_16x16x32_bf16 v[232:235], v[56:59], a[24:27], v[232:235]
  v_mfma_f32_16x16x32_bf16 v[236:239], v[56:59], a[28:31], v[236:239]
  v_cvt_pk_bf16_f32 v96, v208, v209
  v_cvt_pk_bf16_f32 v97, v210, v211
  v_mfma_f32_16x16x32_bf16 v[224:227], v[60:63], a[32:35], v[224:227]
  ds_read_b64_tr_b16 v[56:57], v10 offset:37088
  ds_read_b64_tr_b16 v[58:59], v10 offset:41696
  v_mfma_f32_16x16x32_bf16 v[228:231], v[60:63], a[36:39], v[228:231]
  v_cvt_pk_bf16_f32 v98, v212, v213
  v_cvt_pk_bf16_f32 v99, v214, v215
  v_mfma_f32_16x16x32_bf16 v[232:235], v[60:63], a[40:43], v[232:235]
  s_mov_b32 s68, 6144
  buffer_store_dwordx4 v[96:99], v16, s[28:31], s68 offen sc1
  v_mfma_f32_16x16x32_bf16 v[236:239], v[60:63], a[44:47], v[236:239]
  v_cvt_pk_bf16_f32 v100, v216, v217
  s_waitcnt lgkmcnt(6)
  v_mfma_f32_16x16x32_bf16 v[224:227], v[64:67], a[48:51], v[224:227]
  ds_read_b64_tr_b16 v[60:61], v10 offset:46304
  ds_read_b64_tr_b16 v[62:63], v10 offset:50912
  v_mfma_f32_16x16x32_bf16 v[228:231], v[64:67], a[52:55], v[228:231]
  v_cvt_pk_bf16_f32 v101, v218, v219
  v_cvt_pk_bf16_f32 v102, v220, v221
  v_mfma_f32_16x16x32_bf16 v[232:235], v[64:67], a[56:59], v[232:235]
  v_cvt_pk_bf16_f32 v103, v222, v223
  v_mfma_f32_16x16x32_bf16 v[236:239], v[64:67], a[60:63], v[236:239]
  v_mfma_f32_16x16x32_bf16 v[224:227], v[68:71], a[64:67], v[224:227]
  ds_read_b64_tr_b16 v[64:65], v10 offset:256
  ds_read_b64_tr_b16 v[66:67], v10 offset:4864
  v_mfma_f32_16x16x32_bf16 v[228:231], v[68:71], a[68:71], v[228:231]
  v_mfma_f32_16x16x32_bf16 v[232:235], v[68:71], a[72:75], v[232:235]
  v_mfma_f32_16x16x32_bf16 v[236:239], v[68:71], a[76:79], v[236:239]
  s_waitcnt lgkmcnt(6)
  v_mfma_f32_16x16x32_bf16 v[224:227], v[48:51], a[80:83], v[224:227]
  ds_read_b64_tr_b16 v[68:69], v10 offset:9472
  ds_read_b64_tr_b16 v[70:71], v10 offset:14080
  v_mfma_f32_16x16x32_bf16 v[228:231], v[48:51], a[84:87], v[228:231]
  v_mfma_f32_16x16x32_bf16 v[232:235], v[48:51], a[88:91], v[232:235]
  v_mfma_f32_16x16x32_bf16 v[236:239], v[48:51], a[92:95], v[236:239]
  s_mov_b32 s68, 15360
  buffer_store_dwordx4 v[100:103], v16, s[28:31], s68 offen sc1
  v_mfma_f32_16x16x32_bf16 v[224:227], v[52:55], a[96:99], v[224:227]
  ds_read_b64_tr_b16 v[48:49], v10 offset:18688
  ds_read_b64_tr_b16 v[50:51], v10 offset:23296
  v_mfma_f32_16x16x32_bf16 v[228:231], v[52:55], a[100:103], v[228:231]
  v_mfma_f32_16x16x32_bf16 v[232:235], v[52:55], a[104:107], v[232:235]
  v_mfma_f32_16x16x32_bf16 v[236:239], v[52:55], a[108:111], v[236:239]
  s_waitcnt lgkmcnt(6)
  v_mfma_f32_16x16x32_bf16 v[224:227], v[56:59], a[112:115], v[224:227]
  ds_read_b64_tr_b16 v[52:53], v10 offset:27904
  ds_read_b64_tr_b16 v[54:55], v10 offset:32512
  v_mfma_f32_16x16x32_bf16 v[228:231], v[56:59], a[116:119], v[228:231]
  v_mfma_f32_16x16x32_bf16 v[232:235], v[56:59], a[120:123], v[232:235]
  v_mfma_f32_16x16x32_bf16 v[236:239], v[56:59], a[124:127], v[236:239]
  v_mfma_f32_16x16x32_bf16 v[224:227], v[60:63], a[128:131], v[224:227]
  ds_read_b64_tr_b16 v[56:57], v12 offset:18688
  ds_read_b64_tr_b16 v[58:59], v12 offset:23296
  v_mfma_f32_16x16x32_bf16 v[228:231], v[60:63], a[132:135], v[228:231]
  v_mfma_f32_16x16x32_bf16 v[232:235], v[60:63], a[136:139], v[232:235]
  v_mfma_f32_16x16x32_bf16 v[236:239], v[60:63], a[140:143], v[236:239]
  s_waitcnt lgkmcnt(6)
  v_mfma_f32_16x16x32_bf16 v[240:243], v[64:67], a[16:19], v[240:243]
  ds_read_b64_tr_b16 v[60:61], v12 offset:27904
  ds_read_b64_tr_b16 v[62:63], v12 offset:32512
  v_mfma_f32_16x16x32_bf16 v[244:247], v[64:67], a[20:23], v[244:247]
  v_mfma_f32_16x16x32_bf16 v[248:251], v[64:67], a[24:27], v[248:251]
  v_mfma_f32_16x16x32_bf16 v[252:255], v[64:67], a[28:31], v[252:255]
  v_cvt_pk_bf16_f32 v104, v224, v225
  v_cvt_pk_bf16_f32 v105, v226, v227
  v_mfma_f32_16x16x32_bf16 v[240:243], v[68:71], a[32:35], v[240:243]
  ds_read_b64_tr_b16 v[64:65], v10 offset:37120
  ds_read_b64_tr_b16 v[66:67], v10 offset:41728
  v_mfma_f32_16x16x32_bf16 v[244:247], v[68:71], a[36:39], v[244:247]
  v_cvt_pk_bf16_f32 v106, v228, v229
  v_cvt_pk_bf16_f32 v107, v230, v231
  v_mfma_f32_16x16x32_bf16 v[248:251], v[68:71], a[40:43], v[248:251]
  s_mov_b32 s68, 7168
  buffer_store_dwordx4 v[104:107], v16, s[28:31], s68 offen sc1
  v_mfma_f32_16x16x32_bf16 v[252:255], v[68:71], a[44:47], v[252:255]
  v_cvt_pk_bf16_f32 v108, v232, v233
  s_waitcnt lgkmcnt(6)
  v_mfma_f32_16x16x32_bf16 v[240:243], v[48:51], a[48:51], v[240:243]
  ds_read_b64_tr_b16 v[68:69], v10 offset:46336
  ds_read_b64_tr_b16 v[70:71], v10 offset:50944
  v_mfma_f32_16x16x32_bf16 v[244:247], v[48:51], a[52:55], v[244:247]
  v_cvt_pk_bf16_f32 v109, v234, v235
  v_cvt_pk_bf16_f32 v110, v236, v237
  v_mfma_f32_16x16x32_bf16 v[248:251], v[48:51], a[56:59], v[248:251]
  v_cvt_pk_bf16_f32 v111, v238, v239
  v_mfma_f32_16x16x32_bf16 v[252:255], v[48:51], a[60:63], v[252:255]
  v_mfma_f32_16x16x32_bf16 v[240:243], v[52:55], a[64:67], v[240:243]
  v_mfma_f32_16x16x32_bf16 v[244:247], v[52:55], a[68:71], v[244:247]
  v_mfma_f32_16x16x32_bf16 v[248:251], v[52:55], a[72:75], v[248:251]
  v_mfma_f32_16x16x32_bf16 v[252:255], v[52:55], a[76:79], v[252:255]
  s_waitcnt lgkmcnt(4)
  v_mfma_f32_16x16x32_bf16 v[240:243], v[56:59], a[80:83], v[240:243]
  buffer_load_dword v74, v79, s[96:99], 0 offen offset:512 sc1
  v_mfma_f32_16x16x32_bf16 v[244:247], v[56:59], a[84:87], v[244:247]
  v_mfma_f32_16x16x32_bf16 v[248:251], v[56:59], a[88:91], v[248:251]
  v_mfma_f32_16x16x32_bf16 v[252:255], v[56:59], a[92:95], v[252:255]
  s_mov_b32 s68, 16384
  buffer_store_dwordx4 v[108:111], v16, s[28:31], s68 offen sc1
  v_mfma_f32_16x16x32_bf16 v[240:243], v[60:63], a[96:99], v[240:243]
  v_mfma_f32_16x16x32_bf16 v[244:247], v[60:63], a[100:103], v[244:247]
  v_mfma_f32_16x16x32_bf16 v[248:251], v[60:63], a[104:107], v[248:251]
  v_mfma_f32_16x16x32_bf16 v[252:255], v[60:63], a[108:111], v[252:255]
  s_waitcnt lgkmcnt(0)
  v_mfma_f32_16x16x32_bf16 v[240:243], v[64:67], a[112:115], v[240:243]
  v_mfma_f32_16x16x32_bf16 v[244:247], v[64:67], a[116:119], v[244:247]
  v_mfma_f32_16x16x32_bf16 v[248:251], v[64:67], a[120:123], v[248:251]
  v_mfma_f32_16x16x32_bf16 v[252:255], v[64:67], a[124:127], v[252:255]
  v_mfma_f32_16x16x32_bf16 v[240:243], v[68:71], a[128:131], v[240:243]
  v_mfma_f32_16x16x32_bf16 v[244:247], v[68:71], a[132:135], v[244:247]
  v_mfma_f32_16x16x32_bf16 v[248:251], v[68:71], a[136:139], v[248:251]
  v_mfma_f32_16x16x32_bf16 v[252:255], v[68:71], a[140:143], v[252:255]
  s_nop 4
  v_cvt_pk_bf16_f32 v96, v240, v241
  v_cvt_pk_bf16_f32 v97, v242, v243
  v_cvt_pk_bf16_f32 v98, v244, v245
  v_cvt_pk_bf16_f32 v99, v246, v247
  s_mov_b32 s68, 8192
  buffer_store_dwordx4 v[96:99], v16, s[28:31], s68 offen sc1
  v_cvt_pk_bf16_f32 v100, v248, v249
  v_cvt_pk_bf16_f32 v101, v250, v251
  v_cvt_pk_bf16_f32 v102, v252, v253
  v_cvt_pk_bf16_f32 v103, v254, v255
  s_mov_b32 s68, 17408
  buffer_store_dwordx4 v[100:103], v16, s[28:31], s68 offen sc1
  s_branch L_p2_done
L_gpath:
  s_waitcnt lgkmcnt(4)
  v_mfma_f32_16x16x32_bf16 v[112:115], v[48:51], a[144:147], 0
  ds_read_b64_tr_b16 v[64:65], v11 offset:128
  ds_read_b64_tr_b16 v[66:67], v11 offset:4736
  v_mfma_f32_16x16x32_bf16 v[116:119], v[48:51], a[148:151], 0
  ds_read_b64_tr_b16 v[68:69], v11 offset:160
  ds_read_b64_tr_b16 v[70:71], v11 offset:4768
  v_mfma_f32_16x16x32_bf16 v[120:123], v[48:51], a[152:155], 0
  v_accvgpr_read_b32 v80, a64
  v_accvgpr_read_b32 v81, a65
  v_mfma_f32_16x16x32_bf16 v[124:127], v[48:51], a[156:159], 0
  v_accvgpr_read_b32 v82, a66
  v_accvgpr_read_b32 v83, a67
  v_mfma_f32_16x16x32_bf16 v[128:131], v[52:55], a[144:147], 0
  ds_read_b64_tr_b16 v[48:49], v11 offset:192
  ds_read_b64_tr_b16 v[50:51], v11 offset:4800
  v_mfma_f32_16x16x32_bf16 v[132:135], v[52:55], a[148:151], 0
  v_accvgpr_read_b32 v84, a80
  v_accvgpr_read_b32 v85, a81
  v_mfma_f32_16x16x32_bf16 v[136:139], v[52:55], a[152:155], 0
  v_accvgpr_read_b32 v86, a82
  v_accvgpr_read_b32 v87, a83
  v_mfma_f32_16x16x32_bf16 v[140:143], v[52:55], a[156:159], 0
  v_mul_f32 v80, v80, v40
  s_waitcnt lgkmcnt(6)
  v_mfma_f32_16x16x32_bf16 v[144:147], v[56:59], a[144:147], 0
  ds_read_b64_tr_b16 v[52:53], v11 offset:224
  ds_read_b64_tr_b16 v[54:55], v11 offset:4832
  v_mfma_f32_16x16x32_bf16 v[148:151], v[56:59], a[148:151], 0
  v_mul_f32 v81, v81, v40
  v_mul_f32 v82, v82, v40
  v_mfma_f32_16x16x32_bf16 v[152:155], v[56:59], a[152:155], 0
  v_mul_f32 v83, v83, v40
  v_mul_f32 v84, v84, v40
  v_mfma_f32_16x16x32_bf16 v[156:159], v[56:59], a[156:159], 0
  v_mul_f32 v85, v85, v40
  v_mul_f32 v86, v86, v40
  v_mfma_f32_16x16x32_bf16 v[160:163], v[60:63], a[144:147], 0
  ds_read_b64_tr_b16 v[56:57], v11 offset:256
  ds_read_b64_tr_b16 v[58:59], v11 offset:4864
  v_mfma_f32_16x16x32_bf16 v[164:167], v[60:63], a[148:151], 0
  v_mul_f32 v87, v87, v40
  v_cvt_pk_bf16_f32 v80, v80, v81
  v_mfma_f32_16x16x32_bf16 v[168:171], v[60:63], a[152:155], 0
  s_mov_b32 exec_hi, 0
  buffer_load_dword v73, v14, s[16:19], s77 offen sc1
  s_mov_b32 exec_hi, -1
  v_mfma_f32_16x16x32_bf16 v[172:175], v[60:63], a[156:159], 0
  v_cvt_pk_bf16_f32 v81, v82, v83
  s_waitcnt lgkmcnt(6)
  v_mfma_f32_16x16x32_bf16 v[176:179], v[64:67], a[144:147], 0
  ds_read_b64_tr_b16 v[60:61], v11 offset:9216
  ds_read_b64_tr_b16 v[62:63], v11 offset:13824
  v_mfma_f32_16x16x32_bf16 v[180:183], v[64:67], a[148:151], 0
  s_mov_b32 exec_hi, 0
  buffer_load_dword v73, v14, s[16:19], s78 offen sc1
  s_mov_b32 exec_hi, -1
  v_mfma_f32_16x16x32_bf16 v[184:187], v[64:67], a[152:155], 0
  v_cvt_pk_bf16_f32 v82, v84, v85
  v_cvt_pk_bf16_f32 v83, v86, v87
  v_mfma_f32_16x16x32_bf16 v[188:191], v[64:67], a[156:159], 0
  v_accvgpr_read_b32 v84, a68
  v_accvgpr_read_b32 v85, a69
  v_mfma_f32_16x16x32_bf16 v[192:195], v[68:71], a[144:147], 0
  ds_read_b64_tr_b16 v[64:65], v11 offset:9248
  ds_read_b64_tr_b16 v[66:67], v11 offset:13856
  v_mfma_f32_16x16x32_bf16 v[196:199], v[68:71], a[148:151], 0
  v_accvgpr_read_b32 v86, a70
  v_accvgpr_read_b32 v87, a71
  v_mfma_f32_16x16x32_bf16 v[200:203], v[68:71], a[152:155], 0
  v_accvgpr_read_b32 v88, a84
  v_accvgpr_read_b32 v89, a85
  v_mfma_f32_16x16x32_bf16 v[204:207], v[68:71], a[156:159], 0
  v_accvgpr_read_b32 v90, a86
  s_waitcnt lgkmcnt(6)
  v_mfma_f32_16x16x32_bf16 v[208:211], v[48:51], a[144:147], 0
  ds_read_b64_tr_b16 v[68:69], v11 offset:9280
  ds_read_b64_tr_b16 v[70:71], v11 offset:13888
  v_mfma_f32_16x16x32_bf16 v[212:215], v[48:51], a[148:151], 0
  v_accvgpr_read_b32 v91, a87
  v_mul_f32 v84, v84, v41
  v_mfma_f32_16x16x32_bf16 v[216:219], v[48:51], a[152:155], 0
  v_mul_f32 v85, v85, v41
  v_mul_f32 v86, v86, v41
  v_mfma_f32_16x16x32_bf16 v[220:223], v[48:51], a[156:159], 0
  v_mul_f32 v87, v87, v41
  v_mul_f32 v88, v88, v41
  v_mfma_f32_16x16x32_bf16 v[224:227], v[52:55], a[144:147], 0
  ds_read_b64_tr_b16 v[48:49], v11 offset:9312
  ds_read_b64_tr_b16 v[50:51], v11 offset:13920
  v_mfma_f32_16x16x32_bf16 v[228:231], v[52:55], a[148:151], 0
  v_mul_f32 v89, v89, v41
  v_mul_f32 v90, v90, v41
  v_mfma_f32_16x16x32_bf16 v[232:235], v[52:55], a[152:155], 0
  v_mul_f32 v91, v91, v41
  v_cvt_pk_bf16_f32 v84, v84, v85
  v_mfma_f32_16x16x32_bf16 v[236:239], v[52:55], a[156:159], 0
  v_cvt_pk_bf16_f32 v85, v86, v87
  s_waitcnt lgkmcnt(6)
  v_mfma_f32_16x16x32_bf16 v[240:243], v[56:59], a[144:147], 0
  ds_read_b64_tr_b16 v[52:53], v11 offset:9344
  ds_read_b64_tr_b16 v[54:55], v11 offset:13952
  v_mfma_f32_16x16x32_bf16 v[244:247], v[56:59], a[148:151], 0
  v_cvt_pk_bf16_f32 v86, v88, v89
  v_cvt_pk_bf16_f32 v87, v90, v91
  v_mfma_f32_16x16x32_bf16 v[248:251], v[56:59], a[152:155], 0
  v_accvgpr_read_b32 v88, a72
  v_accvgpr_read_b32 v89, a73
  v_mfma_f32_16x16x32_bf16 v[252:255], v[56:59], a[156:159], 0
  v_accvgpr_read_b32 v90, a74
  v_accvgpr_read_b32 v91, a75
  v_mfma_f32_16x16x32_bf16 v[112:115], v[60:63], a[160:163], v[112:115]
  ds_read_b64_tr_b16 v[56:57], v11 offset:9376
  ds_read_b64_tr_b16 v[58:59], v11 offset:13984
  v_mfma_f32_16x16x32_bf16 v[116:119], v[60:63], a[164:167], v[116:119]
  v_accvgpr_read_b32 v92, a88
  v_accvgpr_read_b32 v93, a89
  v_mfma_f32_16x16x32_bf16 v[120:123], v[60:63], a[168:171], v[120:123]
  v_accvgpr_read_b32 v94, a90
  v_accvgpr_read_b32 v95, a91
  v_mfma_f32_16x16x32_bf16 v[124:127], v[60:63], a[172:175], v[124:127]
  v_mul_f32 v88, v88, v42
  s_waitcnt lgkmcnt(6)
  v_mfma_f32_16x16x32_bf16 v[128:131], v[64:67], a[160:163], v[128:131]
  s_waitcnt vmcnt(2)
  s_barrier
  v_mfma_f32_16x16x32_bf16 v[132:135], v[64:67], a[164:167], v[132:135]
  v_mov_b32 v75, s100
  buffer_store_dword v75, v77, s[96:99], 0 offen offset:384 sc1
  v_mfma_f32_16x16x32_bf16 v[136:139], v[64:67], a[168:171], v[136:139]
  ds_read_b64_tr_b16 v[60:61], v11 offset:9408
  ds_read_b64_tr_b16 v[62:63], v11 offset:14016
  v_mfma_f32_16x16x32_bf16 v[140:143], v[64:67], a[172:175], v[140:143]
  v_mul_f32 v89, v89, v42
  v_mul_f32 v90, v90, v42
  v_mfma_f32_16x16x32_bf16 v[144:147], v[68:71], a[160:163], v[144:147]
  ds_read_b64_tr_b16 v[64:65], v11 offset:9440
  ds_read_b64_tr_b16 v[66:67], v11 offset:14048
  v_mfma_f32_16x16x32_bf16 v[148:151], v[68:71], a[164:167], v[148:151]
  v_mul_f32 v91, v91, v42
  v_mul_f32 v92, v92, v42
  v_mfma_f32_16x16x32_bf16 v[152:155], v[68:71], a[168:171], v[152:155]
  v_mul_f32 v93, v93, v42
  v_mul_f32 v94, v94, v42
  v_mfma_f32_16x16x32_bf16 v[156:159], v[68:71], a[172:175], v[156:159]
  v_mul_f32 v95, v95, v42
  s_waitcnt lgkmcnt(6)
  v_mfma_f32_16x16x32_bf16 v[160:163], v[48:51], a[160:163], v[160:163]
  ds_read_b64_tr_b16 v[68:69], v11 offset:9472
  ds_read_b64_tr_b16 v[70:71], v11 offset:14080
  v_mfma_f32_16x16x32_bf16 v[164:167], v[48:51], a[164:167], v[164:167]
  v_cvt_pk_bf16_f32 v88, v88, v89
  v_cvt_pk_bf16_f32 v89, v90, v91
  v_mfma_f32_16x16x32_bf16 v[168:171], v[48:51], a[168:171], v[168:171]
  v_cvt_pk_bf16_f32 v90, v92, v93
  v_cvt_pk_bf16_f32 v91, v94, v95
  v_mfma_f32_16x16x32_bf16 v[172:175], v[48:51], a[172:175], v[172:175]
  v_accvgpr_read_b32 v92, a76
  v_accvgpr_read_b32 v93, a77
  v_mfma_f32_16x16x32_bf16 v[176:179], v[52:55], a[160:163], v[176:179]
  ds_read_b64_tr_b16 v[48:49], v11 offset:18432
  ds_read_b64_tr_b16 v[50:51], v11 offset:23040
  v_mfma_f32_16x16x32_bf16 v[180:183], v[52:55], a[164:167], v[180:183]
  v_accvgpr_read_b32 v94, a78
  v_accvgpr_read_b32 v95, a79
  v_mfma_f32_16x16x32_bf16 v[184:187], v[52:55], a[168:171], v[184:187]
  v_accvgpr_read_b32 v96, a92
  v_accvgpr_read_b32 v97, a93
  v_mfma_f32_16x16x32_bf16 v[188:191], v[52:55], a[172:175], v[188:191]
  v_accvgpr_read_b32 v98, a94
  s_waitcnt lgkmcnt(6)
  v_mfma_f32_16x16x32_bf16 v[192:195], v[56:59], a[160:163], v[192:195]
  ds_read_b64_tr_b16 v[52:53], v11 offset:18464
  ds_read_b64_tr_b16 v[54:55], v11 offset:23072
  v_mfma_f32_16x16x32_bf16 v[196:199], v[56:59], a[164:167], v[196:199]
  v_accvgpr_read_b32 v99, a95
  v_mul_f32 v92, v92, v43
  v_mfma_f32_16x16x32_bf16 v[200:203], v[56:59], a[168:171], v[200:203]
  v_mul_f32 v93, v93, v43
  v_mul_f32 v94, v94, v43
  v_mfma_f32_16x16x32_bf16 v[204:207], v[56:59], a[172:175], v[204:207]
  v_mul_f32 v95, v95, v43
  v_mul_f32 v96, v96, v43
  v_mfma_f32_16x16x32_bf16 v[208:211], v[60:63], a[160:163], v[208:211]
  s_add_u32 m0, s41, 0
  ds_read_b64_tr_b16 v[56:57], v11 offset:18496
  v_mfma_f32_16x16x32_bf16 v[212:215], v[60:63], a[164:167], v[212:215]
  ds_read_b64_tr_b16 v[58:59], v11 offset:23104
  v_mul_f32 v97, v97, v43
  v_mfma_f32_16x16x32_bf16 v[216:219], v[60:63], a[168:171], v[216:219]
  v_mul_f32 v98, v98, v43
  v_mul_f32 v99, v99, v43
  v_mfma_f32_16x16x32_bf16 v[220:223], v[60:63], a[172:175], v[220:223]
  v_cvt_pk_bf16_f32 v92, v92, v93
  s_waitcnt lgkmcnt(6)
  v_mfma_f32_16x16x32_bf16 v[224:227], v[64:67], a[160:163], v[224:227]
  ds_read_b64_tr_b16 v[60:61], v11 offset:18528
  ds_read_b64_tr_b16 v[62:63], v11 offset:23136
  v_mfma_f32_16x16x32_bf16 v[228:231], v[64:67], a[164:167], v[228:231]
  buffer_load_dwordx4 v1, s[8:11], s87 offen offset:0 lds
  v_mfma_f32_16x16x32_bf16 v[232:235], v[64:67], a[168:171], v[232:235]
  v_cvt_pk_bf16_f32 v93, v94, v95
  v_cvt_pk_bf16_f32 v94, v96, v97
  v_mfma_f32_16x16x32_bf16 v[236:239], v[64:67], a[172:175], v[236:239]
  v_cvt_pk_bf16_f32 v95, v98, v99
  v_accvgpr_read_b32 v96, a96
  v_mfma_f32_16x16x32_bf16 v[240:243], v[68:71], a[160:163], v[240:243]
  ds_read_b64_tr_b16 v[64:65], v11 offset:18560
  ds_read_b64_tr_b16 v[66:67], v11 offset:23168
  v_mfma_f32_16x16x32_bf16 v[244:247], v[68:71], a[164:167], v[244:247]
  v_accvgpr_read_b32 v97, a97
  v_accvgpr_read_b32 v98, a98
  v_mfma_f32_16x16x32_bf16 v[248:251], v[68:71], a[168:171], v[248:251]
  buffer_load_dwordx4 v2, s[8:11], s87 offen offset:1024 lds
  v_mfma_f32_16x16x32_bf16 v[252:255], v[68:71], a[172:175], v[252:255]
  v_accvgpr_read_b32 v99, a99
  s_waitcnt lgkmcnt(6)
  v_mfma_f32_16x16x32_bf16 v[112:115], v[48:51], a[176:179], v[112:115]
  ds_read_b64_tr_b16 v[68:69], v11 offset:18592
  ds_read_b64_tr_b16 v[70:71], v11 offset:23200
  v_mfma_f32_16x16x32_bf16 v[116:119], v[48:51], a[180:183], v[116:119]
  v_accvgpr_read_b32 v100, a112
  v_accvgpr_read_b32 v101, a113
  v_mfma_f32_16x16x32_bf16 v[120:123], v[48:51], a[184:187], v[120:123]
  v_accvgpr_read_b32 v102, a114
  v_accvgpr_read_b32 v103, a115
  v_mfma_f32_16x16x32_bf16 v[124:127], v[48:51], a[188:191], v[124:127]
  buffer_load_dwordx4 v3, s[8:11], s87 offen offset:2048 lds
  v_mfma_f32_16x16x32_bf16 v[128:131], v[52:55], a[176:179], v[128:131]
  ds_read_b64_tr_b16 v[48:49], v11 offset:18624
  ds_read_b64_tr_b16 v[50:51], v11 offset:23232
  v_mfma_f32_16x16x32_bf16 v[132:135], v[52:55], a[180:183], v[132:135]
  v_mul_f32 v96, v96, v40
  v_mul_f32 v97, v97, v40
  v_mfma_f32_16x16x32_bf16 v[136:139], v[52:55], a[184:187], v[136:139]
  v_mul_f32 v98, v98, v40
  v_mul_f32 v99, v99, v40
  v_mfma_f32_16x16x32_bf16 v[140:143], v[52:55], a[188:191], v[140:143]
  v_mul_f32 v100, v100, v40
  s_waitcnt lgkmcnt(6)
  v_mfma_f32_16x16x32_bf16 v[144:147], v[56:59], a[176:179], v[144:147]
  buffer_load_dwordx4 v4, s[8:11], s87 offen offset:3072 lds
  v_mfma_f32_16x16x32_bf16 v[148:151], v[56:59], a[180:183], v[148:151]
  ds_read_b64_tr_b16 v[52:53], v11 offset:18656
  ds_read_b64_tr_b16 v[54:55], v11 offset:23264
  v_mfma_f32_16x16x32_bf16 v[152:155], v[56:59], a[184:187], v[152:155]
  v_mul_f32 v101, v101, v40
  v_mul_f32 v102, v102, v40
  v_mfma_f32_16x16x32_bf16 v[156:159], v[56:59], a[188:191], v[156:159]
  v_mul_f32 v103, v103, v40
  v_cvt_pk_bf16_f32 v96, v96, v97
  v_mfma_f32_16x16x32_bf16 v[160:163], v[60:63], a[176:179], v[160:163]
  ds_read_b64_tr_b16 v[56:57], v11 offset:18688
  ds_read_b64_tr_b16 v[58:59], v11 offset:23296
  v_mfma_f32_16x16x32_bf16 v[164:167], v[60:63], a[180:183], v[164:167]
  s_add_u32 m0, s41, 4096
  v_cvt_pk_bf16_f32 v97, v98, v99
  v_mfma_f32_16x16x32_bf16 v[168:171], v[60:63], a[184:187], v[168:171]
  v_cvt_pk_bf16_f32 v98, v100, v101
  v_cvt_pk_bf16_f32 v99, v102, v103
  v_mfma_f32_16x16x32_bf16 v[172:175], v[60:63], a[188:191], v[172:175]
  v_accvgpr_read_b32 v100, a100
  s_waitcnt lgkmcnt(6)
  v_mfma_f32_16x16x32_bf16 v[176:179], v[64:67], a[176:179], v[176:179]
  ds_read_b64_tr_b16 v[60:61], v11 offset:27648
  ds_read_b64_tr_b16 v[62:63], v11 offset:32256
  v_mfma_f32_16x16x32_bf16 v[180:183], v[64:67], a[180:183], v[180:183]
  v_accvgpr_read_b32 v101, a101
  v_accvgpr_read_b32 v102, a102
  v_mfma_f32_16x16x32_bf16 v[184:187], v[64:67], a[184:187], v[184:187]
  buffer_load_dwordx4 v5, s[8:11], s87 offen offset:0 lds
  v_mfma_f32_16x16x32_bf16 v[188:191], v[64:67], a[188:191], v[188:191]
  v_accvgpr_read_b32 v103, a103
  v_accvgpr_read_b32 v104, a116
  v_mfma_f32_16x16x32_bf16 v[192:195], v[68:71], a[176:179], v[192:195]
  ds_read_b64_tr_b16 v[64:65], v11 offset:27680
  ds_read_b64_tr_b16 v[66:67], v11 offset:32288
  v_mfma_f32_16x16x32_bf16 v[196:199], v[68:71], a[180:183], v[196:199]
  v_accvgpr_read_b32 v105, a117
  v_accvgpr_read_b32 v106, a118
  v_mfma_f32_16x16x32_bf16 v[200:203], v[68:71], a[184:187], v[200:203]
  v_accvgpr_read_b32 v107, a119
  v_mul_f32 v100, v100, v41
  v_mfma_f32_16x16x32_bf16 v[204:207], v[68:71], a[188:191], v[204:207]
  v_mul_f32 v101, v101, v41
  s_waitcnt lgkmcnt(6)
  v_mfma_f32_16x16x32_bf16 v[208:211], v[48:51], a[176:179], v[208:211]
  buffer_load_dwordx4 v6, s[8:11], s87 offen offset:1024 lds
  v_mfma_f32_16x16x32_bf16 v[212:215], v[48:51], a[180:183], v[212:215]
  ds_read_b64_tr_b16 v[68:69], v11 offset:27712
  ds_read_b64_tr_b16 v[70:71], v11 offset:32320
  v_mfma_f32_16x16x32_bf16 v[216:219], v[48:51], a[184:187], v[216:219]
  v_mul_f32 v102, v102, v41
  v_mul_f32 v103, v103, v41
  v_mfma_f32_16x16x32_bf16 v[220:223], v[48:51], a[188:191], v[220:223]
  v_mul_f32 v104, v104, v41
  v_mul_f32 v105, v105, v41
  v_mfma_f32_16x16x32_bf16 v[224:227], v[52:55], a[176:179], v[224:227]
  buffer_load_dwordx4 v7, s[8:11], s87 offen offset:2048 lds
  v_mfma_f32_16x16x32_bf16 v[228:231], v[52:55], a[180:183], v[228:231]
  ds_read_b64_tr_b16 v[48:49], v11 offset:27744
  ds_read_b64_tr_b16 v[50:51], v11 offset:32352
  v_mfma_f32_16x16x32_bf16 v[232:235], v[52:55], a[184:187], v[232:235]
  v_mul_f32 v106, v106, v41
  v_mul_f32 v107, v107, v41
  v_mfma_f32_16x16x32_bf16 v[236:239], v[52:55], a[188:191], v[236:239]
  v_cvt_pk_bf16_f32 v100, v100, v101
  s_waitcnt lgkmcnt(6)
  v_mfma_f32_16x16x32_bf16 v[240:243], v[56:59], a[176:179], v[240:243]
  ds_read_b64_tr_b16 v[52:53], v11 offset:27776
  ds_read_b64_tr_b16 v[54:55], v11 offset:32384
  v_mfma_f32_16x16x32_bf16 v[244:247], v[56:59], a[180:183], v[244:247]
  buffer_load_dwordx4 v8, s[8:11], s87 offen offset:3072 lds
  v_mfma_f32_16x16x32_bf16 v[248:251], v[56:59], a[184:187], v[248:251]
  v_cvt_pk_bf16_f32 v101, v102, v103
  v_cvt_pk_bf16_f32 v102, v104, v105
  v_mfma_f32_16x16x32_bf16 v[252:255], v[56:59], a[188:191], v[252:255]
  v_cvt_pk_bf16_f32 v103, v106, v107
  v_accvgpr_read_b32 v104, a104
  v_mfma_f32_16x16x32_bf16 v[112:115], v[60:63], a[192:195], v[112:115]
  ds_read_b64_tr_b16 v[56:57], v11 offset:27808
  ds_read_b64_tr_b16 v[58:59], v11 offset:32416
  v_mfma_f32_16x16x32_bf16 v[116:119], v[60:63], a[196:199], v[116:119]
  v_accvgpr_read_b32 v105, a105
  v_accvgpr_read_b32 v106, a106
  v_mfma_f32_16x16x32_bf16 v[120:123], v[60:63], a[200:203], v[120:123]
  s_add_u32 m0, s41, 8192
  v_accvgpr_read_b32 v107, a107
  v_mfma_f32_16x16x32_bf16 v[124:127], v[60:63], a[204:207], v[124:127]
  v_accvgpr_read_b32 v108, a120
  s_waitcnt lgkmcnt(6)
  v_mfma_f32_16x16x32_bf16 v[128:131], v[64:67], a[192:195], v[128:131]
  s_mov_b32 exec_hi, 0
  buffer_load_dword v73, v14, s[16:19], s79 offen sc1
  s_mov_b32 exec_hi, -1
  v_mfma_f32_16x16x32_bf16 v[132:135], v[64:67], a[196:199], v[132:135]
  ds_read_b64_tr_b16 v[60:61], v11 offset:27840
  ds_read_b64_tr_b16 v[62:63], v11 offset:32448
  v_mfma_f32_16x16x32_bf16 v[136:139], v[64:67], a[200:203], v[136:139]
  v_accvgpr_read_b32 v109, a121
  v_accvgpr_read_b32 v110, a122
  v_mfma_f32_16x16x32_bf16 v[140:143], v[64:67], a[204:207], v[140:143]
  buffer_load_dwordx4 v9, s[8:11], s87 offen offset:0 lds
  v_mfma_f32_16x16x32_bf16 v[144:147], v[68:71], a[192:195], v[144:147]
  ds_read_b64_tr_b16 v[64:65], v11 offset:27872
  ds_read_b64_tr_b16 v[66:67], v11 offset:32480
  v_mfma_f32_16x16x32_bf16 v[148:151], v[68:71], a[196:199], v[148:151]
  v_accvgpr_read_b32 v111, a123
  v_mul_f32 v104, v104, v42
  v_mfma_f32_16x16x32_bf16 v[152:155], v[68:71], a[200:203], v[152:155]
  v_mul_f32 v105, v105, v42
  v_mul_f32 v106, v106, v42
  v_mfma_f32_16x16x32_bf16 v[156:159], v[68:71], a[204:207], v[156:159]
  v_mul_f32 v107, v107, v42
  s_waitcnt lgkmcnt(6)
  v_mfma_f32_16x16x32_bf16 v[160:163], v[48:51], a[192:195], v[160:163]
  ds_read_b64_tr_b16 v[68:69], v11 offset:27904
  ds_read_b64_tr_b16 v[70:71], v11 offset:32512
  v_mfma_f32_16x16x32_bf16 v[164:167], v[48:51], a[196:199], v[164:167]
  v_mul_f32 v108, v108, v42
  v_mul_f32 v109, v109, v42
  v_mfma_f32_16x16x32_bf16 v[168:171], v[48:51], a[200:203], v[168:171]
  v_mul_f32 v110, v110, v42
  v_mul_f32 v111, v111, v42
  v_mfma_f32_16x16x32_bf16 v[172:175], v[48:51], a[204:207], v[172:175]
  v_cvt_pk_bf16_f32 v104, v104, v105
  v_cvt_pk_bf16_f32 v105, v106, v107
  v_mfma_f32_16x16x32_bf16 v[176:179], v[52:55], a[192:195], v[176:179]
  ds_read_b64_tr_b16 v[48:49], v11 offset:36864
  ds_read_b64_tr_b16 v[50:51], v11 offset:41472
  v_mfma_f32_16x16x32_bf16 v[180:183], v[52:55], a[196:199], v[180:183]
  v_cvt_pk_bf16_f32 v106, v108, v109
  v_cvt_pk_bf16_f32 v107, v110, v111
  v_mfma_f32_16x16x32_bf16 v[184:187], v[52:55], a[200:203], v[184:187]
  v_accvgpr_read_b32 v108, a108
  v_accvgpr_read_b32 v109, a109
  v_mfma_f32_16x16x32_bf16 v[188:191], v[52:55], a[204:207], v[188:191]
  v_accvgpr_read_b32 v110, a110
  s_waitcnt lgkmcnt(6)
  v_mfma_f32_16x16x32_bf16 v[192:195], v[56:59], a[192:195], v[192:195]
  ds_read_b64_tr_b16 v[52:53], v11 offset:36896
  ds_read_b64_tr_b16 v[54:55], v11 offset:41504
  v_mfma_f32_16x16x32_bf16 v[196:199], v[56:59], a[196:199], v[196:199]
  v_accvgpr_read_b32 v111, a111
  v_accvgpr_read_b32 v44, a124
  v_mfma_f32_16x16x32_bf16 v[200:203], v[56:59], a[200:203], v[200:203]
  v_accvgpr_read_b32 v45, a125
  v_accvgpr_read_b32 v46, a126
  v_mfma_f32_16x16x32_bf16 v[204:207], v[56:59], a[204:207], v[204:207]
  v_accvgpr_read_b32 v47, a127
  v_mul_f32 v108, v108, v43
  v_mfma_f32_16x16x32_bf16 v[208:211], v[60:63], a[192:195], v[208:211]
  ds_read_b64_tr_b16 v[56:57], v11 offset:36928
  ds_read_b64_tr_b16 v[58:59], v11 offset:41536
  v_mfma_f32_16x16x32_bf16 v[212:215], v[60:63], a[196:199], v[212:215]
  v_mul_f32 v109, v109, v43
  v_mul_f32 v110, v110, v43
  v_mfma_f32_16x16x32_bf16 v[216:219], v[60:63], a[200:203], v[216:219]
  v_mul_f32 v111, v111, v43
  v_mul_f32 v44, v44, v43
  v_mfma_f32_16x16x32_bf16 v[220:223], v[60:63], a[204:207], v[220:223]
  v_mul_f32 v45, v45, v43
  s_waitcnt lgkmcnt(6)
  v_mfma_f32_16x16x32_bf16 v[224:227], v[64:67], a[192:195], v[224:227]
  ds_read_b64_tr_b16 v[60:61], v11 offset:36960
  ds_read_b64_tr_b16 v[62:63], v11 offset:41568
  v_mfma_f32_16x16x32_bf16 v[228:231], v[64:67], a[196:199], v[228:231]
  v_mul_f32 v46, v46, v43
  v_mul_f32 v47, v47, v43
  v_mfma_f32_16x16x32_bf16 v[232:235], v[64:67], a[200:203], v[232:235]
  v_cvt_pk_bf16_f32 v108, v108, v109
  v_cvt_pk_bf16_f32 v109, v110, v111
  v_mfma_f32_16x16x32_bf16 v[236:239], v[64:67], a[204:207], v[236:239]
  v_cvt_pk_bf16_f32 v110, v44, v45
  v_cvt_pk_bf16_f32 v111, v46, v47
  v_mfma_f32_16x16x32_bf16 v[240:243], v[68:71], a[192:195], v[240:243]
  ds_read_b64_tr_b16 v[64:65], v11 offset:36992
  ds_read_b64_tr_b16 v[66:67], v11 offset:41600
  v_mfma_f32_16x16x32_bf16 v[244:247], v[68:71], a[196:199], v[244:247]
  v_mfma_f32_16x16x32_bf16 v[248:251], v[68:71], a[200:203], v[248:251]
  v_mfma_f32_16x16x32_bf16 v[252:255], v[68:71], a[204:207], v[252:255]
  s_barrier
  s_waitcnt lgkmcnt(6)
  v_mfma_f32_16x16x32_bf16 v[112:115], v[48:51], a[208:211], v[112:115]
  ds_read_b64_tr_b16 v[68:69], v11 offset:37024
  ds_read_b64_tr_b16 v[70:71], v11 offset:41632
  v_mfma_f32_16x16x32_bf16 v[116:119], v[48:51], a[212:215], v[116:119]
  v_mfma_f32_16x16x32_bf16 v[120:123], v[48:51], a[216:219], v[120:123]
  s_add_u32 m0, s40, 65536
  s_add_u32 s38, s77, 12288
  v_mfma_f32_16x16x32_bf16 v[124:127], v[48:51], a[220:223], v[124:127]
  v_mfma_f32_16x16x32_bf16 v[128:131], v[52:55], a[208:211], v[128:131]
  ds_read_b64_tr_b16 v[48:49], v11 offset:37056
  ds_read_b64_tr_b16 v[50:51], v11 offset:41664
  v_mfma_f32_16x16x32_bf16 v[132:135], v[52:55], a[212:215], v[132:135]
  v_mfma_f32_16x16x32_bf16 v[136:139], v[52:55], a[216:219], v[136:139]
  v_mfma_f32_16x16x32_bf16 v[140:143], v[52:55], a[220:223], v[140:143]
  s_waitcnt lgkmcnt(6)
  v_mfma_f32_16x16x32_bf16 v[144:147], v[56:59], a[208:211], v[144:147]
  ds_read_b64_tr_b16 v[52:53], v11 offset:37088
  ds_read_b64_tr_b16 v[54:55], v11 offset:41696
  v_mfma_f32_16x16x32_bf16 v[148:151], v[56:59], a[212:215], v[148:151]
  buffer_load_dwordx4 a[0:3], v16, s[16:19], s38 offen offset:0 sc1
  v_mfma_f32_16x16x32_bf16 v[152:155], v[56:59], a[216:219], v[152:155]
  buffer_load_dwordx4 v1, s[8:11], s88 offen offset:0 lds
  v_mfma_f32_16x16x32_bf16 v[156:159], v[56:59], a[220:223], v[156:159]
  v_mfma_f32_16x16x32_bf16 v[160:163], v[60:63], a[208:211], v[160:163]
  ds_read_b64_tr_b16 v[56:57], v11 offset:37120
  ds_read_b64_tr_b16 v[58:59], v11 offset:41728
  v_mfma_f32_16x16x32_bf16 v[164:167], v[60:63], a[212:215], v[164:167]
  v_mfma_f32_16x16x32_bf16 v[168:171], v[60:63], a[216:219], v[168:171]
  buffer_load_dwordx4 a[4:7], v16, s[16:19], s38 offen offset:1024 sc1
  v_mfma_f32_16x16x32_bf16 v[172:175], v[60:63], a[220:223], v[172:175]
  s_waitcnt lgkmcnt(6)
  v_mfma_f32_16x16x32_bf16 v[176:179], v[64:67], a[208:211], v[176:179]
  ds_read_b64_tr_b16 v[60:61], v11 offset:46080
  ds_read_b64_tr_b16 v[62:63], v11 offset:50688
  v_mfma_f32_16x16x32_bf16 v[180:183], v[64:67], a[212:215], v[180:183]
  v_mfma_f32_16x16x32_bf16 v[184:187], v[64:67], a[216:219], v[184:187]
  buffer_load_dwordx4 v2, s[8:11], s88 offen offset:1024 lds
  v_mfma_f32_16x16x32_bf16 v[188:191], v[64:67], a[220:223], v[188:191]
  v_mfma_f32_16x16x32_bf16 v[192:195], v[68:71], a[208:211], v[192:195]
  ds_read_b64_tr_b16 v[64:65], v11 offset:46112
  ds_read_b64_tr_b16 v[66:67], v11 offset:50720
  v_mfma_f32_16x16x32_bf16 v[196:199], v[68:71], a[212:215], v[196:199]
  buffer_load_dwordx4 a[8:11], v16, s[16:19], s38 offen offset:2048 sc1
  v_mfma_f32_16x16x32_bf16 v[200:203], v[68:71], a[216:219], v[200:203]
  v_mfma_f32_16x16x32_bf16 v[204:207], v[68:71], a[220:223], v[204:207]
  s_waitcnt lgkmcnt(6)
  v_mfma_f32_16x16x32_bf16 v[208:211], v[48:51], a[208:211], v[208:211]
  ds_read_b64_tr_b16 v[68:69], v11 offset:46144
  ds_read_b64_tr_b16 v[70:71], v11 offset:50752
  v_mfma_f32_16x16x32_bf16 v[212:215], v[48:51], a[212:215], v[212:215]
  v_mfma_f32_16x16x32_bf16 v[216:219], v[48:51], a[216:219], v[216:219]
  buffer_load_dwordx4 v3, s[8:11], s88 offen offset:2048 lds
  v_mfma_f32_16x16x32_bf16 v[220:223], v[48:51], a[220:223], v[220:223]
  buffer_load_dwordx4 a[12:15], v16, s[16:19], s38 offen offset:3072 sc1
  v_mfma_f32_16x16x32_bf16 v[224:227], v[52:55], a[208:211], v[224:227]
  ds_read_b64_tr_b16 v[48:49], v11 offset:46176
  ds_read_b64_tr_b16 v[50:51], v11 offset:50784
  v_mfma_f32_16x16x32_bf16 v[228:231], v[52:55], a[212:215], v[228:231]
  v_mfma_f32_16x16x32_bf16 v[232:235], v[52:55], a[216:219], v[232:235]
  v_mfma_f32_16x16x32_bf16 v[236:239], v[52:55], a[220:223], v[236:239]
  s_waitcnt lgkmcnt(6)
  v_mfma_f32_16x16x32_bf16 v[240:243], v[56:59], a[208:211], v[240:243]
  ds_read_b64_tr_b16 v[52:53], v11 offset:46208
  ds_read_b64_tr_b16 v[54:55], v11 offset:50816
  v_mfma_f32_16x16x32_bf16 v[244:247], v[56:59], a[212:215], v[244:247]
  v_mfma_f32_16x16x32_bf16 v[248:251], v[56:59], a[216:219], v[248:251]
  buffer_load_dwordx4 v4, s[8:11], s88 offen offset:3072 lds
  v_mfma_f32_16x16x32_bf16 v[252:255], v[56:59], a[220:223], v[252:255]
  v_mfma_f32_16x16x32_bf16 v[112:115], v[60:63], a[224:227], v[112:115]
  ds_read_b64_tr_b16 v[56:57], v11 offset:46240
  ds_read_b64_tr_b16 v[58:59], v11 offset:50848
  v_mfma_f32_16x16x32_bf16 v[116:119], v[60:63], a[228:231], v[116:119]
  v_mfma_f32_16x16x32_bf16 v[120:123], v[60:63], a[232:235], v[120:123]
  s_add_u32 s38, s78, 0
  v_mfma_f32_16x16x32_bf16 v[124:127], v[60:63], a[236:239], v[124:127]
  s_waitcnt lgkmcnt(6)
  v_mfma_f32_16x16x32_bf16 v[128:131], v[64:67], a[224:227], v[128:131]
  ds_read_b64_tr_b16 v[60:61], v11 offset:46272
  ds_read_b64_tr_b16 v[62:63], v11 offset:50880
  v_mfma_f32_16x16x32_bf16 v[132:135], v[64:67], a[228:231], v[132:135]
  v_mfma_f32_16x16x32_bf16 v[136:139], v[64:67], a[232:235], v[136:139]
  s_add_u32 m0, s40, 69632
  v_mfma_f32_16x16x32_bf16 v[140:143], v[64:67], a[236:239], v[140:143]
  v_mfma_f32_16x16x32_bf16 v[144:147], v[68:71], a[224:227], v[144:147]
  ds_read_b64_tr_b16 v[64:65], v11 offset:46304
  ds_read_b64_tr_b16 v[66:67], v11 offset:50912
  v_mfma_f32_16x16x32_bf16 v[148:151], v[68:71], a[228:231], v[148:151]
  buffer_load_dwordx4 a[16:19], v16, s[16:19], s38 offen offset:0 sc1
  v_mfma_f32_16x16x32_bf16 v[152:155], v[68:71], a[232:235], v[152:155]
  v_mfma_f32_16x16x32_bf16 v[156:159], v[68:71], a[236:239], v[156:159]
  s_waitcnt lgkmcnt(6)
  v_mfma_f32_16x16x32_bf16 v[160:163], v[48:51], a[224:227], v[160:163]
  ds_read_b64_tr_b16 v[68:69], v11 offset:46336
  ds_read_b64_tr_b16 v[70:71], v11 offset:50944
  v_mfma_f32_16x16x32_bf16 v[164:167], v[48:51], a[228:231], v[164:167]
  v_mfma_f32_16x16x32_bf16 v[168:171], v[48:51], a[232:235], v[168:171]
  buffer_load_dwordx4 v5, s[8:11], s88 offen offset:0 lds
  v_mfma_f32_16x16x32_bf16 v[172:175], v[48:51], a[236:239], v[172:175]
  buffer_load_dwordx4 a[20:23], v16, s[16:19], s38 offen offset:1024 sc1
  v_mfma_f32_16x16x32_bf16 v[176:179], v[52:55], a[224:227], v[176:179]
  ds_read_b64_tr_b16 v[48:49], v12 offset:0
  ds_read_b64_tr_b16 v[50:51], v12 offset:4608
  v_mfma_f32_16x16x32_bf16 v[180:183], v[52:55], a[228:231], v[180:183]
  v_mfma_f32_16x16x32_bf16 v[184:187], v[52:55], a[232:235], v[184:187]
  v_mfma_f32_16x16x32_bf16 v[188:191], v[52:55], a[236:239], v[188:191]
  s_waitcnt lgkmcnt(6)
  v_mfma_f32_16x16x32_bf16 v[192:195], v[56:59], a[224:227], v[192:195]
  ds_read_b64_tr_b16 v[52:53], v12 offset:32
  ds_read_b64_tr_b16 v[54:55], v12 offset:4640
  v_mfma_f32_16x16x32_bf16 v[196:199], v[56:59], a[228:231], v[196:199]
  buffer_load_dwordx4 a[24:27], v16, s[16:19], s38 offen offset:2048 sc1
  v_mfma_f32_16x16x32_bf16 v[200:203], v[56:59], a[232:235], v[200:203]
  buffer_load_dwordx4 v6, s[8:11], s88 offen offset:1024 lds
  v_mfma_f32_16x16x32_bf16 v[204:207], v[56:59], a[236:239], v[204:207]
  v_mfma_f32_16x16x32_bf16 v[208:211], v[60:63], a[224:227], v[208:211]
  ds_read_b64_tr_b16 v[56:57], v12 offset:64
  ds_read_b64_tr_b16 v[58:59], v12 offset:4672
  v_mfma_f32_16x16x32_bf16 v[212:215], v[60:63], a[228:231], v[212:215]
  v_mfma_f32_16x16x32_bf16 v[216:219], v[60:63], a[232:235], v[216:219]
  buffer_load_dwordx4 a[28:31], v16, s[16:19], s38 offen offset:3072 sc1
  v_mfma_f32_16x16x32_bf16 v[220:223], v[60:63], a[236:239], v[220:223]
  s_waitcnt lgkmcnt(6)
  v_mfma_f32_16x16x32_bf16 v[224:227], v[64:67], a[224:227], v[224:227]
  ds_read_b64_tr_b16 v[60:61], v12 offset:96
  ds_read_b64_tr_b16 v[62:63], v12 offset:4704
  v_mfma_f32_16x16x32_bf16 v[228:231], v[64:67], a[228:231], v[228:231]
  v_mfma_f32_16x16x32_bf16 v[232:235], v[64:67], a[232:235], v[232:235]
  buffer_load_dwordx4 v7, s[8:11], s88 offen offset:2048 lds
  v_mfma_f32_16x16x32_bf16 v[236:239], v[64:67], a[236:239], v[236:239]
  v_mfma_f32_16x16x32_bf16 v[240:243], v[68:71], a[224:227], v[240:243]
  ds_read_b64_tr_b16 v[64:65], v12 offset:128
  ds_read_b64_tr_b16 v[66:67], v12 offset:4736
  v_mfma_f32_16x16x32_bf16 v[244:247], v[68:71], a[228:231], v[244:247]
  v_mfma_f32_16x16x32_bf16 v[248:251], v[68:71], a[232:235], v[248:251]
  v_mfma_f32_16x16x32_bf16 v[252:255], v[68:71], a[236:239], v[252:255]
  s_waitcnt lgkmcnt(6)
  v_mfma_f32_16x16x32_bf16 v[112:115], v[48:51], a[240:243], v[112:115]
  ds_read_b64_tr_b16 v[68:69], v12 offset:160
  ds_read_b64_tr_b16 v[70:71], v12 offset:4768
  v_mfma_f32_16x16x32_bf16 v[116:119], v[48:51], a[244:247], v[116:119]
  v_mfma_f32_16x16x32_bf16 v[120:123], v[48:51], a[248:251], v[120:123]
  buffer_load_dwordx4 v8, s[8:11], s88 offen offset:3072 lds
  v_mfma_f32_16x16x32_bf16 v[124:127], v[48:51], a[252:255], v[124:127]
  s_mov_b32 exec_hi, 0
  buffer_load_dword v73, v14, s[16:19], s80 offen sc1
  s_mov_b32 exec_hi, -1
  v_mfma_f32_16x16x32_bf16 v[128:131], v[52:55], a[240:243], v[128:131]
  s_mov_b32 s39, 8192
  buffer_store_dwordx4 v[80:83], v16, s[32:35], s39 offen offset:0 sc1
  v_mfma_f32_16x16x32_bf16 v[132:135], v[52:55], a[244:247], v[132:135]
  ds_read_b64_tr_b16 v[48:49], v12 offset:192
  ds_read_b64_tr_b16 v[50:51], v12 offset:4800
  v_mfma_f32_16x16x32_bf16 v[136:139], v[52:55], a[248:251], v[136:139]
  v_mfma_f32_16x16x32_bf16 v[140:143], v[52:55], a[252:255], v[140:143]
  s_add_u32 s38, s78, 4096
  s_waitcnt lgkmcnt(6)
  v_mfma_f32_16x16x32_bf16 v[144:147], v[56:59], a[240:243], v[144:147]
  ds_read_b64_tr_b16 v[52:53], v12 offset:224
  ds_read_b64_tr_b16 v[54:55], v12 offset:4832
  v_mfma_f32_16x16x32_bf16 v[148:151], v[56:59], a[244:247], v[148:151]
  v_mfma_f32_16x16x32_bf16 v[152:155], v[56:59], a[248:251], v[152:155]
  s_add_u32 m0, s40, 73728
  v_mfma_f32_16x16x32_bf16 v[156:159], v[56:59], a[252:255], v[156:159]
  v_mfma_f32_16x16x32_bf16 v[160:163], v[60:63], a[240:243], v[160:163]
  ds_read_b64_tr_b16 v[56:57], v12 offset:256
  ds_read_b64_tr_b16 v[58:59], v12 offset:4864
  v_mfma_f32_16x16x32_bf16 v[164:167], v[60:63], a[244:247], v[164:167]
  buffer_load_dwordx4 a[32:35], v16, s[16:19], s38 offen offset:0 sc1
  v_mfma_f32_16x16x32_bf16 v[168:171], v[60:63], a[248:251], v[168:171]
  v_mfma_f32_16x16x32_bf16 v[172:175], v[60:63], a[252:255], v[172:175]
  s_waitcnt lgkmcnt(6)
  v_mfma_f32_16x16x32_bf16 v[176:179], v[64:67], a[240:243], v[176:179]
  s_mov_b32 s39, 8192
  buffer_store_dwordx4 v[84:87], v16, s[32:35], s39 offen offset:1024 sc1
  v_mfma_f32_16x16x32_bf16 v[180:183], v[64:67], a[244:247], v[180:183]
  ds_read_b64_tr_b16 v[60:61], v12 offset:9216
  ds_read_b64_tr_b16 v[62:63], v12 offset:13824
  v_mfma_f32_16x16x32_bf16 v[184:187], v[64:67], a[248:251], v[184:187]
  buffer_load_dwordx4 v9, s[8:11], s88 offen offset:0 lds
  v_mfma_f32_16x16x32_bf16 v[188:191], v[64:67], a[252:255], v[188:191]
  buffer_load_dwordx4 a[36:39], v16, s[16:19], s38 offen offset:1024 sc1
  v_mfma_f32_16x16x32_bf16 v[192:195], v[68:71], a[240:243], v[192:195]
  ds_read_b64_tr_b16 v[64:65], v12 offset:9248
  ds_read_b64_tr_b16 v[66:67], v12 offset:13856
  v_mfma_f32_16x16x32_bf16 v[196:199], v[68:71], a[244:247], v[196:199]
  v_mfma_f32_16x16x32_bf16 v[200:203], v[68:71], a[248:251], v[200:203]
  buffer_load_dwordx4 a[40:43], v16, s[16:19], s38 offen offset:2048 sc1
  v_mfma_f32_16x16x32_bf16 v[204:207], v[68:71], a[252:255], v[204:207]
  s_waitcnt lgkmcnt(6)
  v_mfma_f32_16x16x32_bf16 v[208:211], v[48:51], a[240:243], v[208:211]
  ds_read_b64_tr_b16 v[68:69], v12 offset:9280
  ds_read_b64_tr_b16 v[70:71], v12 offset:13888
  v_mfma_f32_16x16x32_bf16 v[212:215], v[48:51], a[244:247], v[212:215]
  v_mfma_f32_16x16x32_bf16 v[216:219], v[48:51], a[248:251], v[216:219]
  v_mfma_f32_16x16x32_bf16 v[220:223], v[48:51], a[252:255], v[220:223]
  buffer_load_dwordx4 a[44:47], v16, s[16:19], s38 offen offset:3072 sc1
  v_mfma_f32_16x16x32_bf16 v[224:227], v[52:55], a[240:243], v[224:227]
  s_mov_b32 s39, 8192
  buffer_store_dwordx4 v[88:91], v16, s[32:35], s39 offen offset:2048 sc1
  v_mfma_f32_16x16x32_bf16 v[228:231], v[52:55], a[244:247], v[228:231]
  ds_read_b64_tr_b16 v[48:49], v12 offset:9312
  ds_read_b64_tr_b16 v[50:51], v12 offset:13920
  v_mfma_f32_16x16x32_bf16 v[232:235], v[52:55], a[248:251], v[232:235]
  v_mfma_f32_16x16x32_bf16 v[236:239], v[52:55], a[252:255], v[236:239]
  s_waitcnt lgkmcnt(6)
  v_mfma_f32_16x16x32_bf16 v[240:243], v[56:59], a[240:243], v[240:243]
  ds_read_b64_tr_b16 v[52:53], v12 offset:9344
  ds_read_b64_tr_b16 v[54:55], v12 offset:13952
  v_mfma_f32_16x16x32_bf16 v[244:247], v[56:59], a[244:247], v[244:247]
  v_mfma_f32_16x16x32_bf16 v[248:251], v[56:59], a[248:251], v[248:251]
  v_mfma_f32_16x16x32_bf16 v[252:255], v[56:59], a[252:255], v[252:255]
  s_barrier
  s_waitcnt vmcnt(18)
  v_mfma_f32_16x16x32_bf16 v[112:115], v[60:63], a[0:3], v[112:115]
  ds_read_b64_tr_b16 v[56:57], v12 offset:9376
  ds_read_b64_tr_b16 v[58:59], v12 offset:13984
  v_mfma_f32_16x16x32_bf16 v[116:119], v[60:63], a[4:7], v[116:119]
  v_mfma_f32_16x16x32_bf16 v[120:123], v[60:63], a[8:11], v[120:123]
  s_add_u32 s38, s78, 8192
  v_mfma_f32_16x16x32_bf16 v[124:127], v[60:63], a[12:15], v[124:127]
  s_waitcnt lgkmcnt(6)
  v_mfma_f32_16x16x32_bf16 v[128:131], v[64:67], a[0:3], v[128:131]
  s_mov_b32 s39, 8192
  buffer_store_dwordx4 v[92:95], v16, s[32:35], s39 offen offset:3072 sc1
  v_mfma_f32_16x16x32_bf16 v[132:135], v[64:67], a[4:7], v[132:135]
  ds_read_b64_tr_b16 v[60:61], v12 offset:9408
  ds_read_b64_tr_b16 v[62:63], v12 offset:14016
  v_mfma_f32_16x16x32_bf16 v[136:139], v[64:67], a[8:11], v[136:139]
  v_mfma_f32_16x16x32_bf16 v[140:143], v[64:67], a[12:15], v[140:143]
  v_mfma_f32_16x16x32_bf16 v[144:147], v[68:71], a[0:3], v[144:147]
  ds_read_b64_tr_b16 v[64:65], v12 offset:9440
  ds_read_b64_tr_b16 v[66:67], v12 offset:14048
  v_mfma_f32_16x16x32_bf16 v[148:151], v[68:71], a[4:7], v[148:151]
  buffer_load_dwordx4 a[48:51], v16, s[16:19], s38 offen offset:0 sc1
  v_mfma_f32_16x16x32_bf16 v[152:155], v[68:71], a[8:11], v[152:155]
  v_mfma_f32_16x16x32_bf16 v[156:159], v[68:71], a[12:15], v[156:159]
  s_waitcnt lgkmcnt(6)
  v_mfma_f32_16x16x32_bf16 v[160:163], v[48:51], a[0:3], v[160:163]
  ds_read_b64_tr_b16 v[68:69], v12 offset:9472
  ds_read_b64_tr_b16 v[70:71], v12 offset:14080
  v_mfma_f32_16x16x32_bf16 v[164:167], v[48:51], a[4:7], v[164:167]
  v_mfma_f32_16x16x32_bf16 v[168:171], v[48:51], a[8:11], v[168:171]
  buffer_load_dwordx4 a[52:55], v16, s[16:19], s38 offen offset:1024 sc1
  v_mfma_f32_16x16x32_bf16 v[172:175], v[48:51], a[12:15], v[172:175]
  v_mfma_f32_16x16x32_bf16 v[176:179], v[52:55], a[0:3], v[176:179]
  s_mov_b32 s39, 12288
  buffer_store_dwordx4 v[96:99], v16, s[32:35], s39 offen offset:0 sc1
  v_mfma_f32_16x16x32_bf16 v[180:183], v[52:55], a[4:7], v[180:183]
  ds_read_b64_tr_b16 v[48:49], v10 offset:0
  ds_read_b64_tr_b16 v[50:51], v10 offset:4608
  v_mfma_f32_16x16x32_bf16 v[184:187], v[52:55], a[8:11], v[184:187]
  v_mfma_f32_16x16x32_bf16 v[188:191], v[52:55], a[12:15], v[188:191]
  s_waitcnt lgkmcnt(6)
  v_mfma_f32_16x16x32_bf16 v[192:195], v[56:59], a[0:3], v[192:195]
  ds_read_b64_tr_b16 v[52:53], v10 offset:32
  ds_read_b64_tr_b16 v[54:55], v10 offset:4640
  v_mfma_f32_16x16x32_bf16 v[196:199], v[56:59], a[4:7], v[196:199]
  buffer_load_dwordx4 a[56:59], v16, s[16:19], s38 offen offset:2048 sc1
  v_mfma_f32_16x16x32_bf16 v[200:203], v[56:59], a[8:11], v[200:203]
  v_mfma_f32_16x16x32_bf16 v[204:207], v[56:59], a[12:15], v[204:207]
  v_mfma_f32_16x16x32_bf16 v[208:211], v[60:63], a[0:3], v[208:211]
  ds_read_b64_tr_b16 v[56:57], v10 offset:64
  ds_read_b64_tr_b16 v[58:59], v10 offset:4672
  v_mfma_f32_16x16x32_bf16 v[212:215], v[60:63], a[4:7], v[212:215]
  v_mfma_f32_16x16x32_bf16 v[216:219], v[60:63], a[8:11], v[216:219]
  buffer_load_dwordx4 a[60:63], v16, s[16:19], s38 offen offset:3072 sc1
  v_mfma_f32_16x16x32_bf16 v[220:223], v[60:63], a[12:15], v[220:223]
  s_waitcnt lgkmcnt(6)
  v_mfma_f32_16x16x32_bf16 v[224:227], v[64:67], a[0:3], v[224:227]
  s_mov_b32 s39, 12288
  buffer_store_dwordx4 v[100:103], v16, s[32:35], s39 offen offset:1024 sc1
  v_mfma_f32_16x16x32_bf16 v[228:231], v[64:67], a[4:7], v[228:231]
  ds_read_b64_tr_b16 v[60:61], v10 offset:96
  ds_read_b64_tr_b16 v[62:63], v10 offset:4704
  v_mfma_f32_16x16x32_bf16 v[232:235], v[64:67], a[8:11], v[232:235]
  v_mfma_f32_16x16x32_bf16 v[236:239], v[64:67], a[12:15], v[236:239]
  v_mfma_f32_16x16x32_bf16 v[240:243], v[68:71], a[0:3], v[240:243]
  ds_read_b64_tr_b16 v[64:65], v10 offset:128
  ds_read_b64_tr_b16 v[66:67], v10 offset:4736
  v_mfma_f32_16x16x32_bf16 v[244:247], v[68:71], a[4:7], v[244:247]
  v_mfma_f32_16x16x32_bf16 v[248:251], v[68:71], a[8:11], v[248:251]
  v_mfma_f32_16x16x32_bf16 v[252:255], v[68:71], a[12:15], v[252:255]
  s_barrier
  s_waitcnt vmcnt(18) lgkmcnt(6)
  v_mfma_f32_16x16x32_bf16 v[112:115], v[48:51], a[16:19], v[112:115]
  ds_read_b64_tr_b16 v[68:69], v10 offset:160
  ds_read_b64_tr_b16 v[70:71], v10 offset:4768
  v_mfma_f32_16x16x32_bf16 v[116:119], v[48:51], a[20:23], v[116:119]
  v_mfma_f32_16x16x32_bf16 v[120:123], v[48:51], a[24:27], v[120:123]
  s_add_u32 m0, s40, 102400
  s_add_u32 s38, s78, 12288
  v_mfma_f32_16x16x32_bf16 v[124:127], v[48:51], a[28:31], v[124:127]
  v_mfma_f32_16x16x32_bf16 v[128:131], v[52:55], a[16:19], v[128:131]
  s_mov_b32 s39, 12288
  buffer_store_dwordx4 v[104:107], v16, s[32:35], s39 offen offset:2048 sc1
  v_mfma_f32_16x16x32_bf16 v[132:135], v[52:55], a[20:23], v[132:135]
  ds_read_b64_tr_b16 v[48:49], v10 offset:192
  ds_read_b64_tr_b16 v[50:51], v10 offset:4800
  v_mfma_f32_16x16x32_bf16 v[136:139], v[52:55], a[24:27], v[136:139]
  v_mfma_f32_16x16x32_bf16 v[140:143], v[52:55], a[28:31], v[140:143]
  s_waitcnt lgkmcnt(6)
  v_mfma_f32_16x16x32_bf16 v[144:147], v[56:59], a[16:19], v[144:147]
  ds_read_b64_tr_b16 v[52:53], v10 offset:224
  ds_read_b64_tr_b16 v[54:55], v10 offset:4832
  v_mfma_f32_16x16x32_bf16 v[148:151], v[56:59], a[20:23], v[148:151]
  buffer_load_dwordx4 a[64:67], v16, s[16:19], s38 offen offset:0 sc1
  v_mfma_f32_16x16x32_bf16 v[152:155], v[56:59], a[24:27], v[152:155]
  buffer_load_dwordx4 v1, s[8:11], s89 offen offset:0 lds
  v_mfma_f32_16x16x32_bf16 v[156:159], v[56:59], a[28:31], v[156:159]
  v_mfma_f32_16x16x32_bf16 v[160:163], v[60:63], a[16:19], v[160:163]
  ds_read_b64_tr_b16 v[56:57], v10 offset:256
  ds_read_b64_tr_b16 v[58:59], v10 offset:4864
  v_mfma_f32_16x16x32_bf16 v[164:167], v[60:63], a[20:23], v[164:167]
  v_mfma_f32_16x16x32_bf16 v[168:171], v[60:63], a[24:27], v[168:171]
  buffer_load_dwordx4 a[68:71], v16, s[16:19], s38 offen offset:1024 sc1
  v_mfma_f32_16x16x32_bf16 v[172:175], v[60:63], a[28:31], v[172:175]
  s_waitcnt lgkmcnt(6)
  v_mfma_f32_16x16x32_bf16 v[176:179], v[64:67], a[16:19], v[176:179]
  s_mov_b32 s39, 12288
  buffer_store_dwordx4 v[108:111], v16, s[32:35], s39 offen offset:3072 sc1
  v_mfma_f32_16x16x32_bf16 v[180:183], v[64:67], a[20:23], v[180:183]
  ds_read_b64_tr_b16 v[60:61], v10 offset:9216
  ds_read_b64_tr_b16 v[62:63], v10 offset:13824
  v_mfma_f32_16x16x32_bf16 v[184:187], v[64:67], a[24:27], v[184:187]
  buffer_load_dwordx4 v2, s[8:11], s89 offen offset:1024 lds
  v_mfma_f32_16x16x32_bf16 v[188:191], v[64:67], a[28:31], v[188:191]
  v_mfma_f32_16x16x32_bf16 v[192:195], v[68:71], a[16:19], v[192:195]
  ds_read_b64_tr_b16 v[64:65], v10 offset:9248
  ds_read_b64_tr_b16 v[66:67], v10 offset:13856
  v_mfma_f32_16x16x32_bf16 v[196:199], v[68:71], a[20:23], v[196:199]
  buffer_load_dwordx4 a[72:75], v16, s[16:19], s38 offen offset:2048 sc1
  v_mfma_f32_16x16x32_bf16 v[200:203], v[68:71], a[24:27], v[200:203]
  v_mfma_f32_16x16x32_bf16 v[204:207], v[68:71], a[28:31], v[204:207]
  s_waitcnt lgkmcnt(6)
  v_mfma_f32_16x16x32_bf16 v[208:211], v[48:51], a[16:19], v[208:211]
  ds_read_b64_tr_b16 v[68:69], v10 offset:9280
  ds_read_b64_tr_b16 v[70:71], v10 offset:13888
  v_mfma_f32_16x16x32_bf16 v[212:215], v[48:51], a[20:23], v[212:215]
  v_mfma_f32_16x16x32_bf16 v[216:219], v[48:51], a[24:27], v[216:219]
  buffer_load_dwordx4 v3, s[8:11], s89 offen offset:2048 lds
  v_mfma_f32_16x16x32_bf16 v[220:223], v[48:51], a[28:31], v[220:223]
  buffer_load_dwordx4 a[76:79], v16, s[16:19], s38 offen offset:3072 sc1
  v_mfma_f32_16x16x32_bf16 v[224:227], v[52:55], a[16:19], v[224:227]
  ds_read_b64_tr_b16 v[48:49], v10 offset:9312
  ds_read_b64_tr_b16 v[50:51], v10 offset:13920
  v_mfma_f32_16x16x32_bf16 v[228:231], v[52:55], a[20:23], v[228:231]
  v_mfma_f32_16x16x32_bf16 v[232:235], v[52:55], a[24:27], v[232:235]
  v_mfma_f32_16x16x32_bf16 v[236:239], v[52:55], a[28:31], v[236:239]
  s_waitcnt lgkmcnt(6)
  v_mfma_f32_16x16x32_bf16 v[240:243], v[56:59], a[16:19], v[240:243]
  ds_read_b64_tr_b16 v[52:53], v10 offset:9344
  ds_read_b64_tr_b16 v[54:55], v10 offset:13952
  v_mfma_f32_16x16x32_bf16 v[244:247], v[56:59], a[20:23], v[244:247]
  v_mfma_f32_16x16x32_bf16 v[248:251], v[56:59], a[24:27], v[248:251]
  buffer_load_dwordx4 v4, s[8:11], s89 offen offset:3072 lds
  v_mfma_f32_16x16x32_bf16 v[252:255], v[56:59], a[28:31], v[252:255]
  s_waitcnt vmcnt(18)
  v_mfma_f32_16x16x32_bf16 v[112:115], v[60:63], a[32:35], v[112:115]
  ds_read_b64_tr_b16 v[56:57], v10 offset:9376
  ds_read_b64_tr_b16 v[58:59], v10 offset:13984
  v_mfma_f32_16x16x32_bf16 v[116:119], v[60:63], a[36:39], v[116:119]
  v_mfma_f32_16x16x32_bf16 v[120:123], v[60:63], a[40:43], v[120:123]
  s_add_u32 s38, s79, 0
  v_mfma_f32_16x16x32_bf16 v[124:127], v[60:63], a[44:47], v[124:127]
  s_waitcnt lgkmcnt(6)
  v_mfma_f32_16x16x32_bf16 v[128:131], v[64:67], a[32:35], v[128:131]
  ds_read_b64_tr_b16 v[60:61], v10 offset:9408
  ds_read_b64_tr_b16 v[62:63], v10 offset:14016
  v_mfma_f32_16x16x32_bf16 v[132:135], v[64:67], a[36:39], v[132:135]
  v_mfma_f32_16x16x32_bf16 v[136:139], v[64:67], a[40:43], v[136:139]
  s_add_u32 m0, s40, 106496
  v_mfma_f32_16x16x32_bf16 v[140:143], v[64:67], a[44:47], v[140:143]
  v_mfma_f32_16x16x32_bf16 v[144:147], v[68:71], a[32:35], v[144:147]
  ds_read_b64_tr_b16 v[64:65], v10 offset:9440
  ds_read_b64_tr_b16 v[66:67], v10 offset:14048
  v_mfma_f32_16x16x32_bf16 v[148:151], v[68:71], a[36:39], v[148:151]
  buffer_load_dwordx4 a[80:83], v16, s[16:19], s38 offen offset:0 sc1
  v_mfma_f32_16x16x32_bf16 v[152:155], v[68:71], a[40:43], v[152:155]
  v_mfma_f32_16x16x32_bf16 v[156:159], v[68:71], a[44:47], v[156:159]
  s_waitcnt lgkmcnt(6)
  v_mfma_f32_16x16x32_bf16 v[160:163], v[48:51], a[32:35], v[160:163]
  ds_read_b64_tr_b16 v[68:69], v10 offset:9472
  ds_read_b64_tr_b16 v[70:71], v10 offset:14080
  v_mfma_f32_16x16x32_bf16 v[164:167], v[48:51], a[36:39], v[164:167]
  v_mfma_f32_16x16x32_bf16 v[168:171], v[48:51], a[40:43], v[168:171]
  buffer_load_dwordx4 v5, s[8:11], s89 offen offset:0 lds
  v_mfma_f32_16x16x32_bf16 v[172:175], v[48:51], a[44:47], v[172:175]
  buffer_load_dwordx4 a[84:87], v16, s[16:19], s38 offen offset:1024 sc1
  v_mfma_f32_16x16x32_bf16 v[176:179], v[52:55], a[32:35], v[176:179]
  ds_read_b64_tr_b16 v[48:49], v10 offset:18432
  ds_read_b64_tr_b16 v[50:51], v10 offset:23040
  v_mfma_f32_16x16x32_bf16 v[180:183], v[52:55], a[36:39], v[180:183]
  v_mfma_f32_16x16x32_bf16 v[184:187], v[52:55], a[40:43], v[184:187]
  v_mfma_f32_16x16x32_bf16 v[188:191], v[52:55], a[44:47], v[188:191]
  s_waitcnt lgkmcnt(6)
  v_mfma_f32_16x16x32_bf16 v[192:195], v[56:59], a[32:35], v[192:195]
  s_waitcnt vmcnt(8)
  s_barrier
  v_mfma_f32_16x16x32_bf16 v[196:199], v[56:59], a[36:39], v[196:199]
  v_mov_b32 v75, s100
  buffer_store_dword v75, v77, s[96:99], 0 offen offset:896 sc1
  v_mfma_f32_16x16x32_bf16 v[200:203], v[56:59], a[40:43], v[200:203]
  ds_read_b64_tr_b16 v[52:53], v10 offset:18464
  ds_read_b64_tr_b16 v[54:55], v10 offset:23072
  v_mfma_f32_16x16x32_bf16 v[204:207], v[56:59], a[44:47], v[204:207]
  buffer_load_dwordx4 v6, s[8:11], s89 offen offset:1024 lds
  v_mfma_f32_16x16x32_bf16 v[208:211], v[60:63], a[32:35], v[208:211]
  buffer_load_dwordx4 a[88:91], v16, s[16:19], s38 offen offset:2048 sc1
  v_mfma_f32_16x16x32_bf16 v[212:215], v[60:63], a[36:39], v[212:215]
  ds_read_b64_tr_b16 v[56:57], v10 offset:18496
  ds_read_b64_tr_b16 v[58:59], v10 offset:23104
  v_mfma_f32_16x16x32_bf16 v[216:219], v[60:63], a[40:43], v[216:219]
  buffer_load_dwordx4 a[92:95], v16, s[16:19], s38 offen offset:3072 sc1
  v_mfma_f32_16x16x32_bf16 v[220:223], v[60:63], a[44:47], v[220:223]
  s_and_b32 s67, s2, 0xf8
  s_waitcnt lgkmcnt(6)
  v_mfma_f32_16x16x32_bf16 v[224:227], v[64:67], a[32:35], v[224:227]
  ds_read_b64_tr_b16 v[60:61], v10 offset:18528
  ds_read_b64_tr_b16 v[62:63], v10 offset:23136
  v_mfma_f32_16x16x32_bf16 v[228:231], v[64:67], a[36:39], v[228:231]
  s_lshl_b32 s66, s3, 1
  s_add_u32 s70, s67, s66
  v_mfma_f32_16x16x32_bf16 v[232:235], v[64:67], a[40:43], v[232:235]
  buffer_load_dwordx4 v7, s[8:11], s89 offen offset:2048 lds
  v_mfma_f32_16x16x32_bf16 v[236:239], v[64:67], a[44:47], v[236:239]
  s_mul_i32 s70, s70, 9216
  s_mul_i32 s69, s7, 2359296
  v_mfma_f32_16x16x32_bf16 v[240:243], v[68:71], a[32:35], v[240:243]
  ds_read_b64_tr_b16 v[64:65], v10 offset:18560
  ds_read_b64_tr_b16 v[66:67], v10 offset:23168
  v_mfma_f32_16x16x32_bf16 v[244:247], v[68:71], a[36:39], v[244:247]
  s_add_u32 s70, s70, s69
  s_add_u32 s70, s70, 50331648
  v_mfma_f32_16x16x32_bf16 v[248:251], v[68:71], a[40:43], v[248:251]
  s_add_u32 s28, s64, s70
  s_addc_u32 s29, s65, 0
  v_mfma_f32_16x16x32_bf16 v[252:255], v[68:71], a[44:47], v[252:255]
  s_mov_b32 s30, 18432
  s_waitcnt lgkmcnt(6)
  v_mfma_f32_16x16x32_bf16 v[112:115], v[48:51], a[48:51], v[112:115]
  ds_read_b64_tr_b16 v[68:69], v10 offset:18592
  ds_read_b64_tr_b16 v[70:71], v10 offset:23200
  v_mfma_f32_16x16x32_bf16 v[116:119], v[48:51], a[52:55], v[116:119]
  s_mul_i32 s70, s2, 9216
  s_add_u32 s70, s70, 50331648
  v_mfma_f32_16x16x32_bf16 v[120:123], v[48:51], a[56:59], v[120:123]
  buffer_load_dwordx4 v8, s[8:11], s89 offen offset:3072 lds
  v_mfma_f32_16x16x32_bf16 v[124:127], v[48:51], a[60:63], v[124:127]
  s_mov_b32 exec_hi, 0
  buffer_load_dword v73, v14, s[16:19], s81 offen sc1
  s_mov_b32 exec_hi, -1
  v_mfma_f32_16x16x32_bf16 v[128:131], v[52:55], a[48:51], v[128:131]
  ds_read_b64_tr_b16 v[48:49], v10 offset:18624
  ds_read_b64_tr_b16 v[50:51], v10 offset:23232
  v_mfma_f32_16x16x32_bf16 v[132:135], v[52:55], a[52:55], v[132:135]
  s_add_u32 s32, s64, s70
  s_addc_u32 s33, s65, 0
  v_mfma_f32_16x16x32_bf16 v[136:139], v[52:55], a[56:59], v[136:139]
  s_mov_b32 s34, 16524288
  s_lshr_b32 s70, s2, 5
  v_mfma_f32_16x16x32_bf16 v[140:143], v[52:55], a[60:63], v[140:143]
  s_add_u32 s38, s79, 4096
  s_waitcnt lgkmcnt(6)
  v_mfma_f32_16x16x32_bf16 v[144:147], v[56:59], a[48:51], v[144:147]
  ds_read_b64_tr_b16 v[52:53], v10 offset:18656
  ds_read_b64_tr_b16 v[54:55], v10 offset:23264
  v_mfma_f32_16x16x32_bf16 v[148:151], v[56:59], a[52:55], v[148:151]
  s_lshl_b32 s70, s70, 3
  s_add_u32 s70, s70, s7
  v_mfma_f32_16x16x32_bf16 v[152:155], v[56:59], a[56:59], v[152:155]
  s_add_u32 m0, s40, 110592
  s_mul_i32 s70, s70, 36864
  v_mfma_f32_16x16x32_bf16 v[156:159], v[56:59], a[60:63], v[156:159]
  s_add_u32 s69, s70, s43
  v_lshrrev_b32 v39, 4, v16
  v_mfma_f32_16x16x32_bf16 v[160:163], v[60:63], a[48:51], v[160:163]
  ds_read_b64_tr_b16 v[56:57], v10 offset:18688
  ds_read_b64_tr_b16 v[58:59], v10 offset:23296
  v_mfma_f32_16x16x32_bf16 v[164:167], v[60:63], a[52:55], v[164:167]
  buffer_load_dwordx4 a[96:99], v16, s[16:19], s38 offen offset:0 sc1
  v_mfma_f32_16x16x32_bf16 v[168:171], v[60:63], a[56:59], v[168:171]
  v_and_b32 v46, 15, v39
  v_mul_u32_u24 v46, 1152, v46
  v_mfma_f32_16x16x32_bf16 v[172:175], v[60:63], a[60:63], v[172:175]
  v_lshrrev_b32 v47, 4, v39
  s_waitcnt lgkmcnt(6)
  v_mfma_f32_16x16x32_bf16 v[176:179], v[64:67], a[48:51], v[176:179]
  ds_read_b64_tr_b16 v[60:61], v10 offset:27648
  ds_read_b64_tr_b16 v[62:63], v10 offset:32256
  v_mfma_f32_16x16x32_bf16 v[180:183], v[64:67], a[52:55], v[180:183]
  buffer_load_dwordx4 a[100:103], v16, s[16:19], s38 offen offset:1024 sc1
  v_mfma_f32_16x16x32_bf16 v[184:187], v[64:67], a[56:59], v[184:187]
  buffer_load_dwordx4 v9, s[8:11], s89 offen offset:0 lds
  v_mfma_f32_16x16x32_bf16 v[188:191], v[64:67], a[60:63], v[188:191]
  v_lshlrev_b32 v47, 3, v47
  v_add_u32 v46, v46, v47
  v_mfma_f32_16x16x32_bf16 v[192:195], v[68:71], a[48:51], v[192:195]
  ds_read_b64_tr_b16 v[64:65], v10 offset:27680
  ds_read_b64_tr_b16 v[66:67], v10 offset:32288
  v_mfma_f32_16x16x32_bf16 v[196:199], v[68:71], a[52:55], v[196:199]
  v_add_u32 v46, s69, v46
  s_lshl_b32 s70, s3, 10
  v_mfma_f32_16x16x32_bf16 v[200:203], v[68:71], a[56:59], v[200:203]
  buffer_load_dwordx4 a[104:107], v16, s[16:19], s38 offen offset:2048 sc1
  v_mfma_f32_16x16x32_bf16 v[204:207], v[68:71], a[60:63], v[204:207]
  v_add_u32 v80, s70, v16
  s_waitcnt lgkmcnt(6)
  v_mfma_f32_16x16x32_bf16 v[208:211], v[48:51], a[48:51], v[208:211]
  ds_read_b64_tr_b16 v[68:69], v10 offset:27712
  ds_read_b64_tr_b16 v[70:71], v10 offset:32320
  v_mfma_f32_16x16x32_bf16 v[212:215], v[48:51], a[52:55], v[212:215]
  s_lshl_b32 s70, s3, 5
  v_add_u32 v81, s70, v46
  v_mfma_f32_16x16x32_bf16 v[216:219], v[48:51], a[56:59], v[216:219]
  s_add_u32 s71, s3, 5
  v_mfma_f32_16x16x32_bf16 v[220:223], v[48:51], a[60:63], v[220:223]
  buffer_load_dwordx4 a[108:111], v16, s[16:19], s38 offen offset:3072 sc1
  v_mfma_f32_16x16x32_bf16 v[224:227], v[52:55], a[48:51], v[224:227]
  ds_read_b64_tr_b16 v[48:49], v10 offset:27744
  ds_read_b64_tr_b16 v[50:51], v10 offset:32352
  v_mfma_f32_16x16x32_bf16 v[228:231], v[52:55], a[52:55], v[228:231]
  s_cmp_eq_u32 s3, 0
  s_cselect_b32 s71, 4, s71
  v_mfma_f32_16x16x32_bf16 v[232:235], v[52:55], a[56:59], v[232:235]
  s_lshl_b32 s70, s71, 10
  v_add_u32 v82, s70, v16
  v_mfma_f32_16x16x32_bf16 v[236:239], v[52:55], a[60:63], v[236:239]
  s_lshl_b32 s70, s71, 5
  s_waitcnt lgkmcnt(6)
  v_mfma_f32_16x16x32_bf16 v[240:243], v[56:59], a[48:51], v[240:243]
  ds_read_b64_tr_b16 v[52:53], v10 offset:27776
  ds_read_b64_tr_b16 v[54:55], v10 offset:32384
  v_mfma_f32_16x16x32_bf16 v[244:247], v[56:59], a[52:55], v[244:247]
  v_add_u32 v83, s70, v46
  s_lshr_b32 s70, s3, 1
  v_mfma_f32_16x16x32_bf16 v[248:251], v[56:59], a[56:59], v[248:251]
  s_lshl_b32 s70, s70, 7
  v_add_u32 v84, s70, v79
  v_mfma_f32_16x16x32_bf16 v[252:255], v[56:59], a[60:63], v[252:255]
  s_barrier
  s_waitcnt vmcnt(16)
  v_mfma_f32_16x16x32_bf16 v[112:115], v[60:63], a[64:67], v[112:115]
  ds_read_b64_tr_b16 v[56:57], v10 offset:27808
  ds_read_b64_tr_b16 v[58:59], v10 offset:32416
  v_mfma_f32_16x16x32_bf16 v[116:119], v[60:63], a[68:71], v[116:119]
  s_mov_b32 s66, 18432
  s_mov_b32 s20, s44
  v_mfma_f32_16x16x32_bf16 v[120:123], v[60:63], a[72:75], v[120:123]
  s_add_u32 s38, s79, 8192
  s_mov_b32 s21, s45
  v_mfma_f32_16x16x32_bf16 v[124:127], v[60:63], a[76:79], v[124:127]
  s_mov_b32 s22, 2359296
  s_waitcnt lgkmcnt(6)
  v_mfma_f32_16x16x32_bf16 v[128:131], v[64:67], a[64:67], v[128:131]
  ds_read_b64_tr_b16 v[60:61], v10 offset:27840
  ds_read_b64_tr_b16 v[62:63], v10 offset:32448
  v_mfma_f32_16x16x32_bf16 v[132:135], v[64:67], a[68:71], v[132:135]
  s_mov_b32 s24, s60
  s_mov_b32 s25, s61
  v_mfma_f32_16x16x32_bf16 v[136:139], v[64:67], a[72:75], v[136:139]
  s_mov_b32 s26, 2359296
  v_mfma_f32_16x16x32_bf16 v[140:143], v[64:67], a[76:79], v[140:143]
  v_mfma_f32_16x16x32_bf16 v[144:147], v[68:71], a[64:67], v[144:147]
  ds_read_b64_tr_b16 v[64:65], v10 offset:27872
  ds_read_b64_tr_b16 v[66:67], v10 offset:32480
  v_mfma_f32_16x16x32_bf16 v[148:151], v[68:71], a[68:71], v[148:151]
  buffer_load_dwordx4 a[112:115], v16, s[16:19], s38 offen offset:0 sc1
  v_mfma_f32_16x16x32_bf16 v[152:155], v[68:71], a[72:75], v[152:155]
  v_mfma_f32_16x16x32_bf16 v[156:159], v[68:71], a[76:79], v[156:159]
  s_waitcnt lgkmcnt(6)
  v_mfma_f32_16x16x32_bf16 v[160:163], v[48:51], a[64:67], v[160:163]
  ds_read_b64_tr_b16 v[68:69], v10 offset:27904
  ds_read_b64_tr_b16 v[70:71], v10 offset:32512
  v_mfma_f32_16x16x32_bf16 v[164:167], v[48:51], a[68:71], v[164:167]
  v_mfma_f32_16x16x32_bf16 v[168:171], v[48:51], a[72:75], v[168:171]
  buffer_load_dwordx4 a[116:119], v16, s[16:19], s38 offen offset:1024 sc1
  v_mfma_f32_16x16x32_bf16 v[172:175], v[48:51], a[76:79], v[172:175]
  v_mfma_f32_16x16x32_bf16 v[176:179], v[52:55], a[64:67], v[176:179]
  ds_read_b64_tr_b16 v[48:49], v12 offset:18432
  ds_read_b64_tr_b16 v[50:51], v12 offset:23040
  v_mfma_f32_16x16x32_bf16 v[180:183], v[52:55], a[68:71], v[180:183]
  v_mfma_f32_16x16x32_bf16 v[184:187], v[52:55], a[72:75], v[184:187]
  v_mfma_f32_16x16x32_bf16 v[188:191], v[52:55], a[76:79], v[188:191]
  s_waitcnt lgkmcnt(6)
  v_mfma_f32_16x16x32_bf16 v[192:195], v[56:59], a[64:67], v[192:195]
  ds_read_b64_tr_b16 v[52:53], v12 offset:18464
  ds_read_b64_tr_b16 v[54:55], v12 offset:23072
  v_mfma_f32_16x16x32_bf16 v[196:199], v[56:59], a[68:71], v[196:199]
  buffer_load_dwordx4 a[120:123], v16, s[16:19], s38 offen offset:2048 sc1
  v_mfma_f32_16x16x32_bf16 v[200:203], v[56:59], a[72:75], v[200:203]
  v_mfma_f32_16x16x32_bf16 v[204:207], v[56:59], a[76:79], v[204:207]
  v_mfma_f32_16x16x32_bf16 v[208:211], v[60:63], a[64:67], v[208:211]
  ds_read_b64_tr_b16 v[56:57], v12 offset:18496
  ds_read_b64_tr_b16 v[58:59], v12 offset:23104
  v_mfma_f32_16x16x32_bf16 v[212:215], v[60:63], a[68:71], v[212:215]
  v_mfma_f32_16x16x32_bf16 v[216:219], v[60:63], a[72:75], v[216:219]
  buffer_load_dwordx4 a[124:127], v16, s[16:19], s38 offen offset:3072 sc1
  v_mfma_f32_16x16x32_bf16 v[220:223], v[60:63], a[76:79], v[220:223]
  s_waitcnt lgkmcnt(6)
  v_mfma_f32_16x16x32_bf16 v[224:227], v[64:67], a[64:67], v[224:227]
  ds_read_b64_tr_b16 v[60:61], v12 offset:18528
  ds_read_b64_tr_b16 v[62:63], v12 offset:23136
  v_mfma_f32_16x16x32_bf16 v[228:231], v[64:67], a[68:71], v[228:231]
  v_mfma_f32_16x16x32_bf16 v[232:235], v[64:67], a[72:75], v[232:235]
  v_mfma_f32_16x16x32_bf16 v[236:239], v[64:67], a[76:79], v[236:239]
  v_mfma_f32_16x16x32_bf16 v[240:243], v[68:71], a[64:67], v[240:243]
  ds_read_b64_tr_b16 v[64:65], v12 offset:18560
  ds_read_b64_tr_b16 v[66:67], v12 offset:23168
  v_mfma_f32_16x16x32_bf16 v[244:247], v[68:71], a[68:71], v[244:247]
  v_mfma_f32_16x16x32_bf16 v[248:251], v[68:71], a[72:75], v[248:251]
  v_mfma_f32_16x16x32_bf16 v[252:255], v[68:71], a[76:79], v[252:255]
  s_barrier
  s_waitcnt vmcnt(12) lgkmcnt(6)
  v_mfma_f32_16x16x32_bf16 v[112:115], v[48:51], a[80:83], v[112:115]
  ds_read_b64_tr_b16 v[68:69], v12 offset:18592
  ds_read_b64_tr_b16 v[70:71], v12 offset:23200
  v_mfma_f32_16x16x32_bf16 v[116:119], v[48:51], a[84:87], v[116:119]
  v_mfma_f32_16x16x32_bf16 v[120:123], v[48:51], a[88:91], v[120:123]
  s_add_u32 m0, s40, 0
  s_add_u32 s38, s79, 12288
  v_mfma_f32_16x16x32_bf16 v[124:127], v[48:51], a[92:95], v[124:127]
  v_mfma_f32_16x16x32_bf16 v[128:131], v[52:55], a[80:83], v[128:131]
  ds_read_b64_tr_b16 v[48:49], v12 offset:18624
  ds_read_b64_tr_b16 v[50:51], v12 offset:23232
  v_mfma_f32_16x16x32_bf16 v[132:135], v[52:55], a[84:87], v[132:135]
  buffer_load_dwordx4 a[128:131], v16, s[16:19], s38 offen offset:0 sc1
  v_mfma_f32_16x16x32_bf16 v[136:139], v[52:55], a[88:91], v[136:139]
  v_mfma_f32_16x16x32_bf16 v[140:143], v[52:55], a[92:95], v[140:143]
  s_waitcnt lgkmcnt(6)
  v_mfma_f32_16x16x32_bf16 v[144:147], v[56:59], a[80:83], v[144:147]
  ds_read_b64_tr_b16 v[52:53], v12 offset:18656
  ds_read_b64_tr_b16 v[54:55], v12 offset:23264
  v_mfma_f32_16x16x32_bf16 v[148:151], v[56:59], a[84:87], v[148:151]
  buffer_load_dwordx4 a[132:135], v16, s[16:19], s38 offen offset:1024 sc1
  v_mfma_f32_16x16x32_bf16 v[152:155], v[56:59], a[88:91], v[152:155]
  buffer_load_dwordx4 v1, s[8:11], s90 offen offset:0 lds
  v_mfma_f32_16x16x32_bf16 v[156:159], v[56:59], a[92:95], v[156:159]
  buffer_load_dwordx4 a[136:139], v16, s[16:19], s38 offen offset:2048 sc1
  v_mfma_f32_16x16x32_bf16 v[160:163], v[60:63], a[80:83], v[160:163]
  ds_read_b64_tr_b16 v[56:57], v12 offset:18688
  ds_read_b64_tr_b16 v[58:59], v12 offset:23296
  v_mfma_f32_16x16x32_bf16 v[164:167], v[60:63], a[84:87], v[164:167]
  v_mfma_f32_16x16x32_bf16 v[168:171], v[60:63], a[88:91], v[168:171]
  buffer_load_dwordx4 a[140:143], v16, s[16:19], s38 offen offset:3072 sc1
  v_mfma_f32_16x16x32_bf16 v[172:175], v[60:63], a[92:95], v[172:175]
  s_waitcnt lgkmcnt(6)
  v_mfma_f32_16x16x32_bf16 v[176:179], v[64:67], a[80:83], v[176:179]
  ds_read_b64_tr_b16 v[60:61], v12 offset:27648
  ds_read_b64_tr_b16 v[62:63], v12 offset:32256
  v_mfma_f32_16x16x32_bf16 v[180:183], v[64:67], a[84:87], v[180:183]
  s_add_u32 s38, s80, 0
  v_mfma_f32_16x16x32_bf16 v[184:187], v[64:67], a[88:91], v[184:187]
  buffer_load_dwordx4 v2, s[8:11], s90 offen offset:1024 lds
  v_mfma_f32_16x16x32_bf16 v[188:191], v[64:67], a[92:95], v[188:191]
  v_mfma_f32_16x16x32_bf16 v[192:195], v[68:71], a[80:83], v[192:195]
  ds_read_b64_tr_b16 v[64:65], v12 offset:27680
  ds_read_b64_tr_b16 v[66:67], v12 offset:32288
  v_mfma_f32_16x16x32_bf16 v[196:199], v[68:71], a[84:87], v[196:199]
  buffer_load_dwordx4 a[144:147], v16, s[16:19], s38 offen offset:0 sc1
  v_mfma_f32_16x16x32_bf16 v[200:203], v[68:71], a[88:91], v[200:203]
  v_mfma_f32_16x16x32_bf16 v[204:207], v[68:71], a[92:95], v[204:207]
  s_waitcnt lgkmcnt(6)
  v_mfma_f32_16x16x32_bf16 v[208:211], v[48:51], a[80:83], v[208:211]
  ds_read_b64_tr_b16 v[68:69], v12 offset:27712
  ds_read_b64_tr_b16 v[70:71], v12 offset:32320
  v_mfma_f32_16x16x32_bf16 v[212:215], v[48:51], a[84:87], v[212:215]
  buffer_load_dwordx4 a[148:151], v16, s[16:19], s38 offen offset:1024 sc1
  v_mfma_f32_16x16x32_bf16 v[216:219], v[48:51], a[88:91], v[216:219]
  buffer_load_dwordx4 v3, s[8:11], s90 offen offset:2048 lds
  v_mfma_f32_16x16x32_bf16 v[220:223], v[48:51], a[92:95], v[220:223]
  buffer_load_dwordx4 a[152:155], v16, s[16:19], s38 offen offset:2048 sc1
  v_mfma_f32_16x16x32_bf16 v[224:227], v[52:55], a[80:83], v[224:227]
  ds_read_b64_tr_b16 v[48:49], v12 offset:27744
  ds_read_b64_tr_b16 v[50:51], v12 offset:32352
  v_mfma_f32_16x16x32_bf16 v[228:231], v[52:55], a[84:87], v[228:231]
  buffer_load_dwordx4 a[156:159], v16, s[16:19], s38 offen offset:3072 sc1
  v_mfma_f32_16x16x32_bf16 v[232:235], v[52:55], a[88:91], v[232:235]
  v_mfma_f32_16x16x32_bf16 v[236:239], v[52:55], a[92:95], v[236:239]
  s_waitcnt lgkmcnt(6)
  v_mfma_f32_16x16x32_bf16 v[240:243], v[56:59], a[80:83], v[240:243]
  ds_read_b64_tr_b16 v[52:53], v12 offset:27776
  ds_read_b64_tr_b16 v[54:55], v12 offset:32384
  v_mfma_f32_16x16x32_bf16 v[244:247], v[56:59], a[84:87], v[244:247]
  v_mfma_f32_16x16x32_bf16 v[248:251], v[56:59], a[88:91], v[248:251]
  buffer_load_dwordx4 v4, s[8:11], s90 offen offset:3072 lds
  v_mfma_f32_16x16x32_bf16 v[252:255], v[56:59], a[92:95], v[252:255]
  s_waitcnt vmcnt(16)
  v_mfma_f32_16x16x32_bf16 v[112:115], v[60:63], a[96:99], v[112:115]
  ds_read_b64_tr_b16 v[56:57], v12 offset:27808
  ds_read_b64_tr_b16 v[58:59], v12 offset:32416
  v_mfma_f32_16x16x32_bf16 v[116:119], v[60:63], a[100:103], v[116:119]
  v_mfma_f32_16x16x32_bf16 v[120:123], v[60:63], a[104:107], v[120:123]
  s_mov_b32 exec_hi, 0
  buffer_load_dword v73, v14, s[16:19], s82 offen sc1
  s_mov_b32 exec_hi, -1
  v_mfma_f32_16x16x32_bf16 v[124:127], v[60:63], a[108:111], v[124:127]
  s_waitcnt lgkmcnt(6)
  v_mfma_f32_16x16x32_bf16 v[128:131], v[64:67], a[96:99], v[128:131]
  ds_read_b64_tr_b16 v[60:61], v12 offset:27840
  ds_read_b64_tr_b16 v[62:63], v12 offset:32448
  v_mfma_f32_16x16x32_bf16 v[132:135], v[64:67], a[100:103], v[132:135]
  v_mfma_f32_16x16x32_bf16 v[136:139], v[64:67], a[104:107], v[136:139]
  s_add_u32 m0, s40, 4096
  v_mfma_f32_16x16x32_bf16 v[140:143], v[64:67], a[108:111], v[140:143]
  s_add_u32 s38, s80, 4096
  v_mfma_f32_16x16x32_bf16 v[144:147], v[68:71], a[96:99], v[144:147]
  ds_read_b64_tr_b16 v[64:65], v12 offset:27872
  ds_read_b64_tr_b16 v[66:67], v12 offset:32480
  v_mfma_f32_16x16x32_bf16 v[148:151], v[68:71], a[100:103], v[148:151]
  v_mfma_f32_16x16x32_bf16 v[152:155], v[68:71], a[104:107], v[152:155]
  v_mfma_f32_16x16x32_bf16 v[156:159], v[68:71], a[108:111], v[156:159]
  s_waitcnt lgkmcnt(6)
  v_mfma_f32_16x16x32_bf16 v[160:163], v[48:51], a[96:99], v[160:163]
  ds_read_b64_tr_b16 v[68:69], v12 offset:27904
  ds_read_b64_tr_b16 v[70:71], v12 offset:32512
  v_mfma_f32_16x16x32_bf16 v[164:167], v[48:51], a[100:103], v[164:167]
  buffer_load_dwordx4 a[160:163], v16, s[16:19], s38 offen offset:0 sc1
  v_mfma_f32_16x16x32_bf16 v[168:171], v[48:51], a[104:107], v[168:171]
  buffer_load_dwordx4 v5, s[8:11], s90 offen offset:0 lds
  v_mfma_f32_16x16x32_bf16 v[172:175], v[48:51], a[108:111], v[172:175]
  v_mfma_f32_16x16x32_bf16 v[176:179], v[52:55], a[96:99], v[176:179]
  ds_read_b64_tr_b16 v[48:49], v10 offset:36864
  ds_read_b64_tr_b16 v[50:51], v10 offset:41472
  v_mfma_f32_16x16x32_bf16 v[180:183], v[52:55], a[100:103], v[180:183]
  buffer_load_dwordx4 a[164:167], v16, s[16:19], s38 offen offset:1024 sc1
  v_mfma_f32_16x16x32_bf16 v[184:187], v[52:55], a[104:107], v[184:187]
  v_mfma_f32_16x16x32_bf16 v[188:191], v[52:55], a[108:111], v[188:191]
  s_waitcnt lgkmcnt(6)
  v_mfma_f32_16x16x32_bf16 v[192:195], v[56:59], a[96:99], v[192:195]
  ds_read_b64_tr_b16 v[52:53], v10 offset:36896
  ds_read_b64_tr_b16 v[54:55], v10 offset:41504
  v_mfma_f32_16x16x32_bf16 v[196:199], v[56:59], a[100:103], v[196:199]
  v_mfma_f32_16x16x32_bf16 v[200:203], v[56:59], a[104:107], v[200:203]
  buffer_load_dwordx4 v6, s[8:11], s90 offen offset:1024 lds
  v_mfma_f32_16x16x32_bf16 v[204:207], v[56:59], a[108:111], v[204:207]
  buffer_load_dwordx4 a[168:171], v16, s[16:19], s38 offen offset:2048 sc1
  v_mfma_f32_16x16x32_bf16 v[208:211], v[60:63], a[96:99], v[208:211]
  ds_read_b64_tr_b16 v[56:57], v10 offset:36928
  ds_read_b64_tr_b16 v[58:59], v10 offset:41536
  v_mfma_f32_16x16x32_bf16 v[212:215], v[60:63], a[100:103], v[212:215]
  v_mfma_f32_16x16x32_bf16 v[216:219], v[60:63], a[104:107], v[216:219]
  v_mfma_f32_16x16x32_bf16 v[220:223], v[60:63], a[108:111], v[220:223]
  s_waitcnt lgkmcnt(6)
  v_mfma_f32_16x16x32_bf16 v[224:227], v[64:67], a[96:99], v[224:227]
  ds_read_b64_tr_b16 v[60:61], v10 offset:36960
  ds_read_b64_tr_b16 v[62:63], v10 offset:41568
  v_mfma_f32_16x16x32_bf16 v[228:231], v[64:67], a[100:103], v[228:231]
  buffer_load_dwordx4 a[172:175], v16, s[16:19], s38 offen offset:3072 sc1
  v_mfma_f32_16x16x32_bf16 v[232:235], v[64:67], a[104:107], v[232:235]
  buffer_load_dwordx4 v7, s[8:11], s90 offen offset:2048 lds
  v_mfma_f32_16x16x32_bf16 v[236:239], v[64:67], a[108:111], v[236:239]
  v_mfma_f32_16x16x32_bf16 v[240:243], v[68:71], a[96:99], v[240:243]
  ds_read_b64_tr_b16 v[64:65], v10 offset:36992
  ds_read_b64_tr_b16 v[66:67], v10 offset:41600
  v_mfma_f32_16x16x32_bf16 v[244:247], v[68:71], a[100:103], v[244:247]
  v_mfma_f32_16x16x32_bf16 v[248:251], v[68:71], a[104:107], v[248:251]
  v_mfma_f32_16x16x32_bf16 v[252:255], v[68:71], a[108:111], v[252:255]
  s_waitcnt vmcnt(20) lgkmcnt(6)
  v_mfma_f32_16x16x32_bf16 v[112:115], v[48:51], a[112:115], v[112:115]
  ds_read_b64_tr_b16 v[68:69], v10 offset:37024
  ds_read_b64_tr_b16 v[70:71], v10 offset:41632
  v_mfma_f32_16x16x32_bf16 v[116:119], v[48:51], a[116:119], v[116:119]
  v_mfma_f32_16x16x32_bf16 v[120:123], v[48:51], a[120:123], v[120:123]
  buffer_load_dwordx4 v8, s[8:11], s90 offen offset:3072 lds
  v_mfma_f32_16x16x32_bf16 v[124:127], v[48:51], a[124:127], v[124:127]
  s_lshr_b32 s52, s2, 3
  s_lshl_b32 s52, s52, 2
  s_add_u32 s52, s52, s3
  s_lshl_b32 s52, s52, 9
  s_mov_b64 exec, 0xf
  buffer_load_dword v73, v72, s[48:51], s52 offen
  s_mov_b64 exec, -1
  v_mfma_f32_16x16x32_bf16 v[128:131], v[52:55], a[112:115], v[128:131]
  ds_read_b64_tr_b16 v[48:49], v10 offset:37056
  ds_read_b64_tr_b16 v[50:51], v10 offset:41664
  v_mfma_f32_16x16x32_bf16 v[132:135], v[52:55], a[116:119], v[132:135]
  v_mfma_f32_16x16x32_bf16 v[136:139], v[52:55], a[120:123], v[136:139]
  v_mfma_f32_16x16x32_bf16 v[140:143], v[52:55], a[124:127], v[140:143]
  s_add_u32 s38, s80, 8192
  s_waitcnt lgkmcnt(6)
  v_mfma_f32_16x16x32_bf16 v[144:147], v[56:59], a[112:115], v[144:147]
  ds_read_b64_tr_b16 v[52:53], v10 offset:37088
  ds_read_b64_tr_b16 v[54:55], v10 offset:41696
  v_mfma_f32_16x16x32_bf16 v[148:151], v[56:59], a[116:119], v[148:151]
  v_mfma_f32_16x16x32_bf16 v[152:155], v[56:59], a[120:123], v[152:155]
  s_add_u32 m0, s40, 8192
  v_mfma_f32_16x16x32_bf16 v[156:159], v[56:59], a[124:127], v[156:159]
  v_mfma_f32_16x16x32_bf16 v[160:163], v[60:63], a[112:115], v[160:163]
  ds_read_b64_tr_b16 v[56:57], v10 offset:37120
  ds_read_b64_tr_b16 v[58:59], v10 offset:41728
  v_mfma_f32_16x16x32_bf16 v[164:167], v[60:63], a[116:119], v[164:167]
  buffer_load_dwordx4 a[176:179], v16, s[16:19], s38 offen offset:0 sc1
  v_mfma_f32_16x16x32_bf16 v[168:171], v[60:63], a[120:123], v[168:171]
  v_mfma_f32_16x16x32_bf16 v[172:175], v[60:63], a[124:127], v[172:175]
  s_waitcnt lgkmcnt(6)
  v_mfma_f32_16x16x32_bf16 v[176:179], v[64:67], a[112:115], v[176:179]
  ds_read_b64_tr_b16 v[60:61], v10 offset:46080
  ds_read_b64_tr_b16 v[62:63], v10 offset:50688
  v_mfma_f32_16x16x32_bf16 v[180:183], v[64:67], a[116:119], v[180:183]
  buffer_load_dwordx4 a[180:183], v16, s[16:19], s38 offen offset:1024 sc1
  v_mfma_f32_16x16x32_bf16 v[184:187], v[64:67], a[120:123], v[184:187]
  buffer_load_dwordx4 v9, s[8:11], s90 offen offset:0 lds
  v_mfma_f32_16x16x32_bf16 v[188:191], v[64:67], a[124:127], v[188:191]
  v_mfma_f32_16x16x32_bf16 v[192:195], v[68:71], a[112:115], v[192:195]
  ds_read_b64_tr_b16 v[64:65], v10 offset:46112
  ds_read_b64_tr_b16 v[66:67], v10 offset:50720
  v_mfma_f32_16x16x32_bf16 v[196:199], v[68:71], a[116:119], v[196:199]
  v_mfma_f32_16x16x32_bf16 v[200:203], v[68:71], a[120:123], v[200:203]
  buffer_load_dwordx4 a[184:187], v16, s[16:19], s38 offen offset:2048 sc1
  v_mfma_f32_16x16x32_bf16 v[204:207], v[68:71], a[124:127], v[204:207]
  s_waitcnt lgkmcnt(6)
  v_mfma_f32_16x16x32_bf16 v[208:211], v[48:51], a[112:115], v[208:211]
  ds_read_b64_tr_b16 v[68:69], v10 offset:46144
  ds_read_b64_tr_b16 v[70:71], v10 offset:50752
  v_mfma_f32_16x16x32_bf16 v[212:215], v[48:51], a[116:119], v[212:215]
  v_mfma_f32_16x16x32_bf16 v[216:219], v[48:51], a[120:123], v[216:219]
  v_mfma_f32_16x16x32_bf16 v[220:223], v[48:51], a[124:127], v[220:223]
  buffer_load_dwordx4 a[188:191], v16, s[16:19], s38 offen offset:3072 sc1
  v_mfma_f32_16x16x32_bf16 v[224:227], v[52:55], a[112:115], v[224:227]
  ds_read_b64_tr_b16 v[48:49], v10 offset:46176
  ds_read_b64_tr_b16 v[50:51], v10 offset:50784
  v_mfma_f32_16x16x32_bf16 v[228:231], v[52:55], a[116:119], v[228:231]
  v_mfma_f32_16x16x32_bf16 v[232:235], v[52:55], a[120:123], v[232:235]
  v_mfma_f32_16x16x32_bf16 v[236:239], v[52:55], a[124:127], v[236:239]
  s_waitcnt lgkmcnt(6)
  v_mfma_f32_16x16x32_bf16 v[240:243], v[56:59], a[112:115], v[240:243]
  ds_read_b64_tr_b16 v[52:53], v10 offset:46208
  ds_read_b64_tr_b16 v[54:55], v10 offset:50816
  v_mfma_f32_16x16x32_bf16 v[244:247], v[56:59], a[116:119], v[244:247]
  v_mfma_f32_16x16x32_bf16 v[248:251], v[56:59], a[120:123], v[248:251]
  v_mfma_f32_16x16x32_bf16 v[252:255], v[56:59], a[124:127], v[252:255]
  s_barrier
  s_waitcnt vmcnt(22)
  v_mfma_f32_16x16x32_bf16 v[112:115], v[60:63], a[128:131], v[112:115]
  ds_read_b64_tr_b16 v[56:57], v10 offset:46240
  ds_read_b64_tr_b16 v[58:59], v10 offset:50848
  v_mfma_f32_16x16x32_bf16 v[116:119], v[60:63], a[132:135], v[116:119]
  v_mfma_f32_16x16x32_bf16 v[120:123], v[60:63], a[136:139], v[120:123]
  s_add_u32 s38, s80, 12288
  v_mfma_f32_16x16x32_bf16 v[124:127], v[60:63], a[140:143], v[124:127]
  s_waitcnt lgkmcnt(6)
  v_mfma_f32_16x16x32_bf16 v[128:131], v[64:67], a[128:131], v[128:131]
  ds_read_b64_tr_b16 v[60:61], v10 offset:46272
  ds_read_b64_tr_b16 v[62:63], v10 offset:50880
  v_mfma_f32_16x16x32_bf16 v[132:135], v[64:67], a[132:135], v[132:135]
  v_mfma_f32_16x16x32_bf16 v[136:139], v[64:67], a[136:139], v[136:139]
  v_mfma_f32_16x16x32_bf16 v[140:143], v[64:67], a[140:143], v[140:143]
  v_mfma_f32_16x16x32_bf16 v[144:147], v[68:71], a[128:131], v[144:147]
  ds_read_b64_tr_b16 v[64:65], v10 offset:46304
  ds_read_b64_tr_b16 v[66:67], v10 offset:50912
  v_mfma_f32_16x16x32_bf16 v[148:151], v[68:71], a[132:135], v[148:151]
  buffer_load_dwordx4 a[192:195], v16, s[16:19], s38 offen offset:0 sc1
  v_mfma_f32_16x16x32_bf16 v[152:155], v[68:71], a[136:139], v[152:155]
  v_mfma_f32_16x16x32_bf16 v[156:159], v[68:71], a[140:143], v[156:159]
  s_waitcnt lgkmcnt(6)
  v_mfma_f32_16x16x32_bf16 v[160:163], v[48:51], a[128:131], v[160:163]
  ds_read_b64_tr_b16 v[68:69], v10 offset:46336
  ds_read_b64_tr_b16 v[70:71], v10 offset:50944
  v_mfma_f32_16x16x32_bf16 v[164:167], v[48:51], a[132:135], v[164:167]
  v_mfma_f32_16x16x32_bf16 v[168:171], v[48:51], a[136:139], v[168:171]
  buffer_load_dwordx4 a[196:199], v16, s[16:19], s38 offen offset:1024 sc1
  v_mfma_f32_16x16x32_bf16 v[172:175], v[48:51], a[140:143], v[172:175]
  v_mfma_f32_16x16x32_bf16 v[176:179], v[52:55], a[128:131], v[176:179]
  ds_read_b64_tr_b16 v[48:49], v11 offset:0
  ds_read_b64_tr_b16 v[50:51], v11 offset:4608
  v_mfma_f32_16x16x32_bf16 v[180:183], v[52:55], a[132:135], v[180:183]
  v_mfma_f32_16x16x32_bf16 v[184:187], v[52:55], a[136:139], v[184:187]
  v_mfma_f32_16x16x32_bf16 v[188:191], v[52:55], a[140:143], v[188:191]
  s_waitcnt lgkmcnt(6)
  v_mfma_f32_16x16x32_bf16 v[192:195], v[56:59], a[128:131], v[192:195]
  ds_read_b64_tr_b16 v[52:53], v11 offset:32
  ds_read_b64_tr_b16 v[54:55], v11 offset:4640
  v_mfma_f32_16x16x32_bf16 v[196:199], v[56:59], a[132:135], v[196:199]
  buffer_load_dwordx4 a[200:203], v16, s[16:19], s38 offen offset:2048 sc1
  v_mfma_f32_16x16x32_bf16 v[200:203], v[56:59], a[136:139], v[200:203]
  v_mfma_f32_16x16x32_bf16 v[204:207], v[56:59], a[140:143], v[204:207]
  v_mfma_f32_16x16x32_bf16 v[208:211], v[60:63], a[128:131], v[208:211]
  ds_read_b64_tr_b16 v[56:57], v11 offset:64
  ds_read_b64_tr_b16 v[58:59], v11 offset:4672
  v_mfma_f32_16x16x32_bf16 v[212:215], v[60:63], a[132:135], v[212:215]
  v_mfma_f32_16x16x32_bf16 v[216:219], v[60:63], a[136:139], v[216:219]
  buffer_load_dwordx4 a[204:207], v16, s[16:19], s38 offen offset:3072 sc1
  v_mfma_f32_16x16x32_bf16 v[220:223], v[60:63], a[140:143], v[220:223]
  s_waitcnt lgkmcnt(6)
  v_mfma_f32_16x16x32_bf16 v[224:227], v[64:67], a[128:131], v[224:227]
  ds_read_b64_tr_b16 v[60:61], v11 offset:96
  ds_read_b64_tr_b16 v[62:63], v11 offset:4704
  v_mfma_f32_16x16x32_bf16 v[228:231], v[64:67], a[132:135], v[228:231]
  v_mfma_f32_16x16x32_bf16 v[232:235], v[64:67], a[136:139], v[232:235]
  v_mfma_f32_16x16x32_bf16 v[236:239], v[64:67], a[140:143], v[236:239]
  v_mfma_f32_16x16x32_bf16 v[240:243], v[68:71], a[128:131], v[240:243]
  ds_read_b64_tr_b16 v[64:65], v11 offset:128
  ds_read_b64_tr_b16 v[66:67], v11 offset:4736
  v_mfma_f32_16x16x32_bf16 v[244:247], v[68:71], a[132:135], v[244:247]
  v_mfma_f32_16x16x32_bf16 v[248:251], v[68:71], a[136:139], v[248:251]
  v_mfma_f32_16x16x32_bf16 v[252:255], v[68:71], a[140:143], v[252:255]
  s_barrier
  s_waitcnt vmcnt(20) lgkmcnt(6)
  v_mfma_f32_16x16x32_bf16 v[112:115], v[48:51], a[144:147], v[112:115]
  ds_read_b64_tr_b16 v[68:69], v11 offset:160
  ds_read_b64_tr_b16 v[70:71], v11 offset:4768
  v_mfma_f32_16x16x32_bf16 v[116:119], v[48:51], a[148:151], v[116:119]
  v_mfma_f32_16x16x32_bf16 v[120:123], v[48:51], a[152:155], v[120:123]
  s_add_u32 m0, s41, 0
  v_mfma_f32_16x16x32_bf16 v[124:127], v[48:51], a[156:159], v[124:127]
  s_mov_b32 exec_hi, 0
  buffer_load_dword v73, v14, s[16:19], s83 offen sc1
  s_mov_b32 exec_hi, -1
  v_mfma_f32_16x16x32_bf16 v[128:131], v[52:55], a[144:147], v[128:131]
  ds_read_b64_tr_b16 v[48:49], v11 offset:192
  ds_read_b64_tr_b16 v[50:51], v11 offset:4800
  v_mfma_f32_16x16x32_bf16 v[132:135], v[52:55], a[148:151], v[132:135]
  s_add_u32 s38, s81, 0
  v_mfma_f32_16x16x32_bf16 v[136:139], v[52:55], a[152:155], v[136:139]
  buffer_load_dwordx4 a[208:211], v16, s[16:19], s38 offen offset:0 sc1
  v_mfma_f32_16x16x32_bf16 v[140:143], v[52:55], a[156:159], v[140:143]
  s_waitcnt lgkmcnt(6)
  v_mfma_f32_16x16x32_bf16 v[144:147], v[56:59], a[144:147], v[144:147]
  ds_read_b64_tr_b16 v[52:53], v11 offset:224
  ds_read_b64_tr_b16 v[54:55], v11 offset:4832
  v_mfma_f32_16x16x32_bf16 v[148:151], v[56:59], a[148:151], v[148:151]
  buffer_load_dwordx4 a[212:215], v16, s[16:19], s38 offen offset:1024 sc1
  v_mfma_f32_16x16x32_bf16 v[152:155], v[56:59], a[152:155], v[152:155]
  buffer_load_dwordx4 v1, s[8:11], s91 offen offset:0 lds
  v_mfma_f32_16x16x32_bf16 v[156:159], v[56:59], a[156:159], v[156:159]
  buffer_load_dwordx4 a[216:219], v16, s[16:19], s38 offen offset:2048 sc1
  v_mfma_f32_16x16x32_bf16 v[160:163], v[60:63], a[144:147], v[160:163]
  ds_read_b64_tr_b16 v[56:57], v11 offset:256
  ds_read_b64_tr_b16 v[58:59], v11 offset:4864
  v_mfma_f32_16x16x32_bf16 v[164:167], v[60:63], a[148:151], v[164:167]
  buffer_load_dwordx4 a[220:223], v16, s[16:19], s38 offen offset:3072 sc1
  v_mfma_f32_16x16x32_bf16 v[168:171], v[60:63], a[152:155], v[168:171]
  s_add_u32 s38, s81, 4096
  v_mfma_f32_16x16x32_bf16 v[172:175], v[60:63], a[156:159], v[172:175]
  s_waitcnt lgkmcnt(6)
  v_mfma_f32_16x16x32_bf16 v[176:179], v[64:67], a[144:147], v[176:179]
  ds_read_b64_tr_b16 v[60:61], v11 offset:9216
  ds_read_b64_tr_b16 v[62:63], v11 offset:13824
  v_mfma_f32_16x16x32_bf16 v[180:183], v[64:67], a[148:151], v[180:183]
  buffer_load_dwordx4 a[224:227], v16, s[16:19], s38 offen offset:0 sc1
  v_mfma_f32_16x16x32_bf16 v[184:187], v[64:67], a[152:155], v[184:187]
  buffer_load_dwordx4 v2, s[8:11], s91 offen offset:1024 lds
  v_mfma_f32_16x16x32_bf16 v[188:191], v[64:67], a[156:159], v[188:191]
  buffer_load_dwordx4 a[228:231], v16, s[16:19], s38 offen offset:1024 sc1
  v_mfma_f32_16x16x32_bf16 v[192:195], v[68:71], a[144:147], v[192:195]
  ds_read_b64_tr_b16 v[64:65], v11 offset:9248
  ds_read_b64_tr_b16 v[66:67], v11 offset:13856
  v_mfma_f32_16x16x32_bf16 v[196:199], v[68:71], a[148:151], v[196:199]
  buffer_load_dwordx4 a[232:235], v16, s[16:19], s38 offen offset:2048 sc1
  v_mfma_f32_16x16x32_bf16 v[200:203], v[68:71], a[152:155], v[200:203]
  buffer_load_dwordx4 a[236:239], v16, s[16:19], s38 offen offset:3072 sc1
  v_mfma_f32_16x16x32_bf16 v[204:207], v[68:71], a[156:159], v[204:207]
  s_waitcnt lgkmcnt(6)
  v_mfma_f32_16x16x32_bf16 v[208:211], v[48:51], a[144:147], v[208:211]
  ds_read_b64_tr_b16 v[68:69], v11 offset:9280
  ds_read_b64_tr_b16 v[70:71], v11 offset:13888
  v_mfma_f32_16x16x32_bf16 v[212:215], v[48:51], a[148:151], v[212:215]
  v_mfma_f32_16x16x32_bf16 v[216:219], v[48:51], a[152:155], v[216:219]
  buffer_load_dwordx4 v3, s[8:11], s91 offen offset:2048 lds
  v_mfma_f32_16x16x32_bf16 v[220:223], v[48:51], a[156:159], v[220:223]
  v_mfma_f32_16x16x32_bf16 v[224:227], v[52:55], a[144:147], v[224:227]
  ds_read_b64_tr_b16 v[48:49], v11 offset:9312
  ds_read_b64_tr_b16 v[50:51], v11 offset:13920
  v_mfma_f32_16x16x32_bf16 v[228:231], v[52:55], a[148:151], v[228:231]
  v_mfma_f32_16x16x32_bf16 v[232:235], v[52:55], a[152:155], v[232:235]
  v_mfma_f32_16x16x32_bf16 v[236:239], v[52:55], a[156:159], v[236:239]
  s_waitcnt lgkmcnt(6)
  v_mfma_f32_16x16x32_bf16 v[240:243], v[56:59], a[144:147], v[240:243]
  ds_read_b64_tr_b16 v[52:53], v11 offset:9344
  ds_read_b64_tr_b16 v[54:55], v11 offset:13952
  v_mfma_f32_16x16x32_bf16 v[244:247], v[56:59], a[148:151], v[244:247]
  v_mfma_f32_16x16x32_bf16 v[248:251], v[56:59], a[152:155], v[248:251]
  buffer_load_dwordx4 v4, s[8:11], s91 offen offset:3072 lds
  v_mfma_f32_16x16x32_bf16 v[252:255], v[56:59], a[156:159], v[252:255]
  s_waitcnt vmcnt(25)
  v_mfma_f32_16x16x32_bf16 v[112:115], v[60:63], a[160:163], v[112:115]
  ds_read_b64_tr_b16 v[56:57], v11 offset:9376
  ds_read_b64_tr_b16 v[58:59], v11 offset:13984
  v_mfma_f32_16x16x32_bf16 v[116:119], v[60:63], a[164:167], v[116:119]
  v_mfma_f32_16x16x32_bf16 v[120:123], v[60:63], a[168:171], v[120:123]
  s_add_u32 s38, s81, 8192
  v_mfma_f32_16x16x32_bf16 v[124:127], v[60:63], a[172:175], v[124:127]
  s_waitcnt lgkmcnt(6)
  v_mfma_f32_16x16x32_bf16 v[128:131], v[64:67], a[160:163], v[128:131]
  ds_read_b64_tr_b16 v[60:61], v11 offset:9408
  ds_read_b64_tr_b16 v[62:63], v11 offset:14016
  v_mfma_f32_16x16x32_bf16 v[132:135], v[64:67], a[164:167], v[132:135]
  v_mfma_f32_16x16x32_bf16 v[136:139], v[64:67], a[168:171], v[136:139]
  s_add_u32 m0, s41, 4096
  v_mfma_f32_16x16x32_bf16 v[140:143], v[64:67], a[172:175], v[140:143]
  v_mfma_f32_16x16x32_bf16 v[144:147], v[68:71], a[160:163], v[144:147]
  ds_read_b64_tr_b16 v[64:65], v11 offset:9440
  ds_read_b64_tr_b16 v[66:67], v11 offset:14048
  v_mfma_f32_16x16x32_bf16 v[148:151], v[68:71], a[164:167], v[148:151]
  buffer_load_dwordx4 a[240:243], v16, s[16:19], s38 offen offset:0 sc1
  v_mfma_f32_16x16x32_bf16 v[152:155], v[68:71], a[168:171], v[152:155]
  v_mfma_f32_16x16x32_bf16 v[156:159], v[68:71], a[172:175], v[156:159]
  s_waitcnt lgkmcnt(6)
  v_mfma_f32_16x16x32_bf16 v[160:163], v[48:51], a[160:163], v[160:163]
  ds_read_b64_tr_b16 v[68:69], v11 offset:9472
  ds_read_b64_tr_b16 v[70:71], v11 offset:14080
  v_mfma_f32_16x16x32_bf16 v[164:167], v[48:51], a[164:167], v[164:167]
  v_mfma_f32_16x16x32_bf16 v[168:171], v[48:51], a[168:171], v[168:171]
  buffer_load_dwordx4 v5, s[8:11], s91 offen offset:0 lds
  v_mfma_f32_16x16x32_bf16 v[172:175], v[48:51], a[172:175], v[172:175]
  buffer_load_dwordx4 a[244:247], v16, s[16:19], s38 offen offset:1024 sc1
  v_mfma_f32_16x16x32_bf16 v[176:179], v[52:55], a[160:163], v[176:179]
  ds_read_b64_tr_b16 v[48:49], v11 offset:18432
  ds_read_b64_tr_b16 v[50:51], v11 offset:23040
  v_mfma_f32_16x16x32_bf16 v[180:183], v[52:55], a[164:167], v[180:183]
  v_mfma_f32_16x16x32_bf16 v[184:187], v[52:55], a[168:171], v[184:187]
  v_mfma_f32_16x16x32_bf16 v[188:191], v[52:55], a[172:175], v[188:191]
  s_waitcnt lgkmcnt(6)
  v_mfma_f32_16x16x32_bf16 v[192:195], v[56:59], a[160:163], v[192:195]
  ds_read_b64_tr_b16 v[52:53], v11 offset:18464
  ds_read_b64_tr_b16 v[54:55], v11 offset:23072
  v_mfma_f32_16x16x32_bf16 v[196:199], v[56:59], a[164:167], v[196:199]
  buffer_load_dwordx4 a[248:251], v16, s[16:19], s38 offen offset:2048 sc1
  v_mfma_f32_16x16x32_bf16 v[200:203], v[56:59], a[168:171], v[200:203]
  buffer_load_dwordx4 v6, s[8:11], s91 offen offset:1024 lds
  v_mfma_f32_16x16x32_bf16 v[204:207], v[56:59], a[172:175], v[204:207]
  v_mfma_f32_16x16x32_bf16 v[208:211], v[60:63], a[160:163], v[208:211]
  ds_read_b64_tr_b16 v[56:57], v11 offset:18496
  ds_read_b64_tr_b16 v[58:59], v11 offset:23104
  v_mfma_f32_16x16x32_bf16 v[212:215], v[60:63], a[164:167], v[212:215]
  v_mfma_f32_16x16x32_bf16 v[216:219], v[60:63], a[168:171], v[216:219]
  buffer_load_dwordx4 a[252:255], v16, s[16:19], s38 offen offset:3072 sc1
  v_mfma_f32_16x16x32_bf16 v[220:223], v[60:63], a[172:175], v[220:223]
  s_waitcnt lgkmcnt(6)
  v_mfma_f32_16x16x32_bf16 v[224:227], v[64:67], a[160:163], v[224:227]
  ds_read_b64_tr_b16 v[60:61], v11 offset:18528
  ds_read_b64_tr_b16 v[62:63], v11 offset:23136
  v_mfma_f32_16x16x32_bf16 v[228:231], v[64:67], a[164:167], v[228:231]
  v_mfma_f32_16x16x32_bf16 v[232:235], v[64:67], a[168:171], v[232:235]
  buffer_load_dwordx4 v7, s[8:11], s91 offen offset:2048 lds
  v_mfma_f32_16x16x32_bf16 v[236:239], v[64:67], a[172:175], v[236:239]
  v_mfma_f32_16x16x32_bf16 v[240:243], v[68:71], a[160:163], v[240:243]
  ds_read_b64_tr_b16 v[64:65], v11 offset:18560
  ds_read_b64_tr_b16 v[66:67], v11 offset:23168
  v_mfma_f32_16x16x32_bf16 v[244:247], v[68:71], a[164:167], v[244:247]
  v_mfma_f32_16x16x32_bf16 v[248:251], v[68:71], a[168:171], v[248:251]
  v_mfma_f32_16x16x32_bf16 v[252:255], v[68:71], a[172:175], v[252:255]
  s_waitcnt vmcnt(24) lgkmcnt(6)
  v_mfma_f32_16x16x32_bf16 v[112:115], v[48:51], a[176:179], v[112:115]
  ds_read_b64_tr_b16 v[68:69], v11 offset:18592
  ds_read_b64_tr_b16 v[70:71], v11 offset:23200
  v_mfma_f32_16x16x32_bf16 v[116:119], v[48:51], a[180:183], v[116:119]
  v_mfma_f32_16x16x32_bf16 v[120:123], v[48:51], a[184:187], v[120:123]
  buffer_load_dwordx4 v8, s[8:11], s91 offen offset:3072 lds
  v_mfma_f32_16x16x32_bf16 v[124:127], v[48:51], a[188:191], v[124:127]
  s_add_u32 s38, s81, 12288
  v_mfma_f32_16x16x32_bf16 v[128:131], v[52:55], a[176:179], v[128:131]
  ds_read_b64_tr_b16 v[48:49], v11 offset:18624
  ds_read_b64_tr_b16 v[50:51], v11 offset:23232
  v_mfma_f32_16x16x32_bf16 v[132:135], v[52:55], a[180:183], v[132:135]
  v_mfma_f32_16x16x32_bf16 v[136:139], v[52:55], a[184:187], v[136:139]
  v_mfma_f32_16x16x32_bf16 v[140:143], v[52:55], a[188:191], v[140:143]
  s_waitcnt lgkmcnt(6)
  v_mfma_f32_16x16x32_bf16 v[144:147], v[56:59], a[176:179], v[144:147]
  ds_read_b64_tr_b16 v[52:53], v11 offset:18656
  ds_read_b64_tr_b16 v[54:55], v11 offset:23264
  v_mfma_f32_16x16x32_bf16 v[148:151], v[56:59], a[180:183], v[148:151]
  buffer_load_dwordx4 a[0:3], v16, s[16:19], s38 offen offset:0 sc1
  v_mfma_f32_16x16x32_bf16 v[152:155], v[56:59], a[184:187], v[152:155]
  s_add_u32 m0, s41, 8192
  v_mfma_f32_16x16x32_bf16 v[156:159], v[56:59], a[188:191], v[156:159]
  v_mfma_f32_16x16x32_bf16 v[160:163], v[60:63], a[176:179], v[160:163]
  ds_read_b64_tr_b16 v[56:57], v11 offset:18688
  ds_read_b64_tr_b16 v[58:59], v11 offset:23296
  v_mfma_f32_16x16x32_bf16 v[164:167], v[60:63], a[180:183], v[164:167]
  v_mfma_f32_16x16x32_bf16 v[168:171], v[60:63], a[184:187], v[168:171]
  buffer_load_dwordx4 a[4:7], v16, s[16:19], s38 offen offset:1024 sc1
  v_mfma_f32_16x16x32_bf16 v[172:175], v[60:63], a[188:191], v[172:175]
  s_waitcnt lgkmcnt(6)
  v_mfma_f32_16x16x32_bf16 v[176:179], v[64:67], a[176:179], v[176:179]
  ds_read_b64_tr_b16 v[60:61], v11 offset:27648
  ds_read_b64_tr_b16 v[62:63], v11 offset:32256
  v_mfma_f32_16x16x32_bf16 v[180:183], v[64:67], a[180:183], v[180:183]
  v_mfma_f32_16x16x32_bf16 v[184:187], v[64:67], a[184:187], v[184:187]
  buffer_load_dwordx4 v9, s[8:11], s91 offen offset:0 lds
  v_mfma_f32_16x16x32_bf16 v[188:191], v[64:67], a[188:191], v[188:191]
  v_mfma_f32_16x16x32_bf16 v[192:195], v[68:71], a[176:179], v[192:195]
  ds_read_b64_tr_b16 v[64:65], v11 offset:27680
  ds_read_b64_tr_b16 v[66:67], v11 offset:32288
  v_mfma_f32_16x16x32_bf16 v[196:199], v[68:71], a[180:183], v[196:199]
  buffer_load_dwordx4 a[8:11], v16, s[16:19], s38 offen offset:2048 sc1
  v_mfma_f32_16x16x32_bf16 v[200:203], v[68:71], a[184:187], v[200:203]
  v_mfma_f32_16x16x32_bf16 v[204:207], v[68:71], a[188:191], v[204:207]
  s_waitcnt lgkmcnt(6)
  v_mfma_f32_16x16x32_bf16 v[208:211], v[48:51], a[176:179], v[208:211]
  ds_read_b64_tr_b16 v[68:69], v11 offset:27712
  ds_read_b64_tr_b16 v[70:71], v11 offset:32320
  v_mfma_f32_16x16x32_bf16 v[212:215], v[48:51], a[180:183], v[212:215]
  v_mfma_f32_16x16x32_bf16 v[216:219], v[48:51], a[184:187], v[216:219]
  buffer_load_dwordx4 a[12:15], v16, s[16:19], s38 offen offset:3072 sc1
  v_mfma_f32_16x16x32_bf16 v[220:223], v[48:51], a[188:191], v[220:223]
  v_mfma_f32_16x16x32_bf16 v[224:227], v[52:55], a[176:179], v[224:227]
  ds_read_b64_tr_b16 v[48:49], v11 offset:27744
  ds_read_b64_tr_b16 v[50:51], v11 offset:32352
  v_mfma_f32_16x16x32_bf16 v[228:231], v[52:55], a[180:183], v[228:231]
  v_mfma_f32_16x16x32_bf16 v[232:235], v[52:55], a[184:187], v[232:235]
  v_mfma_f32_16x16x32_bf16 v[236:239], v[52:55], a[188:191], v[236:239]
  s_waitcnt lgkmcnt(6)
  v_mfma_f32_16x16x32_bf16 v[240:243], v[56:59], a[176:179], v[240:243]
  ds_read_b64_tr_b16 v[52:53], v11 offset:27776
  ds_read_b64_tr_b16 v[54:55], v11 offset:32384
  v_mfma_f32_16x16x32_bf16 v[244:247], v[56:59], a[180:183], v[244:247]
  v_mfma_f32_16x16x32_bf16 v[248:251], v[56:59], a[184:187], v[248:251]
  v_mfma_f32_16x16x32_bf16 v[252:255], v[56:59], a[188:191], v[252:255]
  s_barrier
  s_waitcnt vmcnt(26)
  v_mfma_f32_16x16x32_bf16 v[112:115], v[60:63], a[192:195], v[112:115]
  ds_read_b64_tr_b16 v[56:57], v11 offset:27808
  ds_read_b64_tr_b16 v[58:59], v11 offset:32416
  v_mfma_f32_16x16x32_bf16 v[116:119], v[60:63], a[196:199], v[116:119]
  v_mfma_f32_16x16x32_bf16 v[120:123], v[60:63], a[200:203], v[120:123]
  s_add_u32 s38, s82, 0
  v_mfma_f32_16x16x32_bf16 v[124:127], v[60:63], a[204:207], v[124:127]
  s_waitcnt lgkmcnt(6)
  v_mfma_f32_16x16x32_bf16 v[128:131], v[64:67], a[192:195], v[128:131]
  ds_read_b64_tr_b16 v[60:61], v11 offset:27840
  ds_read_b64_tr_b16 v[62:63], v11 offset:32448
  v_mfma_f32_16x16x32_bf16 v[132:135], v[64:67], a[196:199], v[132:135]
  v_mfma_f32_16x16x32_bf16 v[136:139], v[64:67], a[200:203], v[136:139]
  v_mfma_f32_16x16x32_bf16 v[140:143], v[64:67], a[204:207], v[140:143]
  v_mfma_f32_16x16x32_bf16 v[144:147], v[68:71], a[192:195], v[144:147]
  ds_read_b64_tr_b16 v[64:65], v11 offset:27872
  ds_read_b64_tr_b16 v[66:67], v11 offset:32480
  v_mfma_f32_16x16x32_bf16 v[148:151], v[68:71], a[196:199], v[148:151]
  buffer_load_dwordx4 a[16:19], v16, s[16:19], s38 offen offset:0 sc1
  v_mfma_f32_16x16x32_bf16 v[152:155], v[68:71], a[200:203], v[152:155]
  v_mfma_f32_16x16x32_bf16 v[156:159], v[68:71], a[204:207], v[156:159]
  s_waitcnt lgkmcnt(6)
  v_mfma_f32_16x16x32_bf16 v[160:163], v[48:51], a[192:195], v[160:163]
  ds_read_b64_tr_b16 v[68:69], v11 offset:27904
  ds_read_b64_tr_b16 v[70:71], v11 offset:32512
  v_mfma_f32_16x16x32_bf16 v[164:167], v[48:51], a[196:199], v[164:167]
  v_mfma_f32_16x16x32_bf16 v[168:171], v[48:51], a[200:203], v[168:171]
  buffer_load_dwordx4 a[20:23], v16, s[16:19], s38 offen offset:1024 sc1
  v_mfma_f32_16x16x32_bf16 v[172:175], v[48:51], a[204:207], v[172:175]
  v_mfma_f32_16x16x32_bf16 v[176:179], v[52:55], a[192:195], v[176:179]
  ds_read_b64_tr_b16 v[48:49], v11 offset:36864
  ds_read_b64_tr_b16 v[50:51], v11 offset:41472
  v_mfma_f32_16x16x32_bf16 v[180:183], v[52:55], a[196:199], v[180:183]
  v_mfma_f32_16x16x32_bf16 v[184:187], v[52:55], a[200:203], v[184:187]
  v_mfma_f32_16x16x32_bf16 v[188:191], v[52:55], a[204:207], v[188:191]
  s_waitcnt lgkmcnt(6)
  v_mfma_f32_16x16x32_bf16 v[192:195], v[56:59], a[192:195], v[192:195]
  ds_read_b64_tr_b16 v[52:53], v11 offset:36896
  ds_read_b64_tr_b16 v[54:55], v11 offset:41504
  v_mfma_f32_16x16x32_bf16 v[196:199], v[56:59], a[196:199], v[196:199]
  buffer_load_dwordx4 a[24:27], v16, s[16:19], s38 offen offset:2048 sc1
  v_mfma_f32_16x16x32_bf16 v[200:203], v[56:59], a[200:203], v[200:203]
  v_mfma_f32_16x16x32_bf16 v[204:207], v[56:59], a[204:207], v[204:207]
  v_mfma_f32_16x16x32_bf16 v[208:211], v[60:63], a[192:195], v[208:211]
  ds_read_b64_tr_b16 v[56:57], v11 offset:36928
  ds_read_b64_tr_b16 v[58:59], v11 offset:41536
  v_mfma_f32_16x16x32_bf16 v[212:215], v[60:63], a[196:199], v[212:215]
  v_mfma_f32_16x16x32_bf16 v[216:219], v[60:63], a[200:203], v[216:219]
  buffer_load_dwordx4 a[28:31], v16, s[16:19], s38 offen offset:3072 sc1
  v_mfma_f32_16x16x32_bf16 v[220:223], v[60:63], a[204:207], v[220:223]
  s_waitcnt lgkmcnt(6)
  v_mfma_f32_16x16x32_bf16 v[224:227], v[64:67], a[192:195], v[224:227]
  ds_read_b64_tr_b16 v[60:61], v11 offset:36960
  ds_read_b64_tr_b16 v[62:63], v11 offset:41568
  v_mfma_f32_16x16x32_bf16 v[228:231], v[64:67], a[196:199], v[228:231]
  v_mfma_f32_16x16x32_bf16 v[232:235], v[64:67], a[200:203], v[232:235]
  v_mfma_f32_16x16x32_bf16 v[236:239], v[64:67], a[204:207], v[236:239]
  v_mfma_f32_16x16x32_bf16 v[240:243], v[68:71], a[192:195], v[240:243]
  ds_read_b64_tr_b16 v[64:65], v11 offset:36992
  ds_read_b64_tr_b16 v[66:67], v11 offset:41600
  v_mfma_f32_16x16x32_bf16 v[244:247], v[68:71], a[196:199], v[244:247]
  v_mfma_f32_16x16x32_bf16 v[248:251], v[68:71], a[200:203], v[248:251]
  v_mfma_f32_16x16x32_bf16 v[252:255], v[68:71], a[204:207], v[252:255]
  s_barrier
  s_waitcnt vmcnt(24) lgkmcnt(6)
  v_mfma_f32_16x16x32_bf16 v[112:115], v[48:51], a[208:211], v[112:115]
  ds_read_b64_tr_b16 v[68:69], v11 offset:37024
  ds_read_b64_tr_b16 v[70:71], v11 offset:41632
  v_mfma_f32_16x16x32_bf16 v[116:119], v[48:51], a[212:215], v[116:119]
  v_mfma_f32_16x16x32_bf16 v[120:123], v[48:51], a[216:219], v[120:123]
  s_add_u32 m0, s40, 65536
  v_mfma_f32_16x16x32_bf16 v[124:127], v[48:51], a[220:223], v[124:127]
  s_mov_b32 s52, 16384
  s_mov_b64 exec, 0xff
  buffer_load_dword v73, v14, s[16:19], s52 offen sc1
  s_mov_b64 exec, -1
  v_mfma_f32_16x16x32_bf16 v[128:131], v[52:55], a[208:211], v[128:131]
  ds_read_b64_tr_b16 v[48:49], v11 offset:37056
  ds_read_b64_tr_b16 v[50:51], v11 offset:41664
  v_mfma_f32_16x16x32_bf16 v[132:135], v[52:55], a[212:215], v[132:135]
  s_add_u32 s38, s82, 4096
  v_mfma_f32_16x16x32_bf16 v[136:139], v[52:55], a[216:219], v[136:139]
  buffer_load_dwordx4 a[32:35], v16, s[16:19], s38 offen offset:0 sc1
  v_mfma_f32_16x16x32_bf16 v[140:143], v[52:55], a[220:223], v[140:143]
  s_waitcnt lgkmcnt(6)
  v_mfma_f32_16x16x32_bf16 v[144:147], v[56:59], a[208:211], v[144:147]
  ds_read_b64_tr_b16 v[52:53], v11 offset:37088
  ds_read_b64_tr_b16 v[54:55], v11 offset:41696
  v_mfma_f32_16x16x32_bf16 v[148:151], v[56:59], a[212:215], v[148:151]
  buffer_load_dwordx4 a[36:39], v16, s[16:19], s38 offen offset:1024 sc1
  v_mfma_f32_16x16x32_bf16 v[152:155], v[56:59], a[216:219], v[152:155]
  buffer_load_dwordx4 v1, s[8:11], s93 offen offset:0 lds
  v_mfma_f32_16x16x32_bf16 v[156:159], v[56:59], a[220:223], v[156:159]
  buffer_load_dwordx4 a[40:43], v16, s[16:19], s38 offen offset:2048 sc1
  v_mfma_f32_16x16x32_bf16 v[160:163], v[60:63], a[208:211], v[160:163]
  ds_read_b64_tr_b16 v[56:57], v11 offset:37120
  ds_read_b64_tr_b16 v[58:59], v11 offset:41728
  v_mfma_f32_16x16x32_bf16 v[164:167], v[60:63], a[212:215], v[164:167]
  buffer_load_dwordx4 a[44:47], v16, s[16:19], s38 offen offset:3072 sc1
  v_mfma_f32_16x16x32_bf16 v[168:171], v[60:63], a[216:219], v[168:171]
  s_add_u32 s38, s82, 8192
  v_mfma_f32_16x16x32_bf16 v[172:175], v[60:63], a[220:223], v[172:175]
  s_waitcnt lgkmcnt(6)
  v_mfma_f32_16x16x32_bf16 v[176:179], v[64:67], a[208:211], v[176:179]
  ds_read_b64_tr_b16 v[60:61], v11 offset:46080
  ds_read_b64_tr_b16 v[62:63], v11 offset:50688
  v_mfma_f32_16x16x32_bf16 v[180:183], v[64:67], a[212:215], v[180:183]
  buffer_load_dwordx4 a[48:51], v16, s[16:19], s38 offen offset:0 sc1
  v_mfma_f32_16x16x32_bf16 v[184:187], v[64:67], a[216:219], v[184:187]
  buffer_load_dwordx4 v2, s[8:11], s93 offen offset:1024 lds
  v_mfma_f32_16x16x32_bf16 v[188:191], v[64:67], a[220:223], v[188:191]
  buffer_load_dwordx4 a[52:55], v16, s[16:19], s38 offen offset:1024 sc1
  v_mfma_f32_16x16x32_bf16 v[192:195], v[68:71], a[208:211], v[192:195]
  ds_read_b64_tr_b16 v[64:65], v11 offset:46112
  ds_read_b64_tr_b16 v[66:67], v11 offset:50720
  v_mfma_f32_16x16x32_bf16 v[196:199], v[68:71], a[212:215], v[196:199]
  buffer_load_dwordx4 a[56:59], v16, s[16:19], s38 offen offset:2048 sc1
  v_mfma_f32_16x16x32_bf16 v[200:203], v[68:71], a[216:219], v[200:203]
  buffer_load_dwordx4 a[60:63], v16, s[16:19], s38 offen offset:3072 sc1
  v_mfma_f32_16x16x32_bf16 v[204:207], v[68:71], a[220:223], v[204:207]
  s_waitcnt lgkmcnt(6)
  v_mfma_f32_16x16x32_bf16 v[208:211], v[48:51], a[208:211], v[208:211]
  ds_read_b64_tr_b16 v[68:69], v11 offset:46144
  ds_read_b64_tr_b16 v[70:71], v11 offset:50752
  v_mfma_f32_16x16x32_bf16 v[212:215], v[48:51], a[212:215], v[212:215]
  v_mfma_f32_16x16x32_bf16 v[216:219], v[48:51], a[216:219], v[216:219]
  buffer_load_dwordx4 v3, s[8:11], s93 offen offset:2048 lds
  v_mfma_f32_16x16x32_bf16 v[220:223], v[48:51], a[220:223], v[220:223]
  v_mfma_f32_16x16x32_bf16 v[224:227], v[52:55], a[208:211], v[224:227]
  ds_read_b64_tr_b16 v[48:49], v11 offset:46176
  ds_read_b64_tr_b16 v[50:51], v11 offset:50784
  v_mfma_f32_16x16x32_bf16 v[228:231], v[52:55], a[212:215], v[228:231]
  v_mfma_f32_16x16x32_bf16 v[232:235], v[52:55], a[216:219], v[232:235]
  v_mfma_f32_16x16x32_bf16 v[236:239], v[52:55], a[220:223], v[236:239]
  s_waitcnt lgkmcnt(6)
  v_mfma_f32_16x16x32_bf16 v[240:243], v[56:59], a[208:211], v[240:243]
  ds_read_b64_tr_b16 v[52:53], v11 offset:46208
  ds_read_b64_tr_b16 v[54:55], v11 offset:50816
  v_mfma_f32_16x16x32_bf16 v[244:247], v[56:59], a[212:215], v[244:247]
  v_mfma_f32_16x16x32_bf16 v[248:251], v[56:59], a[216:219], v[248:251]
  buffer_load_dwordx4 v4, s[8:11], s93 offen offset:3072 lds
  v_mfma_f32_16x16x32_bf16 v[252:255], v[56:59], a[220:223], v[252:255]
  s_waitcnt vmcnt(32)
  v_mfma_f32_16x16x32_bf16 v[112:115], v[60:63], a[224:227], v[112:115]
  ds_read_b64_tr_b16 v[56:57], v11 offset:46240
  ds_read_b64_tr_b16 v[58:59], v11 offset:50848
  v_mfma_f32_16x16x32_bf16 v[116:119], v[60:63], a[228:231], v[116:119]
  v_mfma_f32_16x16x32_bf16 v[120:123], v[60:63], a[232:235], v[120:123]
  s_mov_b32 s52, 53248
  s_mov_b64 exec, 0xff
  buffer_load_dword v73, v14, s[16:19], s52 offen sc1
  s_mov_b64 exec, -1
  v_mfma_f32_16x16x32_bf16 v[124:127], v[60:63], a[236:239], v[124:127]
  s_waitcnt lgkmcnt(6)
  v_mfma_f32_16x16x32_bf16 v[128:131], v[64:67], a[224:227], v[128:131]
  ds_read_b64_tr_b16 v[60:61], v11 offset:46272
  ds_read_b64_tr_b16 v[62:63], v11 offset:50880
  v_mfma_f32_16x16x32_bf16 v[132:135], v[64:67], a[228:231], v[132:135]
  v_mfma_f32_16x16x32_bf16 v[136:139], v[64:67], a[232:235], v[136:139]
  s_add_u32 m0, s40, 69632
  v_mfma_f32_16x16x32_bf16 v[140:143], v[64:67], a[236:239], v[140:143]
  s_add_u32 s38, s82, 12288
  v_mfma_f32_16x16x32_bf16 v[144:147], v[68:71], a[224:227], v[144:147]
  ds_read_b64_tr_b16 v[64:65], v11 offset:46304
  ds_read_b64_tr_b16 v[66:67], v11 offset:50912
  v_mfma_f32_16x16x32_bf16 v[148:151], v[68:71], a[228:231], v[148:151]
  v_mfma_f32_16x16x32_bf16 v[152:155], v[68:71], a[232:235], v[152:155]
  v_mfma_f32_16x16x32_bf16 v[156:159], v[68:71], a[236:239], v[156:159]
  s_waitcnt lgkmcnt(6)
  v_mfma_f32_16x16x32_bf16 v[160:163], v[48:51], a[224:227], v[160:163]
  ds_read_b64_tr_b16 v[68:69], v11 offset:46336
  ds_read_b64_tr_b16 v[70:71], v11 offset:50944
  v_mfma_f32_16x16x32_bf16 v[164:167], v[48:51], a[228:231], v[164:167]
  buffer_load_dwordx4 a[64:67], v16, s[16:19], s38 offen offset:0 sc1
  v_mfma_f32_16x16x32_bf16 v[168:171], v[48:51], a[232:235], v[168:171]
  buffer_load_dwordx4 v5, s[8:11], s93 offen offset:0 lds
  v_mfma_f32_16x16x32_bf16 v[172:175], v[48:51], a[236:239], v[172:175]
  v_mfma_f32_16x16x32_bf16 v[176:179], v[52:55], a[224:227], v[176:179]
  ds_read_b64_tr_b16 v[48:49], v12 offset:0
  ds_read_b64_tr_b16 v[50:51], v12 offset:4608
  v_mfma_f32_16x16x32_bf16 v[180:183], v[52:55], a[228:231], v[180:183]
  buffer_load_dwordx4 a[68:71], v16, s[16:19], s38 offen offset:1024 sc1
  v_mfma_f32_16x16x32_bf16 v[184:187], v[52:55], a[232:235], v[184:187]
  v_mfma_f32_16x16x32_bf16 v[188:191], v[52:55], a[236:239], v[188:191]
  s_waitcnt lgkmcnt(6)
  v_mfma_f32_16x16x32_bf16 v[192:195], v[56:59], a[224:227], v[192:195]
  ds_read_b64_tr_b16 v[52:53], v12 offset:32
  ds_read_b64_tr_b16 v[54:55], v12 offset:4640
  v_mfma_f32_16x16x32_bf16 v[196:199], v[56:59], a[228:231], v[196:199]
  v_mfma_f32_16x16x32_bf16 v[200:203], v[56:59], a[232:235], v[200:203]
  buffer_load_dwordx4 v6, s[8:11], s93 offen offset:1024 lds
  v_mfma_f32_16x16x32_bf16 v[204:207], v[56:59], a[236:239], v[204:207]
  buffer_load_dwordx4 a[72:75], v16, s[16:19], s38 offen offset:2048 sc1
  v_mfma_f32_16x16x32_bf16 v[208:211], v[60:63], a[224:227], v[208:211]
  ds_read_b64_tr_b16 v[56:57], v12 offset:64
  ds_read_b64_tr_b16 v[58:59], v12 offset:4672
  v_mfma_f32_16x16x32_bf16 v[212:215], v[60:63], a[228:231], v[212:215]
  v_mfma_f32_16x16x32_bf16 v[216:219], v[60:63], a[232:235], v[216:219]
  v_mfma_f32_16x16x32_bf16 v[220:223], v[60:63], a[236:239], v[220:223]
  s_waitcnt lgkmcnt(6)
  v_mfma_f32_16x16x32_bf16 v[224:227], v[64:67], a[224:227], v[224:227]
  ds_read_b64_tr_b16 v[60:61], v12 offset:96
  ds_read_b64_tr_b16 v[62:63], v12 offset:4704
  v_mfma_f32_16x16x32_bf16 v[228:231], v[64:67], a[228:231], v[228:231]
  buffer_load_dwordx4 a[76:79], v16, s[16:19], s38 offen offset:3072 sc1
  v_mfma_f32_16x16x32_bf16 v[232:235], v[64:67], a[232:235], v[232:235]
  buffer_load_dwordx4 v7, s[8:11], s93 offen offset:2048 lds
  v_mfma_f32_16x16x32_bf16 v[236:239], v[64:67], a[236:239], v[236:239]
  v_mfma_f32_16x16x32_bf16 v[240:243], v[68:71], a[224:227], v[240:243]
  ds_read_b64_tr_b16 v[64:65], v12 offset:128
  ds_read_b64_tr_b16 v[66:67], v12 offset:4736
  v_mfma_f32_16x16x32_bf16 v[244:247], v[68:71], a[228:231], v[244:247]
  v_mfma_f32_16x16x32_bf16 v[248:251], v[68:71], a[232:235], v[248:251]
  v_mfma_f32_16x16x32_bf16 v[252:255], v[68:71], a[236:239], v[252:255]
  s_waitcnt vmcnt(32) lgkmcnt(6)
  v_mfma_f32_16x16x32_bf16 v[112:115], v[48:51], a[240:243], v[112:115]
  ds_read_b64_tr_b16 v[68:69], v12 offset:160
  ds_read_b64_tr_b16 v[70:71], v12 offset:4768
  v_mfma_f32_16x16x32_bf16 v[116:119], v[48:51], a[244:247], v[116:119]
  v_mfma_f32_16x16x32_bf16 v[120:123], v[48:51], a[248:251], v[120:123]
  buffer_load_dwordx4 v8, s[8:11], s93 offen offset:3072 lds
  v_mfma_f32_16x16x32_bf16 v[124:127], v[48:51], a[252:255], v[124:127]
  s_mov_b32 s52, 90112
  s_mov_b64 exec, 0xff
  buffer_load_dword v73, v14, s[16:19], s52 offen sc1
  s_mov_b64 exec, -1
  v_mfma_f32_16x16x32_bf16 v[128:131], v[52:55], a[240:243], v[128:131]
  ds_read_b64_tr_b16 v[48:49], v12 offset:192
  ds_read_b64_tr_b16 v[50:51], v12 offset:4800
  v_mfma_f32_16x16x32_bf16 v[132:135], v[52:55], a[244:247], v[132:135]
  v_mfma_f32_16x16x32_bf16 v[136:139], v[52:55], a[248:251], v[136:139]
  v_mfma_f32_16x16x32_bf16 v[140:143], v[52:55], a[252:255], v[140:143]
  s_add_u32 s38, s83, 0
  s_waitcnt lgkmcnt(6)
  v_mfma_f32_16x16x32_bf16 v[144:147], v[56:59], a[240:243], v[144:147]
  ds_read_b64_tr_b16 v[52:53], v12 offset:224
  ds_read_b64_tr_b16 v[54:55], v12 offset:4832
  v_mfma_f32_16x16x32_bf16 v[148:151], v[56:59], a[244:247], v[148:151]
  v_mfma_f32_16x16x32_bf16 v[152:155], v[56:59], a[248:251], v[152:155]
  s_add_u32 m0, s40, 73728
  v_mfma_f32_16x16x32_bf16 v[156:159], v[56:59], a[252:255], v[156:159]
  v_mfma_f32_16x16x32_bf16 v[160:163], v[60:63], a[240:243], v[160:163]
  ds_read_b64_tr_b16 v[56:57], v12 offset:256
  ds_read_b64_tr_b16 v[58:59], v12 offset:4864
  v_mfma_f32_16x16x32_bf16 v[164:167], v[60:63], a[244:247], v[164:167]
  buffer_load_dwordx4 a[80:83], v16, s[16:19], s38 offen offset:0 sc1
  v_mfma_f32_16x16x32_bf16 v[168:171], v[60:63], a[248:251], v[168:171]
  v_mfma_f32_16x16x32_bf16 v[172:175], v[60:63], a[252:255], v[172:175]
  s_waitcnt lgkmcnt(6)
  v_mfma_f32_16x16x32_bf16 v[176:179], v[64:67], a[240:243], v[176:179]
  ds_read_b64_tr_b16 v[60:61], v12 offset:9216
  ds_read_b64_tr_b16 v[62:63], v12 offset:13824
  v_mfma_f32_16x16x32_bf16 v[180:183], v[64:67], a[244:247], v[180:183]
  buffer_load_dwordx4 a[84:87], v16, s[16:19], s38 offen offset:1024 sc1
  v_mfma_f32_16x16x32_bf16 v[184:187], v[64:67], a[248:251], v[184:187]
  buffer_load_dwordx4 v9, s[8:11], s93 offen offset:0 lds
  v_mfma_f32_16x16x32_bf16 v[188:191], v[64:67], a[252:255], v[188:191]
  v_mfma_f32_16x16x32_bf16 v[192:195], v[68:71], a[240:243], v[192:195]
  ds_read_b64_tr_b16 v[64:65], v12 offset:9248
  ds_read_b64_tr_b16 v[66:67], v12 offset:13856
  v_mfma_f32_16x16x32_bf16 v[196:199], v[68:71], a[244:247], v[196:199]
  v_mfma_f32_16x16x32_bf16 v[200:203], v[68:71], a[248:251], v[200:203]
  buffer_load_dwordx4 a[88:91], v16, s[16:19], s38 offen offset:2048 sc1
  v_mfma_f32_16x16x32_bf16 v[204:207], v[68:71], a[252:255], v[204:207]
  s_waitcnt lgkmcnt(6)
  v_mfma_f32_16x16x32_bf16 v[208:211], v[48:51], a[240:243], v[208:211]
  ds_read_b64_tr_b16 v[68:69], v12 offset:9280
  ds_read_b64_tr_b16 v[70:71], v12 offset:13888
  v_mfma_f32_16x16x32_bf16 v[212:215], v[48:51], a[244:247], v[212:215]
  v_mfma_f32_16x16x32_bf16 v[216:219], v[48:51], a[248:251], v[216:219]
  v_mfma_f32_16x16x32_bf16 v[220:223], v[48:51], a[252:255], v[220:223]
  buffer_load_dwordx4 a[92:95], v16, s[16:19], s38 offen offset:3072 sc1
  v_mfma_f32_16x16x32_bf16 v[224:227], v[52:55], a[240:243], v[224:227]
  ds_read_b64_tr_b16 v[48:49], v12 offset:9312
  ds_read_b64_tr_b16 v[50:51], v12 offset:13920
  v_mfma_f32_16x16x32_bf16 v[228:231], v[52:55], a[244:247], v[228:231]
  v_mfma_f32_16x16x32_bf16 v[232:235], v[52:55], a[248:251], v[232:235]
  v_mfma_f32_16x16x32_bf16 v[236:239], v[52:55], a[252:255], v[236:239]
  s_waitcnt lgkmcnt(6)
  v_mfma_f32_16x16x32_bf16 v[240:243], v[56:59], a[240:243], v[240:243]
  ds_read_b64_tr_b16 v[52:53], v12 offset:9344
  ds_read_b64_tr_b16 v[54:55], v12 offset:13952
  v_mfma_f32_16x16x32_bf16 v[244:247], v[56:59], a[244:247], v[244:247]
  v_mfma_f32_16x16x32_bf16 v[248:251], v[56:59], a[248:251], v[248:251]
  v_mfma_f32_16x16x32_bf16 v[252:255], v[56:59], a[252:255], v[252:255]
  s_barrier
  s_waitcnt vmcnt(32)
  v_mfma_f32_16x16x32_bf16 v[112:115], v[60:63], a[0:3], v[112:115]
  ds_read_b64_tr_b16 v[56:57], v12 offset:9376
  ds_read_b64_tr_b16 v[58:59], v12 offset:13984
  v_mfma_f32_16x16x32_bf16 v[116:119], v[60:63], a[4:7], v[116:119]
  v_mfma_f32_16x16x32_bf16 v[120:123], v[60:63], a[8:11], v[120:123]
  s_mov_b32 s52, 126976
  s_mov_b64 exec, 0xff
  buffer_load_dword v73, v14, s[16:19], s52 offen sc1
  s_mov_b64 exec, -1
  v_mfma_f32_16x16x32_bf16 v[124:127], v[60:63], a[12:15], v[124:127]
  s_waitcnt lgkmcnt(6)
  v_mfma_f32_16x16x32_bf16 v[128:131], v[64:67], a[0:3], v[128:131]
  ds_read_b64_tr_b16 v[60:61], v12 offset:9408
  ds_read_b64_tr_b16 v[62:63], v12 offset:14016
  v_mfma_f32_16x16x32_bf16 v[132:135], v[64:67], a[4:7], v[132:135]
  v_mfma_f32_16x16x32_bf16 v[136:139], v[64:67], a[8:11], v[136:139]
  v_mfma_f32_16x16x32_bf16 v[140:143], v[64:67], a[12:15], v[140:143]
  s_add_u32 s38, s83, 4096
  v_mfma_f32_16x16x32_bf16 v[144:147], v[68:71], a[0:3], v[144:147]
  ds_read_b64_tr_b16 v[64:65], v12 offset:9440
  ds_read_b64_tr_b16 v[66:67], v12 offset:14048
  v_mfma_f32_16x16x32_bf16 v[148:151], v[68:71], a[4:7], v[148:151]
  v_mfma_f32_16x16x32_bf16 v[152:155], v[68:71], a[8:11], v[152:155]
  v_mfma_f32_16x16x32_bf16 v[156:159], v[68:71], a[12:15], v[156:159]
  s_waitcnt lgkmcnt(6)
  v_mfma_f32_16x16x32_bf16 v[160:163], v[48:51], a[0:3], v[160:163]
  ds_read_b64_tr_b16 v[68:69], v12 offset:9472
  ds_read_b64_tr_b16 v[70:71], v12 offset:14080
  v_mfma_f32_16x16x32_bf16 v[164:167], v[48:51], a[4:7], v[164:167]
  buffer_load_dwordx4 a[96:99], v16, s[16:19], s38 offen offset:0 sc1
  v_mfma_f32_16x16x32_bf16 v[168:171], v[48:51], a[8:11], v[168:171]
  v_mfma_f32_16x16x32_bf16 v[172:175], v[48:51], a[12:15], v[172:175]
  v_mfma_f32_16x16x32_bf16 v[176:179], v[52:55], a[0:3], v[176:179]
  ds_read_b64_tr_b16 v[48:49], v10 offset:0
  ds_read_b64_tr_b16 v[50:51], v10 offset:4608
  v_mfma_f32_16x16x32_bf16 v[180:183], v[52:55], a[4:7], v[180:183]
  buffer_load_dwordx4 a[100:103], v16, s[16:19], s38 offen offset:1024 sc1
  v_mfma_f32_16x16x32_bf16 v[184:187], v[52:55], a[8:11], v[184:187]
  v_mfma_f32_16x16x32_bf16 v[188:191], v[52:55], a[12:15], v[188:191]
  s_waitcnt lgkmcnt(6)
  v_mfma_f32_16x16x32_bf16 v[192:195], v[56:59], a[0:3], v[192:195]
  ds_read_b64_tr_b16 v[52:53], v10 offset:32
  ds_read_b64_tr_b16 v[54:55], v10 offset:4640
  v_mfma_f32_16x16x32_bf16 v[196:199], v[56:59], a[4:7], v[196:199]
  v_mfma_f32_16x16x32_bf16 v[200:203], v[56:59], a[8:11], v[200:203]
  buffer_load_dwordx4 a[104:107], v16, s[16:19], s38 offen offset:2048 sc1
  v_mfma_f32_16x16x32_bf16 v[204:207], v[56:59], a[12:15], v[204:207]
  v_mfma_f32_16x16x32_bf16 v[208:211], v[60:63], a[0:3], v[208:211]
  ds_read_b64_tr_b16 v[56:57], v10 offset:64
  ds_read_b64_tr_b16 v[58:59], v10 offset:4672
  v_mfma_f32_16x16x32_bf16 v[212:215], v[60:63], a[4:7], v[212:215]
  v_mfma_f32_16x16x32_bf16 v[216:219], v[60:63], a[8:11], v[216:219]
  v_mfma_f32_16x16x32_bf16 v[220:223], v[60:63], a[12:15], v[220:223]
  s_waitcnt lgkmcnt(6)
  v_mfma_f32_16x16x32_bf16 v[224:227], v[64:67], a[0:3], v[224:227]
  ds_read_b64_tr_b16 v[60:61], v10 offset:96
  ds_read_b64_tr_b16 v[62:63], v10 offset:4704
  v_mfma_f32_16x16x32_bf16 v[228:231], v[64:67], a[4:7], v[228:231]
  buffer_load_dwordx4 a[108:111], v16, s[16:19], s38 offen offset:3072 sc1
  v_mfma_f32_16x16x32_bf16 v[232:235], v[64:67], a[8:11], v[232:235]
  v_mfma_f32_16x16x32_bf16 v[236:239], v[64:67], a[12:15], v[236:239]
  v_mfma_f32_16x16x32_bf16 v[240:243], v[68:71], a[0:3], v[240:243]
  ds_read_b64_tr_b16 v[64:65], v10 offset:128
  ds_read_b64_tr_b16 v[66:67], v10 offset:4736
  v_mfma_f32_16x16x32_bf16 v[244:247], v[68:71], a[4:7], v[244:247]
  v_mfma_f32_16x16x32_bf16 v[248:251], v[68:71], a[8:11], v[248:251]
  v_mfma_f32_16x16x32_bf16 v[252:255], v[68:71], a[12:15], v[252:255]
  s_waitcnt vmcnt(33) lgkmcnt(6)
  v_mfma_f32_16x16x32_bf16 v[112:115], v[48:51], a[16:19], v[112:115]
  ds_read_b64_tr_b16 v[68:69], v10 offset:160
  ds_read_b64_tr_b16 v[70:71], v10 offset:4768
  v_mfma_f32_16x16x32_bf16 v[116:119], v[48:51], a[20:23], v[116:119]
  v_mfma_f32_16x16x32_bf16 v[120:123], v[48:51], a[24:27], v[120:123]
  s_add_u32 s38, s83, 8192
  v_mfma_f32_16x16x32_bf16 v[124:127], v[48:51], a[28:31], v[124:127]
  v_mfma_f32_16x16x32_bf16 v[128:131], v[52:55], a[16:19], v[128:131]
  ds_read_b64_tr_b16 v[48:49], v10 offset:192
  ds_read_b64_tr_b16 v[50:51], v10 offset:4800
  v_mfma_f32_16x16x32_bf16 v[132:135], v[52:55], a[20:23], v[132:135]
  buffer_load_dwordx4 a[112:115], v16, s[16:19], s38 offen offset:0 sc1
  v_mfma_f32_16x16x32_bf16 v[136:139], v[52:55], a[24:27], v[136:139]
  v_mfma_f32_16x16x32_bf16 v[140:143], v[52:55], a[28:31], v[140:143]
  s_waitcnt lgkmcnt(6)
  v_mfma_f32_16x16x32_bf16 v[144:147], v[56:59], a[16:19], v[144:147]
  ds_read_b64_tr_b16 v[52:53], v10 offset:224
  ds_read_b64_tr_b16 v[54:55], v10 offset:4832
  v_mfma_f32_16x16x32_bf16 v[148:151], v[56:59], a[20:23], v[148:151]
  buffer_load_dwordx4 a[116:119], v16, s[16:19], s38 offen offset:1024 sc1
  v_mfma_f32_16x16x32_bf16 v[152:155], v[56:59], a[24:27], v[152:155]
  v_mfma_f32_16x16x32_bf16 v[156:159], v[56:59], a[28:31], v[156:159]
  buffer_load_dwordx4 a[120:123], v16, s[16:19], s38 offen offset:2048 sc1
  v_mfma_f32_16x16x32_bf16 v[160:163], v[60:63], a[16:19], v[160:163]
  ds_read_b64_tr_b16 v[56:57], v10 offset:256
  ds_read_b64_tr_b16 v[58:59], v10 offset:4864
  v_mfma_f32_16x16x32_bf16 v[164:167], v[60:63], a[20:23], v[164:167]
  v_mfma_f32_16x16x32_bf16 v[168:171], v[60:63], a[24:27], v[168:171]
  buffer_load_dwordx4 a[124:127], v16, s[16:19], s38 offen offset:3072 sc1
  v_mfma_f32_16x16x32_bf16 v[172:175], v[60:63], a[28:31], v[172:175]
  s_waitcnt lgkmcnt(6)
  v_mfma_f32_16x16x32_bf16 v[176:179], v[64:67], a[16:19], v[176:179]
  ds_read_b64_tr_b16 v[60:61], v10 offset:9216
  ds_read_b64_tr_b16 v[62:63], v10 offset:13824
  v_mfma_f32_16x16x32_bf16 v[180:183], v[64:67], a[20:23], v[180:183]
  s_add_u32 s38, s83, 12288
  v_mfma_f32_16x16x32_bf16 v[184:187], v[64:67], a[24:27], v[184:187]
  v_mfma_f32_16x16x32_bf16 v[188:191], v[64:67], a[28:31], v[188:191]
  v_mfma_f32_16x16x32_bf16 v[192:195], v[68:71], a[16:19], v[192:195]
  ds_read_b64_tr_b16 v[64:65], v10 offset:9248
  ds_read_b64_tr_b16 v[66:67], v10 offset:13856
  v_mfma_f32_16x16x32_bf16 v[196:199], v[68:71], a[20:23], v[196:199]
  buffer_load_dwordx4 a[128:131], v16, s[16:19], s38 offen offset:0 sc1
  v_mfma_f32_16x16x32_bf16 v[200:203], v[68:71], a[24:27], v[200:203]
  v_mfma_f32_16x16x32_bf16 v[204:207], v[68:71], a[28:31], v[204:207]
  s_waitcnt lgkmcnt(6)
  v_mfma_f32_16x16x32_bf16 v[208:211], v[48:51], a[16:19], v[208:211]
  ds_read_b64_tr_b16 v[68:69], v10 offset:9280
  ds_read_b64_tr_b16 v[70:71], v10 offset:13888
  v_mfma_f32_16x16x32_bf16 v[212:215], v[48:51], a[20:23], v[212:215]
  buffer_load_dwordx4 a[132:135], v16, s[16:19], s38 offen offset:1024 sc1
  v_mfma_f32_16x16x32_bf16 v[216:219], v[48:51], a[24:27], v[216:219]
  buffer_load_dwordx4 a[136:139], v16, s[16:19], s38 offen offset:2048 sc1
  v_mfma_f32_16x16x32_bf16 v[220:223], v[48:51], a[28:31], v[220:223]
  v_mfma_f32_16x16x32_bf16 v[224:227], v[52:55], a[16:19], v[224:227]
  ds_read_b64_tr_b16 v[48:49], v10 offset:9312
  ds_read_b64_tr_b16 v[50:51], v10 offset:13920
  v_mfma_f32_16x16x32_bf16 v[228:231], v[52:55], a[20:23], v[228:231]
  buffer_load_dwordx4 a[140:143], v16, s[16:19], s38 offen offset:3072 sc1
  v_mfma_f32_16x16x32_bf16 v[232:235], v[52:55], a[24:27], v[232:235]
  v_mfma_f32_16x16x32_bf16 v[236:239], v[52:55], a[28:31], v[236:239]
  s_waitcnt lgkmcnt(6)
  v_mfma_f32_16x16x32_bf16 v[240:243], v[56:59], a[16:19], v[240:243]
  ds_read_b64_tr_b16 v[52:53], v10 offset:9344
  ds_read_b64_tr_b16 v[54:55], v10 offset:13952
  v_mfma_f32_16x16x32_bf16 v[244:247], v[56:59], a[20:23], v[244:247]
  v_mfma_f32_16x16x32_bf16 v[248:251], v[56:59], a[24:27], v[248:251]
  v_mfma_f32_16x16x32_bf16 v[252:255], v[56:59], a[28:31], v[252:255]
  s_waitcnt vmcnt(35)
  v_mfma_f32_16x16x32_bf16 v[112:115], v[60:63], a[32:35], v[112:115]
  ds_read_b64_tr_b16 v[56:57], v10 offset:9376
  ds_read_b64_tr_b16 v[58:59], v10 offset:13984
  v_mfma_f32_16x16x32_bf16 v[116:119], v[60:63], a[36:39], v[116:119]
  v_mfma_f32_16x16x32_bf16 v[120:123], v[60:63], a[40:43], v[120:123]
  s_mov_b32 s38, 16384
  v_mfma_f32_16x16x32_bf16 v[124:127], v[60:63], a[44:47], v[124:127]
  s_waitcnt lgkmcnt(6)
  v_mfma_f32_16x16x32_bf16 v[128:131], v[64:67], a[32:35], v[128:131]
  ds_read_b64_tr_b16 v[60:61], v10 offset:9408
  ds_read_b64_tr_b16 v[62:63], v10 offset:14016
  v_mfma_f32_16x16x32_bf16 v[132:135], v[64:67], a[36:39], v[132:135]
  buffer_load_dwordx2 a[144:145], v13, s[16:19], s38 offen offset:0 sc1
  v_mfma_f32_16x16x32_bf16 v[136:139], v[64:67], a[40:43], v[136:139]
  v_mfma_f32_16x16x32_bf16 v[140:143], v[64:67], a[44:47], v[140:143]
  v_mfma_f32_16x16x32_bf16 v[144:147], v[68:71], a[32:35], v[144:147]
  ds_read_b64_tr_b16 v[64:65], v10 offset:9440
  ds_read_b64_tr_b16 v[66:67], v10 offset:14048
  v_mfma_f32_16x16x32_bf16 v[148:151], v[68:71], a[36:39], v[148:151]
  buffer_load_dwordx2 a[146:147], v13, s[16:19], s38 offen offset:512 sc1
  v_mfma_f32_16x16x32_bf16 v[152:155], v[68:71], a[40:43], v[152:155]
  v_mfma_f32_16x16x32_bf16 v[156:159], v[68:71], a[44:47], v[156:159]
  s_waitcnt lgkmcnt(6)
  v_mfma_f32_16x16x32_bf16 v[160:163], v[48:51], a[32:35], v[160:163]
  ds_read_b64_tr_b16 v[68:69], v10 offset:9472
  ds_read_b64_tr_b16 v[70:71], v10 offset:14080
  v_mfma_f32_16x16x32_bf16 v[164:167], v[48:51], a[36:39], v[164:167]
  buffer_load_dwordx2 a[148:149], v13, s[16:19], s38 offen offset:1024 sc1
  v_mfma_f32_16x16x32_bf16 v[168:171], v[48:51], a[40:43], v[168:171]
  buffer_load_dwordx2 a[150:151], v13, s[16:19], s38 offen offset:1536 sc1
  v_mfma_f32_16x16x32_bf16 v[172:175], v[48:51], a[44:47], v[172:175]
  v_mfma_f32_16x16x32_bf16 v[176:179], v[52:55], a[32:35], v[176:179]
  ds_read_b64_tr_b16 v[48:49], v10 offset:18432
  ds_read_b64_tr_b16 v[50:51], v10 offset:23040
  v_mfma_f32_16x16x32_bf16 v[180:183], v[52:55], a[36:39], v[180:183]
  buffer_load_dwordx2 a[152:153], v13, s[16:19], s38 offen offset:2048 sc1
  v_mfma_f32_16x16x32_bf16 v[184:187], v[52:55], a[40:43], v[184:187]
  v_mfma_f32_16x16x32_bf16 v[188:191], v[52:55], a[44:47], v[188:191]
  s_waitcnt lgkmcnt(6)
  v_mfma_f32_16x16x32_bf16 v[192:195], v[56:59], a[32:35], v[192:195]
  ds_read_b64_tr_b16 v[52:53], v10 offset:18464
  ds_read_b64_tr_b16 v[54:55], v10 offset:23072
  v_mfma_f32_16x16x32_bf16 v[196:199], v[56:59], a[36:39], v[196:199]
  buffer_load_dwordx2 a[154:155], v13, s[16:19], s38 offen offset:2560 sc1
  v_mfma_f32_16x16x32_bf16 v[200:203], v[56:59], a[40:43], v[200:203]
  v_mfma_f32_16x16x32_bf16 v[204:207], v[56:59], a[44:47], v[204:207]
  buffer_load_dwordx2 a[156:157], v13, s[16:19], s38 offen offset:3072 sc1
  v_mfma_f32_16x16x32_bf16 v[208:211], v[60:63], a[32:35], v[208:211]
  ds_read_b64_tr_b16 v[56:57], v10 offset:18496
  ds_read_b64_tr_b16 v[58:59], v10 offset:23104
  v_mfma_f32_16x16x32_bf16 v[212:215], v[60:63], a[36:39], v[212:215]
  v_mfma_f32_16x16x32_bf16 v[216:219], v[60:63], a[40:43], v[216:219]
  buffer_load_dwordx2 a[158:159], v13, s[16:19], s38 offen offset:3584 sc1
  v_mfma_f32_16x16x32_bf16 v[220:223], v[60:63], a[44:47], v[220:223]
  s_waitcnt lgkmcnt(6)
  v_mfma_f32_16x16x32_bf16 v[224:227], v[64:67], a[32:35], v[224:227]
  ds_read_b64_tr_b16 v[60:61], v10 offset:18528
  ds_read_b64_tr_b16 v[62:63], v10 offset:23136
  v_mfma_f32_16x16x32_bf16 v[228:231], v[64:67], a[36:39], v[228:231]
  v_mfma_f32_16x16x32_bf16 v[232:235], v[64:67], a[40:43], v[232:235]
  v_mfma_f32_16x16x32_bf16 v[236:239], v[64:67], a[44:47], v[236:239]
  v_mfma_f32_16x16x32_bf16 v[240:243], v[68:71], a[32:35], v[240:243]
  ds_read_b64_tr_b16 v[64:65], v10 offset:18560
  ds_read_b64_tr_b16 v[66:67], v10 offset:23168
  v_mfma_f32_16x16x32_bf16 v[244:247], v[68:71], a[36:39], v[244:247]
  v_mfma_f32_16x16x32_bf16 v[248:251], v[68:71], a[40:43], v[248:251]
  v_mfma_f32_16x16x32_bf16 v[252:255], v[68:71], a[44:47], v[252:255]
  s_waitcnt vmcnt(38) lgkmcnt(6)
  v_mfma_f32_16x16x32_bf16 v[112:115], v[48:51], a[48:51], v[112:115]
  ds_read_b64_tr_b16 v[68:69], v10 offset:18592
  ds_read_b64_tr_b16 v[70:71], v10 offset:23200
  v_mfma_f32_16x16x32_bf16 v[116:119], v[48:51], a[52:55], v[116:119]
  v_mfma_f32_16x16x32_bf16 v[120:123], v[48:51], a[56:59], v[120:123]
  s_mov_b32 s38, 53248
  v_mfma_f32_16x16x32_bf16 v[124:127], v[48:51], a[60:63], v[124:127]
  v_mfma_f32_16x16x32_bf16 v[128:131], v[52:55], a[48:51], v[128:131]
  ds_read_b64_tr_b16 v[48:49], v10 offset:18624
  ds_read_b64_tr_b16 v[50:51], v10 offset:23232
  v_mfma_f32_16x16x32_bf16 v[132:135], v[52:55], a[52:55], v[132:135]
  buffer_load_dwordx2 a[160:161], v13, s[16:19], s38 offen offset:0 sc1
  v_mfma_f32_16x16x32_bf16 v[136:139], v[52:55], a[56:59], v[136:139]
  v_mfma_f32_16x16x32_bf16 v[140:143], v[52:55], a[60:63], v[140:143]
  s_waitcnt lgkmcnt(6)
  v_mfma_f32_16x16x32_bf16 v[144:147], v[56:59], a[48:51], v[144:147]
  ds_read_b64_tr_b16 v[52:53], v10 offset:18656
  ds_read_b64_tr_b16 v[54:55], v10 offset:23264
  v_mfma_f32_16x16x32_bf16 v[148:151], v[56:59], a[52:55], v[148:151]
  buffer_load_dwordx2 a[162:163], v13, s[16:19], s38 offen offset:512 sc1
  v_mfma_f32_16x16x32_bf16 v[152:155], v[56:59], a[56:59], v[152:155]
  v_mfma_f32_16x16x32_bf16 v[156:159], v[56:59], a[60:63], v[156:159]
  buffer_load_dwordx2 a[164:165], v13, s[16:19], s38 offen offset:1024 sc1
  v_mfma_f32_16x16x32_bf16 v[160:163], v[60:63], a[48:51], v[160:163]
  ds_read_b64_tr_b16 v[56:57], v10 offset:18688
  ds_read_b64_tr_b16 v[58:59], v10 offset:23296
  v_mfma_f32_16x16x32_bf16 v[164:167], v[60:63], a[52:55], v[164:167]
  v_mfma_f32_16x16x32_bf16 v[168:171], v[60:63], a[56:59], v[168:171]
  buffer_load_dwordx2 a[166:167], v13, s[16:19], s38 offen offset:1536 sc1
  v_mfma_f32_16x16x32_bf16 v[172:175], v[60:63], a[60:63], v[172:175]
  s_waitcnt lgkmcnt(6)
  v_mfma_f32_16x16x32_bf16 v[176:179], v[64:67], a[48:51], v[176:179]
  ds_read_b64_tr_b16 v[60:61], v10 offset:27648
  ds_read_b64_tr_b16 v[62:63], v10 offset:32256
  v_mfma_f32_16x16x32_bf16 v[180:183], v[64:67], a[52:55], v[180:183]
  buffer_load_dwordx2 a[168:169], v13, s[16:19], s38 offen offset:2048 sc1
  v_mfma_f32_16x16x32_bf16 v[184:187], v[64:67], a[56:59], v[184:187]
  v_mfma_f32_16x16x32_bf16 v[188:191], v[64:67], a[60:63], v[188:191]
  v_mfma_f32_16x16x32_bf16 v[192:195], v[68:71], a[48:51], v[192:195]
  ds_read_b64_tr_b16 v[64:65], v10 offset:27680
  ds_read_b64_tr_b16 v[66:67], v10 offset:32288
  v_mfma_f32_16x16x32_bf16 v[196:199], v[68:71], a[52:55], v[196:199]
  buffer_load_dwordx2 a[170:171], v13, s[16:19], s38 offen offset:2560 sc1
  v_mfma_f32_16x16x32_bf16 v[200:203], v[68:71], a[56:59], v[200:203]
  v_mfma_f32_16x16x32_bf16 v[204:207], v[68:71], a[60:63], v[204:207]
  s_waitcnt lgkmcnt(6)
  v_mfma_f32_16x16x32_bf16 v[208:211], v[48:51], a[48:51], v[208:211]
  ds_read_b64_tr_b16 v[68:69], v10 offset:27712
  ds_read_b64_tr_b16 v[70:71], v10 offset:32320
  v_mfma_f32_16x16x32_bf16 v[212:215], v[48:51], a[52:55], v[212:215]
  buffer_load_dwordx2 a[172:173], v13, s[16:19], s38 offen offset:3072 sc1
  v_mfma_f32_16x16x32_bf16 v[216:219], v[48:51], a[56:59], v[216:219]
  buffer_load_dwordx2 a[174:175], v13, s[16:19], s38 offen offset:3584 sc1
  v_mfma_f32_16x16x32_bf16 v[220:223], v[48:51], a[60:63], v[220:223]
  v_mfma_f32_16x16x32_bf16 v[224:227], v[52:55], a[48:51], v[224:227]
  ds_read_b64_tr_b16 v[48:49], v10 offset:27744
  ds_read_b64_tr_b16 v[50:51], v10 offset:32352
  v_mfma_f32_16x16x32_bf16 v[228:231], v[52:55], a[52:55], v[228:231]
  v_mfma_f32_16x16x32_bf16 v[232:235], v[52:55], a[56:59], v[232:235]
  v_mfma_f32_16x16x32_bf16 v[236:239], v[52:55], a[60:63], v[236:239]
  s_waitcnt lgkmcnt(6)
  v_mfma_f32_16x16x32_bf16 v[240:243], v[56:59], a[48:51], v[240:243]
  ds_read_b64_tr_b16 v[52:53], v10 offset:27776
  ds_read_b64_tr_b16 v[54:55], v10 offset:32384
  v_mfma_f32_16x16x32_bf16 v[244:247], v[56:59], a[52:55], v[244:247]
  v_mfma_f32_16x16x32_bf16 v[248:251], v[56:59], a[56:59], v[248:251]
  v_mfma_f32_16x16x32_bf16 v[252:255], v[56:59], a[60:63], v[252:255]
  s_waitcnt vmcnt(31)
  s_barrier
  v_mfma_f32_16x16x32_bf16 v[112:115], v[60:63], a[64:67], v[112:115]
  ds_read_b64_tr_b16 v[56:57], v10 offset:27808
  ds_read_b64_tr_b16 v[58:59], v10 offset:32416
  v_mfma_f32_16x16x32_bf16 v[116:119], v[60:63], a[68:71], v[116:119]
  v_mfma_f32_16x16x32_bf16 v[120:123], v[60:63], a[72:75], v[120:123]
  s_mov_b32 s38, 90112
  v_mfma_f32_16x16x32_bf16 v[124:127], v[60:63], a[76:79], v[124:127]
  s_waitcnt lgkmcnt(6)
  v_mfma_f32_16x16x32_bf16 v[128:131], v[64:67], a[64:67], v[128:131]
  ds_read_b64_tr_b16 v[60:61], v10 offset:27840
  ds_read_b64_tr_b16 v[62:63], v10 offset:32448
  v_mfma_f32_16x16x32_bf16 v[132:135], v[64:67], a[68:71], v[132:135]
  buffer_load_dwordx2 a[176:177], v13, s[16:19], s38 offen offset:0 sc1
  v_mfma_f32_16x16x32_bf16 v[136:139], v[64:67], a[72:75], v[136:139]
  buffer_load_dwordx2 a[178:179], v13, s[16:19], s38 offen offset:512 sc1
  v_mfma_f32_16x16x32_bf16 v[140:143], v[64:67], a[76:79], v[140:143]
  buffer_load_dwordx2 a[180:181], v13, s[16:19], s38 offen offset:1024 sc1
  v_mfma_f32_16x16x32_bf16 v[144:147], v[68:71], a[64:67], v[144:147]
  buffer_load_dwordx2 a[182:183], v13, s[16:19], s38 offen offset:1536 sc1
  v_mfma_f32_16x16x32_bf16 v[148:151], v[68:71], a[68:71], v[148:151]
  ds_read_b64_tr_b16 v[64:65], v10 offset:27872
  ds_read_b64_tr_b16 v[66:67], v10 offset:32480
  v_mfma_f32_16x16x32_bf16 v[152:155], v[68:71], a[72:75], v[152:155]
  buffer_load_dwordx2 a[184:185], v13, s[16:19], s38 offen offset:2048 sc1
  v_mfma_f32_16x16x32_bf16 v[156:159], v[68:71], a[76:79], v[156:159]
  s_waitcnt lgkmcnt(6)
  v_mfma_f32_16x16x32_bf16 v[160:163], v[48:51], a[64:67], v[160:163]
  buffer_load_dwordx2 a[186:187], v13, s[16:19], s38 offen offset:2560 sc1
  v_mfma_f32_16x16x32_bf16 v[164:167], v[48:51], a[68:71], v[164:167]
  buffer_load_dwordx2 a[188:189], v13, s[16:19], s38 offen offset:3072 sc1
  v_mfma_f32_16x16x32_bf16 v[168:171], v[48:51], a[72:75], v[168:171]
  buffer_load_dwordx2 a[190:191], v13, s[16:19], s38 offen offset:3584 sc1
  v_mfma_f32_16x16x32_bf16 v[172:175], v[48:51], a[76:79], v[172:175]
  ds_read_b64_tr_b16 v[68:69], v10 offset:27904
  s_mov_b32 s38, 126976
  v_mfma_f32_16x16x32_bf16 v[176:179], v[52:55], a[64:67], v[176:179]
  ds_read_b64_tr_b16 v[70:71], v10 offset:32512
  ds_read_b64_tr_b16 v[48:49], v12 offset:18432
  v_mfma_f32_16x16x32_bf16 v[180:183], v[52:55], a[68:71], v[180:183]
  buffer_load_dwordx2 a[192:193], v13, s[16:19], s38 offen offset:0 sc1
  v_mfma_f32_16x16x32_bf16 v[184:187], v[52:55], a[72:75], v[184:187]
  buffer_load_dwordx2 a[194:195], v13, s[16:19], s38 offen offset:512 sc1
  v_mfma_f32_16x16x32_bf16 v[188:191], v[52:55], a[76:79], v[188:191]
  ds_read_b64_tr_b16 v[50:51], v12 offset:23040
  s_waitcnt lgkmcnt(6)
  v_mfma_f32_16x16x32_bf16 v[192:195], v[56:59], a[64:67], v[192:195]
  buffer_load_dwordx2 a[196:197], v13, s[16:19], s38 offen offset:1024 sc1
  v_mfma_f32_16x16x32_bf16 v[196:199], v[56:59], a[68:71], v[196:199]
  buffer_load_dwordx2 a[198:199], v13, s[16:19], s38 offen offset:1536 sc1
  v_mfma_f32_16x16x32_bf16 v[200:203], v[56:59], a[72:75], v[200:203]
  buffer_load_dwordx2 a[200:201], v13, s[16:19], s38 offen offset:2048 sc1
  v_mfma_f32_16x16x32_bf16 v[204:207], v[56:59], a[76:79], v[204:207]
  buffer_load_dwordx2 a[202:203], v13, s[16:19], s38 offen offset:2560 sc1
  v_mfma_f32_16x16x32_bf16 v[208:211], v[60:63], a[64:67], v[208:211]
  buffer_load_dwordx2 a[204:205], v13, s[16:19], s38 offen offset:3072 sc1
  v_mfma_f32_16x16x32_bf16 v[212:215], v[60:63], a[68:71], v[212:215]
  ds_read_b64_tr_b16 v[52:53], v12 offset:27648
  buffer_load_dwordx2 a[206:207], v13, s[16:19], s38 offen offset:3584 sc1
  v_mfma_f32_16x16x32_bf16 v[216:219], v[60:63], a[72:75], v[216:219]
  ds_read_b64_tr_b16 v[54:55], v12 offset:32256
  ds_read_b64_tr_b16 v[56:57], v10 offset:36864
  v_mfma_f32_16x16x32_bf16 v[220:223], v[60:63], a[76:79], v[220:223]
  ds_read_b64_tr_b16 v[58:59], v10 offset:41472
  s_waitcnt lgkmcnt(6)
  v_mfma_f32_16x16x32_bf16 v[224:227], v[64:67], a[64:67], v[224:227]
  ds_read_b64_tr_b16 v[60:61], v10 offset:46080
  ds_read_b64_tr_b16 v[62:63], v10 offset:50688
  v_mfma_f32_16x16x32_bf16 v[228:231], v[64:67], a[68:71], v[228:231]
  v_mfma_f32_16x16x32_bf16 v[232:235], v[64:67], a[72:75], v[232:235]
  v_mfma_f32_16x16x32_bf16 v[236:239], v[64:67], a[76:79], v[236:239]
  v_mfma_f32_16x16x32_bf16 v[240:243], v[68:71], a[64:67], v[240:243]
  ds_read_b64_tr_b16 v[64:65], v11 offset:0
  ds_read_b64_tr_b16 v[66:67], v11 offset:4608
  v_mfma_f32_16x16x32_bf16 v[244:247], v[68:71], a[68:71], v[244:247]
  v_mfma_f32_16x16x32_bf16 v[248:251], v[68:71], a[72:75], v[248:251]
  v_mfma_f32_16x16x32_bf16 v[252:255], v[68:71], a[76:79], v[252:255]
  s_waitcnt vmcnt(45) lgkmcnt(6)
  v_mfma_f32_16x16x32_bf16 v[112:115], v[48:51], a[80:83], v[112:115]
  ds_read_b64_tr_b16 v[68:69], v11 offset:9216
  ds_read_b64_tr_b16 v[70:71], v11 offset:13824
  v_mfma_f32_16x16x32_bf16 v[116:119], v[48:51], a[84:87], v[116:119]
  v_mfma_f32_16x16x32_bf16 v[120:123], v[48:51], a[88:91], v[120:123]
  v_mfma_f32_16x16x32_bf16 v[124:127], v[48:51], a[92:95], v[124:127]
  s_waitcnt vmcnt(40)
  v_mfma_f32_16x16x32_bf16 v[112:115], v[52:55], a[96:99], v[112:115]
  ds_read_b64_tr_b16 v[48:49], v11 offset:18432
  ds_read_b64_tr_b16 v[50:51], v11 offset:23040
  v_mfma_f32_16x16x32_bf16 v[116:119], v[52:55], a[100:103], v[116:119]
  v_mfma_f32_16x16x32_bf16 v[120:123], v[52:55], a[104:107], v[120:123]
  v_mfma_f32_16x16x32_bf16 v[124:127], v[52:55], a[108:111], v[124:127]
  s_waitcnt vmcnt(36) lgkmcnt(6)
  v_mfma_f32_16x16x32_bf16 v[112:115], v[56:59], a[112:115], v[112:115]
  ds_read_b64_tr_b16 v[52:53], v11 offset:27648
  ds_read_b64_tr_b16 v[54:55], v11 offset:32256
  v_mfma_f32_16x16x32_bf16 v[116:119], v[56:59], a[116:119], v[116:119]
  v_mfma_f32_16x16x32_bf16 v[120:123], v[56:59], a[120:123], v[120:123]
  v_mfma_f32_16x16x32_bf16 v[124:127], v[56:59], a[124:127], v[124:127]
  s_waitcnt vmcnt(32)
  v_mfma_f32_16x16x32_bf16 v[112:115], v[60:63], a[128:131], v[112:115]
  ds_read_b64_tr_b16 v[56:57], v12 offset:18464
  ds_read_b64_tr_b16 v[58:59], v12 offset:23072
  v_mfma_f32_16x16x32_bf16 v[116:119], v[60:63], a[132:135], v[116:119]
  v_mfma_f32_16x16x32_bf16 v[120:123], v[60:63], a[136:139], v[120:123]
  v_mfma_f32_16x16x32_bf16 v[124:127], v[60:63], a[140:143], v[124:127]
  s_waitcnt vmcnt(24) lgkmcnt(6)
  v_mfma_f32_16x16x32_bf16 v[112:115], v[64:67], a[144:147], v[112:115]
  ds_read_b64_tr_b16 v[60:61], v12 offset:27680
  ds_read_b64_tr_b16 v[62:63], v12 offset:32288
  v_mfma_f32_16x16x32_bf16 v[116:119], v[64:67], a[148:151], v[116:119]
  v_mfma_f32_16x16x32_bf16 v[120:123], v[64:67], a[152:155], v[120:123]
  v_mfma_f32_16x16x32_bf16 v[124:127], v[64:67], a[156:159], v[124:127]
  s_waitcnt vmcnt(16)
  v_mfma_f32_16x16x32_bf16 v[112:115], v[68:71], a[160:163], v[112:115]
  ds_read_b64_tr_b16 v[64:65], v10 offset:36896
  ds_read_b64_tr_b16 v[66:67], v10 offset:41504
  v_mfma_f32_16x16x32_bf16 v[116:119], v[68:71], a[164:167], v[116:119]
  v_mfma_f32_16x16x32_bf16 v[120:123], v[68:71], a[168:171], v[120:123]
  v_mfma_f32_16x16x32_bf16 v[124:127], v[68:71], a[172:175], v[124:127]
  s_waitcnt vmcnt(8) lgkmcnt(6)
  v_mfma_f32_16x16x32_bf16 v[112:115], v[48:51], a[176:179], v[112:115]
  ds_read_b64_tr_b16 v[68:69], v10 offset:46112
  ds_read_b64_tr_b16 v[70:71], v10 offset:50720
  v_mfma_f32_16x16x32_bf16 v[116:119], v[48:51], a[180:183], v[116:119]
  v_mfma_f32_16x16x32_bf16 v[120:123], v[48:51], a[184:187], v[120:123]
  v_mfma_f32_16x16x32_bf16 v[124:127], v[48:51], a[188:191], v[124:127]
  s_waitcnt vmcnt(0)
  v_mfma_f32_16x16x32_bf16 v[112:115], v[52:55], a[192:195], v[112:115]
  ds_read_b64_tr_b16 v[48:49], v11 offset:32
  ds_read_b64_tr_b16 v[50:51], v11 offset:4640
  v_mfma_f32_16x16x32_bf16 v[116:119], v[52:55], a[196:199], v[116:119]
  v_mfma_f32_16x16x32_bf16 v[120:123], v[52:55], a[200:203], v[120:123]
  v_mfma_f32_16x16x32_bf16 v[124:127], v[52:55], a[204:207], v[124:127]
  s_waitcnt lgkmcnt(6)
  v_mfma_f32_16x16x32_bf16 v[128:131], v[56:59], a[80:83], v[128:131]
  ds_read_b64_tr_b16 v[52:53], v11 offset:9248
  ds_read_b64_tr_b16 v[54:55], v11 offset:13856
  v_mfma_f32_16x16x32_bf16 v[132:135], v[56:59], a[84:87], v[132:135]
  v_mfma_f32_16x16x32_bf16 v[136:139], v[56:59], a[88:91], v[136:139]
  v_mfma_f32_16x16x32_bf16 v[140:143], v[56:59], a[92:95], v[140:143]
  v_cvt_pk_bf16_f32 v96, v112, v113
  v_cvt_pk_bf16_f32 v97, v114, v115
  v_mfma_f32_16x16x32_bf16 v[128:131], v[60:63], a[96:99], v[128:131]
  ds_read_b64_tr_b16 v[56:57], v11 offset:18464
  ds_read_b64_tr_b16 v[58:59], v11 offset:23072
  v_mfma_f32_16x16x32_bf16 v[132:135], v[60:63], a[100:103], v[132:135]
  v_cvt_pk_bf16_f32 v98, v116, v117
  v_cvt_pk_bf16_f32 v99, v118, v119
  v_mfma_f32_16x16x32_bf16 v[136:139], v[60:63], a[104:107], v[136:139]
  s_mov_b32 s68, 0
  buffer_store_dwordx4 v[96:99], v16, s[28:31], s68 offen sc1
  v_mfma_f32_16x16x32_bf16 v[140:143], v[60:63], a[108:111], v[140:143]
  v_cvt_pk_bf16_f32 v100, v120, v121
  s_waitcnt lgkmcnt(6)
  v_mfma_f32_16x16x32_bf16 v[128:131], v[64:67], a[112:115], v[128:131]
  ds_read_b64_tr_b16 v[60:61], v11 offset:27680
  ds_read_b64_tr_b16 v[62:63], v11 offset:32288
  v_mfma_f32_16x16x32_bf16 v[132:135], v[64:67], a[116:119], v[132:135]
  v_cvt_pk_bf16_f32 v101, v122, v123
  v_cvt_pk_bf16_f32 v102, v124, v125
  v_mfma_f32_16x16x32_bf16 v[136:139], v[64:67], a[120:123], v[136:139]
  v_cvt_pk_bf16_f32 v103, v126, v127
  v_mfma_f32_16x16x32_bf16 v[140:143], v[64:67], a[124:127], v[140:143]
  v_mfma_f32_16x16x32_bf16 v[128:131], v[68:71], a[128:131], v[128:131]
  ds_read_b64_tr_b16 v[64:65], v12 offset:18496
  ds_read_b64_tr_b16 v[66:67], v12 offset:23104
  v_mfma_f32_16x16x32_bf16 v[132:135], v[68:71], a[132:135], v[132:135]
  v_mfma_f32_16x16x32_bf16 v[136:139], v[68:71], a[136:139], v[136:139]
  v_mfma_f32_16x16x32_bf16 v[140:143], v[68:71], a[140:143], v[140:143]
  s_waitcnt lgkmcnt(6)
  v_mfma_f32_16x16x32_bf16 v[128:131], v[48:51], a[144:147], v[128:131]
  ds_read_b64_tr_b16 v[68:69], v12 offset:27712
  ds_read_b64_tr_b16 v[70:71], v12 offset:32320
  v_mfma_f32_16x16x32_bf16 v[132:135], v[48:51], a[148:151], v[132:135]
  v_mfma_f32_16x16x32_bf16 v[136:139], v[48:51], a[152:155], v[136:139]
  v_mfma_f32_16x16x32_bf16 v[140:143], v[48:51], a[156:159], v[140:143]
  s_mov_b32 s68, 9216
  buffer_store_dwordx4 v[100:103], v16, s[28:31], s68 offen sc1
  v_mfma_f32_16x16x32_bf16 v[128:131], v[52:55], a[160:163], v[128:131]
  ds_read_b64_tr_b16 v[48:49], v10 offset:36928
  ds_read_b64_tr_b16 v[50:51], v10 offset:41536
  v_mfma_f32_16x16x32_bf16 v[132:135], v[52:55], a[164:167], v[132:135]
  v_mfma_f32_16x16x32_bf16 v[136:139], v[52:55], a[168:171], v[136:139]
  v_mfma_f32_16x16x32_bf16 v[140:143], v[52:55], a[172:175], v[140:143]
  s_waitcnt lgkmcnt(6)
  v_mfma_f32_16x16x32_bf16 v[128:131], v[56:59], a[176:179], v[128:131]
  ds_read_b64_tr_b16 v[52:53], v10 offset:46144
  ds_read_b64_tr_b16 v[54:55], v10 offset:50752
  v_mfma_f32_16x16x32_bf16 v[132:135], v[56:59], a[180:183], v[132:135]
  v_mfma_f32_16x16x32_bf16 v[136:139], v[56:59], a[184:187], v[136:139]
  v_mfma_f32_16x16x32_bf16 v[140:143], v[56:59], a[188:191], v[140:143]
  v_mfma_f32_16x16x32_bf16 v[128:131], v[60:63], a[192:195], v[128:131]
  ds_read_b64_tr_b16 v[56:57], v11 offset:64
  ds_read_b64_tr_b16 v[58:59], v11 offset:4672
  v_mfma_f32_16x16x32_bf16 v[132:135], v[60:63], a[196:199], v[132:135]
  v_mfma_f32_16x16x32_bf16 v[136:139], v[60:63], a[200:203], v[136:139]
  v_mfma_f32_16x16x32_bf16 v[140:143], v[60:63], a[204:207], v[140:143]
  s_waitcnt lgkmcnt(6)
  v_mfma_f32_16x16x32_bf16 v[144:147], v[64:67], a[80:83], v[144:147]
  ds_read_b64_tr_b16 v[60:61], v11 offset:9280
  ds_read_b64_tr_b16 v[62:63], v11 offset:13888
  v_mfma_f32_16x16x32_bf16 v[148:151], v[64:67], a[84:87], v[148:151]
  v_mfma_f32_16x16x32_bf16 v[152:155], v[64:67], a[88:91], v[152:155]
  v_mfma_f32_16x16x32_bf16 v[156:159], v[64:67], a[92:95], v[156:159]
  v_cvt_pk_bf16_f32 v104, v128, v129
  v_cvt_pk_bf16_f32 v105, v130, v131
  v_mfma_f32_16x16x32_bf16 v[144:147], v[68:71], a[96:99], v[144:147]
  ds_read_b64_tr_b16 v[64:65], v11 offset:18496
  ds_read_b64_tr_b16 v[66:67], v11 offset:23104
  v_mfma_f32_16x16x32_bf16 v[148:151], v[68:71], a[100:103], v[148:151]
  v_cvt_pk_bf16_f32 v106, v132, v133
  v_cvt_pk_bf16_f32 v107, v134, v135
  v_mfma_f32_16x16x32_bf16 v[152:155], v[68:71], a[104:107], v[152:155]
  s_mov_b32 s68, 1024
  buffer_store_dwordx4 v[104:107], v16, s[28:31], s68 offen sc1
  v_mfma_f32_16x16x32_bf16 v[156:159], v[68:71], a[108:111], v[156:159]
  v_cvt_pk_bf16_f32 v108, v136, v137
  s_waitcnt lgkmcnt(6)
  v_mfma_f32_16x16x32_bf16 v[144:147], v[48:51], a[112:115], v[144:147]
  ds_read_b64_tr_b16 v[68:69], v11 offset:27712
  ds_read_b64_tr_b16 v[70:71], v11 offset:32320
  v_mfma_f32_16x16x32_bf16 v[148:151], v[48:51], a[116:119], v[148:151]
  v_cvt_pk_bf16_f32 v109, v138, v139
  v_cvt_pk_bf16_f32 v110, v140, v141
  v_mfma_f32_16x16x32_bf16 v[152:155], v[48:51], a[120:123], v[152:155]
  v_cvt_pk_bf16_f32 v111, v142, v143
  v_mfma_f32_16x16x32_bf16 v[156:159], v[48:51], a[124:127], v[156:159]
  v_mfma_f32_16x16x32_bf16 v[144:147], v[52:55], a[128:131], v[144:147]
  ds_read_b64_tr_b16 v[48:49], v12 offset:18528
  ds_read_b64_tr_b16 v[50:51], v12 offset:23136
  v_mfma_f32_16x16x32_bf16 v[148:151], v[52:55], a[132:135], v[148:151]
  v_mfma_f32_16x16x32_bf16 v[152:155], v[52:55], a[136:139], v[152:155]
  v_mfma_f32_16x16x32_bf16 v[156:159], v[52:55], a[140:143], v[156:159]
  s_waitcnt lgkmcnt(6)
  v_mfma_f32_16x16x32_bf16 v[144:147], v[56:59], a[144:147], v[144:147]
  ds_read_b64_tr_b16 v[52:53], v12 offset:27744
  ds_read_b64_tr_b16 v[54:55], v12 offset:32352
  v_mfma_f32_16x16x32_bf16 v[148:151], v[56:59], a[148:151], v[148:151]
  v_mfma_f32_16x16x32_bf16 v[152:155], v[56:59], a[152:155], v[152:155]
  v_mfma_f32_16x16x32_bf16 v[156:159], v[56:59], a[156:159], v[156:159]
  s_mov_b32 s68, 10240
  buffer_store_dwordx4 v[108:111], v16, s[28:31], s68 offen sc1
  v_mfma_f32_16x16x32_bf16 v[144:147], v[60:63], a[160:163], v[144:147]
  ds_read_b64_tr_b16 v[56:57], v10 offset:36960
  ds_read_b64_tr_b16 v[58:59], v10 offset:41568
  v_mfma_f32_16x16x32_bf16 v[148:151], v[60:63], a[164:167], v[148:151]
  v_mfma_f32_16x16x32_bf16 v[152:155], v[60:63], a[168:171], v[152:155]
  v_mfma_f32_16x16x32_bf16 v[156:159], v[60:63], a[172:175], v[156:159]
  s_waitcnt lgkmcnt(6)
  v_mfma_f32_16x16x32_bf16 v[144:147], v[64:67], a[176:179], v[144:147]
  ds_read_b64_tr_b16 v[60:61], v10 offset:46176
  ds_read_b64_tr_b16 v[62:63], v10 offset:50784
  v_mfma_f32_16x16x32_bf16 v[148:151], v[64:67], a[180:183], v[148:151]
  v_mfma_f32_16x16x32_bf16 v[152:155], v[64:67], a[184:187], v[152:155]
  v_mfma_f32_16x16x32_bf16 v[156:159], v[64:67], a[188:191], v[156:159]
  v_mfma_f32_16x16x32_bf16 v[144:147], v[68:71], a[192:195], v[144:147]
  ds_read_b64_tr_b16 v[64:65], v11 offset:96
  ds_read_b64_tr_b16 v[66:67], v11 offset:4704
  v_mfma_f32_16x16x32_bf16 v[148:151], v[68:71], a[196:199], v[148:151]
  v_mfma_f32_16x16x32_bf16 v[152:155], v[68:71], a[200:203], v[152:155]
  v_mfma_f32_16x16x32_bf16 v[156:159], v[68:71], a[204:207], v[156:159]
  s_waitcnt lgkmcnt(6)
  v_mfma_f32_16x16x32_bf16 v[160:163], v[48:51], a[80:83], v[160:163]
  ds_read_b64_tr_b16 v[68:69], v11 offset:9312
  ds_read_b64_tr_b16 v[70:71], v11 offset:13920
  v_mfma_f32_16x16x32_bf16 v[164:167], v[48:51], a[84:87], v[164:167]
  v_mfma_f32_16x16x32_bf16 v[168:171], v[48:51], a[88:91], v[168:171]
  v_mfma_f32_16x16x32_bf16 v[172:175], v[48:51], a[92:95], v[172:175]
  v_cvt_pk_bf16_f32 v96, v144, v145
  v_cvt_pk_bf16_f32 v97, v146, v147
  v_mfma_f32_16x16x32_bf16 v[160:163], v[52:55], a[96:99], v[160:163]
  ds_read_b64_tr_b16 v[48:49], v11 offset:18528
  ds_read_b64_tr_b16 v[50:51], v11 offset:23136
  v_mfma_f32_16x16x32_bf16 v[164:167], v[52:55], a[100:103], v[164:167]
  v_cvt_pk_bf16_f32 v98, v148, v149
  v_cvt_pk_bf16_f32 v99, v150, v151
  v_mfma_f32_16x16x32_bf16 v[168:171], v[52:55], a[104:107], v[168:171]
  s_mov_b32 s68, 2048
  buffer_store_dwordx4 v[96:99], v16, s[28:31], s68 offen sc1
  v_mfma_f32_16x16x32_bf16 v[172:175], v[52:55], a[108:111], v[172:175]
  v_cvt_pk_bf16_f32 v100, v152, v153
  s_waitcnt lgkmcnt(6)
  v_mfma_f32_16x16x32_bf16 v[160:163], v[56:59], a[112:115], v[160:163]
  ds_read_b64_tr_b16 v[52:53], v11 offset:27744
  ds_read_b64_tr_b16 v[54:55], v11 offset:32352
  v_mfma_f32_16x16x32_bf16 v[164:167], v[56:59], a[116:119], v[164:167]
  v_cvt_pk_bf16_f32 v101, v154, v155
  v_cvt_pk_bf16_f32 v102, v156, v157
  v_mfma_f32_16x16x32_bf16 v[168:171], v[56:59], a[120:123], v[168:171]
  v_cvt_pk_bf16_f32 v103, v158, v159
  v_mfma_f32_16x16x32_bf16 v[172:175], v[56:59], a[124:127], v[172:175]
  v_mfma_f32_16x16x32_bf16 v[160:163], v[60:63], a[128:131], v[160:163]
  ds_read_b64_tr_b16 v[56:57], v12 offset:18560
  ds_read_b64_tr_b16 v[58:59], v12 offset:23168
  v_mfma_f32_16x16x32_bf16 v[164:167], v[60:63], a[132:135], v[164:167]
  v_mfma_f32_16x16x32_bf16 v[168:171], v[60:63], a[136:139], v[168:171]
  v_mfma_f32_16x16x32_bf16 v[172:175], v[60:63], a[140:143], v[172:175]
  s_waitcnt lgkmcnt(6)
  v_mfma_f32_16x16x32_bf16 v[160:163], v[64:67], a[144:147], v[160:163]
  ds_read_b64_tr_b16 v[60:61], v12 offset:27776
  ds_read_b64_tr_b16 v[62:63], v12 offset:32384
  v_mfma_f32_16x16x32_bf16 v[164:167], v[64:67], a[148:151], v[164:167]
  v_mfma_f32_16x16x32_bf16 v[168:171], v[64:67], a[152:155], v[168:171]
  v_mfma_f32_16x16x32_bf16 v[172:175], v[64:67], a[156:159], v[172:175]
  s_mov_b32 s68, 11264
  buffer_store_dwordx4 v[100:103], v16, s[28:31], s68 offen sc1
  v_mfma_f32_16x16x32_bf16 v[160:163], v[68:71], a[160:163], v[160:163]
  ds_read_b64_tr_b16 v[64:65], v10 offset:36992
  ds_read_b64_tr_b16 v[66:67], v10 offset:41600
  v_mfma_f32_16x16x32_bf16 v[164:167], v[68:71], a[164:167], v[164:167]
  v_mfma_f32_16x16x32_bf16 v[168:171], v[68:71], a[168:171], v[168:171]
  v_mfma_f32_16x16x32_bf16 v[172:175], v[68:71], a[172:175], v[172:175]
  s_waitcnt lgkmcnt(6)
  v_mfma_f32_16x16x32_bf16 v[160:163], v[48:51], a[176:179], v[160:163]
  ds_read_b64_tr_b16 v[68:69], v10 offset:46208
  ds_read_b64_tr_b16 v[70:71], v10 offset:50816
  v_mfma_f32_16x16x32_bf16 v[164:167], v[48:51], a[180:183], v[164:167]
  v_mfma_f32_16x16x32_bf16 v[168:171], v[48:51], a[184:187], v[168:171]
  v_mfma_f32_16x16x32_bf16 v[172:175], v[48:51], a[188:191], v[172:175]
  v_mfma_f32_16x16x32_bf16 v[160:163], v[52:55], a[192:195], v[160:163]
  ds_read_b64_tr_b16 v[48:49], v11 offset:128
  ds_read_b64_tr_b16 v[50:51], v11 offset:4736
  v_mfma_f32_16x16x32_bf16 v[164:167], v[52:55], a[196:199], v[164:167]
  v_mfma_f32_16x16x32_bf16 v[168:171], v[52:55], a[200:203], v[168:171]
  v_mfma_f32_16x16x32_bf16 v[172:175], v[52:55], a[204:207], v[172:175]
  s_waitcnt lgkmcnt(6)
  v_mfma_f32_16x16x32_bf16 v[176:179], v[56:59], a[80:83], v[176:179]
  ds_read_b64_tr_b16 v[52:53], v11 offset:9344
  ds_read_b64_tr_b16 v[54:55], v11 offset:13952
  v_mfma_f32_16x16x32_bf16 v[180:183], v[56:59], a[84:87], v[180:183]
  v_mfma_f32_16x16x32_bf16 v[184:187], v[56:59], a[88:91], v[184:187]
  v_mfma_f32_16x16x32_bf16 v[188:191], v[56:59], a[92:95], v[188:191]
  v_cvt_pk_bf16_f32 v104, v160, v161
  v_cvt_pk_bf16_f32 v105, v162, v163
  v_mfma_f32_16x16x32_bf16 v[176:179], v[60:63], a[96:99], v[176:179]
  ds_read_b64_tr_b16 v[56:57], v11 offset:18560
  ds_read_b64_tr_b16 v[58:59], v11 offset:23168
  v_mfma_f32_16x16x32_bf16 v[180:183], v[60:63], a[100:103], v[180:183]
  v_cvt_pk_bf16_f32 v106, v164, v165
  v_cvt_pk_bf16_f32 v107, v166, v167
  v_mfma_f32_16x16x32_bf16 v[184:187], v[60:63], a[104:107], v[184:187]
  s_mov_b32 s68, 3072
  buffer_store_dwordx4 v[104:107], v16, s[28:31], s68 offen sc1
  v_mfma_f32_16x16x32_bf16 v[188:191], v[60:63], a[108:111], v[188:191]
  v_cvt_pk_bf16_f32 v108, v168, v169
  s_waitcnt lgkmcnt(6)
  v_mfma_f32_16x16x32_bf16 v[176:179], v[64:67], a[112:115], v[176:179]
  ds_read_b64_tr_b16 v[60:61], v11 offset:27776
  ds_read_b64_tr_b16 v[62:63], v11 offset:32384
  v_mfma_f32_16x16x32_bf16 v[180:183], v[64:67], a[116:119], v[180:183]
  v_cvt_pk_bf16_f32 v109, v170, v171
  v_cvt_pk_bf16_f32 v110, v172, v173
  v_mfma_f32_16x16x32_bf16 v[184:187], v[64:67], a[120:123], v[184:187]
  v_cvt_pk_bf16_f32 v111, v174, v175
  v_mfma_f32_16x16x32_bf16 v[188:191], v[64:67], a[124:127], v[188:191]
  v_mfma_f32_16x16x32_bf16 v[176:179], v[68:71], a[128:131], v[176:179]
  ds_read_b64_tr_b16 v[64:65], v12 offset:18592
  ds_read_b64_tr_b16 v[66:67], v12 offset:23200
  v_mfma_f32_16x16x32_bf16 v[180:183], v[68:71], a[132:135], v[180:183]
  v_mfma_f32_16x16x32_bf16 v[184:187], v[68:71], a[136:139], v[184:187]
  v_mfma_f32_16x16x32_bf16 v[188:191], v[68:71], a[140:143], v[188:191]
  s_waitcnt lgkmcnt(6)
  v_mfma_f32_16x16x32_bf16 v[176:179], v[48:51], a[144:147], v[176:179]
  ds_read_b64_tr_b16 v[68:69], v12 offset:27808
  ds_read_b64_tr_b16 v[70:71], v12 offset:32416
  v_mfma_f32_16x16x32_bf16 v[180:183], v[48:51], a[148:151], v[180:183]
  v_mfma_f32_16x16x32_bf16 v[184:187], v[48:51], a[152:155], v[184:187]
  v_mfma_f32_16x16x32_bf16 v[188:191], v[48:51], a[156:159], v[188:191]
  s_mov_b32 s68, 12288
  buffer_store_dwordx4 v[108:111], v16, s[28:31], s68 offen sc1
  v_mfma_f32_16x16x32_bf16 v[176:179], v[52:55], a[160:163], v[176:179]
  ds_read_b64_tr_b16 v[48:49], v10 offset:37024
  ds_read_b64_tr_b16 v[50:51], v10 offset:41632
  v_mfma_f32_16x16x32_bf16 v[180:183], v[52:55], a[164:167], v[180:183]
  v_mfma_f32_16x16x32_bf16 v[184:187], v[52:55], a[168:171], v[184:187]
  v_mfma_f32_16x16x32_bf16 v[188:191], v[52:55], a[172:175], v[188:191]
  s_waitcnt lgkmcnt(6)
  v_mfma_f32_16x16x32_bf16 v[176:179], v[56:59], a[176:179], v[176:179]
  ds_read_b64_tr_b16 v[52:53], v10 offset:46240
  ds_read_b64_tr_b16 v[54:55], v10 offset:50848
  v_mfma_f32_16x16x32_bf16 v[180:183], v[56:59], a[180:183], v[180:183]
  v_mfma_f32_16x16x32_bf16 v[184:187], v[56:59], a[184:187], v[184:187]
  v_mfma_f32_16x16x32_bf16 v[188:191], v[56:59], a[188:191], v[188:191]
  v_mfma_f32_16x16x32_bf16 v[176:179], v[60:63], a[192:195], v[176:179]
  ds_read_b64_tr_b16 v[56:57], v11 offset:160
  ds_read_b64_tr_b16 v[58:59], v11 offset:4768
  v_mfma_f32_16x16x32_bf16 v[180:183], v[60:63], a[196:199], v[180:183]
  v_mfma_f32_16x16x32_bf16 v[184:187], v[60:63], a[200:203], v[184:187]
  v_mfma_f32_16x16x32_bf16 v[188:191], v[60:63], a[204:207], v[188:191]
  s_waitcnt lgkmcnt(6)
  v_mfma_f32_16x16x32_bf16 v[192:195], v[64:67], a[80:83], v[192:195]
  ds_read_b64_tr_b16 v[60:61], v11 offset:9376
  ds_read_b64_tr_b16 v[62:63], v11 offset:13984
  v_mfma_f32_16x16x32_bf16 v[196:199], v[64:67], a[84:87], v[196:199]
  v_mfma_f32_16x16x32_bf16 v[200:203], v[64:67], a[88:91], v[200:203]
  v_mfma_f32_16x16x32_bf16 v[204:207], v[64:67], a[92:95], v[204:207]
  v_cvt_pk_bf16_f32 v96, v176, v177
  v_cvt_pk_bf16_f32 v97, v178, v179
  v_mfma_f32_16x16x32_bf16 v[192:195], v[68:71], a[96:99], v[192:195]
  ds_read_b64_tr_b16 v[64:65], v11 offset:18592
  ds_read_b64_tr_b16 v[66:67], v11 offset:23200
  v_mfma_f32_16x16x32_bf16 v[196:199], v[68:71], a[100:103], v[196:199]
  v_cvt_pk_bf16_f32 v98, v180, v181
  v_cvt_pk_bf16_f32 v99, v182, v183
  v_mfma_f32_16x16x32_bf16 v[200:203], v[68:71], a[104:107], v[200:203]
  s_mov_b32 s68, 4096
  buffer_store_dwordx4 v[96:99], v16, s[28:31], s68 offen sc1
  v_mfma_f32_16x16x32_bf16 v[204:207], v[68:71], a[108:111], v[204:207]
  v_cvt_pk_bf16_f32 v100, v184, v185
  s_waitcnt lgkmcnt(6)
  v_mfma_f32_16x16x32_bf16 v[192:195], v[48:51], a[112:115], v[192:195]
  ds_read_b64_tr_b16 v[68:69], v11 offset:27808
  ds_read_b64_tr_b16 v[70:71], v11 offset:32416
  v_mfma_f32_16x16x32_bf16 v[196:199], v[48:51], a[116:119], v[196:199]
  v_cvt_pk_bf16_f32 v101, v186, v187
  v_cvt_pk_bf16_f32 v102, v188, v189
  v_mfma_f32_16x16x32_bf16 v[200:203], v[48:51], a[120:123], v[200:203]
  v_cvt_pk_bf16_f32 v103, v190, v191
  v_mfma_f32_16x16x32_bf16 v[204:207], v[48:51], a[124:127], v[204:207]
  v_mfma_f32_16x16x32_bf16 v[192:195], v[52:55], a[128:131], v[192:195]
  ds_read_b64_tr_b16 v[48:49], v12 offset:18624
  ds_read_b64_tr_b16 v[50:51], v12 offset:23232
  v_mfma_f32_16x16x32_bf16 v[196:199], v[52:55], a[132:135], v[196:199]
  v_mfma_f32_16x16x32_bf16 v[200:203], v[52:55], a[136:139], v[200:203]
  v_mfma_f32_16x16x32_bf16 v[204:207], v[52:55], a[140:143], v[204:207]
  s_waitcnt lgkmcnt(6)
  v_mfma_f32_16x16x32_bf16 v[192:195], v[56:59], a[144:147], v[192:195]
  ds_read_b64_tr_b16 v[52:53], v12 offset:27840
  ds_read_b64_tr_b16 v[54:55], v12 offset:32448
  v_mfma_f32_16x16x32_bf16 v[196:199], v[56:59], a[148:151], v[196:199]
  v_mfma_f32_16x16x32_bf16 v[200:203], v[56:59], a[152:155], v[200:203]
  v_mfma_f32_16x16x32_bf16 v[204:207], v[56:59], a[156:159], v[204:207]
  s_mov_b32 s68, 13312
  buffer_store_dwordx4 v[100:103], v16, s[28:31], s68 offen sc1
  v_mfma_f32_16x16x32_bf16 v[192:195], v[60:63], a[160:163], v[192:195]
  ds_read_b64_tr_b16 v[56:57], v10 offset:37056
  ds_read_b64_tr_b16 v[58:59], v10 offset:41664
  v_mfma_f32_16x16x32_bf16 v[196:199], v[60:63], a[164:167], v[196:199]
  v_mfma_f32_16x16x32_bf16 v[200:203], v[60:63], a[168:171], v[200:203]
  v_mfma_f32_16x16x32_bf16 v[204:207], v[60:63], a[172:175], v[204:207]
  s_waitcnt lgkmcnt(6)
  v_mfma_f32_16x16x32_bf16 v[192:195], v[64:67], a[176:179], v[192:195]
  ds_read_b64_tr_b16 v[60:61], v10 offset:46272
  ds_read_b64_tr_b16 v[62:63], v10 offset:50880
  v_mfma_f32_16x16x32_bf16 v[196:199], v[64:67], a[180:183], v[196:199]
  v_mfma_f32_16x16x32_bf16 v[200:203], v[64:67], a[184:187], v[200:203]
  v_mfma_f32_16x16x32_bf16 v[204:207], v[64:67], a[188:191], v[204:207]
  v_mfma_f32_16x16x32_bf16 v[192:195], v[68:71], a[192:195], v[192:195]
  ds_read_b64_tr_b16 v[64:65], v11 offset:192
  ds_read_b64_tr_b16 v[66:67], v11 offset:4800
  v_mfma_f32_16x16x32_bf16 v[196:199], v[68:71], a[196:199], v[196:199]
  s_waitcnt vmcnt(2)
  s_barrier
  v_mfma_f32_16x16x32_bf16 v[200:203], v[68:71], a[200:203], v[200:203]
  v_mov_b32 v75, s100
  buffer_store_dword v75, v77, s[96:99], 0 offen offset:512 sc1
  v_mfma_f32_16x16x32_bf16 v[204:207], v[68:71], a[204:207], v[204:207]
  s_waitcnt lgkmcnt(6)
  v_mfma_f32_16x16x32_bf16 v[208:211], v[48:51], a[80:83], v[208:211]
  ds_read_b64_tr_b16 v[68:69], v11 offset:9408
  ds_read_b64_tr_b16 v[70:71], v11 offset:14016
  v_mfma_f32_16x16x32_bf16 v[212:215], v[48:51], a[84:87], v[212:215]
  v_mfma_f32_16x16x32_bf16 v[216:219], v[48:51], a[88:91], v[216:219]
  v_mfma_f32_16x16x32_bf16 v[220:223], v[48:51], a[92:95], v[220:223]
  v_cvt_pk_bf16_f32 v104, v192, v193
  v_cvt_pk_bf16_f32 v105, v194, v195
  v_mfma_f32_16x16x32_bf16 v[208:211], v[52:55], a[96:99], v[208:211]
  ds_read_b64_tr_b16 v[48:49], v11 offset:18624
  ds_read_b64_tr_b16 v[50:51], v11 offset:23232
  v_mfma_f32_16x16x32_bf16 v[212:215], v[52:55], a[100:103], v[212:215]
  v_cvt_pk_bf16_f32 v106, v196, v197
  v_cvt_pk_bf16_f32 v107, v198, v199
  v_mfma_f32_16x16x32_bf16 v[216:219], v[52:55], a[104:107], v[216:219]
  s_mov_b32 s68, 5120
  buffer_store_dwordx4 v[104:107], v16, s[28:31], s68 offen sc1
  v_mfma_f32_16x16x32_bf16 v[220:223], v[52:55], a[108:111], v[220:223]
  v_cvt_pk_bf16_f32 v108, v200, v201
  s_waitcnt lgkmcnt(6)
  v_mfma_f32_16x16x32_bf16 v[208:211], v[56:59], a[112:115], v[208:211]
  ds_read_b64_tr_b16 v[52:53], v11 offset:27840
  ds_read_b64_tr_b16 v[54:55], v11 offset:32448
  v_mfma_f32_16x16x32_bf16 v[212:215], v[56:59], a[116:119], v[212:215]
  v_cvt_pk_bf16_f32 v109, v202, v203
  v_cvt_pk_bf16_f32 v110, v204, v205
  v_mfma_f32_16x16x32_bf16 v[216:219], v[56:59], a[120:123], v[216:219]
  v_cvt_pk_bf16_f32 v111, v206, v207
  v_mfma_f32_16x16x32_bf16 v[220:223], v[56:59], a[124:127], v[220:223]
  v_mfma_f32_16x16x32_bf16 v[208:211], v[60:63], a[128:131], v[208:211]
  ds_read_b64_tr_b16 v[56:57], v12 offset:18656
  ds_read_b64_tr_b16 v[58:59], v12 offset:23264
  v_mfma_f32_16x16x32_bf16 v[212:215], v[60:63], a[132:135], v[212:215]
  v_mfma_f32_16x16x32_bf16 v[216:219], v[60:63], a[136:139], v[216:219]
  v_mfma_f32_16x16x32_bf16 v[220:223], v[60:63], a[140:143], v[220:223]
  s_waitcnt lgkmcnt(6)
  v_mfma_f32_16x16x32_bf16 v[208:211], v[64:67], a[144:147], v[208:211]
  ds_read_b64_tr_b16 v[60:61], v12 offset:27872
  ds_read_b64_tr_b16 v[62:63], v12 offset:32480
  v_mfma_f32_16x16x32_bf16 v[212:215], v[64:67], a[148:151], v[212:215]
  v_mfma_f32_16x16x32_bf16 v[216:219], v[64:67], a[152:155], v[216:219]
  v_mfma_f32_16x16x32_bf16 v[220:223], v[64:67], a[156:159], v[220:223]
  s_mov_b32 s68, 14336
  buffer_store_dwordx4 v[108:111], v16, s[28:31], s68 offen sc1
  v_mfma_f32_16x16x32_bf16 v[208:211], v[68:71], a[160:163], v[208:211]
  ds_read_b64_tr_b16 v[64:65], v10 offset:37088
  ds_read_b64_tr_b16 v[66:67], v10 offset:41696
  v_mfma_f32_16x16x32_bf16 v[212:215], v[68:71], a[164:167], v[212:215]
  v_mfma_f32_16x16x32_bf16 v[216:219], v[68:71], a[168:171], v[216:219]
  v_mfma_f32_16x16x32_bf16 v[220:223], v[68:71], a[172:175], v[220:223]
  s_waitcnt lgkmcnt(6)
  v_mfma_f32_16x16x32_bf16 v[208:211], v[48:51], a[176:179], v[208:211]
  ds_read_b64_tr_b16 v[68:69], v10 offset:46304
  ds_read_b64_tr_b16 v[70:71], v10 offset:50912
  v_mfma_f32_16x16x32_bf16 v[212:215], v[48:51], a[180:183], v[212:215]
  v_mfma_f32_16x16x32_bf16 v[216:219], v[48:51], a[184:187], v[216:219]
  v_mfma_f32_16x16x32_bf16 v[220:223], v[48:51], a[188:191], v[220:223]
  v_mfma_f32_16x16x32_bf16 v[208:211], v[52:55], a[192:195], v[208:211]
  ds_read_b64_tr_b16 v[48:49], v11 offset:224
  ds_read_b64_tr_b16 v[50:51], v11 offset:4832
  v_mfma_f32_16x16x32_bf16 v[212:215], v[52:55], a[196:199], v[212:215]
  v_mfma_f32_16x16x32_bf16 v[216:219], v[52:55], a[200:203], v[216:219]
  v_mfma_f32_16x16x32_bf16 v[220:223], v[52:55], a[204:207], v[220:223]
  s_waitcnt lgkmcnt(6)
  v_mfma_f32_16x16x32_bf16 v[224:227], v[56:59], a[80:83], v[224:227]
  ds_read_b64_tr_b16 v[52:53], v11 offset:9440
  ds_read_b64_tr_b16 v[54:55], v11 offset:14048
  v_mfma_f32_16x16x32_bf16 v[228:231], v[56:59], a[84:87], v[228:231]
  v_mfma_f32_16x16x32_bf16 v[232:235], v[56:59], a[88:91], v[232:235]
  v_mfma_f32_16x16x32_bf16 v[236:239], v[56:59], a[92:95], v[236:239]
  v_cvt_pk_bf16_f32 v96, v208, v209
  v_cvt_pk_bf16_f32 v97, v210, v211
  v_mfma_f32_16x16x32_bf16 v[224:227], v[60:63], a[96:99], v[224:227]
  ds_read_b64_tr_b16 v[56:57], v11 offset:18656
  ds_read_b64_tr_b16 v[58:59], v11 offset:23264
  v_mfma_f32_16x16x32_bf16 v[228:231], v[60:63], a[100:103], v[228:231]
  v_cvt_pk_bf16_f32 v98, v212, v213
  v_cvt_pk_bf16_f32 v99, v214, v215
  v_mfma_f32_16x16x32_bf16 v[232:235], v[60:63], a[104:107], v[232:235]
  s_mov_b32 s68, 6144
  buffer_store_dwordx4 v[96:99], v16, s[28:31], s68 offen sc1
  v_mfma_f32_16x16x32_bf16 v[236:239], v[60:63], a[108:111], v[236:239]
  v_cvt_pk_bf16_f32 v100, v216, v217
  s_waitcnt lgkmcnt(6)
  v_mfma_f32_16x16x32_bf16 v[224:227], v[64:67], a[112:115], v[224:227]
  ds_read_b64_tr_b16 v[60:61], v11 offset:27872
  ds_read_b64_tr_b16 v[62:63], v11 offset:32480
  v_mfma_f32_16x16x32_bf16 v[228:231], v[64:67], a[116:119], v[228:231]
  v_cvt_pk_bf16_f32 v101, v218, v219
  v_cvt_pk_bf16_f32 v102, v220, v221
  v_mfma_f32_16x16x32_bf16 v[232:235], v[64:67], a[120:123], v[232:235]
  v_cvt_pk_bf16_f32 v103, v222, v223
  v_mfma_f32_16x16x32_bf16 v[236:239], v[64:67], a[124:127], v[236:239]
  v_mfma_f32_16x16x32_bf16 v[224:227], v[68:71], a[128:131], v[224:227]
  ds_read_b64_tr_b16 v[64:65], v12 offset:18688
  ds_read_b64_tr_b16 v[66:67], v12 offset:23296
  v_mfma_f32_16x16x32_bf16 v[228:231], v[68:71], a[132:135], v[228:231]
  v_mfma_f32_16x16x32_bf16 v[232:235], v[68:71], a[136:139], v[232:235]
  v_mfma_f32_16x16x32_bf16 v[236:239], v[68:71], a[140:143], v[236:239]
  s_waitcnt lgkmcnt(6)
  v_mfma_f32_16x16x32_bf16 v[224:227], v[48:51], a[144:147], v[224:227]
  ds_read_b64_tr_b16 v[68:69], v12 offset:27904
  ds_read_b64_tr_b16 v[70:71], v12 offset:32512
  v_mfma_f32_16x16x32_bf16 v[228:231], v[48:51], a[148:151], v[228:231]
  v_mfma_f32_16x16x32_bf16 v[232:235], v[48:51], a[152:155], v[232:235]
  v_mfma_f32_16x16x32_bf16 v[236:239], v[48:51], a[156:159], v[236:239]
  s_mov_b32 s68, 15360
  buffer_store_dwordx4 v[100:103], v16, s[28:31], s68 offen sc1
  v_mfma_f32_16x16x32_bf16 v[224:227], v[52:55], a[160:163], v[224:227]
  ds_read_b64_tr_b16 v[48:49], v10 offset:37120
  ds_read_b64_tr_b16 v[50:51], v10 offset:41728
  v_mfma_f32_16x16x32_bf16 v[228:231], v[52:55], a[164:167], v[228:231]
  v_mfma_f32_16x16x32_bf16 v[232:235], v[52:55], a[168:171], v[232:235]
  v_mfma_f32_16x16x32_bf16 v[236:239], v[52:55], a[172:175], v[236:239]
  s_waitcnt lgkmcnt(6)
  v_mfma_f32_16x16x32_bf16 v[224:227], v[56:59], a[176:179], v[224:227]
  ds_read_b64_tr_b16 v[52:53], v10 offset:46336
  ds_read_b64_tr_b16 v[54:55], v10 offset:50944
  v_mfma_f32_16x16x32_bf16 v[228:231], v[56:59], a[180:183], v[228:231]
  v_mfma_f32_16x16x32_bf16 v[232:235], v[56:59], a[184:187], v[232:235]
  v_mfma_f32_16x16x32_bf16 v[236:239], v[56:59], a[188:191], v[236:239]
  v_mfma_f32_16x16x32_bf16 v[224:227], v[60:63], a[192:195], v[224:227]
  ds_read_b64_tr_b16 v[56:57], v11 offset:256
  ds_read_b64_tr_b16 v[58:59], v11 offset:4864
  v_mfma_f32_16x16x32_bf16 v[228:231], v[60:63], a[196:199], v[228:231]
  v_mfma_f32_16x16x32_bf16 v[232:235], v[60:63], a[200:203], v[232:235]
  v_mfma_f32_16x16x32_bf16 v[236:239], v[60:63], a[204:207], v[236:239]
  s_waitcnt lgkmcnt(6)
  v_mfma_f32_16x16x32_bf16 v[240:243], v[64:67], a[80:83], v[240:243]
  ds_read_b64_tr_b16 v[60:61], v11 offset:9472
  ds_read_b64_tr_b16 v[62:63], v11 offset:14080
  v_mfma_f32_16x16x32_bf16 v[244:247], v[64:67], a[84:87], v[244:247]
  v_mfma_f32_16x16x32_bf16 v[248:251], v[64:67], a[88:91], v[248:251]
  v_mfma_f32_16x16x32_bf16 v[252:255], v[64:67], a[92:95], v[252:255]
  v_cvt_pk_bf16_f32 v104, v224, v225
  v_cvt_pk_bf16_f32 v105, v226, v227
  v_mfma_f32_16x16x32_bf16 v[240:243], v[68:71], a[96:99], v[240:243]
  ds_read_b64_tr_b16 v[64:65], v11 offset:18688
  ds_read_b64_tr_b16 v[66:67], v11 offset:23296
  v_mfma_f32_16x16x32_bf16 v[244:247], v[68:71], a[100:103], v[244:247]
  v_cvt_pk_bf16_f32 v106, v228, v229
  v_cvt_pk_bf16_f32 v107, v230, v231
  v_mfma_f32_16x16x32_bf16 v[248:251], v[68:71], a[104:107], v[248:251]
  s_mov_b32 s68, 7168
  buffer_store_dwordx4 v[104:107], v16, s[28:31], s68 offen sc1
  v_mfma_f32_16x16x32_bf16 v[252:255], v[68:71], a[108:111], v[252:255]
  v_cvt_pk_bf16_f32 v108, v232, v233
  s_waitcnt lgkmcnt(6)
  v_mfma_f32_16x16x32_bf16 v[240:243], v[48:51], a[112:115], v[240:243]
  ds_read_b64_tr_b16 v[68:69], v11 offset:27904
  ds_read_b64_tr_b16 v[70:71], v11 offset:32512
  v_mfma_f32_16x16x32_bf16 v[244:247], v[48:51], a[116:119], v[244:247]
  v_cvt_pk_bf16_f32 v109, v234, v235
  v_cvt_pk_bf16_f32 v110, v236, v237
  v_mfma_f32_16x16x32_bf16 v[248:251], v[48:51], a[120:123], v[248:251]
  v_cvt_pk_bf16_f32 v111, v238, v239
  v_mfma_f32_16x16x32_bf16 v[252:255], v[48:51], a[124:127], v[252:255]
  v_mfma_f32_16x16x32_bf16 v[240:243], v[52:55], a[128:131], v[240:243]
  v_mfma_f32_16x16x32_bf16 v[244:247], v[52:55], a[132:135], v[244:247]
  v_mfma_f32_16x16x32_bf16 v[248:251], v[52:55], a[136:139], v[248:251]
  v_mfma_f32_16x16x32_bf16 v[252:255], v[52:55], a[140:143], v[252:255]
  s_waitcnt lgkmcnt(4)
  v_mfma_f32_16x16x32_bf16 v[240:243], v[56:59], a[144:147], v[240:243]
  buffer_load_dword v74, v79, s[96:99], 0 offen offset:512 sc1
  v_mfma_f32_16x16x32_bf16 v[244:247], v[56:59], a[148:151], v[244:247]
  v_mfma_f32_16x16x32_bf16 v[248:251], v[56:59], a[152:155], v[248:251]
  v_mfma_f32_16x16x32_bf16 v[252:255], v[56:59], a[156:159], v[252:255]
  s_mov_b32 s68, 16384
  buffer_store_dwordx4 v[108:111], v16, s[28:31], s68 offen sc1
  v_mfma_f32_16x16x32_bf16 v[240:243], v[60:63], a[160:163], v[240:243]
  v_mfma_f32_16x16x32_bf16 v[244:247], v[60:63], a[164:167], v[244:247]
  v_mfma_f32_16x16x32_bf16 v[248:251], v[60:63], a[168:171], v[248:251]
  v_mfma_f32_16x16x32_bf16 v[252:255], v[60:63], a[172:175], v[252:255]
  s_waitcnt lgkmcnt(0)
  v_mfma_f32_16x16x32_bf16 v[240:243], v[64:67], a[176:179], v[240:243]
  v_mfma_f32_16x16x32_bf16 v[244:247], v[64:67], a[180:183], v[244:247]
  v_mfma_f32_16x16x32_bf16 v[248:251], v[64:67], a[184:187], v[248:251]
  v_mfma_f32_16x16x32_bf16 v[252:255], v[64:67], a[188:191], v[252:255]
  v_mfma_f32_16x16x32_bf16 v[240:243], v[68:71], a[192:195], v[240:243]
  v_mfma_f32_16x16x32_bf16 v[244:247], v[68:71], a[196:199], v[244:247]
  v_mfma_f32_16x16x32_bf16 v[248:251], v[68:71], a[200:203], v[248:251]
  v_mfma_f32_16x16x32_bf16 v[252:255], v[68:71], a[204:207], v[252:255]
  s_nop 4
  v_cvt_pk_bf16_f32 v96, v240, v241
  v_cvt_pk_bf16_f32 v97, v242, v243
  v_cvt_pk_bf16_f32 v98, v244, v245
  v_cvt_pk_bf16_f32 v99, v246, v247
  s_mov_b32 s68, 8192
  buffer_store_dwordx4 v[96:99], v16, s[28:31], s68 offen sc1
  v_cvt_pk_bf16_f32 v100, v248, v249
  v_cvt_pk_bf16_f32 v101, v250, v251
  v_cvt_pk_bf16_f32 v102, v252, v253
  v_cvt_pk_bf16_f32 v103, v254, v255
  s_mov_b32 s68, 17408
  buffer_store_dwordx4 v[100:103], v16, s[28:31], s68 offen sc1
L_p2_done:
  s_waitcnt vmcnt(5)
  s_barrier
  v_mov_b32 v75, s100
  buffer_store_dword v75, v77, s[96:99], 0 offen offset:640 sc1
  s_waitcnt vmcnt(1)
  s_barrier
  v_mov_b32 v75, s100
  buffer_store_dword v75, v77, s[96:99], 0 offen offset:768 sc1
  v_cmp_eq_u32 vcc, s100, v74
  s_cmp_eq_u64 vcc, -1
  s_cbranch_scc0 L_retry5
L_back5:
  s_mov_b32 s39, 0
  buffer_load_dwordx4 v[112:115], v80, s[32:35], s39 offen offset:0 sc1
  s_mov_b32 s39, 4718592
  buffer_load_dwordx4 v[120:123], v80, s[32:35], s39 offen offset:0 sc1
  s_mov_b32 s39, 9437184
  buffer_load_dwordx4 v[128:131], v80, s[32:35], s39 offen offset:0 sc1
  s_mov_b32 s39, 14155776
  buffer_load_dwordx4 v[136:139], v80, s[32:35], s39 offen offset:0 sc1
  s_mov_b32 s39, 2359296
  buffer_load_dwordx4 v[116:119], v80, s[32:35], s39 offen offset:0 sc1
  s_mov_b32 s39, 7077888
  buffer_load_dwordx4 v[124:127], v80, s[32:35], s39 offen offset:0 sc1
  s_mov_b32 s39, 11796480
  buffer_load_dwordx4 v[132:135], v80, s[32:35], s39 offen offset:0 sc1
  s_mov_b32 s39, 16515072
  buffer_load_dwordx4 v[140:143], v80, s[32:35], s39 offen offset:0 sc1
  buffer_load_dwordx2 v[52:53], v81, s[20:23], 0 offen offset:0
  buffer_load_dwordx2 v[54:55], v81, s[20:23], s66 offen offset:0
  buffer_load_dwordx2 v[56:57], v83, s[20:23], 0 offen offset:0
  buffer_load_dwordx2 v[58:59], v83, s[20:23], s66 offen offset:0
  buffer_load_dwordx2 v[60:61], v83, s[20:23], 0 offen offset:32
  buffer_load_dwordx2 v[62:63], v83, s[20:23], s66 offen offset:32
  v_mov_b32 v18, 0x3f80
  v_mov_b32 v19, 0x3f800000
  s_waitcnt vmcnt(13)
  v_lshlrev_b32 v10, 16, v112
  v_and_b32 v11, 0xffff0000, v112
  v_lshlrev_b32 v12, 16, v113
  v_and_b32 v13, 0xffff0000, v113
  v_lshlrev_b32 v14, 16, v114
  v_and_b32 v15, 0xffff0000, v114
  v_lshlrev_b32 v16, 16, v115
  v_and_b32 v17, 0xffff0000, v115
  s_waitcnt vmcnt(12)
  v_dot2c_f32_bf16 v10, v120, v18
  v_dot2c_f32_bf16 v11, v120, v19
  v_dot2c_f32_bf16 v12, v121, v18
  v_dot2c_f32_bf16 v13, v121, v19
  v_dot2c_f32_bf16 v14, v122, v18
  v_dot2c_f32_bf16 v15, v122, v19
  v_dot2c_f32_bf16 v16, v123, v18
  v_dot2c_f32_bf16 v17, v123, v19
  s_waitcnt vmcnt(11)
  v_dot2c_f32_bf16 v10, v128, v18
  v_dot2c_f32_bf16 v11, v128, v19
  v_dot2c_f32_bf16 v12, v129, v18
  v_dot2c_f32_bf16 v13, v129, v19
  v_dot2c_f32_bf16 v14, v130, v18
  v_dot2c_f32_bf16 v15, v130, v19
  v_dot2c_f32_bf16 v16, v131, v18
  v_dot2c_f32_bf16 v17, v131, v19
  s_waitcnt vmcnt(10)
  v_dot2c_f32_bf16 v10, v136, v18
  v_dot2c_f32_bf16 v11, v136, v19
  v_dot2c_f32_bf16 v12, v137, v18
  v_dot2c_f32_bf16 v13, v137, v19
  v_dot2c_f32_bf16 v14, v138, v18
  v_dot2c_f32_bf16 v15, v138, v19
  v_dot2c_f32_bf16 v16, v139, v18
  v_dot2c_f32_bf16 v17, v139, v19
  v_exp_f32_e64 v36, -v10
  v_exp_f32_e64 v37, -v11
  v_exp_f32_e64 v38, -v12
  v_exp_f32_e64 v39, -v13
  v_exp_f32_e64 v40, -v14
  v_exp_f32_e64 v41, -v15
  v_exp_f32_e64 v42, -v16
  v_exp_f32_e64 v43, -v17
  v_add_f32 v36, 1.0, v36
  v_add_f32 v37, 1.0, v37
  v_add_f32 v38, 1.0, v38
  v_add_f32 v39, 1.0, v39
  v_add_f32 v40, 1.0, v40
  v_add_f32 v41, 1.0, v41
  v_add_f32 v42, 1.0, v42
  v_add_f32 v43, 1.0, v43
  v_rcp_f32 v36, v36
  v_rcp_f32 v37, v37
  v_rcp_f32 v38, v38
  v_rcp_f32 v39, v39
  v_rcp_f32 v40, v40
  v_rcp_f32 v41, v41
  v_rcp_f32 v42, v42
  v_rcp_f32 v43, v43
  v_mul_f32 v10, 0x3f317218, v10
  v_mul_f32 v11, 0x3f317218, v11
  v_mul_f32 v12, 0x3f317218, v12
  v_mul_f32 v13, 0x3f317218, v13
  v_mul_f32 v14, 0x3f317218, v14
  v_mul_f32 v15, 0x3f317218, v15
  v_mul_f32 v16, 0x3f317218, v16
  v_mul_f32 v17, 0x3f317218, v17
  v_mul_f32 v10, v10, v36
  v_mul_f32 v11, v11, v37
  v_mul_f32 v12, v12, v38
  v_mul_f32 v13, v13, v39
  v_mul_f32 v14, v14, v40
  v_mul_f32 v15, v15, v41
  v_mul_f32 v16, v16, v42
  v_mul_f32 v17, v17, v43
  s_waitcnt vmcnt(9)
  v_lshlrev_b32 v2, 16, v116
  v_and_b32 v3, 0xffff0000, v116
  v_lshlrev_b32 v4, 16, v117
  v_and_b32 v5, 0xffff0000, v117
  v_lshlrev_b32 v6, 16, v118
  v_and_b32 v7, 0xffff0000, v118
  v_lshlrev_b32 v8, 16, v119
  v_and_b32 v9, 0xffff0000, v119
  s_waitcnt vmcnt(8)
  v_dot2c_f32_bf16 v2, v124, v18
  v_dot2c_f32_bf16 v3, v124, v19
  v_dot2c_f32_bf16 v4, v125, v18
  v_dot2c_f32_bf16 v5, v125, v19
  v_dot2c_f32_bf16 v6, v126, v18
  v_dot2c_f32_bf16 v7, v126, v19
  v_dot2c_f32_bf16 v8, v127, v18
  v_dot2c_f32_bf16 v9, v127, v19
  s_waitcnt vmcnt(7)
  v_dot2c_f32_bf16 v2, v132, v18
  v_dot2c_f32_bf16 v3, v132, v19
  v_dot2c_f32_bf16 v4, v133, v18
  v_dot2c_f32_bf16 v5, v133, v19
  v_dot2c_f32_bf16 v6, v134, v18
  v_dot2c_f32_bf16 v7, v134, v19
  v_dot2c_f32_bf16 v8, v135, v18
  v_dot2c_f32_bf16 v9, v135, v19
  s_waitcnt vmcnt(6)
  v_dot2c_f32_bf16 v2, v140, v18
  v_dot2c_f32_bf16 v3, v140, v19
  v_dot2c_f32_bf16 v4, v141, v18
  v_dot2c_f32_bf16 v5, v141, v19
  v_dot2c_f32_bf16 v6, v142, v18
  v_dot2c_f32_bf16 v7, v142, v19
  v_dot2c_f32_bf16 v8, v143, v18
  v_dot2c_f32_bf16 v9, v143, v19
  s_waitcnt vmcnt(4)
  v_lshlrev_b32 v36, 16, v52
  v_and_b32 v37, 0xffff0000, v52
  v_lshlrev_b32 v38, 16, v53
  v_and_b32 v39, 0xffff0000, v53
  v_lshlrev_b32 v40, 16, v54
  v_and_b32 v41, 0xffff0000, v54
  v_lshlrev_b32 v42, 16, v55
  v_and_b32 v43, 0xffff0000, v55
  v_fmac_f32 v36, v2, v10
  v_fmac_f32 v37, v3, v11
  v_fmac_f32 v38, v4, v12
  v_fmac_f32 v39, v5, v13
  v_fmac_f32 v40, v6, v14
  v_fmac_f32 v41, v7, v15
  v_fmac_f32 v42, v8, v16
  v_fmac_f32 v43, v9, v17
  v_cvt_pk_bf16_f32 v52, v36, v37
  v_cvt_pk_bf16_f32 v53, v38, v39
  v_cvt_pk_bf16_f32 v54, v40, v41
  v_cvt_pk_bf16_f32 v55, v42, v43
  buffer_store_dwordx2 v[52:53], v81, s[24:27], 0 offen offset:0
  buffer_store_dwordx2 v[54:55], v81, s[24:27], s66 offen offset:0
  buffer_load_dword v74, v84, s[96:99], 0 offen offset:640 sc1
  s_waitcnt vmcnt(0)
  v_cmp_eq_u32 vcc, s100, v74
  s_cmp_eq_u64 vcc, -1
  s_cbranch_scc0 L_retry6
L_back6:
  s_mov_b32 s39, 0
  buffer_load_dwordx4 v[144:147], v82, s[32:35], s39 offen offset:0 sc1
  s_mov_b32 s39, 4718592
  buffer_load_dwordx4 v[152:155], v82, s[32:35], s39 offen offset:0 sc1
  s_mov_b32 s39, 9437184
  buffer_load_dwordx4 v[160:163], v82, s[32:35], s39 offen offset:0 sc1
  s_mov_b32 s39, 14155776
  buffer_load_dwordx4 v[168:171], v82, s[32:35], s39 offen offset:0 sc1
  s_mov_b32 s39, 2359296
  buffer_load_dwordx4 v[148:151], v82, s[32:35], s39 offen offset:0 sc1
  s_mov_b32 s39, 7077888
  buffer_load_dwordx4 v[156:159], v82, s[32:35], s39 offen offset:0 sc1
  s_mov_b32 s39, 11796480
  buffer_load_dwordx4 v[164:167], v82, s[32:35], s39 offen offset:0 sc1
  s_mov_b32 s39, 16515072
  buffer_load_dwordx4 v[172:175], v82, s[32:35], s39 offen offset:0 sc1
  s_cmp_lg_u32 s3, 0
  s_cbranch_scc1 L_one
  s_mov_b32 s39, 0
  buffer_load_dwordx4 v[176:179], v82, s[32:35], s39 offen offset:1024 sc1
  s_mov_b32 s39, 4718592
  buffer_load_dwordx4 v[184:187], v82, s[32:35], s39 offen offset:1024 sc1
  s_mov_b32 s39, 9437184
  buffer_load_dwordx4 v[192:195], v82, s[32:35], s39 offen offset:1024 sc1
  s_mov_b32 s39, 14155776
  buffer_load_dwordx4 v[200:203], v82, s[32:35], s39 offen offset:1024 sc1
  s_mov_b32 s39, 2359296
  buffer_load_dwordx4 v[180:183], v82, s[32:35], s39 offen offset:1024 sc1
  s_mov_b32 s39, 7077888
  buffer_load_dwordx4 v[188:191], v82, s[32:35], s39 offen offset:1024 sc1
  s_mov_b32 s39, 11796480
  buffer_load_dwordx4 v[196:199], v82, s[32:35], s39 offen offset:1024 sc1
  s_mov_b32 s39, 16515072
  buffer_load_dwordx4 v[204:207], v82, s[32:35], s39 offen offset:1024 sc1
  s_waitcnt vmcnt(15)
  v_lshlrev_b32 v10, 16, v144
  v_and_b32 v11, 0xffff0000, v144
  v_lshlrev_b32 v12, 16, v145
  v_and_b32 v13, 0xffff0000, v145
  v_lshlrev_b32 v14, 16, v146
  v_and_b32 v15, 0xffff0000, v146
  v_lshlrev_b32 v16, 16, v147
  v_and_b32 v17, 0xffff0000, v147
  s_waitcnt vmcnt(14)
  v_dot2c_f32_bf16 v10, v152, v18
  v_dot2c_f32_bf16 v11, v152, v19
  v_dot2c_f32_bf16 v12, v153, v18
  v_dot2c_f32_bf16 v13, v153, v19
  v_dot2c_f32_bf16 v14, v154, v18
  v_dot2c_f32_bf16 v15, v154, v19
  v_dot2c_f32_bf16 v16, v155, v18
  v_dot2c_f32_bf16 v17, v155, v19
  s_waitcnt vmcnt(13)
  v_dot2c_f32_bf16 v10, v160, v18
  v_dot2c_f32_bf16 v11, v160, v19
  v_dot2c_f32_bf16 v12, v161, v18
  v_dot2c_f32_bf16 v13, v161, v19
  v_dot2c_f32_bf16 v14, v162, v18
  v_dot2c_f32_bf16 v15, v162, v19
  v_dot2c_f32_bf16 v16, v163, v18
  v_dot2c_f32_bf16 v17, v163, v19
  s_waitcnt vmcnt(12)
  v_dot2c_f32_bf16 v10, v168, v18
  v_dot2c_f32_bf16 v11, v168, v19
  v_dot2c_f32_bf16 v12, v169, v18
  v_dot2c_f32_bf16 v13, v169, v19
  v_dot2c_f32_bf16 v14, v170, v18
  v_dot2c_f32_bf16 v15, v170, v19
  v_dot2c_f32_bf16 v16, v171, v18
  v_dot2c_f32_bf16 v17, v171, v19
  v_exp_f32_e64 v36, -v10
  v_exp_f32_e64 v37, -v11
  v_exp_f32_e64 v38, -v12
  v_exp_f32_e64 v39, -v13
  v_exp_f32_e64 v40, -v14
  v_exp_f32_e64 v41, -v15
  v_exp_f32_e64 v42, -v16
  v_exp_f32_e64 v43, -v17
  v_add_f32 v36, 1.0, v36
  v_add_f32 v37, 1.0, v37
  v_add_f32 v38, 1.0, v38
  v_add_f32 v39, 1.0, v39
  v_add_f32 v40, 1.0, v40
  v_add_f32 v41, 1.0, v41
  v_add_f32 v42, 1.0, v42
  v_add_f32 v43, 1.0, v43
  v_rcp_f32 v36, v36
  v_rcp_f32 v37, v37
  v_rcp_f32 v38, v38
  v_rcp_f32 v39, v39
  v_rcp_f32 v40, v40
  v_rcp_f32 v41, v41
  v_rcp_f32 v42, v42
  v_rcp_f32 v43, v43
  v_mul_f32 v10, 0x3f317218, v10
  v_mul_f32 v11, 0x3f317218, v11
  v_mul_f32 v12, 0x3f317218, v12
  v_mul_f32 v13, 0x3f317218, v13
  v_mul_f32 v14, 0x3f317218, v14
  v_mul_f32 v15, 0x3f317218, v15
  v_mul_f32 v16, 0x3f317218, v16
  v_mul_f32 v17, 0x3f317218, v17
  v_mul_f32 v10, v10, v36
  v_mul_f32 v11, v11, v37
  v_mul_f32 v12, v12, v38
  v_mul_f32 v13, v13, v39
  v_mul_f32 v14, v14, v40
  v_mul_f32 v15, v15, v41
  v_mul_f32 v16, v16, v42
  v_mul_f32 v17, v17, v43
  s_waitcnt vmcnt(11)
  v_lshlrev_b32 v2, 16, v148
  v_and_b32 v3, 0xffff0000, v148
  v_lshlrev_b32 v4, 16, v149
  v_and_b32 v5, 0xffff0000, v149
  v_lshlrev_b32 v6, 16, v150
  v_and_b32 v7, 0xffff0000, v150
  v_lshlrev_b32 v8, 16, v151
  v_and_b32 v9, 0xffff0000, v151
  s_waitcnt vmcnt(10)
  v_dot2c_f32_bf16 v2, v156, v18
  v_dot2c_f32_bf16 v3, v156, v19
  v_dot2c_f32_bf16 v4, v157, v18
  v_dot2c_f32_bf16 v5, v157, v19
  v_dot2c_f32_bf16 v6, v158, v18
  v_dot2c_f32_bf16 v7, v158, v19
  v_dot2c_f32_bf16 v8, v159, v18
  v_dot2c_f32_bf16 v9, v159, v19
  s_waitcnt vmcnt(9)
  v_dot2c_f32_bf16 v2, v164, v18
  v_dot2c_f32_bf16 v3, v164, v19
  v_dot2c_f32_bf16 v4, v165, v18
  v_dot2c_f32_bf16 v5, v165, v19
  v_dot2c_f32_bf16 v6, v166, v18
  v_dot2c_f32_bf16 v7, v166, v19
  v_dot2c_f32_bf16 v8, v167, v18
  v_dot2c_f32_bf16 v9, v167, v19
  s_waitcnt vmcnt(8)
  v_dot2c_f32_bf16 v2, v172, v18
  v_dot2c_f32_bf16 v3, v172, v19
  v_dot2c_f32_bf16 v4, v173, v18
  v_dot2c_f32_bf16 v5, v173, v19
  v_dot2c_f32_bf16 v6, v174, v18
  v_dot2c_f32_bf16 v7, v174, v19
  v_dot2c_f32_bf16 v8, v175, v18
  v_dot2c_f32_bf16 v9, v175, v19
  v_lshlrev_b32 v36, 16, v56
  v_and_b32 v37, 0xffff0000, v56
  v_lshlrev_b32 v38, 16, v57
  v_and_b32 v39, 0xffff0000, v57
  v_lshlrev_b32 v40, 16, v58
  v_and_b32 v41, 0xffff0000, v58
  v_lshlrev_b32 v42, 16, v59
  v_and_b32 v43, 0xffff0000, v59
  v_fmac_f32 v36, v2, v10
  v_fmac_f32 v37, v3, v11
  v_fmac_f32 v38, v4, v12
  v_fmac_f32 v39, v5, v13
  v_fmac_f32 v40, v6, v14
  v_fmac_f32 v41, v7, v15
  v_fmac_f32 v42, v8, v16
  v_fmac_f32 v43, v9, v17
  v_cvt_pk_bf16_f32 v56, v36, v37
  v_cvt_pk_bf16_f32 v57, v38, v39
  v_cvt_pk_bf16_f32 v58, v40, v41
  v_cvt_pk_bf16_f32 v59, v42, v43
  buffer_store_dwordx2 v[56:57], v83, s[24:27], 0 offen offset:0
  buffer_store_dwordx2 v[58:59], v83, s[24:27], s66 offen offset:0
  s_waitcnt vmcnt(9)
  v_lshlrev_b32 v10, 16, v176
  v_and_b32 v11, 0xffff0000, v176
  v_lshlrev_b32 v12, 16, v177
  v_and_b32 v13, 0xffff0000, v177
  v_lshlrev_b32 v14, 16, v178
  v_and_b32 v15, 0xffff0000, v178
  v_lshlrev_b32 v16, 16, v179
  v_and_b32 v17, 0xffff0000, v179
  s_waitcnt vmcnt(8)
  v_dot2c_f32_bf16 v10, v184, v18
  v_dot2c_f32_bf16 v11, v184, v19
  v_dot2c_f32_bf16 v12, v185, v18
  v_dot2c_f32_bf16 v13, v185, v19
  v_dot2c_f32_bf16 v14, v186, v18
  v_dot2c_f32_bf16 v15, v186, v19
  v_dot2c_f32_bf16 v16, v187, v18
  v_dot2c_f32_bf16 v17, v187, v19
  s_waitcnt vmcnt(7)
  v_dot2c_f32_bf16 v10, v192, v18
  v_dot2c_f32_bf16 v11, v192, v19
  v_dot2c_f32_bf16 v12, v193, v18
  v_dot2c_f32_bf16 v13, v193, v19
  v_dot2c_f32_bf16 v14, v194, v18
  v_dot2c_f32_bf16 v15, v194, v19
  v_dot2c_f32_bf16 v16, v195, v18
  v_dot2c_f32_bf16 v17, v195, v19
  s_waitcnt vmcnt(6)
  v_dot2c_f32_bf16 v10, v200, v18
  v_dot2c_f32_bf16 v11, v200, v19
  v_dot2c_f32_bf16 v12, v201, v18
  v_dot2c_f32_bf16 v13, v201, v19
  v_dot2c_f32_bf16 v14, v202, v18
  v_dot2c_f32_bf16 v15, v202, v19
  v_dot2c_f32_bf16 v16, v203, v18
  v_dot2c_f32_bf16 v17, v203, v19
  v_exp_f32_e64 v36, -v10
  v_exp_f32_e64 v37, -v11
  v_exp_f32_e64 v38, -v12
  v_exp_f32_e64 v39, -v13
  v_exp_f32_e64 v40, -v14
  v_exp_f32_e64 v41, -v15
  v_exp_f32_e64 v42, -v16
  v_exp_f32_e64 v43, -v17
  v_add_f32 v36, 1.0, v36
  v_add_f32 v37, 1.0, v37
  v_add_f32 v38, 1.0, v38
  v_add_f32 v39, 1.0, v39
  v_add_f32 v40, 1.0, v40
  v_add_f32 v41, 1.0, v41
  v_add_f32 v42, 1.0, v42
  v_add_f32 v43, 1.0, v43
  v_rcp_f32 v36, v36
  v_rcp_f32 v37, v37
  v_rcp_f32 v38, v38
  v_rcp_f32 v39, v39
  v_rcp_f32 v40, v40
  v_rcp_f32 v41, v41
  v_rcp_f32 v42, v42
  v_rcp_f32 v43, v43
  v_mul_f32 v10, 0x3f317218, v10
  v_mul_f32 v11, 0x3f317218, v11
  v_mul_f32 v12, 0x3f317218, v12
  v_mul_f32 v13, 0x3f317218, v13
  v_mul_f32 v14, 0x3f317218, v14
  v_mul_f32 v15, 0x3f317218, v15
  v_mul_f32 v16, 0x3f317218, v16
  v_mul_f32 v17, 0x3f317218, v17
  v_mul_f32 v10, v10, v36
  v_mul_f32 v11, v11, v37
  v_mul_f32 v12, v12, v38
  v_mul_f32 v13, v13, v39
  v_mul_f32 v14, v14, v40
  v_mul_f32 v15, v15, v41
  v_mul_f32 v16, v16, v42
  v_mul_f32 v17, v17, v43
  s_waitcnt vmcnt(5)
  v_lshlrev_b32 v2, 16, v180
  v_and_b32 v3, 0xffff0000, v180
  v_lshlrev_b32 v4, 16, v181
  v_and_b32 v5, 0xffff0000, v181
  v_lshlrev_b32 v6, 16, v182
  v_and_b32 v7, 0xffff0000, v182
  v_lshlrev_b32 v8, 16, v183
  v_and_b32 v9, 0xffff0000, v183
  s_waitcnt vmcnt(4)
  v_dot2c_f32_bf16 v2, v188, v18
  v_dot2c_f32_bf16 v3, v188, v19
  v_dot2c_f32_bf16 v4, v189, v18
  v_dot2c_f32_bf16 v5, v189, v19
  v_dot2c_f32_bf16 v6, v190, v18
  v_dot2c_f32_bf16 v7, v190, v19
  v_dot2c_f32_bf16 v8, v191, v18
  v_dot2c_f32_bf16 v9, v191, v19
  s_waitcnt vmcnt(3)
  v_dot2c_f32_bf16 v2, v196, v18
  v_dot2c_f32_bf16 v3, v196, v19
  v_dot2c_f32_bf16 v4, v197, v18
  v_dot2c_f32_bf16 v5, v197, v19
  v_dot2c_f32_bf16 v6, v198, v18
  v_dot2c_f32_bf16 v7, v198, v19
  v_dot2c_f32_bf16 v8, v199, v18
  v_dot2c_f32_bf16 v9, v199, v19
  s_waitcnt vmcnt(2)
  v_dot2c_f32_bf16 v2, v204, v18
  v_dot2c_f32_bf16 v3, v204, v19
  v_dot2c_f32_bf16 v4, v205, v18
  v_dot2c_f32_bf16 v5, v205, v19
  v_dot2c_f32_bf16 v6, v206, v18
  v_dot2c_f32_bf16 v7, v206, v19
  v_dot2c_f32_bf16 v8, v207, v18
  v_dot2c_f32_bf16 v9, v207, v19
  v_lshlrev_b32 v36, 16, v60
  v_and_b32 v37, 0xffff0000, v60
  v_lshlrev_b32 v38, 16, v61
  v_and_b32 v39, 0xffff0000, v61
  v_lshlrev_b32 v40, 16, v62
  v_and_b32 v41, 0xffff0000, v62
  v_lshlrev_b32 v42, 16, v63
  v_and_b32 v43, 0xffff0000, v63
  v_fmac_f32 v36, v2, v10
  v_fmac_f32 v37, v3, v11
  v_fmac_f32 v38, v4, v12
  v_fmac_f32 v39, v5, v13
  v_fmac_f32 v40, v6, v14
  v_fmac_f32 v41, v7, v15
  v_fmac_f32 v42, v8, v16
  v_fmac_f32 v43, v9, v17
  v_cvt_pk_bf16_f32 v60, v36, v37
  v_cvt_pk_bf16_f32 v61, v38, v39
  v_cvt_pk_bf16_f32 v62, v40, v41
  v_cvt_pk_bf16_f32 v63, v42, v43
  buffer_store_dwordx2 v[60:61], v83, s[24:27], 0 offen offset:32
  buffer_store_dwordx2 v[62:63], v83, s[24:27], s66 offen offset:32
  s_branch L_fin
L_one:
  s_waitcnt vmcnt(7)
  v_lshlrev_b32 v10, 16, v144
  v_and_b32 v11, 0xffff0000, v144
  v_lshlrev_b32 v12, 16, v145
  v_and_b32 v13, 0xffff0000, v145
  v_lshlrev_b32 v14, 16, v146
  v_and_b32 v15, 0xffff0000, v146
  v_lshlrev_b32 v16, 16, v147
  v_and_b32 v17, 0xffff0000, v147
  s_waitcnt vmcnt(6)
  v_dot2c_f32_bf16 v10, v152, v18
  v_dot2c_f32_bf16 v11, v152, v19
  v_dot2c_f32_bf16 v12, v153, v18
  v_dot2c_f32_bf16 v13, v153, v19
  v_dot2c_f32_bf16 v14, v154, v18
  v_dot2c_f32_bf16 v15, v154, v19
  v_dot2c_f32_bf16 v16, v155, v18
  v_dot2c_f32_bf16 v17, v155, v19
  s_waitcnt vmcnt(5)
  v_dot2c_f32_bf16 v10, v160, v18
  v_dot2c_f32_bf16 v11, v160, v19
  v_dot2c_f32_bf16 v12, v161, v18
  v_dot2c_f32_bf16 v13, v161, v19
  v_dot2c_f32_bf16 v14, v162, v18
  v_dot2c_f32_bf16 v15, v162, v19
  v_dot2c_f32_bf16 v16, v163, v18
  v_dot2c_f32_bf16 v17, v163, v19
  s_waitcnt vmcnt(4)
  v_dot2c_f32_bf16 v10, v168, v18
  v_dot2c_f32_bf16 v11, v168, v19
  v_dot2c_f32_bf16 v12, v169, v18
  v_dot2c_f32_bf16 v13, v169, v19
  v_dot2c_f32_bf16 v14, v170, v18
  v_dot2c_f32_bf16 v15, v170, v19
  v_dot2c_f32_bf16 v16, v171, v18
  v_dot2c_f32_bf16 v17, v171, v19
  v_exp_f32_e64 v36, -v10
  v_exp_f32_e64 v37, -v11
  v_exp_f32_e64 v38, -v12
  v_exp_f32_e64 v39, -v13
  v_exp_f32_e64 v40, -v14
  v_exp_f32_e64 v41, -v15
  v_exp_f32_e64 v42, -v16
  v_exp_f32_e64 v43, -v17
  v_add_f32 v36, 1.0, v36
  v_add_f32 v37, 1.0, v37
  v_add_f32 v38, 1.0, v38
  v_add_f32 v39, 1.0, v39
  v_add_f32 v40, 1.0, v40
  v_add_f32 v41, 1.0, v41
  v_add_f32 v42, 1.0, v42
  v_add_f32 v43, 1.0, v43
  v_rcp_f32 v36, v36
  v_rcp_f32 v37, v37
  v_rcp_f32 v38, v38
  v_rcp_f32 v39, v39
  v_rcp_f32 v40, v40
  v_rcp_f32 v41, v41
  v_rcp_f32 v42, v42
  v_rcp_f32 v43, v43
  v_mul_f32 v10, 0x3f317218, v10
  v_mul_f32 v11, 0x3f317218, v11
  v_mul_f32 v12, 0x3f317218, v12
  v_mul_f32 v13, 0x3f317218, v13
  v_mul_f32 v14, 0x3f317218, v14
  v_mul_f32 v15, 0x3f317218, v15
  v_mul_f32 v16, 0x3f317218, v16
  v_mul_f32 v17, 0x3f317218, v17
  v_mul_f32 v10, v10, v36
  v_mul_f32 v11, v11, v37
  v_mul_f32 v12, v12, v38
  v_mul_f32 v13, v13, v39
  v_mul_f32 v14, v14, v40
  v_mul_f32 v15, v15, v41
  v_mul_f32 v16, v16, v42
  v_mul_f32 v17, v17, v43
  s_waitcnt vmcnt(3)
  v_lshlrev_b32 v2, 16, v148
  v_and_b32 v3, 0xffff0000, v148
  v_lshlrev_b32 v4, 16, v149
  v_and_b32 v5, 0xffff0000, v149
  v_lshlrev_b32 v6, 16, v150
  v_and_b32 v7, 0xffff0000, v150
  v_lshlrev_b32 v8, 16, v151
  v_and_b32 v9, 0xffff0000, v151
  s_waitcnt vmcnt(2)
  v_dot2c_f32_bf16 v2, v156, v18
  v_dot2c_f32_bf16 v3, v156, v19
  v_dot2c_f32_bf16 v4, v157, v18
  v_dot2c_f32_bf16 v5, v157, v19
  v_dot2c_f32_bf16 v6, v158, v18
  v_dot2c_f32_bf16 v7, v158, v19
  v_dot2c_f32_bf16 v8, v159, v18
  v_dot2c_f32_bf16 v9, v159, v19
  s_waitcnt vmcnt(1)
  v_dot2c_f32_bf16 v2, v164, v18
  v_dot2c_f32_bf16 v3, v164, v19
  v_dot2c_f32_bf16 v4, v165, v18
  v_dot2c_f32_bf16 v5, v165, v19
  v_dot2c_f32_bf16 v6, v166, v18
  v_dot2c_f32_bf16 v7, v166, v19
  v_dot2c_f32_bf16 v8, v167, v18
  v_dot2c_f32_bf16 v9, v167, v19
  s_waitcnt vmcnt(0)
  v_dot2c_f32_bf16 v2, v172, v18
  v_dot2c_f32_bf16 v3, v172, v19
  v_dot2c_f32_bf16 v4, v173, v18
  v_dot2c_f32_bf16 v5, v173, v19
  v_dot2c_f32_bf16 v6, v174, v18
  v_dot2c_f32_bf16 v7, v174, v19
  v_dot2c_f32_bf16 v8, v175, v18
  v_dot2c_f32_bf16 v9, v175, v19
  v_lshlrev_b32 v36, 16, v56
  v_and_b32 v37, 0xffff0000, v56
  v_lshlrev_b32 v38, 16, v57
  v_and_b32 v39, 0xffff0000, v57
  v_lshlrev_b32 v40, 16, v58
  v_and_b32 v41, 0xffff0000, v58
  v_lshlrev_b32 v42, 16, v59
  v_and_b32 v43, 0xffff0000, v59
  v_fmac_f32 v36, v2, v10
  v_fmac_f32 v37, v3, v11
  v_fmac_f32 v38, v4, v12
  v_fmac_f32 v39, v5, v13
  v_fmac_f32 v40, v6, v14
  v_fmac_f32 v41, v7, v15
  v_fmac_f32 v42, v8, v16
  v_fmac_f32 v43, v9, v17
  v_cvt_pk_bf16_f32 v56, v36, v37
  v_cvt_pk_bf16_f32 v57, v38, v39
  v_cvt_pk_bf16_f32 v58, v40, v41
  v_cvt_pk_bf16_f32 v59, v42, v43
  buffer_store_dwordx2 v[56:57], v83, s[24:27], 0 offen offset:0
  buffer_store_dwordx2 v[58:59], v83, s[24:27], s66 offen offset:0
L_fin:
L_end:
  s_endpgm
L_code_end:
L_warm:
  v_mul_u32_u24 v44, 7282, v39
  v_lshrrev_b32 v44, 16, v44
  v_mul_u32_u24 v47, 9, v44
  v_sub_u32 v43, v39, v47
  v_mul_u32_u24 v44, 9216, v44
  v_lshlrev_b32 v43, 7, v43
  v_add_u32 v93, v43, v44
  v_lshrrev_b32 v44, 3, v39
  v_lshlrev_b32 v44, 13, v44
  v_and_b32 v43, 7, v39
  v_lshlrev_b32 v43, 7, v43
  v_add_u32 v94, v43, v44
  s_mul_i32 s70, s6, 4
  s_add_u32 s70, s70, 0
  s_mul_i32 s71, s70, 9216
  s_mul_i32 s74, s7, 1152
  s_add_u32 s71, s71, s74
  s_add_u32 s72, s56, s71
  s_addc_u32 s73, s57, 0
  s_mov_b32 s74, 28800
  s_mov_b32 s75, 0x20000
  buffer_load_dword v73, v93, s[72:75], 0 offen
  s_lshl_b32 s71, s70, 13
  s_lshl_b32 s74, s7, 10
  s_add_u32 s71, s71, s74
  s_add_u32 s72, s50, s71
  s_addc_u32 s73, s51, 0
  s_mov_b32 s74, 25600
  buffer_load_dword v73, v94, s[72:75], 0 offen
  s_barrier
  s_mul_i32 s70, s6, 6
  s_add_u32 s70, s70, 128
  s_mul_i32 s71, s70, 9216
  s_mul_i32 s74, s7, 1152
  s_add_u32 s71, s71, s74
  s_add_u32 s72, s56, s71
  s_addc_u32 s73, s57, 0
  s_mov_b32 s74, 47232
  s_mov_b32 s75, 0x20000
  buffer_load_dword v73, v93, s[72:75], 0 offen
  s_lshl_b32 s71, s70, 13
  s_lshl_b32 s74, s7, 10
  s_add_u32 s71, s71, s74
  s_add_u32 s72, s50, s71
  s_addc_u32 s73, s51, 0
  s_mov_b32 s74, 41984
  buffer_load_dword v73, v94, s[72:75], 0 offen
  s_branch L_ln_done
L_nonce_retry:
  s_sleep 1
  v_mov_b32 v45, 0
  buffer_load_dword v74, v45, s[96:99], 0 offen sc1
  s_waitcnt vmcnt(0)
  v_readfirstlane_b32 s100, v74
  s_cmp_eq_u32 s54, 0
  s_cbranch_scc1 L_nonce_ok
  s_sub_u32 s54, s54, 1
  s_cmp_eq_u32 s100, 0
  s_cbranch_scc1 L_nonce_retry
  s_branch L_nonce_ok
L_retry0:
  s_sleep 1
  buffer_load_dword v74, v76, s[96:99], 0 offen offset:128 sc1
  s_waitcnt vmcnt(0)
  s_cmp_eq_u32 s54, 0
  s_cbranch_scc1 L_back0
  s_sub_u32 s54, s54, 1
  v_cmp_eq_u32 vcc, s100, v74
  s_cmp_eq_u64 vcc, -1
  s_cbranch_scc0 L_retry0
  s_branch L_back0
L_retry1:
  s_sleep 1
  buffer_load_dword v74, v78, s[96:99], 0 offen offset:256 sc1
  s_waitcnt vmcnt(0)
  s_cmp_eq_u32 s54, 0
  s_cbranch_scc1 L_back1
  s_sub_u32 s54, s54, 1
  v_cmp_eq_u32 vcc, s100, v74
  s_cmp_eq_u64 vcc, -1
  s_cbranch_scc0 L_retry1
  s_branch L_back1
L_retry2:
  s_sleep 1
  buffer_load_dword v74, v15, s[96:99], 0 offen offset:384 sc1
  s_waitcnt vmcnt(0)
  s_cmp_eq_u32 s54, 0
  s_cbranch_scc1 L_back2
  s_sub_u32 s54, s54, 1
  v_cmp_eq_u32 vcc, s100, v74
  s_cmp_eq_u64 vcc, -1
  s_cbranch_scc0 L_retry2
  s_branch L_back2
L_retry3:
  s_sleep 1
  buffer_load_dword v74, v78, s[96:99], 0 offen offset:384 sc1
  s_waitcnt vmcnt(0)
  s_cmp_eq_u32 s54, 0
  s_cbranch_scc1 L_back3
  s_sub_u32 s54, s54, 1
  v_cmp_eq_u32 vcc, s100, v74
  s_cmp_eq_u64 vcc, -1
  s_cbranch_scc0 L_retry3
  s_branch L_back3
L_retry4:
  s_sleep 1
  buffer_load_dword v74, v78, s[96:99], 0 offen offset:896 sc1
  s_waitcnt vmcnt(0)
  s_cmp_eq_u32 s54, 0
  s_cbranch_scc1 L_back4
  s_sub_u32 s54, s54, 1
  v_cmp_eq_u32 vcc, s100, v74
  s_cmp_eq_u64 vcc, -1
  s_cbranch_scc0 L_retry4
  s_branch L_back4
L_retry5:
  s_sleep 1
  buffer_load_dword v74, v79, s[96:99], 0 offen offset:512 sc1
  s_waitcnt vmcnt(0)
  s_cmp_eq_u32 s54, 0
  s_cbranch_scc1 L_back5
  s_sub_u32 s54, s54, 1
  v_cmp_eq_u32 vcc, s100, v74
  s_cmp_eq_u64 vcc, -1
  s_cbranch_scc0 L_retry5
  s_branch L_back5
L_retry6:
  s_sleep 1
  buffer_load_dword v74, v84, s[96:99], 0 offen offset:640 sc1
  s_waitcnt vmcnt(0)
  s_cmp_eq_u32 s54, 0
  s_cbranch_scc1 L_back6
  s_sub_u32 s54, s54, 1
  v_cmp_eq_u32 vcc, s100, v74
  s_cmp_eq_u64 vcc, -1
  s_cbranch_scc0 L_retry6
  s_branch L_back6
L_fallback:
  s_waitcnt vmcnt(0) lgkmcnt(0)
  s_mov_b32 s55, 1
  v_mov_b32 v38, 0xff800000
  v_mov_b32 v39, 0xff800000
  v_mov_b32 v40, 0xff800000
  v_mov_b32 v41, 0xff800000
  s_mov_b32 s39, 0
L_maxloop:
  s_barrier
  s_mov_b32 m0, s42
  s_nop 0
  buffer_load_dwordx4 v17, s[20:23], s39 offen lds
  buffer_load_dwordx4 v18, s[20:23], s39 offen offset:1024 lds
  s_waitcnt vmcnt(0)
  s_barrier
  ds_read_b128 v[48:51], v21 offset:0
  s_waitcnt lgkmcnt(0)
  v_mfma_f32_16x16x32_bf16 v[192:195], v[48:51], v[80:83], 0
  v_mfma_f32_16x16x32_bf16 v[196:199], v[48:51], v[84:87], 0
  v_mfma_f32_16x16x32_bf16 v[200:203], v[48:51], v[88:91], 0
  v_mfma_f32_16x16x32_bf16 v[204:207], v[48:51], v[92:95], 0
  ds_read_b128 v[52:55], v22 offset:0
  s_waitcnt lgkmcnt(0)
  v_mfma_f32_16x16x32_bf16 v[192:195], v[52:55], v[96:99], v[192:195]
  v_mfma_f32_16x16x32_bf16 v[196:199], v[52:55], v[100:103], v[196:199]
  v_mfma_f32_16x16x32_bf16 v[200:203], v[52:55], v[104:107], v[200:203]
  v_mfma_f32_16x16x32_bf16 v[204:207], v[52:55], v[108:111], v[204:207]
  ds_read_b128 v[56:59], v23 offset:0
  s_waitcnt lgkmcnt(0)
  v_mfma_f32_16x16x32_bf16 v[192:195], v[56:59], v[112:115], v[192:195]
  v_mfma_f32_16x16x32_bf16 v[196:199], v[56:59], v[116:119], v[196:199]
  v_mfma_f32_16x16x32_bf16 v[200:203], v[56:59], v[120:123], v[200:203]
  v_mfma_f32_16x16x32_bf16 v[204:207], v[56:59], v[124:127], v[204:207]
  ds_read_b128 v[60:63], v24 offset:0
  s_waitcnt lgkmcnt(0)
  v_mfma_f32_16x16x32_bf16 v[192:195], v[60:63], v[128:131], v[192:195]
  v_mfma_f32_16x16x32_bf16 v[196:199], v[60:63], v[132:135], v[196:199]
  v_mfma_f32_16x16x32_bf16 v[200:203], v[60:63], v[136:139], v[200:203]
  v_mfma_f32_16x16x32_bf16 v[204:207], v[60:63], v[140:143], v[204:207]
  ds_read_b128 v[64:67], v21 offset:4096
  s_waitcnt lgkmcnt(0)
  v_mfma_f32_16x16x32_bf16 v[208:211], v[64:67], v[80:83], 0
  v_mfma_f32_16x16x32_bf16 v[212:215], v[64:67], v[84:87], 0
  v_mfma_f32_16x16x32_bf16 v[216:219], v[64:67], v[88:91], 0
  v_mfma_f32_16x16x32_bf16 v[220:223], v[64:67], v[92:95], 0
  ds_read_b128 v[68:71], v22 offset:4096
  s_waitcnt lgkmcnt(0)
  v_mfma_f32_16x16x32_bf16 v[208:211], v[68:71], v[96:99], v[208:211]
  v_mfma_f32_16x16x32_bf16 v[212:215], v[68:71], v[100:103], v[212:215]
  v_mfma_f32_16x16x32_bf16 v[216:219], v[68:71], v[104:107], v[216:219]
  v_mfma_f32_16x16x32_bf16 v[220:223], v[68:71], v[108:111], v[220:223]
  ds_read_b128 v[48:51], v23 offset:4096
  s_waitcnt lgkmcnt(0)
  v_mfma_f32_16x16x32_bf16 v[208:211], v[48:51], v[112:115], v[208:211]
  v_mfma_f32_16x16x32_bf16 v[212:215], v[48:51], v[116:119], v[212:215]
  v_mfma_f32_16x16x32_bf16 v[216:219], v[48:51], v[120:123], v[216:219]
  v_mfma_f32_16x16x32_bf16 v[220:223], v[48:51], v[124:127], v[220:223]
  ds_read_b128 v[52:55], v24 offset:4096
  s_waitcnt lgkmcnt(0)
  v_mfma_f32_16x16x32_bf16 v[208:211], v[52:55], v[128:131], v[208:211]
  v_mfma_f32_16x16x32_bf16 v[212:215], v[52:55], v[132:135], v[212:215]
  v_mfma_f32_16x16x32_bf16 v[216:219], v[52:55], v[136:139], v[216:219]
  v_mfma_f32_16x16x32_bf16 v[220:223], v[52:55], v[140:143], v[220:223]
  s_nop 7
  v_max3_f32 v42, v192, v193, v194
  v_max3_f32 v42, v42, v195, v208
  v_max3_f32 v42, v42, v209, v210
  v_max_f32 v42, v42, v211
  v_max_f32 v38, v38, v42
  v_max3_f32 v42, v196, v197, v198
  v_max3_f32 v42, v42, v199, v212
  v_max3_f32 v42, v42, v213, v214
  v_max_f32 v42, v42, v215
  v_max_f32 v39, v39, v42
  v_max3_f32 v42, v200, v201, v202
  v_max3_f32 v42, v42, v203, v216
  v_max3_f32 v42, v42, v217, v218
  v_max_f32 v42, v42, v219
  v_max_f32 v40, v40, v42
  v_max3_f32 v42, v204, v205, v206
  v_max3_f32 v42, v42, v207, v220
  v_max3_f32 v42, v42, v221, v222
  v_max_f32 v42, v42, v223
  v_max_f32 v41, v41, v42
  s_add_u32 s39, s39, 8192
  s_cmp_lt_u32 s39, 131072
  s_cbranch_scc1 L_maxloop
  v_mov_b32 v42, v38
  v_mov_b32 v43, v39
  v_mov_b32 v44, v40
  v_mov_b32 v45, v41
  v_permlane32_swap_b32 v38, v42
  v_permlane32_swap_b32 v39, v43
  v_permlane32_swap_b32 v40, v44
  v_permlane32_swap_b32 v41, v45
  v_max_f32 v38, v38, v42
  v_max_f32 v39, v39, v43
  v_max_f32 v40, v40, v44
  v_max_f32 v41, v41, v45
  v_mov_b32 v42, v38
  v_mov_b32 v43, v39
  v_mov_b32 v44, v40
  v_mov_b32 v45, v41
  v_permlane16_swap_b32 v38, v42
  v_permlane16_swap_b32 v39, v43
  v_permlane16_swap_b32 v40, v44
  v_permlane16_swap_b32 v41, v45
  v_max_f32 v38, v38, v42
  v_max_f32 v39, v39, v43
  v_max_f32 v40, v40, v44
  v_max_f32 v41, v41, v45
  v_sub_f32 v144, 0, v38
  v_sub_f32 v145, 0, v38
  v_sub_f32 v146, 0, v38
  v_sub_f32 v147, 0, v38
  v_sub_f32 v148, 0, v39
  v_sub_f32 v149, 0, v39
  v_sub_f32 v150, 0, v39
  v_sub_f32 v151, 0, v39
  v_sub_f32 v152, 0, v40
  v_sub_f32 v153, 0, v40
  v_sub_f32 v154, 0, v40
  v_sub_f32 v155, 0, v40
  v_sub_f32 v156, 0, v41
  v_sub_f32 v157, 0, v41
  v_sub_f32 v158, 0, v41
  v_sub_f32 v159, 0, v41
  s_barrier
  s_add_u32 m0, s42, 0
  s_mov_b32 s39, 0
  buffer_load_dwordx4 v17, s[20:23], s39 offen lds
  buffer_load_dwordx4 v18, s[20:23], s39 offen offset:1024 lds
  s_add_u32 m0, s42, 8192
  s_mov_b32 s39, 8192
  buffer_load_dwordx4 v17, s[20:23], s39 offen lds
  buffer_load_dwordx4 v18, s[20:23], s39 offen offset:1024 lds
  s_add_u32 m0, s42, 32768
  s_mov_b32 s39, 0
  buffer_load_dwordx4 v19, s[24:27], s39 offen lds
  buffer_load_dwordx4 v20, s[24:27], s39 offen offset:1024 lds
  s_add_u32 m0, s42, 16384
  s_mov_b32 s39, 16384
  buffer_load_dwordx4 v17, s[20:23], s39 offen lds
  buffer_load_dwordx4 v18, s[20:23], s39 offen offset:1024 lds
  s_add_u32 m0, s42, 40960
  s_mov_b32 s39, 8192
  buffer_load_dwordx4 v19, s[24:27], s39 offen lds
  buffer_load_dwordx4 v20, s[24:27], s39 offen offset:1024 lds
  s_add_u32 m0, s42, 24576
  s_mov_b32 s39, 24576
  buffer_load_dwordx4 v17, s[20:23], s39 offen lds
  buffer_load_dwordx4 v18, s[20:23], s39 offen offset:1024 lds
  s_waitcnt vmcnt(6)
  s_barrier
  ds_read_b128 v[48:51], v21 offset:0
  ds_read_b128 v[52:55], v22 offset:0
  ds_read_b128 v[56:59], v23 offset:0
  ds_read_b128 v[60:63], v24 offset:0
  ds_read_b128 v[64:67], v21 offset:4096
  ds_read_b128 v[68:71], v22 offset:4096
  s_waitcnt lgkmcnt(5)
  v_mfma_f32_16x16x32_bf16 v[192:195], v[48:51], v[80:83], 0
  v_mfma_f32_16x16x32_bf16 v[196:199], v[48:51], v[84:87], 0
  v_mfma_f32_16x16x32_bf16 v[200:203], v[48:51], v[88:91], 0
  v_mfma_f32_16x16x32_bf16 v[204:207], v[48:51], v[92:95], 0
  ds_read_b128 v[48:51], v23 offset:4096
  s_waitcnt lgkmcnt(5)
  v_mfma_f32_16x16x32_bf16 v[192:195], v[52:55], v[96:99], v[192:195]
  v_mfma_f32_16x16x32_bf16 v[196:199], v[52:55], v[100:103], v[196:199]
  v_mfma_f32_16x16x32_bf16 v[200:203], v[52:55], v[104:107], v[200:203]
  v_mfma_f32_16x16x32_bf16 v[204:207], v[52:55], v[108:111], v[204:207]
  ds_read_b128 v[52:55], v24 offset:4096
  s_waitcnt lgkmcnt(5)
  v_mfma_f32_16x16x32_bf16 v[192:195], v[56:59], v[112:115], v[192:195]
  v_mfma_f32_16x16x32_bf16 v[196:199], v[56:59], v[116:119], v[196:199]
  v_mfma_f32_16x16x32_bf16 v[200:203], v[56:59], v[120:123], v[200:203]
  v_mfma_f32_16x16x32_bf16 v[204:207], v[56:59], v[124:127], v[204:207]
  s_waitcnt lgkmcnt(4)
  v_mfma_f32_16x16x32_bf16 v[192:195], v[60:63], v[128:131], v[192:195]
  v_mfma_f32_16x16x32_bf16 v[196:199], v[60:63], v[132:135], v[196:199]
  v_mfma_f32_16x16x32_bf16 v[200:203], v[60:63], v[136:139], v[200:203]
  v_mfma_f32_16x16x32_bf16 v[204:207], v[60:63], v[140:143], v[204:207]
  s_waitcnt lgkmcnt(3)
  v_mfma_f32_16x16x32_bf16 v[208:211], v[64:67], v[80:83], 0
  v_mfma_f32_16x16x32_bf16 v[212:215], v[64:67], v[84:87], 0
  v_mfma_f32_16x16x32_bf16 v[216:219], v[64:67], v[88:91], 0
  v_mfma_f32_16x16x32_bf16 v[220:223], v[64:67], v[92:95], 0
  s_waitcnt lgkmcnt(2)
  v_mfma_f32_16x16x32_bf16 v[208:211], v[68:71], v[96:99], v[208:211]
  v_mfma_f32_16x16x32_bf16 v[212:215], v[68:71], v[100:103], v[212:215]
  v_mfma_f32_16x16x32_bf16 v[216:219], v[68:71], v[104:107], v[216:219]
  v_mfma_f32_16x16x32_bf16 v[220:223], v[68:71], v[108:111], v[220:223]
  s_waitcnt lgkmcnt(1)
  v_mfma_f32_16x16x32_bf16 v[208:211], v[48:51], v[112:115], v[208:211]
  v_mfma_f32_16x16x32_bf16 v[212:215], v[48:51], v[116:119], v[212:215]
  v_mfma_f32_16x16x32_bf16 v[216:219], v[48:51], v[120:123], v[216:219]
  v_mfma_f32_16x16x32_bf16 v[220:223], v[48:51], v[124:127], v[220:223]
  s_waitcnt lgkmcnt(0)
  v_mfma_f32_16x16x32_bf16 v[208:211], v[52:55], v[128:131], v[208:211]
  v_mfma_f32_16x16x32_bf16 v[212:215], v[52:55], v[132:135], v[212:215]
  v_mfma_f32_16x16x32_bf16 v[216:219], v[52:55], v[136:139], v[216:219]
  v_mfma_f32_16x16x32_bf16 v[220:223], v[52:55], v[140:143], v[220:223]
  ds_read_b128 v[56:59], v21 offset:8192
  ds_read_b128 v[60:63], v22 offset:8192
  ds_read_b128 v[64:67], v23 offset:8192
  ds_read_b128 v[68:71], v24 offset:8192
  s_nop 7
  s_barrier
  s_waitcnt lgkmcnt(2)
  v_mfma_f32_16x16x32_bf16 v[224:227], v[56:59], v[80:83], v[144:147]
  ds_read_b128 v[48:51], v21 offset:12288
  v_add_f32 v192, v192, v144
  v_mfma_f32_16x16x32_bf16 v[228:231], v[56:59], v[84:87], v[148:151]
  ds_read_b128 v[52:55], v22 offset:12288
  s_add_u32 m0, s42, 49152
  v_mfma_f32_16x16x32_bf16 v[232:235], v[56:59], v[88:91], v[152:155]
  s_mov_b32 s39, 16384
  v_add_f32 v193, v193, v144
  v_mfma_f32_16x16x32_bf16 v[236:239], v[56:59], v[92:95], v[156:159]
  buffer_load_dwordx4 v19, s[24:27], s39 offen lds
  v_mfma_f32_16x16x32_bf16 v[224:227], v[60:63], v[96:99], v[224:227]
  buffer_load_dwordx4 v20, s[24:27], s39 offen offset:1024 lds
  v_mfma_f32_16x16x32_bf16 v[228:231], v[60:63], v[100:103], v[228:231]
  ds_read_b128 v[56:59], v23 offset:12288
  s_add_u32 m0, s42, 0
  v_mfma_f32_16x16x32_bf16 v[232:235], v[60:63], v[104:107], v[232:235]
  s_mov_b32 s39, 32768
  v_add_f32 v194, v194, v144
  v_mfma_f32_16x16x32_bf16 v[236:239], v[60:63], v[108:111], v[236:239]
  v_add_f32 v195, v195, v144
  s_waitcnt lgkmcnt(3)
  v_mfma_f32_16x16x32_bf16 v[224:227], v[64:67], v[112:115], v[224:227]
  buffer_load_dwordx4 v17, s[20:23], s39 offen lds
  v_mfma_f32_16x16x32_bf16 v[228:231], v[64:67], v[116:119], v[228:231]
  ds_read_b128 v[60:63], v24 offset:12288
  v_mfma_f32_16x16x32_bf16 v[232:235], v[64:67], v[120:123], v[232:235]
  buffer_load_dwordx4 v18, s[20:23], s39 offen offset:1024 lds
  v_mfma_f32_16x16x32_bf16 v[236:239], v[64:67], v[124:127], v[236:239]
  v_exp_f32 v192, v192
  v_mfma_f32_16x16x32_bf16 v[224:227], v[68:71], v[128:131], v[224:227]
  v_exp_f32 v193, v193
  v_mfma_f32_16x16x32_bf16 v[228:231], v[68:71], v[132:135], v[228:231]
  ds_read_b64_tr_b16 v[64:65], v25 offset:0
  ds_read_b64_tr_b16 v[66:67], v25 offset:4096
  v_mfma_f32_16x16x32_bf16 v[232:235], v[68:71], v[136:139], v[232:235]
  v_exp_f32 v194, v194
  v_mfma_f32_16x16x32_bf16 v[236:239], v[68:71], v[140:143], v[236:239]
  s_waitcnt lgkmcnt(4)
  v_mfma_f32_16x16x32_bf16 v[240:243], v[48:51], v[80:83], v[144:147]
  v_exp_f32 v195, v195
  v_mfma_f32_16x16x32_bf16 v[244:247], v[48:51], v[84:87], v[148:151]
  ds_read_b64_tr_b16 v[68:69], v26 offset:0
  ds_read_b64_tr_b16 v[70:71], v26 offset:4096
  v_mfma_f32_16x16x32_bf16 v[248:251], v[48:51], v[88:91], v[152:155]
  v_add_f32 v196, v196, v148
  v_add_f32 v197, v197, v148
  v_mfma_f32_16x16x32_bf16 v[252:255], v[48:51], v[92:95], v[156:159]
  v_add_f32 v198, v198, v148
  v_add_f32 v199, v199, v148
  v_mfma_f32_16x16x32_bf16 v[240:243], v[52:55], v[96:99], v[240:243]
  v_exp_f32 v196, v196
  v_mfma_f32_16x16x32_bf16 v[244:247], v[52:55], v[100:103], v[244:247]
  ds_read_b64_tr_b16 v[48:49], v27 offset:0
  ds_read_b64_tr_b16 v[50:51], v27 offset:4096
  v_mfma_f32_16x16x32_bf16 v[248:251], v[52:55], v[104:107], v[248:251]
  v_exp_f32 v197, v197
  v_mfma_f32_16x16x32_bf16 v[252:255], v[52:55], v[108:111], v[252:255]
  s_waitcnt lgkmcnt(6)
  v_mfma_f32_16x16x32_bf16 v[240:243], v[56:59], v[112:115], v[240:243]
  v_exp_f32 v198, v198
  v_mfma_f32_16x16x32_bf16 v[244:247], v[56:59], v[116:119], v[244:247]
  ds_read_b64_tr_b16 v[52:53], v28 offset:0
  ds_read_b64_tr_b16 v[54:55], v28 offset:4096
  v_mfma_f32_16x16x32_bf16 v[248:251], v[56:59], v[120:123], v[248:251]
  v_exp_f32 v199, v199
  v_mfma_f32_16x16x32_bf16 v[252:255], v[56:59], v[124:127], v[252:255]
  v_cvt_pk_bf16_f32 v160, v192, v193
  v_cvt_pk_bf16_f32 v161, v194, v195
  v_mfma_f32_16x16x32_bf16 v[240:243], v[60:63], v[128:131], v[240:243]
  v_add_f32 v200, v200, v152
  v_add_f32 v201, v201, v152
  v_mfma_f32_16x16x32_bf16 v[244:247], v[60:63], v[132:135], v[244:247]
  v_add_f32 v202, v202, v152
  v_add_f32 v203, v203, v152
  v_mfma_f32_16x16x32_bf16 v[248:251], v[60:63], v[136:139], v[248:251]
  v_exp_f32 v200, v200
  v_exp_f32 v201, v201
  v_exp_f32 v202, v202
  v_exp_f32 v203, v203
  v_cvt_pk_bf16_f32 v164, v196, v197
  v_cvt_pk_bf16_f32 v165, v198, v199
  v_add_f32 v204, v204, v156
  v_add_f32 v205, v205, v156
  v_add_f32 v206, v206, v156
  v_add_f32 v207, v207, v156
  v_exp_f32 v204, v204
  v_exp_f32 v205, v205
  v_exp_f32 v206, v206
  v_exp_f32 v207, v207
  v_cvt_pk_bf16_f32 v168, v200, v201
  v_cvt_pk_bf16_f32 v169, v202, v203
  v_add_f32 v208, v208, v144
  v_add_f32 v209, v209, v144
  v_add_f32 v210, v210, v144
  v_add_f32 v211, v211, v144
  v_exp_f32 v208, v208
  v_exp_f32 v209, v209
  v_exp_f32 v210, v210
  v_exp_f32 v211, v211
  v_cvt_pk_bf16_f32 v172, v204, v205
  v_cvt_pk_bf16_f32 v173, v206, v207
  v_add_f32 v212, v212, v148
  v_add_f32 v213, v213, v148
  v_add_f32 v214, v214, v148
  v_add_f32 v215, v215, v148
  v_exp_f32 v212, v212
  v_exp_f32 v213, v213
  v_exp_f32 v214, v214
  v_exp_f32 v215, v215
  v_cvt_pk_bf16_f32 v162, v208, v209
  v_cvt_pk_bf16_f32 v163, v210, v211
  v_add_f32 v216, v216, v152
  v_add_f32 v217, v217, v152
  v_add_f32 v218, v218, v152
  v_add_f32 v219, v219, v152
  v_exp_f32 v216, v216
  v_exp_f32 v217, v217
  v_exp_f32 v218, v218
  v_exp_f32 v219, v219
  v_cvt_pk_bf16_f32 v166, v212, v213
  v_cvt_pk_bf16_f32 v167, v214, v215
  v_add_f32 v220, v220, v156
  v_add_f32 v221, v221, v156
  v_add_f32 v222, v222, v156
  v_add_f32 v223, v223, v156
  v_exp_f32 v220, v220
  v_exp_f32 v221, v221
  v_exp_f32 v222, v222
  v_exp_f32 v223, v223
  v_cvt_pk_bf16_f32 v170, v216, v217
  v_cvt_pk_bf16_f32 v171, v218, v219
  v_cvt_pk_bf16_f32 v174, v220, v221
  v_cvt_pk_bf16_f32 v175, v222, v223
  v_mfma_f32_16x16x32_bf16 v[252:255], v[60:63], v[140:143], v[252:255]
  s_waitcnt vmcnt(6)
  s_barrier
  s_waitcnt lgkmcnt(4)
  v_mfma_f32_16x16x32_bf16 a[0:3], v[64:67], v[160:163], 0
  ds_read_b64_tr_b16 v[56:57], v29 offset:0
  ds_read_b64_tr_b16 v[58:59], v29 offset:4096
  v_mfma_f32_16x16x32_bf16 a[4:7], v[64:67], v[164:167], 0
  ds_read_b64_tr_b16 v[60:61], v30 offset:0
  ds_read_b64_tr_b16 v[62:63], v30 offset:4096
  v_mfma_f32_16x16x32_bf16 a[8:11], v[64:67], v[168:171], 0
  s_add_u32 m0, s42, 57344
  v_mfma_f32_16x16x32_bf16 a[12:15], v[64:67], v[172:175], 0
  v_exp_f32 v224, v224
  v_mfma_f32_16x16x32_bf16 a[16:19], v[68:71], v[160:163], 0
  v_exp_f32 v225, v225
  v_mfma_f32_16x16x32_bf16 a[20:23], v[68:71], v[164:167], 0
  ds_read_b64_tr_b16 v[64:65], v31 offset:0
  ds_read_b64_tr_b16 v[66:67], v31 offset:4096
  v_mfma_f32_16x16x32_bf16 a[24:27], v[68:71], v[168:171], 0
  s_mov_b32 s39, 24576
  v_mfma_f32_16x16x32_bf16 a[28:31], v[68:71], v[172:175], 0
  s_waitcnt lgkmcnt(6)
  v_mfma_f32_16x16x32_bf16 a[32:35], v[48:51], v[160:163], 0
  v_exp_f32 v226, v226
  v_mfma_f32_16x16x32_bf16 a[36:39], v[48:51], v[164:167], 0
  ds_read_b64_tr_b16 v[68:69], v32 offset:0
  ds_read_b64_tr_b16 v[70:71], v32 offset:4096
  v_mfma_f32_16x16x32_bf16 a[40:43], v[48:51], v[168:171], 0
  buffer_load_dwordx4 v19, s[24:27], s39 offen lds
  v_mfma_f32_16x16x32_bf16 a[44:47], v[48:51], v[172:175], 0
  v_exp_f32 v227, v227
  v_mfma_f32_16x16x32_bf16 a[48:51], v[52:55], v[160:163], 0
  v_exp_f32 v228, v228
  v_mfma_f32_16x16x32_bf16 a[52:55], v[52:55], v[164:167], 0
  buffer_load_dwordx4 v20, s[24:27], s39 offen offset:1024 lds
  v_mfma_f32_16x16x32_bf16 a[56:59], v[52:55], v[168:171], 0
  v_exp_f32 v229, v229
  v_mfma_f32_16x16x32_bf16 a[60:63], v[52:55], v[172:175], 0
  v_exp_f32 v230, v230
  v_mfma_f32_16x16x32_bf16 a[128:131], v[34:37], v[160:163], 0
  v_exp_f32 v231, v231
  v_mfma_f32_16x16x32_bf16 a[132:135], v[34:37], v[164:167], 0
  ds_read_b128 v[48:51], v21 offset:16384
  s_add_u32 m0, s42, 8192
  v_mfma_f32_16x16x32_bf16 a[136:139], v[34:37], v[168:171], 0
  v_cvt_pk_bf16_f32 v176, v224, v225
  v_cvt_pk_bf16_f32 v177, v226, v227
  v_mfma_f32_16x16x32_bf16 a[140:143], v[34:37], v[172:175], 0
  s_waitcnt lgkmcnt(5)
  v_mfma_f32_16x16x32_bf16 a[64:67], v[56:59], v[160:163], 0
  v_exp_f32 v232, v232
  v_mfma_f32_16x16x32_bf16 a[68:71], v[56:59], v[164:167], 0
  ds_read_b128 v[52:55], v22 offset:16384
  s_mov_b32 s39, 40960
  v_mfma_f32_16x16x32_bf16 a[72:75], v[56:59], v[168:171], 0
  v_exp_f32 v233, v233
  v_mfma_f32_16x16x32_bf16 a[76:79], v[56:59], v[172:175], 0
  v_exp_f32 v234, v234
  v_mfma_f32_16x16x32_bf16 a[80:83], v[60:63], v[160:163], 0
  v_exp_f32 v235, v235
  v_mfma_f32_16x16x32_bf16 a[84:87], v[60:63], v[164:167], 0
  ds_read_b128 v[56:59], v23 offset:16384
  v_cvt_pk_bf16_f32 v180, v228, v229
  v_mfma_f32_16x16x32_bf16 a[88:91], v[60:63], v[168:171], 0
  buffer_load_dwordx4 v17, s[20:23], s39 offen lds
  v_mfma_f32_16x16x32_bf16 a[92:95], v[60:63], v[172:175], 0
  v_cvt_pk_bf16_f32 v181, v230, v231
  s_waitcnt lgkmcnt(3)
  v_mfma_f32_16x16x32_bf16 a[96:99], v[64:67], v[160:163], 0
  v_exp_f32 v236, v236
  v_mfma_f32_16x16x32_bf16 a[100:103], v[64:67], v[164:167], 0
  ds_read_b128 v[60:63], v24 offset:16384
  v_mfma_f32_16x16x32_bf16 a[104:107], v[64:67], v[168:171], 0
  buffer_load_dwordx4 v18, s[20:23], s39 offen offset:1024 lds
  v_mfma_f32_16x16x32_bf16 a[108:111], v[64:67], v[172:175], 0
  v_exp_f32 v237, v237
  v_mfma_f32_16x16x32_bf16 a[112:115], v[68:71], v[160:163], 0
  v_exp_f32 v238, v238
  v_mfma_f32_16x16x32_bf16 a[116:119], v[68:71], v[164:167], 0
  ds_read_b128 v[64:67], v21 offset:20480
  v_mfma_f32_16x16x32_bf16 a[120:123], v[68:71], v[168:171], 0
  v_exp_f32 v239, v239
  v_mfma_f32_16x16x32_bf16 a[124:127], v[68:71], v[172:175], 0
  v_cvt_pk_bf16_f32 v184, v232, v233
  s_waitcnt lgkmcnt(3)
  v_mfma_f32_16x16x32_bf16 v[192:195], v[48:51], v[80:83], v[144:147]
  v_cvt_pk_bf16_f32 v185, v234, v235
  v_mfma_f32_16x16x32_bf16 v[196:199], v[48:51], v[84:87], v[148:151]
  ds_read_b128 v[68:71], v22 offset:20480
  v_mfma_f32_16x16x32_bf16 v[200:203], v[48:51], v[88:91], v[152:155]
  v_exp_f32 v240, v240
  v_mfma_f32_16x16x32_bf16 v[204:207], v[48:51], v[92:95], v[156:159]
  v_exp_f32 v241, v241
  v_mfma_f32_16x16x32_bf16 v[192:195], v[52:55], v[96:99], v[192:195]
  v_exp_f32 v242, v242
  v_mfma_f32_16x16x32_bf16 v[196:199], v[52:55], v[100:103], v[196:199]
  ds_read_b128 v[48:51], v23 offset:20480
  v_mfma_f32_16x16x32_bf16 v[200:203], v[52:55], v[104:107], v[200:203]
  v_exp_f32 v243, v243
  v_mfma_f32_16x16x32_bf16 v[204:207], v[52:55], v[108:111], v[204:207]
  v_cvt_pk_bf16_f32 v188, v236, v237
  s_waitcnt lgkmcnt(3)
  v_mfma_f32_16x16x32_bf16 v[192:195], v[56:59], v[112:115], v[192:195]
  v_cvt_pk_bf16_f32 v189, v238, v239
  v_mfma_f32_16x16x32_bf16 v[196:199], v[56:59], v[116:119], v[196:199]
  ds_read_b128 v[52:55], v24 offset:20480
  v_mfma_f32_16x16x32_bf16 v[200:203], v[56:59], v[120:123], v[200:203]
  v_exp_f32 v244, v244
  v_mfma_f32_16x16x32_bf16 v[204:207], v[56:59], v[124:127], v[204:207]
  v_exp_f32 v245, v245
  v_mfma_f32_16x16x32_bf16 v[192:195], v[60:63], v[128:131], v[192:195]
  v_exp_f32 v246, v246
  v_mfma_f32_16x16x32_bf16 v[196:199], v[60:63], v[132:135], v[196:199]
  ds_read_b64_tr_b16 v[56:57], v25 offset:8192
  ds_read_b64_tr_b16 v[58:59], v25 offset:12288
  v_mfma_f32_16x16x32_bf16 v[200:203], v[60:63], v[136:139], v[200:203]
  v_exp_f32 v247, v247
  v_mfma_f32_16x16x32_bf16 v[204:207], v[60:63], v[140:143], v[204:207]
  v_cvt_pk_bf16_f32 v178, v240, v241
  s_waitcnt lgkmcnt(4)
  v_mfma_f32_16x16x32_bf16 v[208:211], v[64:67], v[80:83], v[144:147]
  v_cvt_pk_bf16_f32 v179, v242, v243
  v_mfma_f32_16x16x32_bf16 v[212:215], v[64:67], v[84:87], v[148:151]
  ds_read_b64_tr_b16 v[60:61], v26 offset:8192
  ds_read_b64_tr_b16 v[62:63], v26 offset:12288
  v_mfma_f32_16x16x32_bf16 v[216:219], v[64:67], v[88:91], v[152:155]
  v_exp_f32 v248, v248
  v_mfma_f32_16x16x32_bf16 v[220:223], v[64:67], v[92:95], v[156:159]
  v_exp_f32 v249, v249
  v_mfma_f32_16x16x32_bf16 v[208:211], v[68:71], v[96:99], v[208:211]
  v_exp_f32 v250, v250
  v_mfma_f32_16x16x32_bf16 v[212:215], v[68:71], v[100:103], v[212:215]
  ds_read_b64_tr_b16 v[64:65], v27 offset:8192
  ds_read_b64_tr_b16 v[66:67], v27 offset:12288
  v_mfma_f32_16x16x32_bf16 v[216:219], v[68:71], v[104:107], v[216:219]
  v_exp_f32 v251, v251
  v_mfma_f32_16x16x32_bf16 v[220:223], v[68:71], v[108:111], v[220:223]
  v_cvt_pk_bf16_f32 v182, v244, v245
  s_waitcnt lgkmcnt(6)
  v_mfma_f32_16x16x32_bf16 v[208:211], v[48:51], v[112:115], v[208:211]
  v_cvt_pk_bf16_f32 v183, v246, v247
  v_mfma_f32_16x16x32_bf16 v[212:215], v[48:51], v[116:119], v[212:215]
  ds_read_b64_tr_b16 v[68:69], v28 offset:8192
  ds_read_b64_tr_b16 v[70:71], v28 offset:12288
  v_mfma_f32_16x16x32_bf16 v[216:219], v[48:51], v[120:123], v[216:219]
  v_exp_f32 v252, v252
  v_mfma_f32_16x16x32_bf16 v[220:223], v[48:51], v[124:127], v[220:223]
  v_exp_f32 v253, v253
  v_mfma_f32_16x16x32_bf16 v[208:211], v[52:55], v[128:131], v[208:211]
  v_exp_f32 v254, v254
  v_mfma_f32_16x16x32_bf16 v[212:215], v[52:55], v[132:135], v[212:215]
  v_exp_f32 v255, v255
  v_mfma_f32_16x16x32_bf16 v[216:219], v[52:55], v[136:139], v[216:219]
  v_cvt_pk_bf16_f32 v186, v248, v249
  v_cvt_pk_bf16_f32 v187, v250, v251
  v_cvt_pk_bf16_f32 v190, v252, v253
  v_cvt_pk_bf16_f32 v191, v254, v255
  v_mfma_f32_16x16x32_bf16 v[220:223], v[52:55], v[140:143], v[220:223]
  s_waitcnt vmcnt(6)
  s_barrier
  s_waitcnt lgkmcnt(4)
  v_mfma_f32_16x16x32_bf16 a[0:3], v[56:59], v[176:179], a[0:3]
  ds_read_b64_tr_b16 v[48:49], v29 offset:8192
  ds_read_b64_tr_b16 v[50:51], v29 offset:12288
  v_mfma_f32_16x16x32_bf16 a[4:7], v[56:59], v[180:183], a[4:7]
  ds_read_b64_tr_b16 v[52:53], v30 offset:8192
  ds_read_b64_tr_b16 v[54:55], v30 offset:12288
  v_mfma_f32_16x16x32_bf16 a[8:11], v[56:59], v[184:187], a[8:11]
  s_add_u32 m0, s42, 32768
  v_mfma_f32_16x16x32_bf16 a[12:15], v[56:59], v[188:191], a[12:15]
  v_exp_f32 v192, v192
  v_mfma_f32_16x16x32_bf16 a[16:19], v[60:63], v[176:179], a[16:19]
  v_exp_f32 v193, v193
  v_mfma_f32_16x16x32_bf16 a[20:23], v[60:63], v[180:183], a[20:23]
  ds_read_b64_tr_b16 v[56:57], v31 offset:8192
  ds_read_b64_tr_b16 v[58:59], v31 offset:12288
  v_mfma_f32_16x16x32_bf16 a[24:27], v[60:63], v[184:187], a[24:27]
  s_mov_b32 s39, 32768
  v_mfma_f32_16x16x32_bf16 a[28:31], v[60:63], v[188:191], a[28:31]
  s_waitcnt lgkmcnt(6)
  v_mfma_f32_16x16x32_bf16 a[32:35], v[64:67], v[176:179], a[32:35]
  v_exp_f32 v194, v194
  v_mfma_f32_16x16x32_bf16 a[36:39], v[64:67], v[180:183], a[36:39]
  ds_read_b64_tr_b16 v[60:61], v32 offset:8192
  ds_read_b64_tr_b16 v[62:63], v32 offset:12288
  v_mfma_f32_16x16x32_bf16 a[40:43], v[64:67], v[184:187], a[40:43]
  buffer_load_dwordx4 v19, s[24:27], s39 offen lds
  v_mfma_f32_16x16x32_bf16 a[44:47], v[64:67], v[188:191], a[44:47]
  v_exp_f32 v195, v195
  v_mfma_f32_16x16x32_bf16 a[48:51], v[68:71], v[176:179], a[48:51]
  v_exp_f32 v196, v196
  v_mfma_f32_16x16x32_bf16 a[52:55], v[68:71], v[180:183], a[52:55]
  buffer_load_dwordx4 v20, s[24:27], s39 offen offset:1024 lds
  v_mfma_f32_16x16x32_bf16 a[56:59], v[68:71], v[184:187], a[56:59]
  v_exp_f32 v197, v197
  v_mfma_f32_16x16x32_bf16 a[60:63], v[68:71], v[188:191], a[60:63]
  v_exp_f32 v198, v198
  v_mfma_f32_16x16x32_bf16 a[128:131], v[34:37], v[176:179], a[128:131]
  v_exp_f32 v199, v199
  v_mfma_f32_16x16x32_bf16 a[132:135], v[34:37], v[180:183], a[132:135]
  ds_read_b128 v[64:67], v21 offset:24576
  s_add_u32 m0, s42, 16384
  v_mfma_f32_16x16x32_bf16 a[136:139], v[34:37], v[184:187], a[136:139]
  v_cvt_pk_bf16_f32 v160, v192, v193
  v_cvt_pk_bf16_f32 v161, v194, v195
  v_mfma_f32_16x16x32_bf16 a[140:143], v[34:37], v[188:191], a[140:143]
  s_waitcnt lgkmcnt(5)
  v_mfma_f32_16x16x32_bf16 a[64:67], v[48:51], v[176:179], a[64:67]
  v_exp_f32 v200, v200
  v_mfma_f32_16x16x32_bf16 a[68:71], v[48:51], v[180:183], a[68:71]
  ds_read_b128 v[68:71], v22 offset:24576
  s_mov_b32 s39, 49152
  v_mfma_f32_16x16x32_bf16 a[72:75], v[48:51], v[184:187], a[72:75]
  v_exp_f32 v201, v201
  v_mfma_f32_16x16x32_bf16 a[76:79], v[48:51], v[188:191], a[76:79]
  v_exp_f32 v202, v202
  v_mfma_f32_16x16x32_bf16 a[80:83], v[52:55], v[176:179], a[80:83]
  v_exp_f32 v203, v203
  v_mfma_f32_16x16x32_bf16 a[84:87], v[52:55], v[180:183], a[84:87]
  ds_read_b128 v[48:51], v23 offset:24576
  v_cvt_pk_bf16_f32 v164, v196, v197
  v_mfma_f32_16x16x32_bf16 a[88:91], v[52:55], v[184:187], a[88:91]
  buffer_load_dwordx4 v17, s[20:23], s39 offen lds
  v_mfma_f32_16x16x32_bf16 a[92:95], v[52:55], v[188:191], a[92:95]
  v_cvt_pk_bf16_f32 v165, v198, v199
  s_waitcnt lgkmcnt(3)
  v_mfma_f32_16x16x32_bf16 a[96:99], v[56:59], v[176:179], a[96:99]
  v_exp_f32 v204, v204
  v_mfma_f32_16x16x32_bf16 a[100:103], v[56:59], v[180:183], a[100:103]
  ds_read_b128 v[52:55], v24 offset:24576
  v_mfma_f32_16x16x32_bf16 a[104:107], v[56:59], v[184:187], a[104:107]
  buffer_load_dwordx4 v18, s[20:23], s39 offen offset:1024 lds
  v_mfma_f32_16x16x32_bf16 a[108:111], v[56:59], v[188:191], a[108:111]
  v_exp_f32 v205, v205
  v_mfma_f32_16x16x32_bf16 a[112:115], v[60:63], v[176:179], a[112:115]
  v_exp_f32 v206, v206
  v_mfma_f32_16x16x32_bf16 a[116:119], v[60:63], v[180:183], a[116:119]
  ds_read_b128 v[56:59], v21 offset:28672
  v_mfma_f32_16x16x32_bf16 a[120:123], v[60:63], v[184:187], a[120:123]
  v_exp_f32 v207, v207
  v_mfma_f32_16x16x32_bf16 a[124:127], v[60:63], v[188:191], a[124:127]
  v_cvt_pk_bf16_f32 v168, v200, v201
  s_waitcnt lgkmcnt(3)
  v_mfma_f32_16x16x32_bf16 v[224:227], v[64:67], v[80:83], v[144:147]
  v_cvt_pk_bf16_f32 v169, v202, v203
  v_mfma_f32_16x16x32_bf16 v[228:231], v[64:67], v[84:87], v[148:151]
  ds_read_b128 v[60:63], v22 offset:28672
  v_mfma_f32_16x16x32_bf16 v[232:235], v[64:67], v[88:91], v[152:155]
  v_exp_f32 v208, v208
  v_mfma_f32_16x16x32_bf16 v[236:239], v[64:67], v[92:95], v[156:159]
  v_exp_f32 v209, v209
  v_mfma_f32_16x16x32_bf16 v[224:227], v[68:71], v[96:99], v[224:227]
  v_exp_f32 v210, v210
  v_mfma_f32_16x16x32_bf16 v[228:231], v[68:71], v[100:103], v[228:231]
  ds_read_b128 v[64:67], v23 offset:28672
  v_mfma_f32_16x16x32_bf16 v[232:235], v[68:71], v[104:107], v[232:235]
  v_exp_f32 v211, v211
  v_mfma_f32_16x16x32_bf16 v[236:239], v[68:71], v[108:111], v[236:239]
  v_cvt_pk_bf16_f32 v172, v204, v205
  s_waitcnt lgkmcnt(3)
  v_mfma_f32_16x16x32_bf16 v[224:227], v[48:51], v[112:115], v[224:227]
  v_cvt_pk_bf16_f32 v173, v206, v207
  v_mfma_f32_16x16x32_bf16 v[228:231], v[48:51], v[116:119], v[228:231]
  ds_read_b128 v[68:71], v24 offset:28672
  v_mfma_f32_16x16x32_bf16 v[232:235], v[48:51], v[120:123], v[232:235]
  v_exp_f32 v212, v212
  v_mfma_f32_16x16x32_bf16 v[236:239], v[48:51], v[124:127], v[236:239]
  v_exp_f32 v213, v213
  v_mfma_f32_16x16x32_bf16 v[224:227], v[52:55], v[128:131], v[224:227]
  v_exp_f32 v214, v214
  v_mfma_f32_16x16x32_bf16 v[228:231], v[52:55], v[132:135], v[228:231]
  ds_read_b64_tr_b16 v[48:49], v25 offset:16384
  ds_read_b64_tr_b16 v[50:51], v25 offset:20480
  v_mfma_f32_16x16x32_bf16 v[232:235], v[52:55], v[136:139], v[232:235]
  v_exp_f32 v215, v215
  v_mfma_f32_16x16x32_bf16 v[236:239], v[52:55], v[140:143], v[236:239]
  v_cvt_pk_bf16_f32 v162, v208, v209
  s_waitcnt lgkmcnt(4)
  v_mfma_f32_16x16x32_bf16 v[240:243], v[56:59], v[80:83], v[144:147]
  v_cvt_pk_bf16_f32 v163, v210, v211
  v_mfma_f32_16x16x32_bf16 v[244:247], v[56:59], v[84:87], v[148:151]
  ds_read_b64_tr_b16 v[52:53], v26 offset:16384
  ds_read_b64_tr_b16 v[54:55], v26 offset:20480
  v_mfma_f32_16x16x32_bf16 v[248:251], v[56:59], v[88:91], v[152:155]
  v_exp_f32 v216, v216
  v_mfma_f32_16x16x32_bf16 v[252:255], v[56:59], v[92:95], v[156:159]
  v_exp_f32 v217, v217
  v_mfma_f32_16x16x32_bf16 v[240:243], v[60:63], v[96:99], v[240:243]
  v_exp_f32 v218, v218
  v_mfma_f32_16x16x32_bf16 v[244:247], v[60:63], v[100:103], v[244:247]
  ds_read_b64_tr_b16 v[56:57], v27 offset:16384
  ds_read_b64_tr_b16 v[58:59], v27 offset:20480
  v_mfma_f32_16x16x32_bf16 v[248:251], v[60:63], v[104:107], v[248:251]
  v_exp_f32 v219, v219
  v_mfma_f32_16x16x32_bf16 v[252:255], v[60:63], v[108:111], v[252:255]
  v_cvt_pk_bf16_f32 v166, v212, v213
  s_waitcnt lgkmcnt(6)
  v_mfma_f32_16x16x32_bf16 v[240:243], v[64:67], v[112:115], v[240:243]
  v_cvt_pk_bf16_f32 v167, v214, v215
  v_mfma_f32_16x16x32_bf16 v[244:247], v[64:67], v[116:119], v[244:247]
  ds_read_b64_tr_b16 v[60:61], v28 offset:16384
  ds_read_b64_tr_b16 v[62:63], v28 offset:20480
  v_mfma_f32_16x16x32_bf16 v[248:251], v[64:67], v[120:123], v[248:251]
  v_exp_f32 v220, v220
  v_mfma_f32_16x16x32_bf16 v[252:255], v[64:67], v[124:127], v[252:255]
  v_exp_f32 v221, v221
  v_mfma_f32_16x16x32_bf16 v[240:243], v[68:71], v[128:131], v[240:243]
  v_exp_f32 v222, v222
  v_mfma_f32_16x16x32_bf16 v[244:247], v[68:71], v[132:135], v[244:247]
  v_exp_f32 v223, v223
  v_mfma_f32_16x16x32_bf16 v[248:251], v[68:71], v[136:139], v[248:251]
  v_cvt_pk_bf16_f32 v170, v216, v217
  v_cvt_pk_bf16_f32 v171, v218, v219
  v_cvt_pk_bf16_f32 v174, v220, v221
  v_cvt_pk_bf16_f32 v175, v222, v223
  v_mfma_f32_16x16x32_bf16 v[252:255], v[68:71], v[140:143], v[252:255]
  s_waitcnt vmcnt(6)
  s_barrier
  s_waitcnt lgkmcnt(4)
  v_mfma_f32_16x16x32_bf16 a[0:3], v[48:51], v[160:163], a[0:3]
  ds_read_b64_tr_b16 v[64:65], v29 offset:16384
  ds_read_b64_tr_b16 v[66:67], v29 offset:20480
  v_mfma_f32_16x16x32_bf16 a[4:7], v[48:51], v[164:167], a[4:7]
  ds_read_b64_tr_b16 v[68:69], v30 offset:16384
  ds_read_b64_tr_b16 v[70:71], v30 offset:20480
  v_mfma_f32_16x16x32_bf16 a[8:11], v[48:51], v[168:171], a[8:11]
  s_add_u32 m0, s42, 40960
  v_mfma_f32_16x16x32_bf16 a[12:15], v[48:51], v[172:175], a[12:15]
  v_exp_f32 v224, v224
  v_mfma_f32_16x16x32_bf16 a[16:19], v[52:55], v[160:163], a[16:19]
  v_exp_f32 v225, v225
  v_mfma_f32_16x16x32_bf16 a[20:23], v[52:55], v[164:167], a[20:23]
  ds_read_b64_tr_b16 v[48:49], v31 offset:16384
  ds_read_b64_tr_b16 v[50:51], v31 offset:20480
  v_mfma_f32_16x16x32_bf16 a[24:27], v[52:55], v[168:171], a[24:27]
  s_mov_b32 s39, 40960
  v_mfma_f32_16x16x32_bf16 a[28:31], v[52:55], v[172:175], a[28:31]
  s_waitcnt lgkmcnt(6)
  v_mfma_f32_16x16x32_bf16 a[32:35], v[56:59], v[160:163], a[32:35]
  v_exp_f32 v226, v226
  v_mfma_f32_16x16x32_bf16 a[36:39], v[56:59], v[164:167], a[36:39]
  ds_read_b64_tr_b16 v[52:53], v32 offset:16384
  ds_read_b64_tr_b16 v[54:55], v32 offset:20480
  v_mfma_f32_16x16x32_bf16 a[40:43], v[56:59], v[168:171], a[40:43]
  buffer_load_dwordx4 v19, s[24:27], s39 offen lds
  v_mfma_f32_16x16x32_bf16 a[44:47], v[56:59], v[172:175], a[44:47]
  v_exp_f32 v227, v227
  v_mfma_f32_16x16x32_bf16 a[48:51], v[60:63], v[160:163], a[48:51]
  v_exp_f32 v228, v228
  v_mfma_f32_16x16x32_bf16 a[52:55], v[60:63], v[164:167], a[52:55]
  buffer_load_dwordx4 v20, s[24:27], s39 offen offset:1024 lds
  v_mfma_f32_16x16x32_bf16 a[56:59], v[60:63], v[168:171], a[56:59]
  v_exp_f32 v229, v229
  v_mfma_f32_16x16x32_bf16 a[60:63], v[60:63], v[172:175], a[60:63]
  v_exp_f32 v230, v230
  v_mfma_f32_16x16x32_bf16 a[128:131], v[34:37], v[160:163], a[128:131]
  v_exp_f32 v231, v231
  v_mfma_f32_16x16x32_bf16 a[132:135], v[34:37], v[164:167], a[132:135]
  ds_read_b128 v[56:59], v21 offset:0
  s_add_u32 m0, s42, 24576
  v_mfma_f32_16x16x32_bf16 a[136:139], v[34:37], v[168:171], a[136:139]
  v_cvt_pk_bf16_f32 v176, v224, v225
  v_cvt_pk_bf16_f32 v177, v226, v227
  v_mfma_f32_16x16x32_bf16 a[140:143], v[34:37], v[172:175], a[140:143]
  s_waitcnt lgkmcnt(5)
  v_mfma_f32_16x16x32_bf16 a[64:67], v[64:67], v[160:163], a[64:67]
  v_exp_f32 v232, v232
  v_mfma_f32_16x16x32_bf16 a[68:71], v[64:67], v[164:167], a[68:71]
  ds_read_b128 v[60:63], v22 offset:0
  s_mov_b32 s39, 57344
  v_mfma_f32_16x16x32_bf16 a[72:75], v[64:67], v[168:171], a[72:75]
  v_exp_f32 v233, v233
  v_mfma_f32_16x16x32_bf16 a[76:79], v[64:67], v[172:175], a[76:79]
  v_exp_f32 v234, v234
  v_mfma_f32_16x16x32_bf16 a[80:83], v[68:71], v[160:163], a[80:83]
  v_exp_f32 v235, v235
  v_mfma_f32_16x16x32_bf16 a[84:87], v[68:71], v[164:167], a[84:87]
  ds_read_b128 v[64:67], v23 offset:0
  v_cvt_pk_bf16_f32 v180, v228, v229
  v_mfma_f32_16x16x32_bf16 a[88:91], v[68:71], v[168:171], a[88:91]
  buffer_load_dwordx4 v17, s[20:23], s39 offen lds
  v_mfma_f32_16x16x32_bf16 a[92:95], v[68:71], v[172:175], a[92:95]
  v_cvt_pk_bf16_f32 v181, v230, v231
  s_waitcnt lgkmcnt(3)
  v_mfma_f32_16x16x32_bf16 a[96:99], v[48:51], v[160:163], a[96:99]
  v_exp_f32 v236, v236
  v_mfma_f32_16x16x32_bf16 a[100:103], v[48:51], v[164:167], a[100:103]
  ds_read_b128 v[68:71], v24 offset:0
  v_mfma_f32_16x16x32_bf16 a[104:107], v[48:51], v[168:171], a[104:107]
  buffer_load_dwordx4 v18, s[20:23], s39 offen offset:1024 lds
  v_mfma_f32_16x16x32_bf16 a[108:111], v[48:51], v[172:175], a[108:111]
  v_exp_f32 v237, v237
  v_mfma_f32_16x16x32_bf16 a[112:115], v[52:55], v[160:163], a[112:115]
  v_exp_f32 v238, v238
  v_mfma_f32_16x16x32_bf16 a[116:119], v[52:55], v[164:167], a[116:119]
  ds_read_b128 v[48:51], v21 offset:4096
  v_mfma_f32_16x16x32_bf16 a[120:123], v[52:55], v[168:171], a[120:123]
  v_exp_f32 v239, v239
  v_mfma_f32_16x16x32_bf16 a[124:127], v[52:55], v[172:175], a[124:127]
  v_cvt_pk_bf16_f32 v184, v232, v233
  s_waitcnt lgkmcnt(3)
  v_mfma_f32_16x16x32_bf16 v[192:195], v[56:59], v[80:83], v[144:147]
  v_cvt_pk_bf16_f32 v185, v234, v235
  v_mfma_f32_16x16x32_bf16 v[196:199], v[56:59], v[84:87], v[148:151]
  ds_read_b128 v[52:55], v22 offset:4096
  v_mfma_f32_16x16x32_bf16 v[200:203], v[56:59], v[88:91], v[152:155]
  v_exp_f32 v240, v240
  v_mfma_f32_16x16x32_bf16 v[204:207], v[56:59], v[92:95], v[156:159]
  v_exp_f32 v241, v241
  v_mfma_f32_16x16x32_bf16 v[192:195], v[60:63], v[96:99], v[192:195]
  v_exp_f32 v242, v242
  v_mfma_f32_16x16x32_bf16 v[196:199], v[60:63], v[100:103], v[196:199]
  ds_read_b128 v[56:59], v23 offset:4096
  v_mfma_f32_16x16x32_bf16 v[200:203], v[60:63], v[104:107], v[200:203]
  v_exp_f32 v243, v243
  v_mfma_f32_16x16x32_bf16 v[204:207], v[60:63], v[108:111], v[204:207]
  v_cvt_pk_bf16_f32 v188, v236, v237
  s_waitcnt lgkmcnt(3)
  v_mfma_f32_16x16x32_bf16 v[192:195], v[64:67], v[112:115], v[192:195]
  v_cvt_pk_bf16_f32 v189, v238, v239
  v_mfma_f32_16x16x32_bf16 v[196:199], v[64:67], v[116:119], v[196:199]
  ds_read_b128 v[60:63], v24 offset:4096
  v_mfma_f32_16x16x32_bf16 v[200:203], v[64:67], v[120:123], v[200:203]
  v_exp_f32 v244, v244
  v_mfma_f32_16x16x32_bf16 v[204:207], v[64:67], v[124:127], v[204:207]
  v_exp_f32 v245, v245
  v_mfma_f32_16x16x32_bf16 v[192:195], v[68:71], v[128:131], v[192:195]
  v_exp_f32 v246, v246
  v_mfma_f32_16x16x32_bf16 v[196:199], v[68:71], v[132:135], v[196:199]
  ds_read_b64_tr_b16 v[64:65], v25 offset:24576
  ds_read_b64_tr_b16 v[66:67], v25 offset:28672
  v_mfma_f32_16x16x32_bf16 v[200:203], v[68:71], v[136:139], v[200:203]
  v_exp_f32 v247, v247
  v_mfma_f32_16x16x32_bf16 v[204:207], v[68:71], v[140:143], v[204:207]
  v_cvt_pk_bf16_f32 v178, v240, v241
  s_waitcnt lgkmcnt(4)
  v_mfma_f32_16x16x32_bf16 v[208:211], v[48:51], v[80:83], v[144:147]
  v_cvt_pk_bf16_f32 v179, v242, v243
  v_mfma_f32_16x16x32_bf16 v[212:215], v[48:51], v[84:87], v[148:151]
  ds_read_b64_tr_b16 v[68:69], v26 offset:24576
  ds_read_b64_tr_b16 v[70:71], v26 offset:28672
  v_mfma_f32_16x16x32_bf16 v[216:219], v[48:51], v[88:91], v[152:155]
  v_exp_f32 v248, v248
  v_mfma_f32_16x16x32_bf16 v[220:223], v[48:51], v[92:95], v[156:159]
  v_exp_f32 v249, v249
  v_mfma_f32_16x16x32_bf16 v[208:211], v[52:55], v[96:99], v[208:211]
  v_exp_f32 v250, v250
  v_mfma_f32_16x16x32_bf16 v[212:215], v[52:55], v[100:103], v[212:215]
  ds_read_b64_tr_b16 v[48:49], v27 offset:24576
  ds_read_b64_tr_b16 v[50:51], v27 offset:28672
  v_mfma_f32_16x16x32_bf16 v[216:219], v[52:55], v[104:107], v[216:219]
  v_exp_f32 v251, v251
  v_mfma_f32_16x16x32_bf16 v[220:223], v[52:55], v[108:111], v[220:223]
  v_cvt_pk_bf16_f32 v182, v244, v245
  s_waitcnt lgkmcnt(6)
  v_mfma_f32_16x16x32_bf16 v[208:211], v[56:59], v[112:115], v[208:211]
  v_cvt_pk_bf16_f32 v183, v246, v247
  v_mfma_f32_16x16x32_bf16 v[212:215], v[56:59], v[116:119], v[212:215]
  ds_read_b64_tr_b16 v[52:53], v28 offset:24576
  ds_read_b64_tr_b16 v[54:55], v28 offset:28672
  v_mfma_f32_16x16x32_bf16 v[216:219], v[56:59], v[120:123], v[216:219]
  v_exp_f32 v252, v252
  v_mfma_f32_16x16x32_bf16 v[220:223], v[56:59], v[124:127], v[220:223]
  v_exp_f32 v253, v253
  v_mfma_f32_16x16x32_bf16 v[208:211], v[60:63], v[128:131], v[208:211]
  v_exp_f32 v254, v254
  v_mfma_f32_16x16x32_bf16 v[212:215], v[60:63], v[132:135], v[212:215]
  v_exp_f32 v255, v255
  v_mfma_f32_16x16x32_bf16 v[216:219], v[60:63], v[136:139], v[216:219]
  v_cvt_pk_bf16_f32 v186, v248, v249
  v_cvt_pk_bf16_f32 v187, v250, v251
  v_cvt_pk_bf16_f32 v190, v252, v253
  v_cvt_pk_bf16_f32 v191, v254, v255
  v_mfma_f32_16x16x32_bf16 v[220:223], v[60:63], v[140:143], v[220:223]
  s_waitcnt vmcnt(6)
  s_barrier
  s_waitcnt lgkmcnt(4)
  v_mfma_f32_16x16x32_bf16 a[0:3], v[64:67], v[176:179], a[0:3]
  ds_read_b64_tr_b16 v[56:57], v29 offset:24576
  ds_read_b64_tr_b16 v[58:59], v29 offset:28672
  v_mfma_f32_16x16x32_bf16 a[4:7], v[64:67], v[180:183], a[4:7]
  ds_read_b64_tr_b16 v[60:61], v30 offset:24576
  ds_read_b64_tr_b16 v[62:63], v30 offset:28672
  v_mfma_f32_16x16x32_bf16 a[8:11], v[64:67], v[184:187], a[8:11]
  s_add_u32 m0, s42, 49152
  v_mfma_f32_16x16x32_bf16 a[12:15], v[64:67], v[188:191], a[12:15]
  v_exp_f32 v192, v192
  v_mfma_f32_16x16x32_bf16 a[16:19], v[68:71], v[176:179], a[16:19]
  v_exp_f32 v193, v193
  v_mfma_f32_16x16x32_bf16 a[20:23], v[68:71], v[180:183], a[20:23]
  ds_read_b64_tr_b16 v[64:65], v31 offset:24576
  ds_read_b64_tr_b16 v[66:67], v31 offset:28672
  v_mfma_f32_16x16x32_bf16 a[24:27], v[68:71], v[184:187], a[24:27]
  s_mov_b32 s39, 49152
  v_mfma_f32_16x16x32_bf16 a[28:31], v[68:71], v[188:191], a[28:31]
  s_waitcnt lgkmcnt(6)
  v_mfma_f32_16x16x32_bf16 a[32:35], v[48:51], v[176:179], a[32:35]
  v_exp_f32 v194, v194
  v_mfma_f32_16x16x32_bf16 a[36:39], v[48:51], v[180:183], a[36:39]
  ds_read_b64_tr_b16 v[68:69], v32 offset:24576
  ds_read_b64_tr_b16 v[70:71], v32 offset:28672
  v_mfma_f32_16x16x32_bf16 a[40:43], v[48:51], v[184:187], a[40:43]
  buffer_load_dwordx4 v19, s[24:27], s39 offen lds
  v_mfma_f32_16x16x32_bf16 a[44:47], v[48:51], v[188:191], a[44:47]
  v_exp_f32 v195, v195
  v_mfma_f32_16x16x32_bf16 a[48:51], v[52:55], v[176:179], a[48:51]
  v_exp_f32 v196, v196
  v_mfma_f32_16x16x32_bf16 a[52:55], v[52:55], v[180:183], a[52:55]
  buffer_load_dwordx4 v20, s[24:27], s39 offen offset:1024 lds
  v_mfma_f32_16x16x32_bf16 a[56:59], v[52:55], v[184:187], a[56:59]
  v_exp_f32 v197, v197
  v_mfma_f32_16x16x32_bf16 a[60:63], v[52:55], v[188:191], a[60:63]
  v_exp_f32 v198, v198
  v_mfma_f32_16x16x32_bf16 a[128:131], v[34:37], v[176:179], a[128:131]
  v_exp_f32 v199, v199
  v_mfma_f32_16x16x32_bf16 a[132:135], v[34:37], v[180:183], a[132:135]
  ds_read_b128 v[48:51], v21 offset:8192
  s_add_u32 m0, s42, 0
  v_mfma_f32_16x16x32_bf16 a[136:139], v[34:37], v[184:187], a[136:139]
  v_cvt_pk_bf16_f32 v160, v192, v193
  v_cvt_pk_bf16_f32 v161, v194, v195
  v_mfma_f32_16x16x32_bf16 a[140:143], v[34:37], v[188:191], a[140:143]
  s_waitcnt lgkmcnt(5)
  v_mfma_f32_16x16x32_bf16 a[64:67], v[56:59], v[176:179], a[64:67]
  v_exp_f32 v200, v200
  v_mfma_f32_16x16x32_bf16 a[68:71], v[56:59], v[180:183], a[68:71]
  ds_read_b128 v[52:55], v22 offset:8192
  s_mov_b32 s39, 65536
  v_mfma_f32_16x16x32_bf16 a[72:75], v[56:59], v[184:187], a[72:75]
  v_exp_f32 v201, v201
  v_mfma_f32_16x16x32_bf16 a[76:79], v[56:59], v[188:191], a[76:79]
  v_exp_f32 v202, v202
  v_mfma_f32_16x16x32_bf16 a[80:83], v[60:63], v[176:179], a[80:83]
  v_exp_f32 v203, v203
  v_mfma_f32_16x16x32_bf16 a[84:87], v[60:63], v[180:183], a[84:87]
  ds_read_b128 v[56:59], v23 offset:8192
  v_cvt_pk_bf16_f32 v164, v196, v197
  v_mfma_f32_16x16x32_bf16 a[88:91], v[60:63], v[184:187], a[88:91]
  buffer_load_dwordx4 v17, s[20:23], s39 offen lds
  v_mfma_f32_16x16x32_bf16 a[92:95], v[60:63], v[188:191], a[92:95]
  v_cvt_pk_bf16_f32 v165, v198, v199
  s_waitcnt lgkmcnt(3)
  v_mfma_f32_16x16x32_bf16 a[96:99], v[64:67], v[176:179], a[96:99]
  v_exp_f32 v204, v204
  v_mfma_f32_16x16x32_bf16 a[100:103], v[64:67], v[180:183], a[100:103]
  ds_read_b128 v[60:63], v24 offset:8192
  v_mfma_f32_16x16x32_bf16 a[104:107], v[64:67], v[184:187], a[104:107]
  buffer_load_dwordx4 v18, s[20:23], s39 offen offset:1024 lds
  v_mfma_f32_16x16x32_bf16 a[108:111], v[64:67], v[188:191], a[108:111]
  v_exp_f32 v205, v205
  v_mfma_f32_16x16x32_bf16 a[112:115], v[68:71], v[176:179], a[112:115]
  v_exp_f32 v206, v206
  v_mfma_f32_16x16x32_bf16 a[116:119], v[68:71], v[180:183], a[116:119]
  ds_read_b128 v[64:67], v21 offset:12288
  v_mfma_f32_16x16x32_bf16 a[120:123], v[68:71], v[184:187], a[120:123]
  v_exp_f32 v207, v207
  v_mfma_f32_16x16x32_bf16 a[124:127], v[68:71], v[188:191], a[124:127]
  v_cvt_pk_bf16_f32 v168, v200, v201
  s_waitcnt lgkmcnt(3)
  v_mfma_f32_16x16x32_bf16 v[224:227], v[48:51], v[80:83], v[144:147]
  v_cvt_pk_bf16_f32 v169, v202, v203
  v_mfma_f32_16x16x32_bf16 v[228:231], v[48:51], v[84:87], v[148:151]
  ds_read_b128 v[68:71], v22 offset:12288
  v_mfma_f32_16x16x32_bf16 v[232:235], v[48:51], v[88:91], v[152:155]
  v_exp_f32 v208, v208
  v_mfma_f32_16x16x32_bf16 v[236:239], v[48:51], v[92:95], v[156:159]
  v_exp_f32 v209, v209
  v_mfma_f32_16x16x32_bf16 v[224:227], v[52:55], v[96:99], v[224:227]
  v_exp_f32 v210, v210
  v_mfma_f32_16x16x32_bf16 v[228:231], v[52:55], v[100:103], v[228:231]
  ds_read_b128 v[48:51], v23 offset:12288
  v_mfma_f32_16x16x32_bf16 v[232:235], v[52:55], v[104:107], v[232:235]
  v_exp_f32 v211, v211
  v_mfma_f32_16x16x32_bf16 v[236:239], v[52:55], v[108:111], v[236:239]
  v_cvt_pk_bf16_f32 v172, v204, v205
  s_waitcnt lgkmcnt(3)
  v_mfma_f32_16x16x32_bf16 v[224:227], v[56:59], v[112:115], v[224:227]
  v_cvt_pk_bf16_f32 v173, v206, v207
  v_mfma_f32_16x16x32_bf16 v[228:231], v[56:59], v[116:119], v[228:231]
  ds_read_b128 v[52:55], v24 offset:12288
  v_mfma_f32_16x16x32_bf16 v[232:235], v[56:59], v[120:123], v[232:235]
  v_exp_f32 v212, v212
  v_mfma_f32_16x16x32_bf16 v[236:239], v[56:59], v[124:127], v[236:239]
  v_exp_f32 v213, v213
  v_mfma_f32_16x16x32_bf16 v[224:227], v[60:63], v[128:131], v[224:227]
  v_exp_f32 v214, v214
  v_mfma_f32_16x16x32_bf16 v[228:231], v[60:63], v[132:135], v[228:231]
  ds_read_b64_tr_b16 v[56:57], v25 offset:0
  ds_read_b64_tr_b16 v[58:59], v25 offset:4096
  v_mfma_f32_16x16x32_bf16 v[232:235], v[60:63], v[136:139], v[232:235]
  v_exp_f32 v215, v215
  v_mfma_f32_16x16x32_bf16 v[236:239], v[60:63], v[140:143], v[236:239]
  v_cvt_pk_bf16_f32 v162, v208, v209
  s_waitcnt lgkmcnt(4)
  v_mfma_f32_16x16x32_bf16 v[240:243], v[64:67], v[80:83], v[144:147]
  v_cvt_pk_bf16_f32 v163, v210, v211
  v_mfma_f32_16x16x32_bf16 v[244:247], v[64:67], v[84:87], v[148:151]
  ds_read_b64_tr_b16 v[60:61], v26 offset:0
  ds_read_b64_tr_b16 v[62:63], v26 offset:4096
  v_mfma_f32_16x16x32_bf16 v[248:251], v[64:67], v[88:91], v[152:155]
  v_exp_f32 v216, v216
  v_mfma_f32_16x16x32_bf16 v[252:255], v[64:67], v[92:95], v[156:159]
  v_exp_f32 v217, v217
  v_mfma_f32_16x16x32_bf16 v[240:243], v[68:71], v[96:99], v[240:243]
  v_exp_f32 v218, v218
  v_mfma_f32_16x16x32_bf16 v[244:247], v[68:71], v[100:103], v[244:247]
  ds_read_b64_tr_b16 v[64:65], v27 offset:0
  ds_read_b64_tr_b16 v[66:67], v27 offset:4096
  v_mfma_f32_16x16x32_bf16 v[248:251], v[68:71], v[104:107], v[248:251]
  v_exp_f32 v219, v219
  v_mfma_f32_16x16x32_bf16 v[252:255], v[68:71], v[108:111], v[252:255]
  v_cvt_pk_bf16_f32 v166, v212, v213
  s_waitcnt lgkmcnt(6)
  v_mfma_f32_16x16x32_bf16 v[240:243], v[48:51], v[112:115], v[240:243]
  v_cvt_pk_bf16_f32 v167, v214, v215
  v_mfma_f32_16x16x32_bf16 v[244:247], v[48:51], v[116:119], v[244:247]
  ds_read_b64_tr_b16 v[68:69], v28 offset:0
  ds_read_b64_tr_b16 v[70:71], v28 offset:4096
  v_mfma_f32_16x16x32_bf16 v[248:251], v[48:51], v[120:123], v[248:251]
  v_exp_f32 v220, v220
  v_mfma_f32_16x16x32_bf16 v[252:255], v[48:51], v[124:127], v[252:255]
  v_exp_f32 v221, v221
  v_mfma_f32_16x16x32_bf16 v[240:243], v[52:55], v[128:131], v[240:243]
  v_exp_f32 v222, v222
  v_mfma_f32_16x16x32_bf16 v[244:247], v[52:55], v[132:135], v[244:247]
  v_exp_f32 v223, v223
  v_mfma_f32_16x16x32_bf16 v[248:251], v[52:55], v[136:139], v[248:251]
  v_cvt_pk_bf16_f32 v170, v216, v217
  v_cvt_pk_bf16_f32 v171, v218, v219
  v_cvt_pk_bf16_f32 v174, v220, v221
  v_cvt_pk_bf16_f32 v175, v222, v223
  v_mfma_f32_16x16x32_bf16 v[252:255], v[52:55], v[140:143], v[252:255]
  s_waitcnt vmcnt(6)
  s_barrier
  s_waitcnt lgkmcnt(4)
  v_mfma_f32_16x16x32_bf16 a[0:3], v[56:59], v[160:163], a[0:3]
  ds_read_b64_tr_b16 v[48:49], v29 offset:0
  ds_read_b64_tr_b16 v[50:51], v29 offset:4096
  v_mfma_f32_16x16x32_bf16 a[4:7], v[56:59], v[164:167], a[4:7]
  ds_read_b64_tr_b16 v[52:53], v30 offset:0
  ds_read_b64_tr_b16 v[54:55], v30 offset:4096
  v_mfma_f32_16x16x32_bf16 a[8:11], v[56:59], v[168:171], a[8:11]
  s_add_u32 m0, s42, 57344
  v_mfma_f32_16x16x32_bf16 a[12:15], v[56:59], v[172:175], a[12:15]
  v_exp_f32 v224, v224
  v_mfma_f32_16x16x32_bf16 a[16:19], v[60:63], v[160:163], a[16:19]
  v_exp_f32 v225, v225
  v_mfma_f32_16x16x32_bf16 a[20:23], v[60:63], v[164:167], a[20:23]
  ds_read_b64_tr_b16 v[56:57], v31 offset:0
  ds_read_b64_tr_b16 v[58:59], v31 offset:4096
  v_mfma_f32_16x16x32_bf16 a[24:27], v[60:63], v[168:171], a[24:27]
  s_mov_b32 s39, 57344
  v_mfma_f32_16x16x32_bf16 a[28:31], v[60:63], v[172:175], a[28:31]
  s_waitcnt lgkmcnt(6)
  v_mfma_f32_16x16x32_bf16 a[32:35], v[64:67], v[160:163], a[32:35]
  v_exp_f32 v226, v226
  v_mfma_f32_16x16x32_bf16 a[36:39], v[64:67], v[164:167], a[36:39]
  ds_read_b64_tr_b16 v[60:61], v32 offset:0
  ds_read_b64_tr_b16 v[62:63], v32 offset:4096
  v_mfma_f32_16x16x32_bf16 a[40:43], v[64:67], v[168:171], a[40:43]
  buffer_load_dwordx4 v19, s[24:27], s39 offen lds
  v_mfma_f32_16x16x32_bf16 a[44:47], v[64:67], v[172:175], a[44:47]
  v_exp_f32 v227, v227
  v_mfma_f32_16x16x32_bf16 a[48:51], v[68:71], v[160:163], a[48:51]
  v_exp_f32 v228, v228
  v_mfma_f32_16x16x32_bf16 a[52:55], v[68:71], v[164:167], a[52:55]
  buffer_load_dwordx4 v20, s[24:27], s39 offen offset:1024 lds
  v_mfma_f32_16x16x32_bf16 a[56:59], v[68:71], v[168:171], a[56:59]
  v_exp_f32 v229, v229
  v_mfma_f32_16x16x32_bf16 a[60:63], v[68:71], v[172:175], a[60:63]
  v_exp_f32 v230, v230
  v_mfma_f32_16x16x32_bf16 a[128:131], v[34:37], v[160:163], a[128:131]
  v_exp_f32 v231, v231
  v_mfma_f32_16x16x32_bf16 a[132:135], v[34:37], v[164:167], a[132:135]
  ds_read_b128 v[64:67], v21 offset:16384
  s_add_u32 m0, s42, 8192
  v_mfma_f32_16x16x32_bf16 a[136:139], v[34:37], v[168:171], a[136:139]
  v_cvt_pk_bf16_f32 v176, v224, v225
  v_cvt_pk_bf16_f32 v177, v226, v227
  v_mfma_f32_16x16x32_bf16 a[140:143], v[34:37], v[172:175], a[140:143]
  s_waitcnt lgkmcnt(5)
  v_mfma_f32_16x16x32_bf16 a[64:67], v[48:51], v[160:163], a[64:67]
  v_exp_f32 v232, v232
  v_mfma_f32_16x16x32_bf16 a[68:71], v[48:51], v[164:167], a[68:71]
  ds_read_b128 v[68:71], v22 offset:16384
  s_mov_b32 s39, 73728
  v_mfma_f32_16x16x32_bf16 a[72:75], v[48:51], v[168:171], a[72:75]
  v_exp_f32 v233, v233
  v_mfma_f32_16x16x32_bf16 a[76:79], v[48:51], v[172:175], a[76:79]
  v_exp_f32 v234, v234
  v_mfma_f32_16x16x32_bf16 a[80:83], v[52:55], v[160:163], a[80:83]
  v_exp_f32 v235, v235
  v_mfma_f32_16x16x32_bf16 a[84:87], v[52:55], v[164:167], a[84:87]
  ds_read_b128 v[48:51], v23 offset:16384
  v_cvt_pk_bf16_f32 v180, v228, v229
  v_mfma_f32_16x16x32_bf16 a[88:91], v[52:55], v[168:171], a[88:91]
  buffer_load_dwordx4 v17, s[20:23], s39 offen lds
  v_mfma_f32_16x16x32_bf16 a[92:95], v[52:55], v[172:175], a[92:95]
  v_cvt_pk_bf16_f32 v181, v230, v231
  s_waitcnt lgkmcnt(3)
  v_mfma_f32_16x16x32_bf16 a[96:99], v[56:59], v[160:163], a[96:99]
  v_exp_f32 v236, v236
  v_mfma_f32_16x16x32_bf16 a[100:103], v[56:59], v[164:167], a[100:103]
  ds_read_b128 v[52:55], v24 offset:16384
  v_mfma_f32_16x16x32_bf16 a[104:107], v[56:59], v[168:171], a[104:107]
  buffer_load_dwordx4 v18, s[20:23], s39 offen offset:1024 lds
  v_mfma_f32_16x16x32_bf16 a[108:111], v[56:59], v[172:175], a[108:111]
  v_exp_f32 v237, v237
  v_mfma_f32_16x16x32_bf16 a[112:115], v[60:63], v[160:163], a[112:115]
  v_exp_f32 v238, v238
  v_mfma_f32_16x16x32_bf16 a[116:119], v[60:63], v[164:167], a[116:119]
  ds_read_b128 v[56:59], v21 offset:20480
  v_mfma_f32_16x16x32_bf16 a[120:123], v[60:63], v[168:171], a[120:123]
  v_exp_f32 v239, v239
  v_mfma_f32_16x16x32_bf16 a[124:127], v[60:63], v[172:175], a[124:127]
  v_cvt_pk_bf16_f32 v184, v232, v233
  s_waitcnt lgkmcnt(3)
  v_mfma_f32_16x16x32_bf16 v[192:195], v[64:67], v[80:83], v[144:147]
  v_cvt_pk_bf16_f32 v185, v234, v235
  v_mfma_f32_16x16x32_bf16 v[196:199], v[64:67], v[84:87], v[148:151]
  ds_read_b128 v[60:63], v22 offset:20480
  v_mfma_f32_16x16x32_bf16 v[200:203], v[64:67], v[88:91], v[152:155]
  v_exp_f32 v240, v240
  v_mfma_f32_16x16x32_bf16 v[204:207], v[64:67], v[92:95], v[156:159]
  v_exp_f32 v241, v241
  v_mfma_f32_16x16x32_bf16 v[192:195], v[68:71], v[96:99], v[192:195]
  v_exp_f32 v242, v242
  v_mfma_f32_16x16x32_bf16 v[196:199], v[68:71], v[100:103], v[196:199]
  ds_read_b128 v[64:67], v23 offset:20480
  v_mfma_f32_16x16x32_bf16 v[200:203], v[68:71], v[104:107], v[200:203]
  v_exp_f32 v243, v243
  v_mfma_f32_16x16x32_bf16 v[204:207], v[68:71], v[108:111], v[204:207]
  v_cvt_pk_bf16_f32 v188, v236, v237
  s_waitcnt lgkmcnt(3)
  v_mfma_f32_16x16x32_bf16 v[192:195], v[48:51], v[112:115], v[192:195]
  v_cvt_pk_bf16_f32 v189, v238, v239
  v_mfma_f32_16x16x32_bf16 v[196:199], v[48:51], v[116:119], v[196:199]
  ds_read_b128 v[68:71], v24 offset:20480
  v_mfma_f32_16x16x32_bf16 v[200:203], v[48:51], v[120:123], v[200:203]
  v_exp_f32 v244, v244
  v_mfma_f32_16x16x32_bf16 v[204:207], v[48:51], v[124:127], v[204:207]
  v_exp_f32 v245, v245
  v_mfma_f32_16x16x32_bf16 v[192:195], v[52:55], v[128:131], v[192:195]
  v_exp_f32 v246, v246
  v_mfma_f32_16x16x32_bf16 v[196:199], v[52:55], v[132:135], v[196:199]
  ds_read_b64_tr_b16 v[48:49], v25 offset:8192
  ds_read_b64_tr_b16 v[50:51], v25 offset:12288
  v_mfma_f32_16x16x32_bf16 v[200:203], v[52:55], v[136:139], v[200:203]
  v_exp_f32 v247, v247
  v_mfma_f32_16x16x32_bf16 v[204:207], v[52:55], v[140:143], v[204:207]
  v_cvt_pk_bf16_f32 v178, v240, v241
  s_waitcnt lgkmcnt(4)
  v_mfma_f32_16x16x32_bf16 v[208:211], v[56:59], v[80:83], v[144:147]
  v_cvt_pk_bf16_f32 v179, v242, v243
  v_mfma_f32_16x16x32_bf16 v[212:215], v[56:59], v[84:87], v[148:151]
  ds_read_b64_tr_b16 v[52:53], v26 offset:8192
  ds_read_b64_tr_b16 v[54:55], v26 offset:12288
  v_mfma_f32_16x16x32_bf16 v[216:219], v[56:59], v[88:91], v[152:155]
  v_exp_f32 v248, v248
  v_mfma_f32_16x16x32_bf16 v[220:223], v[56:59], v[92:95], v[156:159]
  v_exp_f32 v249, v249
  v_mfma_f32_16x16x32_bf16 v[208:211], v[60:63], v[96:99], v[208:211]
  v_exp_f32 v250, v250
  v_mfma_f32_16x16x32_bf16 v[212:215], v[60:63], v[100:103], v[212:215]
  ds_read_b64_tr_b16 v[56:57], v27 offset:8192
  ds_read_b64_tr_b16 v[58:59], v27 offset:12288
  v_mfma_f32_16x16x32_bf16 v[216:219], v[60:63], v[104:107], v[216:219]
  v_exp_f32 v251, v251
  v_mfma_f32_16x16x32_bf16 v[220:223], v[60:63], v[108:111], v[220:223]
  v_cvt_pk_bf16_f32 v182, v244, v245
  s_waitcnt lgkmcnt(6)
  v_mfma_f32_16x16x32_bf16 v[208:211], v[64:67], v[112:115], v[208:211]
  v_cvt_pk_bf16_f32 v183, v246, v247
  v_mfma_f32_16x16x32_bf16 v[212:215], v[64:67], v[116:119], v[212:215]
  ds_read_b64_tr_b16 v[60:61], v28 offset:8192
  ds_read_b64_tr_b16 v[62:63], v28 offset:12288
  v_mfma_f32_16x16x32_bf16 v[216:219], v[64:67], v[120:123], v[216:219]
  v_exp_f32 v252, v252
  v_mfma_f32_16x16x32_bf16 v[220:223], v[64:67], v[124:127], v[220:223]
  v_exp_f32 v253, v253
  v_mfma_f32_16x16x32_bf16 v[208:211], v[68:71], v[128:131], v[208:211]
  v_exp_f32 v254, v254
  v_mfma_f32_16x16x32_bf16 v[212:215], v[68:71], v[132:135], v[212:215]
  v_exp_f32 v255, v255
  v_mfma_f32_16x16x32_bf16 v[216:219], v[68:71], v[136:139], v[216:219]
  v_cvt_pk_bf16_f32 v186, v248, v249
  v_cvt_pk_bf16_f32 v187, v250, v251
  v_cvt_pk_bf16_f32 v190, v252, v253
  v_cvt_pk_bf16_f32 v191, v254, v255
  v_mfma_f32_16x16x32_bf16 v[220:223], v[68:71], v[140:143], v[220:223]
  s_waitcnt vmcnt(6)
  s_barrier
  s_waitcnt lgkmcnt(4)
  v_mfma_f32_16x16x32_bf16 a[0:3], v[48:51], v[176:179], a[0:3]
  ds_read_b64_tr_b16 v[64:65], v29 offset:8192
  ds_read_b64_tr_b16 v[66:67], v29 offset:12288
  v_mfma_f32_16x16x32_bf16 a[4:7], v[48:51], v[180:183], a[4:7]
  ds_read_b64_tr_b16 v[68:69], v30 offset:8192
  ds_read_b64_tr_b16 v[70:71], v30 offset:12288
  v_mfma_f32_16x16x32_bf16 a[8:11], v[48:51], v[184:187], a[8:11]
  s_add_u32 m0, s42, 32768
  v_mfma_f32_16x16x32_bf16 a[12:15], v[48:51], v[188:191], a[12:15]
  v_exp_f32 v192, v192
  v_mfma_f32_16x16x32_bf16 a[16:19], v[52:55], v[176:179], a[16:19]
  v_exp_f32 v193, v193
  v_mfma_f32_16x16x32_bf16 a[20:23], v[52:55], v[180:183], a[20:23]
  ds_read_b64_tr_b16 v[48:49], v31 offset:8192
  ds_read_b64_tr_b16 v[50:51], v31 offset:12288
  v_mfma_f32_16x16x32_bf16 a[24:27], v[52:55], v[184:187], a[24:27]
  s_mov_b32 s39, 65536
  v_mfma_f32_16x16x32_bf16 a[28:31], v[52:55], v[188:191], a[28:31]
  s_waitcnt lgkmcnt(6)
  v_mfma_f32_16x16x32_bf16 a[32:35], v[56:59], v[176:179], a[32:35]
  v_exp_f32 v194, v194
  v_mfma_f32_16x16x32_bf16 a[36:39], v[56:59], v[180:183], a[36:39]
  ds_read_b64_tr_b16 v[52:53], v32 offset:8192
  ds_read_b64_tr_b16 v[54:55], v32 offset:12288
  v_mfma_f32_16x16x32_bf16 a[40:43], v[56:59], v[184:187], a[40:43]
  buffer_load_dwordx4 v19, s[24:27], s39 offen lds
  v_mfma_f32_16x16x32_bf16 a[44:47], v[56:59], v[188:191], a[44:47]
  v_exp_f32 v195, v195
  v_mfma_f32_16x16x32_bf16 a[48:51], v[60:63], v[176:179], a[48:51]
  v_exp_f32 v196, v196
  v_mfma_f32_16x16x32_bf16 a[52:55], v[60:63], v[180:183], a[52:55]
  buffer_load_dwordx4 v20, s[24:27], s39 offen offset:1024 lds
  v_mfma_f32_16x16x32_bf16 a[56:59], v[60:63], v[184:187], a[56:59]
  v_exp_f32 v197, v197
  v_mfma_f32_16x16x32_bf16 a[60:63], v[60:63], v[188:191], a[60:63]
  v_exp_f32 v198, v198
  v_mfma_f32_16x16x32_bf16 a[128:131], v[34:37], v[176:179], a[128:131]
  v_exp_f32 v199, v199
  v_mfma_f32_16x16x32_bf16 a[132:135], v[34:37], v[180:183], a[132:135]
  ds_read_b128 v[56:59], v21 offset:24576
  s_add_u32 m0, s42, 16384
  v_mfma_f32_16x16x32_bf16 a[136:139], v[34:37], v[184:187], a[136:139]
  v_cvt_pk_bf16_f32 v160, v192, v193
  v_cvt_pk_bf16_f32 v161, v194, v195
  v_mfma_f32_16x16x32_bf16 a[140:143], v[34:37], v[188:191], a[140:143]
  s_waitcnt lgkmcnt(5)
  v_mfma_f32_16x16x32_bf16 a[64:67], v[64:67], v[176:179], a[64:67]
  v_exp_f32 v200, v200
  v_mfma_f32_16x16x32_bf16 a[68:71], v[64:67], v[180:183], a[68:71]
  ds_read_b128 v[60:63], v22 offset:24576
  s_mov_b32 s39, 81920
  v_mfma_f32_16x16x32_bf16 a[72:75], v[64:67], v[184:187], a[72:75]
  v_exp_f32 v201, v201
  v_mfma_f32_16x16x32_bf16 a[76:79], v[64:67], v[188:191], a[76:79]
  v_exp_f32 v202, v202
  v_mfma_f32_16x16x32_bf16 a[80:83], v[68:71], v[176:179], a[80:83]
  v_exp_f32 v203, v203
  v_mfma_f32_16x16x32_bf16 a[84:87], v[68:71], v[180:183], a[84:87]
  ds_read_b128 v[64:67], v23 offset:24576
  v_cvt_pk_bf16_f32 v164, v196, v197
  v_mfma_f32_16x16x32_bf16 a[88:91], v[68:71], v[184:187], a[88:91]
  buffer_load_dwordx4 v17, s[20:23], s39 offen lds
  v_mfma_f32_16x16x32_bf16 a[92:95], v[68:71], v[188:191], a[92:95]
  v_cvt_pk_bf16_f32 v165, v198, v199
  s_waitcnt lgkmcnt(3)
  v_mfma_f32_16x16x32_bf16 a[96:99], v[48:51], v[176:179], a[96:99]
  v_exp_f32 v204, v204
  v_mfma_f32_16x16x32_bf16 a[100:103], v[48:51], v[180:183], a[100:103]
  ds_read_b128 v[68:71], v24 offset:24576
  v_mfma_f32_16x16x32_bf16 a[104:107], v[48:51], v[184:187], a[104:107]
  buffer_load_dwordx4 v18, s[20:23], s39 offen offset:1024 lds
  v_mfma_f32_16x16x32_bf16 a[108:111], v[48:51], v[188:191], a[108:111]
  v_exp_f32 v205, v205
  v_mfma_f32_16x16x32_bf16 a[112:115], v[52:55], v[176:179], a[112:115]
  v_exp_f32 v206, v206
  v_mfma_f32_16x16x32_bf16 a[116:119], v[52:55], v[180:183], a[116:119]
  ds_read_b128 v[48:51], v21 offset:28672
  v_mfma_f32_16x16x32_bf16 a[120:123], v[52:55], v[184:187], a[120:123]
  v_exp_f32 v207, v207
  v_mfma_f32_16x16x32_bf16 a[124:127], v[52:55], v[188:191], a[124:127]
  v_cvt_pk_bf16_f32 v168, v200, v201
  s_waitcnt lgkmcnt(3)
  v_mfma_f32_16x16x32_bf16 v[224:227], v[56:59], v[80:83], v[144:147]
  v_cvt_pk_bf16_f32 v169, v202, v203
  v_mfma_f32_16x16x32_bf16 v[228:231], v[56:59], v[84:87], v[148:151]
  ds_read_b128 v[52:55], v22 offset:28672
  v_mfma_f32_16x16x32_bf16 v[232:235], v[56:59], v[88:91], v[152:155]
  v_exp_f32 v208, v208
  v_mfma_f32_16x16x32_bf16 v[236:239], v[56:59], v[92:95], v[156:159]
  v_exp_f32 v209, v209
  v_mfma_f32_16x16x32_bf16 v[224:227], v[60:63], v[96:99], v[224:227]
  v_exp_f32 v210, v210
  v_mfma_f32_16x16x32_bf16 v[228:231], v[60:63], v[100:103], v[228:231]
  ds_read_b128 v[56:59], v23 offset:28672
  v_mfma_f32_16x16x32_bf16 v[232:235], v[60:63], v[104:107], v[232:235]
  v_exp_f32 v211, v211
  v_mfma_f32_16x16x32_bf16 v[236:239], v[60:63], v[108:111], v[236:239]
  v_cvt_pk_bf16_f32 v172, v204, v205
  s_waitcnt lgkmcnt(3)
  v_mfma_f32_16x16x32_bf16 v[224:227], v[64:67], v[112:115], v[224:227]
  v_cvt_pk_bf16_f32 v173, v206, v207
  v_mfma_f32_16x16x32_bf16 v[228:231], v[64:67], v[116:119], v[228:231]
  ds_read_b128 v[60:63], v24 offset:28672
  v_mfma_f32_16x16x32_bf16 v[232:235], v[64:67], v[120:123], v[232:235]
  v_exp_f32 v212, v212
  v_mfma_f32_16x16x32_bf16 v[236:239], v[64:67], v[124:127], v[236:239]
  v_exp_f32 v213, v213
  v_mfma_f32_16x16x32_bf16 v[224:227], v[68:71], v[128:131], v[224:227]
  v_exp_f32 v214, v214
  v_mfma_f32_16x16x32_bf16 v[228:231], v[68:71], v[132:135], v[228:231]
  ds_read_b64_tr_b16 v[64:65], v25 offset:16384
  ds_read_b64_tr_b16 v[66:67], v25 offset:20480
  v_mfma_f32_16x16x32_bf16 v[232:235], v[68:71], v[136:139], v[232:235]
  v_exp_f32 v215, v215
  v_mfma_f32_16x16x32_bf16 v[236:239], v[68:71], v[140:143], v[236:239]
  v_cvt_pk_bf16_f32 v162, v208, v209
  s_waitcnt lgkmcnt(4)
  v_mfma_f32_16x16x32_bf16 v[240:243], v[48:51], v[80:83], v[144:147]
  v_cvt_pk_bf16_f32 v163, v210, v211
  v_mfma_f32_16x16x32_bf16 v[244:247], v[48:51], v[84:87], v[148:151]
  ds_read_b64_tr_b16 v[68:69], v26 offset:16384
  ds_read_b64_tr_b16 v[70:71], v26 offset:20480
  v_mfma_f32_16x16x32_bf16 v[248:251], v[48:51], v[88:91], v[152:155]
  v_exp_f32 v216, v216
  v_mfma_f32_16x16x32_bf16 v[252:255], v[48:51], v[92:95], v[156:159]
  v_exp_f32 v217, v217
  v_mfma_f32_16x16x32_bf16 v[240:243], v[52:55], v[96:99], v[240:243]
  v_exp_f32 v218, v218
  v_mfma_f32_16x16x32_bf16 v[244:247], v[52:55], v[100:103], v[244:247]
  ds_read_b64_tr_b16 v[48:49], v27 offset:16384
  ds_read_b64_tr_b16 v[50:51], v27 offset:20480
  v_mfma_f32_16x16x32_bf16 v[248:251], v[52:55], v[104:107], v[248:251]
  v_exp_f32 v219, v219
  v_mfma_f32_16x16x32_bf16 v[252:255], v[52:55], v[108:111], v[252:255]
  v_cvt_pk_bf16_f32 v166, v212, v213
  s_waitcnt lgkmcnt(6)
  v_mfma_f32_16x16x32_bf16 v[240:243], v[56:59], v[112:115], v[240:243]
  v_cvt_pk_bf16_f32 v167, v214, v215
  v_mfma_f32_16x16x32_bf16 v[244:247], v[56:59], v[116:119], v[244:247]
  ds_read_b64_tr_b16 v[52:53], v28 offset:16384
  ds_read_b64_tr_b16 v[54:55], v28 offset:20480
  v_mfma_f32_16x16x32_bf16 v[248:251], v[56:59], v[120:123], v[248:251]
  v_exp_f32 v220, v220
  v_mfma_f32_16x16x32_bf16 v[252:255], v[56:59], v[124:127], v[252:255]
  v_exp_f32 v221, v221
  v_mfma_f32_16x16x32_bf16 v[240:243], v[60:63], v[128:131], v[240:243]
  v_exp_f32 v222, v222
  v_mfma_f32_16x16x32_bf16 v[244:247], v[60:63], v[132:135], v[244:247]
  v_exp_f32 v223, v223
  v_mfma_f32_16x16x32_bf16 v[248:251], v[60:63], v[136:139], v[248:251]
  v_cvt_pk_bf16_f32 v170, v216, v217
  v_cvt_pk_bf16_f32 v171, v218, v219
  v_cvt_pk_bf16_f32 v174, v220, v221
  v_cvt_pk_bf16_f32 v175, v222, v223
  v_mfma_f32_16x16x32_bf16 v[252:255], v[60:63], v[140:143], v[252:255]
  s_waitcnt vmcnt(6)
  s_barrier
  s_waitcnt lgkmcnt(4)
  v_mfma_f32_16x16x32_bf16 a[0:3], v[64:67], v[160:163], a[0:3]
  ds_read_b64_tr_b16 v[56:57], v29 offset:16384
  ds_read_b64_tr_b16 v[58:59], v29 offset:20480
  v_mfma_f32_16x16x32_bf16 a[4:7], v[64:67], v[164:167], a[4:7]
  ds_read_b64_tr_b16 v[60:61], v30 offset:16384
  ds_read_b64_tr_b16 v[62:63], v30 offset:20480
  v_mfma_f32_16x16x32_bf16 a[8:11], v[64:67], v[168:171], a[8:11]
  s_add_u32 m0, s42, 40960
  v_mfma_f32_16x16x32_bf16 a[12:15], v[64:67], v[172:175], a[12:15]
  v_exp_f32 v224, v224
  v_mfma_f32_16x16x32_bf16 a[16:19], v[68:71], v[160:163], a[16:19]
  v_exp_f32 v225, v225
  v_mfma_f32_16x16x32_bf16 a[20:23], v[68:71], v[164:167], a[20:23]
  ds_read_b64_tr_b16 v[64:65], v31 offset:16384
  ds_read_b64_tr_b16 v[66:67], v31 offset:20480
  v_mfma_f32_16x16x32_bf16 a[24:27], v[68:71], v[168:171], a[24:27]
  s_mov_b32 s39, 73728
  v_mfma_f32_16x16x32_bf16 a[28:31], v[68:71], v[172:175], a[28:31]
  s_waitcnt lgkmcnt(6)
  v_mfma_f32_16x16x32_bf16 a[32:35], v[48:51], v[160:163], a[32:35]
  v_exp_f32 v226, v226
  v_mfma_f32_16x16x32_bf16 a[36:39], v[48:51], v[164:167], a[36:39]
  ds_read_b64_tr_b16 v[68:69], v32 offset:16384
  ds_read_b64_tr_b16 v[70:71], v32 offset:20480
  v_mfma_f32_16x16x32_bf16 a[40:43], v[48:51], v[168:171], a[40:43]
  buffer_load_dwordx4 v19, s[24:27], s39 offen lds
  v_mfma_f32_16x16x32_bf16 a[44:47], v[48:51], v[172:175], a[44:47]
  v_exp_f32 v227, v227
  v_mfma_f32_16x16x32_bf16 a[48:51], v[52:55], v[160:163], a[48:51]
  v_exp_f32 v228, v228
  v_mfma_f32_16x16x32_bf16 a[52:55], v[52:55], v[164:167], a[52:55]
  buffer_load_dwordx4 v20, s[24:27], s39 offen offset:1024 lds
  v_mfma_f32_16x16x32_bf16 a[56:59], v[52:55], v[168:171], a[56:59]
  v_exp_f32 v229, v229
  v_mfma_f32_16x16x32_bf16 a[60:63], v[52:55], v[172:175], a[60:63]
  v_exp_f32 v230, v230
  v_mfma_f32_16x16x32_bf16 a[128:131], v[34:37], v[160:163], a[128:131]
  v_exp_f32 v231, v231
  v_mfma_f32_16x16x32_bf16 a[132:135], v[34:37], v[164:167], a[132:135]
  ds_read_b128 v[48:51], v21 offset:0
  s_add_u32 m0, s42, 24576
  v_mfma_f32_16x16x32_bf16 a[136:139], v[34:37], v[168:171], a[136:139]
  v_cvt_pk_bf16_f32 v176, v224, v225
  v_cvt_pk_bf16_f32 v177, v226, v227
  v_mfma_f32_16x16x32_bf16 a[140:143], v[34:37], v[172:175], a[140:143]
  s_waitcnt lgkmcnt(5)
  v_mfma_f32_16x16x32_bf16 a[64:67], v[56:59], v[160:163], a[64:67]
  v_exp_f32 v232, v232
  v_mfma_f32_16x16x32_bf16 a[68:71], v[56:59], v[164:167], a[68:71]
  ds_read_b128 v[52:55], v22 offset:0
  s_mov_b32 s39, 90112
  v_mfma_f32_16x16x32_bf16 a[72:75], v[56:59], v[168:171], a[72:75]
  v_exp_f32 v233, v233
  v_mfma_f32_16x16x32_bf16 a[76:79], v[56:59], v[172:175], a[76:79]
  v_exp_f32 v234, v234
  v_mfma_f32_16x16x32_bf16 a[80:83], v[60:63], v[160:163], a[80:83]
  v_exp_f32 v235, v235
  v_mfma_f32_16x16x32_bf16 a[84:87], v[60:63], v[164:167], a[84:87]
  ds_read_b128 v[56:59], v23 offset:0
  v_cvt_pk_bf16_f32 v180, v228, v229
  v_mfma_f32_16x16x32_bf16 a[88:91], v[60:63], v[168:171], a[88:91]
  buffer_load_dwordx4 v17, s[20:23], s39 offen lds
  v_mfma_f32_16x16x32_bf16 a[92:95], v[60:63], v[172:175], a[92:95]
  v_cvt_pk_bf16_f32 v181, v230, v231
  s_waitcnt lgkmcnt(3)
  v_mfma_f32_16x16x32_bf16 a[96:99], v[64:67], v[160:163], a[96:99]
  v_exp_f32 v236, v236
  v_mfma_f32_16x16x32_bf16 a[100:103], v[64:67], v[164:167], a[100:103]
  ds_read_b128 v[60:63], v24 offset:0
  v_mfma_f32_16x16x32_bf16 a[104:107], v[64:67], v[168:171], a[104:107]
  buffer_load_dwordx4 v18, s[20:23], s39 offen offset:1024 lds
  v_mfma_f32_16x16x32_bf16 a[108:111], v[64:67], v[172:175], a[108:111]
  v_exp_f32 v237, v237
  v_mfma_f32_16x16x32_bf16 a[112:115], v[68:71], v[160:163], a[112:115]
  v_exp_f32 v238, v238
  v_mfma_f32_16x16x32_bf16 a[116:119], v[68:71], v[164:167], a[116:119]
  ds_read_b128 v[64:67], v21 offset:4096
  v_mfma_f32_16x16x32_bf16 a[120:123], v[68:71], v[168:171], a[120:123]
  v_exp_f32 v239, v239
  v_mfma_f32_16x16x32_bf16 a[124:127], v[68:71], v[172:175], a[124:127]
  v_cvt_pk_bf16_f32 v184, v232, v233
  s_waitcnt lgkmcnt(3)
  v_mfma_f32_16x16x32_bf16 v[192:195], v[48:51], v[80:83], v[144:147]
  v_cvt_pk_bf16_f32 v185, v234, v235
  v_mfma_f32_16x16x32_bf16 v[196:199], v[48:51], v[84:87], v[148:151]
  ds_read_b128 v[68:71], v22 offset:4096
  v_mfma_f32_16x16x32_bf16 v[200:203], v[48:51], v[88:91], v[152:155]
  v_exp_f32 v240, v240
  v_mfma_f32_16x16x32_bf16 v[204:207], v[48:51], v[92:95], v[156:159]
  v_exp_f32 v241, v241
  v_mfma_f32_16x16x32_bf16 v[192:195], v[52:55], v[96:99], v[192:195]
  v_exp_f32 v242, v242
  v_mfma_f32_16x16x32_bf16 v[196:199], v[52:55], v[100:103], v[196:199]
  ds_read_b128 v[48:51], v23 offset:4096
  v_mfma_f32_16x16x32_bf16 v[200:203], v[52:55], v[104:107], v[200:203]
  v_exp_f32 v243, v243
  v_mfma_f32_16x16x32_bf16 v[204:207], v[52:55], v[108:111], v[204:207]
  v_cvt_pk_bf16_f32 v188, v236, v237
  s_waitcnt lgkmcnt(3)
  v_mfma_f32_16x16x32_bf16 v[192:195], v[56:59], v[112:115], v[192:195]
  v_cvt_pk_bf16_f32 v189, v238, v239
  v_mfma_f32_16x16x32_bf16 v[196:199], v[56:59], v[116:119], v[196:199]
  ds_read_b128 v[52:55], v24 offset:4096
  v_mfma_f32_16x16x32_bf16 v[200:203], v[56:59], v[120:123], v[200:203]
  v_exp_f32 v244, v244
  v_mfma_f32_16x16x32_bf16 v[204:207], v[56:59], v[124:127], v[204:207]
  v_exp_f32 v245, v245
  v_mfma_f32_16x16x32_bf16 v[192:195], v[60:63], v[128:131], v[192:195]
  v_exp_f32 v246, v246
  v_mfma_f32_16x16x32_bf16 v[196:199], v[60:63], v[132:135], v[196:199]
  ds_read_b64_tr_b16 v[56:57], v25 offset:24576
  ds_read_b64_tr_b16 v[58:59], v25 offset:28672
  v_mfma_f32_16x16x32_bf16 v[200:203], v[60:63], v[136:139], v[200:203]
  v_exp_f32 v247, v247
  v_mfma_f32_16x16x32_bf16 v[204:207], v[60:63], v[140:143], v[204:207]
  v_cvt_pk_bf16_f32 v178, v240, v241
  s_waitcnt lgkmcnt(4)
  v_mfma_f32_16x16x32_bf16 v[208:211], v[64:67], v[80:83], v[144:147]
  v_cvt_pk_bf16_f32 v179, v242, v243
  v_mfma_f32_16x16x32_bf16 v[212:215], v[64:67], v[84:87], v[148:151]
  ds_read_b64_tr_b16 v[60:61], v26 offset:24576
  ds_read_b64_tr_b16 v[62:63], v26 offset:28672
  v_mfma_f32_16x16x32_bf16 v[216:219], v[64:67], v[88:91], v[152:155]
  v_exp_f32 v248, v248
  v_mfma_f32_16x16x32_bf16 v[220:223], v[64:67], v[92:95], v[156:159]
  v_exp_f32 v249, v249
  v_mfma_f32_16x16x32_bf16 v[208:211], v[68:71], v[96:99], v[208:211]
  v_exp_f32 v250, v250
  v_mfma_f32_16x16x32_bf16 v[212:215], v[68:71], v[100:103], v[212:215]
  ds_read_b64_tr_b16 v[64:65], v27 offset:24576
  ds_read_b64_tr_b16 v[66:67], v27 offset:28672
  v_mfma_f32_16x16x32_bf16 v[216:219], v[68:71], v[104:107], v[216:219]
  v_exp_f32 v251, v251
  v_mfma_f32_16x16x32_bf16 v[220:223], v[68:71], v[108:111], v[220:223]
  v_cvt_pk_bf16_f32 v182, v244, v245
  s_waitcnt lgkmcnt(6)
  v_mfma_f32_16x16x32_bf16 v[208:211], v[48:51], v[112:115], v[208:211]
  v_cvt_pk_bf16_f32 v183, v246, v247
  v_mfma_f32_16x16x32_bf16 v[212:215], v[48:51], v[116:119], v[212:215]
  ds_read_b64_tr_b16 v[68:69], v28 offset:24576
  ds_read_b64_tr_b16 v[70:71], v28 offset:28672
  v_mfma_f32_16x16x32_bf16 v[216:219], v[48:51], v[120:123], v[216:219]
  v_exp_f32 v252, v252
  v_mfma_f32_16x16x32_bf16 v[220:223], v[48:51], v[124:127], v[220:223]
  v_exp_f32 v253, v253
  v_mfma_f32_16x16x32_bf16 v[208:211], v[52:55], v[128:131], v[208:211]
  v_exp_f32 v254, v254
  v_mfma_f32_16x16x32_bf16 v[212:215], v[52:55], v[132:135], v[212:215]
  v_exp_f32 v255, v255
  v_mfma_f32_16x16x32_bf16 v[216:219], v[52:55], v[136:139], v[216:219]
  v_cvt_pk_bf16_f32 v186, v248, v249
  v_cvt_pk_bf16_f32 v187, v250, v251
  v_cvt_pk_bf16_f32 v190, v252, v253
  v_cvt_pk_bf16_f32 v191, v254, v255
  v_mfma_f32_16x16x32_bf16 v[220:223], v[52:55], v[140:143], v[220:223]
  s_waitcnt vmcnt(6)
  s_barrier
  s_waitcnt lgkmcnt(4)
  v_mfma_f32_16x16x32_bf16 a[0:3], v[56:59], v[176:179], a[0:3]
  ds_read_b64_tr_b16 v[48:49], v29 offset:24576
  ds_read_b64_tr_b16 v[50:51], v29 offset:28672
  v_mfma_f32_16x16x32_bf16 a[4:7], v[56:59], v[180:183], a[4:7]
  ds_read_b64_tr_b16 v[52:53], v30 offset:24576
  ds_read_b64_tr_b16 v[54:55], v30 offset:28672
  v_mfma_f32_16x16x32_bf16 a[8:11], v[56:59], v[184:187], a[8:11]
  s_add_u32 m0, s42, 49152
  v_mfma_f32_16x16x32_bf16 a[12:15], v[56:59], v[188:191], a[12:15]
  v_exp_f32 v192, v192
  v_mfma_f32_16x16x32_bf16 a[16:19], v[60:63], v[176:179], a[16:19]
  v_exp_f32 v193, v193
  v_mfma_f32_16x16x32_bf16 a[20:23], v[60:63], v[180:183], a[20:23]
  ds_read_b64_tr_b16 v[56:57], v31 offset:24576
  ds_read_b64_tr_b16 v[58:59], v31 offset:28672
  v_mfma_f32_16x16x32_bf16 a[24:27], v[60:63], v[184:187], a[24:27]
  s_mov_b32 s39, 81920
  v_mfma_f32_16x16x32_bf16 a[28:31], v[60:63], v[188:191], a[28:31]
  s_waitcnt lgkmcnt(6)
  v_mfma_f32_16x16x32_bf16 a[32:35], v[64:67], v[176:179], a[32:35]
  v_exp_f32 v194, v194
  v_mfma_f32_16x16x32_bf16 a[36:39], v[64:67], v[180:183], a[36:39]
  ds_read_b64_tr_b16 v[60:61], v32 offset:24576
  ds_read_b64_tr_b16 v[62:63], v32 offset:28672
  v_mfma_f32_16x16x32_bf16 a[40:43], v[64:67], v[184:187], a[40:43]
  buffer_load_dwordx4 v19, s[24:27], s39 offen lds
  v_mfma_f32_16x16x32_bf16 a[44:47], v[64:67], v[188:191], a[44:47]
  v_exp_f32 v195, v195
  v_mfma_f32_16x16x32_bf16 a[48:51], v[68:71], v[176:179], a[48:51]
  v_exp_f32 v196, v196
  v_mfma_f32_16x16x32_bf16 a[52:55], v[68:71], v[180:183], a[52:55]
  buffer_load_dwordx4 v20, s[24:27], s39 offen offset:1024 lds
  v_mfma_f32_16x16x32_bf16 a[56:59], v[68:71], v[184:187], a[56:59]
  v_exp_f32 v197, v197
  v_mfma_f32_16x16x32_bf16 a[60:63], v[68:71], v[188:191], a[60:63]
  v_exp_f32 v198, v198
  v_mfma_f32_16x16x32_bf16 a[128:131], v[34:37], v[176:179], a[128:131]
  v_exp_f32 v199, v199
  v_mfma_f32_16x16x32_bf16 a[132:135], v[34:37], v[180:183], a[132:135]
  ds_read_b128 v[64:67], v21 offset:8192
  s_add_u32 m0, s42, 0
  v_mfma_f32_16x16x32_bf16 a[136:139], v[34:37], v[184:187], a[136:139]
  v_cvt_pk_bf16_f32 v160, v192, v193
  v_cvt_pk_bf16_f32 v161, v194, v195
  v_mfma_f32_16x16x32_bf16 a[140:143], v[34:37], v[188:191], a[140:143]
  s_waitcnt lgkmcnt(5)
  v_mfma_f32_16x16x32_bf16 a[64:67], v[48:51], v[176:179], a[64:67]
  v_exp_f32 v200, v200
  v_mfma_f32_16x16x32_bf16 a[68:71], v[48:51], v[180:183], a[68:71]
  ds_read_b128 v[68:71], v22 offset:8192
  s_mov_b32 s39, 98304
  v_mfma_f32_16x16x32_bf16 a[72:75], v[48:51], v[184:187], a[72:75]
  v_exp_f32 v201, v201
  v_mfma_f32_16x16x32_bf16 a[76:79], v[48:51], v[188:191], a[76:79]
  v_exp_f32 v202, v202
  v_mfma_f32_16x16x32_bf16 a[80:83], v[52:55], v[176:179], a[80:83]
  v_exp_f32 v203, v203
  v_mfma_f32_16x16x32_bf16 a[84:87], v[52:55], v[180:183], a[84:87]
  ds_read_b128 v[48:51], v23 offset:8192
  v_cvt_pk_bf16_f32 v164, v196, v197
  v_mfma_f32_16x16x32_bf16 a[88:91], v[52:55], v[184:187], a[88:91]
  buffer_load_dwordx4 v17, s[20:23], s39 offen lds
  v_mfma_f32_16x16x32_bf16 a[92:95], v[52:55], v[188:191], a[92:95]
  v_cvt_pk_bf16_f32 v165, v198, v199
  s_waitcnt lgkmcnt(3)
  v_mfma_f32_16x16x32_bf16 a[96:99], v[56:59], v[176:179], a[96:99]
  v_exp_f32 v204, v204
  v_mfma_f32_16x16x32_bf16 a[100:103], v[56:59], v[180:183], a[100:103]
  ds_read_b128 v[52:55], v24 offset:8192
  v_mfma_f32_16x16x32_bf16 a[104:107], v[56:59], v[184:187], a[104:107]
  buffer_load_dwordx4 v18, s[20:23], s39 offen offset:1024 lds
  v_mfma_f32_16x16x32_bf16 a[108:111], v[56:59], v[188:191], a[108:111]
  v_exp_f32 v205, v205
  v_mfma_f32_16x16x32_bf16 a[112:115], v[60:63], v[176:179], a[112:115]
  v_exp_f32 v206, v206
  v_mfma_f32_16x16x32_bf16 a[116:119], v[60:63], v[180:183], a[116:119]
  ds_read_b128 v[56:59], v21 offset:12288
  v_mfma_f32_16x16x32_bf16 a[120:123], v[60:63], v[184:187], a[120:123]
  v_exp_f32 v207, v207
  v_mfma_f32_16x16x32_bf16 a[124:127], v[60:63], v[188:191], a[124:127]
  v_cvt_pk_bf16_f32 v168, v200, v201
  s_waitcnt lgkmcnt(3)
  v_mfma_f32_16x16x32_bf16 v[224:227], v[64:67], v[80:83], v[144:147]
  v_cvt_pk_bf16_f32 v169, v202, v203
  v_mfma_f32_16x16x32_bf16 v[228:231], v[64:67], v[84:87], v[148:151]
  ds_read_b128 v[60:63], v22 offset:12288
  v_mfma_f32_16x16x32_bf16 v[232:235], v[64:67], v[88:91], v[152:155]
  v_exp_f32 v208, v208
  v_mfma_f32_16x16x32_bf16 v[236:239], v[64:67], v[92:95], v[156:159]
  v_exp_f32 v209, v209
  v_mfma_f32_16x16x32_bf16 v[224:227], v[68:71], v[96:99], v[224:227]
  v_exp_f32 v210, v210
  v_mfma_f32_16x16x32_bf16 v[228:231], v[68:71], v[100:103], v[228:231]
  ds_read_b128 v[64:67], v23 offset:12288
  v_mfma_f32_16x16x32_bf16 v[232:235], v[68:71], v[104:107], v[232:235]
  v_exp_f32 v211, v211
  v_mfma_f32_16x16x32_bf16 v[236:239], v[68:71], v[108:111], v[236:239]
  v_cvt_pk_bf16_f32 v172, v204, v205
  s_waitcnt lgkmcnt(3)
  v_mfma_f32_16x16x32_bf16 v[224:227], v[48:51], v[112:115], v[224:227]
  v_cvt_pk_bf16_f32 v173, v206, v207
  v_mfma_f32_16x16x32_bf16 v[228:231], v[48:51], v[116:119], v[228:231]
  ds_read_b128 v[68:71], v24 offset:12288
  v_mfma_f32_16x16x32_bf16 v[232:235], v[48:51], v[120:123], v[232:235]
  v_exp_f32 v212, v212
  v_mfma_f32_16x16x32_bf16 v[236:239], v[48:51], v[124:127], v[236:239]
  v_exp_f32 v213, v213
  v_mfma_f32_16x16x32_bf16 v[224:227], v[52:55], v[128:131], v[224:227]
  v_exp_f32 v214, v214
  v_mfma_f32_16x16x32_bf16 v[228:231], v[52:55], v[132:135], v[228:231]
  ds_read_b64_tr_b16 v[48:49], v25 offset:0
  ds_read_b64_tr_b16 v[50:51], v25 offset:4096
  v_mfma_f32_16x16x32_bf16 v[232:235], v[52:55], v[136:139], v[232:235]
  v_exp_f32 v215, v215
  v_mfma_f32_16x16x32_bf16 v[236:239], v[52:55], v[140:143], v[236:239]
  v_cvt_pk_bf16_f32 v162, v208, v209
  s_waitcnt lgkmcnt(4)
  v_mfma_f32_16x16x32_bf16 v[240:243], v[56:59], v[80:83], v[144:147]
  v_cvt_pk_bf16_f32 v163, v210, v211
  v_mfma_f32_16x16x32_bf16 v[244:247], v[56:59], v[84:87], v[148:151]
  ds_read_b64_tr_b16 v[52:53], v26 offset:0
  ds_read_b64_tr_b16 v[54:55], v26 offset:4096
  v_mfma_f32_16x16x32_bf16 v[248:251], v[56:59], v[88:91], v[152:155]
  v_exp_f32 v216, v216
  v_mfma_f32_16x16x32_bf16 v[252:255], v[56:59], v[92:95], v[156:159]
  v_exp_f32 v217, v217
  v_mfma_f32_16x16x32_bf16 v[240:243], v[60:63], v[96:99], v[240:243]
  v_exp_f32 v218, v218
  v_mfma_f32_16x16x32_bf16 v[244:247], v[60:63], v[100:103], v[244:247]
  ds_read_b64_tr_b16 v[56:57], v27 offset:0
  ds_read_b64_tr_b16 v[58:59], v27 offset:4096
  v_mfma_f32_16x16x32_bf16 v[248:251], v[60:63], v[104:107], v[248:251]
  v_exp_f32 v219, v219
  v_mfma_f32_16x16x32_bf16 v[252:255], v[60:63], v[108:111], v[252:255]
  v_cvt_pk_bf16_f32 v166, v212, v213
  s_waitcnt lgkmcnt(6)
  v_mfma_f32_16x16x32_bf16 v[240:243], v[64:67], v[112:115], v[240:243]
  v_cvt_pk_bf16_f32 v167, v214, v215
  v_mfma_f32_16x16x32_bf16 v[244:247], v[64:67], v[116:119], v[244:247]
  ds_read_b64_tr_b16 v[60:61], v28 offset:0
  ds_read_b64_tr_b16 v[62:63], v28 offset:4096
  v_mfma_f32_16x16x32_bf16 v[248:251], v[64:67], v[120:123], v[248:251]
  v_exp_f32 v220, v220
  v_mfma_f32_16x16x32_bf16 v[252:255], v[64:67], v[124:127], v[252:255]
  v_exp_f32 v221, v221
  v_mfma_f32_16x16x32_bf16 v[240:243], v[68:71], v[128:131], v[240:243]
  v_exp_f32 v222, v222
  v_mfma_f32_16x16x32_bf16 v[244:247], v[68:71], v[132:135], v[244:247]
  v_exp_f32 v223, v223
  v_mfma_f32_16x16x32_bf16 v[248:251], v[68:71], v[136:139], v[248:251]
  v_cvt_pk_bf16_f32 v170, v216, v217
  v_cvt_pk_bf16_f32 v171, v218, v219
  v_cvt_pk_bf16_f32 v174, v220, v221
  v_cvt_pk_bf16_f32 v175, v222, v223
  v_mfma_f32_16x16x32_bf16 v[252:255], v[68:71], v[140:143], v[252:255]
  s_waitcnt vmcnt(6)
  s_barrier
  s_waitcnt lgkmcnt(4)
  v_mfma_f32_16x16x32_bf16 a[0:3], v[48:51], v[160:163], a[0:3]
  ds_read_b64_tr_b16 v[64:65], v29 offset:0
  ds_read_b64_tr_b16 v[66:67], v29 offset:4096
  v_mfma_f32_16x16x32_bf16 a[4:7], v[48:51], v[164:167], a[4:7]
  ds_read_b64_tr_b16 v[68:69], v30 offset:0
  ds_read_b64_tr_b16 v[70:71], v30 offset:4096
  v_mfma_f32_16x16x32_bf16 a[8:11], v[48:51], v[168:171], a[8:11]
  s_add_u32 m0, s42, 57344
  v_mfma_f32_16x16x32_bf16 a[12:15], v[48:51], v[172:175], a[12:15]
  v_exp_f32 v224, v224
  v_mfma_f32_16x16x32_bf16 a[16:19], v[52:55], v[160:163], a[16:19]
  v_exp_f32 v225, v225
  v_mfma_f32_16x16x32_bf16 a[20:23], v[52:55], v[164:167], a[20:23]
  ds_read_b64_tr_b16 v[48:49], v31 offset:0
  ds_read_b64_tr_b16 v[50:51], v31 offset:4096
  v_mfma_f32_16x16x32_bf16 a[24:27], v[52:55], v[168:171], a[24:27]
  s_mov_b32 s39, 90112
  v_mfma_f32_16x16x32_bf16 a[28:31], v[52:55], v[172:175], a[28:31]
  s_waitcnt lgkmcnt(6)
  v_mfma_f32_16x16x32_bf16 a[32:35], v[56:59], v[160:163], a[32:35]
  v_exp_f32 v226, v226
  v_mfma_f32_16x16x32_bf16 a[36:39], v[56:59], v[164:167], a[36:39]
  ds_read_b64_tr_b16 v[52:53], v32 offset:0
  ds_read_b64_tr_b16 v[54:55], v32 offset:4096
  v_mfma_f32_16x16x32_bf16 a[40:43], v[56:59], v[168:171], a[40:43]
  buffer_load_dwordx4 v19, s[24:27], s39 offen lds
  v_mfma_f32_16x16x32_bf16 a[44:47], v[56:59], v[172:175], a[44:47]
  v_exp_f32 v227, v227
  v_mfma_f32_16x16x32_bf16 a[48:51], v[60:63], v[160:163], a[48:51]
  v_exp_f32 v228, v228
  v_mfma_f32_16x16x32_bf16 a[52:55], v[60:63], v[164:167], a[52:55]
  buffer_load_dwordx4 v20, s[24:27], s39 offen offset:1024 lds
  v_mfma_f32_16x16x32_bf16 a[56:59], v[60:63], v[168:171], a[56:59]
  v_exp_f32 v229, v229
  v_mfma_f32_16x16x32_bf16 a[60:63], v[60:63], v[172:175], a[60:63]
  v_exp_f32 v230, v230
  v_mfma_f32_16x16x32_bf16 a[128:131], v[34:37], v[160:163], a[128:131]
  v_exp_f32 v231, v231
  v_mfma_f32_16x16x32_bf16 a[132:135], v[34:37], v[164:167], a[132:135]
  ds_read_b128 v[56:59], v21 offset:16384
  s_add_u32 m0, s42, 8192
  v_mfma_f32_16x16x32_bf16 a[136:139], v[34:37], v[168:171], a[136:139]
  v_cvt_pk_bf16_f32 v176, v224, v225
  v_cvt_pk_bf16_f32 v177, v226, v227
  v_mfma_f32_16x16x32_bf16 a[140:143], v[34:37], v[172:175], a[140:143]
  s_waitcnt lgkmcnt(5)
  v_mfma_f32_16x16x32_bf16 a[64:67], v[64:67], v[160:163], a[64:67]
  v_exp_f32 v232, v232
  v_mfma_f32_16x16x32_bf16 a[68:71], v[64:67], v[164:167], a[68:71]
  ds_read_b128 v[60:63], v22 offset:16384
  s_mov_b32 s39, 106496
  v_mfma_f32_16x16x32_bf16 a[72:75], v[64:67], v[168:171], a[72:75]
  v_exp_f32 v233, v233
  v_mfma_f32_16x16x32_bf16 a[76:79], v[64:67], v[172:175], a[76:79]
  v_exp_f32 v234, v234
  v_mfma_f32_16x16x32_bf16 a[80:83], v[68:71], v[160:163], a[80:83]
  v_exp_f32 v235, v235
  v_mfma_f32_16x16x32_bf16 a[84:87], v[68:71], v[164:167], a[84:87]
  ds_read_b128 v[64:67], v23 offset:16384
  v_cvt_pk_bf16_f32 v180, v228, v229
  v_mfma_f32_16x16x32_bf16 a[88:91], v[68:71], v[168:171], a[88:91]
  buffer_load_dwordx4 v17, s[20:23], s39 offen lds
  v_mfma_f32_16x16x32_bf16 a[92:95], v[68:71], v[172:175], a[92:95]
  v_cvt_pk_bf16_f32 v181, v230, v231
  s_waitcnt lgkmcnt(3)
  v_mfma_f32_16x16x32_bf16 a[96:99], v[48:51], v[160:163], a[96:99]
  v_exp_f32 v236, v236
  v_mfma_f32_16x16x32_bf16 a[100:103], v[48:51], v[164:167], a[100:103]
  ds_read_b128 v[68:71], v24 offset:16384
  v_mfma_f32_16x16x32_bf16 a[104:107], v[48:51], v[168:171], a[104:107]
  buffer_load_dwordx4 v18, s[20:23], s39 offen offset:1024 lds
  v_mfma_f32_16x16x32_bf16 a[108:111], v[48:51], v[172:175], a[108:111]
  v_exp_f32 v237, v237
  v_mfma_f32_16x16x32_bf16 a[112:115], v[52:55], v[160:163], a[112:115]
  v_exp_f32 v238, v238
  v_mfma_f32_16x16x32_bf16 a[116:119], v[52:55], v[164:167], a[116:119]
  ds_read_b128 v[48:51], v21 offset:20480
  v_mfma_f32_16x16x32_bf16 a[120:123], v[52:55], v[168:171], a[120:123]
  v_exp_f32 v239, v239
  v_mfma_f32_16x16x32_bf16 a[124:127], v[52:55], v[172:175], a[124:127]
  v_cvt_pk_bf16_f32 v184, v232, v233
  s_waitcnt lgkmcnt(3)
  v_mfma_f32_16x16x32_bf16 v[192:195], v[56:59], v[80:83], v[144:147]
  v_cvt_pk_bf16_f32 v185, v234, v235
  v_mfma_f32_16x16x32_bf16 v[196:199], v[56:59], v[84:87], v[148:151]
  ds_read_b128 v[52:55], v22 offset:20480
  v_mfma_f32_16x16x32_bf16 v[200:203], v[56:59], v[88:91], v[152:155]
  v_exp_f32 v240, v240
  v_mfma_f32_16x16x32_bf16 v[204:207], v[56:59], v[92:95], v[156:159]
  v_exp_f32 v241, v241
  v_mfma_f32_16x16x32_bf16 v[192:195], v[60:63], v[96:99], v[192:195]
  v_exp_f32 v242, v242
  v_mfma_f32_16x16x32_bf16 v[196:199], v[60:63], v[100:103], v[196:199]
  ds_read_b128 v[56:59], v23 offset:20480
  v_mfma_f32_16x16x32_bf16 v[200:203], v[60:63], v[104:107], v[200:203]
  v_exp_f32 v243, v243
  v_mfma_f32_16x16x32_bf16 v[204:207], v[60:63], v[108:111], v[204:207]
  v_cvt_pk_bf16_f32 v188, v236, v237
  s_waitcnt lgkmcnt(3)
  v_mfma_f32_16x16x32_bf16 v[192:195], v[64:67], v[112:115], v[192:195]
  v_cvt_pk_bf16_f32 v189, v238, v239
  v_mfma_f32_16x16x32_bf16 v[196:199], v[64:67], v[116:119], v[196:199]
  ds_read_b128 v[60:63], v24 offset:20480
  v_mfma_f32_16x16x32_bf16 v[200:203], v[64:67], v[120:123], v[200:203]
  v_exp_f32 v244, v244
  v_mfma_f32_16x16x32_bf16 v[204:207], v[64:67], v[124:127], v[204:207]
  v_exp_f32 v245, v245
  v_mfma_f32_16x16x32_bf16 v[192:195], v[68:71], v[128:131], v[192:195]
  v_exp_f32 v246, v246
  v_mfma_f32_16x16x32_bf16 v[196:199], v[68:71], v[132:135], v[196:199]
  ds_read_b64_tr_b16 v[64:65], v25 offset:8192
  ds_read_b64_tr_b16 v[66:67], v25 offset:12288
  v_mfma_f32_16x16x32_bf16 v[200:203], v[68:71], v[136:139], v[200:203]
  v_exp_f32 v247, v247
  v_mfma_f32_16x16x32_bf16 v[204:207], v[68:71], v[140:143], v[204:207]
  v_cvt_pk_bf16_f32 v178, v240, v241
  s_waitcnt lgkmcnt(4)
  v_mfma_f32_16x16x32_bf16 v[208:211], v[48:51], v[80:83], v[144:147]
  v_cvt_pk_bf16_f32 v179, v242, v243
  v_mfma_f32_16x16x32_bf16 v[212:215], v[48:51], v[84:87], v[148:151]
  ds_read_b64_tr_b16 v[68:69], v26 offset:8192
  ds_read_b64_tr_b16 v[70:71], v26 offset:12288
  v_mfma_f32_16x16x32_bf16 v[216:219], v[48:51], v[88:91], v[152:155]
  v_exp_f32 v248, v248
  v_mfma_f32_16x16x32_bf16 v[220:223], v[48:51], v[92:95], v[156:159]
  v_exp_f32 v249, v249
  v_mfma_f32_16x16x32_bf16 v[208:211], v[52:55], v[96:99], v[208:211]
  v_exp_f32 v250, v250
  v_mfma_f32_16x16x32_bf16 v[212:215], v[52:55], v[100:103], v[212:215]
  ds_read_b64_tr_b16 v[48:49], v27 offset:8192
  ds_read_b64_tr_b16 v[50:51], v27 offset:12288
  v_mfma_f32_16x16x32_bf16 v[216:219], v[52:55], v[104:107], v[216:219]
  v_exp_f32 v251, v251
  v_mfma_f32_16x16x32_bf16 v[220:223], v[52:55], v[108:111], v[220:223]
  v_cvt_pk_bf16_f32 v182, v244, v245
  s_waitcnt lgkmcnt(6)
  v_mfma_f32_16x16x32_bf16 v[208:211], v[56:59], v[112:115], v[208:211]
  v_cvt_pk_bf16_f32 v183, v246, v247
  v_mfma_f32_16x16x32_bf16 v[212:215], v[56:59], v[116:119], v[212:215]
  ds_read_b64_tr_b16 v[52:53], v28 offset:8192
  ds_read_b64_tr_b16 v[54:55], v28 offset:12288
  v_mfma_f32_16x16x32_bf16 v[216:219], v[56:59], v[120:123], v[216:219]
  v_exp_f32 v252, v252
  v_mfma_f32_16x16x32_bf16 v[220:223], v[56:59], v[124:127], v[220:223]
  v_exp_f32 v253, v253
  v_mfma_f32_16x16x32_bf16 v[208:211], v[60:63], v[128:131], v[208:211]
  v_exp_f32 v254, v254
  v_mfma_f32_16x16x32_bf16 v[212:215], v[60:63], v[132:135], v[212:215]
  v_exp_f32 v255, v255
  v_mfma_f32_16x16x32_bf16 v[216:219], v[60:63], v[136:139], v[216:219]
  v_cvt_pk_bf16_f32 v186, v248, v249
  v_cvt_pk_bf16_f32 v187, v250, v251
  v_cvt_pk_bf16_f32 v190, v252, v253
  v_cvt_pk_bf16_f32 v191, v254, v255
  v_mfma_f32_16x16x32_bf16 v[220:223], v[60:63], v[140:143], v[220:223]
  s_waitcnt vmcnt(6)
  s_barrier
  s_waitcnt lgkmcnt(4)
  v_mfma_f32_16x16x32_bf16 a[0:3], v[64:67], v[176:179], a[0:3]
  ds_read_b64_tr_b16 v[56:57], v29 offset:8192
  ds_read_b64_tr_b16 v[58:59], v29 offset:12288
  v_mfma_f32_16x16x32_bf16 a[4:7], v[64:67], v[180:183], a[4:7]
  ds_read_b64_tr_b16 v[60:61], v30 offset:8192
  ds_read_b64_tr_b16 v[62:63], v30 offset:12288
  v_mfma_f32_16x16x32_bf16 a[8:11], v[64:67], v[184:187], a[8:11]
  s_add_u32 m0, s42, 32768
  v_mfma_f32_16x16x32_bf16 a[12:15], v[64:67], v[188:191], a[12:15]
  v_exp_f32 v192, v192
  v_mfma_f32_16x16x32_bf16 a[16:19], v[68:71], v[176:179], a[16:19]
  v_exp_f32 v193, v193
  v_mfma_f32_16x16x32_bf16 a[20:23], v[68:71], v[180:183], a[20:23]
  ds_read_b64_tr_b16 v[64:65], v31 offset:8192
  ds_read_b64_tr_b16 v[66:67], v31 offset:12288
  v_mfma_f32_16x16x32_bf16 a[24:27], v[68:71], v[184:187], a[24:27]
  s_mov_b32 s39, 98304
  v_mfma_f32_16x16x32_bf16 a[28:31], v[68:71], v[188:191], a[28:31]
  s_waitcnt lgkmcnt(6)
  v_mfma_f32_16x16x32_bf16 a[32:35], v[48:51], v[176:179], a[32:35]
  v_exp_f32 v194, v194
  v_mfma_f32_16x16x32_bf16 a[36:39], v[48:51], v[180:183], a[36:39]
  ds_read_b64_tr_b16 v[68:69], v32 offset:8192
  ds_read_b64_tr_b16 v[70:71], v32 offset:12288
  v_mfma_f32_16x16x32_bf16 a[40:43], v[48:51], v[184:187], a[40:43]
  buffer_load_dwordx4 v19, s[24:27], s39 offen lds
  v_mfma_f32_16x16x32_bf16 a[44:47], v[48:51], v[188:191], a[44:47]
  v_exp_f32 v195, v195
  v_mfma_f32_16x16x32_bf16 a[48:51], v[52:55], v[176:179], a[48:51]
  v_exp_f32 v196, v196
  v_mfma_f32_16x16x32_bf16 a[52:55], v[52:55], v[180:183], a[52:55]
  buffer_load_dwordx4 v20, s[24:27], s39 offen offset:1024 lds
  v_mfma_f32_16x16x32_bf16 a[56:59], v[52:55], v[184:187], a[56:59]
  v_exp_f32 v197, v197
  v_mfma_f32_16x16x32_bf16 a[60:63], v[52:55], v[188:191], a[60:63]
  v_exp_f32 v198, v198
  v_mfma_f32_16x16x32_bf16 a[128:131], v[34:37], v[176:179], a[128:131]
  v_exp_f32 v199, v199
  v_mfma_f32_16x16x32_bf16 a[132:135], v[34:37], v[180:183], a[132:135]
  ds_read_b128 v[48:51], v21 offset:24576
  s_add_u32 m0, s42, 16384
  v_mfma_f32_16x16x32_bf16 a[136:139], v[34:37], v[184:187], a[136:139]
  v_cvt_pk_bf16_f32 v160, v192, v193
  v_cvt_pk_bf16_f32 v161, v194, v195
  v_mfma_f32_16x16x32_bf16 a[140:143], v[34:37], v[188:191], a[140:143]
  s_waitcnt lgkmcnt(5)
  v_mfma_f32_16x16x32_bf16 a[64:67], v[56:59], v[176:179], a[64:67]
  v_exp_f32 v200, v200
  v_mfma_f32_16x16x32_bf16 a[68:71], v[56:59], v[180:183], a[68:71]
  ds_read_b128 v[52:55], v22 offset:24576
  s_mov_b32 s39, 114688
  v_mfma_f32_16x16x32_bf16 a[72:75], v[56:59], v[184:187], a[72:75]
  v_exp_f32 v201, v201
  v_mfma_f32_16x16x32_bf16 a[76:79], v[56:59], v[188:191], a[76:79]
  v_exp_f32 v202, v202
  v_mfma_f32_16x16x32_bf16 a[80:83], v[60:63], v[176:179], a[80:83]
  v_exp_f32 v203, v203
  v_mfma_f32_16x16x32_bf16 a[84:87], v[60:63], v[180:183], a[84:87]
  ds_read_b128 v[56:59], v23 offset:24576
  v_cvt_pk_bf16_f32 v164, v196, v197
  v_mfma_f32_16x16x32_bf16 a[88:91], v[60:63], v[184:187], a[88:91]
  buffer_load_dwordx4 v17, s[20:23], s39 offen lds
  v_mfma_f32_16x16x32_bf16 a[92:95], v[60:63], v[188:191], a[92:95]
  v_cvt_pk_bf16_f32 v165, v198, v199
  s_waitcnt lgkmcnt(3)
  v_mfma_f32_16x16x32_bf16 a[96:99], v[64:67], v[176:179], a[96:99]
  v_exp_f32 v204, v204
  v_mfma_f32_16x16x32_bf16 a[100:103], v[64:67], v[180:183], a[100:103]
  ds_read_b128 v[60:63], v24 offset:24576
  v_mfma_f32_16x16x32_bf16 a[104:107], v[64:67], v[184:187], a[104:107]
  buffer_load_dwordx4 v18, s[20:23], s39 offen offset:1024 lds
  v_mfma_f32_16x16x32_bf16 a[108:111], v[64:67], v[188:191], a[108:111]
  v_exp_f32 v205, v205
  v_mfma_f32_16x16x32_bf16 a[112:115], v[68:71], v[176:179], a[112:115]
  v_exp_f32 v206, v206
  v_mfma_f32_16x16x32_bf16 a[116:119], v[68:71], v[180:183], a[116:119]
  ds_read_b128 v[64:67], v21 offset:28672
  v_mfma_f32_16x16x32_bf16 a[120:123], v[68:71], v[184:187], a[120:123]
  v_exp_f32 v207, v207
  v_mfma_f32_16x16x32_bf16 a[124:127], v[68:71], v[188:191], a[124:127]
  v_cvt_pk_bf16_f32 v168, v200, v201
  s_waitcnt lgkmcnt(3)
  v_mfma_f32_16x16x32_bf16 v[224:227], v[48:51], v[80:83], v[144:147]
  v_cvt_pk_bf16_f32 v169, v202, v203
  v_mfma_f32_16x16x32_bf16 v[228:231], v[48:51], v[84:87], v[148:151]
  ds_read_b128 v[68:71], v22 offset:28672
  v_mfma_f32_16x16x32_bf16 v[232:235], v[48:51], v[88:91], v[152:155]
  v_exp_f32 v208, v208
  v_mfma_f32_16x16x32_bf16 v[236:239], v[48:51], v[92:95], v[156:159]
  v_exp_f32 v209, v209
  v_mfma_f32_16x16x32_bf16 v[224:227], v[52:55], v[96:99], v[224:227]
  v_exp_f32 v210, v210
  v_mfma_f32_16x16x32_bf16 v[228:231], v[52:55], v[100:103], v[228:231]
  ds_read_b128 v[48:51], v23 offset:28672
  v_mfma_f32_16x16x32_bf16 v[232:235], v[52:55], v[104:107], v[232:235]
  v_exp_f32 v211, v211
  v_mfma_f32_16x16x32_bf16 v[236:239], v[52:55], v[108:111], v[236:239]
  v_cvt_pk_bf16_f32 v172, v204, v205
  s_waitcnt lgkmcnt(3)
  v_mfma_f32_16x16x32_bf16 v[224:227], v[56:59], v[112:115], v[224:227]
  v_cvt_pk_bf16_f32 v173, v206, v207
  v_mfma_f32_16x16x32_bf16 v[228:231], v[56:59], v[116:119], v[228:231]
  ds_read_b128 v[52:55], v24 offset:28672
  v_mfma_f32_16x16x32_bf16 v[232:235], v[56:59], v[120:123], v[232:235]
  v_exp_f32 v212, v212
  v_mfma_f32_16x16x32_bf16 v[236:239], v[56:59], v[124:127], v[236:239]
  v_exp_f32 v213, v213
  v_mfma_f32_16x16x32_bf16 v[224:227], v[60:63], v[128:131], v[224:227]
  v_exp_f32 v214, v214
  v_mfma_f32_16x16x32_bf16 v[228:231], v[60:63], v[132:135], v[228:231]
  ds_read_b64_tr_b16 v[56:57], v25 offset:16384
  ds_read_b64_tr_b16 v[58:59], v25 offset:20480
  v_mfma_f32_16x16x32_bf16 v[232:235], v[60:63], v[136:139], v[232:235]
  v_exp_f32 v215, v215
  v_mfma_f32_16x16x32_bf16 v[236:239], v[60:63], v[140:143], v[236:239]
  v_cvt_pk_bf16_f32 v162, v208, v209
  s_waitcnt lgkmcnt(4)
  v_mfma_f32_16x16x32_bf16 v[240:243], v[64:67], v[80:83], v[144:147]
  v_cvt_pk_bf16_f32 v163, v210, v211
  v_mfma_f32_16x16x32_bf16 v[244:247], v[64:67], v[84:87], v[148:151]
  ds_read_b64_tr_b16 v[60:61], v26 offset:16384
  ds_read_b64_tr_b16 v[62:63], v26 offset:20480
  v_mfma_f32_16x16x32_bf16 v[248:251], v[64:67], v[88:91], v[152:155]
  v_exp_f32 v216, v216
  v_mfma_f32_16x16x32_bf16 v[252:255], v[64:67], v[92:95], v[156:159]
  v_exp_f32 v217, v217
  v_mfma_f32_16x16x32_bf16 v[240:243], v[68:71], v[96:99], v[240:243]
  v_exp_f32 v218, v218
  v_mfma_f32_16x16x32_bf16 v[244:247], v[68:71], v[100:103], v[244:247]
  ds_read_b64_tr_b16 v[64:65], v27 offset:16384
  ds_read_b64_tr_b16 v[66:67], v27 offset:20480
  v_mfma_f32_16x16x32_bf16 v[248:251], v[68:71], v[104:107], v[248:251]
  v_exp_f32 v219, v219
  v_mfma_f32_16x16x32_bf16 v[252:255], v[68:71], v[108:111], v[252:255]
  v_cvt_pk_bf16_f32 v166, v212, v213
  s_waitcnt lgkmcnt(6)
  v_mfma_f32_16x16x32_bf16 v[240:243], v[48:51], v[112:115], v[240:243]
  v_cvt_pk_bf16_f32 v167, v214, v215
  v_mfma_f32_16x16x32_bf16 v[244:247], v[48:51], v[116:119], v[244:247]
  ds_read_b64_tr_b16 v[68:69], v28 offset:16384
  ds_read_b64_tr_b16 v[70:71], v28 offset:20480
  v_mfma_f32_16x16x32_bf16 v[248:251], v[48:51], v[120:123], v[248:251]
  v_exp_f32 v220, v220
  v_mfma_f32_16x16x32_bf16 v[252:255], v[48:51], v[124:127], v[252:255]
  v_exp_f32 v221, v221
  v_mfma_f32_16x16x32_bf16 v[240:243], v[52:55], v[128:131], v[240:243]
  v_exp_f32 v222, v222
  v_mfma_f32_16x16x32_bf16 v[244:247], v[52:55], v[132:135], v[244:247]
  v_exp_f32 v223, v223
  v_mfma_f32_16x16x32_bf16 v[248:251], v[52:55], v[136:139], v[248:251]
  v_cvt_pk_bf16_f32 v170, v216, v217
  v_cvt_pk_bf16_f32 v171, v218, v219
  v_cvt_pk_bf16_f32 v174, v220, v221
  v_cvt_pk_bf16_f32 v175, v222, v223
  v_mfma_f32_16x16x32_bf16 v[252:255], v[52:55], v[140:143], v[252:255]
  s_waitcnt vmcnt(6)
  s_barrier
  s_waitcnt lgkmcnt(4)
  v_mfma_f32_16x16x32_bf16 a[0:3], v[56:59], v[160:163], a[0:3]
  ds_read_b64_tr_b16 v[48:49], v29 offset:16384
  ds_read_b64_tr_b16 v[50:51], v29 offset:20480
  v_mfma_f32_16x16x32_bf16 a[4:7], v[56:59], v[164:167], a[4:7]
  ds_read_b64_tr_b16 v[52:53], v30 offset:16384
  ds_read_b64_tr_b16 v[54:55], v30 offset:20480
  v_mfma_f32_16x16x32_bf16 a[8:11], v[56:59], v[168:171], a[8:11]
  s_add_u32 m0, s42, 40960
  v_mfma_f32_16x16x32_bf16 a[12:15], v[56:59], v[172:175], a[12:15]
  v_exp_f32 v224, v224
  v_mfma_f32_16x16x32_bf16 a[16:19], v[60:63], v[160:163], a[16:19]
  v_exp_f32 v225, v225
  v_mfma_f32_16x16x32_bf16 a[20:23], v[60:63], v[164:167], a[20:23]
  ds_read_b64_tr_b16 v[56:57], v31 offset:16384
  ds_read_b64_tr_b16 v[58:59], v31 offset:20480
  v_mfma_f32_16x16x32_bf16 a[24:27], v[60:63], v[168:171], a[24:27]
  s_mov_b32 s39, 106496
  v_mfma_f32_16x16x32_bf16 a[28:31], v[60:63], v[172:175], a[28:31]
  s_waitcnt lgkmcnt(6)
  v_mfma_f32_16x16x32_bf16 a[32:35], v[64:67], v[160:163], a[32:35]
  v_exp_f32 v226, v226
  v_mfma_f32_16x16x32_bf16 a[36:39], v[64:67], v[164:167], a[36:39]
  ds_read_b64_tr_b16 v[60:61], v32 offset:16384
  ds_read_b64_tr_b16 v[62:63], v32 offset:20480
  v_mfma_f32_16x16x32_bf16 a[40:43], v[64:67], v[168:171], a[40:43]
  buffer_load_dwordx4 v19, s[24:27], s39 offen lds
  v_mfma_f32_16x16x32_bf16 a[44:47], v[64:67], v[172:175], a[44:47]
  v_exp_f32 v227, v227
  v_mfma_f32_16x16x32_bf16 a[48:51], v[68:71], v[160:163], a[48:51]
  v_exp_f32 v228, v228
  v_mfma_f32_16x16x32_bf16 a[52:55], v[68:71], v[164:167], a[52:55]
  buffer_load_dwordx4 v20, s[24:27], s39 offen offset:1024 lds
  v_mfma_f32_16x16x32_bf16 a[56:59], v[68:71], v[168:171], a[56:59]
  v_exp_f32 v229, v229
  v_mfma_f32_16x16x32_bf16 a[60:63], v[68:71], v[172:175], a[60:63]
  v_exp_f32 v230, v230
  v_mfma_f32_16x16x32_bf16 a[128:131], v[34:37], v[160:163], a[128:131]
  v_exp_f32 v231, v231
  v_mfma_f32_16x16x32_bf16 a[132:135], v[34:37], v[164:167], a[132:135]
  ds_read_b128 v[64:67], v21 offset:0
  s_add_u32 m0, s42, 24576
  v_mfma_f32_16x16x32_bf16 a[136:139], v[34:37], v[168:171], a[136:139]
  v_cvt_pk_bf16_f32 v176, v224, v225
  v_cvt_pk_bf16_f32 v177, v226, v227
  v_mfma_f32_16x16x32_bf16 a[140:143], v[34:37], v[172:175], a[140:143]
  s_waitcnt lgkmcnt(5)
  v_mfma_f32_16x16x32_bf16 a[64:67], v[48:51], v[160:163], a[64:67]
  v_exp_f32 v232, v232
  v_mfma_f32_16x16x32_bf16 a[68:71], v[48:51], v[164:167], a[68:71]
  ds_read_b128 v[68:71], v22 offset:0
  s_mov_b32 s39, 122880
  v_mfma_f32_16x16x32_bf16 a[72:75], v[48:51], v[168:171], a[72:75]
  v_exp_f32 v233, v233
  v_mfma_f32_16x16x32_bf16 a[76:79], v[48:51], v[172:175], a[76:79]
  v_exp_f32 v234, v234
  v_mfma_f32_16x16x32_bf16 a[80:83], v[52:55], v[160:163], a[80:83]
  v_exp_f32 v235, v235
  v_mfma_f32_16x16x32_bf16 a[84:87], v[52:55], v[164:167], a[84:87]
  ds_read_b128 v[48:51], v23 offset:0
  v_cvt_pk_bf16_f32 v180, v228, v229
  v_mfma_f32_16x16x32_bf16 a[88:91], v[52:55], v[168:171], a[88:91]
  buffer_load_dwordx4 v17, s[20:23], s39 offen lds
  v_mfma_f32_16x16x32_bf16 a[92:95], v[52:55], v[172:175], a[92:95]
  v_cvt_pk_bf16_f32 v181, v230, v231
  s_waitcnt lgkmcnt(3)
  v_mfma_f32_16x16x32_bf16 a[96:99], v[56:59], v[160:163], a[96:99]
  v_exp_f32 v236, v236
  v_mfma_f32_16x16x32_bf16 a[100:103], v[56:59], v[164:167], a[100:103]
  ds_read_b128 v[52:55], v24 offset:0
  v_mfma_f32_16x16x32_bf16 a[104:107], v[56:59], v[168:171], a[104:107]
  buffer_load_dwordx4 v18, s[20:23], s39 offen offset:1024 lds
  v_mfma_f32_16x16x32_bf16 a[108:111], v[56:59], v[172:175], a[108:111]
  v_exp_f32 v237, v237
  v_mfma_f32_16x16x32_bf16 a[112:115], v[60:63], v[160:163], a[112:115]
  v_exp_f32 v238, v238
  v_mfma_f32_16x16x32_bf16 a[116:119], v[60:63], v[164:167], a[116:119]
  ds_read_b128 v[56:59], v21 offset:4096
  v_mfma_f32_16x16x32_bf16 a[120:123], v[60:63], v[168:171], a[120:123]
  v_exp_f32 v239, v239
  v_mfma_f32_16x16x32_bf16 a[124:127], v[60:63], v[172:175], a[124:127]
  v_cvt_pk_bf16_f32 v184, v232, v233
  s_waitcnt lgkmcnt(3)
  v_mfma_f32_16x16x32_bf16 v[192:195], v[64:67], v[80:83], v[144:147]
  v_cvt_pk_bf16_f32 v185, v234, v235
  v_mfma_f32_16x16x32_bf16 v[196:199], v[64:67], v[84:87], v[148:151]
  ds_read_b128 v[60:63], v22 offset:4096
  v_mfma_f32_16x16x32_bf16 v[200:203], v[64:67], v[88:91], v[152:155]
  v_exp_f32 v240, v240
  v_mfma_f32_16x16x32_bf16 v[204:207], v[64:67], v[92:95], v[156:159]
  v_exp_f32 v241, v241
  v_mfma_f32_16x16x32_bf16 v[192:195], v[68:71], v[96:99], v[192:195]
  v_exp_f32 v242, v242
  v_mfma_f32_16x16x32_bf16 v[196:199], v[68:71], v[100:103], v[196:199]
  ds_read_b128 v[64:67], v23 offset:4096
  v_mfma_f32_16x16x32_bf16 v[200:203], v[68:71], v[104:107], v[200:203]
  v_exp_f32 v243, v243
  v_mfma_f32_16x16x32_bf16 v[204:207], v[68:71], v[108:111], v[204:207]
  v_cvt_pk_bf16_f32 v188, v236, v237
  s_waitcnt lgkmcnt(3)
  v_mfma_f32_16x16x32_bf16 v[192:195], v[48:51], v[112:115], v[192:195]
  v_cvt_pk_bf16_f32 v189, v238, v239
  v_mfma_f32_16x16x32_bf16 v[196:199], v[48:51], v[116:119], v[196:199]
  ds_read_b128 v[68:71], v24 offset:4096
  v_mfma_f32_16x16x32_bf16 v[200:203], v[48:51], v[120:123], v[200:203]
  v_exp_f32 v244, v244
  v_mfma_f32_16x16x32_bf16 v[204:207], v[48:51], v[124:127], v[204:207]
  v_exp_f32 v245, v245
  v_mfma_f32_16x16x32_bf16 v[192:195], v[52:55], v[128:131], v[192:195]
  v_exp_f32 v246, v246
  v_mfma_f32_16x16x32_bf16 v[196:199], v[52:55], v[132:135], v[196:199]
  ds_read_b64_tr_b16 v[48:49], v25 offset:24576
  ds_read_b64_tr_b16 v[50:51], v25 offset:28672
  v_mfma_f32_16x16x32_bf16 v[200:203], v[52:55], v[136:139], v[200:203]
  v_exp_f32 v247, v247
  v_mfma_f32_16x16x32_bf16 v[204:207], v[52:55], v[140:143], v[204:207]
  v_cvt_pk_bf16_f32 v178, v240, v241
  s_waitcnt lgkmcnt(4)
  v_mfma_f32_16x16x32_bf16 v[208:211], v[56:59], v[80:83], v[144:147]
  v_cvt_pk_bf16_f32 v179, v242, v243
  v_mfma_f32_16x16x32_bf16 v[212:215], v[56:59], v[84:87], v[148:151]
  ds_read_b64_tr_b16 v[52:53], v26 offset:24576
  ds_read_b64_tr_b16 v[54:55], v26 offset:28672
  v_mfma_f32_16x16x32_bf16 v[216:219], v[56:59], v[88:91], v[152:155]
  v_exp_f32 v248, v248
  v_mfma_f32_16x16x32_bf16 v[220:223], v[56:59], v[92:95], v[156:159]
  v_exp_f32 v249, v249
  v_mfma_f32_16x16x32_bf16 v[208:211], v[60:63], v[96:99], v[208:211]
  v_exp_f32 v250, v250
  v_mfma_f32_16x16x32_bf16 v[212:215], v[60:63], v[100:103], v[212:215]
  ds_read_b64_tr_b16 v[56:57], v27 offset:24576
  ds_read_b64_tr_b16 v[58:59], v27 offset:28672
  v_mfma_f32_16x16x32_bf16 v[216:219], v[60:63], v[104:107], v[216:219]
  v_exp_f32 v251, v251
  v_mfma_f32_16x16x32_bf16 v[220:223], v[60:63], v[108:111], v[220:223]
  v_cvt_pk_bf16_f32 v182, v244, v245
  s_waitcnt lgkmcnt(6)
  v_mfma_f32_16x16x32_bf16 v[208:211], v[64:67], v[112:115], v[208:211]
  v_cvt_pk_bf16_f32 v183, v246, v247
  v_mfma_f32_16x16x32_bf16 v[212:215], v[64:67], v[116:119], v[212:215]
  ds_read_b64_tr_b16 v[60:61], v28 offset:24576
  ds_read_b64_tr_b16 v[62:63], v28 offset:28672
  v_mfma_f32_16x16x32_bf16 v[216:219], v[64:67], v[120:123], v[216:219]
  v_exp_f32 v252, v252
  v_mfma_f32_16x16x32_bf16 v[220:223], v[64:67], v[124:127], v[220:223]
  v_exp_f32 v253, v253
  v_mfma_f32_16x16x32_bf16 v[208:211], v[68:71], v[128:131], v[208:211]
  v_exp_f32 v254, v254
  v_mfma_f32_16x16x32_bf16 v[212:215], v[68:71], v[132:135], v[212:215]
  v_exp_f32 v255, v255
  v_mfma_f32_16x16x32_bf16 v[216:219], v[68:71], v[136:139], v[216:219]
  v_cvt_pk_bf16_f32 v186, v248, v249
  v_cvt_pk_bf16_f32 v187, v250, v251
  v_cvt_pk_bf16_f32 v190, v252, v253
  v_cvt_pk_bf16_f32 v191, v254, v255
  v_mfma_f32_16x16x32_bf16 v[220:223], v[68:71], v[140:143], v[220:223]
  s_waitcnt vmcnt(6)
  s_barrier
  s_waitcnt lgkmcnt(4)
  v_mfma_f32_16x16x32_bf16 a[0:3], v[48:51], v[176:179], a[0:3]
  ds_read_b64_tr_b16 v[64:65], v29 offset:24576
  ds_read_b64_tr_b16 v[66:67], v29 offset:28672
  v_mfma_f32_16x16x32_bf16 a[4:7], v[48:51], v[180:183], a[4:7]
  ds_read_b64_tr_b16 v[68:69], v30 offset:24576
  ds_read_b64_tr_b16 v[70:71], v30 offset:28672
  v_mfma_f32_16x16x32_bf16 a[8:11], v[48:51], v[184:187], a[8:11]
  s_add_u32 m0, s42, 49152
  v_mfma_f32_16x16x32_bf16 a[12:15], v[48:51], v[188:191], a[12:15]
  v_exp_f32 v192, v192
  v_mfma_f32_16x16x32_bf16 a[16:19], v[52:55], v[176:179], a[16:19]
  v_exp_f32 v193, v193
  v_mfma_f32_16x16x32_bf16 a[20:23], v[52:55], v[180:183], a[20:23]
  ds_read_b64_tr_b16 v[48:49], v31 offset:24576
  ds_read_b64_tr_b16 v[50:51], v31 offset:28672
  v_mfma_f32_16x16x32_bf16 a[24:27], v[52:55], v[184:187], a[24:27]
  s_mov_b32 s39, 114688
  v_mfma_f32_16x16x32_bf16 a[28:31], v[52:55], v[188:191], a[28:31]
  s_waitcnt lgkmcnt(6)
  v_mfma_f32_16x16x32_bf16 a[32:35], v[56:59], v[176:179], a[32:35]
  v_exp_f32 v194, v194
  v_mfma_f32_16x16x32_bf16 a[36:39], v[56:59], v[180:183], a[36:39]
  ds_read_b64_tr_b16 v[52:53], v32 offset:24576
  ds_read_b64_tr_b16 v[54:55], v32 offset:28672
  v_mfma_f32_16x16x32_bf16 a[40:43], v[56:59], v[184:187], a[40:43]
  buffer_load_dwordx4 v19, s[24:27], s39 offen lds
  v_mfma_f32_16x16x32_bf16 a[44:47], v[56:59], v[188:191], a[44:47]
  v_exp_f32 v195, v195
  v_mfma_f32_16x16x32_bf16 a[48:51], v[60:63], v[176:179], a[48:51]
  v_exp_f32 v196, v196
  v_mfma_f32_16x16x32_bf16 a[52:55], v[60:63], v[180:183], a[52:55]
  buffer_load_dwordx4 v20, s[24:27], s39 offen offset:1024 lds
  v_mfma_f32_16x16x32_bf16 a[56:59], v[60:63], v[184:187], a[56:59]
  v_exp_f32 v197, v197
  v_mfma_f32_16x16x32_bf16 a[60:63], v[60:63], v[188:191], a[60:63]
  v_exp_f32 v198, v198
  v_mfma_f32_16x16x32_bf16 a[128:131], v[34:37], v[176:179], a[128:131]
  v_exp_f32 v199, v199
  v_mfma_f32_16x16x32_bf16 a[132:135], v[34:37], v[180:183], a[132:135]
  ds_read_b128 v[56:59], v21 offset:8192
  v_cvt_pk_bf16_f32 v160, v192, v193
  v_mfma_f32_16x16x32_bf16 a[136:139], v[34:37], v[184:187], a[136:139]
  v_cvt_pk_bf16_f32 v161, v194, v195
  v_mfma_f32_16x16x32_bf16 a[140:143], v[34:37], v[188:191], a[140:143]
  s_waitcnt lgkmcnt(5)
  v_mfma_f32_16x16x32_bf16 a[64:67], v[64:67], v[176:179], a[64:67]
  v_exp_f32 v200, v200
  v_mfma_f32_16x16x32_bf16 a[68:71], v[64:67], v[180:183], a[68:71]
  ds_read_b128 v[60:63], v22 offset:8192
  v_mfma_f32_16x16x32_bf16 a[72:75], v[64:67], v[184:187], a[72:75]
  v_exp_f32 v201, v201
  v_mfma_f32_16x16x32_bf16 a[76:79], v[64:67], v[188:191], a[76:79]
  v_exp_f32 v202, v202
  v_mfma_f32_16x16x32_bf16 a[80:83], v[68:71], v[176:179], a[80:83]
  v_exp_f32 v203, v203
  v_mfma_f32_16x16x32_bf16 a[84:87], v[68:71], v[180:183], a[84:87]
  ds_read_b128 v[64:67], v23 offset:8192
  v_cvt_pk_bf16_f32 v164, v196, v197
  v_mfma_f32_16x16x32_bf16 a[88:91], v[68:71], v[184:187], a[88:91]
  v_cvt_pk_bf16_f32 v165, v198, v199
  v_mfma_f32_16x16x32_bf16 a[92:95], v[68:71], v[188:191], a[92:95]
  s_waitcnt lgkmcnt(3)
  v_mfma_f32_16x16x32_bf16 a[96:99], v[48:51], v[176:179], a[96:99]
  v_exp_f32 v204, v204
  v_mfma_f32_16x16x32_bf16 a[100:103], v[48:51], v[180:183], a[100:103]
  ds_read_b128 v[68:71], v24 offset:8192
  v_mfma_f32_16x16x32_bf16 a[104:107], v[48:51], v[184:187], a[104:107]
  v_exp_f32 v205, v205
  v_mfma_f32_16x16x32_bf16 a[108:111], v[48:51], v[188:191], a[108:111]
  v_exp_f32 v206, v206
  v_mfma_f32_16x16x32_bf16 a[112:115], v[52:55], v[176:179], a[112:115]
  v_exp_f32 v207, v207
  v_mfma_f32_16x16x32_bf16 a[116:119], v[52:55], v[180:183], a[116:119]
  ds_read_b128 v[48:51], v21 offset:12288
  v_cvt_pk_bf16_f32 v168, v200, v201
  v_mfma_f32_16x16x32_bf16 a[120:123], v[52:55], v[184:187], a[120:123]
  v_cvt_pk_bf16_f32 v169, v202, v203
  v_mfma_f32_16x16x32_bf16 a[124:127], v[52:55], v[188:191], a[124:127]
  s_waitcnt lgkmcnt(3)
  v_mfma_f32_16x16x32_bf16 v[224:227], v[56:59], v[80:83], v[144:147]
  v_exp_f32 v208, v208
  v_mfma_f32_16x16x32_bf16 v[228:231], v[56:59], v[84:87], v[148:151]
  ds_read_b128 v[52:55], v22 offset:12288
  v_mfma_f32_16x16x32_bf16 v[232:235], v[56:59], v[88:91], v[152:155]
  v_exp_f32 v209, v209
  v_mfma_f32_16x16x32_bf16 v[236:239], v[56:59], v[92:95], v[156:159]
  v_exp_f32 v210, v210
  v_mfma_f32_16x16x32_bf16 v[224:227], v[60:63], v[96:99], v[224:227]
  v_exp_f32 v211, v211
  v_mfma_f32_16x16x32_bf16 v[228:231], v[60:63], v[100:103], v[228:231]
  ds_read_b128 v[56:59], v23 offset:12288
  v_cvt_pk_bf16_f32 v172, v204, v205
  v_mfma_f32_16x16x32_bf16 v[232:235], v[60:63], v[104:107], v[232:235]
  v_cvt_pk_bf16_f32 v173, v206, v207
  v_mfma_f32_16x16x32_bf16 v[236:239], v[60:63], v[108:111], v[236:239]
  s_waitcnt lgkmcnt(3)
  v_mfma_f32_16x16x32_bf16 v[224:227], v[64:67], v[112:115], v[224:227]
  v_exp_f32 v212, v212
  v_mfma_f32_16x16x32_bf16 v[228:231], v[64:67], v[116:119], v[228:231]
  ds_read_b128 v[60:63], v24 offset:12288
  v_mfma_f32_16x16x32_bf16 v[232:235], v[64:67], v[120:123], v[232:235]
  v_exp_f32 v213, v213
  v_mfma_f32_16x16x32_bf16 v[236:239], v[64:67], v[124:127], v[236:239]
  v_exp_f32 v214, v214
  v_mfma_f32_16x16x32_bf16 v[224:227], v[68:71], v[128:131], v[224:227]
  v_exp_f32 v215, v215
  v_mfma_f32_16x16x32_bf16 v[228:231], v[68:71], v[132:135], v[228:231]
  ds_read_b64_tr_b16 v[64:65], v25 offset:0
  ds_read_b64_tr_b16 v[66:67], v25 offset:4096
  v_mfma_f32_16x16x32_bf16 v[232:235], v[68:71], v[136:139], v[232:235]
  v_cvt_pk_bf16_f32 v162, v208, v209
  v_cvt_pk_bf16_f32 v163, v210, v211
  v_mfma_f32_16x16x32_bf16 v[236:239], v[68:71], v[140:143], v[236:239]
  s_waitcnt lgkmcnt(4)
  v_mfma_f32_16x16x32_bf16 v[240:243], v[48:51], v[80:83], v[144:147]
  v_exp_f32 v216, v216
  v_mfma_f32_16x16x32_bf16 v[244:247], v[48:51], v[84:87], v[148:151]
  ds_read_b64_tr_b16 v[68:69], v26 offset:0
  ds_read_b64_tr_b16 v[70:71], v26 offset:4096
  v_mfma_f32_16x16x32_bf16 v[248:251], v[48:51], v[88:91], v[152:155]
  v_exp_f32 v217, v217
  v_mfma_f32_16x16x32_bf16 v[252:255], v[48:51], v[92:95], v[156:159]
  v_exp_f32 v218, v218
  v_mfma_f32_16x16x32_bf16 v[240:243], v[52:55], v[96:99], v[240:243]
  v_exp_f32 v219, v219
  v_mfma_f32_16x16x32_bf16 v[244:247], v[52:55], v[100:103], v[244:247]
  ds_read_b64_tr_b16 v[48:49], v27 offset:0
  ds_read_b64_tr_b16 v[50:51], v27 offset:4096
  v_mfma_f32_16x16x32_bf16 v[248:251], v[52:55], v[104:107], v[248:251]
  v_cvt_pk_bf16_f32 v166, v212, v213
  v_cvt_pk_bf16_f32 v167, v214, v215
  v_mfma_f32_16x16x32_bf16 v[252:255], v[52:55], v[108:111], v[252:255]
  s_waitcnt lgkmcnt(6)
  v_mfma_f32_16x16x32_bf16 v[240:243], v[56:59], v[112:115], v[240:243]
  v_exp_f32 v220, v220
  v_mfma_f32_16x16x32_bf16 v[244:247], v[56:59], v[116:119], v[244:247]
  ds_read_b64_tr_b16 v[52:53], v28 offset:0
  ds_read_b64_tr_b16 v[54:55], v28 offset:4096
  v_mfma_f32_16x16x32_bf16 v[248:251], v[56:59], v[120:123], v[248:251]
  v_exp_f32 v221, v221
  v_mfma_f32_16x16x32_bf16 v[252:255], v[56:59], v[124:127], v[252:255]
  v_exp_f32 v222, v222
  v_mfma_f32_16x16x32_bf16 v[240:243], v[60:63], v[128:131], v[240:243]
  v_exp_f32 v223, v223
  v_mfma_f32_16x16x32_bf16 v[244:247], v[60:63], v[132:135], v[244:247]
  v_cvt_pk_bf16_f32 v170, v216, v217
  v_cvt_pk_bf16_f32 v171, v218, v219
  v_mfma_f32_16x16x32_bf16 v[248:251], v[60:63], v[136:139], v[248:251]
  v_cvt_pk_bf16_f32 v174, v220, v221
  v_cvt_pk_bf16_f32 v175, v222, v223
  v_mfma_f32_16x16x32_bf16 v[252:255], v[60:63], v[140:143], v[252:255]
  s_waitcnt vmcnt(4)
  s_barrier
  s_waitcnt lgkmcnt(4)
  v_mfma_f32_16x16x32_bf16 a[0:3], v[64:67], v[160:163], a[0:3]
  ds_read_b64_tr_b16 v[56:57], v29 offset:0
  ds_read_b64_tr_b16 v[58:59], v29 offset:4096
  v_mfma_f32_16x16x32_bf16 a[4:7], v[64:67], v[164:167], a[4:7]
  ds_read_b64_tr_b16 v[60:61], v30 offset:0
  ds_read_b64_tr_b16 v[62:63], v30 offset:4096
  v_mfma_f32_16x16x32_bf16 a[8:11], v[64:67], v[168:171], a[8:11]
  s_add_u32 m0, s42, 57344
  v_mfma_f32_16x16x32_bf16 a[12:15], v[64:67], v[172:175], a[12:15]
  v_exp_f32 v224, v224
  v_mfma_f32_16x16x32_bf16 a[16:19], v[68:71], v[160:163], a[16:19]
  v_exp_f32 v225, v225
  v_mfma_f32_16x16x32_bf16 a[20:23], v[68:71], v[164:167], a[20:23]
  ds_read_b64_tr_b16 v[64:65], v31 offset:0
  ds_read_b64_tr_b16 v[66:67], v31 offset:4096
  v_mfma_f32_16x16x32_bf16 a[24:27], v[68:71], v[168:171], a[24:27]
  s_mov_b32 s39, 122880
  v_mfma_f32_16x16x32_bf16 a[28:31], v[68:71], v[172:175], a[28:31]
  s_waitcnt lgkmcnt(6)
  v_mfma_f32_16x16x32_bf16 a[32:35], v[48:51], v[160:163], a[32:35]
  v_exp_f32 v226, v226
  v_mfma_f32_16x16x32_bf16 a[36:39], v[48:51], v[164:167], a[36:39]
  ds_read_b64_tr_b16 v[68:69], v32 offset:0
  ds_read_b64_tr_b16 v[70:71], v32 offset:4096
  v_mfma_f32_16x16x32_bf16 a[40:43], v[48:51], v[168:171], a[40:43]
  buffer_load_dwordx4 v19, s[24:27], s39 offen lds
  v_mfma_f32_16x16x32_bf16 a[44:47], v[48:51], v[172:175], a[44:47]
  v_exp_f32 v227, v227
  v_mfma_f32_16x16x32_bf16 a[48:51], v[52:55], v[160:163], a[48:51]
  v_exp_f32 v228, v228
  v_mfma_f32_16x16x32_bf16 a[52:55], v[52:55], v[164:167], a[52:55]
  buffer_load_dwordx4 v20, s[24:27], s39 offen offset:1024 lds
  v_mfma_f32_16x16x32_bf16 a[56:59], v[52:55], v[168:171], a[56:59]
  v_exp_f32 v229, v229
  v_mfma_f32_16x16x32_bf16 a[60:63], v[52:55], v[172:175], a[60:63]
  v_exp_f32 v230, v230
  v_mfma_f32_16x16x32_bf16 a[128:131], v[34:37], v[160:163], a[128:131]
  v_exp_f32 v231, v231
  v_mfma_f32_16x16x32_bf16 a[132:135], v[34:37], v[164:167], a[132:135]
  ds_read_b128 v[48:51], v21 offset:16384
  v_cvt_pk_bf16_f32 v176, v224, v225
  v_mfma_f32_16x16x32_bf16 a[136:139], v[34:37], v[168:171], a[136:139]
  v_cvt_pk_bf16_f32 v177, v226, v227
  v_mfma_f32_16x16x32_bf16 a[140:143], v[34:37], v[172:175], a[140:143]
  s_waitcnt lgkmcnt(5)
  v_mfma_f32_16x16x32_bf16 a[64:67], v[56:59], v[160:163], a[64:67]
  v_exp_f32 v232, v232
  v_mfma_f32_16x16x32_bf16 a[68:71], v[56:59], v[164:167], a[68:71]
  ds_read_b128 v[52:55], v22 offset:16384
  v_mfma_f32_16x16x32_bf16 a[72:75], v[56:59], v[168:171], a[72:75]
  v_exp_f32 v233, v233
  v_mfma_f32_16x16x32_bf16 a[76:79], v[56:59], v[172:175], a[76:79]
  v_exp_f32 v234, v234
  v_mfma_f32_16x16x32_bf16 a[80:83], v[60:63], v[160:163], a[80:83]
  v_exp_f32 v235, v235
  v_mfma_f32_16x16x32_bf16 a[84:87], v[60:63], v[164:167], a[84:87]
  ds_read_b128 v[56:59], v23 offset:16384
  v_cvt_pk_bf16_f32 v180, v228, v229
  v_mfma_f32_16x16x32_bf16 a[88:91], v[60:63], v[168:171], a[88:91]
  v_cvt_pk_bf16_f32 v181, v230, v231
  v_mfma_f32_16x16x32_bf16 a[92:95], v[60:63], v[172:175], a[92:95]
  s_waitcnt lgkmcnt(3)
  v_mfma_f32_16x16x32_bf16 a[96:99], v[64:67], v[160:163], a[96:99]
  v_exp_f32 v236, v236
  v_mfma_f32_16x16x32_bf16 a[100:103], v[64:67], v[164:167], a[100:103]
  ds_read_b128 v[60:63], v24 offset:16384
  v_mfma_f32_16x16x32_bf16 a[104:107], v[64:67], v[168:171], a[104:107]
  v_exp_f32 v237, v237
  v_mfma_f32_16x16x32_bf16 a[108:111], v[64:67], v[172:175], a[108:111]
  v_exp_f32 v238, v238
  v_mfma_f32_16x16x32_bf16 a[112:115], v[68:71], v[160:163], a[112:115]
  v_exp_f32 v239, v239
  v_mfma_f32_16x16x32_bf16 a[116:119], v[68:71], v[164:167], a[116:119]
  ds_read_b128 v[64:67], v21 offset:20480
  v_cvt_pk_bf16_f32 v184, v232, v233
  v_mfma_f32_16x16x32_bf16 a[120:123], v[68:71], v[168:171], a[120:123]
  v_cvt_pk_bf16_f32 v185, v234, v235
  v_mfma_f32_16x16x32_bf16 a[124:127], v[68:71], v[172:175], a[124:127]
  s_waitcnt lgkmcnt(3)
  v_mfma_f32_16x16x32_bf16 v[192:195], v[48:51], v[80:83], v[144:147]
  v_exp_f32 v240, v240
  v_mfma_f32_16x16x32_bf16 v[196:199], v[48:51], v[84:87], v[148:151]
  ds_read_b128 v[68:71], v22 offset:20480
  v_mfma_f32_16x16x32_bf16 v[200:203], v[48:51], v[88:91], v[152:155]
  v_exp_f32 v241, v241
  v_mfma_f32_16x16x32_bf16 v[204:207], v[48:51], v[92:95], v[156:159]
  v_exp_f32 v242, v242
  v_mfma_f32_16x16x32_bf16 v[192:195], v[52:55], v[96:99], v[192:195]
  v_exp_f32 v243, v243
  v_mfma_f32_16x16x32_bf16 v[196:199], v[52:55], v[100:103], v[196:199]
  ds_read_b128 v[48:51], v23 offset:20480
  v_cvt_pk_bf16_f32 v188, v236, v237
  v_mfma_f32_16x16x32_bf16 v[200:203], v[52:55], v[104:107], v[200:203]
  v_cvt_pk_bf16_f32 v189, v238, v239
  v_mfma_f32_16x16x32_bf16 v[204:207], v[52:55], v[108:111], v[204:207]
  s_waitcnt lgkmcnt(3)
  v_mfma_f32_16x16x32_bf16 v[192:195], v[56:59], v[112:115], v[192:195]
  v_exp_f32 v244, v244
  v_mfma_f32_16x16x32_bf16 v[196:199], v[56:59], v[116:119], v[196:199]
  ds_read_b128 v[52:55], v24 offset:20480
  v_mfma_f32_16x16x32_bf16 v[200:203], v[56:59], v[120:123], v[200:203]
  v_exp_f32 v245, v245
  v_mfma_f32_16x16x32_bf16 v[204:207], v[56:59], v[124:127], v[204:207]
  v_exp_f32 v246, v246
  v_mfma_f32_16x16x32_bf16 v[192:195], v[60:63], v[128:131], v[192:195]
  v_exp_f32 v247, v247
  v_mfma_f32_16x16x32_bf16 v[196:199], v[60:63], v[132:135], v[196:199]
  ds_read_b64_tr_b16 v[56:57], v25 offset:8192
  ds_read_b64_tr_b16 v[58:59], v25 offset:12288
  v_mfma_f32_16x16x32_bf16 v[200:203], v[60:63], v[136:139], v[200:203]
  v_cvt_pk_bf16_f32 v178, v240, v241
  v_cvt_pk_bf16_f32 v179, v242, v243
  v_mfma_f32_16x16x32_bf16 v[204:207], v[60:63], v[140:143], v[204:207]
  s_waitcnt lgkmcnt(4)
  v_mfma_f32_16x16x32_bf16 v[208:211], v[64:67], v[80:83], v[144:147]
  v_exp_f32 v248, v248
  v_mfma_f32_16x16x32_bf16 v[212:215], v[64:67], v[84:87], v[148:151]
  ds_read_b64_tr_b16 v[60:61], v26 offset:8192
  ds_read_b64_tr_b16 v[62:63], v26 offset:12288
  v_mfma_f32_16x16x32_bf16 v[216:219], v[64:67], v[88:91], v[152:155]
  v_exp_f32 v249, v249
  v_mfma_f32_16x16x32_bf16 v[220:223], v[64:67], v[92:95], v[156:159]
  v_exp_f32 v250, v250
  v_mfma_f32_16x16x32_bf16 v[208:211], v[68:71], v[96:99], v[208:211]
  v_exp_f32 v251, v251
  v_mfma_f32_16x16x32_bf16 v[212:215], v[68:71], v[100:103], v[212:215]
  ds_read_b64_tr_b16 v[64:65], v27 offset:8192
  ds_read_b64_tr_b16 v[66:67], v27 offset:12288
  v_mfma_f32_16x16x32_bf16 v[216:219], v[68:71], v[104:107], v[216:219]
  v_cvt_pk_bf16_f32 v182, v244, v245
  v_cvt_pk_bf16_f32 v183, v246, v247
  v_mfma_f32_16x16x32_bf16 v[220:223], v[68:71], v[108:111], v[220:223]
  s_waitcnt lgkmcnt(6)
  v_mfma_f32_16x16x32_bf16 v[208:211], v[48:51], v[112:115], v[208:211]
  v_exp_f32 v252, v252
  v_mfma_f32_16x16x32_bf16 v[212:215], v[48:51], v[116:119], v[212:215]
  ds_read_b64_tr_b16 v[68:69], v28 offset:8192
  ds_read_b64_tr_b16 v[70:71], v28 offset:12288
  v_mfma_f32_16x16x32_bf16 v[216:219], v[48:51], v[120:123], v[216:219]
  v_exp_f32 v253, v253
  v_mfma_f32_16x16x32_bf16 v[220:223], v[48:51], v[124:127], v[220:223]
  v_exp_f32 v254, v254
  v_mfma_f32_16x16x32_bf16 v[208:211], v[52:55], v[128:131], v[208:211]
  v_exp_f32 v255, v255
  v_mfma_f32_16x16x32_bf16 v[212:215], v[52:55], v[132:135], v[212:215]
  v_cvt_pk_bf16_f32 v186, v248, v249
  v_cvt_pk_bf16_f32 v187, v250, v251
  v_mfma_f32_16x16x32_bf16 v[216:219], v[52:55], v[136:139], v[216:219]
  v_cvt_pk_bf16_f32 v190, v252, v253
  v_cvt_pk_bf16_f32 v191, v254, v255
  v_mfma_f32_16x16x32_bf16 v[220:223], v[52:55], v[140:143], v[220:223]
  s_waitcnt vmcnt(2)
  s_barrier
  s_waitcnt lgkmcnt(4)
  v_mfma_f32_16x16x32_bf16 a[0:3], v[56:59], v[176:179], a[0:3]
  ds_read_b64_tr_b16 v[48:49], v29 offset:8192
  ds_read_b64_tr_b16 v[50:51], v29 offset:12288
  v_mfma_f32_16x16x32_bf16 a[4:7], v[56:59], v[180:183], a[4:7]
  ds_read_b64_tr_b16 v[52:53], v30 offset:8192
  ds_read_b64_tr_b16 v[54:55], v30 offset:12288
  v_mfma_f32_16x16x32_bf16 a[8:11], v[56:59], v[184:187], a[8:11]
  v_exp_f32 v192, v192
  v_mfma_f32_16x16x32_bf16 a[12:15], v[56:59], v[188:191], a[12:15]
  v_exp_f32 v193, v193
  v_mfma_f32_16x16x32_bf16 a[16:19], v[60:63], v[176:179], a[16:19]
  v_exp_f32 v194, v194
  v_mfma_f32_16x16x32_bf16 a[20:23], v[60:63], v[180:183], a[20:23]
  ds_read_b64_tr_b16 v[56:57], v31 offset:8192
  ds_read_b64_tr_b16 v[58:59], v31 offset:12288
  v_mfma_f32_16x16x32_bf16 a[24:27], v[60:63], v[184:187], a[24:27]
  v_exp_f32 v195, v195
  v_mfma_f32_16x16x32_bf16 a[28:31], v[60:63], v[188:191], a[28:31]
  s_waitcnt lgkmcnt(6)
  v_mfma_f32_16x16x32_bf16 a[32:35], v[64:67], v[176:179], a[32:35]
  v_exp_f32 v196, v196
  v_mfma_f32_16x16x32_bf16 a[36:39], v[64:67], v[180:183], a[36:39]
  ds_read_b64_tr_b16 v[60:61], v32 offset:8192
  ds_read_b64_tr_b16 v[62:63], v32 offset:12288
  v_mfma_f32_16x16x32_bf16 a[40:43], v[64:67], v[184:187], a[40:43]
  v_exp_f32 v197, v197
  v_mfma_f32_16x16x32_bf16 a[44:47], v[64:67], v[188:191], a[44:47]
  v_exp_f32 v198, v198
  v_mfma_f32_16x16x32_bf16 a[48:51], v[68:71], v[176:179], a[48:51]
  v_exp_f32 v199, v199
  v_mfma_f32_16x16x32_bf16 a[52:55], v[68:71], v[180:183], a[52:55]
  v_cvt_pk_bf16_f32 v160, v192, v193
  v_cvt_pk_bf16_f32 v161, v194, v195
  v_mfma_f32_16x16x32_bf16 a[56:59], v[68:71], v[184:187], a[56:59]
  v_exp_f32 v200, v200
  v_mfma_f32_16x16x32_bf16 a[60:63], v[68:71], v[188:191], a[60:63]
  v_exp_f32 v201, v201
  v_mfma_f32_16x16x32_bf16 a[128:131], v[34:37], v[176:179], a[128:131]
  v_exp_f32 v202, v202
  v_mfma_f32_16x16x32_bf16 a[132:135], v[34:37], v[180:183], a[132:135]
  ds_read_b128 v[64:67], v21 offset:24576
  v_mfma_f32_16x16x32_bf16 a[136:139], v[34:37], v[184:187], a[136:139]
  v_exp_f32 v203, v203
  v_mfma_f32_16x16x32_bf16 a[140:143], v[34:37], v[188:191], a[140:143]
  v_cvt_pk_bf16_f32 v164, v196, v197
  s_waitcnt lgkmcnt(5)
  v_mfma_f32_16x16x32_bf16 a[64:67], v[48:51], v[176:179], a[64:67]
  v_cvt_pk_bf16_f32 v165, v198, v199
  v_mfma_f32_16x16x32_bf16 a[68:71], v[48:51], v[180:183], a[68:71]
  ds_read_b128 v[68:71], v22 offset:24576
  v_mfma_f32_16x16x32_bf16 a[72:75], v[48:51], v[184:187], a[72:75]
  v_exp_f32 v204, v204
  v_mfma_f32_16x16x32_bf16 a[76:79], v[48:51], v[188:191], a[76:79]
  v_exp_f32 v205, v205
  v_mfma_f32_16x16x32_bf16 a[80:83], v[52:55], v[176:179], a[80:83]
  v_exp_f32 v206, v206
  v_mfma_f32_16x16x32_bf16 a[84:87], v[52:55], v[180:183], a[84:87]
  ds_read_b128 v[48:51], v23 offset:24576
  v_mfma_f32_16x16x32_bf16 a[88:91], v[52:55], v[184:187], a[88:91]
  v_exp_f32 v207, v207
  v_mfma_f32_16x16x32_bf16 a[92:95], v[52:55], v[188:191], a[92:95]
  v_cvt_pk_bf16_f32 v168, v200, v201
  s_waitcnt lgkmcnt(3)
  v_mfma_f32_16x16x32_bf16 a[96:99], v[56:59], v[176:179], a[96:99]
  v_cvt_pk_bf16_f32 v169, v202, v203
  v_mfma_f32_16x16x32_bf16 a[100:103], v[56:59], v[180:183], a[100:103]
  ds_read_b128 v[52:55], v24 offset:24576
  v_mfma_f32_16x16x32_bf16 a[104:107], v[56:59], v[184:187], a[104:107]
  v_exp_f32 v208, v208
  v_mfma_f32_16x16x32_bf16 a[108:111], v[56:59], v[188:191], a[108:111]
  v_exp_f32 v209, v209
  v_mfma_f32_16x16x32_bf16 a[112:115], v[60:63], v[176:179], a[112:115]
  v_exp_f32 v210, v210
  v_mfma_f32_16x16x32_bf16 a[116:119], v[60:63], v[180:183], a[116:119]
  ds_read_b128 v[56:59], v21 offset:28672
  v_mfma_f32_16x16x32_bf16 a[120:123], v[60:63], v[184:187], a[120:123]
  v_exp_f32 v211, v211
  v_mfma_f32_16x16x32_bf16 a[124:127], v[60:63], v[188:191], a[124:127]
  v_cvt_pk_bf16_f32 v172, v204, v205
  s_waitcnt lgkmcnt(3)
  v_mfma_f32_16x16x32_bf16 v[224:227], v[64:67], v[80:83], v[144:147]
  v_cvt_pk_bf16_f32 v173, v206, v207
  v_mfma_f32_16x16x32_bf16 v[228:231], v[64:67], v[84:87], v[148:151]
  ds_read_b128 v[60:63], v22 offset:28672
  v_mfma_f32_16x16x32_bf16 v[232:235], v[64:67], v[88:91], v[152:155]
  v_exp_f32 v212, v212
  v_mfma_f32_16x16x32_bf16 v[236:239], v[64:67], v[92:95], v[156:159]
  v_exp_f32 v213, v213
  v_mfma_f32_16x16x32_bf16 v[224:227], v[68:71], v[96:99], v[224:227]
  v_exp_f32 v214, v214
  v_mfma_f32_16x16x32_bf16 v[228:231], v[68:71], v[100:103], v[228:231]
  ds_read_b128 v[64:67], v23 offset:28672
  v_mfma_f32_16x16x32_bf16 v[232:235], v[68:71], v[104:107], v[232:235]
  v_exp_f32 v215, v215
  v_mfma_f32_16x16x32_bf16 v[236:239], v[68:71], v[108:111], v[236:239]
  v_cvt_pk_bf16_f32 v162, v208, v209
  s_waitcnt lgkmcnt(3)
  v_mfma_f32_16x16x32_bf16 v[224:227], v[48:51], v[112:115], v[224:227]
  v_cvt_pk_bf16_f32 v163, v210, v211
  v_mfma_f32_16x16x32_bf16 v[228:231], v[48:51], v[116:119], v[228:231]
  ds_read_b128 v[68:71], v24 offset:28672
  v_mfma_f32_16x16x32_bf16 v[232:235], v[48:51], v[120:123], v[232:235]
  v_exp_f32 v216, v216
  v_mfma_f32_16x16x32_bf16 v[236:239], v[48:51], v[124:127], v[236:239]
  v_exp_f32 v217, v217
  v_mfma_f32_16x16x32_bf16 v[224:227], v[52:55], v[128:131], v[224:227]
  v_exp_f32 v218, v218
  v_mfma_f32_16x16x32_bf16 v[228:231], v[52:55], v[132:135], v[228:231]
  ds_read_b64_tr_b16 v[48:49], v25 offset:16384
  ds_read_b64_tr_b16 v[50:51], v25 offset:20480
  v_mfma_f32_16x16x32_bf16 v[232:235], v[52:55], v[136:139], v[232:235]
  v_exp_f32 v219, v219
  v_mfma_f32_16x16x32_bf16 v[236:239], v[52:55], v[140:143], v[236:239]
  v_cvt_pk_bf16_f32 v166, v212, v213
  s_waitcnt lgkmcnt(4)
  v_mfma_f32_16x16x32_bf16 v[240:243], v[56:59], v[80:83], v[144:147]
  v_cvt_pk_bf16_f32 v167, v214, v215
  v_mfma_f32_16x16x32_bf16 v[244:247], v[56:59], v[84:87], v[148:151]
  ds_read_b64_tr_b16 v[52:53], v26 offset:16384
  ds_read_b64_tr_b16 v[54:55], v26 offset:20480
  v_mfma_f32_16x16x32_bf16 v[248:251], v[56:59], v[88:91], v[152:155]
  v_exp_f32 v220, v220
  v_mfma_f32_16x16x32_bf16 v[252:255], v[56:59], v[92:95], v[156:159]
  v_exp_f32 v221, v221
  v_mfma_f32_16x16x32_bf16 v[240:243], v[60:63], v[96:99], v[240:243]
  v_exp_f32 v222, v222
  v_mfma_f32_16x16x32_bf16 v[244:247], v[60:63], v[100:103], v[244:247]
  ds_read_b64_tr_b16 v[56:57], v27 offset:16384
  ds_read_b64_tr_b16 v[58:59], v27 offset:20480
  v_mfma_f32_16x16x32_bf16 v[248:251], v[60:63], v[104:107], v[248:251]
  v_exp_f32 v223, v223
  v_mfma_f32_16x16x32_bf16 v[252:255], v[60:63], v[108:111], v[252:255]
  v_cvt_pk_bf16_f32 v170, v216, v217
  s_waitcnt lgkmcnt(6)
  v_mfma_f32_16x16x32_bf16 v[240:243], v[64:67], v[112:115], v[240:243]
  v_cvt_pk_bf16_f32 v171, v218, v219
  v_cvt_pk_bf16_f32 v174, v220, v221
  v_mfma_f32_16x16x32_bf16 v[244:247], v[64:67], v[116:119], v[244:247]
  ds_read_b64_tr_b16 v[60:61], v28 offset:16384
  v_cvt_pk_bf16_f32 v175, v222, v223
  v_mfma_f32_16x16x32_bf16 v[248:251], v[64:67], v[120:123], v[248:251]
  ds_read_b64_tr_b16 v[62:63], v28 offset:20480
  v_mfma_f32_16x16x32_bf16 v[252:255], v[64:67], v[124:127], v[252:255]
  v_exp_f32 v224, v224
  v_mfma_f32_16x16x32_bf16 v[240:243], v[68:71], v[128:131], v[240:243]
  v_exp_f32 v225, v225
  v_mfma_f32_16x16x32_bf16 v[244:247], v[68:71], v[132:135], v[244:247]
  ds_read_b64_tr_b16 v[64:65], v29 offset:16384
  ds_read_b64_tr_b16 v[66:67], v29 offset:20480
  v_mfma_f32_16x16x32_bf16 v[248:251], v[68:71], v[136:139], v[248:251]
  v_exp_f32 v226, v226
  v_mfma_f32_16x16x32_bf16 v[252:255], v[68:71], v[140:143], v[252:255]
  s_waitcnt vmcnt(0)
  s_barrier
  s_waitcnt lgkmcnt(6)
  v_mfma_f32_16x16x32_bf16 a[0:3], v[48:51], v[160:163], a[0:3]
  v_exp_f32 v227, v227
  v_mfma_f32_16x16x32_bf16 a[4:7], v[48:51], v[164:167], a[4:7]
  ds_read_b64_tr_b16 v[68:69], v30 offset:16384
  ds_read_b64_tr_b16 v[70:71], v30 offset:20480
  v_mfma_f32_16x16x32_bf16 a[8:11], v[48:51], v[168:171], a[8:11]
  s_add_u32 m0, s40, 0
  v_mfma_f32_16x16x32_bf16 a[12:15], v[48:51], v[172:175], a[12:15]
  v_exp_f32 v228, v228
  v_mfma_f32_16x16x32_bf16 a[16:19], v[52:55], v[160:163], a[16:19]
  v_exp_f32 v229, v229
  v_mfma_f32_16x16x32_bf16 a[20:23], v[52:55], v[164:167], a[20:23]
  ds_read_b64_tr_b16 v[48:49], v31 offset:16384
  ds_read_b64_tr_b16 v[50:51], v31 offset:20480
  v_mfma_f32_16x16x32_bf16 a[24:27], v[52:55], v[168:171], a[24:27]
  buffer_load_dwordx4 v1, s[8:11], s86 offen offset:0 lds
  v_mfma_f32_16x16x32_bf16 a[28:31], v[52:55], v[172:175], a[28:31]
  s_waitcnt lgkmcnt(6)
  v_mfma_f32_16x16x32_bf16 a[32:35], v[56:59], v[160:163], a[32:35]
  v_exp_f32 v230, v230
  v_mfma_f32_16x16x32_bf16 a[36:39], v[56:59], v[164:167], a[36:39]
  ds_read_b64_tr_b16 v[52:53], v32 offset:16384
  ds_read_b64_tr_b16 v[54:55], v32 offset:20480
  v_mfma_f32_16x16x32_bf16 a[40:43], v[56:59], v[168:171], a[40:43]
  buffer_load_dwordx4 v2, s[8:11], s86 offen offset:1024 lds
  v_mfma_f32_16x16x32_bf16 a[44:47], v[56:59], v[172:175], a[44:47]
  v_exp_f32 v231, v231
  v_mfma_f32_16x16x32_bf16 a[48:51], v[60:63], v[160:163], a[48:51]
  v_cvt_pk_bf16_f32 v176, v224, v225
  v_cvt_pk_bf16_f32 v177, v226, v227
  v_mfma_f32_16x16x32_bf16 a[52:55], v[60:63], v[164:167], a[52:55]
  buffer_load_dwordx4 v3, s[8:11], s86 offen offset:2048 lds
  v_mfma_f32_16x16x32_bf16 a[56:59], v[60:63], v[168:171], a[56:59]
  v_exp_f32 v232, v232
  v_mfma_f32_16x16x32_bf16 a[60:63], v[60:63], v[172:175], a[60:63]
  v_exp_f32 v233, v233
  v_mfma_f32_16x16x32_bf16 a[128:131], v[34:37], v[160:163], a[128:131]
  v_exp_f32 v234, v234
  v_mfma_f32_16x16x32_bf16 a[132:135], v[34:37], v[164:167], a[132:135]
  ds_read_b64_tr_b16 v[56:57], v25 offset:24576
  ds_read_b64_tr_b16 v[58:59], v25 offset:28672
  v_mfma_f32_16x16x32_bf16 a[136:139], v[34:37], v[168:171], a[136:139]
  buffer_load_dwordx4 v4, s[8:11], s86 offen offset:3072 lds
  v_mfma_f32_16x16x32_bf16 a[140:143], v[34:37], v[172:175], a[140:143]
  s_waitcnt lgkmcnt(6)
  v_mfma_f32_16x16x32_bf16 a[64:67], v[64:67], v[160:163], a[64:67]
  v_exp_f32 v235, v235
  v_mfma_f32_16x16x32_bf16 a[68:71], v[64:67], v[164:167], a[68:71]
  ds_read_b64_tr_b16 v[60:61], v26 offset:24576
  ds_read_b64_tr_b16 v[62:63], v26 offset:28672
  v_mfma_f32_16x16x32_bf16 a[72:75], v[64:67], v[168:171], a[72:75]
  s_add_u32 m0, s40, 4096
  v_cvt_pk_bf16_f32 v180, v228, v229
  v_mfma_f32_16x16x32_bf16 a[76:79], v[64:67], v[172:175], a[76:79]
  v_cvt_pk_bf16_f32 v181, v230, v231
  v_mfma_f32_16x16x32_bf16 a[80:83], v[68:71], v[160:163], a[80:83]
  v_exp_f32 v236, v236
  v_mfma_f32_16x16x32_bf16 a[84:87], v[68:71], v[164:167], a[84:87]
  ds_read_b64_tr_b16 v[64:65], v27 offset:24576
  ds_read_b64_tr_b16 v[66:67], v27 offset:28672
  v_mfma_f32_16x16x32_bf16 a[88:91], v[68:71], v[168:171], a[88:91]
  v_exp_f32 v237, v237
  v_mfma_f32_16x16x32_bf16 a[92:95], v[68:71], v[172:175], a[92:95]
  s_waitcnt lgkmcnt(6)
  v_mfma_f32_16x16x32_bf16 a[96:99], v[48:51], v[160:163], a[96:99]
  v_exp_f32 v238, v238
  v_mfma_f32_16x16x32_bf16 a[100:103], v[48:51], v[164:167], a[100:103]
  ds_read_b64_tr_b16 v[68:69], v28 offset:24576
  ds_read_b64_tr_b16 v[70:71], v28 offset:28672
  v_mfma_f32_16x16x32_bf16 a[104:107], v[48:51], v[168:171], a[104:107]
  v_exp_f32 v239, v239
  v_mfma_f32_16x16x32_bf16 a[108:111], v[48:51], v[172:175], a[108:111]
  v_cvt_pk_bf16_f32 v184, v232, v233
  v_cvt_pk_bf16_f32 v185, v234, v235
  v_mfma_f32_16x16x32_bf16 a[112:115], v[52:55], v[160:163], a[112:115]
  v_exp_f32 v240, v240
  v_mfma_f32_16x16x32_bf16 a[116:119], v[52:55], v[164:167], a[116:119]
  v_exp_f32 v241, v241
  v_mfma_f32_16x16x32_bf16 a[120:123], v[52:55], v[168:171], a[120:123]
  v_exp_f32 v242, v242
  v_exp_f32 v243, v243
  v_cvt_pk_bf16_f32 v188, v236, v237
  v_cvt_pk_bf16_f32 v189, v238, v239
  v_exp_f32 v244, v244
  v_exp_f32 v245, v245
  v_exp_f32 v246, v246
  v_exp_f32 v247, v247
  v_cvt_pk_bf16_f32 v178, v240, v241
  v_cvt_pk_bf16_f32 v179, v242, v243
  v_exp_f32 v248, v248
  v_exp_f32 v249, v249
  v_exp_f32 v250, v250
  v_exp_f32 v251, v251
  v_cvt_pk_bf16_f32 v182, v244, v245
  v_cvt_pk_bf16_f32 v183, v246, v247
  v_exp_f32 v252, v252
  v_exp_f32 v253, v253
  v_exp_f32 v254, v254
  v_exp_f32 v255, v255
  v_cvt_pk_bf16_f32 v186, v248, v249
  v_cvt_pk_bf16_f32 v187, v250, v251
  v_cvt_pk_bf16_f32 v190, v252, v253
  v_cvt_pk_bf16_f32 v191, v254, v255
  v_mfma_f32_16x16x32_bf16 a[124:127], v[52:55], v[172:175], a[124:127]
  ds_read_b64_tr_b16 v[48:49], v29 offset:24576
  s_waitcnt lgkmcnt(5)
  v_mfma_f32_16x16x32_bf16 a[0:3], v[56:59], v[176:179], a[0:3]
  buffer_load_dwordx4 v5, s[8:11], s86 offen offset:0 lds
  v_mfma_f32_16x16x32_bf16 a[4:7], v[56:59], v[180:183], a[4:7]
  ds_read_b64_tr_b16 v[50:51], v29 offset:28672
  v_mfma_f32_16x16x32_bf16 a[8:11], v[56:59], v[184:187], a[8:11]
  buffer_load_dwordx4 v6, s[8:11], s86 offen offset:1024 lds
  v_mfma_f32_16x16x32_bf16 a[12:15], v[56:59], v[188:191], a[12:15]
  buffer_load_dwordx4 v7, s[8:11], s86 offen offset:2048 lds
  v_mfma_f32_16x16x32_bf16 a[128:131], v[34:37], v[176:179], a[128:131]
  buffer_load_dwordx4 v8, s[8:11], s86 offen offset:3072 lds
  v_mfma_f32_16x16x32_bf16 a[132:135], v[34:37], v[180:183], a[132:135]
  ds_read_b64_tr_b16 v[52:53], v30 offset:24576
  ds_read_b64_tr_b16 v[54:55], v30 offset:28672
  v_mfma_f32_16x16x32_bf16 a[136:139], v[34:37], v[184:187], a[136:139]
  s_add_u32 m0, s40, 8192
  v_mfma_f32_16x16x32_bf16 a[140:143], v[34:37], v[188:191], a[140:143]
  v_mfma_f32_16x16x32_bf16 a[16:19], v[60:63], v[176:179], a[16:19]
  v_mfma_f32_16x16x32_bf16 a[20:23], v[60:63], v[180:183], a[20:23]
  ds_read_b64_tr_b16 v[56:57], v31 offset:24576
  ds_read_b64_tr_b16 v[58:59], v31 offset:28672
  v_mfma_f32_16x16x32_bf16 a[24:27], v[60:63], v[184:187], a[24:27]
  buffer_load_dwordx4 v9, s[8:11], s86 offen offset:0 lds
  v_mfma_f32_16x16x32_bf16 a[28:31], v[60:63], v[188:191], a[28:31]
  s_waitcnt lgkmcnt(6)
  v_mfma_f32_16x16x32_bf16 a[32:35], v[64:67], v[176:179], a[32:35]
  v_mfma_f32_16x16x32_bf16 a[36:39], v[64:67], v[180:183], a[36:39]
  ds_read_b64_tr_b16 v[60:61], v32 offset:24576
  ds_read_b64_tr_b16 v[62:63], v32 offset:28672
  v_mfma_f32_16x16x32_bf16 a[40:43], v[64:67], v[184:187], a[40:43]
  v_accvgpr_read_b32 v40, a128
  v_accvgpr_read_b32 v41, a132
  v_mfma_f32_16x16x32_bf16 a[44:47], v[64:67], v[188:191], a[44:47]
  v_accvgpr_read_b32 v42, a136
  v_accvgpr_read_b32 v43, a140
  v_mfma_f32_16x16x32_bf16 a[48:51], v[68:71], v[176:179], a[48:51]
  v_add_f32 v38, v40, v41
  v_add_f32 v39, v42, v43
  v_mfma_f32_16x16x32_bf16 a[52:55], v[68:71], v[180:183], a[52:55]
  s_mov_b32 s70, 0x4e800000
  v_add_f32 v38, v38, v39
  v_mfma_f32_16x16x32_bf16 a[56:59], v[68:71], v[184:187], a[56:59]
  v_cmp_ngt_f32 vcc, s70, v38
  s_lshl_b32 s70, s3, 2
  v_mfma_f32_16x16x32_bf16 a[60:63], v[68:71], v[188:191], a[60:63]
  s_add_u32 s70, s70, 163808
  s_waitcnt lgkmcnt(4)
  v_mfma_f32_16x16x32_bf16 a[64:67], v[48:51], v[176:179], a[64:67]
  v_mov_b32 v45, s70
  v_mfma_f32_16x16x32_bf16 a[68:71], v[48:51], v[180:183], a[68:71]
  s_cmp_lg_u64 vcc, 0
  s_cselect_b32 s70, 1, 0
  v_mfma_f32_16x16x32_bf16 a[72:75], v[48:51], v[184:187], a[72:75]
  v_mov_b32 v46, s70
  ds_write_b32 v45, v46
  v_mfma_f32_16x16x32_bf16 a[76:79], v[48:51], v[188:191], a[76:79]
  v_mov_b32 v45, 163808
  v_mfma_f32_16x16x32_bf16 a[80:83], v[52:55], v[176:179], a[80:83]
  v_rcp_f32 v40, v40
  v_mfma_f32_16x16x32_bf16 a[84:87], v[52:55], v[180:183], a[84:87]
  v_rcp_f32 v41, v41
  v_mfma_f32_16x16x32_bf16 a[88:91], v[52:55], v[184:187], a[88:91]
  v_rcp_f32 v42, v42
  v_mfma_f32_16x16x32_bf16 a[92:95], v[52:55], v[188:191], a[92:95]
  s_waitcnt lgkmcnt(1)
  v_mfma_f32_16x16x32_bf16 a[96:99], v[56:59], v[176:179], a[96:99]
  v_rcp_f32 v43, v43
  v_mfma_f32_16x16x32_bf16 a[100:103], v[56:59], v[180:183], a[100:103]
  v_accvgpr_read_b32 v192, a0
  v_accvgpr_read_b32 v193, a1
  v_mfma_f32_16x16x32_bf16 a[104:107], v[56:59], v[184:187], a[104:107]
  v_accvgpr_read_b32 v194, a2
  v_accvgpr_read_b32 v195, a3
  v_mfma_f32_16x16x32_bf16 a[108:111], v[56:59], v[188:191], a[108:111]
  v_accvgpr_read_b32 v224, a16
  v_accvgpr_read_b32 v225, a17
  v_mfma_f32_16x16x32_bf16 a[112:115], v[60:63], v[176:179], a[112:115]
  v_accvgpr_read_b32 v226, a18
  v_accvgpr_read_b32 v227, a19
  v_mfma_f32_16x16x32_bf16 a[116:119], v[60:63], v[180:183], a[116:119]
  v_mul_f32 v192, v192, v40
  v_mul_f32 v193, v193, v40
  v_mfma_f32_16x16x32_bf16 a[120:123], v[60:63], v[184:187], a[120:123]
  v_mul_f32 v194, v194, v40
  v_mul_f32 v195, v195, v40
  v_mfma_f32_16x16x32_bf16 a[124:127], v[60:63], v[188:191], a[124:127]
  v_mul_f32 v224, v224, v40
  v_mul_f32 v225, v225, v40
  v_mul_f32 v226, v226, v40
  v_mul_f32 v227, v227, v40
  v_cvt_pk_bf16_f32 v192, v192, v193
  v_cvt_pk_bf16_f32 v193, v194, v195
  v_cvt_pk_bf16_f32 v194, v224, v225
  v_cvt_pk_bf16_f32 v195, v226, v227
  s_mov_b32 s68, 0
  buffer_store_dwordx4 v[192:195], v16, s[32:35], s68 offen offset:0 sc1
  v_accvgpr_read_b32 v196, a4
  v_accvgpr_read_b32 v197, a5
  v_accvgpr_read_b32 v198, a6
  v_accvgpr_read_b32 v199, a7
  v_accvgpr_read_b32 v224, a20
  v_accvgpr_read_b32 v225, a21
  v_accvgpr_read_b32 v226, a22
  v_accvgpr_read_b32 v227, a23
  v_mul_f32 v196, v196, v41
  v_mul_f32 v197, v197, v41
  v_mul_f32 v198, v198, v41
  v_mul_f32 v199, v199, v41
  v_mul_f32 v224, v224, v41
  v_mul_f32 v225, v225, v41
  v_mul_f32 v226, v226, v41
  v_mul_f32 v227, v227, v41
  v_cvt_pk_bf16_f32 v196, v196, v197
  v_cvt_pk_bf16_f32 v197, v198, v199
  v_cvt_pk_bf16_f32 v198, v224, v225
  v_cvt_pk_bf16_f32 v199, v226, v227
  s_mov_b32 s68, 0
  buffer_store_dwordx4 v[196:199], v16, s[32:35], s68 offen offset:1024 sc1
  v_accvgpr_read_b32 v200, a8
  v_accvgpr_read_b32 v201, a9
  v_accvgpr_read_b32 v202, a10
  v_accvgpr_read_b32 v203, a11
  v_accvgpr_read_b32 v224, a24
  v_accvgpr_read_b32 v225, a25
  v_accvgpr_read_b32 v226, a26
  v_accvgpr_read_b32 v227, a27
  v_mul_f32 v200, v200, v42
  v_mul_f32 v201, v201, v42
  v_mul_f32 v202, v202, v42
  v_mul_f32 v203, v203, v42
  v_mul_f32 v224, v224, v42
  v_mul_f32 v225, v225, v42
  v_mul_f32 v226, v226, v42
  v_mul_f32 v227, v227, v42
  v_cvt_pk_bf16_f32 v200, v200, v201
  v_cvt_pk_bf16_f32 v201, v202, v203
  v_cvt_pk_bf16_f32 v202, v224, v225
  v_cvt_pk_bf16_f32 v203, v226, v227
  s_mov_b32 s68, 0
  buffer_store_dwordx4 v[200:203], v16, s[32:35], s68 offen offset:2048 sc1
  v_accvgpr_read_b32 v204, a12
  v_accvgpr_read_b32 v205, a13
  v_accvgpr_read_b32 v206, a14
  v_accvgpr_read_b32 v207, a15
  v_accvgpr_read_b32 v224, a28
  v_accvgpr_read_b32 v225, a29
  v_accvgpr_read_b32 v226, a30
  v_accvgpr_read_b32 v227, a31
  v_mul_f32 v204, v204, v43
  v_mul_f32 v205, v205, v43
  v_mul_f32 v206, v206, v43
  v_mul_f32 v207, v207, v43
  v_mul_f32 v224, v224, v43
  v_mul_f32 v225, v225, v43
  v_mul_f32 v226, v226, v43
  v_mul_f32 v227, v227, v43
  v_cvt_pk_bf16_f32 v204, v204, v205
  v_cvt_pk_bf16_f32 v205, v206, v207
  v_cvt_pk_bf16_f32 v206, v224, v225
  v_cvt_pk_bf16_f32 v207, v226, v227
  s_mov_b32 s68, 0
  buffer_store_dwordx4 v[204:207], v16, s[32:35], s68 offen offset:3072 sc1
  v_accvgpr_read_b32 v208, a32
  v_accvgpr_read_b32 v209, a33
  v_accvgpr_read_b32 v210, a34
  v_accvgpr_read_b32 v211, a35
  v_accvgpr_read_b32 v224, a48
  v_accvgpr_read_b32 v225, a49
  v_accvgpr_read_b32 v226, a50
  v_accvgpr_read_b32 v227, a51
  v_mul_f32 v208, v208, v40
  v_mul_f32 v209, v209, v40
  v_mul_f32 v210, v210, v40
  v_mul_f32 v211, v211, v40
  v_mul_f32 v224, v224, v40
  v_mul_f32 v225, v225, v40
  v_mul_f32 v226, v226, v40
  v_mul_f32 v227, v227, v40
  v_cvt_pk_bf16_f32 v208, v208, v209
  v_cvt_pk_bf16_f32 v209, v210, v211
  v_cvt_pk_bf16_f32 v210, v224, v225
  v_cvt_pk_bf16_f32 v211, v226, v227
  s_mov_b32 s68, 4096
  buffer_store_dwordx4 v[208:211], v16, s[32:35], s68 offen offset:0 sc1
  v_accvgpr_read_b32 v212, a36
  v_accvgpr_read_b32 v213, a37
  v_accvgpr_read_b32 v214, a38
  v_accvgpr_read_b32 v215, a39
  v_accvgpr_read_b32 v224, a52
  v_accvgpr_read_b32 v225, a53
  v_accvgpr_read_b32 v226, a54
  v_accvgpr_read_b32 v227, a55
  v_mul_f32 v212, v212, v41
  v_mul_f32 v213, v213, v41
  v_mul_f32 v214, v214, v41
  v_mul_f32 v215, v215, v41
  v_mul_f32 v224, v224, v41
  v_mul_f32 v225, v225, v41
  v_mul_f32 v226, v226, v41
  v_mul_f32 v227, v227, v41
  v_cvt_pk_bf16_f32 v212, v212, v213
  v_cvt_pk_bf16_f32 v213, v214, v215
  v_cvt_pk_bf16_f32 v214, v224, v225
  v_cvt_pk_bf16_f32 v215, v226, v227
  s_mov_b32 s68, 4096
  buffer_store_dwordx4 v[212:215], v16, s[32:35], s68 offen offset:1024 sc1
  v_accvgpr_read_b32 v216, a40
  v_accvgpr_read_b32 v217, a41
  v_accvgpr_read_b32 v218, a42
  v_accvgpr_read_b32 v219, a43
  v_accvgpr_read_b32 v224, a56
  v_accvgpr_read_b32 v225, a57
  v_accvgpr_read_b32 v226, a58
  v_accvgpr_read_b32 v227, a59
  v_mul_f32 v216, v216, v42
  v_mul_f32 v217, v217, v42
  v_mul_f32 v218, v218, v42
  v_mul_f32 v219, v219, v42
  v_mul_f32 v224, v224, v42
  v_mul_f32 v225, v225, v42
  v_mul_f32 v226, v226, v42
  v_mul_f32 v227, v227, v42
  v_cvt_pk_bf16_f32 v216, v216, v217
  v_cvt_pk_bf16_f32 v217, v218, v219
  v_cvt_pk_bf16_f32 v218, v224, v225
  v_cvt_pk_bf16_f32 v219, v226, v227
  s_mov_b32 s68, 4096
  buffer_store_dwordx4 v[216:219], v16, s[32:35], s68 offen offset:2048 sc1
  v_accvgpr_read_b32 v220, a44
  v_accvgpr_read_b32 v221, a45
  v_accvgpr_read_b32 v222, a46
  v_accvgpr_read_b32 v223, a47
  v_accvgpr_read_b32 v224, a60
  v_accvgpr_read_b32 v225, a61
  v_accvgpr_read_b32 v226, a62
  v_accvgpr_read_b32 v227, a63
  v_mul_f32 v220, v220, v43
  v_mul_f32 v221, v221, v43
  v_mul_f32 v222, v222, v43
  v_mul_f32 v223, v223, v43
  v_mul_f32 v224, v224, v43
  v_mul_f32 v225, v225, v43
  v_mul_f32 v226, v226, v43
  v_mul_f32 v227, v227, v43
  v_cvt_pk_bf16_f32 v220, v220, v221
  v_cvt_pk_bf16_f32 v221, v222, v223
  v_cvt_pk_bf16_f32 v222, v224, v225
  v_cvt_pk_bf16_f32 v223, v226, v227
  s_mov_b32 s68, 4096
  buffer_store_dwordx4 v[220:223], v16, s[32:35], s68 offen offset:3072 sc1
  s_waitcnt vmcnt(0) lgkmcnt(0)
  s_branch L_attn_done
.section .rodata,"a"
.p2align 6
.amdhsa_kernel recurrent_scan__sliding_block_cached__dense_activation_silu__prompt_kernel
  .amdhsa_next_free_vgpr 512
  .amdhsa_next_free_sgpr 102
  .amdhsa_accum_offset 256
  .amdhsa_group_segment_fixed_size 0
  .amdhsa_kernarg_size 88
  .amdhsa_user_sgpr_count 2
  .amdhsa_user_sgpr_kernarg_segment_ptr 1
  .amdhsa_system_sgpr_workgroup_id_x 1
.end_amdhsa_kernel
```
